```python
import torch

def _softmax(x, axis=-1):
    return torch.softmax(x, dim=axis)

def _gelu(x):
    return torch.nn.functional.gelu(x, approximate='tanh')

def _silu(x):
    return torch.nn.functional.silu(x)

def _sigmoid(x):
    return torch.sigmoid(x)

def _layernorm(x, axis=-1, eps=1e-05):
    m = x.mean(dim=axis, keepdim=True)
    v = x.var(dim=axis, keepdim=True, unbiased=False)
    return (x - m) / torch.sqrt(v + eps)

def _scatter_add(tgt, idx, src, axis=0):
    return tgt.clone().index_add_(axis, idx, src)

def _segment_sum(src, seg, n):
    out = torch.zeros((n,) + src.shape[1:], dtype=src.dtype)
    return out.index_add_(0, seg, src)

def _pad(x, pw):
    flat = tuple((v for pair in reversed(pw) for v in pair))
    return torch.nn.functional.pad(x, flat)
kernel_name = 'interleave_layers__memory_aug_recurrent_mem_tr__spectral_gfnet__prompt'

def setup_inputs():

    _w = lambda a: (lambda t: t.to(torch.bfloat16) if t.is_floating_point() else t)(torch.as_tensor(a))

    def _A_setup():
        B, S, Dm = (1, 2048, 640)
        H, Dh = (32, 128)
        M, seg = (8, 32)
        seg = min(seg, S)
        S = S // seg * seg
        return {'x': _w((lambda *s: torch.randn(*s, dtype=torch.bfloat16) * 0.05)(B, S, Dm)), 'mem0': _w((lambda *s: torch.randn(*s, dtype=torch.bfloat16) * 0.2)(B, M, Dm)), 'Wq': _w((lambda *s: torch.randn(*s, dtype=torch.bfloat16) * 1.6)(Dm, H, Dh) * Dm ** (-0.5)), 'Wk': _w((lambda *s: torch.randn(*s, dtype=torch.bfloat16) * 1.6)(Dm, H, Dh) * Dm ** (-0.5)), 'Wv': _w((lambda *s: torch.randn(*s, dtype=torch.bfloat16) * 0.2)(Dm, H, Dh) * Dm ** (-0.5)), 'Wo': _w((lambda *s: torch.randn(*s, dtype=torch.bfloat16) * 0.2)(H, Dh, Dm) * (H * Dh) ** (-0.5)), 'seg_len': seg}
    _A_in = _A_setup()

    def _B_setup():
        B, S, D = (1, 2048, 640)
        Df = D // 2 + 1
        return {'x': _w((lambda *s: torch.randn(*s, dtype=torch.bfloat16) * 0.05)(B, S, D)), 'w_r': _w((lambda *s: torch.randn(*s, dtype=torch.bfloat16) * 0.4)(S, Df) * 0.02), 'w_i': _w((lambda *s: torch.randn(*s, dtype=torch.bfloat16) * 0.4)(S, Df) * 0.02)}
    _B_in = _B_setup()
    return {'A_x': _A_in['x'], 'A_mem0': _A_in['mem0'], 'A_Wq': _A_in['Wq'], 'A_Wk': _A_in['Wk'], 'A_Wv': _A_in['Wv'], 'A_Wo': _A_in['Wo'], 'A_seg_len': _A_in['seg_len'], 'B_x': _B_in['x'], 'B_w_r': _B_in['w_r'], 'B_w_i': _B_in['w_i']}

def reference(A_x, A_mem0, A_Wq, A_Wk, A_Wv, A_Wo, A_seg_len, B_x, B_w_r, B_w_i):

    def _A_ref(x, mem0, Wq, Wk, Wv, Wo, seg_len):
        B, S, Dm = x.shape
        H, Dh = (Wq.shape[1], Wq.shape[2])
        M = mem0.shape[1]
        scale = Dh ** (-0.5)
        n_seg = S // seg_len
        L = M + seg_len
        idx = torch.arange(L)
        mask = (idx[:, None] < M) | (idx[:, None] >= idx[None, :])
        mem = mem0
        outs = []
        for s in range(n_seg):
            xs = x[:, s * seg_len:(s + 1) * seg_len, :].clone()
            h = torch.concatenate([mem, xs], axis=1)
            q = torch.einsum('btd,dhe->bhte', h, Wq)
            k = torch.einsum('btd,dhe->bhte', h, Wk)
            v = torch.einsum('btd,dhe->bhte', h, Wv)
            scores = torch.einsum('bhqe,bhke->bhqk', q, k) * scale
            scores = torch.where(mask[None, None], scores, -1000000000.0)
            p = _softmax(scores, axis=-1)
            o = torch.einsum('bhqk,bhke->bhqe', p, v)
            o = torch.einsum('bhte,hed->btd', o, Wo)
            mem = o[:, :M, :].clone()
            outs.append(o[:, M:, :])
        return torch.concatenate(outs, axis=1)

    def _B_ref(x, w_r, w_i):
        B, S, D = x.shape
        X = (lambda x, axes=(-2, -1): torch.fft.rfft2(x.float(), dim=axes))(x, axes=(-2, -1))
        W = w_r + 1j * w_i
        X = X * W
        y = (lambda x, s, axes=(-2, -1): torch.fft.irfft2(x, s=s, dim=axes).to(torch.bfloat16))(X, (S, D), axes=(-2, -1))
        return y
    x = A_x
    x = x + _A_ref(_layernorm(x, axis=-1), A_mem0, A_Wq, A_Wk, A_Wv, A_Wo, A_seg_len)
    x = x + _B_ref(_layernorm(x, axis=-1), B_w_r, B_w_i)
    x = x + _A_ref(_layernorm(x, axis=-1), A_mem0, A_Wq, A_Wk, A_Wv, A_Wo, A_seg_len)
    x = x + _B_ref(_layernorm(x, axis=-1), B_w_r, B_w_i)
    return x
```

```asm
; @launch grid=(256,1,1) block=(256,1,1) lds=163840
.amdgcn_target "amdgcn-amd-amdhsa--gfx950"
.text
.globl interleave_layers__memory_aug_recurrent_mem_tr__spectral_gfnet__prompt_kernel
.p2align 8
.type interleave_layers__memory_aug_recurrent_mem_tr__spectral_gfnet__prompt_kernel,@function
interleave_layers__memory_aug_recurrent_mem_tr__spectral_gfnet__prompt_kernel:
s_load_dwordx2 s[72:73], s[0:1], 8
s_load_dwordx4 s[76:79], s[0:1], 16
s_load_dwordx4 s[80:83], s[0:1], 32
s_load_dwordx2 s[28:29], s[0:1], 88
s_load_dwordx2 s[74:75], s[0:1], 96
v_lshrrev_b32 v1, 6, v0
v_and_b32 v0, 63, v0
v_readfirstlane_b32 s3, v1
s_waitcnt lgkmcnt(0)
s_mov_b32 s4, s74
s_mov_b32 s5, s75
s_mov_b32 s6, 268435456
s_mov_b32 s7, 0x20000
s_mov_b32 s8, s76
s_mov_b32 s9, s77
s_mov_b32 s10, 5242880
s_mov_b32 s11, 0x20000
s_mov_b32 s12, s78
s_mov_b32 s13, s79
s_mov_b32 s14, 5242880
s_mov_b32 s15, 0x20000
s_mov_b32 s16, s80
s_mov_b32 s17, s81
s_mov_b32 s18, 5242880
s_mov_b32 s19, 0x20000
s_mov_b32 s20, s82
s_mov_b32 s21, s83
s_mov_b32 s22, 5242880
s_mov_b32 s23, 0x20000
s_mov_b32 s24, s72
s_mov_b32 s25, s73
s_mov_b32 s26, 10240
s_mov_b32 s27, 0x20000
s_mov_b32 s32, 400000
s_getreg_b32 s52, hwreg(HW_REG_XCC_ID, 0, 4)
s_cmp_lg_u32 s3, 0
s_cbranch_scc1 k_skip_1
s_mov_b64 exec, 1
s_lshl_b32 s53, s52, 2
v_mov_b32 v1, s53
v_mov_b32 v2, 1
global_atomic_add v3, v1, v2, s[28:29] sc0 sc1
v_mov_b32 v1, 0
s_waitcnt vmcnt(0)
ds_write_b32 v1, v3
s_mov_b64 exec, -1
s_waitcnt lgkmcnt(0)
k_skip_1:
s_barrier
v_mov_b32 v1, 0
ds_read_b32 v2, v1
s_waitcnt lgkmcnt(0)
v_readfirstlane_b32 s30, v2
s_barrier
s_cmp_gt_u32 s30, 31
s_cbranch_scc1 k_end_2
s_cmp_eq_u32 s52, 0
s_cbranch_scc1 k_team_3
v_lshlrev_b32 v0, 4, v0
s_cmp_gt_u32 s52, 7
s_cbranch_scc1 k_end_2
s_cmp_gt_u32 s30, 29
s_cbranch_scc1 k_end_2
s_cmp_gt_u32 s52, 4
s_cbranch_scc1 k_nb_8
s_mul_i32 s53, s52, 20
s_add_u32 s53, s53, s30
s_sub_u32 s53, s53, 20
s_cmp_lt_u32 s30, 20
s_cmov_b32 s30, s53
s_cbranch_scc1 k_o_4
s_mul_i32 s53, s52, 10
s_add_u32 s30, s30, s53
s_sub_u32 s30, s30, 30
s_cmp_lt_u32 s30, 32
s_cbranch_scc1 k_at_5
s_sub_u32 s30, s30, 32
s_branch k_p_6
k_nb_8:
s_mul_i32 s53, s52, 30
s_add_u32 s30, s30, s53
s_sub_u32 s30, s30, 142
s_cmp_lt_u32 s30, 96
s_cbranch_scc1 k_p_6
k_end_2:
s_endpgm
k_at_5:
s_lshl_b32 s52, s30, 2
s_add_u32 s52, s52, s3
s_lshl_b32 s52, s52, 9
s_add_u32 s52, s52, 222298112
v_mov_b64 v[2:3], 0
v_lshrrev_b32 v1, 1, v0
buffer_store_dwordx2 v[2:3], v1, s[4:7], s52 offen sc1
s_lshl_b32 s47, s30, 2
s_add_u32 s47, s47, s3
v_bfe_u32 v6, v0, 4, 5
v_lshrrev_b32 v2, 9, v0
v_bfe_u32 v8, v6, 2, 1
s_mov_b32 s56, 0x3acccccd
v_bfe_u32 v9, v6, 3, 1
v_and_b32 v1, 0x13, v6
v_lshl_add_u32 v1, v8, 3, v1
v_lshl_add_u32 v1, v9, 2, v1
k_gt_9:
s_mul_i32 s52, s47, 1639
s_lshr_b32 s52, s52, 16
s_mul_i32 s53, s52, 40
s_sub_u32 s53, s47, s53
s_lshl_b32 s52, s52, 5
s_lshl_b32 s53, s53, 1
v_add_u32 v3, s52, v1
v_add_u32 v6, s53, v2
v_and_b32 v4, 1, v3
v_cvt_f32_u32 v4, v4
v_mul_f32 v4, 0.5, v4
v_mul_f32 v4, 0.5, v4
v_cmp_gt_u32 vcc, 2, v3
s_nop 1
v_cndmask_b32 v4, v4, 0, vcc
v_mov_b32 v5, 0x3d64f92e
v_mov_b32 v8, 0x3d21e89b
v_cndmask_b32 v5, v5, v8, vcc
v_cmp_eq_u32 vcc, 0, v3
v_lshrrev_b32 v3, 1, v3
v_mov_b32 v8, 320
v_cndmask_b32 v3, v3, v8, vcc
v_lshlrev_b32 v6, 3, v6
v_mul_u32_u24 v6, v6, v3
v_cvt_f32_u32 v6, v6
v_cvt_f32_u32 v3, v3
v_fma_f32 v8, v6, s56, v4
v_add_f32 v6, v6, v3
v_fract_f32 v8, v8
v_cos_f32 v8, v8
v_fma_f32 v9, v6, s56, v4
v_add_f32 v6, v6, v3
v_fract_f32 v9, v9
v_cos_f32 v9, v9
v_fma_f32 v10, v6, s56, v4
v_add_f32 v6, v6, v3
v_fract_f32 v10, v10
v_cos_f32 v10, v10
v_fma_f32 v11, v6, s56, v4
v_add_f32 v6, v6, v3
v_fract_f32 v11, v11
v_cos_f32 v11, v11
v_fma_f32 v12, v6, s56, v4
v_add_f32 v6, v6, v3
v_fract_f32 v12, v12
v_cos_f32 v12, v12
v_fma_f32 v13, v6, s56, v4
v_add_f32 v6, v6, v3
v_fract_f32 v13, v13
v_cos_f32 v13, v13
v_fma_f32 v14, v6, s56, v4
v_add_f32 v6, v6, v3
v_fract_f32 v14, v14
v_cos_f32 v14, v14
v_fma_f32 v15, v6, s56, v4
v_add_f32 v6, v6, v3
v_fract_f32 v15, v15
v_cos_f32 v15, v15
v_mul_f32 v8, v5, v8
v_mul_f32 v9, v5, v9
v_mul_f32 v10, v5, v10
v_mul_f32 v11, v5, v11
v_mul_f32 v12, v5, v12
v_mul_f32 v13, v5, v13
v_mul_f32 v14, v5, v14
v_mul_f32 v15, v5, v15
v_cvt_pk_bf16_f32 v16, v8, v9
v_cvt_pk_bf16_f32 v17, v10, v11
v_cvt_pk_bf16_f32 v18, v12, v13
v_cvt_pk_bf16_f32 v19, v14, v15
s_lshl_b32 s52, s47, 10
s_add_u32 s52, s52, 213909504
buffer_store_dwordx4 v[16:19], v0, s[4:7], s52 offen sc1
s_add_u32 s47, s47, 128
s_cmp_lt_u32 s47, 800
s_cbranch_scc1 k_gt_9
s_waitcnt vmcnt(0)
s_barrier
s_cmp_lg_u32 s3, 0
s_cbranch_scc1 k_sd_11
s_mov_b64 exec, 1
v_mov_b32 v2, 128
v_mov_b32 v3, 1
global_atomic_add v2, v3, s[28:29] sc1
s_mov_b64 exec, -1
k_sd_11:
s_lshl_b32 s47, s30, 2
s_add_u32 s47, s47, s3
v_bfe_u32 v6, v0, 4, 5
v_lshrrev_b32 v2, 9, v0
v_bfe_u32 v8, v6, 2, 1
s_mov_b32 s56, 0x3acccccd
v_lshrrev_b32 v9, 3, v6
v_and_b32 v1, 3, v6
v_lshl_add_u32 v1, v8, 4, v1
v_lshl_add_u32 v1, v9, 2, v1
k_gt_12:
s_mul_i32 s52, s47, 1639
s_lshr_b32 s52, s52, 16
s_mul_i32 s53, s52, 40
s_sub_u32 s53, s47, s53
s_lshl_b32 s52, s52, 5
s_lshl_b32 s53, s53, 1
v_add_u32 v3, s52, v1
v_add_u32 v6, s53, v2
v_cmp_eq_u32 vcc, 0, v6
v_lshlrev_b32 v6, 2, v6
v_mul_u32_u24 v6, v6, v3
v_cvt_f32_u32 v6, v6
v_lshlrev_b32 v4, 31, v3
v_cvt_f32_u32 v3, v3
v_mul_f32 v8, s56, v6
v_add_f32 v6, v6, v3
v_fract_f32 v8, v8
v_sin_f32 v9, v8
v_cos_f32 v8, v8
v_mul_f32 v10, s56, v6
v_add_f32 v6, v6, v3
v_fract_f32 v10, v10
v_sin_f32 v11, v10
v_cos_f32 v10, v10
v_mul_f32 v12, s56, v6
v_add_f32 v6, v6, v3
v_fract_f32 v12, v12
v_sin_f32 v13, v12
v_cos_f32 v12, v12
v_mul_f32 v14, s56, v6
v_add_f32 v6, v6, v3
v_fract_f32 v14, v14
v_sin_f32 v15, v14
v_cos_f32 v14, v14
v_mul_f32 v8, 0x3d64f92e, v8
v_mul_f32 v9, 0xbd64f92e, v9
v_mul_f32 v10, 0x3d64f92e, v10
v_mul_f32 v11, 0xbd64f92e, v11
v_mul_f32 v12, 0x3d64f92e, v12
v_mul_f32 v13, 0xbd64f92e, v13
v_mul_f32 v14, 0x3d64f92e, v14
v_mul_f32 v15, 0xbd64f92e, v15
v_mov_b32 v5, 0x3d21e89b
v_xor_b32 v4, v4, v5
v_cndmask_b32 v8, v8, v4, vcc
v_cndmask_b32 v9, v9, v5, vcc
v_cvt_pk_bf16_f32 v16, v8, v9
v_cvt_pk_bf16_f32 v17, v10, v11
v_cvt_pk_bf16_f32 v18, v12, v13
v_cvt_pk_bf16_f32 v19, v14, v15
s_lshl_b32 s52, s47, 10
s_add_u32 s52, s52, 214958080
buffer_store_dwordx4 v[16:19], v0, s[4:7], s52 offen sc1
s_add_u32 s47, s47, 128
s_cmp_lt_u32 s47, 800
s_cbranch_scc1 k_gt_12
s_lshl_b32 s52, s30, 13
s_lshl_b32 s53, s3, 11
s_add_u32 s57, s52, s53
s_add_u32 s52, s57, 83886080
v_mov_b64 v[4:5], -1
v_mov_b64 v[6:7], -1
s_mov_b32 s47, 64
k_po_14:
buffer_store_dwordx4 v[4:7], v0, s[4:7], s52 offen sc1
buffer_store_dwordx4 v[4:7], v0, s[4:7], s52 offen offset:1024 sc1
s_add_u32 s52, s52, 262144
s_sub_u32 s47, s47, 1
s_cmp_lg_u32 s47, 0
s_cbranch_scc1 k_po_14
s_waitcnt vmcnt(0)
s_barrier
s_cmp_lg_u32 s3, 0
s_cbranch_scc1 k_sd_15
s_mov_b64 exec, 1
v_mov_b32 v2, 192
v_mov_b32 v3, 1
global_atomic_add v2, v3, s[28:29] sc1
s_mov_b64 exec, -1
k_sd_15:
s_and_b32 s47, s3, 1
s_lshr_b32 s52, s3, 1
s_add_u32 s50, s52, 1
s_lshl_b32 s53, s52, 5
s_add_u32 s53, s53, s30
s_lshl_b32 s44, s53, 14
s_add_u32 s44, s44, 0
s_lshl_b32 s53, s53, 13
s_add_u32 s46, s53, 83886080
s_lshl_b32 s45, s47, 10
s_add_u32 s45, s45, s53
s_add_u32 s45, s45, 125829120
s_lshl_b32 s48, s3, 17
s_lshl_b32 s53, s30, 11
s_add_u32 s48, s48, s53
s_add_u32 s48, s48, 159383552
s_lshl_b32 s56, s30, 6
s_add_u32 s56, s56, 222330880
s_lshl_b32 s57, s3, 8
s_lshl_b32 s53, s30, 2
s_add_u32 s57, s57, s53
s_add_u32 s57, s57, 222339072
s_mov_b32 s49, 0
s_mov_b32 s58, 0x3e0293ee
v_bfe_u32 v192, v0, 7, 1
v_and_b32 v1, 0x370, v0
v_lshl_add_u32 v1, v192, 16, v1
v_mov_b32 v2, 2146435072
v_cmp_eq_u32 vcc, 0, v0
s_nop 1
v_cndmask_b32 v2, v2, 0, vcc
v_bfe_u32 v192, v0, 4, 4
s_lshl_b32 s52, s47, 4
v_add_u32 v192, s52, v192
v_lshrrev_b32 v193, 8, v0
v_lshlrev_b32 v193, 2, v193
v_sub_u32 v192, v192, v193
v_mov_b32 v193, 0xff800000
v_add_u32 v3, 4096, v0
v_add_u32 v18, 8192, v0
v_add_u32 v19, 12288, v0
v_cmp_le_i32 vcc, 0, v192
s_nop 1
v_cndmask_b32 v4, v193, 0, vcc
v_cmp_le_i32 vcc, 1, v192
s_nop 1
v_cndmask_b32 v5, v193, 0, vcc
v_cmp_le_i32 vcc, 2, v192
s_nop 1
v_cndmask_b32 v6, v193, 0, vcc
v_cmp_le_i32 vcc, 3, v192
s_nop 1
v_cndmask_b32 v7, v193, 0, vcc
v_cmp_le_i32 vcc, 16, v192
s_nop 1
v_cndmask_b32 v8, v193, 0, vcc
v_cmp_le_i32 vcc, 17, v192
s_nop 1
v_cndmask_b32 v9, v193, 0, vcc
v_cmp_le_i32 vcc, 18, v192
s_nop 1
v_cndmask_b32 v10, v193, 0, vcc
v_cmp_le_i32 vcc, 19, v192
s_nop 1
v_cndmask_b32 v11, v193, 0, vcc
v_mov_b32 v12, 0x3f803f80
v_mov_b32 v20, -1
v_mov_b32 v13, 0x3f803f80
v_mov_b32 v21, -1
v_mov_b32 v14, 0x3f803f80
v_mov_b32 v22, -1
v_mov_b32 v15, 0x3f803f80
v_mov_b32 v23, -1
v_mov_b32 v16, 0x3f003f00
v_mov_b32 v17, 0x3f003f00
s_cmp_lg_u32 s3, 0
s_cbranch_scc1 k_wdd_17
v_mov_b32 v192, 192
k_wd_16:
global_load_dword v193, v192, s[28:29] sc1
s_waitcnt vmcnt(0)
v_readfirstlane_b32 s52, v193
s_cmp_ge_u32 s52, 32
s_cbranch_scc1 k_wdd_17
s_sleep 2
s_sub_u32 s32, s32, 1
s_cmp_gt_i32 s32, 0
s_cbranch_scc1 k_wd_16
k_wdd_17:
s_barrier
k_top_18:
s_cmp_ge_u32 s49, s50
s_cbranch_scc1 k_cd_20
k_ck_19:
buffer_load_dwordx3 v[192:194], off, s[4:7], s56 sc1
s_waitcnt vmcnt(0)
v_min3_u32 v192, v192, v193, v194
s_nop 0
v_readfirstlane_b32 s49, v192
s_cmp_ge_u32 s49, s50
s_cbranch_scc1 k_cd_20
s_sleep 4
s_sub_u32 s32, s32, 1
s_cmp_gt_i32 s32, 0
s_cbranch_scc1 k_ck_19
k_cd_20:
buffer_load_dwordx4 v[24:27], v0, s[4:7], s45 offen offset:0 sc1
buffer_load_dwordx4 v[40:43], v0, s[4:7], s44 offen offset:0 sc1
buffer_load_dwordx4 v[44:47], v0, s[4:7], s44 offen offset:1024 sc1
buffer_load_dwordx4 v[28:31], v0, s[4:7], s45 offen offset:2048 sc1
buffer_load_dwordx4 v[48:51], v3, s[4:7], s44 offen offset:0 sc1
buffer_load_dwordx4 v[52:55], v3, s[4:7], s44 offen offset:1024 sc1
buffer_load_dwordx4 v[32:35], v3, s[4:7], s45 offen offset:0 sc1
buffer_load_dwordx4 v[56:59], v18, s[4:7], s44 offen offset:0 sc1
buffer_load_dwordx4 v[60:63], v18, s[4:7], s44 offen offset:1024 sc1
buffer_load_dwordx4 v[36:39], v3, s[4:7], s45 offen offset:2048 sc1
buffer_load_dwordx4 v[64:67], v19, s[4:7], s44 offen offset:0 sc1
buffer_load_dwordx4 v[68:71], v19, s[4:7], s44 offen offset:1024 sc1
buffer_load_dwordx4 v[72:75], v0, s[4:7], s44 offen offset:2048 sc1
buffer_load_dwordx4 v[76:79], v0, s[4:7], s44 offen offset:3072 sc1
buffer_load_dwordx4 v[80:83], v3, s[4:7], s44 offen offset:2048 sc1
buffer_load_dwordx4 v[84:87], v3, s[4:7], s44 offen offset:3072 sc1
buffer_load_dwordx4 v[88:91], v18, s[4:7], s44 offen offset:2048 sc1
buffer_load_dwordx4 v[92:95], v18, s[4:7], s44 offen offset:3072 sc1
buffer_load_dwordx4 v[96:99], v19, s[4:7], s44 offen offset:2048 sc1
buffer_load_dwordx4 v[100:103], v19, s[4:7], s44 offen offset:3072 sc1
s_waitcnt vmcnt(18)
v_mfma_f32_16x16x32_bf16 v[136:139], v[40:43], v[24:27], v[4:7]
s_waitcnt vmcnt(17)
v_mfma_f32_16x16x32_bf16 v[140:143], v[44:47], v[24:27], v[8:11]
s_waitcnt vmcnt(15)
v_mfma_f32_16x16x32_bf16 v[136:139], v[48:51], v[28:31], v[136:139]
s_waitcnt vmcnt(14)
v_mfma_f32_16x16x32_bf16 v[140:143], v[52:55], v[28:31], v[140:143]
s_waitcnt vmcnt(12)
v_mfma_f32_16x16x32_bf16 v[136:139], v[56:59], v[32:35], v[136:139]
s_waitcnt vmcnt(11)
v_mfma_f32_16x16x32_bf16 v[140:143], v[60:63], v[32:35], v[140:143]
s_waitcnt vmcnt(9)
v_mfma_f32_16x16x32_bf16 v[136:139], v[64:67], v[36:39], v[136:139]
s_waitcnt vmcnt(8)
v_mfma_f32_16x16x32_bf16 v[140:143], v[68:71], v[36:39], v[140:143]
s_cmp_gt_u32 s50, 64
s_cbranch_scc1 k_nopo_21
s_lshl_b32 s52, s47, 12
s_add_u32 s52, s52, s46
s_add_u32 s52, s52, 16777216
buffer_store_dwordx4 v[20:23], v0, s[4:7], s52 offen offset:0 sc1
buffer_store_dwordx4 v[20:23], v0, s[4:7], s52 offen offset:1024 sc1
buffer_store_dwordx4 v[20:23], v0, s[4:7], s52 offen offset:2048 sc1
buffer_store_dwordx4 v[20:23], v0, s[4:7], s52 offen offset:3072 sc1
k_nopo_21:
s_nop 1
v_max3_f32 v196, v136, v137, v138
s_nop 1
v_max3_f32 v196, v196, v139, v140
v_max3_f32 v196, v196, v141, v142
v_max_f32 v196, v196, v143
k_pr_22:
buffer_load_dword v192, off, s[4:7], s46 sc1
s_waitcnt vmcnt(0)
v_cmp_eq_u32 vcc, -1, v192
s_cbranch_vccz k_prd_23
s_sleep 2
s_sub_u32 s32, s32, 1
s_cmp_gt_i32 s32, 0
s_cbranch_scc1 k_pr_22
k_prd_23:
k_pk_24:
buffer_load_dwordx4 v[104:107], v0, s[4:7], s46 offen offset:0 sc1
buffer_load_dwordx4 v[108:111], v0, s[4:7], s46 offen offset:2048 sc1
buffer_load_dwordx4 v[112:115], v3, s[4:7], s46 offen offset:0 sc1
buffer_load_dwordx4 v[116:119], v3, s[4:7], s46 offen offset:2048 sc1
buffer_load_dwordx4 v[120:123], v0, s[4:7], s46 offen offset:1024 sc1
buffer_load_dwordx4 v[124:127], v0, s[4:7], s46 offen offset:3072 sc1
buffer_load_dwordx4 v[128:131], v3, s[4:7], s46 offen offset:1024 sc1
buffer_load_dwordx4 v[132:135], v3, s[4:7], s46 offen offset:3072 sc1
s_waitcnt vmcnt(7)
v_mfma_f32_16x16x32_bf16 v[144:147], v[104:107], v[24:27], 0
s_waitcnt vmcnt(6)
v_mfma_f32_16x16x32_bf16 v[144:147], v[108:111], v[28:31], v[144:147]
s_waitcnt vmcnt(5)
v_mfma_f32_16x16x32_bf16 v[144:147], v[112:115], v[32:35], v[144:147]
s_waitcnt vmcnt(4)
v_mfma_f32_16x16x32_bf16 v[144:147], v[116:119], v[36:39], v[144:147]
v_max3_u32 v192, v104, v108, v112
v_max_u32 v192, v192, v116
v_cmp_eq_u32 vcc, -1, v192
s_cbranch_vccz k_pkd_25
s_sub_u32 s32, s32, 1
s_cmp_gt_i32 s32, 0
s_cbranch_scc1 k_pk_24
k_pkd_25:
s_nop 2
v_max3_f32 v196, v196, v144, v145
v_max3_f32 v196, v196, v146, v147
v_mov_b32 v197, v196
s_nop 1
v_permlane32_swap_b32 v196, v197
v_max_f32 v196, v196, v197
v_mov_b32 v197, v196
s_nop 1
v_permlane16_swap_b32 v196, v197
v_max_f32 v196, v196, v197
v_mul_f32 v196, s58, v196
v_fma_f32 v136, v136, s58, -v196
v_exp_f32 v136, v136
v_fma_f32 v137, v137, s58, -v196
v_exp_f32 v137, v137
v_fma_f32 v138, v138, s58, -v196
v_exp_f32 v138, v138
v_fma_f32 v139, v139, s58, -v196
v_exp_f32 v139, v139
v_fma_f32 v140, v140, s58, -v196
v_exp_f32 v140, v140
v_fma_f32 v141, v141, s58, -v196
v_exp_f32 v141, v141
v_fma_f32 v142, v142, s58, -v196
v_exp_f32 v142, v142
v_fma_f32 v143, v143, s58, -v196
v_exp_f32 v143, v143
v_fma_f32 v144, v144, s58, -v196
v_exp_f32 v144, v144
v_fma_f32 v145, v145, s58, -v196
v_exp_f32 v145, v145
v_fma_f32 v146, v146, s58, -v196
v_exp_f32 v146, v146
v_fma_f32 v147, v147, s58, -v196
v_exp_f32 v147, v147
v_cvt_pk_bf16_f32 v148, v136, v137
v_cvt_pk_bf16_f32 v149, v138, v139
v_cvt_pk_bf16_f32 v150, v140, v141
v_cvt_pk_bf16_f32 v151, v142, v143
v_cvt_pk_bf16_f32 v152, v144, v145
v_cvt_pk_bf16_f32 v153, v146, v147
v_mfma_f32_16x16x32_bf16 v[156:159], v[12:15], v[148:151], 0
v_mfma_f32_16x16x32_bf16 v[160:163], v[72:75], v[148:151], 0
v_mfma_f32_16x16x32_bf16 v[164:167], v[76:79], v[148:151], 0
v_mfma_f32_16x16x16_bf16 v[156:159], v[16:17], v[152:153], v[156:159]
v_mfma_f32_16x16x32_bf16 v[168:171], v[80:83], v[148:151], 0
v_mfma_f32_16x16x32_bf16 v[172:175], v[84:87], v[148:151], 0
v_mfma_f32_16x16x32_bf16 v[176:179], v[88:91], v[148:151], 0
v_mfma_f32_16x16x32_bf16 v[180:183], v[92:95], v[148:151], 0
v_mfma_f32_16x16x32_bf16 v[184:187], v[96:99], v[148:151], 0
v_mfma_f32_16x16x32_bf16 v[188:191], v[100:103], v[148:151], 0
v_rcp_f32 v156, v156
s_branch k_pvd_27
k_pv_26:
buffer_load_dwordx4 v[120:123], v0, s[4:7], s46 offen offset:1024 sc1
buffer_load_dwordx4 v[124:127], v0, s[4:7], s46 offen offset:3072 sc1
buffer_load_dwordx4 v[128:131], v3, s[4:7], s46 offen offset:1024 sc1
buffer_load_dwordx4 v[132:135], v3, s[4:7], s46 offen offset:3072 sc1
s_sub_u32 s32, s32, 1
k_pvd_27:
s_waitcnt vmcnt(1)
v_max3_u32 v192, v120, v124, v128
s_waitcnt vmcnt(0)
v_max_u32 v192, v192, v132
v_cmp_eq_u32 vcc, -1, v192
s_cmp_gt_i32 s32, 0
s_cselect_b64 vcc, vcc, 0
s_cbranch_vccnz k_pv_26
v_mfma_f32_16x16x16_bf16 v[160:163], v[120:121], v[152:153], v[160:163]
v_mfma_f32_16x16x16_bf16 v[164:167], v[122:123], v[152:153], v[164:167]
v_mfma_f32_16x16x16_bf16 v[168:171], v[124:125], v[152:153], v[168:171]
v_mfma_f32_16x16x16_bf16 v[172:175], v[126:127], v[152:153], v[172:175]
v_mfma_f32_16x16x16_bf16 v[176:179], v[128:129], v[152:153], v[176:179]
v_mfma_f32_16x16x16_bf16 v[180:183], v[130:131], v[152:153], v[180:183]
v_mfma_f32_16x16x16_bf16 v[184:187], v[132:133], v[152:153], v[184:187]
v_mfma_f32_16x16x16_bf16 v[188:191], v[134:135], v[152:153], v[188:191]
v_mul_f32 v160, v156, v160
v_mul_f32 v161, v156, v161
v_mul_f32 v162, v156, v162
v_mul_f32 v163, v156, v163
v_mul_f32 v164, v156, v164
v_mul_f32 v165, v156, v165
v_mul_f32 v166, v156, v166
v_mul_f32 v167, v156, v167
v_cvt_pk_bf16_f32 v160, v160, v161
v_cvt_pk_bf16_f32 v161, v162, v163
v_cvt_pk_bf16_f32 v162, v164, v165
v_cvt_pk_bf16_f32 v163, v166, v167
buffer_store_dwordx4 v[160:163], v1, s[4:7], s48 offen offset:0 sc1
v_mul_f32 v168, v156, v168
v_mul_f32 v169, v156, v169
v_mul_f32 v170, v156, v170
v_mul_f32 v171, v156, v171
v_mul_f32 v172, v156, v172
v_mul_f32 v173, v156, v173
v_mul_f32 v174, v156, v174
v_mul_f32 v175, v156, v175
v_cvt_pk_bf16_f32 v168, v168, v169
v_cvt_pk_bf16_f32 v169, v170, v171
v_cvt_pk_bf16_f32 v170, v172, v173
v_cvt_pk_bf16_f32 v171, v174, v175
buffer_store_dwordx4 v[168:171], v1, s[4:7], s48 offen offset:128 sc1
v_mul_f32 v176, v156, v176
v_mul_f32 v177, v156, v177
v_mul_f32 v178, v156, v178
v_mul_f32 v179, v156, v179
v_mul_f32 v180, v156, v180
v_mul_f32 v181, v156, v181
v_mul_f32 v182, v156, v182
v_mul_f32 v183, v156, v183
v_cvt_pk_bf16_f32 v176, v176, v177
v_cvt_pk_bf16_f32 v177, v178, v179
v_cvt_pk_bf16_f32 v178, v180, v181
v_cvt_pk_bf16_f32 v179, v182, v183
buffer_store_dwordx4 v[176:179], v1, s[4:7], s48 offen offset:1024 sc1
v_mul_f32 v184, v156, v184
v_mul_f32 v185, v156, v185
v_mul_f32 v186, v156, v186
v_mul_f32 v187, v156, v187
v_mul_f32 v188, v156, v188
v_mul_f32 v189, v156, v189
v_mul_f32 v190, v156, v190
v_mul_f32 v191, v156, v191
v_cvt_pk_bf16_f32 v184, v184, v185
v_cvt_pk_bf16_f32 v185, v186, v187
v_cvt_pk_bf16_f32 v186, v188, v189
v_cvt_pk_bf16_f32 v187, v190, v191
buffer_store_dwordx4 v[184:187], v1, s[4:7], s48 offen offset:1152 sc1
v_mov_b32 v192, s50
s_add_u32 s44, s44, 1048576
s_add_u32 s45, s45, 524288
s_add_u32 s46, s46, 524288
s_add_u32 s48, s48, 524288
s_waitcnt vmcnt(0)
buffer_store_dword v192, v2, s[4:7], s57 offen sc1
s_add_u32 s50, s50, 2
s_sub_u32 s52, s50, 65
s_cmp_lt_u32 s52, 2
s_cbranch_scc0 k_nosw_28
s_add_u32 s44, s44, 8388608
s_add_u32 s48, s48, 1048576
k_nosw_28:
s_cmp_le_u32 s50, 128
s_cbranch_scc1 k_top_18
s_waitcnt vmcnt(0) lgkmcnt(0)
s_barrier
s_add_u32 s30, s30, 80
s_branch k_fin_7
k_p_6:
s_mul_i32 s57, s30, 21846
s_lshr_b32 s57, s57, 16
s_mul_i32 s52, s57, 3
s_sub_u32 s58, s30, s52
s_cmp_eq_u32 s58, 1
s_cselect_b32 s12, s16, s12
s_cselect_b32 s13, s17, s13
s_cmp_eq_u32 s58, 2
s_cselect_b32 s12, s8, s12
s_cselect_b32 s13, s9, s13
v_lshrrev_b32 v1, 8, v0
v_and_b32 v2, 0xf0, v0
v_lshlrev_b32 v3, 5, v1
v_xor_b32 v2, v2, v3
v_lshl_add_u32 v1, v1, 13, v2
s_mul_i32 s52, s3, 1310720
s_lshl_b32 s53, s57, 8
s_add_u32 s52, s52, s53
s_mul_i32 s53, s3, 40960
s_add_u32 m0, s53, 0
s_add_u32 s54, s52, 0
buffer_load_dwordx4 v1, s[12:15], s54 offen lds
s_add_u32 m0, s53, 1024
s_add_u32 s54, s52, 32768
buffer_load_dwordx4 v1, s[12:15], s54 offen lds
s_add_u32 m0, s53, 2048
s_add_u32 s54, s52, 65536
buffer_load_dwordx4 v1, s[12:15], s54 offen lds
s_add_u32 m0, s53, 3072
s_add_u32 s54, s52, 98304
buffer_load_dwordx4 v1, s[12:15], s54 offen lds
s_add_u32 m0, s53, 4096
s_add_u32 s54, s52, 131072
buffer_load_dwordx4 v1, s[12:15], s54 offen lds
s_add_u32 m0, s53, 5120
s_add_u32 s54, s52, 163840
buffer_load_dwordx4 v1, s[12:15], s54 offen lds
s_add_u32 m0, s53, 6144
s_add_u32 s54, s52, 196608
buffer_load_dwordx4 v1, s[12:15], s54 offen lds
s_add_u32 m0, s53, 7168
s_add_u32 s54, s52, 229376
buffer_load_dwordx4 v1, s[12:15], s54 offen lds
s_add_u32 m0, s53, 8192
s_add_u32 s54, s52, 262144
buffer_load_dwordx4 v1, s[12:15], s54 offen lds
s_add_u32 m0, s53, 9216
s_add_u32 s54, s52, 294912
buffer_load_dwordx4 v1, s[12:15], s54 offen lds
s_add_u32 m0, s53, 10240
s_add_u32 s54, s52, 327680
buffer_load_dwordx4 v1, s[12:15], s54 offen lds
s_add_u32 m0, s53, 11264
s_add_u32 s54, s52, 360448
buffer_load_dwordx4 v1, s[12:15], s54 offen lds
s_add_u32 m0, s53, 12288
s_add_u32 s54, s52, 393216
buffer_load_dwordx4 v1, s[12:15], s54 offen lds
s_add_u32 m0, s53, 13312
s_add_u32 s54, s52, 425984
buffer_load_dwordx4 v1, s[12:15], s54 offen lds
s_add_u32 m0, s53, 14336
s_add_u32 s54, s52, 458752
buffer_load_dwordx4 v1, s[12:15], s54 offen lds
s_add_u32 m0, s53, 15360
s_add_u32 s54, s52, 491520
buffer_load_dwordx4 v1, s[12:15], s54 offen lds
s_add_u32 m0, s53, 16384
s_add_u32 s54, s52, 524288
buffer_load_dwordx4 v1, s[12:15], s54 offen lds
s_add_u32 m0, s53, 17408
s_add_u32 s54, s52, 557056
buffer_load_dwordx4 v1, s[12:15], s54 offen lds
s_add_u32 m0, s53, 18432
s_add_u32 s54, s52, 589824
buffer_load_dwordx4 v1, s[12:15], s54 offen lds
s_add_u32 m0, s53, 19456
s_add_u32 s54, s52, 622592
buffer_load_dwordx4 v1, s[12:15], s54 offen lds
s_add_u32 m0, s53, 20480
s_add_u32 s54, s52, 655360
buffer_load_dwordx4 v1, s[12:15], s54 offen lds
s_add_u32 m0, s53, 21504
s_add_u32 s54, s52, 688128
buffer_load_dwordx4 v1, s[12:15], s54 offen lds
s_add_u32 m0, s53, 22528
s_add_u32 s54, s52, 720896
buffer_load_dwordx4 v1, s[12:15], s54 offen lds
s_add_u32 m0, s53, 23552
s_add_u32 s54, s52, 753664
buffer_load_dwordx4 v1, s[12:15], s54 offen lds
s_add_u32 m0, s53, 24576
s_add_u32 s54, s52, 786432
buffer_load_dwordx4 v1, s[12:15], s54 offen lds
s_add_u32 m0, s53, 25600
s_add_u32 s54, s52, 819200
buffer_load_dwordx4 v1, s[12:15], s54 offen lds
s_add_u32 m0, s53, 26624
s_add_u32 s54, s52, 851968
buffer_load_dwordx4 v1, s[12:15], s54 offen lds
s_add_u32 m0, s53, 27648
s_add_u32 s54, s52, 884736
buffer_load_dwordx4 v1, s[12:15], s54 offen lds
s_add_u32 m0, s53, 28672
s_add_u32 s54, s52, 917504
buffer_load_dwordx4 v1, s[12:15], s54 offen lds
s_add_u32 m0, s53, 29696
s_add_u32 s54, s52, 950272
buffer_load_dwordx4 v1, s[12:15], s54 offen lds
s_add_u32 m0, s53, 30720
s_add_u32 s54, s52, 983040
buffer_load_dwordx4 v1, s[12:15], s54 offen lds
s_add_u32 m0, s53, 31744
s_add_u32 s54, s52, 1015808
buffer_load_dwordx4 v1, s[12:15], s54 offen lds
s_add_u32 m0, s53, 32768
s_add_u32 s54, s52, 1048576
buffer_load_dwordx4 v1, s[12:15], s54 offen lds
s_add_u32 m0, s53, 33792
s_add_u32 s54, s52, 1081344
buffer_load_dwordx4 v1, s[12:15], s54 offen lds
s_add_u32 m0, s53, 34816
s_add_u32 s54, s52, 1114112
buffer_load_dwordx4 v1, s[12:15], s54 offen lds
s_add_u32 m0, s53, 35840
s_add_u32 s54, s52, 1146880
buffer_load_dwordx4 v1, s[12:15], s54 offen lds
s_add_u32 m0, s53, 36864
s_add_u32 s54, s52, 1179648
buffer_load_dwordx4 v1, s[12:15], s54 offen lds
s_add_u32 m0, s53, 37888
s_add_u32 s54, s52, 1212416
buffer_load_dwordx4 v1, s[12:15], s54 offen lds
s_add_u32 m0, s53, 38912
s_add_u32 s54, s52, 1245184
buffer_load_dwordx4 v1, s[12:15], s54 offen lds
s_add_u32 m0, s53, 39936
s_add_u32 s54, s52, 1277952
buffer_load_dwordx4 v1, s[12:15], s54 offen lds
v_bfe_u32 v2, v0, 8, 1
v_bfe_u32 v3, v0, 5, 1
s_cmp_eq_u32 s58, 1
s_cselect_b32 s52, 7, 4
s_cselect_b32 s53, 4, 7
v_lshlrev_b32 v2, s52, v2
v_lshlrev_b32 v3, s53, v3
v_add_u32 v2, v2, v3
v_bfe_u32 v3, v0, 4, 1
v_lshl_add_u32 v2, v3, 3, v2
v_bfe_u32 v3, v0, 6, 2
v_xor_b32 v4, s3, v3
v_lshl_add_u32 v2, v4, 5, v2
v_lshl_add_u32 v2, v3, 8, v2
v_lshrrev_b32 v3, 9, v0
v_lshl_add_u32 v2, v3, 11, v2
v_add_u32 v3, 0x10000, v2
v_add_u32 v4, 0x20000, v2
s_waitcnt vmcnt(0)
s_barrier
ds_read_b64_tr_b16 v[96:97], v2 offset:0
ds_read_b64_tr_b16 v[98:99], v2 offset:1024
ds_read_b64_tr_b16 v[100:101], v2 offset:4096
ds_read_b64_tr_b16 v[102:103], v2 offset:5120
ds_read_b64_tr_b16 v[104:105], v2 offset:8192
ds_read_b64_tr_b16 v[106:107], v2 offset:9216
ds_read_b64_tr_b16 v[108:109], v2 offset:12288
ds_read_b64_tr_b16 v[110:111], v2 offset:13312
ds_read_b64_tr_b16 v[112:113], v2 offset:16384
ds_read_b64_tr_b16 v[114:115], v2 offset:17408
ds_read_b64_tr_b16 v[116:117], v2 offset:20480
ds_read_b64_tr_b16 v[118:119], v2 offset:21504
ds_read_b64_tr_b16 v[120:121], v2 offset:24576
ds_read_b64_tr_b16 v[122:123], v2 offset:25600
ds_read_b64_tr_b16 v[124:125], v2 offset:28672
ds_read_b64_tr_b16 v[126:127], v2 offset:29696
ds_read_b64_tr_b16 v[128:129], v2 offset:32768
ds_read_b64_tr_b16 v[130:131], v2 offset:33792
ds_read_b64_tr_b16 v[132:133], v2 offset:36864
ds_read_b64_tr_b16 v[134:135], v2 offset:37888
ds_read_b64_tr_b16 v[136:137], v2 offset:40960
ds_read_b64_tr_b16 v[138:139], v2 offset:41984
ds_read_b64_tr_b16 v[140:141], v2 offset:45056
ds_read_b64_tr_b16 v[142:143], v2 offset:46080
ds_read_b64_tr_b16 v[144:145], v2 offset:49152
ds_read_b64_tr_b16 v[146:147], v2 offset:50176
ds_read_b64_tr_b16 v[148:149], v2 offset:53248
ds_read_b64_tr_b16 v[150:151], v2 offset:54272
ds_read_b64_tr_b16 v[152:153], v2 offset:57344
ds_read_b64_tr_b16 v[154:155], v2 offset:58368
ds_read_b64_tr_b16 v[156:157], v2 offset:61440
ds_read_b64_tr_b16 v[158:159], v2 offset:62464
ds_read_b64_tr_b16 v[160:161], v3 offset:0
ds_read_b64_tr_b16 v[162:163], v3 offset:1024
ds_read_b64_tr_b16 v[164:165], v3 offset:4096
ds_read_b64_tr_b16 v[166:167], v3 offset:5120
ds_read_b64_tr_b16 v[168:169], v3 offset:8192
ds_read_b64_tr_b16 v[170:171], v3 offset:9216
ds_read_b64_tr_b16 v[172:173], v3 offset:12288
ds_read_b64_tr_b16 v[174:175], v3 offset:13312
ds_read_b64_tr_b16 v[176:177], v3 offset:16384
ds_read_b64_tr_b16 v[178:179], v3 offset:17408
ds_read_b64_tr_b16 v[180:181], v3 offset:20480
ds_read_b64_tr_b16 v[182:183], v3 offset:21504
ds_read_b64_tr_b16 v[184:185], v3 offset:24576
ds_read_b64_tr_b16 v[186:187], v3 offset:25600
ds_read_b64_tr_b16 v[188:189], v3 offset:28672
ds_read_b64_tr_b16 v[190:191], v3 offset:29696
ds_read_b64_tr_b16 v[192:193], v3 offset:32768
ds_read_b64_tr_b16 v[194:195], v3 offset:33792
ds_read_b64_tr_b16 v[196:197], v3 offset:36864
ds_read_b64_tr_b16 v[198:199], v3 offset:37888
ds_read_b64_tr_b16 v[200:201], v3 offset:40960
ds_read_b64_tr_b16 v[202:203], v3 offset:41984
ds_read_b64_tr_b16 v[204:205], v3 offset:45056
ds_read_b64_tr_b16 v[206:207], v3 offset:46080
ds_read_b64_tr_b16 v[208:209], v3 offset:49152
ds_read_b64_tr_b16 v[210:211], v3 offset:50176
ds_read_b64_tr_b16 v[212:213], v3 offset:53248
ds_read_b64_tr_b16 v[214:215], v3 offset:54272
ds_read_b64_tr_b16 v[216:217], v3 offset:57344
ds_read_b64_tr_b16 v[218:219], v3 offset:58368
ds_read_b64_tr_b16 v[220:221], v3 offset:61440
ds_read_b64_tr_b16 v[222:223], v3 offset:62464
ds_read_b64_tr_b16 v[224:225], v4 offset:0
ds_read_b64_tr_b16 v[226:227], v4 offset:1024
ds_read_b64_tr_b16 v[228:229], v4 offset:4096
ds_read_b64_tr_b16 v[230:231], v4 offset:5120
ds_read_b64_tr_b16 v[232:233], v4 offset:8192
ds_read_b64_tr_b16 v[234:235], v4 offset:9216
ds_read_b64_tr_b16 v[236:237], v4 offset:12288
ds_read_b64_tr_b16 v[238:239], v4 offset:13312
ds_read_b64_tr_b16 v[240:241], v4 offset:16384
ds_read_b64_tr_b16 v[242:243], v4 offset:17408
ds_read_b64_tr_b16 v[244:245], v4 offset:20480
ds_read_b64_tr_b16 v[246:247], v4 offset:21504
ds_read_b64_tr_b16 v[248:249], v4 offset:24576
ds_read_b64_tr_b16 v[250:251], v4 offset:25600
ds_read_b64_tr_b16 v[252:253], v4 offset:28672
ds_read_b64_tr_b16 v[254:255], v4 offset:29696
s_waitcnt lgkmcnt(0)
s_cmp_lg_u32 s3, 0
s_cbranch_scc1 k_wdd_30
v_mov_b32 v2, 128
k_wd_29:
global_load_dword v3, v2, s[28:29] sc1
s_waitcnt vmcnt(0)
v_readfirstlane_b32 s52, v3
s_cmp_ge_u32 s52, 32
s_cbranch_scc1 k_wdd_30
s_sleep 2
s_sub_u32 s32, s32, 1
s_cmp_gt_i32 s32, 0
s_cbranch_scc1 k_wd_29
k_wdd_30:
s_barrier
s_mul_i32 s46, s3, 10240
s_add_u32 s46, s46, 213909504
s_mul_i32 s45, s3, 10240
s_mov_b32 s44, 0
v_mov_b32 v64, v0
s_add_u32 m0, s45, 0
s_add_u32 s55, s46, 0
buffer_load_dwordx4 v0, s[4:7], s55 offen offset:0 sc1 lds
buffer_load_dwordx4 v0, s[4:7], s55 offen offset:1024 sc1 lds
buffer_load_dwordx4 v0, s[4:7], s55 offen offset:2048 sc1 lds
buffer_load_dwordx4 v0, s[4:7], s55 offen offset:3072 sc1 lds
s_add_u32 m0, s45, 4096
s_add_u32 s55, s46, 4096
buffer_load_dwordx4 v0, s[4:7], s55 offen offset:0 sc1 lds
buffer_load_dwordx4 v0, s[4:7], s55 offen offset:1024 sc1 lds
buffer_load_dwordx4 v0, s[4:7], s55 offen offset:2048 sc1 lds
buffer_load_dwordx4 v0, s[4:7], s55 offen offset:3072 sc1 lds
s_add_u32 m0, s45, 8192
s_add_u32 s55, s46, 8192
buffer_load_dwordx4 v0, s[4:7], s55 offen offset:0 sc1 lds
buffer_load_dwordx4 v0, s[4:7], s55 offen offset:1024 sc1 lds
s_add_u32 s45, s45, 40960
s_cmp_ge_u32 s45, 122880
s_cselect_b32 s55, 122880, 0
s_sub_u32 s45, s45, s55
s_add_u32 s46, s46, 40960
s_add_u32 m0, s45, 0
s_add_u32 s55, s46, 0
buffer_load_dwordx4 v0, s[4:7], s55 offen offset:0 sc1 lds
buffer_load_dwordx4 v0, s[4:7], s55 offen offset:1024 sc1 lds
buffer_load_dwordx4 v0, s[4:7], s55 offen offset:2048 sc1 lds
buffer_load_dwordx4 v0, s[4:7], s55 offen offset:3072 sc1 lds
s_add_u32 m0, s45, 4096
s_add_u32 s55, s46, 4096
buffer_load_dwordx4 v0, s[4:7], s55 offen offset:0 sc1 lds
buffer_load_dwordx4 v0, s[4:7], s55 offen offset:1024 sc1 lds
buffer_load_dwordx4 v0, s[4:7], s55 offen offset:2048 sc1 lds
buffer_load_dwordx4 v0, s[4:7], s55 offen offset:3072 sc1 lds
s_add_u32 m0, s45, 8192
s_add_u32 s55, s46, 8192
buffer_load_dwordx4 v0, s[4:7], s55 offen offset:0 sc1 lds
buffer_load_dwordx4 v0, s[4:7], s55 offen offset:1024 sc1 lds
s_add_u32 s45, s45, 40960
s_cmp_ge_u32 s45, 122880
s_cselect_b32 s55, 122880, 0
s_sub_u32 s45, s45, s55
s_add_u32 s46, s46, 40960
s_waitcnt vmcnt(10)
s_barrier
ds_read_b128 v[8:11], v64 offset:0
ds_read_b128 v[12:15], v64 offset:1024
ds_read_b128 v[16:19], v64 offset:2048
ds_read_b128 v[20:23], v64 offset:3072
v_mov_b32 v1, 0xffff
v_cmp_gt_u32 vcc, 512, v0
s_nop 1
v_cndmask_b32 v1, -1, v1, vcc
s_waitcnt lgkmcnt(3)
v_mfma_f32_32x32x16_bf16 v[32:47], v[8:11], v[96:99], 0
s_waitcnt lgkmcnt(2)
ds_read_b128 v[24:27], v64 offset:4096
v_mfma_f32_32x32x16_bf16 v[32:47], v[12:15], v[100:103], v[32:47]
s_waitcnt lgkmcnt(2)
ds_read_b128 v[8:11], v64 offset:5120
s_add_u32 m0, s45, 0
s_add_u32 s55, s46, 0
buffer_load_dwordx4 v0, s[4:7], s55 offen offset:0 sc1 lds
buffer_load_dwordx4 v0, s[4:7], s55 offen offset:1024 sc1 lds
v_mfma_f32_32x32x16_bf16 v[32:47], v[16:19], v[104:107], v[32:47]
s_waitcnt lgkmcnt(2)
ds_read_b128 v[12:15], v64 offset:6144
buffer_load_dwordx4 v0, s[4:7], s55 offen offset:2048 sc1 lds
buffer_load_dwordx4 v0, s[4:7], s55 offen offset:3072 sc1 lds
v_mfma_f32_32x32x16_bf16 v[32:47], v[20:23], v[108:111], v[32:47]
s_waitcnt lgkmcnt(2)
ds_read_b128 v[16:19], v64 offset:7168
s_add_u32 m0, s45, 4096
s_add_u32 s55, s46, 4096
buffer_load_dwordx4 v0, s[4:7], s55 offen offset:0 sc1 lds
buffer_load_dwordx4 v0, s[4:7], s55 offen offset:1024 sc1 lds
v_mfma_f32_32x32x16_bf16 v[32:47], v[24:27], v[112:115], v[32:47]
s_waitcnt lgkmcnt(2)
ds_read_b128 v[20:23], v64 offset:8192
buffer_load_dwordx4 v0, s[4:7], s55 offen offset:2048 sc1 lds
buffer_load_dwordx4 v0, s[4:7], s55 offen offset:3072 sc1 lds
v_mfma_f32_32x32x16_bf16 v[32:47], v[8:11], v[116:119], v[32:47]
s_waitcnt lgkmcnt(2)
ds_read_b128 v[24:27], v64 offset:9216
s_add_u32 m0, s45, 8192
s_add_u32 s55, s46, 8192
buffer_load_dwordx4 v0, s[4:7], s55 offen offset:0 sc1 lds
buffer_load_dwordx4 v0, s[4:7], s55 offen offset:1024 sc1 lds
v_mfma_f32_32x32x16_bf16 v[32:47], v[12:15], v[120:123], v[32:47]
s_waitcnt lgkmcnt(2)
ds_read_b128 v[8:11], v64 offset:10240
s_add_u32 s45, s45, 40960
s_cmp_ge_u32 s45, 122880
s_cselect_b32 s55, 122880, 0
s_sub_u32 s45, s45, s55
s_add_u32 s46, s46, 40960
v_mfma_f32_32x32x16_bf16 v[32:47], v[16:19], v[124:127], v[32:47]
s_waitcnt lgkmcnt(2)
ds_read_b128 v[12:15], v64 offset:11264
v_mfma_f32_32x32x16_bf16 v[32:47], v[20:23], v[128:131], v[32:47]
s_waitcnt lgkmcnt(2)
ds_read_b128 v[16:19], v64 offset:12288
v_mfma_f32_32x32x16_bf16 v[32:47], v[24:27], v[132:135], v[32:47]
s_waitcnt lgkmcnt(2)
ds_read_b128 v[20:23], v64 offset:13312
v_mfma_f32_32x32x16_bf16 v[32:47], v[8:11], v[136:139], v[32:47]
s_waitcnt lgkmcnt(2)
ds_read_b128 v[24:27], v64 offset:14336
v_mfma_f32_32x32x16_bf16 v[32:47], v[12:15], v[140:143], v[32:47]
s_waitcnt lgkmcnt(2)
ds_read_b128 v[8:11], v64 offset:15360
v_mfma_f32_32x32x16_bf16 v[32:47], v[16:19], v[144:147], v[32:47]
s_waitcnt lgkmcnt(2)
ds_read_b128 v[12:15], v64 offset:16384
v_mfma_f32_32x32x16_bf16 v[32:47], v[20:23], v[148:151], v[32:47]
s_waitcnt lgkmcnt(2)
ds_read_b128 v[16:19], v64 offset:17408
v_mfma_f32_32x32x16_bf16 v[32:47], v[24:27], v[152:155], v[32:47]
s_waitcnt lgkmcnt(2)
ds_read_b128 v[20:23], v64 offset:18432
v_mfma_f32_32x32x16_bf16 v[32:47], v[8:11], v[156:159], v[32:47]
s_waitcnt lgkmcnt(2)
ds_read_b128 v[24:27], v64 offset:19456
v_mfma_f32_32x32x16_bf16 v[32:47], v[12:15], v[160:163], v[32:47]
s_waitcnt lgkmcnt(2)
ds_read_b128 v[8:11], v64 offset:20480
v_mfma_f32_32x32x16_bf16 v[32:47], v[16:19], v[164:167], v[32:47]
s_waitcnt lgkmcnt(2)
ds_read_b128 v[12:15], v64 offset:21504
v_mfma_f32_32x32x16_bf16 v[32:47], v[20:23], v[168:171], v[32:47]
s_waitcnt lgkmcnt(2)
ds_read_b128 v[16:19], v64 offset:22528
v_mfma_f32_32x32x16_bf16 v[32:47], v[24:27], v[172:175], v[32:47]
s_waitcnt lgkmcnt(2)
ds_read_b128 v[20:23], v64 offset:23552
v_mfma_f32_32x32x16_bf16 v[32:47], v[8:11], v[176:179], v[32:47]
s_waitcnt lgkmcnt(2)
ds_read_b128 v[24:27], v64 offset:24576
v_mfma_f32_32x32x16_bf16 v[32:47], v[12:15], v[180:183], v[32:47]
s_waitcnt lgkmcnt(2)
ds_read_b128 v[8:11], v64 offset:25600
v_mfma_f32_32x32x16_bf16 v[32:47], v[16:19], v[184:187], v[32:47]
s_waitcnt lgkmcnt(2)
ds_read_b128 v[12:15], v64 offset:26624
v_mfma_f32_32x32x16_bf16 v[32:47], v[20:23], v[188:191], v[32:47]
s_waitcnt lgkmcnt(2)
ds_read_b128 v[16:19], v64 offset:27648
v_mfma_f32_32x32x16_bf16 v[32:47], v[24:27], v[192:195], v[32:47]
s_waitcnt lgkmcnt(2)
ds_read_b128 v[20:23], v64 offset:28672
v_mfma_f32_32x32x16_bf16 v[32:47], v[8:11], v[196:199], v[32:47]
s_waitcnt lgkmcnt(2)
ds_read_b128 v[24:27], v64 offset:29696
v_mfma_f32_32x32x16_bf16 v[32:47], v[12:15], v[200:203], v[32:47]
s_waitcnt lgkmcnt(2)
ds_read_b128 v[8:11], v64 offset:30720
v_mfma_f32_32x32x16_bf16 v[32:47], v[16:19], v[204:207], v[32:47]
s_waitcnt lgkmcnt(2)
ds_read_b128 v[12:15], v64 offset:31744
v_mfma_f32_32x32x16_bf16 v[32:47], v[20:23], v[208:211], v[32:47]
s_waitcnt lgkmcnt(2)
ds_read_b128 v[16:19], v64 offset:32768
v_mfma_f32_32x32x16_bf16 v[32:47], v[24:27], v[212:215], v[32:47]
s_waitcnt lgkmcnt(2)
ds_read_b128 v[20:23], v64 offset:33792
v_mfma_f32_32x32x16_bf16 v[32:47], v[8:11], v[216:219], v[32:47]
s_waitcnt lgkmcnt(2)
ds_read_b128 v[24:27], v64 offset:34816
v_mfma_f32_32x32x16_bf16 v[32:47], v[12:15], v[220:223], v[32:47]
s_waitcnt lgkmcnt(2)
ds_read_b128 v[8:11], v64 offset:35840
v_mfma_f32_32x32x16_bf16 v[32:47], v[16:19], v[224:227], v[32:47]
s_waitcnt lgkmcnt(2)
ds_read_b128 v[12:15], v64 offset:36864
v_mfma_f32_32x32x16_bf16 v[32:47], v[20:23], v[228:231], v[32:47]
s_waitcnt lgkmcnt(2)
ds_read_b128 v[16:19], v64 offset:37888
v_mfma_f32_32x32x16_bf16 v[32:47], v[24:27], v[232:235], v[32:47]
s_waitcnt lgkmcnt(2)
ds_read_b128 v[20:23], v64 offset:38912
v_mfma_f32_32x32x16_bf16 v[32:47], v[8:11], v[236:239], v[32:47]
s_waitcnt lgkmcnt(2)
ds_read_b128 v[24:27], v64 offset:39936
v_mfma_f32_32x32x16_bf16 v[32:47], v[12:15], v[240:243], v[32:47]
s_add_u32 s44, s44, 1
s_cmp_eq_u32 s44, 3
s_mov_b32 s56, 40960
s_cmov_b32 s56, -81920
s_cselect_b32 s44, 0, s44
v_add_u32 v64, s56, v64
s_waitcnt vmcnt(10) lgkmcnt(2)
s_barrier
ds_read_b128 v[8:11], v64 offset:0
v_mfma_f32_32x32x16_bf16 v[32:47], v[16:19], v[244:247], v[32:47]
s_waitcnt lgkmcnt(2)
ds_read_b128 v[12:15], v64 offset:1024
v_mfma_f32_32x32x16_bf16 v[32:47], v[20:23], v[248:251], v[32:47]
s_waitcnt lgkmcnt(2)
ds_read_b128 v[16:19], v64 offset:2048
v_mfma_f32_32x32x16_bf16 v[32:47], v[24:27], v[252:255], v[32:47]
s_waitcnt lgkmcnt(2)
ds_read_b128 v[20:23], v64 offset:3072
v_mfma_f32_32x32x16_bf16 v[48:63], v[8:11], v[96:99], 0
s_waitcnt lgkmcnt(2)
ds_read_b128 v[24:27], v64 offset:4096
v_mfma_f32_32x32x16_bf16 v[48:63], v[12:15], v[100:103], v[48:63]
s_waitcnt lgkmcnt(2)
ds_read_b128 v[8:11], v64 offset:5120
v_cvt_pk_bf16_f32 v32, v32, v33
v_cvt_pk_bf16_f32 v33, v34, v35
v_mfma_f32_32x32x16_bf16 v[48:63], v[16:19], v[104:107], v[48:63]
s_waitcnt lgkmcnt(2)
ds_read_b128 v[12:15], v64 offset:6144
v_cvt_pk_bf16_f32 v34, v36, v37
v_cvt_pk_bf16_f32 v35, v38, v39
v_mfma_f32_32x32x16_bf16 v[48:63], v[20:23], v[108:111], v[48:63]
s_waitcnt lgkmcnt(2)
ds_read_b128 v[16:19], v64 offset:7168
v_cvt_pk_bf16_f32 v36, v40, v41
v_cvt_pk_bf16_f32 v37, v42, v43
v_mfma_f32_32x32x16_bf16 v[48:63], v[24:27], v[112:115], v[48:63]
s_waitcnt lgkmcnt(2)
ds_read_b128 v[20:23], v64 offset:8192
v_cvt_pk_bf16_f32 v38, v44, v45
v_cvt_pk_bf16_f32 v39, v46, v47
v_mfma_f32_32x32x16_bf16 v[48:63], v[8:11], v[116:119], v[48:63]
s_waitcnt lgkmcnt(2)
ds_read_b128 v[24:27], v64 offset:9216
v_and_b32 v32, v1, v32
v_accvgpr_write_b32 a0, v32
v_mfma_f32_32x32x16_bf16 v[48:63], v[12:15], v[120:123], v[48:63]
s_waitcnt lgkmcnt(2)
ds_read_b128 v[8:11], v64 offset:10240
v_accvgpr_write_b32 a1, v33
v_accvgpr_write_b32 a2, v34
v_mfma_f32_32x32x16_bf16 v[48:63], v[16:19], v[124:127], v[48:63]
s_waitcnt lgkmcnt(2)
ds_read_b128 v[12:15], v64 offset:11264
v_accvgpr_write_b32 a3, v35
v_accvgpr_write_b32 a4, v36
v_mfma_f32_32x32x16_bf16 v[48:63], v[20:23], v[128:131], v[48:63]
s_waitcnt lgkmcnt(2)
ds_read_b128 v[16:19], v64 offset:12288
v_accvgpr_write_b32 a5, v37
v_accvgpr_write_b32 a6, v38
v_mfma_f32_32x32x16_bf16 v[48:63], v[24:27], v[132:135], v[48:63]
s_waitcnt lgkmcnt(2)
ds_read_b128 v[20:23], v64 offset:13312
v_accvgpr_write_b32 a7, v39
s_add_u32 m0, s45, 0
s_add_u32 s55, s46, 0
buffer_load_dwordx4 v0, s[4:7], s55 offen offset:0 sc1 lds
v_mfma_f32_32x32x16_bf16 v[48:63], v[8:11], v[136:139], v[48:63]
s_waitcnt lgkmcnt(2)
ds_read_b128 v[24:27], v64 offset:14336
buffer_load_dwordx4 v0, s[4:7], s55 offen offset:1024 sc1 lds
buffer_load_dwordx4 v0, s[4:7], s55 offen offset:2048 sc1 lds
v_mfma_f32_32x32x16_bf16 v[48:63], v[12:15], v[140:143], v[48:63]
s_waitcnt lgkmcnt(2)
ds_read_b128 v[8:11], v64 offset:15360
buffer_load_dwordx4 v0, s[4:7], s55 offen offset:3072 sc1 lds
s_add_u32 m0, s45, 4096
s_add_u32 s55, s46, 4096
buffer_load_dwordx4 v0, s[4:7], s55 offen offset:0 sc1 lds
v_mfma_f32_32x32x16_bf16 v[48:63], v[16:19], v[144:147], v[48:63]
s_waitcnt lgkmcnt(2)
ds_read_b128 v[12:15], v64 offset:16384
buffer_load_dwordx4 v0, s[4:7], s55 offen offset:1024 sc1 lds
buffer_load_dwordx4 v0, s[4:7], s55 offen offset:2048 sc1 lds
v_mfma_f32_32x32x16_bf16 v[48:63], v[20:23], v[148:151], v[48:63]
s_waitcnt lgkmcnt(2)
ds_read_b128 v[16:19], v64 offset:17408
buffer_load_dwordx4 v0, s[4:7], s55 offen offset:3072 sc1 lds
s_add_u32 m0, s45, 8192
s_add_u32 s55, s46, 8192
buffer_load_dwordx4 v0, s[4:7], s55 offen offset:0 sc1 lds
v_mfma_f32_32x32x16_bf16 v[48:63], v[24:27], v[152:155], v[48:63]
s_waitcnt lgkmcnt(2)
ds_read_b128 v[20:23], v64 offset:18432
buffer_load_dwordx4 v0, s[4:7], s55 offen offset:1024 sc1 lds
s_add_u32 s45, s45, 40960
s_cmp_ge_u32 s45, 122880
s_cselect_b32 s55, 122880, 0
s_sub_u32 s45, s45, s55
v_mfma_f32_32x32x16_bf16 v[48:63], v[8:11], v[156:159], v[48:63]
s_waitcnt lgkmcnt(2)
ds_read_b128 v[24:27], v64 offset:19456
s_add_u32 s46, s46, 40960
v_mfma_f32_32x32x16_bf16 v[48:63], v[12:15], v[160:163], v[48:63]
s_waitcnt lgkmcnt(2)
ds_read_b128 v[8:11], v64 offset:20480
v_mfma_f32_32x32x16_bf16 v[48:63], v[16:19], v[164:167], v[48:63]
s_waitcnt lgkmcnt(2)
ds_read_b128 v[12:15], v64 offset:21504
v_mfma_f32_32x32x16_bf16 v[48:63], v[20:23], v[168:171], v[48:63]
s_waitcnt lgkmcnt(2)
ds_read_b128 v[16:19], v64 offset:22528
v_mfma_f32_32x32x16_bf16 v[48:63], v[24:27], v[172:175], v[48:63]
s_waitcnt lgkmcnt(2)
ds_read_b128 v[20:23], v64 offset:23552
v_mfma_f32_32x32x16_bf16 v[48:63], v[8:11], v[176:179], v[48:63]
s_waitcnt lgkmcnt(2)
ds_read_b128 v[24:27], v64 offset:24576
v_mfma_f32_32x32x16_bf16 v[48:63], v[12:15], v[180:183], v[48:63]
s_waitcnt lgkmcnt(2)
ds_read_b128 v[8:11], v64 offset:25600
v_mfma_f32_32x32x16_bf16 v[48:63], v[16:19], v[184:187], v[48:63]
s_waitcnt lgkmcnt(2)
ds_read_b128 v[12:15], v64 offset:26624
v_mfma_f32_32x32x16_bf16 v[48:63], v[20:23], v[188:191], v[48:63]
s_waitcnt lgkmcnt(2)
ds_read_b128 v[16:19], v64 offset:27648
v_mfma_f32_32x32x16_bf16 v[48:63], v[24:27], v[192:195], v[48:63]
s_waitcnt lgkmcnt(2)
ds_read_b128 v[20:23], v64 offset:28672
v_mfma_f32_32x32x16_bf16 v[48:63], v[8:11], v[196:199], v[48:63]
s_waitcnt lgkmcnt(2)
ds_read_b128 v[24:27], v64 offset:29696
v_mfma_f32_32x32x16_bf16 v[48:63], v[12:15], v[200:203], v[48:63]
s_waitcnt lgkmcnt(2)
ds_read_b128 v[8:11], v64 offset:30720
v_mfma_f32_32x32x16_bf16 v[48:63], v[16:19], v[204:207], v[48:63]
s_waitcnt lgkmcnt(2)
ds_read_b128 v[12:15], v64 offset:31744
v_mfma_f32_32x32x16_bf16 v[48:63], v[20:23], v[208:211], v[48:63]
s_waitcnt lgkmcnt(2)
ds_read_b128 v[16:19], v64 offset:32768
v_mfma_f32_32x32x16_bf16 v[48:63], v[24:27], v[212:215], v[48:63]
s_waitcnt lgkmcnt(2)
ds_read_b128 v[20:23], v64 offset:33792
v_mfma_f32_32x32x16_bf16 v[48:63], v[8:11], v[216:219], v[48:63]
s_waitcnt lgkmcnt(2)
ds_read_b128 v[24:27], v64 offset:34816
v_mfma_f32_32x32x16_bf16 v[48:63], v[12:15], v[220:223], v[48:63]
s_waitcnt lgkmcnt(2)
ds_read_b128 v[8:11], v64 offset:35840
v_mfma_f32_32x32x16_bf16 v[48:63], v[16:19], v[224:227], v[48:63]
s_waitcnt lgkmcnt(2)
ds_read_b128 v[12:15], v64 offset:36864
v_mfma_f32_32x32x16_bf16 v[48:63], v[20:23], v[228:231], v[48:63]
s_waitcnt lgkmcnt(2)
ds_read_b128 v[16:19], v64 offset:37888
v_mfma_f32_32x32x16_bf16 v[48:63], v[24:27], v[232:235], v[48:63]
s_waitcnt lgkmcnt(2)
ds_read_b128 v[20:23], v64 offset:38912
v_mfma_f32_32x32x16_bf16 v[48:63], v[8:11], v[236:239], v[48:63]
s_waitcnt lgkmcnt(2)
ds_read_b128 v[24:27], v64 offset:39936
v_mfma_f32_32x32x16_bf16 v[48:63], v[12:15], v[240:243], v[48:63]
s_add_u32 s44, s44, 1
s_cmp_eq_u32 s44, 3
s_mov_b32 s56, 40960
s_cmov_b32 s56, -81920
s_cselect_b32 s44, 0, s44
v_add_u32 v64, s56, v64
s_waitcnt vmcnt(10) lgkmcnt(2)
s_barrier
ds_read_b128 v[8:11], v64 offset:0
v_mfma_f32_32x32x16_bf16 v[48:63], v[16:19], v[244:247], v[48:63]
s_waitcnt lgkmcnt(2)
ds_read_b128 v[12:15], v64 offset:1024
v_mfma_f32_32x32x16_bf16 v[48:63], v[20:23], v[248:251], v[48:63]
s_waitcnt lgkmcnt(2)
ds_read_b128 v[16:19], v64 offset:2048
v_mfma_f32_32x32x16_bf16 v[48:63], v[24:27], v[252:255], v[48:63]
s_waitcnt lgkmcnt(2)
ds_read_b128 v[20:23], v64 offset:3072
v_mfma_f32_32x32x16_bf16 v[32:47], v[8:11], v[96:99], 0
s_waitcnt lgkmcnt(2)
ds_read_b128 v[24:27], v64 offset:4096
v_mfma_f32_32x32x16_bf16 v[32:47], v[12:15], v[100:103], v[32:47]
s_waitcnt lgkmcnt(2)
ds_read_b128 v[8:11], v64 offset:5120
v_cvt_pk_bf16_f32 v48, v48, v49
v_cvt_pk_bf16_f32 v49, v50, v51
v_mfma_f32_32x32x16_bf16 v[32:47], v[16:19], v[104:107], v[32:47]
s_waitcnt lgkmcnt(2)
ds_read_b128 v[12:15], v64 offset:6144
v_cvt_pk_bf16_f32 v50, v52, v53
v_cvt_pk_bf16_f32 v51, v54, v55
v_mfma_f32_32x32x16_bf16 v[32:47], v[20:23], v[108:111], v[32:47]
s_waitcnt lgkmcnt(2)
ds_read_b128 v[16:19], v64 offset:7168
v_cvt_pk_bf16_f32 v52, v56, v57
v_cvt_pk_bf16_f32 v53, v58, v59
v_mfma_f32_32x32x16_bf16 v[32:47], v[24:27], v[112:115], v[32:47]
s_waitcnt lgkmcnt(2)
ds_read_b128 v[20:23], v64 offset:8192
v_cvt_pk_bf16_f32 v54, v60, v61
v_cvt_pk_bf16_f32 v55, v62, v63
v_mfma_f32_32x32x16_bf16 v[32:47], v[8:11], v[116:119], v[32:47]
s_waitcnt lgkmcnt(2)
ds_read_b128 v[24:27], v64 offset:9216
v_accvgpr_write_b32 a8, v48
v_accvgpr_write_b32 a9, v49
v_mfma_f32_32x32x16_bf16 v[32:47], v[12:15], v[120:123], v[32:47]
s_waitcnt lgkmcnt(2)
ds_read_b128 v[8:11], v64 offset:10240
v_accvgpr_write_b32 a10, v50
v_accvgpr_write_b32 a11, v51
v_mfma_f32_32x32x16_bf16 v[32:47], v[16:19], v[124:127], v[32:47]
s_waitcnt lgkmcnt(2)
ds_read_b128 v[12:15], v64 offset:11264
v_accvgpr_write_b32 a12, v52
v_accvgpr_write_b32 a13, v53
v_mfma_f32_32x32x16_bf16 v[32:47], v[20:23], v[128:131], v[32:47]
s_waitcnt lgkmcnt(2)
ds_read_b128 v[16:19], v64 offset:12288
v_accvgpr_write_b32 a14, v54
v_accvgpr_write_b32 a15, v55
v_mfma_f32_32x32x16_bf16 v[32:47], v[24:27], v[132:135], v[32:47]
s_waitcnt lgkmcnt(2)
ds_read_b128 v[20:23], v64 offset:13312
s_add_u32 m0, s45, 0
s_add_u32 s55, s46, 0
buffer_load_dwordx4 v0, s[4:7], s55 offen offset:0 sc1 lds
buffer_load_dwordx4 v0, s[4:7], s55 offen offset:1024 sc1 lds
v_mfma_f32_32x32x16_bf16 v[32:47], v[8:11], v[136:139], v[32:47]
s_waitcnt lgkmcnt(2)
ds_read_b128 v[24:27], v64 offset:14336
buffer_load_dwordx4 v0, s[4:7], s55 offen offset:2048 sc1 lds
buffer_load_dwordx4 v0, s[4:7], s55 offen offset:3072 sc1 lds
v_mfma_f32_32x32x16_bf16 v[32:47], v[12:15], v[140:143], v[32:47]
s_waitcnt lgkmcnt(2)
ds_read_b128 v[8:11], v64 offset:15360
s_add_u32 m0, s45, 4096
s_add_u32 s55, s46, 4096
buffer_load_dwordx4 v0, s[4:7], s55 offen offset:0 sc1 lds
buffer_load_dwordx4 v0, s[4:7], s55 offen offset:1024 sc1 lds
v_mfma_f32_32x32x16_bf16 v[32:47], v[16:19], v[144:147], v[32:47]
s_waitcnt lgkmcnt(2)
ds_read_b128 v[12:15], v64 offset:16384
buffer_load_dwordx4 v0, s[4:7], s55 offen offset:2048 sc1 lds
buffer_load_dwordx4 v0, s[4:7], s55 offen offset:3072 sc1 lds
v_mfma_f32_32x32x16_bf16 v[32:47], v[20:23], v[148:151], v[32:47]
s_waitcnt lgkmcnt(2)
ds_read_b128 v[16:19], v64 offset:17408
s_add_u32 m0, s45, 8192
s_add_u32 s55, s46, 8192
buffer_load_dwordx4 v0, s[4:7], s55 offen offset:0 sc1 lds
buffer_load_dwordx4 v0, s[4:7], s55 offen offset:1024 sc1 lds
v_mfma_f32_32x32x16_bf16 v[32:47], v[24:27], v[152:155], v[32:47]
s_waitcnt lgkmcnt(2)
ds_read_b128 v[20:23], v64 offset:18432
s_add_u32 s45, s45, 40960
s_cmp_ge_u32 s45, 122880
s_cselect_b32 s55, 122880, 0
s_sub_u32 s45, s45, s55
s_add_u32 s46, s46, 40960
v_mfma_f32_32x32x16_bf16 v[32:47], v[8:11], v[156:159], v[32:47]
s_waitcnt lgkmcnt(2)
ds_read_b128 v[24:27], v64 offset:19456
v_mfma_f32_32x32x16_bf16 v[32:47], v[12:15], v[160:163], v[32:47]
s_waitcnt lgkmcnt(2)
ds_read_b128 v[8:11], v64 offset:20480
v_mfma_f32_32x32x16_bf16 v[32:47], v[16:19], v[164:167], v[32:47]
s_waitcnt lgkmcnt(2)
ds_read_b128 v[12:15], v64 offset:21504
v_mfma_f32_32x32x16_bf16 v[32:47], v[20:23], v[168:171], v[32:47]
s_waitcnt lgkmcnt(2)
ds_read_b128 v[16:19], v64 offset:22528
v_mfma_f32_32x32x16_bf16 v[32:47], v[24:27], v[172:175], v[32:47]
s_waitcnt lgkmcnt(2)
ds_read_b128 v[20:23], v64 offset:23552
v_mfma_f32_32x32x16_bf16 v[32:47], v[8:11], v[176:179], v[32:47]
s_waitcnt lgkmcnt(2)
ds_read_b128 v[24:27], v64 offset:24576
v_mfma_f32_32x32x16_bf16 v[32:47], v[12:15], v[180:183], v[32:47]
s_waitcnt lgkmcnt(2)
ds_read_b128 v[8:11], v64 offset:25600
v_mfma_f32_32x32x16_bf16 v[32:47], v[16:19], v[184:187], v[32:47]
s_waitcnt lgkmcnt(2)
ds_read_b128 v[12:15], v64 offset:26624
v_mfma_f32_32x32x16_bf16 v[32:47], v[20:23], v[188:191], v[32:47]
s_waitcnt lgkmcnt(2)
ds_read_b128 v[16:19], v64 offset:27648
v_mfma_f32_32x32x16_bf16 v[32:47], v[24:27], v[192:195], v[32:47]
s_waitcnt lgkmcnt(2)
ds_read_b128 v[20:23], v64 offset:28672
v_mfma_f32_32x32x16_bf16 v[32:47], v[8:11], v[196:199], v[32:47]
s_waitcnt lgkmcnt(2)
ds_read_b128 v[24:27], v64 offset:29696
v_mfma_f32_32x32x16_bf16 v[32:47], v[12:15], v[200:203], v[32:47]
s_waitcnt lgkmcnt(2)
ds_read_b128 v[8:11], v64 offset:30720
v_mfma_f32_32x32x16_bf16 v[32:47], v[16:19], v[204:207], v[32:47]
s_waitcnt lgkmcnt(2)
ds_read_b128 v[12:15], v64 offset:31744
v_mfma_f32_32x32x16_bf16 v[32:47], v[20:23], v[208:211], v[32:47]
s_waitcnt lgkmcnt(2)
ds_read_b128 v[16:19], v64 offset:32768
v_mfma_f32_32x32x16_bf16 v[32:47], v[24:27], v[212:215], v[32:47]
s_waitcnt lgkmcnt(2)
ds_read_b128 v[20:23], v64 offset:33792
v_mfma_f32_32x32x16_bf16 v[32:47], v[8:11], v[216:219], v[32:47]
s_waitcnt lgkmcnt(2)
ds_read_b128 v[24:27], v64 offset:34816
v_mfma_f32_32x32x16_bf16 v[32:47], v[12:15], v[220:223], v[32:47]
s_waitcnt lgkmcnt(2)
ds_read_b128 v[8:11], v64 offset:35840
v_mfma_f32_32x32x16_bf16 v[32:47], v[16:19], v[224:227], v[32:47]
s_waitcnt lgkmcnt(2)
ds_read_b128 v[12:15], v64 offset:36864
v_mfma_f32_32x32x16_bf16 v[32:47], v[20:23], v[228:231], v[32:47]
s_waitcnt lgkmcnt(2)
ds_read_b128 v[16:19], v64 offset:37888
v_mfma_f32_32x32x16_bf16 v[32:47], v[24:27], v[232:235], v[32:47]
s_waitcnt lgkmcnt(2)
ds_read_b128 v[20:23], v64 offset:38912
v_mfma_f32_32x32x16_bf16 v[32:47], v[8:11], v[236:239], v[32:47]
s_waitcnt lgkmcnt(2)
ds_read_b128 v[24:27], v64 offset:39936
v_mfma_f32_32x32x16_bf16 v[32:47], v[12:15], v[240:243], v[32:47]
s_add_u32 s44, s44, 1
s_cmp_eq_u32 s44, 3
s_mov_b32 s56, 40960
s_cmov_b32 s56, -81920
s_cselect_b32 s44, 0, s44
v_add_u32 v64, s56, v64
s_waitcnt vmcnt(10) lgkmcnt(2)
s_barrier
ds_read_b128 v[8:11], v64 offset:0
v_mfma_f32_32x32x16_bf16 v[32:47], v[16:19], v[244:247], v[32:47]
s_waitcnt lgkmcnt(2)
ds_read_b128 v[12:15], v64 offset:1024
v_mfma_f32_32x32x16_bf16 v[32:47], v[20:23], v[248:251], v[32:47]
s_waitcnt lgkmcnt(2)
ds_read_b128 v[16:19], v64 offset:2048
v_mfma_f32_32x32x16_bf16 v[32:47], v[24:27], v[252:255], v[32:47]
s_waitcnt lgkmcnt(2)
ds_read_b128 v[20:23], v64 offset:3072
v_mfma_f32_32x32x16_bf16 v[48:63], v[8:11], v[96:99], 0
s_waitcnt lgkmcnt(2)
ds_read_b128 v[24:27], v64 offset:4096
v_mfma_f32_32x32x16_bf16 v[48:63], v[12:15], v[100:103], v[48:63]
s_waitcnt lgkmcnt(2)
ds_read_b128 v[8:11], v64 offset:5120
v_cvt_pk_bf16_f32 v32, v32, v33
v_cvt_pk_bf16_f32 v33, v34, v35
v_mfma_f32_32x32x16_bf16 v[48:63], v[16:19], v[104:107], v[48:63]
s_waitcnt lgkmcnt(2)
ds_read_b128 v[12:15], v64 offset:6144
v_cvt_pk_bf16_f32 v34, v36, v37
v_cvt_pk_bf16_f32 v35, v38, v39
v_mfma_f32_32x32x16_bf16 v[48:63], v[20:23], v[108:111], v[48:63]
s_waitcnt lgkmcnt(2)
ds_read_b128 v[16:19], v64 offset:7168
v_cvt_pk_bf16_f32 v36, v40, v41
v_cvt_pk_bf16_f32 v37, v42, v43
v_mfma_f32_32x32x16_bf16 v[48:63], v[24:27], v[112:115], v[48:63]
s_waitcnt lgkmcnt(2)
ds_read_b128 v[20:23], v64 offset:8192
v_cvt_pk_bf16_f32 v38, v44, v45
v_cvt_pk_bf16_f32 v39, v46, v47
v_mfma_f32_32x32x16_bf16 v[48:63], v[8:11], v[116:119], v[48:63]
s_waitcnt lgkmcnt(2)
ds_read_b128 v[24:27], v64 offset:9216
v_accvgpr_write_b32 a16, v32
v_accvgpr_write_b32 a17, v33
v_mfma_f32_32x32x16_bf16 v[48:63], v[12:15], v[120:123], v[48:63]
s_waitcnt lgkmcnt(2)
ds_read_b128 v[8:11], v64 offset:10240
v_accvgpr_write_b32 a18, v34
v_accvgpr_write_b32 a19, v35
v_mfma_f32_32x32x16_bf16 v[48:63], v[16:19], v[124:127], v[48:63]
s_waitcnt lgkmcnt(2)
ds_read_b128 v[12:15], v64 offset:11264
v_accvgpr_write_b32 a20, v36
v_accvgpr_write_b32 a21, v37
v_mfma_f32_32x32x16_bf16 v[48:63], v[20:23], v[128:131], v[48:63]
s_waitcnt lgkmcnt(2)
ds_read_b128 v[16:19], v64 offset:12288
v_accvgpr_write_b32 a22, v38
v_accvgpr_write_b32 a23, v39
v_mfma_f32_32x32x16_bf16 v[48:63], v[24:27], v[132:135], v[48:63]
s_waitcnt lgkmcnt(2)
ds_read_b128 v[20:23], v64 offset:13312
s_add_u32 m0, s45, 0
s_add_u32 s55, s46, 0
buffer_load_dwordx4 v0, s[4:7], s55 offen offset:0 sc1 lds
buffer_load_dwordx4 v0, s[4:7], s55 offen offset:1024 sc1 lds
v_mfma_f32_32x32x16_bf16 v[48:63], v[8:11], v[136:139], v[48:63]
s_waitcnt lgkmcnt(2)
ds_read_b128 v[24:27], v64 offset:14336
buffer_load_dwordx4 v0, s[4:7], s55 offen offset:2048 sc1 lds
buffer_load_dwordx4 v0, s[4:7], s55 offen offset:3072 sc1 lds
v_mfma_f32_32x32x16_bf16 v[48:63], v[12:15], v[140:143], v[48:63]
s_waitcnt lgkmcnt(2)
ds_read_b128 v[8:11], v64 offset:15360
s_add_u32 m0, s45, 4096
s_add_u32 s55, s46, 4096
buffer_load_dwordx4 v0, s[4:7], s55 offen offset:0 sc1 lds
buffer_load_dwordx4 v0, s[4:7], s55 offen offset:1024 sc1 lds
v_mfma_f32_32x32x16_bf16 v[48:63], v[16:19], v[144:147], v[48:63]
s_waitcnt lgkmcnt(2)
ds_read_b128 v[12:15], v64 offset:16384
buffer_load_dwordx4 v0, s[4:7], s55 offen offset:2048 sc1 lds
buffer_load_dwordx4 v0, s[4:7], s55 offen offset:3072 sc1 lds
v_mfma_f32_32x32x16_bf16 v[48:63], v[20:23], v[148:151], v[48:63]
s_waitcnt lgkmcnt(2)
ds_read_b128 v[16:19], v64 offset:17408
s_add_u32 m0, s45, 8192
s_add_u32 s55, s46, 8192
buffer_load_dwordx4 v0, s[4:7], s55 offen offset:0 sc1 lds
buffer_load_dwordx4 v0, s[4:7], s55 offen offset:1024 sc1 lds
v_mfma_f32_32x32x16_bf16 v[48:63], v[24:27], v[152:155], v[48:63]
s_waitcnt lgkmcnt(2)
ds_read_b128 v[20:23], v64 offset:18432
s_add_u32 s45, s45, 40960
s_cmp_ge_u32 s45, 122880
s_cselect_b32 s55, 122880, 0
s_sub_u32 s45, s45, s55
s_add_u32 s46, s46, 40960
v_mfma_f32_32x32x16_bf16 v[48:63], v[8:11], v[156:159], v[48:63]
s_waitcnt lgkmcnt(2)
ds_read_b128 v[24:27], v64 offset:19456
v_mfma_f32_32x32x16_bf16 v[48:63], v[12:15], v[160:163], v[48:63]
s_waitcnt lgkmcnt(2)
ds_read_b128 v[8:11], v64 offset:20480
v_mfma_f32_32x32x16_bf16 v[48:63], v[16:19], v[164:167], v[48:63]
s_waitcnt lgkmcnt(2)
ds_read_b128 v[12:15], v64 offset:21504
v_mfma_f32_32x32x16_bf16 v[48:63], v[20:23], v[168:171], v[48:63]
s_waitcnt lgkmcnt(2)
ds_read_b128 v[16:19], v64 offset:22528
v_mfma_f32_32x32x16_bf16 v[48:63], v[24:27], v[172:175], v[48:63]
s_waitcnt lgkmcnt(2)
ds_read_b128 v[20:23], v64 offset:23552
v_mfma_f32_32x32x16_bf16 v[48:63], v[8:11], v[176:179], v[48:63]
s_waitcnt lgkmcnt(2)
ds_read_b128 v[24:27], v64 offset:24576
v_mfma_f32_32x32x16_bf16 v[48:63], v[12:15], v[180:183], v[48:63]
s_waitcnt lgkmcnt(2)
ds_read_b128 v[8:11], v64 offset:25600
v_mfma_f32_32x32x16_bf16 v[48:63], v[16:19], v[184:187], v[48:63]
s_waitcnt lgkmcnt(2)
ds_read_b128 v[12:15], v64 offset:26624
v_mfma_f32_32x32x16_bf16 v[48:63], v[20:23], v[188:191], v[48:63]
s_waitcnt lgkmcnt(2)
ds_read_b128 v[16:19], v64 offset:27648
v_mfma_f32_32x32x16_bf16 v[48:63], v[24:27], v[192:195], v[48:63]
s_waitcnt lgkmcnt(2)
ds_read_b128 v[20:23], v64 offset:28672
v_mfma_f32_32x32x16_bf16 v[48:63], v[8:11], v[196:199], v[48:63]
s_waitcnt lgkmcnt(2)
ds_read_b128 v[24:27], v64 offset:29696
v_mfma_f32_32x32x16_bf16 v[48:63], v[12:15], v[200:203], v[48:63]
s_waitcnt lgkmcnt(2)
ds_read_b128 v[8:11], v64 offset:30720
v_mfma_f32_32x32x16_bf16 v[48:63], v[16:19], v[204:207], v[48:63]
s_waitcnt lgkmcnt(2)
ds_read_b128 v[12:15], v64 offset:31744
v_mfma_f32_32x32x16_bf16 v[48:63], v[20:23], v[208:211], v[48:63]
s_waitcnt lgkmcnt(2)
ds_read_b128 v[16:19], v64 offset:32768
v_mfma_f32_32x32x16_bf16 v[48:63], v[24:27], v[212:215], v[48:63]
s_waitcnt lgkmcnt(2)
ds_read_b128 v[20:23], v64 offset:33792
v_mfma_f32_32x32x16_bf16 v[48:63], v[8:11], v[216:219], v[48:63]
s_waitcnt lgkmcnt(2)
ds_read_b128 v[24:27], v64 offset:34816
v_mfma_f32_32x32x16_bf16 v[48:63], v[12:15], v[220:223], v[48:63]
s_waitcnt lgkmcnt(2)
ds_read_b128 v[8:11], v64 offset:35840
v_mfma_f32_32x32x16_bf16 v[48:63], v[16:19], v[224:227], v[48:63]
s_waitcnt lgkmcnt(2)
ds_read_b128 v[12:15], v64 offset:36864
v_mfma_f32_32x32x16_bf16 v[48:63], v[20:23], v[228:231], v[48:63]
s_waitcnt lgkmcnt(2)
ds_read_b128 v[16:19], v64 offset:37888
v_mfma_f32_32x32x16_bf16 v[48:63], v[24:27], v[232:235], v[48:63]
s_waitcnt lgkmcnt(2)
ds_read_b128 v[20:23], v64 offset:38912
v_mfma_f32_32x32x16_bf16 v[48:63], v[8:11], v[236:239], v[48:63]
s_waitcnt lgkmcnt(2)
ds_read_b128 v[24:27], v64 offset:39936
v_mfma_f32_32x32x16_bf16 v[48:63], v[12:15], v[240:243], v[48:63]
s_add_u32 s44, s44, 1
s_cmp_eq_u32 s44, 3
s_mov_b32 s56, 40960
s_cmov_b32 s56, -81920
s_cselect_b32 s44, 0, s44
v_add_u32 v64, s56, v64
s_waitcnt vmcnt(10) lgkmcnt(2)
s_barrier
ds_read_b128 v[8:11], v64 offset:0
v_mfma_f32_32x32x16_bf16 v[48:63], v[16:19], v[244:247], v[48:63]
s_waitcnt lgkmcnt(2)
ds_read_b128 v[12:15], v64 offset:1024
v_mfma_f32_32x32x16_bf16 v[48:63], v[20:23], v[248:251], v[48:63]
s_waitcnt lgkmcnt(2)
ds_read_b128 v[16:19], v64 offset:2048
v_mfma_f32_32x32x16_bf16 v[48:63], v[24:27], v[252:255], v[48:63]
s_waitcnt lgkmcnt(2)
ds_read_b128 v[20:23], v64 offset:3072
v_mfma_f32_32x32x16_bf16 v[32:47], v[8:11], v[96:99], 0
s_waitcnt lgkmcnt(2)
ds_read_b128 v[24:27], v64 offset:4096
v_mfma_f32_32x32x16_bf16 v[32:47], v[12:15], v[100:103], v[32:47]
s_waitcnt lgkmcnt(2)
ds_read_b128 v[8:11], v64 offset:5120
v_cvt_pk_bf16_f32 v48, v48, v49
v_cvt_pk_bf16_f32 v49, v50, v51
v_mfma_f32_32x32x16_bf16 v[32:47], v[16:19], v[104:107], v[32:47]
s_waitcnt lgkmcnt(2)
ds_read_b128 v[12:15], v64 offset:6144
v_cvt_pk_bf16_f32 v50, v52, v53
v_cvt_pk_bf16_f32 v51, v54, v55
v_mfma_f32_32x32x16_bf16 v[32:47], v[20:23], v[108:111], v[32:47]
s_waitcnt lgkmcnt(2)
ds_read_b128 v[16:19], v64 offset:7168
v_cvt_pk_bf16_f32 v52, v56, v57
v_cvt_pk_bf16_f32 v53, v58, v59
v_mfma_f32_32x32x16_bf16 v[32:47], v[24:27], v[112:115], v[32:47]
s_waitcnt lgkmcnt(2)
ds_read_b128 v[20:23], v64 offset:8192
v_cvt_pk_bf16_f32 v54, v60, v61
v_cvt_pk_bf16_f32 v55, v62, v63
v_mfma_f32_32x32x16_bf16 v[32:47], v[8:11], v[116:119], v[32:47]
s_waitcnt lgkmcnt(2)
ds_read_b128 v[24:27], v64 offset:9216
v_accvgpr_write_b32 a24, v48
v_accvgpr_write_b32 a25, v49
v_mfma_f32_32x32x16_bf16 v[32:47], v[12:15], v[120:123], v[32:47]
s_waitcnt lgkmcnt(2)
ds_read_b128 v[8:11], v64 offset:10240
v_accvgpr_write_b32 a26, v50
v_accvgpr_write_b32 a27, v51
v_mfma_f32_32x32x16_bf16 v[32:47], v[16:19], v[124:127], v[32:47]
s_waitcnt lgkmcnt(2)
ds_read_b128 v[12:15], v64 offset:11264
v_accvgpr_write_b32 a28, v52
v_accvgpr_write_b32 a29, v53
v_mfma_f32_32x32x16_bf16 v[32:47], v[20:23], v[128:131], v[32:47]
s_waitcnt lgkmcnt(2)
ds_read_b128 v[16:19], v64 offset:12288
v_accvgpr_write_b32 a30, v54
v_accvgpr_write_b32 a31, v55
v_mfma_f32_32x32x16_bf16 v[32:47], v[24:27], v[132:135], v[32:47]
s_waitcnt lgkmcnt(2)
ds_read_b128 v[20:23], v64 offset:13312
s_add_u32 m0, s45, 0
s_add_u32 s55, s46, 0
buffer_load_dwordx4 v0, s[4:7], s55 offen offset:0 sc1 lds
buffer_load_dwordx4 v0, s[4:7], s55 offen offset:1024 sc1 lds
v_mfma_f32_32x32x16_bf16 v[32:47], v[8:11], v[136:139], v[32:47]
s_waitcnt lgkmcnt(2)
ds_read_b128 v[24:27], v64 offset:14336
buffer_load_dwordx4 v0, s[4:7], s55 offen offset:2048 sc1 lds
buffer_load_dwordx4 v0, s[4:7], s55 offen offset:3072 sc1 lds
v_mfma_f32_32x32x16_bf16 v[32:47], v[12:15], v[140:143], v[32:47]
s_waitcnt lgkmcnt(2)
ds_read_b128 v[8:11], v64 offset:15360
s_add_u32 m0, s45, 4096
s_add_u32 s55, s46, 4096
buffer_load_dwordx4 v0, s[4:7], s55 offen offset:0 sc1 lds
buffer_load_dwordx4 v0, s[4:7], s55 offen offset:1024 sc1 lds
v_mfma_f32_32x32x16_bf16 v[32:47], v[16:19], v[144:147], v[32:47]
s_waitcnt lgkmcnt(2)
ds_read_b128 v[12:15], v64 offset:16384
buffer_load_dwordx4 v0, s[4:7], s55 offen offset:2048 sc1 lds
buffer_load_dwordx4 v0, s[4:7], s55 offen offset:3072 sc1 lds
v_mfma_f32_32x32x16_bf16 v[32:47], v[20:23], v[148:151], v[32:47]
s_waitcnt lgkmcnt(2)
ds_read_b128 v[16:19], v64 offset:17408
s_add_u32 m0, s45, 8192
s_add_u32 s55, s46, 8192
buffer_load_dwordx4 v0, s[4:7], s55 offen offset:0 sc1 lds
buffer_load_dwordx4 v0, s[4:7], s55 offen offset:1024 sc1 lds
v_mfma_f32_32x32x16_bf16 v[32:47], v[24:27], v[152:155], v[32:47]
s_waitcnt lgkmcnt(2)
ds_read_b128 v[20:23], v64 offset:18432
s_add_u32 s45, s45, 40960
s_cmp_ge_u32 s45, 122880
s_cselect_b32 s55, 122880, 0
s_sub_u32 s45, s45, s55
s_add_u32 s46, s46, 40960
v_mfma_f32_32x32x16_bf16 v[32:47], v[8:11], v[156:159], v[32:47]
s_waitcnt lgkmcnt(2)
ds_read_b128 v[24:27], v64 offset:19456
v_mfma_f32_32x32x16_bf16 v[32:47], v[12:15], v[160:163], v[32:47]
s_waitcnt lgkmcnt(2)
ds_read_b128 v[8:11], v64 offset:20480
v_mfma_f32_32x32x16_bf16 v[32:47], v[16:19], v[164:167], v[32:47]
s_waitcnt lgkmcnt(2)
ds_read_b128 v[12:15], v64 offset:21504
v_mfma_f32_32x32x16_bf16 v[32:47], v[20:23], v[168:171], v[32:47]
s_waitcnt lgkmcnt(2)
ds_read_b128 v[16:19], v64 offset:22528
v_mfma_f32_32x32x16_bf16 v[32:47], v[24:27], v[172:175], v[32:47]
s_waitcnt lgkmcnt(2)
ds_read_b128 v[20:23], v64 offset:23552
v_mfma_f32_32x32x16_bf16 v[32:47], v[8:11], v[176:179], v[32:47]
s_waitcnt lgkmcnt(2)
ds_read_b128 v[24:27], v64 offset:24576
v_mfma_f32_32x32x16_bf16 v[32:47], v[12:15], v[180:183], v[32:47]
s_waitcnt lgkmcnt(2)
ds_read_b128 v[8:11], v64 offset:25600
v_mfma_f32_32x32x16_bf16 v[32:47], v[16:19], v[184:187], v[32:47]
s_waitcnt lgkmcnt(2)
ds_read_b128 v[12:15], v64 offset:26624
v_mfma_f32_32x32x16_bf16 v[32:47], v[20:23], v[188:191], v[32:47]
s_waitcnt lgkmcnt(2)
ds_read_b128 v[16:19], v64 offset:27648
v_mfma_f32_32x32x16_bf16 v[32:47], v[24:27], v[192:195], v[32:47]
s_waitcnt lgkmcnt(2)
ds_read_b128 v[20:23], v64 offset:28672
v_mfma_f32_32x32x16_bf16 v[32:47], v[8:11], v[196:199], v[32:47]
s_waitcnt lgkmcnt(2)
ds_read_b128 v[24:27], v64 offset:29696
v_mfma_f32_32x32x16_bf16 v[32:47], v[12:15], v[200:203], v[32:47]
s_waitcnt lgkmcnt(2)
ds_read_b128 v[8:11], v64 offset:30720
v_mfma_f32_32x32x16_bf16 v[32:47], v[16:19], v[204:207], v[32:47]
s_waitcnt lgkmcnt(2)
ds_read_b128 v[12:15], v64 offset:31744
v_mfma_f32_32x32x16_bf16 v[32:47], v[20:23], v[208:211], v[32:47]
s_waitcnt lgkmcnt(2)
ds_read_b128 v[16:19], v64 offset:32768
v_mfma_f32_32x32x16_bf16 v[32:47], v[24:27], v[212:215], v[32:47]
s_waitcnt lgkmcnt(2)
ds_read_b128 v[20:23], v64 offset:33792
v_mfma_f32_32x32x16_bf16 v[32:47], v[8:11], v[216:219], v[32:47]
s_waitcnt lgkmcnt(2)
ds_read_b128 v[24:27], v64 offset:34816
v_mfma_f32_32x32x16_bf16 v[32:47], v[12:15], v[220:223], v[32:47]
s_waitcnt lgkmcnt(2)
ds_read_b128 v[8:11], v64 offset:35840
v_mfma_f32_32x32x16_bf16 v[32:47], v[16:19], v[224:227], v[32:47]
s_waitcnt lgkmcnt(2)
ds_read_b128 v[12:15], v64 offset:36864
v_mfma_f32_32x32x16_bf16 v[32:47], v[20:23], v[228:231], v[32:47]
s_waitcnt lgkmcnt(2)
ds_read_b128 v[16:19], v64 offset:37888
v_mfma_f32_32x32x16_bf16 v[32:47], v[24:27], v[232:235], v[32:47]
s_waitcnt lgkmcnt(2)
ds_read_b128 v[20:23], v64 offset:38912
v_mfma_f32_32x32x16_bf16 v[32:47], v[8:11], v[236:239], v[32:47]
s_waitcnt lgkmcnt(2)
ds_read_b128 v[24:27], v64 offset:39936
v_mfma_f32_32x32x16_bf16 v[32:47], v[12:15], v[240:243], v[32:47]
s_add_u32 s44, s44, 1
s_cmp_eq_u32 s44, 3
s_mov_b32 s56, 40960
s_cmov_b32 s56, -81920
s_cselect_b32 s44, 0, s44
v_add_u32 v64, s56, v64
s_waitcnt vmcnt(10) lgkmcnt(2)
s_barrier
ds_read_b128 v[8:11], v64 offset:0
v_mfma_f32_32x32x16_bf16 v[32:47], v[16:19], v[244:247], v[32:47]
s_waitcnt lgkmcnt(2)
ds_read_b128 v[12:15], v64 offset:1024
v_mfma_f32_32x32x16_bf16 v[32:47], v[20:23], v[248:251], v[32:47]
s_waitcnt lgkmcnt(2)
ds_read_b128 v[16:19], v64 offset:2048
v_mfma_f32_32x32x16_bf16 v[32:47], v[24:27], v[252:255], v[32:47]
s_waitcnt lgkmcnt(2)
ds_read_b128 v[20:23], v64 offset:3072
v_mfma_f32_32x32x16_bf16 v[48:63], v[8:11], v[96:99], 0
s_waitcnt lgkmcnt(2)
ds_read_b128 v[24:27], v64 offset:4096
v_mfma_f32_32x32x16_bf16 v[48:63], v[12:15], v[100:103], v[48:63]
s_waitcnt lgkmcnt(2)
ds_read_b128 v[8:11], v64 offset:5120
v_cvt_pk_bf16_f32 v32, v32, v33
v_cvt_pk_bf16_f32 v33, v34, v35
v_mfma_f32_32x32x16_bf16 v[48:63], v[16:19], v[104:107], v[48:63]
s_waitcnt lgkmcnt(2)
ds_read_b128 v[12:15], v64 offset:6144
v_cvt_pk_bf16_f32 v34, v36, v37
v_cvt_pk_bf16_f32 v35, v38, v39
v_mfma_f32_32x32x16_bf16 v[48:63], v[20:23], v[108:111], v[48:63]
s_waitcnt lgkmcnt(2)
ds_read_b128 v[16:19], v64 offset:7168
v_cvt_pk_bf16_f32 v36, v40, v41
v_cvt_pk_bf16_f32 v37, v42, v43
v_mfma_f32_32x32x16_bf16 v[48:63], v[24:27], v[112:115], v[48:63]
s_waitcnt lgkmcnt(2)
ds_read_b128 v[20:23], v64 offset:8192
v_cvt_pk_bf16_f32 v38, v44, v45
v_cvt_pk_bf16_f32 v39, v46, v47
v_mfma_f32_32x32x16_bf16 v[48:63], v[8:11], v[116:119], v[48:63]
s_waitcnt lgkmcnt(2)
ds_read_b128 v[24:27], v64 offset:9216
v_accvgpr_write_b32 a32, v32
v_accvgpr_write_b32 a33, v33
v_mfma_f32_32x32x16_bf16 v[48:63], v[12:15], v[120:123], v[48:63]
s_waitcnt lgkmcnt(2)
ds_read_b128 v[8:11], v64 offset:10240
v_accvgpr_write_b32 a34, v34
v_accvgpr_write_b32 a35, v35
v_mfma_f32_32x32x16_bf16 v[48:63], v[16:19], v[124:127], v[48:63]
s_waitcnt lgkmcnt(2)
ds_read_b128 v[12:15], v64 offset:11264
v_accvgpr_write_b32 a36, v36
v_accvgpr_write_b32 a37, v37
v_mfma_f32_32x32x16_bf16 v[48:63], v[20:23], v[128:131], v[48:63]
s_waitcnt lgkmcnt(2)
ds_read_b128 v[16:19], v64 offset:12288
v_accvgpr_write_b32 a38, v38
v_accvgpr_write_b32 a39, v39
v_mfma_f32_32x32x16_bf16 v[48:63], v[24:27], v[132:135], v[48:63]
s_waitcnt lgkmcnt(2)
ds_read_b128 v[20:23], v64 offset:13312
s_add_u32 m0, s45, 0
s_add_u32 s55, s46, 0
buffer_load_dwordx4 v0, s[4:7], s55 offen offset:0 sc1 lds
buffer_load_dwordx4 v0, s[4:7], s55 offen offset:1024 sc1 lds
v_mfma_f32_32x32x16_bf16 v[48:63], v[8:11], v[136:139], v[48:63]
s_waitcnt lgkmcnt(2)
ds_read_b128 v[24:27], v64 offset:14336
buffer_load_dwordx4 v0, s[4:7], s55 offen offset:2048 sc1 lds
buffer_load_dwordx4 v0, s[4:7], s55 offen offset:3072 sc1 lds
v_mfma_f32_32x32x16_bf16 v[48:63], v[12:15], v[140:143], v[48:63]
s_waitcnt lgkmcnt(2)
ds_read_b128 v[8:11], v64 offset:15360
s_add_u32 m0, s45, 4096
s_add_u32 s55, s46, 4096
buffer_load_dwordx4 v0, s[4:7], s55 offen offset:0 sc1 lds
buffer_load_dwordx4 v0, s[4:7], s55 offen offset:1024 sc1 lds
v_mfma_f32_32x32x16_bf16 v[48:63], v[16:19], v[144:147], v[48:63]
s_waitcnt lgkmcnt(2)
ds_read_b128 v[12:15], v64 offset:16384
buffer_load_dwordx4 v0, s[4:7], s55 offen offset:2048 sc1 lds
buffer_load_dwordx4 v0, s[4:7], s55 offen offset:3072 sc1 lds
v_mfma_f32_32x32x16_bf16 v[48:63], v[20:23], v[148:151], v[48:63]
s_waitcnt lgkmcnt(2)
ds_read_b128 v[16:19], v64 offset:17408
s_add_u32 m0, s45, 8192
s_add_u32 s55, s46, 8192
buffer_load_dwordx4 v0, s[4:7], s55 offen offset:0 sc1 lds
buffer_load_dwordx4 v0, s[4:7], s55 offen offset:1024 sc1 lds
v_mfma_f32_32x32x16_bf16 v[48:63], v[24:27], v[152:155], v[48:63]
s_waitcnt lgkmcnt(2)
ds_read_b128 v[20:23], v64 offset:18432
s_add_u32 s45, s45, 40960
s_cmp_ge_u32 s45, 122880
s_cselect_b32 s55, 122880, 0
s_sub_u32 s45, s45, s55
s_add_u32 s46, s46, 40960
v_mfma_f32_32x32x16_bf16 v[48:63], v[8:11], v[156:159], v[48:63]
s_waitcnt lgkmcnt(2)
ds_read_b128 v[24:27], v64 offset:19456
v_mfma_f32_32x32x16_bf16 v[48:63], v[12:15], v[160:163], v[48:63]
s_waitcnt lgkmcnt(2)
ds_read_b128 v[8:11], v64 offset:20480
v_mfma_f32_32x32x16_bf16 v[48:63], v[16:19], v[164:167], v[48:63]
s_waitcnt lgkmcnt(2)
ds_read_b128 v[12:15], v64 offset:21504
v_mfma_f32_32x32x16_bf16 v[48:63], v[20:23], v[168:171], v[48:63]
s_waitcnt lgkmcnt(2)
ds_read_b128 v[16:19], v64 offset:22528
v_mfma_f32_32x32x16_bf16 v[48:63], v[24:27], v[172:175], v[48:63]
s_waitcnt lgkmcnt(2)
ds_read_b128 v[20:23], v64 offset:23552
v_mfma_f32_32x32x16_bf16 v[48:63], v[8:11], v[176:179], v[48:63]
s_waitcnt lgkmcnt(2)
ds_read_b128 v[24:27], v64 offset:24576
v_mfma_f32_32x32x16_bf16 v[48:63], v[12:15], v[180:183], v[48:63]
s_waitcnt lgkmcnt(2)
ds_read_b128 v[8:11], v64 offset:25600
v_mfma_f32_32x32x16_bf16 v[48:63], v[16:19], v[184:187], v[48:63]
s_waitcnt lgkmcnt(2)
ds_read_b128 v[12:15], v64 offset:26624
v_mfma_f32_32x32x16_bf16 v[48:63], v[20:23], v[188:191], v[48:63]
s_waitcnt lgkmcnt(2)
ds_read_b128 v[16:19], v64 offset:27648
v_mfma_f32_32x32x16_bf16 v[48:63], v[24:27], v[192:195], v[48:63]
s_waitcnt lgkmcnt(2)
ds_read_b128 v[20:23], v64 offset:28672
v_mfma_f32_32x32x16_bf16 v[48:63], v[8:11], v[196:199], v[48:63]
s_waitcnt lgkmcnt(2)
ds_read_b128 v[24:27], v64 offset:29696
v_mfma_f32_32x32x16_bf16 v[48:63], v[12:15], v[200:203], v[48:63]
s_waitcnt lgkmcnt(2)
ds_read_b128 v[8:11], v64 offset:30720
v_mfma_f32_32x32x16_bf16 v[48:63], v[16:19], v[204:207], v[48:63]
s_waitcnt lgkmcnt(2)
ds_read_b128 v[12:15], v64 offset:31744
v_mfma_f32_32x32x16_bf16 v[48:63], v[20:23], v[208:211], v[48:63]
s_waitcnt lgkmcnt(2)
ds_read_b128 v[16:19], v64 offset:32768
v_mfma_f32_32x32x16_bf16 v[48:63], v[24:27], v[212:215], v[48:63]
s_waitcnt lgkmcnt(2)
ds_read_b128 v[20:23], v64 offset:33792
v_mfma_f32_32x32x16_bf16 v[48:63], v[8:11], v[216:219], v[48:63]
s_waitcnt lgkmcnt(2)
ds_read_b128 v[24:27], v64 offset:34816
v_mfma_f32_32x32x16_bf16 v[48:63], v[12:15], v[220:223], v[48:63]
s_waitcnt lgkmcnt(2)
ds_read_b128 v[8:11], v64 offset:35840
v_mfma_f32_32x32x16_bf16 v[48:63], v[16:19], v[224:227], v[48:63]
s_waitcnt lgkmcnt(2)
ds_read_b128 v[12:15], v64 offset:36864
v_mfma_f32_32x32x16_bf16 v[48:63], v[20:23], v[228:231], v[48:63]
s_waitcnt lgkmcnt(2)
ds_read_b128 v[16:19], v64 offset:37888
v_mfma_f32_32x32x16_bf16 v[48:63], v[24:27], v[232:235], v[48:63]
s_waitcnt lgkmcnt(2)
ds_read_b128 v[20:23], v64 offset:38912
v_mfma_f32_32x32x16_bf16 v[48:63], v[8:11], v[236:239], v[48:63]
s_waitcnt lgkmcnt(2)
ds_read_b128 v[24:27], v64 offset:39936
v_mfma_f32_32x32x16_bf16 v[48:63], v[12:15], v[240:243], v[48:63]
s_add_u32 s44, s44, 1
s_cmp_eq_u32 s44, 3
s_mov_b32 s56, 40960
s_cmov_b32 s56, -81920
s_cselect_b32 s44, 0, s44
v_add_u32 v64, s56, v64
s_waitcnt vmcnt(10) lgkmcnt(2)
s_barrier
ds_read_b128 v[8:11], v64 offset:0
v_mfma_f32_32x32x16_bf16 v[48:63], v[16:19], v[244:247], v[48:63]
s_waitcnt lgkmcnt(2)
ds_read_b128 v[12:15], v64 offset:1024
v_mfma_f32_32x32x16_bf16 v[48:63], v[20:23], v[248:251], v[48:63]
s_waitcnt lgkmcnt(2)
ds_read_b128 v[16:19], v64 offset:2048
v_mfma_f32_32x32x16_bf16 v[48:63], v[24:27], v[252:255], v[48:63]
s_waitcnt lgkmcnt(2)
ds_read_b128 v[20:23], v64 offset:3072
v_mfma_f32_32x32x16_bf16 v[32:47], v[8:11], v[96:99], 0
s_waitcnt lgkmcnt(2)
ds_read_b128 v[24:27], v64 offset:4096
v_mfma_f32_32x32x16_bf16 v[32:47], v[12:15], v[100:103], v[32:47]
s_waitcnt lgkmcnt(2)
ds_read_b128 v[8:11], v64 offset:5120
v_cvt_pk_bf16_f32 v48, v48, v49
v_cvt_pk_bf16_f32 v49, v50, v51
v_mfma_f32_32x32x16_bf16 v[32:47], v[16:19], v[104:107], v[32:47]
s_waitcnt lgkmcnt(2)
ds_read_b128 v[12:15], v64 offset:6144
v_cvt_pk_bf16_f32 v50, v52, v53
v_cvt_pk_bf16_f32 v51, v54, v55
v_mfma_f32_32x32x16_bf16 v[32:47], v[20:23], v[108:111], v[32:47]
s_waitcnt lgkmcnt(2)
ds_read_b128 v[16:19], v64 offset:7168
v_cvt_pk_bf16_f32 v52, v56, v57
v_cvt_pk_bf16_f32 v53, v58, v59
v_mfma_f32_32x32x16_bf16 v[32:47], v[24:27], v[112:115], v[32:47]
s_waitcnt lgkmcnt(2)
ds_read_b128 v[20:23], v64 offset:8192
v_cvt_pk_bf16_f32 v54, v60, v61
v_cvt_pk_bf16_f32 v55, v62, v63
v_mfma_f32_32x32x16_bf16 v[32:47], v[8:11], v[116:119], v[32:47]
s_waitcnt lgkmcnt(2)
ds_read_b128 v[24:27], v64 offset:9216
v_accvgpr_write_b32 a40, v48
v_accvgpr_write_b32 a41, v49
v_mfma_f32_32x32x16_bf16 v[32:47], v[12:15], v[120:123], v[32:47]
s_waitcnt lgkmcnt(2)
ds_read_b128 v[8:11], v64 offset:10240
v_accvgpr_write_b32 a42, v50
v_accvgpr_write_b32 a43, v51
v_mfma_f32_32x32x16_bf16 v[32:47], v[16:19], v[124:127], v[32:47]
s_waitcnt lgkmcnt(2)
ds_read_b128 v[12:15], v64 offset:11264
v_accvgpr_write_b32 a44, v52
v_accvgpr_write_b32 a45, v53
v_mfma_f32_32x32x16_bf16 v[32:47], v[20:23], v[128:131], v[32:47]
s_waitcnt lgkmcnt(2)
ds_read_b128 v[16:19], v64 offset:12288
v_accvgpr_write_b32 a46, v54
v_accvgpr_write_b32 a47, v55
v_mfma_f32_32x32x16_bf16 v[32:47], v[24:27], v[132:135], v[32:47]
s_waitcnt lgkmcnt(2)
ds_read_b128 v[20:23], v64 offset:13312
s_add_u32 m0, s45, 0
s_add_u32 s55, s46, 0
buffer_load_dwordx4 v0, s[4:7], s55 offen offset:0 sc1 lds
buffer_load_dwordx4 v0, s[4:7], s55 offen offset:1024 sc1 lds
v_mfma_f32_32x32x16_bf16 v[32:47], v[8:11], v[136:139], v[32:47]
s_waitcnt lgkmcnt(2)
ds_read_b128 v[24:27], v64 offset:14336
buffer_load_dwordx4 v0, s[4:7], s55 offen offset:2048 sc1 lds
buffer_load_dwordx4 v0, s[4:7], s55 offen offset:3072 sc1 lds
v_mfma_f32_32x32x16_bf16 v[32:47], v[12:15], v[140:143], v[32:47]
s_waitcnt lgkmcnt(2)
ds_read_b128 v[8:11], v64 offset:15360
s_add_u32 m0, s45, 4096
s_add_u32 s55, s46, 4096
buffer_load_dwordx4 v0, s[4:7], s55 offen offset:0 sc1 lds
buffer_load_dwordx4 v0, s[4:7], s55 offen offset:1024 sc1 lds
v_mfma_f32_32x32x16_bf16 v[32:47], v[16:19], v[144:147], v[32:47]
s_waitcnt lgkmcnt(2)
ds_read_b128 v[12:15], v64 offset:16384
buffer_load_dwordx4 v0, s[4:7], s55 offen offset:2048 sc1 lds
buffer_load_dwordx4 v0, s[4:7], s55 offen offset:3072 sc1 lds
v_mfma_f32_32x32x16_bf16 v[32:47], v[20:23], v[148:151], v[32:47]
s_waitcnt lgkmcnt(2)
ds_read_b128 v[16:19], v64 offset:17408
s_add_u32 m0, s45, 8192
s_add_u32 s55, s46, 8192
buffer_load_dwordx4 v0, s[4:7], s55 offen offset:0 sc1 lds
buffer_load_dwordx4 v0, s[4:7], s55 offen offset:1024 sc1 lds
v_mfma_f32_32x32x16_bf16 v[32:47], v[24:27], v[152:155], v[32:47]
s_waitcnt lgkmcnt(2)
ds_read_b128 v[20:23], v64 offset:18432
s_add_u32 s45, s45, 40960
s_cmp_ge_u32 s45, 122880
s_cselect_b32 s55, 122880, 0
s_sub_u32 s45, s45, s55
s_add_u32 s46, s46, 40960
v_mfma_f32_32x32x16_bf16 v[32:47], v[8:11], v[156:159], v[32:47]
s_waitcnt lgkmcnt(2)
ds_read_b128 v[24:27], v64 offset:19456
v_mfma_f32_32x32x16_bf16 v[32:47], v[12:15], v[160:163], v[32:47]
s_waitcnt lgkmcnt(2)
ds_read_b128 v[8:11], v64 offset:20480
v_mfma_f32_32x32x16_bf16 v[32:47], v[16:19], v[164:167], v[32:47]
s_waitcnt lgkmcnt(2)
ds_read_b128 v[12:15], v64 offset:21504
v_mfma_f32_32x32x16_bf16 v[32:47], v[20:23], v[168:171], v[32:47]
s_waitcnt lgkmcnt(2)
ds_read_b128 v[16:19], v64 offset:22528
v_mfma_f32_32x32x16_bf16 v[32:47], v[24:27], v[172:175], v[32:47]
s_waitcnt lgkmcnt(2)
ds_read_b128 v[20:23], v64 offset:23552
v_mfma_f32_32x32x16_bf16 v[32:47], v[8:11], v[176:179], v[32:47]
s_waitcnt lgkmcnt(2)
ds_read_b128 v[24:27], v64 offset:24576
v_mfma_f32_32x32x16_bf16 v[32:47], v[12:15], v[180:183], v[32:47]
s_waitcnt lgkmcnt(2)
ds_read_b128 v[8:11], v64 offset:25600
v_mfma_f32_32x32x16_bf16 v[32:47], v[16:19], v[184:187], v[32:47]
s_waitcnt lgkmcnt(2)
ds_read_b128 v[12:15], v64 offset:26624
v_mfma_f32_32x32x16_bf16 v[32:47], v[20:23], v[188:191], v[32:47]
s_waitcnt lgkmcnt(2)
ds_read_b128 v[16:19], v64 offset:27648
v_mfma_f32_32x32x16_bf16 v[32:47], v[24:27], v[192:195], v[32:47]
s_waitcnt lgkmcnt(2)
ds_read_b128 v[20:23], v64 offset:28672
v_mfma_f32_32x32x16_bf16 v[32:47], v[8:11], v[196:199], v[32:47]
s_waitcnt lgkmcnt(2)
ds_read_b128 v[24:27], v64 offset:29696
v_mfma_f32_32x32x16_bf16 v[32:47], v[12:15], v[200:203], v[32:47]
s_waitcnt lgkmcnt(2)
ds_read_b128 v[8:11], v64 offset:30720
v_mfma_f32_32x32x16_bf16 v[32:47], v[16:19], v[204:207], v[32:47]
s_waitcnt lgkmcnt(2)
ds_read_b128 v[12:15], v64 offset:31744
v_mfma_f32_32x32x16_bf16 v[32:47], v[20:23], v[208:211], v[32:47]
s_waitcnt lgkmcnt(2)
ds_read_b128 v[16:19], v64 offset:32768
v_mfma_f32_32x32x16_bf16 v[32:47], v[24:27], v[212:215], v[32:47]
s_waitcnt lgkmcnt(2)
ds_read_b128 v[20:23], v64 offset:33792
v_mfma_f32_32x32x16_bf16 v[32:47], v[8:11], v[216:219], v[32:47]
s_waitcnt lgkmcnt(2)
ds_read_b128 v[24:27], v64 offset:34816
v_mfma_f32_32x32x16_bf16 v[32:47], v[12:15], v[220:223], v[32:47]
s_waitcnt lgkmcnt(2)
ds_read_b128 v[8:11], v64 offset:35840
v_mfma_f32_32x32x16_bf16 v[32:47], v[16:19], v[224:227], v[32:47]
s_waitcnt lgkmcnt(2)
ds_read_b128 v[12:15], v64 offset:36864
v_mfma_f32_32x32x16_bf16 v[32:47], v[20:23], v[228:231], v[32:47]
s_waitcnt lgkmcnt(2)
ds_read_b128 v[16:19], v64 offset:37888
v_mfma_f32_32x32x16_bf16 v[32:47], v[24:27], v[232:235], v[32:47]
s_waitcnt lgkmcnt(2)
ds_read_b128 v[20:23], v64 offset:38912
v_mfma_f32_32x32x16_bf16 v[32:47], v[8:11], v[236:239], v[32:47]
s_waitcnt lgkmcnt(2)
ds_read_b128 v[24:27], v64 offset:39936
v_mfma_f32_32x32x16_bf16 v[32:47], v[12:15], v[240:243], v[32:47]
s_add_u32 s44, s44, 1
s_cmp_eq_u32 s44, 3
s_mov_b32 s56, 40960
s_cmov_b32 s56, -81920
s_cselect_b32 s44, 0, s44
v_add_u32 v64, s56, v64
s_waitcnt vmcnt(10) lgkmcnt(2)
s_barrier
ds_read_b128 v[8:11], v64 offset:0
v_mfma_f32_32x32x16_bf16 v[32:47], v[16:19], v[244:247], v[32:47]
s_waitcnt lgkmcnt(2)
ds_read_b128 v[12:15], v64 offset:1024
v_mfma_f32_32x32x16_bf16 v[32:47], v[20:23], v[248:251], v[32:47]
s_waitcnt lgkmcnt(2)
ds_read_b128 v[16:19], v64 offset:2048
v_mfma_f32_32x32x16_bf16 v[32:47], v[24:27], v[252:255], v[32:47]
s_waitcnt lgkmcnt(2)
ds_read_b128 v[20:23], v64 offset:3072
v_mfma_f32_32x32x16_bf16 v[48:63], v[8:11], v[96:99], 0
s_waitcnt lgkmcnt(2)
ds_read_b128 v[24:27], v64 offset:4096
v_mfma_f32_32x32x16_bf16 v[48:63], v[12:15], v[100:103], v[48:63]
s_waitcnt lgkmcnt(2)
ds_read_b128 v[8:11], v64 offset:5120
v_cvt_pk_bf16_f32 v32, v32, v33
v_cvt_pk_bf16_f32 v33, v34, v35
v_mfma_f32_32x32x16_bf16 v[48:63], v[16:19], v[104:107], v[48:63]
s_waitcnt lgkmcnt(2)
ds_read_b128 v[12:15], v64 offset:6144
v_cvt_pk_bf16_f32 v34, v36, v37
v_cvt_pk_bf16_f32 v35, v38, v39
v_mfma_f32_32x32x16_bf16 v[48:63], v[20:23], v[108:111], v[48:63]
s_waitcnt lgkmcnt(2)
ds_read_b128 v[16:19], v64 offset:7168
v_cvt_pk_bf16_f32 v36, v40, v41
v_cvt_pk_bf16_f32 v37, v42, v43
v_mfma_f32_32x32x16_bf16 v[48:63], v[24:27], v[112:115], v[48:63]
s_waitcnt lgkmcnt(2)
ds_read_b128 v[20:23], v64 offset:8192
v_cvt_pk_bf16_f32 v38, v44, v45
v_cvt_pk_bf16_f32 v39, v46, v47
v_mfma_f32_32x32x16_bf16 v[48:63], v[8:11], v[116:119], v[48:63]
s_waitcnt lgkmcnt(2)
ds_read_b128 v[24:27], v64 offset:9216
v_accvgpr_write_b32 a48, v32
v_accvgpr_write_b32 a49, v33
v_mfma_f32_32x32x16_bf16 v[48:63], v[12:15], v[120:123], v[48:63]
s_waitcnt lgkmcnt(2)
ds_read_b128 v[8:11], v64 offset:10240
v_accvgpr_write_b32 a50, v34
v_accvgpr_write_b32 a51, v35
v_mfma_f32_32x32x16_bf16 v[48:63], v[16:19], v[124:127], v[48:63]
s_waitcnt lgkmcnt(2)
ds_read_b128 v[12:15], v64 offset:11264
v_accvgpr_write_b32 a52, v36
v_accvgpr_write_b32 a53, v37
v_mfma_f32_32x32x16_bf16 v[48:63], v[20:23], v[128:131], v[48:63]
s_waitcnt lgkmcnt(2)
ds_read_b128 v[16:19], v64 offset:12288
v_accvgpr_write_b32 a54, v38
v_accvgpr_write_b32 a55, v39
v_mfma_f32_32x32x16_bf16 v[48:63], v[24:27], v[132:135], v[48:63]
s_waitcnt lgkmcnt(2)
ds_read_b128 v[20:23], v64 offset:13312
s_add_u32 m0, s45, 0
s_add_u32 s55, s46, 0
buffer_load_dwordx4 v0, s[4:7], s55 offen offset:0 sc1 lds
buffer_load_dwordx4 v0, s[4:7], s55 offen offset:1024 sc1 lds
v_mfma_f32_32x32x16_bf16 v[48:63], v[8:11], v[136:139], v[48:63]
s_waitcnt lgkmcnt(2)
ds_read_b128 v[24:27], v64 offset:14336
buffer_load_dwordx4 v0, s[4:7], s55 offen offset:2048 sc1 lds
buffer_load_dwordx4 v0, s[4:7], s55 offen offset:3072 sc1 lds
v_mfma_f32_32x32x16_bf16 v[48:63], v[12:15], v[140:143], v[48:63]
s_waitcnt lgkmcnt(2)
ds_read_b128 v[8:11], v64 offset:15360
s_add_u32 m0, s45, 4096
s_add_u32 s55, s46, 4096
buffer_load_dwordx4 v0, s[4:7], s55 offen offset:0 sc1 lds
buffer_load_dwordx4 v0, s[4:7], s55 offen offset:1024 sc1 lds
v_mfma_f32_32x32x16_bf16 v[48:63], v[16:19], v[144:147], v[48:63]
s_waitcnt lgkmcnt(2)
ds_read_b128 v[12:15], v64 offset:16384
buffer_load_dwordx4 v0, s[4:7], s55 offen offset:2048 sc1 lds
buffer_load_dwordx4 v0, s[4:7], s55 offen offset:3072 sc1 lds
v_mfma_f32_32x32x16_bf16 v[48:63], v[20:23], v[148:151], v[48:63]
s_waitcnt lgkmcnt(2)
ds_read_b128 v[16:19], v64 offset:17408
s_add_u32 m0, s45, 8192
s_add_u32 s55, s46, 8192
buffer_load_dwordx4 v0, s[4:7], s55 offen offset:0 sc1 lds
buffer_load_dwordx4 v0, s[4:7], s55 offen offset:1024 sc1 lds
v_mfma_f32_32x32x16_bf16 v[48:63], v[24:27], v[152:155], v[48:63]
s_waitcnt lgkmcnt(2)
ds_read_b128 v[20:23], v64 offset:18432
s_add_u32 s45, s45, 40960
s_cmp_ge_u32 s45, 122880
s_cselect_b32 s55, 122880, 0
s_sub_u32 s45, s45, s55
s_add_u32 s46, s46, 40960
v_mfma_f32_32x32x16_bf16 v[48:63], v[8:11], v[156:159], v[48:63]
s_waitcnt lgkmcnt(2)
ds_read_b128 v[24:27], v64 offset:19456
v_mfma_f32_32x32x16_bf16 v[48:63], v[12:15], v[160:163], v[48:63]
s_waitcnt lgkmcnt(2)
ds_read_b128 v[8:11], v64 offset:20480
v_mfma_f32_32x32x16_bf16 v[48:63], v[16:19], v[164:167], v[48:63]
s_waitcnt lgkmcnt(2)
ds_read_b128 v[12:15], v64 offset:21504
v_mfma_f32_32x32x16_bf16 v[48:63], v[20:23], v[168:171], v[48:63]
s_waitcnt lgkmcnt(2)
ds_read_b128 v[16:19], v64 offset:22528
v_mfma_f32_32x32x16_bf16 v[48:63], v[24:27], v[172:175], v[48:63]
s_waitcnt lgkmcnt(2)
ds_read_b128 v[20:23], v64 offset:23552
v_mfma_f32_32x32x16_bf16 v[48:63], v[8:11], v[176:179], v[48:63]
s_waitcnt lgkmcnt(2)
ds_read_b128 v[24:27], v64 offset:24576
v_mfma_f32_32x32x16_bf16 v[48:63], v[12:15], v[180:183], v[48:63]
s_waitcnt lgkmcnt(2)
ds_read_b128 v[8:11], v64 offset:25600
v_mfma_f32_32x32x16_bf16 v[48:63], v[16:19], v[184:187], v[48:63]
s_waitcnt lgkmcnt(2)
ds_read_b128 v[12:15], v64 offset:26624
v_mfma_f32_32x32x16_bf16 v[48:63], v[20:23], v[188:191], v[48:63]
s_waitcnt lgkmcnt(2)
ds_read_b128 v[16:19], v64 offset:27648
v_mfma_f32_32x32x16_bf16 v[48:63], v[24:27], v[192:195], v[48:63]
s_waitcnt lgkmcnt(2)
ds_read_b128 v[20:23], v64 offset:28672
v_mfma_f32_32x32x16_bf16 v[48:63], v[8:11], v[196:199], v[48:63]
s_waitcnt lgkmcnt(2)
ds_read_b128 v[24:27], v64 offset:29696
v_mfma_f32_32x32x16_bf16 v[48:63], v[12:15], v[200:203], v[48:63]
s_waitcnt lgkmcnt(2)
ds_read_b128 v[8:11], v64 offset:30720
v_mfma_f32_32x32x16_bf16 v[48:63], v[16:19], v[204:207], v[48:63]
s_waitcnt lgkmcnt(2)
ds_read_b128 v[12:15], v64 offset:31744
v_mfma_f32_32x32x16_bf16 v[48:63], v[20:23], v[208:211], v[48:63]
s_waitcnt lgkmcnt(2)
ds_read_b128 v[16:19], v64 offset:32768
v_mfma_f32_32x32x16_bf16 v[48:63], v[24:27], v[212:215], v[48:63]
s_waitcnt lgkmcnt(2)
ds_read_b128 v[20:23], v64 offset:33792
v_mfma_f32_32x32x16_bf16 v[48:63], v[8:11], v[216:219], v[48:63]
s_waitcnt lgkmcnt(2)
ds_read_b128 v[24:27], v64 offset:34816
v_mfma_f32_32x32x16_bf16 v[48:63], v[12:15], v[220:223], v[48:63]
s_waitcnt lgkmcnt(2)
ds_read_b128 v[8:11], v64 offset:35840
v_mfma_f32_32x32x16_bf16 v[48:63], v[16:19], v[224:227], v[48:63]
s_waitcnt lgkmcnt(2)
ds_read_b128 v[12:15], v64 offset:36864
v_mfma_f32_32x32x16_bf16 v[48:63], v[20:23], v[228:231], v[48:63]
s_waitcnt lgkmcnt(2)
ds_read_b128 v[16:19], v64 offset:37888
v_mfma_f32_32x32x16_bf16 v[48:63], v[24:27], v[232:235], v[48:63]
s_waitcnt lgkmcnt(2)
ds_read_b128 v[20:23], v64 offset:38912
v_mfma_f32_32x32x16_bf16 v[48:63], v[8:11], v[236:239], v[48:63]
s_waitcnt lgkmcnt(2)
ds_read_b128 v[24:27], v64 offset:39936
v_mfma_f32_32x32x16_bf16 v[48:63], v[12:15], v[240:243], v[48:63]
s_add_u32 s44, s44, 1
s_cmp_eq_u32 s44, 3
s_mov_b32 s56, 40960
s_cmov_b32 s56, -81920
s_cselect_b32 s44, 0, s44
v_add_u32 v64, s56, v64
s_waitcnt vmcnt(10) lgkmcnt(2)
s_barrier
ds_read_b128 v[8:11], v64 offset:0
v_mfma_f32_32x32x16_bf16 v[48:63], v[16:19], v[244:247], v[48:63]
s_waitcnt lgkmcnt(2)
ds_read_b128 v[12:15], v64 offset:1024
v_mfma_f32_32x32x16_bf16 v[48:63], v[20:23], v[248:251], v[48:63]
s_waitcnt lgkmcnt(2)
ds_read_b128 v[16:19], v64 offset:2048
v_mfma_f32_32x32x16_bf16 v[48:63], v[24:27], v[252:255], v[48:63]
s_waitcnt lgkmcnt(2)
ds_read_b128 v[20:23], v64 offset:3072
v_mfma_f32_32x32x16_bf16 v[32:47], v[8:11], v[96:99], 0
s_waitcnt lgkmcnt(2)
ds_read_b128 v[24:27], v64 offset:4096
v_mfma_f32_32x32x16_bf16 v[32:47], v[12:15], v[100:103], v[32:47]
s_waitcnt lgkmcnt(2)
ds_read_b128 v[8:11], v64 offset:5120
v_cvt_pk_bf16_f32 v48, v48, v49
v_cvt_pk_bf16_f32 v49, v50, v51
v_mfma_f32_32x32x16_bf16 v[32:47], v[16:19], v[104:107], v[32:47]
s_waitcnt lgkmcnt(2)
ds_read_b128 v[12:15], v64 offset:6144
v_cvt_pk_bf16_f32 v50, v52, v53
v_cvt_pk_bf16_f32 v51, v54, v55
v_mfma_f32_32x32x16_bf16 v[32:47], v[20:23], v[108:111], v[32:47]
s_waitcnt lgkmcnt(2)
ds_read_b128 v[16:19], v64 offset:7168
v_cvt_pk_bf16_f32 v52, v56, v57
v_cvt_pk_bf16_f32 v53, v58, v59
v_mfma_f32_32x32x16_bf16 v[32:47], v[24:27], v[112:115], v[32:47]
s_waitcnt lgkmcnt(2)
ds_read_b128 v[20:23], v64 offset:8192
v_cvt_pk_bf16_f32 v54, v60, v61
v_cvt_pk_bf16_f32 v55, v62, v63
v_mfma_f32_32x32x16_bf16 v[32:47], v[8:11], v[116:119], v[32:47]
s_waitcnt lgkmcnt(2)
ds_read_b128 v[24:27], v64 offset:9216
v_accvgpr_write_b32 a56, v48
v_accvgpr_write_b32 a57, v49
v_mfma_f32_32x32x16_bf16 v[32:47], v[12:15], v[120:123], v[32:47]
s_waitcnt lgkmcnt(2)
ds_read_b128 v[8:11], v64 offset:10240
v_accvgpr_write_b32 a58, v50
v_accvgpr_write_b32 a59, v51
v_mfma_f32_32x32x16_bf16 v[32:47], v[16:19], v[124:127], v[32:47]
s_waitcnt lgkmcnt(2)
ds_read_b128 v[12:15], v64 offset:11264
v_accvgpr_write_b32 a60, v52
v_accvgpr_write_b32 a61, v53
v_mfma_f32_32x32x16_bf16 v[32:47], v[20:23], v[128:131], v[32:47]
s_waitcnt lgkmcnt(2)
ds_read_b128 v[16:19], v64 offset:12288
v_accvgpr_write_b32 a62, v54
v_accvgpr_write_b32 a63, v55
v_mfma_f32_32x32x16_bf16 v[32:47], v[24:27], v[132:135], v[32:47]
s_waitcnt lgkmcnt(2)
ds_read_b128 v[20:23], v64 offset:13312
s_add_u32 m0, s45, 0
s_add_u32 s55, s46, 0
buffer_load_dwordx4 v0, s[4:7], s55 offen offset:0 sc1 lds
buffer_load_dwordx4 v0, s[4:7], s55 offen offset:1024 sc1 lds
v_mfma_f32_32x32x16_bf16 v[32:47], v[8:11], v[136:139], v[32:47]
s_waitcnt lgkmcnt(2)
ds_read_b128 v[24:27], v64 offset:14336
buffer_load_dwordx4 v0, s[4:7], s55 offen offset:2048 sc1 lds
buffer_load_dwordx4 v0, s[4:7], s55 offen offset:3072 sc1 lds
v_mfma_f32_32x32x16_bf16 v[32:47], v[12:15], v[140:143], v[32:47]
s_waitcnt lgkmcnt(2)
ds_read_b128 v[8:11], v64 offset:15360
s_add_u32 m0, s45, 4096
s_add_u32 s55, s46, 4096
buffer_load_dwordx4 v0, s[4:7], s55 offen offset:0 sc1 lds
buffer_load_dwordx4 v0, s[4:7], s55 offen offset:1024 sc1 lds
v_mfma_f32_32x32x16_bf16 v[32:47], v[16:19], v[144:147], v[32:47]
s_waitcnt lgkmcnt(2)
ds_read_b128 v[12:15], v64 offset:16384
buffer_load_dwordx4 v0, s[4:7], s55 offen offset:2048 sc1 lds
buffer_load_dwordx4 v0, s[4:7], s55 offen offset:3072 sc1 lds
v_mfma_f32_32x32x16_bf16 v[32:47], v[20:23], v[148:151], v[32:47]
s_waitcnt lgkmcnt(2)
ds_read_b128 v[16:19], v64 offset:17408
s_add_u32 m0, s45, 8192
s_add_u32 s55, s46, 8192
buffer_load_dwordx4 v0, s[4:7], s55 offen offset:0 sc1 lds
buffer_load_dwordx4 v0, s[4:7], s55 offen offset:1024 sc1 lds
v_mfma_f32_32x32x16_bf16 v[32:47], v[24:27], v[152:155], v[32:47]
s_waitcnt lgkmcnt(2)
ds_read_b128 v[20:23], v64 offset:18432
s_add_u32 s45, s45, 40960
s_cmp_ge_u32 s45, 122880
s_cselect_b32 s55, 122880, 0
s_sub_u32 s45, s45, s55
s_add_u32 s46, s46, 40960
v_mfma_f32_32x32x16_bf16 v[32:47], v[8:11], v[156:159], v[32:47]
s_waitcnt lgkmcnt(2)
ds_read_b128 v[24:27], v64 offset:19456
v_mfma_f32_32x32x16_bf16 v[32:47], v[12:15], v[160:163], v[32:47]
s_waitcnt lgkmcnt(2)
ds_read_b128 v[8:11], v64 offset:20480
v_mfma_f32_32x32x16_bf16 v[32:47], v[16:19], v[164:167], v[32:47]
s_waitcnt lgkmcnt(2)
ds_read_b128 v[12:15], v64 offset:21504
v_mfma_f32_32x32x16_bf16 v[32:47], v[20:23], v[168:171], v[32:47]
s_waitcnt lgkmcnt(2)
ds_read_b128 v[16:19], v64 offset:22528
v_mfma_f32_32x32x16_bf16 v[32:47], v[24:27], v[172:175], v[32:47]
s_waitcnt lgkmcnt(2)
ds_read_b128 v[20:23], v64 offset:23552
v_mfma_f32_32x32x16_bf16 v[32:47], v[8:11], v[176:179], v[32:47]
s_waitcnt lgkmcnt(2)
ds_read_b128 v[24:27], v64 offset:24576
v_mfma_f32_32x32x16_bf16 v[32:47], v[12:15], v[180:183], v[32:47]
s_waitcnt lgkmcnt(2)
ds_read_b128 v[8:11], v64 offset:25600
v_mfma_f32_32x32x16_bf16 v[32:47], v[16:19], v[184:187], v[32:47]
s_waitcnt lgkmcnt(2)
ds_read_b128 v[12:15], v64 offset:26624
v_mfma_f32_32x32x16_bf16 v[32:47], v[20:23], v[188:191], v[32:47]
s_waitcnt lgkmcnt(2)
ds_read_b128 v[16:19], v64 offset:27648
v_mfma_f32_32x32x16_bf16 v[32:47], v[24:27], v[192:195], v[32:47]
s_waitcnt lgkmcnt(2)
ds_read_b128 v[20:23], v64 offset:28672
v_mfma_f32_32x32x16_bf16 v[32:47], v[8:11], v[196:199], v[32:47]
s_waitcnt lgkmcnt(2)
ds_read_b128 v[24:27], v64 offset:29696
v_mfma_f32_32x32x16_bf16 v[32:47], v[12:15], v[200:203], v[32:47]
s_waitcnt lgkmcnt(2)
ds_read_b128 v[8:11], v64 offset:30720
v_mfma_f32_32x32x16_bf16 v[32:47], v[16:19], v[204:207], v[32:47]
s_waitcnt lgkmcnt(2)
ds_read_b128 v[12:15], v64 offset:31744
v_mfma_f32_32x32x16_bf16 v[32:47], v[20:23], v[208:211], v[32:47]
s_waitcnt lgkmcnt(2)
ds_read_b128 v[16:19], v64 offset:32768
v_mfma_f32_32x32x16_bf16 v[32:47], v[24:27], v[212:215], v[32:47]
s_waitcnt lgkmcnt(2)
ds_read_b128 v[20:23], v64 offset:33792
v_mfma_f32_32x32x16_bf16 v[32:47], v[8:11], v[216:219], v[32:47]
s_waitcnt lgkmcnt(2)
ds_read_b128 v[24:27], v64 offset:34816
v_mfma_f32_32x32x16_bf16 v[32:47], v[12:15], v[220:223], v[32:47]
s_waitcnt lgkmcnt(2)
ds_read_b128 v[8:11], v64 offset:35840
v_mfma_f32_32x32x16_bf16 v[32:47], v[16:19], v[224:227], v[32:47]
s_waitcnt lgkmcnt(2)
ds_read_b128 v[12:15], v64 offset:36864
v_mfma_f32_32x32x16_bf16 v[32:47], v[20:23], v[228:231], v[32:47]
s_waitcnt lgkmcnt(2)
ds_read_b128 v[16:19], v64 offset:37888
v_mfma_f32_32x32x16_bf16 v[32:47], v[24:27], v[232:235], v[32:47]
s_waitcnt lgkmcnt(2)
ds_read_b128 v[20:23], v64 offset:38912
v_mfma_f32_32x32x16_bf16 v[32:47], v[8:11], v[236:239], v[32:47]
s_waitcnt lgkmcnt(2)
ds_read_b128 v[24:27], v64 offset:39936
v_mfma_f32_32x32x16_bf16 v[32:47], v[12:15], v[240:243], v[32:47]
s_add_u32 s44, s44, 1
s_cmp_eq_u32 s44, 3
s_mov_b32 s56, 40960
s_cmov_b32 s56, -81920
s_cselect_b32 s44, 0, s44
v_add_u32 v64, s56, v64
s_waitcnt vmcnt(10) lgkmcnt(2)
s_barrier
ds_read_b128 v[8:11], v64 offset:0
v_mfma_f32_32x32x16_bf16 v[32:47], v[16:19], v[244:247], v[32:47]
s_waitcnt lgkmcnt(2)
ds_read_b128 v[12:15], v64 offset:1024
v_mfma_f32_32x32x16_bf16 v[32:47], v[20:23], v[248:251], v[32:47]
s_waitcnt lgkmcnt(2)
ds_read_b128 v[16:19], v64 offset:2048
v_mfma_f32_32x32x16_bf16 v[32:47], v[24:27], v[252:255], v[32:47]
s_waitcnt lgkmcnt(2)
ds_read_b128 v[20:23], v64 offset:3072
v_mfma_f32_32x32x16_bf16 v[48:63], v[8:11], v[96:99], 0
s_waitcnt lgkmcnt(2)
ds_read_b128 v[24:27], v64 offset:4096
v_mfma_f32_32x32x16_bf16 v[48:63], v[12:15], v[100:103], v[48:63]
s_waitcnt lgkmcnt(2)
ds_read_b128 v[8:11], v64 offset:5120
v_cvt_pk_bf16_f32 v32, v32, v33
v_cvt_pk_bf16_f32 v33, v34, v35
v_mfma_f32_32x32x16_bf16 v[48:63], v[16:19], v[104:107], v[48:63]
s_waitcnt lgkmcnt(2)
ds_read_b128 v[12:15], v64 offset:6144
v_cvt_pk_bf16_f32 v34, v36, v37
v_cvt_pk_bf16_f32 v35, v38, v39
v_mfma_f32_32x32x16_bf16 v[48:63], v[20:23], v[108:111], v[48:63]
s_waitcnt lgkmcnt(2)
ds_read_b128 v[16:19], v64 offset:7168
v_cvt_pk_bf16_f32 v36, v40, v41
v_cvt_pk_bf16_f32 v37, v42, v43
v_mfma_f32_32x32x16_bf16 v[48:63], v[24:27], v[112:115], v[48:63]
s_waitcnt lgkmcnt(2)
ds_read_b128 v[20:23], v64 offset:8192
v_cvt_pk_bf16_f32 v38, v44, v45
v_cvt_pk_bf16_f32 v39, v46, v47
v_mfma_f32_32x32x16_bf16 v[48:63], v[8:11], v[116:119], v[48:63]
s_waitcnt lgkmcnt(2)
ds_read_b128 v[24:27], v64 offset:9216
v_accvgpr_write_b32 a64, v32
v_accvgpr_write_b32 a65, v33
v_mfma_f32_32x32x16_bf16 v[48:63], v[12:15], v[120:123], v[48:63]
s_waitcnt lgkmcnt(2)
ds_read_b128 v[8:11], v64 offset:10240
v_accvgpr_write_b32 a66, v34
v_accvgpr_write_b32 a67, v35
v_mfma_f32_32x32x16_bf16 v[48:63], v[16:19], v[124:127], v[48:63]
s_waitcnt lgkmcnt(2)
ds_read_b128 v[12:15], v64 offset:11264
v_accvgpr_write_b32 a68, v36
v_accvgpr_write_b32 a69, v37
v_mfma_f32_32x32x16_bf16 v[48:63], v[20:23], v[128:131], v[48:63]
s_waitcnt lgkmcnt(2)
ds_read_b128 v[16:19], v64 offset:12288
v_accvgpr_write_b32 a70, v38
v_accvgpr_write_b32 a71, v39
v_mfma_f32_32x32x16_bf16 v[48:63], v[24:27], v[132:135], v[48:63]
s_waitcnt lgkmcnt(2)
ds_read_b128 v[20:23], v64 offset:13312
s_add_u32 m0, s45, 0
s_add_u32 s55, s46, 0
buffer_load_dwordx4 v0, s[4:7], s55 offen offset:0 sc1 lds
buffer_load_dwordx4 v0, s[4:7], s55 offen offset:1024 sc1 lds
v_mfma_f32_32x32x16_bf16 v[48:63], v[8:11], v[136:139], v[48:63]
s_waitcnt lgkmcnt(2)
ds_read_b128 v[24:27], v64 offset:14336
buffer_load_dwordx4 v0, s[4:7], s55 offen offset:2048 sc1 lds
buffer_load_dwordx4 v0, s[4:7], s55 offen offset:3072 sc1 lds
v_mfma_f32_32x32x16_bf16 v[48:63], v[12:15], v[140:143], v[48:63]
s_waitcnt lgkmcnt(2)
ds_read_b128 v[8:11], v64 offset:15360
s_add_u32 m0, s45, 4096
s_add_u32 s55, s46, 4096
buffer_load_dwordx4 v0, s[4:7], s55 offen offset:0 sc1 lds
buffer_load_dwordx4 v0, s[4:7], s55 offen offset:1024 sc1 lds
v_mfma_f32_32x32x16_bf16 v[48:63], v[16:19], v[144:147], v[48:63]
s_waitcnt lgkmcnt(2)
ds_read_b128 v[12:15], v64 offset:16384
buffer_load_dwordx4 v0, s[4:7], s55 offen offset:2048 sc1 lds
buffer_load_dwordx4 v0, s[4:7], s55 offen offset:3072 sc1 lds
v_mfma_f32_32x32x16_bf16 v[48:63], v[20:23], v[148:151], v[48:63]
s_waitcnt lgkmcnt(2)
ds_read_b128 v[16:19], v64 offset:17408
s_add_u32 m0, s45, 8192
s_add_u32 s55, s46, 8192
buffer_load_dwordx4 v0, s[4:7], s55 offen offset:0 sc1 lds
buffer_load_dwordx4 v0, s[4:7], s55 offen offset:1024 sc1 lds
v_mfma_f32_32x32x16_bf16 v[48:63], v[24:27], v[152:155], v[48:63]
s_waitcnt lgkmcnt(2)
ds_read_b128 v[20:23], v64 offset:18432
s_add_u32 s45, s45, 40960
s_cmp_ge_u32 s45, 122880
s_cselect_b32 s55, 122880, 0
s_sub_u32 s45, s45, s55
s_add_u32 s46, s46, 40960
v_mfma_f32_32x32x16_bf16 v[48:63], v[8:11], v[156:159], v[48:63]
s_waitcnt lgkmcnt(2)
ds_read_b128 v[24:27], v64 offset:19456
v_mfma_f32_32x32x16_bf16 v[48:63], v[12:15], v[160:163], v[48:63]
s_waitcnt lgkmcnt(2)
ds_read_b128 v[8:11], v64 offset:20480
v_mfma_f32_32x32x16_bf16 v[48:63], v[16:19], v[164:167], v[48:63]
s_waitcnt lgkmcnt(2)
ds_read_b128 v[12:15], v64 offset:21504
v_mfma_f32_32x32x16_bf16 v[48:63], v[20:23], v[168:171], v[48:63]
s_waitcnt lgkmcnt(2)
ds_read_b128 v[16:19], v64 offset:22528
v_mfma_f32_32x32x16_bf16 v[48:63], v[24:27], v[172:175], v[48:63]
s_waitcnt lgkmcnt(2)
ds_read_b128 v[20:23], v64 offset:23552
v_mfma_f32_32x32x16_bf16 v[48:63], v[8:11], v[176:179], v[48:63]
s_waitcnt lgkmcnt(2)
ds_read_b128 v[24:27], v64 offset:24576
v_mfma_f32_32x32x16_bf16 v[48:63], v[12:15], v[180:183], v[48:63]
s_waitcnt lgkmcnt(2)
ds_read_b128 v[8:11], v64 offset:25600
v_mfma_f32_32x32x16_bf16 v[48:63], v[16:19], v[184:187], v[48:63]
s_waitcnt lgkmcnt(2)
ds_read_b128 v[12:15], v64 offset:26624
v_mfma_f32_32x32x16_bf16 v[48:63], v[20:23], v[188:191], v[48:63]
s_waitcnt lgkmcnt(2)
ds_read_b128 v[16:19], v64 offset:27648
v_mfma_f32_32x32x16_bf16 v[48:63], v[24:27], v[192:195], v[48:63]
s_waitcnt lgkmcnt(2)
ds_read_b128 v[20:23], v64 offset:28672
v_mfma_f32_32x32x16_bf16 v[48:63], v[8:11], v[196:199], v[48:63]
s_waitcnt lgkmcnt(2)
ds_read_b128 v[24:27], v64 offset:29696
v_mfma_f32_32x32x16_bf16 v[48:63], v[12:15], v[200:203], v[48:63]
s_waitcnt lgkmcnt(2)
ds_read_b128 v[8:11], v64 offset:30720
v_mfma_f32_32x32x16_bf16 v[48:63], v[16:19], v[204:207], v[48:63]
s_waitcnt lgkmcnt(2)
ds_read_b128 v[12:15], v64 offset:31744
v_mfma_f32_32x32x16_bf16 v[48:63], v[20:23], v[208:211], v[48:63]
s_waitcnt lgkmcnt(2)
ds_read_b128 v[16:19], v64 offset:32768
v_mfma_f32_32x32x16_bf16 v[48:63], v[24:27], v[212:215], v[48:63]
s_waitcnt lgkmcnt(2)
ds_read_b128 v[20:23], v64 offset:33792
v_mfma_f32_32x32x16_bf16 v[48:63], v[8:11], v[216:219], v[48:63]
s_waitcnt lgkmcnt(2)
ds_read_b128 v[24:27], v64 offset:34816
v_mfma_f32_32x32x16_bf16 v[48:63], v[12:15], v[220:223], v[48:63]
s_waitcnt lgkmcnt(2)
ds_read_b128 v[8:11], v64 offset:35840
v_mfma_f32_32x32x16_bf16 v[48:63], v[16:19], v[224:227], v[48:63]
s_waitcnt lgkmcnt(2)
ds_read_b128 v[12:15], v64 offset:36864
v_mfma_f32_32x32x16_bf16 v[48:63], v[20:23], v[228:231], v[48:63]
s_waitcnt lgkmcnt(2)
ds_read_b128 v[16:19], v64 offset:37888
v_mfma_f32_32x32x16_bf16 v[48:63], v[24:27], v[232:235], v[48:63]
s_waitcnt lgkmcnt(2)
ds_read_b128 v[20:23], v64 offset:38912
v_mfma_f32_32x32x16_bf16 v[48:63], v[8:11], v[236:239], v[48:63]
s_waitcnt lgkmcnt(2)
ds_read_b128 v[24:27], v64 offset:39936
v_mfma_f32_32x32x16_bf16 v[48:63], v[12:15], v[240:243], v[48:63]
s_add_u32 s44, s44, 1
s_cmp_eq_u32 s44, 3
s_mov_b32 s56, 40960
s_cmov_b32 s56, -81920
s_cselect_b32 s44, 0, s44
v_add_u32 v64, s56, v64
s_waitcnt vmcnt(10) lgkmcnt(2)
s_barrier
ds_read_b128 v[8:11], v64 offset:0
v_mfma_f32_32x32x16_bf16 v[48:63], v[16:19], v[244:247], v[48:63]
s_waitcnt lgkmcnt(2)
ds_read_b128 v[12:15], v64 offset:1024
v_mfma_f32_32x32x16_bf16 v[48:63], v[20:23], v[248:251], v[48:63]
s_waitcnt lgkmcnt(2)
ds_read_b128 v[16:19], v64 offset:2048
v_mfma_f32_32x32x16_bf16 v[48:63], v[24:27], v[252:255], v[48:63]
s_waitcnt lgkmcnt(2)
ds_read_b128 v[20:23], v64 offset:3072
v_mfma_f32_32x32x16_bf16 v[32:47], v[8:11], v[96:99], 0
s_waitcnt lgkmcnt(2)
ds_read_b128 v[24:27], v64 offset:4096
v_mfma_f32_32x32x16_bf16 v[32:47], v[12:15], v[100:103], v[32:47]
s_waitcnt lgkmcnt(2)
ds_read_b128 v[8:11], v64 offset:5120
v_cvt_pk_bf16_f32 v48, v48, v49
v_cvt_pk_bf16_f32 v49, v50, v51
v_mfma_f32_32x32x16_bf16 v[32:47], v[16:19], v[104:107], v[32:47]
s_waitcnt lgkmcnt(2)
ds_read_b128 v[12:15], v64 offset:6144
v_cvt_pk_bf16_f32 v50, v52, v53
v_cvt_pk_bf16_f32 v51, v54, v55
v_mfma_f32_32x32x16_bf16 v[32:47], v[20:23], v[108:111], v[32:47]
s_waitcnt lgkmcnt(2)
ds_read_b128 v[16:19], v64 offset:7168
v_cvt_pk_bf16_f32 v52, v56, v57
v_cvt_pk_bf16_f32 v53, v58, v59
v_mfma_f32_32x32x16_bf16 v[32:47], v[24:27], v[112:115], v[32:47]
s_waitcnt lgkmcnt(2)
ds_read_b128 v[20:23], v64 offset:8192
v_cvt_pk_bf16_f32 v54, v60, v61
v_cvt_pk_bf16_f32 v55, v62, v63
v_mfma_f32_32x32x16_bf16 v[32:47], v[8:11], v[116:119], v[32:47]
s_waitcnt lgkmcnt(2)
ds_read_b128 v[24:27], v64 offset:9216
v_accvgpr_write_b32 a72, v48
v_accvgpr_write_b32 a73, v49
v_mfma_f32_32x32x16_bf16 v[32:47], v[12:15], v[120:123], v[32:47]
s_waitcnt lgkmcnt(2)
ds_read_b128 v[8:11], v64 offset:10240
v_accvgpr_write_b32 a74, v50
v_accvgpr_write_b32 a75, v51
v_mfma_f32_32x32x16_bf16 v[32:47], v[16:19], v[124:127], v[32:47]
s_waitcnt lgkmcnt(2)
ds_read_b128 v[12:15], v64 offset:11264
v_accvgpr_write_b32 a76, v52
v_accvgpr_write_b32 a77, v53
v_mfma_f32_32x32x16_bf16 v[32:47], v[20:23], v[128:131], v[32:47]
s_waitcnt lgkmcnt(2)
ds_read_b128 v[16:19], v64 offset:12288
v_accvgpr_write_b32 a78, v54
v_accvgpr_write_b32 a79, v55
v_mfma_f32_32x32x16_bf16 v[32:47], v[24:27], v[132:135], v[32:47]
s_waitcnt lgkmcnt(2)
ds_read_b128 v[20:23], v64 offset:13312
s_add_u32 m0, s45, 0
s_add_u32 s55, s46, 0
buffer_load_dwordx4 v0, s[4:7], s55 offen offset:0 sc1 lds
buffer_load_dwordx4 v0, s[4:7], s55 offen offset:1024 sc1 lds
v_mfma_f32_32x32x16_bf16 v[32:47], v[8:11], v[136:139], v[32:47]
s_waitcnt lgkmcnt(2)
ds_read_b128 v[24:27], v64 offset:14336
buffer_load_dwordx4 v0, s[4:7], s55 offen offset:2048 sc1 lds
buffer_load_dwordx4 v0, s[4:7], s55 offen offset:3072 sc1 lds
v_mfma_f32_32x32x16_bf16 v[32:47], v[12:15], v[140:143], v[32:47]
s_waitcnt lgkmcnt(2)
ds_read_b128 v[8:11], v64 offset:15360
s_add_u32 m0, s45, 4096
s_add_u32 s55, s46, 4096
buffer_load_dwordx4 v0, s[4:7], s55 offen offset:0 sc1 lds
buffer_load_dwordx4 v0, s[4:7], s55 offen offset:1024 sc1 lds
v_mfma_f32_32x32x16_bf16 v[32:47], v[16:19], v[144:147], v[32:47]
s_waitcnt lgkmcnt(2)
ds_read_b128 v[12:15], v64 offset:16384
buffer_load_dwordx4 v0, s[4:7], s55 offen offset:2048 sc1 lds
buffer_load_dwordx4 v0, s[4:7], s55 offen offset:3072 sc1 lds
v_mfma_f32_32x32x16_bf16 v[32:47], v[20:23], v[148:151], v[32:47]
s_waitcnt lgkmcnt(2)
ds_read_b128 v[16:19], v64 offset:17408
s_add_u32 m0, s45, 8192
s_add_u32 s55, s46, 8192
buffer_load_dwordx4 v0, s[4:7], s55 offen offset:0 sc1 lds
buffer_load_dwordx4 v0, s[4:7], s55 offen offset:1024 sc1 lds
v_mfma_f32_32x32x16_bf16 v[32:47], v[24:27], v[152:155], v[32:47]
s_waitcnt lgkmcnt(2)
ds_read_b128 v[20:23], v64 offset:18432
s_add_u32 s45, s45, 40960
s_cmp_ge_u32 s45, 122880
s_cselect_b32 s55, 122880, 0
s_sub_u32 s45, s45, s55
s_add_u32 s46, s46, 40960
v_mfma_f32_32x32x16_bf16 v[32:47], v[8:11], v[156:159], v[32:47]
s_waitcnt lgkmcnt(2)
ds_read_b128 v[24:27], v64 offset:19456
v_mfma_f32_32x32x16_bf16 v[32:47], v[12:15], v[160:163], v[32:47]
s_waitcnt lgkmcnt(2)
ds_read_b128 v[8:11], v64 offset:20480
v_mfma_f32_32x32x16_bf16 v[32:47], v[16:19], v[164:167], v[32:47]
s_waitcnt lgkmcnt(2)
ds_read_b128 v[12:15], v64 offset:21504
v_mfma_f32_32x32x16_bf16 v[32:47], v[20:23], v[168:171], v[32:47]
s_waitcnt lgkmcnt(2)
ds_read_b128 v[16:19], v64 offset:22528
v_mfma_f32_32x32x16_bf16 v[32:47], v[24:27], v[172:175], v[32:47]
s_waitcnt lgkmcnt(2)
ds_read_b128 v[20:23], v64 offset:23552
v_mfma_f32_32x32x16_bf16 v[32:47], v[8:11], v[176:179], v[32:47]
s_waitcnt lgkmcnt(2)
ds_read_b128 v[24:27], v64 offset:24576
v_mfma_f32_32x32x16_bf16 v[32:47], v[12:15], v[180:183], v[32:47]
s_waitcnt lgkmcnt(2)
ds_read_b128 v[8:11], v64 offset:25600
v_mfma_f32_32x32x16_bf16 v[32:47], v[16:19], v[184:187], v[32:47]
s_waitcnt lgkmcnt(2)
ds_read_b128 v[12:15], v64 offset:26624
v_mfma_f32_32x32x16_bf16 v[32:47], v[20:23], v[188:191], v[32:47]
s_waitcnt lgkmcnt(2)
ds_read_b128 v[16:19], v64 offset:27648
v_mfma_f32_32x32x16_bf16 v[32:47], v[24:27], v[192:195], v[32:47]
s_waitcnt lgkmcnt(2)
ds_read_b128 v[20:23], v64 offset:28672
v_mfma_f32_32x32x16_bf16 v[32:47], v[8:11], v[196:199], v[32:47]
s_waitcnt lgkmcnt(2)
ds_read_b128 v[24:27], v64 offset:29696
v_mfma_f32_32x32x16_bf16 v[32:47], v[12:15], v[200:203], v[32:47]
s_waitcnt lgkmcnt(2)
ds_read_b128 v[8:11], v64 offset:30720
v_mfma_f32_32x32x16_bf16 v[32:47], v[16:19], v[204:207], v[32:47]
s_waitcnt lgkmcnt(2)
ds_read_b128 v[12:15], v64 offset:31744
v_mfma_f32_32x32x16_bf16 v[32:47], v[20:23], v[208:211], v[32:47]
s_waitcnt lgkmcnt(2)
ds_read_b128 v[16:19], v64 offset:32768
v_mfma_f32_32x32x16_bf16 v[32:47], v[24:27], v[212:215], v[32:47]
s_waitcnt lgkmcnt(2)
ds_read_b128 v[20:23], v64 offset:33792
v_mfma_f32_32x32x16_bf16 v[32:47], v[8:11], v[216:219], v[32:47]
s_waitcnt lgkmcnt(2)
ds_read_b128 v[24:27], v64 offset:34816
v_mfma_f32_32x32x16_bf16 v[32:47], v[12:15], v[220:223], v[32:47]
s_waitcnt lgkmcnt(2)
ds_read_b128 v[8:11], v64 offset:35840
v_mfma_f32_32x32x16_bf16 v[32:47], v[16:19], v[224:227], v[32:47]
s_waitcnt lgkmcnt(2)
ds_read_b128 v[12:15], v64 offset:36864
v_mfma_f32_32x32x16_bf16 v[32:47], v[20:23], v[228:231], v[32:47]
s_waitcnt lgkmcnt(2)
ds_read_b128 v[16:19], v64 offset:37888
v_mfma_f32_32x32x16_bf16 v[32:47], v[24:27], v[232:235], v[32:47]
s_waitcnt lgkmcnt(2)
ds_read_b128 v[20:23], v64 offset:38912
v_mfma_f32_32x32x16_bf16 v[32:47], v[8:11], v[236:239], v[32:47]
s_waitcnt lgkmcnt(2)
ds_read_b128 v[24:27], v64 offset:39936
v_mfma_f32_32x32x16_bf16 v[32:47], v[12:15], v[240:243], v[32:47]
s_add_u32 s44, s44, 1
s_cmp_eq_u32 s44, 3
s_mov_b32 s56, 40960
s_cmov_b32 s56, -81920
s_cselect_b32 s44, 0, s44
v_add_u32 v64, s56, v64
s_waitcnt vmcnt(10) lgkmcnt(2)
s_barrier
ds_read_b128 v[8:11], v64 offset:0
v_mfma_f32_32x32x16_bf16 v[32:47], v[16:19], v[244:247], v[32:47]
s_waitcnt lgkmcnt(2)
ds_read_b128 v[12:15], v64 offset:1024
v_mfma_f32_32x32x16_bf16 v[32:47], v[20:23], v[248:251], v[32:47]
s_waitcnt lgkmcnt(2)
ds_read_b128 v[16:19], v64 offset:2048
v_mfma_f32_32x32x16_bf16 v[32:47], v[24:27], v[252:255], v[32:47]
s_waitcnt lgkmcnt(2)
ds_read_b128 v[20:23], v64 offset:3072
v_mfma_f32_32x32x16_bf16 v[48:63], v[8:11], v[96:99], 0
s_waitcnt lgkmcnt(2)
ds_read_b128 v[24:27], v64 offset:4096
v_mfma_f32_32x32x16_bf16 v[48:63], v[12:15], v[100:103], v[48:63]
s_waitcnt lgkmcnt(2)
ds_read_b128 v[8:11], v64 offset:5120
v_cvt_pk_bf16_f32 v32, v32, v33
v_cvt_pk_bf16_f32 v33, v34, v35
v_mfma_f32_32x32x16_bf16 v[48:63], v[16:19], v[104:107], v[48:63]
s_waitcnt lgkmcnt(2)
ds_read_b128 v[12:15], v64 offset:6144
v_cvt_pk_bf16_f32 v34, v36, v37
v_cvt_pk_bf16_f32 v35, v38, v39
v_mfma_f32_32x32x16_bf16 v[48:63], v[20:23], v[108:111], v[48:63]
s_waitcnt lgkmcnt(2)
ds_read_b128 v[16:19], v64 offset:7168
v_cvt_pk_bf16_f32 v36, v40, v41
v_cvt_pk_bf16_f32 v37, v42, v43
v_mfma_f32_32x32x16_bf16 v[48:63], v[24:27], v[112:115], v[48:63]
s_waitcnt lgkmcnt(2)
ds_read_b128 v[20:23], v64 offset:8192
v_cvt_pk_bf16_f32 v38, v44, v45
v_cvt_pk_bf16_f32 v39, v46, v47
v_mfma_f32_32x32x16_bf16 v[48:63], v[8:11], v[116:119], v[48:63]
s_waitcnt lgkmcnt(2)
ds_read_b128 v[24:27], v64 offset:9216
v_accvgpr_write_b32 a80, v32
v_accvgpr_write_b32 a81, v33
v_mfma_f32_32x32x16_bf16 v[48:63], v[12:15], v[120:123], v[48:63]
s_waitcnt lgkmcnt(2)
ds_read_b128 v[8:11], v64 offset:10240
v_accvgpr_write_b32 a82, v34
v_accvgpr_write_b32 a83, v35
v_mfma_f32_32x32x16_bf16 v[48:63], v[16:19], v[124:127], v[48:63]
s_waitcnt lgkmcnt(2)
ds_read_b128 v[12:15], v64 offset:11264
v_accvgpr_write_b32 a84, v36
v_accvgpr_write_b32 a85, v37
v_mfma_f32_32x32x16_bf16 v[48:63], v[20:23], v[128:131], v[48:63]
s_waitcnt lgkmcnt(2)
ds_read_b128 v[16:19], v64 offset:12288
v_accvgpr_write_b32 a86, v38
v_accvgpr_write_b32 a87, v39
v_mfma_f32_32x32x16_bf16 v[48:63], v[24:27], v[132:135], v[48:63]
s_waitcnt lgkmcnt(2)
ds_read_b128 v[20:23], v64 offset:13312
s_add_u32 m0, s45, 0
s_add_u32 s55, s46, 0
buffer_load_dwordx4 v0, s[4:7], s55 offen offset:0 sc1 lds
buffer_load_dwordx4 v0, s[4:7], s55 offen offset:1024 sc1 lds
v_mfma_f32_32x32x16_bf16 v[48:63], v[8:11], v[136:139], v[48:63]
s_waitcnt lgkmcnt(2)
ds_read_b128 v[24:27], v64 offset:14336
buffer_load_dwordx4 v0, s[4:7], s55 offen offset:2048 sc1 lds
buffer_load_dwordx4 v0, s[4:7], s55 offen offset:3072 sc1 lds
v_mfma_f32_32x32x16_bf16 v[48:63], v[12:15], v[140:143], v[48:63]
s_waitcnt lgkmcnt(2)
ds_read_b128 v[8:11], v64 offset:15360
s_add_u32 m0, s45, 4096
s_add_u32 s55, s46, 4096
buffer_load_dwordx4 v0, s[4:7], s55 offen offset:0 sc1 lds
buffer_load_dwordx4 v0, s[4:7], s55 offen offset:1024 sc1 lds
v_mfma_f32_32x32x16_bf16 v[48:63], v[16:19], v[144:147], v[48:63]
s_waitcnt lgkmcnt(2)
ds_read_b128 v[12:15], v64 offset:16384
buffer_load_dwordx4 v0, s[4:7], s55 offen offset:2048 sc1 lds
buffer_load_dwordx4 v0, s[4:7], s55 offen offset:3072 sc1 lds
v_mfma_f32_32x32x16_bf16 v[48:63], v[20:23], v[148:151], v[48:63]
s_waitcnt lgkmcnt(2)
ds_read_b128 v[16:19], v64 offset:17408
s_add_u32 m0, s45, 8192
s_add_u32 s55, s46, 8192
buffer_load_dwordx4 v0, s[4:7], s55 offen offset:0 sc1 lds
buffer_load_dwordx4 v0, s[4:7], s55 offen offset:1024 sc1 lds
v_mfma_f32_32x32x16_bf16 v[48:63], v[24:27], v[152:155], v[48:63]
s_waitcnt lgkmcnt(2)
ds_read_b128 v[20:23], v64 offset:18432
s_add_u32 s45, s45, 40960
s_cmp_ge_u32 s45, 122880
s_cselect_b32 s55, 122880, 0
s_sub_u32 s45, s45, s55
s_add_u32 s46, s46, 40960
v_mfma_f32_32x32x16_bf16 v[48:63], v[8:11], v[156:159], v[48:63]
s_waitcnt lgkmcnt(2)
ds_read_b128 v[24:27], v64 offset:19456
v_mfma_f32_32x32x16_bf16 v[48:63], v[12:15], v[160:163], v[48:63]
s_waitcnt lgkmcnt(2)
ds_read_b128 v[8:11], v64 offset:20480
v_mfma_f32_32x32x16_bf16 v[48:63], v[16:19], v[164:167], v[48:63]
s_waitcnt lgkmcnt(2)
ds_read_b128 v[12:15], v64 offset:21504
v_mfma_f32_32x32x16_bf16 v[48:63], v[20:23], v[168:171], v[48:63]
s_waitcnt lgkmcnt(2)
ds_read_b128 v[16:19], v64 offset:22528
v_mfma_f32_32x32x16_bf16 v[48:63], v[24:27], v[172:175], v[48:63]
s_waitcnt lgkmcnt(2)
ds_read_b128 v[20:23], v64 offset:23552
v_mfma_f32_32x32x16_bf16 v[48:63], v[8:11], v[176:179], v[48:63]
s_waitcnt lgkmcnt(2)
ds_read_b128 v[24:27], v64 offset:24576
v_mfma_f32_32x32x16_bf16 v[48:63], v[12:15], v[180:183], v[48:63]
s_waitcnt lgkmcnt(2)
ds_read_b128 v[8:11], v64 offset:25600
v_mfma_f32_32x32x16_bf16 v[48:63], v[16:19], v[184:187], v[48:63]
s_waitcnt lgkmcnt(2)
ds_read_b128 v[12:15], v64 offset:26624
v_mfma_f32_32x32x16_bf16 v[48:63], v[20:23], v[188:191], v[48:63]
s_waitcnt lgkmcnt(2)
ds_read_b128 v[16:19], v64 offset:27648
v_mfma_f32_32x32x16_bf16 v[48:63], v[24:27], v[192:195], v[48:63]
s_waitcnt lgkmcnt(2)
ds_read_b128 v[20:23], v64 offset:28672
v_mfma_f32_32x32x16_bf16 v[48:63], v[8:11], v[196:199], v[48:63]
s_waitcnt lgkmcnt(2)
ds_read_b128 v[24:27], v64 offset:29696
v_mfma_f32_32x32x16_bf16 v[48:63], v[12:15], v[200:203], v[48:63]
s_waitcnt lgkmcnt(2)
ds_read_b128 v[8:11], v64 offset:30720
v_mfma_f32_32x32x16_bf16 v[48:63], v[16:19], v[204:207], v[48:63]
s_waitcnt lgkmcnt(2)
ds_read_b128 v[12:15], v64 offset:31744
v_mfma_f32_32x32x16_bf16 v[48:63], v[20:23], v[208:211], v[48:63]
s_waitcnt lgkmcnt(2)
ds_read_b128 v[16:19], v64 offset:32768
v_mfma_f32_32x32x16_bf16 v[48:63], v[24:27], v[212:215], v[48:63]
s_waitcnt lgkmcnt(2)
ds_read_b128 v[20:23], v64 offset:33792
v_mfma_f32_32x32x16_bf16 v[48:63], v[8:11], v[216:219], v[48:63]
s_waitcnt lgkmcnt(2)
ds_read_b128 v[24:27], v64 offset:34816
v_mfma_f32_32x32x16_bf16 v[48:63], v[12:15], v[220:223], v[48:63]
s_waitcnt lgkmcnt(2)
ds_read_b128 v[8:11], v64 offset:35840
v_mfma_f32_32x32x16_bf16 v[48:63], v[16:19], v[224:227], v[48:63]
s_waitcnt lgkmcnt(2)
ds_read_b128 v[12:15], v64 offset:36864
v_mfma_f32_32x32x16_bf16 v[48:63], v[20:23], v[228:231], v[48:63]
s_waitcnt lgkmcnt(2)
ds_read_b128 v[16:19], v64 offset:37888
v_mfma_f32_32x32x16_bf16 v[48:63], v[24:27], v[232:235], v[48:63]
s_waitcnt lgkmcnt(2)
ds_read_b128 v[20:23], v64 offset:38912
v_mfma_f32_32x32x16_bf16 v[48:63], v[8:11], v[236:239], v[48:63]
s_waitcnt lgkmcnt(2)
ds_read_b128 v[24:27], v64 offset:39936
v_mfma_f32_32x32x16_bf16 v[48:63], v[12:15], v[240:243], v[48:63]
s_add_u32 s44, s44, 1
s_cmp_eq_u32 s44, 3
s_mov_b32 s56, 40960
s_cmov_b32 s56, -81920
s_cselect_b32 s44, 0, s44
v_add_u32 v64, s56, v64
s_waitcnt vmcnt(10) lgkmcnt(2)
s_barrier
ds_read_b128 v[8:11], v64 offset:0
v_mfma_f32_32x32x16_bf16 v[48:63], v[16:19], v[244:247], v[48:63]
s_waitcnt lgkmcnt(2)
ds_read_b128 v[12:15], v64 offset:1024
v_mfma_f32_32x32x16_bf16 v[48:63], v[20:23], v[248:251], v[48:63]
s_waitcnt lgkmcnt(2)
ds_read_b128 v[16:19], v64 offset:2048
v_mfma_f32_32x32x16_bf16 v[48:63], v[24:27], v[252:255], v[48:63]
s_waitcnt lgkmcnt(2)
ds_read_b128 v[20:23], v64 offset:3072
v_mfma_f32_32x32x16_bf16 v[32:47], v[8:11], v[96:99], 0
s_waitcnt lgkmcnt(2)
ds_read_b128 v[24:27], v64 offset:4096
v_mfma_f32_32x32x16_bf16 v[32:47], v[12:15], v[100:103], v[32:47]
s_waitcnt lgkmcnt(2)
ds_read_b128 v[8:11], v64 offset:5120
v_cvt_pk_bf16_f32 v48, v48, v49
v_cvt_pk_bf16_f32 v49, v50, v51
v_mfma_f32_32x32x16_bf16 v[32:47], v[16:19], v[104:107], v[32:47]
s_waitcnt lgkmcnt(2)
ds_read_b128 v[12:15], v64 offset:6144
v_cvt_pk_bf16_f32 v50, v52, v53
v_cvt_pk_bf16_f32 v51, v54, v55
v_mfma_f32_32x32x16_bf16 v[32:47], v[20:23], v[108:111], v[32:47]
s_waitcnt lgkmcnt(2)
ds_read_b128 v[16:19], v64 offset:7168
v_cvt_pk_bf16_f32 v52, v56, v57
v_cvt_pk_bf16_f32 v53, v58, v59
v_mfma_f32_32x32x16_bf16 v[32:47], v[24:27], v[112:115], v[32:47]
s_waitcnt lgkmcnt(2)
ds_read_b128 v[20:23], v64 offset:8192
v_cvt_pk_bf16_f32 v54, v60, v61
v_cvt_pk_bf16_f32 v55, v62, v63
v_mfma_f32_32x32x16_bf16 v[32:47], v[8:11], v[116:119], v[32:47]
s_waitcnt lgkmcnt(2)
ds_read_b128 v[24:27], v64 offset:9216
v_accvgpr_write_b32 a88, v48
v_accvgpr_write_b32 a89, v49
v_mfma_f32_32x32x16_bf16 v[32:47], v[12:15], v[120:123], v[32:47]
s_waitcnt lgkmcnt(2)
ds_read_b128 v[8:11], v64 offset:10240
v_accvgpr_write_b32 a90, v50
v_accvgpr_write_b32 a91, v51
v_mfma_f32_32x32x16_bf16 v[32:47], v[16:19], v[124:127], v[32:47]
s_waitcnt lgkmcnt(2)
ds_read_b128 v[12:15], v64 offset:11264
v_accvgpr_write_b32 a92, v52
v_accvgpr_write_b32 a93, v53
v_mfma_f32_32x32x16_bf16 v[32:47], v[20:23], v[128:131], v[32:47]
s_waitcnt lgkmcnt(2)
ds_read_b128 v[16:19], v64 offset:12288
v_accvgpr_write_b32 a94, v54
v_accvgpr_write_b32 a95, v55
v_mfma_f32_32x32x16_bf16 v[32:47], v[24:27], v[132:135], v[32:47]
s_waitcnt lgkmcnt(2)
ds_read_b128 v[20:23], v64 offset:13312
s_add_u32 m0, s45, 0
s_add_u32 s55, s46, 0
buffer_load_dwordx4 v0, s[4:7], s55 offen offset:0 sc1 lds
buffer_load_dwordx4 v0, s[4:7], s55 offen offset:1024 sc1 lds
v_mfma_f32_32x32x16_bf16 v[32:47], v[8:11], v[136:139], v[32:47]
s_waitcnt lgkmcnt(2)
ds_read_b128 v[24:27], v64 offset:14336
buffer_load_dwordx4 v0, s[4:7], s55 offen offset:2048 sc1 lds
buffer_load_dwordx4 v0, s[4:7], s55 offen offset:3072 sc1 lds
v_mfma_f32_32x32x16_bf16 v[32:47], v[12:15], v[140:143], v[32:47]
s_waitcnt lgkmcnt(2)
ds_read_b128 v[8:11], v64 offset:15360
s_add_u32 m0, s45, 4096
s_add_u32 s55, s46, 4096
buffer_load_dwordx4 v0, s[4:7], s55 offen offset:0 sc1 lds
buffer_load_dwordx4 v0, s[4:7], s55 offen offset:1024 sc1 lds
v_mfma_f32_32x32x16_bf16 v[32:47], v[16:19], v[144:147], v[32:47]
s_waitcnt lgkmcnt(2)
ds_read_b128 v[12:15], v64 offset:16384
buffer_load_dwordx4 v0, s[4:7], s55 offen offset:2048 sc1 lds
buffer_load_dwordx4 v0, s[4:7], s55 offen offset:3072 sc1 lds
v_mfma_f32_32x32x16_bf16 v[32:47], v[20:23], v[148:151], v[32:47]
s_waitcnt lgkmcnt(2)
ds_read_b128 v[16:19], v64 offset:17408
s_add_u32 m0, s45, 8192
s_add_u32 s55, s46, 8192
buffer_load_dwordx4 v0, s[4:7], s55 offen offset:0 sc1 lds
buffer_load_dwordx4 v0, s[4:7], s55 offen offset:1024 sc1 lds
v_mfma_f32_32x32x16_bf16 v[32:47], v[24:27], v[152:155], v[32:47]
s_waitcnt lgkmcnt(2)
ds_read_b128 v[20:23], v64 offset:18432
s_add_u32 s45, s45, 40960
s_cmp_ge_u32 s45, 122880
s_cselect_b32 s55, 122880, 0
s_sub_u32 s45, s45, s55
s_add_u32 s46, s46, 40960
v_mfma_f32_32x32x16_bf16 v[32:47], v[8:11], v[156:159], v[32:47]
s_waitcnt lgkmcnt(2)
ds_read_b128 v[24:27], v64 offset:19456
v_mfma_f32_32x32x16_bf16 v[32:47], v[12:15], v[160:163], v[32:47]
s_waitcnt lgkmcnt(2)
ds_read_b128 v[8:11], v64 offset:20480
v_mfma_f32_32x32x16_bf16 v[32:47], v[16:19], v[164:167], v[32:47]
s_waitcnt lgkmcnt(2)
ds_read_b128 v[12:15], v64 offset:21504
v_mfma_f32_32x32x16_bf16 v[32:47], v[20:23], v[168:171], v[32:47]
s_waitcnt lgkmcnt(2)
ds_read_b128 v[16:19], v64 offset:22528
v_mfma_f32_32x32x16_bf16 v[32:47], v[24:27], v[172:175], v[32:47]
s_waitcnt lgkmcnt(2)
ds_read_b128 v[20:23], v64 offset:23552
v_mfma_f32_32x32x16_bf16 v[32:47], v[8:11], v[176:179], v[32:47]
s_waitcnt lgkmcnt(2)
ds_read_b128 v[24:27], v64 offset:24576
v_mfma_f32_32x32x16_bf16 v[32:47], v[12:15], v[180:183], v[32:47]
s_waitcnt lgkmcnt(2)
ds_read_b128 v[8:11], v64 offset:25600
v_mfma_f32_32x32x16_bf16 v[32:47], v[16:19], v[184:187], v[32:47]
s_waitcnt lgkmcnt(2)
ds_read_b128 v[12:15], v64 offset:26624
v_mfma_f32_32x32x16_bf16 v[32:47], v[20:23], v[188:191], v[32:47]
s_waitcnt lgkmcnt(2)
ds_read_b128 v[16:19], v64 offset:27648
v_mfma_f32_32x32x16_bf16 v[32:47], v[24:27], v[192:195], v[32:47]
s_waitcnt lgkmcnt(2)
ds_read_b128 v[20:23], v64 offset:28672
v_mfma_f32_32x32x16_bf16 v[32:47], v[8:11], v[196:199], v[32:47]
s_waitcnt lgkmcnt(2)
ds_read_b128 v[24:27], v64 offset:29696
v_mfma_f32_32x32x16_bf16 v[32:47], v[12:15], v[200:203], v[32:47]
s_waitcnt lgkmcnt(2)
ds_read_b128 v[8:11], v64 offset:30720
v_mfma_f32_32x32x16_bf16 v[32:47], v[16:19], v[204:207], v[32:47]
s_waitcnt lgkmcnt(2)
ds_read_b128 v[12:15], v64 offset:31744
v_mfma_f32_32x32x16_bf16 v[32:47], v[20:23], v[208:211], v[32:47]
s_waitcnt lgkmcnt(2)
ds_read_b128 v[16:19], v64 offset:32768
v_mfma_f32_32x32x16_bf16 v[32:47], v[24:27], v[212:215], v[32:47]
s_waitcnt lgkmcnt(2)
ds_read_b128 v[20:23], v64 offset:33792
v_mfma_f32_32x32x16_bf16 v[32:47], v[8:11], v[216:219], v[32:47]
s_waitcnt lgkmcnt(2)
ds_read_b128 v[24:27], v64 offset:34816
v_mfma_f32_32x32x16_bf16 v[32:47], v[12:15], v[220:223], v[32:47]
s_waitcnt lgkmcnt(2)
ds_read_b128 v[8:11], v64 offset:35840
v_mfma_f32_32x32x16_bf16 v[32:47], v[16:19], v[224:227], v[32:47]
s_waitcnt lgkmcnt(2)
ds_read_b128 v[12:15], v64 offset:36864
v_mfma_f32_32x32x16_bf16 v[32:47], v[20:23], v[228:231], v[32:47]
s_waitcnt lgkmcnt(2)
ds_read_b128 v[16:19], v64 offset:37888
v_mfma_f32_32x32x16_bf16 v[32:47], v[24:27], v[232:235], v[32:47]
s_waitcnt lgkmcnt(2)
ds_read_b128 v[20:23], v64 offset:38912
v_mfma_f32_32x32x16_bf16 v[32:47], v[8:11], v[236:239], v[32:47]
s_waitcnt lgkmcnt(2)
ds_read_b128 v[24:27], v64 offset:39936
v_mfma_f32_32x32x16_bf16 v[32:47], v[12:15], v[240:243], v[32:47]
s_add_u32 s44, s44, 1
s_cmp_eq_u32 s44, 3
s_mov_b32 s56, 40960
s_cmov_b32 s56, -81920
s_cselect_b32 s44, 0, s44
v_add_u32 v64, s56, v64
s_waitcnt vmcnt(10) lgkmcnt(2)
s_barrier
ds_read_b128 v[8:11], v64 offset:0
v_mfma_f32_32x32x16_bf16 v[32:47], v[16:19], v[244:247], v[32:47]
s_waitcnt lgkmcnt(2)
ds_read_b128 v[12:15], v64 offset:1024
v_mfma_f32_32x32x16_bf16 v[32:47], v[20:23], v[248:251], v[32:47]
s_waitcnt lgkmcnt(2)
ds_read_b128 v[16:19], v64 offset:2048
v_mfma_f32_32x32x16_bf16 v[32:47], v[24:27], v[252:255], v[32:47]
s_waitcnt lgkmcnt(2)
ds_read_b128 v[20:23], v64 offset:3072
v_mfma_f32_32x32x16_bf16 v[48:63], v[8:11], v[96:99], 0
s_waitcnt lgkmcnt(2)
ds_read_b128 v[24:27], v64 offset:4096
v_mfma_f32_32x32x16_bf16 v[48:63], v[12:15], v[100:103], v[48:63]
s_waitcnt lgkmcnt(2)
ds_read_b128 v[8:11], v64 offset:5120
v_cvt_pk_bf16_f32 v32, v32, v33
v_cvt_pk_bf16_f32 v33, v34, v35
v_mfma_f32_32x32x16_bf16 v[48:63], v[16:19], v[104:107], v[48:63]
s_waitcnt lgkmcnt(2)
ds_read_b128 v[12:15], v64 offset:6144
v_cvt_pk_bf16_f32 v34, v36, v37
v_cvt_pk_bf16_f32 v35, v38, v39
v_mfma_f32_32x32x16_bf16 v[48:63], v[20:23], v[108:111], v[48:63]
s_waitcnt lgkmcnt(2)
ds_read_b128 v[16:19], v64 offset:7168
v_cvt_pk_bf16_f32 v36, v40, v41
v_cvt_pk_bf16_f32 v37, v42, v43
v_mfma_f32_32x32x16_bf16 v[48:63], v[24:27], v[112:115], v[48:63]
s_waitcnt lgkmcnt(2)
ds_read_b128 v[20:23], v64 offset:8192
v_cvt_pk_bf16_f32 v38, v44, v45
v_cvt_pk_bf16_f32 v39, v46, v47
v_mfma_f32_32x32x16_bf16 v[48:63], v[8:11], v[116:119], v[48:63]
s_waitcnt lgkmcnt(2)
ds_read_b128 v[24:27], v64 offset:9216
v_accvgpr_write_b32 a96, v32
v_accvgpr_write_b32 a97, v33
v_mfma_f32_32x32x16_bf16 v[48:63], v[12:15], v[120:123], v[48:63]
s_waitcnt lgkmcnt(2)
ds_read_b128 v[8:11], v64 offset:10240
v_accvgpr_write_b32 a98, v34
v_accvgpr_write_b32 a99, v35
v_mfma_f32_32x32x16_bf16 v[48:63], v[16:19], v[124:127], v[48:63]
s_waitcnt lgkmcnt(2)
ds_read_b128 v[12:15], v64 offset:11264
v_accvgpr_write_b32 a100, v36
v_accvgpr_write_b32 a101, v37
v_mfma_f32_32x32x16_bf16 v[48:63], v[20:23], v[128:131], v[48:63]
s_waitcnt lgkmcnt(2)
ds_read_b128 v[16:19], v64 offset:12288
v_accvgpr_write_b32 a102, v38
v_accvgpr_write_b32 a103, v39
v_mfma_f32_32x32x16_bf16 v[48:63], v[24:27], v[132:135], v[48:63]
s_waitcnt lgkmcnt(2)
ds_read_b128 v[20:23], v64 offset:13312
s_add_u32 m0, s45, 0
s_add_u32 s55, s46, 0
buffer_load_dwordx4 v0, s[4:7], s55 offen offset:0 sc1 lds
buffer_load_dwordx4 v0, s[4:7], s55 offen offset:1024 sc1 lds
v_mfma_f32_32x32x16_bf16 v[48:63], v[8:11], v[136:139], v[48:63]
s_waitcnt lgkmcnt(2)
ds_read_b128 v[24:27], v64 offset:14336
buffer_load_dwordx4 v0, s[4:7], s55 offen offset:2048 sc1 lds
buffer_load_dwordx4 v0, s[4:7], s55 offen offset:3072 sc1 lds
v_mfma_f32_32x32x16_bf16 v[48:63], v[12:15], v[140:143], v[48:63]
s_waitcnt lgkmcnt(2)
ds_read_b128 v[8:11], v64 offset:15360
s_add_u32 m0, s45, 4096
s_add_u32 s55, s46, 4096
buffer_load_dwordx4 v0, s[4:7], s55 offen offset:0 sc1 lds
buffer_load_dwordx4 v0, s[4:7], s55 offen offset:1024 sc1 lds
v_mfma_f32_32x32x16_bf16 v[48:63], v[16:19], v[144:147], v[48:63]
s_waitcnt lgkmcnt(2)
ds_read_b128 v[12:15], v64 offset:16384
buffer_load_dwordx4 v0, s[4:7], s55 offen offset:2048 sc1 lds
buffer_load_dwordx4 v0, s[4:7], s55 offen offset:3072 sc1 lds
v_mfma_f32_32x32x16_bf16 v[48:63], v[20:23], v[148:151], v[48:63]
s_waitcnt lgkmcnt(2)
ds_read_b128 v[16:19], v64 offset:17408
s_add_u32 m0, s45, 8192
s_add_u32 s55, s46, 8192
buffer_load_dwordx4 v0, s[4:7], s55 offen offset:0 sc1 lds
buffer_load_dwordx4 v0, s[4:7], s55 offen offset:1024 sc1 lds
v_mfma_f32_32x32x16_bf16 v[48:63], v[24:27], v[152:155], v[48:63]
s_waitcnt lgkmcnt(2)
ds_read_b128 v[20:23], v64 offset:18432
s_add_u32 s45, s45, 40960
s_cmp_ge_u32 s45, 122880
s_cselect_b32 s55, 122880, 0
s_sub_u32 s45, s45, s55
s_add_u32 s46, s46, 40960
v_mfma_f32_32x32x16_bf16 v[48:63], v[8:11], v[156:159], v[48:63]
s_waitcnt lgkmcnt(2)
ds_read_b128 v[24:27], v64 offset:19456
v_mfma_f32_32x32x16_bf16 v[48:63], v[12:15], v[160:163], v[48:63]
s_waitcnt lgkmcnt(2)
ds_read_b128 v[8:11], v64 offset:20480
v_mfma_f32_32x32x16_bf16 v[48:63], v[16:19], v[164:167], v[48:63]
s_waitcnt lgkmcnt(2)
ds_read_b128 v[12:15], v64 offset:21504
v_mfma_f32_32x32x16_bf16 v[48:63], v[20:23], v[168:171], v[48:63]
s_waitcnt lgkmcnt(2)
ds_read_b128 v[16:19], v64 offset:22528
v_mfma_f32_32x32x16_bf16 v[48:63], v[24:27], v[172:175], v[48:63]
s_waitcnt lgkmcnt(2)
ds_read_b128 v[20:23], v64 offset:23552
v_mfma_f32_32x32x16_bf16 v[48:63], v[8:11], v[176:179], v[48:63]
s_waitcnt lgkmcnt(2)
ds_read_b128 v[24:27], v64 offset:24576
v_mfma_f32_32x32x16_bf16 v[48:63], v[12:15], v[180:183], v[48:63]
s_waitcnt lgkmcnt(2)
ds_read_b128 v[8:11], v64 offset:25600
v_mfma_f32_32x32x16_bf16 v[48:63], v[16:19], v[184:187], v[48:63]
s_waitcnt lgkmcnt(2)
ds_read_b128 v[12:15], v64 offset:26624
v_mfma_f32_32x32x16_bf16 v[48:63], v[20:23], v[188:191], v[48:63]
s_waitcnt lgkmcnt(2)
ds_read_b128 v[16:19], v64 offset:27648
v_mfma_f32_32x32x16_bf16 v[48:63], v[24:27], v[192:195], v[48:63]
s_waitcnt lgkmcnt(2)
ds_read_b128 v[20:23], v64 offset:28672
v_mfma_f32_32x32x16_bf16 v[48:63], v[8:11], v[196:199], v[48:63]
s_waitcnt lgkmcnt(2)
ds_read_b128 v[24:27], v64 offset:29696
v_mfma_f32_32x32x16_bf16 v[48:63], v[12:15], v[200:203], v[48:63]
s_waitcnt lgkmcnt(2)
ds_read_b128 v[8:11], v64 offset:30720
v_mfma_f32_32x32x16_bf16 v[48:63], v[16:19], v[204:207], v[48:63]
s_waitcnt lgkmcnt(2)
ds_read_b128 v[12:15], v64 offset:31744
v_mfma_f32_32x32x16_bf16 v[48:63], v[20:23], v[208:211], v[48:63]
s_waitcnt lgkmcnt(2)
ds_read_b128 v[16:19], v64 offset:32768
v_mfma_f32_32x32x16_bf16 v[48:63], v[24:27], v[212:215], v[48:63]
s_waitcnt lgkmcnt(2)
ds_read_b128 v[20:23], v64 offset:33792
v_mfma_f32_32x32x16_bf16 v[48:63], v[8:11], v[216:219], v[48:63]
s_waitcnt lgkmcnt(2)
ds_read_b128 v[24:27], v64 offset:34816
v_mfma_f32_32x32x16_bf16 v[48:63], v[12:15], v[220:223], v[48:63]
s_waitcnt lgkmcnt(2)
ds_read_b128 v[8:11], v64 offset:35840
v_mfma_f32_32x32x16_bf16 v[48:63], v[16:19], v[224:227], v[48:63]
s_waitcnt lgkmcnt(2)
ds_read_b128 v[12:15], v64 offset:36864
v_mfma_f32_32x32x16_bf16 v[48:63], v[20:23], v[228:231], v[48:63]
s_waitcnt lgkmcnt(2)
ds_read_b128 v[16:19], v64 offset:37888
v_mfma_f32_32x32x16_bf16 v[48:63], v[24:27], v[232:235], v[48:63]
s_waitcnt lgkmcnt(2)
ds_read_b128 v[20:23], v64 offset:38912
v_mfma_f32_32x32x16_bf16 v[48:63], v[8:11], v[236:239], v[48:63]
s_waitcnt lgkmcnt(2)
ds_read_b128 v[24:27], v64 offset:39936
v_mfma_f32_32x32x16_bf16 v[48:63], v[12:15], v[240:243], v[48:63]
s_add_u32 s44, s44, 1
s_cmp_eq_u32 s44, 3
s_mov_b32 s56, 40960
s_cmov_b32 s56, -81920
s_cselect_b32 s44, 0, s44
v_add_u32 v64, s56, v64
s_waitcnt vmcnt(10) lgkmcnt(2)
s_barrier
ds_read_b128 v[8:11], v64 offset:0
v_mfma_f32_32x32x16_bf16 v[48:63], v[16:19], v[244:247], v[48:63]
s_waitcnt lgkmcnt(2)
ds_read_b128 v[12:15], v64 offset:1024
v_mfma_f32_32x32x16_bf16 v[48:63], v[20:23], v[248:251], v[48:63]
s_waitcnt lgkmcnt(2)
ds_read_b128 v[16:19], v64 offset:2048
v_mfma_f32_32x32x16_bf16 v[48:63], v[24:27], v[252:255], v[48:63]
s_waitcnt lgkmcnt(2)
ds_read_b128 v[20:23], v64 offset:3072
v_mfma_f32_32x32x16_bf16 v[32:47], v[8:11], v[96:99], 0
s_waitcnt lgkmcnt(2)
ds_read_b128 v[24:27], v64 offset:4096
v_mfma_f32_32x32x16_bf16 v[32:47], v[12:15], v[100:103], v[32:47]
s_waitcnt lgkmcnt(2)
ds_read_b128 v[8:11], v64 offset:5120
v_cvt_pk_bf16_f32 v48, v48, v49
v_cvt_pk_bf16_f32 v49, v50, v51
v_mfma_f32_32x32x16_bf16 v[32:47], v[16:19], v[104:107], v[32:47]
s_waitcnt lgkmcnt(2)
ds_read_b128 v[12:15], v64 offset:6144
v_cvt_pk_bf16_f32 v50, v52, v53
v_cvt_pk_bf16_f32 v51, v54, v55
v_mfma_f32_32x32x16_bf16 v[32:47], v[20:23], v[108:111], v[32:47]
s_waitcnt lgkmcnt(2)
ds_read_b128 v[16:19], v64 offset:7168
v_cvt_pk_bf16_f32 v52, v56, v57
v_cvt_pk_bf16_f32 v53, v58, v59
v_mfma_f32_32x32x16_bf16 v[32:47], v[24:27], v[112:115], v[32:47]
s_waitcnt lgkmcnt(2)
ds_read_b128 v[20:23], v64 offset:8192
v_cvt_pk_bf16_f32 v54, v60, v61
v_cvt_pk_bf16_f32 v55, v62, v63
v_mfma_f32_32x32x16_bf16 v[32:47], v[8:11], v[116:119], v[32:47]
s_waitcnt lgkmcnt(2)
ds_read_b128 v[24:27], v64 offset:9216
v_accvgpr_write_b32 a104, v48
v_accvgpr_write_b32 a105, v49
v_mfma_f32_32x32x16_bf16 v[32:47], v[12:15], v[120:123], v[32:47]
s_waitcnt lgkmcnt(2)
ds_read_b128 v[8:11], v64 offset:10240
v_accvgpr_write_b32 a106, v50
v_accvgpr_write_b32 a107, v51
v_mfma_f32_32x32x16_bf16 v[32:47], v[16:19], v[124:127], v[32:47]
s_waitcnt lgkmcnt(2)
ds_read_b128 v[12:15], v64 offset:11264
v_accvgpr_write_b32 a108, v52
v_accvgpr_write_b32 a109, v53
v_mfma_f32_32x32x16_bf16 v[32:47], v[20:23], v[128:131], v[32:47]
s_waitcnt lgkmcnt(2)
ds_read_b128 v[16:19], v64 offset:12288
v_accvgpr_write_b32 a110, v54
v_accvgpr_write_b32 a111, v55
v_mfma_f32_32x32x16_bf16 v[32:47], v[24:27], v[132:135], v[32:47]
s_waitcnt lgkmcnt(2)
ds_read_b128 v[20:23], v64 offset:13312
s_add_u32 m0, s45, 0
s_add_u32 s55, s46, 0
buffer_load_dwordx4 v0, s[4:7], s55 offen offset:0 sc1 lds
buffer_load_dwordx4 v0, s[4:7], s55 offen offset:1024 sc1 lds
v_mfma_f32_32x32x16_bf16 v[32:47], v[8:11], v[136:139], v[32:47]
s_waitcnt lgkmcnt(2)
ds_read_b128 v[24:27], v64 offset:14336
buffer_load_dwordx4 v0, s[4:7], s55 offen offset:2048 sc1 lds
buffer_load_dwordx4 v0, s[4:7], s55 offen offset:3072 sc1 lds
v_mfma_f32_32x32x16_bf16 v[32:47], v[12:15], v[140:143], v[32:47]
s_waitcnt lgkmcnt(2)
ds_read_b128 v[8:11], v64 offset:15360
s_add_u32 m0, s45, 4096
s_add_u32 s55, s46, 4096
buffer_load_dwordx4 v0, s[4:7], s55 offen offset:0 sc1 lds
buffer_load_dwordx4 v0, s[4:7], s55 offen offset:1024 sc1 lds
v_mfma_f32_32x32x16_bf16 v[32:47], v[16:19], v[144:147], v[32:47]
s_waitcnt lgkmcnt(2)
ds_read_b128 v[12:15], v64 offset:16384
buffer_load_dwordx4 v0, s[4:7], s55 offen offset:2048 sc1 lds
buffer_load_dwordx4 v0, s[4:7], s55 offen offset:3072 sc1 lds
v_mfma_f32_32x32x16_bf16 v[32:47], v[20:23], v[148:151], v[32:47]
s_waitcnt lgkmcnt(2)
ds_read_b128 v[16:19], v64 offset:17408
s_add_u32 m0, s45, 8192
s_add_u32 s55, s46, 8192
buffer_load_dwordx4 v0, s[4:7], s55 offen offset:0 sc1 lds
buffer_load_dwordx4 v0, s[4:7], s55 offen offset:1024 sc1 lds
v_mfma_f32_32x32x16_bf16 v[32:47], v[24:27], v[152:155], v[32:47]
s_waitcnt lgkmcnt(2)
ds_read_b128 v[20:23], v64 offset:18432
s_add_u32 s45, s45, 40960
s_cmp_ge_u32 s45, 122880
s_cselect_b32 s55, 122880, 0
s_sub_u32 s45, s45, s55
s_add_u32 s46, s46, 40960
v_mfma_f32_32x32x16_bf16 v[32:47], v[8:11], v[156:159], v[32:47]
s_waitcnt lgkmcnt(2)
ds_read_b128 v[24:27], v64 offset:19456
v_mfma_f32_32x32x16_bf16 v[32:47], v[12:15], v[160:163], v[32:47]
s_waitcnt lgkmcnt(2)
ds_read_b128 v[8:11], v64 offset:20480
v_mfma_f32_32x32x16_bf16 v[32:47], v[16:19], v[164:167], v[32:47]
s_waitcnt lgkmcnt(2)
ds_read_b128 v[12:15], v64 offset:21504
v_mfma_f32_32x32x16_bf16 v[32:47], v[20:23], v[168:171], v[32:47]
s_waitcnt lgkmcnt(2)
ds_read_b128 v[16:19], v64 offset:22528
v_mfma_f32_32x32x16_bf16 v[32:47], v[24:27], v[172:175], v[32:47]
s_waitcnt lgkmcnt(2)
ds_read_b128 v[20:23], v64 offset:23552
v_mfma_f32_32x32x16_bf16 v[32:47], v[8:11], v[176:179], v[32:47]
s_waitcnt lgkmcnt(2)
ds_read_b128 v[24:27], v64 offset:24576
v_mfma_f32_32x32x16_bf16 v[32:47], v[12:15], v[180:183], v[32:47]
s_waitcnt lgkmcnt(2)
ds_read_b128 v[8:11], v64 offset:25600
v_mfma_f32_32x32x16_bf16 v[32:47], v[16:19], v[184:187], v[32:47]
s_waitcnt lgkmcnt(2)
ds_read_b128 v[12:15], v64 offset:26624
v_mfma_f32_32x32x16_bf16 v[32:47], v[20:23], v[188:191], v[32:47]
s_waitcnt lgkmcnt(2)
ds_read_b128 v[16:19], v64 offset:27648
v_mfma_f32_32x32x16_bf16 v[32:47], v[24:27], v[192:195], v[32:47]
s_waitcnt lgkmcnt(2)
ds_read_b128 v[20:23], v64 offset:28672
v_mfma_f32_32x32x16_bf16 v[32:47], v[8:11], v[196:199], v[32:47]
s_waitcnt lgkmcnt(2)
ds_read_b128 v[24:27], v64 offset:29696
v_mfma_f32_32x32x16_bf16 v[32:47], v[12:15], v[200:203], v[32:47]
s_waitcnt lgkmcnt(2)
ds_read_b128 v[8:11], v64 offset:30720
v_mfma_f32_32x32x16_bf16 v[32:47], v[16:19], v[204:207], v[32:47]
s_waitcnt lgkmcnt(2)
ds_read_b128 v[12:15], v64 offset:31744
v_mfma_f32_32x32x16_bf16 v[32:47], v[20:23], v[208:211], v[32:47]
s_waitcnt lgkmcnt(2)
ds_read_b128 v[16:19], v64 offset:32768
v_mfma_f32_32x32x16_bf16 v[32:47], v[24:27], v[212:215], v[32:47]
s_waitcnt lgkmcnt(2)
ds_read_b128 v[20:23], v64 offset:33792
v_mfma_f32_32x32x16_bf16 v[32:47], v[8:11], v[216:219], v[32:47]
s_waitcnt lgkmcnt(2)
ds_read_b128 v[24:27], v64 offset:34816
v_mfma_f32_32x32x16_bf16 v[32:47], v[12:15], v[220:223], v[32:47]
s_waitcnt lgkmcnt(2)
ds_read_b128 v[8:11], v64 offset:35840
v_mfma_f32_32x32x16_bf16 v[32:47], v[16:19], v[224:227], v[32:47]
s_waitcnt lgkmcnt(2)
ds_read_b128 v[12:15], v64 offset:36864
v_mfma_f32_32x32x16_bf16 v[32:47], v[20:23], v[228:231], v[32:47]
s_waitcnt lgkmcnt(2)
ds_read_b128 v[16:19], v64 offset:37888
v_mfma_f32_32x32x16_bf16 v[32:47], v[24:27], v[232:235], v[32:47]
s_waitcnt lgkmcnt(2)
ds_read_b128 v[20:23], v64 offset:38912
v_mfma_f32_32x32x16_bf16 v[32:47], v[8:11], v[236:239], v[32:47]
s_waitcnt lgkmcnt(2)
ds_read_b128 v[24:27], v64 offset:39936
v_mfma_f32_32x32x16_bf16 v[32:47], v[12:15], v[240:243], v[32:47]
s_add_u32 s44, s44, 1
s_cmp_eq_u32 s44, 3
s_mov_b32 s56, 40960
s_cmov_b32 s56, -81920
s_cselect_b32 s44, 0, s44
v_add_u32 v64, s56, v64
s_waitcnt vmcnt(10) lgkmcnt(2)
s_barrier
ds_read_b128 v[8:11], v64 offset:0
v_mfma_f32_32x32x16_bf16 v[32:47], v[16:19], v[244:247], v[32:47]
s_waitcnt lgkmcnt(2)
ds_read_b128 v[12:15], v64 offset:1024
v_mfma_f32_32x32x16_bf16 v[32:47], v[20:23], v[248:251], v[32:47]
s_waitcnt lgkmcnt(2)
ds_read_b128 v[16:19], v64 offset:2048
v_mfma_f32_32x32x16_bf16 v[32:47], v[24:27], v[252:255], v[32:47]
s_waitcnt lgkmcnt(2)
ds_read_b128 v[20:23], v64 offset:3072
v_mfma_f32_32x32x16_bf16 v[48:63], v[8:11], v[96:99], 0
s_waitcnt lgkmcnt(2)
ds_read_b128 v[24:27], v64 offset:4096
v_mfma_f32_32x32x16_bf16 v[48:63], v[12:15], v[100:103], v[48:63]
s_waitcnt lgkmcnt(2)
ds_read_b128 v[8:11], v64 offset:5120
v_cvt_pk_bf16_f32 v32, v32, v33
v_cvt_pk_bf16_f32 v33, v34, v35
v_mfma_f32_32x32x16_bf16 v[48:63], v[16:19], v[104:107], v[48:63]
s_waitcnt lgkmcnt(2)
ds_read_b128 v[12:15], v64 offset:6144
v_cvt_pk_bf16_f32 v34, v36, v37
v_cvt_pk_bf16_f32 v35, v38, v39
v_mfma_f32_32x32x16_bf16 v[48:63], v[20:23], v[108:111], v[48:63]
s_waitcnt lgkmcnt(2)
ds_read_b128 v[16:19], v64 offset:7168
v_cvt_pk_bf16_f32 v36, v40, v41
v_cvt_pk_bf16_f32 v37, v42, v43
v_mfma_f32_32x32x16_bf16 v[48:63], v[24:27], v[112:115], v[48:63]
s_waitcnt lgkmcnt(2)
ds_read_b128 v[20:23], v64 offset:8192
v_cvt_pk_bf16_f32 v38, v44, v45
v_cvt_pk_bf16_f32 v39, v46, v47
v_mfma_f32_32x32x16_bf16 v[48:63], v[8:11], v[116:119], v[48:63]
s_waitcnt lgkmcnt(2)
ds_read_b128 v[24:27], v64 offset:9216
v_accvgpr_write_b32 a112, v32
v_accvgpr_write_b32 a113, v33
v_mfma_f32_32x32x16_bf16 v[48:63], v[12:15], v[120:123], v[48:63]
s_waitcnt lgkmcnt(2)
ds_read_b128 v[8:11], v64 offset:10240
v_accvgpr_write_b32 a114, v34
v_accvgpr_write_b32 a115, v35
v_mfma_f32_32x32x16_bf16 v[48:63], v[16:19], v[124:127], v[48:63]
s_waitcnt lgkmcnt(2)
ds_read_b128 v[12:15], v64 offset:11264
v_accvgpr_write_b32 a116, v36
v_accvgpr_write_b32 a117, v37
v_mfma_f32_32x32x16_bf16 v[48:63], v[20:23], v[128:131], v[48:63]
s_waitcnt lgkmcnt(2)
ds_read_b128 v[16:19], v64 offset:12288
v_accvgpr_write_b32 a118, v38
v_accvgpr_write_b32 a119, v39
v_mfma_f32_32x32x16_bf16 v[48:63], v[24:27], v[132:135], v[48:63]
s_waitcnt lgkmcnt(2)
ds_read_b128 v[20:23], v64 offset:13312
s_add_u32 m0, s45, 0
s_add_u32 s55, s46, 0
buffer_load_dwordx4 v0, s[4:7], s55 offen offset:0 sc1 lds
buffer_load_dwordx4 v0, s[4:7], s55 offen offset:1024 sc1 lds
v_mfma_f32_32x32x16_bf16 v[48:63], v[8:11], v[136:139], v[48:63]
s_waitcnt lgkmcnt(2)
ds_read_b128 v[24:27], v64 offset:14336
buffer_load_dwordx4 v0, s[4:7], s55 offen offset:2048 sc1 lds
buffer_load_dwordx4 v0, s[4:7], s55 offen offset:3072 sc1 lds
v_mfma_f32_32x32x16_bf16 v[48:63], v[12:15], v[140:143], v[48:63]
s_waitcnt lgkmcnt(2)
ds_read_b128 v[8:11], v64 offset:15360
s_add_u32 m0, s45, 4096
s_add_u32 s55, s46, 4096
buffer_load_dwordx4 v0, s[4:7], s55 offen offset:0 sc1 lds
buffer_load_dwordx4 v0, s[4:7], s55 offen offset:1024 sc1 lds
v_mfma_f32_32x32x16_bf16 v[48:63], v[16:19], v[144:147], v[48:63]
s_waitcnt lgkmcnt(2)
ds_read_b128 v[12:15], v64 offset:16384
buffer_load_dwordx4 v0, s[4:7], s55 offen offset:2048 sc1 lds
buffer_load_dwordx4 v0, s[4:7], s55 offen offset:3072 sc1 lds
v_mfma_f32_32x32x16_bf16 v[48:63], v[20:23], v[148:151], v[48:63]
s_waitcnt lgkmcnt(2)
ds_read_b128 v[16:19], v64 offset:17408
s_add_u32 m0, s45, 8192
s_add_u32 s55, s46, 8192
buffer_load_dwordx4 v0, s[4:7], s55 offen offset:0 sc1 lds
buffer_load_dwordx4 v0, s[4:7], s55 offen offset:1024 sc1 lds
v_mfma_f32_32x32x16_bf16 v[48:63], v[24:27], v[152:155], v[48:63]
s_waitcnt lgkmcnt(2)
ds_read_b128 v[20:23], v64 offset:18432
s_add_u32 s45, s45, 40960
s_cmp_ge_u32 s45, 122880
s_cselect_b32 s55, 122880, 0
s_sub_u32 s45, s45, s55
s_add_u32 s46, s46, 40960
v_mfma_f32_32x32x16_bf16 v[48:63], v[8:11], v[156:159], v[48:63]
s_waitcnt lgkmcnt(2)
ds_read_b128 v[24:27], v64 offset:19456
v_mfma_f32_32x32x16_bf16 v[48:63], v[12:15], v[160:163], v[48:63]
s_waitcnt lgkmcnt(2)
ds_read_b128 v[8:11], v64 offset:20480
v_mfma_f32_32x32x16_bf16 v[48:63], v[16:19], v[164:167], v[48:63]
s_waitcnt lgkmcnt(2)
ds_read_b128 v[12:15], v64 offset:21504
v_mfma_f32_32x32x16_bf16 v[48:63], v[20:23], v[168:171], v[48:63]
s_waitcnt lgkmcnt(2)
ds_read_b128 v[16:19], v64 offset:22528
v_mfma_f32_32x32x16_bf16 v[48:63], v[24:27], v[172:175], v[48:63]
s_waitcnt lgkmcnt(2)
ds_read_b128 v[20:23], v64 offset:23552
v_mfma_f32_32x32x16_bf16 v[48:63], v[8:11], v[176:179], v[48:63]
s_waitcnt lgkmcnt(2)
ds_read_b128 v[24:27], v64 offset:24576
v_mfma_f32_32x32x16_bf16 v[48:63], v[12:15], v[180:183], v[48:63]
s_waitcnt lgkmcnt(2)
ds_read_b128 v[8:11], v64 offset:25600
v_mfma_f32_32x32x16_bf16 v[48:63], v[16:19], v[184:187], v[48:63]
s_waitcnt lgkmcnt(2)
ds_read_b128 v[12:15], v64 offset:26624
v_mfma_f32_32x32x16_bf16 v[48:63], v[20:23], v[188:191], v[48:63]
s_waitcnt lgkmcnt(2)
ds_read_b128 v[16:19], v64 offset:27648
v_mfma_f32_32x32x16_bf16 v[48:63], v[24:27], v[192:195], v[48:63]
s_waitcnt lgkmcnt(2)
ds_read_b128 v[20:23], v64 offset:28672
v_mfma_f32_32x32x16_bf16 v[48:63], v[8:11], v[196:199], v[48:63]
s_waitcnt lgkmcnt(2)
ds_read_b128 v[24:27], v64 offset:29696
v_mfma_f32_32x32x16_bf16 v[48:63], v[12:15], v[200:203], v[48:63]
s_waitcnt lgkmcnt(2)
ds_read_b128 v[8:11], v64 offset:30720
v_mfma_f32_32x32x16_bf16 v[48:63], v[16:19], v[204:207], v[48:63]
s_waitcnt lgkmcnt(2)
ds_read_b128 v[12:15], v64 offset:31744
v_mfma_f32_32x32x16_bf16 v[48:63], v[20:23], v[208:211], v[48:63]
s_waitcnt lgkmcnt(2)
ds_read_b128 v[16:19], v64 offset:32768
v_mfma_f32_32x32x16_bf16 v[48:63], v[24:27], v[212:215], v[48:63]
s_waitcnt lgkmcnt(2)
ds_read_b128 v[20:23], v64 offset:33792
v_mfma_f32_32x32x16_bf16 v[48:63], v[8:11], v[216:219], v[48:63]
s_waitcnt lgkmcnt(2)
ds_read_b128 v[24:27], v64 offset:34816
v_mfma_f32_32x32x16_bf16 v[48:63], v[12:15], v[220:223], v[48:63]
s_waitcnt lgkmcnt(2)
ds_read_b128 v[8:11], v64 offset:35840
v_mfma_f32_32x32x16_bf16 v[48:63], v[16:19], v[224:227], v[48:63]
s_waitcnt lgkmcnt(2)
ds_read_b128 v[12:15], v64 offset:36864
v_mfma_f32_32x32x16_bf16 v[48:63], v[20:23], v[228:231], v[48:63]
s_waitcnt lgkmcnt(2)
ds_read_b128 v[16:19], v64 offset:37888
v_mfma_f32_32x32x16_bf16 v[48:63], v[24:27], v[232:235], v[48:63]
s_waitcnt lgkmcnt(2)
ds_read_b128 v[20:23], v64 offset:38912
v_mfma_f32_32x32x16_bf16 v[48:63], v[8:11], v[236:239], v[48:63]
s_waitcnt lgkmcnt(2)
ds_read_b128 v[24:27], v64 offset:39936
v_mfma_f32_32x32x16_bf16 v[48:63], v[12:15], v[240:243], v[48:63]
s_add_u32 s44, s44, 1
s_cmp_eq_u32 s44, 3
s_mov_b32 s56, 40960
s_cmov_b32 s56, -81920
s_cselect_b32 s44, 0, s44
v_add_u32 v64, s56, v64
s_waitcnt vmcnt(10) lgkmcnt(2)
s_barrier
ds_read_b128 v[8:11], v64 offset:0
v_mfma_f32_32x32x16_bf16 v[48:63], v[16:19], v[244:247], v[48:63]
s_waitcnt lgkmcnt(2)
ds_read_b128 v[12:15], v64 offset:1024
v_mfma_f32_32x32x16_bf16 v[48:63], v[20:23], v[248:251], v[48:63]
s_waitcnt lgkmcnt(2)
ds_read_b128 v[16:19], v64 offset:2048
v_mfma_f32_32x32x16_bf16 v[48:63], v[24:27], v[252:255], v[48:63]
s_waitcnt lgkmcnt(2)
ds_read_b128 v[20:23], v64 offset:3072
v_mfma_f32_32x32x16_bf16 v[32:47], v[8:11], v[96:99], 0
s_waitcnt lgkmcnt(2)
ds_read_b128 v[24:27], v64 offset:4096
v_mfma_f32_32x32x16_bf16 v[32:47], v[12:15], v[100:103], v[32:47]
s_waitcnt lgkmcnt(2)
ds_read_b128 v[8:11], v64 offset:5120
v_cvt_pk_bf16_f32 v48, v48, v49
v_cvt_pk_bf16_f32 v49, v50, v51
v_mfma_f32_32x32x16_bf16 v[32:47], v[16:19], v[104:107], v[32:47]
s_waitcnt lgkmcnt(2)
ds_read_b128 v[12:15], v64 offset:6144
v_cvt_pk_bf16_f32 v50, v52, v53
v_cvt_pk_bf16_f32 v51, v54, v55
v_mfma_f32_32x32x16_bf16 v[32:47], v[20:23], v[108:111], v[32:47]
s_waitcnt lgkmcnt(2)
ds_read_b128 v[16:19], v64 offset:7168
v_cvt_pk_bf16_f32 v52, v56, v57
v_cvt_pk_bf16_f32 v53, v58, v59
v_mfma_f32_32x32x16_bf16 v[32:47], v[24:27], v[112:115], v[32:47]
s_waitcnt lgkmcnt(2)
ds_read_b128 v[20:23], v64 offset:8192
v_cvt_pk_bf16_f32 v54, v60, v61
v_cvt_pk_bf16_f32 v55, v62, v63
v_mfma_f32_32x32x16_bf16 v[32:47], v[8:11], v[116:119], v[32:47]
s_waitcnt lgkmcnt(2)
ds_read_b128 v[24:27], v64 offset:9216
v_accvgpr_write_b32 a120, v48
v_accvgpr_write_b32 a121, v49
v_mfma_f32_32x32x16_bf16 v[32:47], v[12:15], v[120:123], v[32:47]
s_waitcnt lgkmcnt(2)
ds_read_b128 v[8:11], v64 offset:10240
v_accvgpr_write_b32 a122, v50
v_accvgpr_write_b32 a123, v51
v_mfma_f32_32x32x16_bf16 v[32:47], v[16:19], v[124:127], v[32:47]
s_waitcnt lgkmcnt(2)
ds_read_b128 v[12:15], v64 offset:11264
v_accvgpr_write_b32 a124, v52
v_accvgpr_write_b32 a125, v53
v_mfma_f32_32x32x16_bf16 v[32:47], v[20:23], v[128:131], v[32:47]
s_waitcnt lgkmcnt(2)
ds_read_b128 v[16:19], v64 offset:12288
v_accvgpr_write_b32 a126, v54
v_accvgpr_write_b32 a127, v55
v_mfma_f32_32x32x16_bf16 v[32:47], v[24:27], v[132:135], v[32:47]
s_waitcnt lgkmcnt(2)
ds_read_b128 v[20:23], v64 offset:13312
s_add_u32 m0, s45, 0
s_add_u32 s55, s46, 0
buffer_load_dwordx4 v0, s[4:7], s55 offen offset:0 sc1 lds
buffer_load_dwordx4 v0, s[4:7], s55 offen offset:1024 sc1 lds
v_mfma_f32_32x32x16_bf16 v[32:47], v[8:11], v[136:139], v[32:47]
s_waitcnt lgkmcnt(2)
ds_read_b128 v[24:27], v64 offset:14336
buffer_load_dwordx4 v0, s[4:7], s55 offen offset:2048 sc1 lds
buffer_load_dwordx4 v0, s[4:7], s55 offen offset:3072 sc1 lds
v_mfma_f32_32x32x16_bf16 v[32:47], v[12:15], v[140:143], v[32:47]
s_waitcnt lgkmcnt(2)
ds_read_b128 v[8:11], v64 offset:15360
s_add_u32 m0, s45, 4096
s_add_u32 s55, s46, 4096
buffer_load_dwordx4 v0, s[4:7], s55 offen offset:0 sc1 lds
buffer_load_dwordx4 v0, s[4:7], s55 offen offset:1024 sc1 lds
v_mfma_f32_32x32x16_bf16 v[32:47], v[16:19], v[144:147], v[32:47]
s_waitcnt lgkmcnt(2)
ds_read_b128 v[12:15], v64 offset:16384
buffer_load_dwordx4 v0, s[4:7], s55 offen offset:2048 sc1 lds
buffer_load_dwordx4 v0, s[4:7], s55 offen offset:3072 sc1 lds
v_mfma_f32_32x32x16_bf16 v[32:47], v[20:23], v[148:151], v[32:47]
s_waitcnt lgkmcnt(2)
ds_read_b128 v[16:19], v64 offset:17408
s_add_u32 m0, s45, 8192
s_add_u32 s55, s46, 8192
buffer_load_dwordx4 v0, s[4:7], s55 offen offset:0 sc1 lds
buffer_load_dwordx4 v0, s[4:7], s55 offen offset:1024 sc1 lds
v_mfma_f32_32x32x16_bf16 v[32:47], v[24:27], v[152:155], v[32:47]
s_waitcnt lgkmcnt(2)
ds_read_b128 v[20:23], v64 offset:18432
s_add_u32 s45, s45, 40960
s_cmp_ge_u32 s45, 122880
s_cselect_b32 s55, 122880, 0
s_sub_u32 s45, s45, s55
s_add_u32 s46, s46, 40960
v_mfma_f32_32x32x16_bf16 v[32:47], v[8:11], v[156:159], v[32:47]
s_waitcnt lgkmcnt(2)
ds_read_b128 v[24:27], v64 offset:19456
v_mfma_f32_32x32x16_bf16 v[32:47], v[12:15], v[160:163], v[32:47]
s_waitcnt lgkmcnt(2)
ds_read_b128 v[8:11], v64 offset:20480
v_mfma_f32_32x32x16_bf16 v[32:47], v[16:19], v[164:167], v[32:47]
s_waitcnt lgkmcnt(2)
ds_read_b128 v[12:15], v64 offset:21504
v_mfma_f32_32x32x16_bf16 v[32:47], v[20:23], v[168:171], v[32:47]
s_waitcnt lgkmcnt(2)
ds_read_b128 v[16:19], v64 offset:22528
v_mfma_f32_32x32x16_bf16 v[32:47], v[24:27], v[172:175], v[32:47]
s_waitcnt lgkmcnt(2)
ds_read_b128 v[20:23], v64 offset:23552
v_mfma_f32_32x32x16_bf16 v[32:47], v[8:11], v[176:179], v[32:47]
s_waitcnt lgkmcnt(2)
ds_read_b128 v[24:27], v64 offset:24576
v_mfma_f32_32x32x16_bf16 v[32:47], v[12:15], v[180:183], v[32:47]
s_waitcnt lgkmcnt(2)
ds_read_b128 v[8:11], v64 offset:25600
v_mfma_f32_32x32x16_bf16 v[32:47], v[16:19], v[184:187], v[32:47]
s_waitcnt lgkmcnt(2)
ds_read_b128 v[12:15], v64 offset:26624
v_mfma_f32_32x32x16_bf16 v[32:47], v[20:23], v[188:191], v[32:47]
s_waitcnt lgkmcnt(2)
ds_read_b128 v[16:19], v64 offset:27648
v_mfma_f32_32x32x16_bf16 v[32:47], v[24:27], v[192:195], v[32:47]
s_waitcnt lgkmcnt(2)
ds_read_b128 v[20:23], v64 offset:28672
v_mfma_f32_32x32x16_bf16 v[32:47], v[8:11], v[196:199], v[32:47]
s_waitcnt lgkmcnt(2)
ds_read_b128 v[24:27], v64 offset:29696
v_mfma_f32_32x32x16_bf16 v[32:47], v[12:15], v[200:203], v[32:47]
s_waitcnt lgkmcnt(2)
ds_read_b128 v[8:11], v64 offset:30720
v_mfma_f32_32x32x16_bf16 v[32:47], v[16:19], v[204:207], v[32:47]
s_waitcnt lgkmcnt(2)
ds_read_b128 v[12:15], v64 offset:31744
v_mfma_f32_32x32x16_bf16 v[32:47], v[20:23], v[208:211], v[32:47]
s_waitcnt lgkmcnt(2)
ds_read_b128 v[16:19], v64 offset:32768
v_mfma_f32_32x32x16_bf16 v[32:47], v[24:27], v[212:215], v[32:47]
s_waitcnt lgkmcnt(2)
ds_read_b128 v[20:23], v64 offset:33792
v_mfma_f32_32x32x16_bf16 v[32:47], v[8:11], v[216:219], v[32:47]
s_waitcnt lgkmcnt(2)
ds_read_b128 v[24:27], v64 offset:34816
v_mfma_f32_32x32x16_bf16 v[32:47], v[12:15], v[220:223], v[32:47]
s_waitcnt lgkmcnt(2)
ds_read_b128 v[8:11], v64 offset:35840
v_mfma_f32_32x32x16_bf16 v[32:47], v[16:19], v[224:227], v[32:47]
s_waitcnt lgkmcnt(2)
ds_read_b128 v[12:15], v64 offset:36864
v_mfma_f32_32x32x16_bf16 v[32:47], v[20:23], v[228:231], v[32:47]
s_waitcnt lgkmcnt(2)
ds_read_b128 v[16:19], v64 offset:37888
v_mfma_f32_32x32x16_bf16 v[32:47], v[24:27], v[232:235], v[32:47]
s_waitcnt lgkmcnt(2)
ds_read_b128 v[20:23], v64 offset:38912
v_mfma_f32_32x32x16_bf16 v[32:47], v[8:11], v[236:239], v[32:47]
s_waitcnt lgkmcnt(2)
ds_read_b128 v[24:27], v64 offset:39936
v_mfma_f32_32x32x16_bf16 v[32:47], v[12:15], v[240:243], v[32:47]
s_add_u32 s44, s44, 1
s_cmp_eq_u32 s44, 3
s_mov_b32 s56, 40960
s_cmov_b32 s56, -81920
s_cselect_b32 s44, 0, s44
v_add_u32 v64, s56, v64
s_waitcnt vmcnt(10) lgkmcnt(2)
s_barrier
ds_read_b128 v[8:11], v64 offset:0
v_mfma_f32_32x32x16_bf16 v[32:47], v[16:19], v[244:247], v[32:47]
s_waitcnt lgkmcnt(2)
ds_read_b128 v[12:15], v64 offset:1024
v_mfma_f32_32x32x16_bf16 v[32:47], v[20:23], v[248:251], v[32:47]
s_waitcnt lgkmcnt(2)
ds_read_b128 v[16:19], v64 offset:2048
v_mfma_f32_32x32x16_bf16 v[32:47], v[24:27], v[252:255], v[32:47]
s_waitcnt lgkmcnt(2)
ds_read_b128 v[20:23], v64 offset:3072
v_mfma_f32_32x32x16_bf16 v[48:63], v[8:11], v[96:99], 0
s_waitcnt lgkmcnt(2)
ds_read_b128 v[24:27], v64 offset:4096
v_mfma_f32_32x32x16_bf16 v[48:63], v[12:15], v[100:103], v[48:63]
s_waitcnt lgkmcnt(2)
ds_read_b128 v[8:11], v64 offset:5120
v_cvt_pk_bf16_f32 v32, v32, v33
v_cvt_pk_bf16_f32 v33, v34, v35
v_mfma_f32_32x32x16_bf16 v[48:63], v[16:19], v[104:107], v[48:63]
s_waitcnt lgkmcnt(2)
ds_read_b128 v[12:15], v64 offset:6144
v_cvt_pk_bf16_f32 v34, v36, v37
v_cvt_pk_bf16_f32 v35, v38, v39
v_mfma_f32_32x32x16_bf16 v[48:63], v[20:23], v[108:111], v[48:63]
s_waitcnt lgkmcnt(2)
ds_read_b128 v[16:19], v64 offset:7168
v_cvt_pk_bf16_f32 v36, v40, v41
v_cvt_pk_bf16_f32 v37, v42, v43
v_mfma_f32_32x32x16_bf16 v[48:63], v[24:27], v[112:115], v[48:63]
s_waitcnt lgkmcnt(2)
ds_read_b128 v[20:23], v64 offset:8192
v_cvt_pk_bf16_f32 v38, v44, v45
v_cvt_pk_bf16_f32 v39, v46, v47
v_mfma_f32_32x32x16_bf16 v[48:63], v[8:11], v[116:119], v[48:63]
s_waitcnt lgkmcnt(2)
ds_read_b128 v[24:27], v64 offset:9216
v_accvgpr_write_b32 a128, v32
v_accvgpr_write_b32 a129, v33
v_mfma_f32_32x32x16_bf16 v[48:63], v[12:15], v[120:123], v[48:63]
s_waitcnt lgkmcnt(2)
ds_read_b128 v[8:11], v64 offset:10240
v_accvgpr_write_b32 a130, v34
v_accvgpr_write_b32 a131, v35
v_mfma_f32_32x32x16_bf16 v[48:63], v[16:19], v[124:127], v[48:63]
s_waitcnt lgkmcnt(2)
ds_read_b128 v[12:15], v64 offset:11264
v_accvgpr_write_b32 a132, v36
v_accvgpr_write_b32 a133, v37
v_mfma_f32_32x32x16_bf16 v[48:63], v[20:23], v[128:131], v[48:63]
s_waitcnt lgkmcnt(2)
ds_read_b128 v[16:19], v64 offset:12288
v_accvgpr_write_b32 a134, v38
v_accvgpr_write_b32 a135, v39
v_mfma_f32_32x32x16_bf16 v[48:63], v[24:27], v[132:135], v[48:63]
s_waitcnt lgkmcnt(2)
ds_read_b128 v[20:23], v64 offset:13312
s_add_u32 m0, s45, 0
s_add_u32 s55, s46, 0
buffer_load_dwordx4 v0, s[4:7], s55 offen offset:0 sc1 lds
buffer_load_dwordx4 v0, s[4:7], s55 offen offset:1024 sc1 lds
v_mfma_f32_32x32x16_bf16 v[48:63], v[8:11], v[136:139], v[48:63]
s_waitcnt lgkmcnt(2)
ds_read_b128 v[24:27], v64 offset:14336
buffer_load_dwordx4 v0, s[4:7], s55 offen offset:2048 sc1 lds
buffer_load_dwordx4 v0, s[4:7], s55 offen offset:3072 sc1 lds
v_mfma_f32_32x32x16_bf16 v[48:63], v[12:15], v[140:143], v[48:63]
s_waitcnt lgkmcnt(2)
ds_read_b128 v[8:11], v64 offset:15360
s_add_u32 m0, s45, 4096
s_add_u32 s55, s46, 4096
buffer_load_dwordx4 v0, s[4:7], s55 offen offset:0 sc1 lds
buffer_load_dwordx4 v0, s[4:7], s55 offen offset:1024 sc1 lds
v_mfma_f32_32x32x16_bf16 v[48:63], v[16:19], v[144:147], v[48:63]
s_waitcnt lgkmcnt(2)
ds_read_b128 v[12:15], v64 offset:16384
buffer_load_dwordx4 v0, s[4:7], s55 offen offset:2048 sc1 lds
buffer_load_dwordx4 v0, s[4:7], s55 offen offset:3072 sc1 lds
v_mfma_f32_32x32x16_bf16 v[48:63], v[20:23], v[148:151], v[48:63]
s_waitcnt lgkmcnt(2)
ds_read_b128 v[16:19], v64 offset:17408
s_add_u32 m0, s45, 8192
s_add_u32 s55, s46, 8192
buffer_load_dwordx4 v0, s[4:7], s55 offen offset:0 sc1 lds
buffer_load_dwordx4 v0, s[4:7], s55 offen offset:1024 sc1 lds
v_mfma_f32_32x32x16_bf16 v[48:63], v[24:27], v[152:155], v[48:63]
s_waitcnt lgkmcnt(2)
ds_read_b128 v[20:23], v64 offset:18432
s_add_u32 s45, s45, 40960
s_cmp_ge_u32 s45, 122880
s_cselect_b32 s55, 122880, 0
s_sub_u32 s45, s45, s55
s_add_u32 s46, s46, 40960
v_mfma_f32_32x32x16_bf16 v[48:63], v[8:11], v[156:159], v[48:63]
s_waitcnt lgkmcnt(2)
ds_read_b128 v[24:27], v64 offset:19456
v_mfma_f32_32x32x16_bf16 v[48:63], v[12:15], v[160:163], v[48:63]
s_waitcnt lgkmcnt(2)
ds_read_b128 v[8:11], v64 offset:20480
v_mfma_f32_32x32x16_bf16 v[48:63], v[16:19], v[164:167], v[48:63]
s_waitcnt lgkmcnt(2)
ds_read_b128 v[12:15], v64 offset:21504
v_mfma_f32_32x32x16_bf16 v[48:63], v[20:23], v[168:171], v[48:63]
s_waitcnt lgkmcnt(2)
ds_read_b128 v[16:19], v64 offset:22528
v_mfma_f32_32x32x16_bf16 v[48:63], v[24:27], v[172:175], v[48:63]
s_waitcnt lgkmcnt(2)
ds_read_b128 v[20:23], v64 offset:23552
v_mfma_f32_32x32x16_bf16 v[48:63], v[8:11], v[176:179], v[48:63]
s_waitcnt lgkmcnt(2)
ds_read_b128 v[24:27], v64 offset:24576
v_mfma_f32_32x32x16_bf16 v[48:63], v[12:15], v[180:183], v[48:63]
s_waitcnt lgkmcnt(2)
ds_read_b128 v[8:11], v64 offset:25600
v_mfma_f32_32x32x16_bf16 v[48:63], v[16:19], v[184:187], v[48:63]
s_waitcnt lgkmcnt(2)
ds_read_b128 v[12:15], v64 offset:26624
v_mfma_f32_32x32x16_bf16 v[48:63], v[20:23], v[188:191], v[48:63]
s_waitcnt lgkmcnt(2)
ds_read_b128 v[16:19], v64 offset:27648
v_mfma_f32_32x32x16_bf16 v[48:63], v[24:27], v[192:195], v[48:63]
s_waitcnt lgkmcnt(2)
ds_read_b128 v[20:23], v64 offset:28672
v_mfma_f32_32x32x16_bf16 v[48:63], v[8:11], v[196:199], v[48:63]
s_waitcnt lgkmcnt(2)
ds_read_b128 v[24:27], v64 offset:29696
v_mfma_f32_32x32x16_bf16 v[48:63], v[12:15], v[200:203], v[48:63]
s_waitcnt lgkmcnt(2)
ds_read_b128 v[8:11], v64 offset:30720
v_mfma_f32_32x32x16_bf16 v[48:63], v[16:19], v[204:207], v[48:63]
s_waitcnt lgkmcnt(2)
ds_read_b128 v[12:15], v64 offset:31744
v_mfma_f32_32x32x16_bf16 v[48:63], v[20:23], v[208:211], v[48:63]
s_waitcnt lgkmcnt(2)
ds_read_b128 v[16:19], v64 offset:32768
v_mfma_f32_32x32x16_bf16 v[48:63], v[24:27], v[212:215], v[48:63]
s_waitcnt lgkmcnt(2)
ds_read_b128 v[20:23], v64 offset:33792
v_mfma_f32_32x32x16_bf16 v[48:63], v[8:11], v[216:219], v[48:63]
s_waitcnt lgkmcnt(2)
ds_read_b128 v[24:27], v64 offset:34816
v_mfma_f32_32x32x16_bf16 v[48:63], v[12:15], v[220:223], v[48:63]
s_waitcnt lgkmcnt(2)
ds_read_b128 v[8:11], v64 offset:35840
v_mfma_f32_32x32x16_bf16 v[48:63], v[16:19], v[224:227], v[48:63]
s_waitcnt lgkmcnt(2)
ds_read_b128 v[12:15], v64 offset:36864
v_mfma_f32_32x32x16_bf16 v[48:63], v[20:23], v[228:231], v[48:63]
s_waitcnt lgkmcnt(2)
ds_read_b128 v[16:19], v64 offset:37888
v_mfma_f32_32x32x16_bf16 v[48:63], v[24:27], v[232:235], v[48:63]
s_waitcnt lgkmcnt(2)
ds_read_b128 v[20:23], v64 offset:38912
v_mfma_f32_32x32x16_bf16 v[48:63], v[8:11], v[236:239], v[48:63]
s_waitcnt lgkmcnt(2)
ds_read_b128 v[24:27], v64 offset:39936
v_mfma_f32_32x32x16_bf16 v[48:63], v[12:15], v[240:243], v[48:63]
s_add_u32 s44, s44, 1
s_cmp_eq_u32 s44, 3
s_mov_b32 s56, 40960
s_cmov_b32 s56, -81920
s_cselect_b32 s44, 0, s44
v_add_u32 v64, s56, v64
s_waitcnt vmcnt(10) lgkmcnt(2)
s_barrier
ds_read_b128 v[8:11], v64 offset:0
v_mfma_f32_32x32x16_bf16 v[48:63], v[16:19], v[244:247], v[48:63]
s_waitcnt lgkmcnt(2)
ds_read_b128 v[12:15], v64 offset:1024
v_mfma_f32_32x32x16_bf16 v[48:63], v[20:23], v[248:251], v[48:63]
s_waitcnt lgkmcnt(2)
ds_read_b128 v[16:19], v64 offset:2048
v_mfma_f32_32x32x16_bf16 v[48:63], v[24:27], v[252:255], v[48:63]
s_waitcnt lgkmcnt(2)
ds_read_b128 v[20:23], v64 offset:3072
v_mfma_f32_32x32x16_bf16 v[32:47], v[8:11], v[96:99], 0
s_waitcnt lgkmcnt(2)
ds_read_b128 v[24:27], v64 offset:4096
v_mfma_f32_32x32x16_bf16 v[32:47], v[12:15], v[100:103], v[32:47]
s_waitcnt lgkmcnt(2)
ds_read_b128 v[8:11], v64 offset:5120
v_cvt_pk_bf16_f32 v48, v48, v49
v_cvt_pk_bf16_f32 v49, v50, v51
v_mfma_f32_32x32x16_bf16 v[32:47], v[16:19], v[104:107], v[32:47]
s_waitcnt lgkmcnt(2)
ds_read_b128 v[12:15], v64 offset:6144
v_cvt_pk_bf16_f32 v50, v52, v53
v_cvt_pk_bf16_f32 v51, v54, v55
v_mfma_f32_32x32x16_bf16 v[32:47], v[20:23], v[108:111], v[32:47]
s_waitcnt lgkmcnt(2)
ds_read_b128 v[16:19], v64 offset:7168
v_cvt_pk_bf16_f32 v52, v56, v57
v_cvt_pk_bf16_f32 v53, v58, v59
v_mfma_f32_32x32x16_bf16 v[32:47], v[24:27], v[112:115], v[32:47]
s_waitcnt lgkmcnt(2)
ds_read_b128 v[20:23], v64 offset:8192
v_cvt_pk_bf16_f32 v54, v60, v61
v_cvt_pk_bf16_f32 v55, v62, v63
v_mfma_f32_32x32x16_bf16 v[32:47], v[8:11], v[116:119], v[32:47]
s_waitcnt lgkmcnt(2)
ds_read_b128 v[24:27], v64 offset:9216
v_accvgpr_write_b32 a136, v48
v_accvgpr_write_b32 a137, v49
v_mfma_f32_32x32x16_bf16 v[32:47], v[12:15], v[120:123], v[32:47]
s_waitcnt lgkmcnt(2)
ds_read_b128 v[8:11], v64 offset:10240
v_accvgpr_write_b32 a138, v50
v_accvgpr_write_b32 a139, v51
v_mfma_f32_32x32x16_bf16 v[32:47], v[16:19], v[124:127], v[32:47]
s_waitcnt lgkmcnt(2)
ds_read_b128 v[12:15], v64 offset:11264
v_accvgpr_write_b32 a140, v52
v_accvgpr_write_b32 a141, v53
v_mfma_f32_32x32x16_bf16 v[32:47], v[20:23], v[128:131], v[32:47]
s_waitcnt lgkmcnt(2)
ds_read_b128 v[16:19], v64 offset:12288
v_accvgpr_write_b32 a142, v54
v_accvgpr_write_b32 a143, v55
v_mfma_f32_32x32x16_bf16 v[32:47], v[24:27], v[132:135], v[32:47]
s_waitcnt lgkmcnt(2)
ds_read_b128 v[20:23], v64 offset:13312
s_add_u32 m0, s45, 0
s_add_u32 s55, s46, 0
buffer_load_dwordx4 v0, s[4:7], s55 offen offset:0 sc1 lds
buffer_load_dwordx4 v0, s[4:7], s55 offen offset:1024 sc1 lds
v_mfma_f32_32x32x16_bf16 v[32:47], v[8:11], v[136:139], v[32:47]
s_waitcnt lgkmcnt(2)
ds_read_b128 v[24:27], v64 offset:14336
buffer_load_dwordx4 v0, s[4:7], s55 offen offset:2048 sc1 lds
buffer_load_dwordx4 v0, s[4:7], s55 offen offset:3072 sc1 lds
v_mfma_f32_32x32x16_bf16 v[32:47], v[12:15], v[140:143], v[32:47]
s_waitcnt lgkmcnt(2)
ds_read_b128 v[8:11], v64 offset:15360
s_add_u32 m0, s45, 4096
s_add_u32 s55, s46, 4096
buffer_load_dwordx4 v0, s[4:7], s55 offen offset:0 sc1 lds
buffer_load_dwordx4 v0, s[4:7], s55 offen offset:1024 sc1 lds
v_mfma_f32_32x32x16_bf16 v[32:47], v[16:19], v[144:147], v[32:47]
s_waitcnt lgkmcnt(2)
ds_read_b128 v[12:15], v64 offset:16384
buffer_load_dwordx4 v0, s[4:7], s55 offen offset:2048 sc1 lds
buffer_load_dwordx4 v0, s[4:7], s55 offen offset:3072 sc1 lds
v_mfma_f32_32x32x16_bf16 v[32:47], v[20:23], v[148:151], v[32:47]
s_waitcnt lgkmcnt(2)
ds_read_b128 v[16:19], v64 offset:17408
s_add_u32 m0, s45, 8192
s_add_u32 s55, s46, 8192
buffer_load_dwordx4 v0, s[4:7], s55 offen offset:0 sc1 lds
buffer_load_dwordx4 v0, s[4:7], s55 offen offset:1024 sc1 lds
v_mfma_f32_32x32x16_bf16 v[32:47], v[24:27], v[152:155], v[32:47]
s_waitcnt lgkmcnt(2)
ds_read_b128 v[20:23], v64 offset:18432
s_add_u32 s45, s45, 40960
s_cmp_ge_u32 s45, 122880
s_cselect_b32 s55, 122880, 0
s_sub_u32 s45, s45, s55
s_add_u32 s46, s46, 40960
v_mfma_f32_32x32x16_bf16 v[32:47], v[8:11], v[156:159], v[32:47]
s_waitcnt lgkmcnt(2)
ds_read_b128 v[24:27], v64 offset:19456
v_mfma_f32_32x32x16_bf16 v[32:47], v[12:15], v[160:163], v[32:47]
s_waitcnt lgkmcnt(2)
ds_read_b128 v[8:11], v64 offset:20480
v_mfma_f32_32x32x16_bf16 v[32:47], v[16:19], v[164:167], v[32:47]
s_waitcnt lgkmcnt(2)
ds_read_b128 v[12:15], v64 offset:21504
v_mfma_f32_32x32x16_bf16 v[32:47], v[20:23], v[168:171], v[32:47]
s_waitcnt lgkmcnt(2)
ds_read_b128 v[16:19], v64 offset:22528
v_mfma_f32_32x32x16_bf16 v[32:47], v[24:27], v[172:175], v[32:47]
s_waitcnt lgkmcnt(2)
ds_read_b128 v[20:23], v64 offset:23552
v_mfma_f32_32x32x16_bf16 v[32:47], v[8:11], v[176:179], v[32:47]
s_waitcnt lgkmcnt(2)
ds_read_b128 v[24:27], v64 offset:24576
v_mfma_f32_32x32x16_bf16 v[32:47], v[12:15], v[180:183], v[32:47]
s_waitcnt lgkmcnt(2)
ds_read_b128 v[8:11], v64 offset:25600
v_mfma_f32_32x32x16_bf16 v[32:47], v[16:19], v[184:187], v[32:47]
s_waitcnt lgkmcnt(2)
ds_read_b128 v[12:15], v64 offset:26624
v_mfma_f32_32x32x16_bf16 v[32:47], v[20:23], v[188:191], v[32:47]
s_waitcnt lgkmcnt(2)
ds_read_b128 v[16:19], v64 offset:27648
v_mfma_f32_32x32x16_bf16 v[32:47], v[24:27], v[192:195], v[32:47]
s_waitcnt lgkmcnt(2)
ds_read_b128 v[20:23], v64 offset:28672
v_mfma_f32_32x32x16_bf16 v[32:47], v[8:11], v[196:199], v[32:47]
s_waitcnt lgkmcnt(2)
ds_read_b128 v[24:27], v64 offset:29696
v_mfma_f32_32x32x16_bf16 v[32:47], v[12:15], v[200:203], v[32:47]
s_waitcnt lgkmcnt(2)
ds_read_b128 v[8:11], v64 offset:30720
v_mfma_f32_32x32x16_bf16 v[32:47], v[16:19], v[204:207], v[32:47]
s_waitcnt lgkmcnt(2)
ds_read_b128 v[12:15], v64 offset:31744
v_mfma_f32_32x32x16_bf16 v[32:47], v[20:23], v[208:211], v[32:47]
s_waitcnt lgkmcnt(2)
ds_read_b128 v[16:19], v64 offset:32768
v_mfma_f32_32x32x16_bf16 v[32:47], v[24:27], v[212:215], v[32:47]
s_waitcnt lgkmcnt(2)
ds_read_b128 v[20:23], v64 offset:33792
v_mfma_f32_32x32x16_bf16 v[32:47], v[8:11], v[216:219], v[32:47]
s_waitcnt lgkmcnt(2)
ds_read_b128 v[24:27], v64 offset:34816
v_mfma_f32_32x32x16_bf16 v[32:47], v[12:15], v[220:223], v[32:47]
s_waitcnt lgkmcnt(2)
ds_read_b128 v[8:11], v64 offset:35840
v_mfma_f32_32x32x16_bf16 v[32:47], v[16:19], v[224:227], v[32:47]
s_waitcnt lgkmcnt(2)
ds_read_b128 v[12:15], v64 offset:36864
v_mfma_f32_32x32x16_bf16 v[32:47], v[20:23], v[228:231], v[32:47]
s_waitcnt lgkmcnt(2)
ds_read_b128 v[16:19], v64 offset:37888
v_mfma_f32_32x32x16_bf16 v[32:47], v[24:27], v[232:235], v[32:47]
s_waitcnt lgkmcnt(2)
ds_read_b128 v[20:23], v64 offset:38912
v_mfma_f32_32x32x16_bf16 v[32:47], v[8:11], v[236:239], v[32:47]
s_waitcnt lgkmcnt(2)
ds_read_b128 v[24:27], v64 offset:39936
v_mfma_f32_32x32x16_bf16 v[32:47], v[12:15], v[240:243], v[32:47]
s_add_u32 s44, s44, 1
s_cmp_eq_u32 s44, 3
s_mov_b32 s56, 40960
s_cmov_b32 s56, -81920
s_cselect_b32 s44, 0, s44
v_add_u32 v64, s56, v64
s_waitcnt vmcnt(10) lgkmcnt(2)
s_barrier
ds_read_b128 v[8:11], v64 offset:0
v_mfma_f32_32x32x16_bf16 v[32:47], v[16:19], v[244:247], v[32:47]
s_waitcnt lgkmcnt(2)
ds_read_b128 v[12:15], v64 offset:1024
v_mfma_f32_32x32x16_bf16 v[32:47], v[20:23], v[248:251], v[32:47]
s_waitcnt lgkmcnt(2)
ds_read_b128 v[16:19], v64 offset:2048
v_mfma_f32_32x32x16_bf16 v[32:47], v[24:27], v[252:255], v[32:47]
s_waitcnt lgkmcnt(2)
ds_read_b128 v[20:23], v64 offset:3072
v_mfma_f32_32x32x16_bf16 v[48:63], v[8:11], v[96:99], 0
s_waitcnt lgkmcnt(2)
ds_read_b128 v[24:27], v64 offset:4096
v_mfma_f32_32x32x16_bf16 v[48:63], v[12:15], v[100:103], v[48:63]
s_waitcnt lgkmcnt(2)
ds_read_b128 v[8:11], v64 offset:5120
v_cvt_pk_bf16_f32 v32, v32, v33
v_cvt_pk_bf16_f32 v33, v34, v35
v_mfma_f32_32x32x16_bf16 v[48:63], v[16:19], v[104:107], v[48:63]
s_waitcnt lgkmcnt(2)
ds_read_b128 v[12:15], v64 offset:6144
v_cvt_pk_bf16_f32 v34, v36, v37
v_cvt_pk_bf16_f32 v35, v38, v39
v_mfma_f32_32x32x16_bf16 v[48:63], v[20:23], v[108:111], v[48:63]
s_waitcnt lgkmcnt(2)
ds_read_b128 v[16:19], v64 offset:7168
v_cvt_pk_bf16_f32 v36, v40, v41
v_cvt_pk_bf16_f32 v37, v42, v43
v_mfma_f32_32x32x16_bf16 v[48:63], v[24:27], v[112:115], v[48:63]
s_waitcnt lgkmcnt(2)
ds_read_b128 v[20:23], v64 offset:8192
v_cvt_pk_bf16_f32 v38, v44, v45
v_cvt_pk_bf16_f32 v39, v46, v47
v_mfma_f32_32x32x16_bf16 v[48:63], v[8:11], v[116:119], v[48:63]
s_waitcnt lgkmcnt(2)
ds_read_b128 v[24:27], v64 offset:9216
v_accvgpr_write_b32 a144, v32
v_accvgpr_write_b32 a145, v33
v_mfma_f32_32x32x16_bf16 v[48:63], v[12:15], v[120:123], v[48:63]
s_waitcnt lgkmcnt(2)
ds_read_b128 v[8:11], v64 offset:10240
v_accvgpr_write_b32 a146, v34
v_accvgpr_write_b32 a147, v35
v_mfma_f32_32x32x16_bf16 v[48:63], v[16:19], v[124:127], v[48:63]
s_waitcnt lgkmcnt(2)
ds_read_b128 v[12:15], v64 offset:11264
v_accvgpr_write_b32 a148, v36
v_accvgpr_write_b32 a149, v37
v_mfma_f32_32x32x16_bf16 v[48:63], v[20:23], v[128:131], v[48:63]
s_waitcnt lgkmcnt(2)
ds_read_b128 v[16:19], v64 offset:12288
v_accvgpr_write_b32 a150, v38
v_accvgpr_write_b32 a151, v39
v_mfma_f32_32x32x16_bf16 v[48:63], v[24:27], v[132:135], v[48:63]
s_waitcnt lgkmcnt(2)
ds_read_b128 v[20:23], v64 offset:13312
s_add_u32 m0, s45, 0
s_add_u32 s55, s46, 0
buffer_load_dwordx4 v0, s[4:7], s55 offen offset:0 sc1 lds
buffer_load_dwordx4 v0, s[4:7], s55 offen offset:1024 sc1 lds
v_mfma_f32_32x32x16_bf16 v[48:63], v[8:11], v[136:139], v[48:63]
s_waitcnt lgkmcnt(2)
ds_read_b128 v[24:27], v64 offset:14336
buffer_load_dwordx4 v0, s[4:7], s55 offen offset:2048 sc1 lds
buffer_load_dwordx4 v0, s[4:7], s55 offen offset:3072 sc1 lds
v_mfma_f32_32x32x16_bf16 v[48:63], v[12:15], v[140:143], v[48:63]
s_waitcnt lgkmcnt(2)
ds_read_b128 v[8:11], v64 offset:15360
s_add_u32 m0, s45, 4096
s_add_u32 s55, s46, 4096
buffer_load_dwordx4 v0, s[4:7], s55 offen offset:0 sc1 lds
buffer_load_dwordx4 v0, s[4:7], s55 offen offset:1024 sc1 lds
v_mfma_f32_32x32x16_bf16 v[48:63], v[16:19], v[144:147], v[48:63]
s_waitcnt lgkmcnt(2)
ds_read_b128 v[12:15], v64 offset:16384
buffer_load_dwordx4 v0, s[4:7], s55 offen offset:2048 sc1 lds
buffer_load_dwordx4 v0, s[4:7], s55 offen offset:3072 sc1 lds
v_mfma_f32_32x32x16_bf16 v[48:63], v[20:23], v[148:151], v[48:63]
s_waitcnt lgkmcnt(2)
ds_read_b128 v[16:19], v64 offset:17408
s_add_u32 m0, s45, 8192
s_add_u32 s55, s46, 8192
buffer_load_dwordx4 v0, s[4:7], s55 offen offset:0 sc1 lds
buffer_load_dwordx4 v0, s[4:7], s55 offen offset:1024 sc1 lds
v_mfma_f32_32x32x16_bf16 v[48:63], v[24:27], v[152:155], v[48:63]
s_waitcnt lgkmcnt(2)
ds_read_b128 v[20:23], v64 offset:18432
s_add_u32 s45, s45, 40960
s_cmp_ge_u32 s45, 122880
s_cselect_b32 s55, 122880, 0
s_sub_u32 s45, s45, s55
s_add_u32 s46, s46, 40960
v_mfma_f32_32x32x16_bf16 v[48:63], v[8:11], v[156:159], v[48:63]
s_waitcnt lgkmcnt(2)
ds_read_b128 v[24:27], v64 offset:19456
v_mfma_f32_32x32x16_bf16 v[48:63], v[12:15], v[160:163], v[48:63]
s_waitcnt lgkmcnt(2)
ds_read_b128 v[8:11], v64 offset:20480
v_mfma_f32_32x32x16_bf16 v[48:63], v[16:19], v[164:167], v[48:63]
s_waitcnt lgkmcnt(2)
ds_read_b128 v[12:15], v64 offset:21504
v_mfma_f32_32x32x16_bf16 v[48:63], v[20:23], v[168:171], v[48:63]
s_waitcnt lgkmcnt(2)
ds_read_b128 v[16:19], v64 offset:22528
v_mfma_f32_32x32x16_bf16 v[48:63], v[24:27], v[172:175], v[48:63]
s_waitcnt lgkmcnt(2)
ds_read_b128 v[20:23], v64 offset:23552
v_mfma_f32_32x32x16_bf16 v[48:63], v[8:11], v[176:179], v[48:63]
s_waitcnt lgkmcnt(2)
ds_read_b128 v[24:27], v64 offset:24576
v_mfma_f32_32x32x16_bf16 v[48:63], v[12:15], v[180:183], v[48:63]
s_waitcnt lgkmcnt(2)
ds_read_b128 v[8:11], v64 offset:25600
v_mfma_f32_32x32x16_bf16 v[48:63], v[16:19], v[184:187], v[48:63]
s_waitcnt lgkmcnt(2)
ds_read_b128 v[12:15], v64 offset:26624
v_mfma_f32_32x32x16_bf16 v[48:63], v[20:23], v[188:191], v[48:63]
s_waitcnt lgkmcnt(2)
ds_read_b128 v[16:19], v64 offset:27648
v_mfma_f32_32x32x16_bf16 v[48:63], v[24:27], v[192:195], v[48:63]
s_waitcnt lgkmcnt(2)
ds_read_b128 v[20:23], v64 offset:28672
v_mfma_f32_32x32x16_bf16 v[48:63], v[8:11], v[196:199], v[48:63]
s_waitcnt lgkmcnt(2)
ds_read_b128 v[24:27], v64 offset:29696
v_mfma_f32_32x32x16_bf16 v[48:63], v[12:15], v[200:203], v[48:63]
s_waitcnt lgkmcnt(2)
ds_read_b128 v[8:11], v64 offset:30720
v_mfma_f32_32x32x16_bf16 v[48:63], v[16:19], v[204:207], v[48:63]
s_waitcnt lgkmcnt(2)
ds_read_b128 v[12:15], v64 offset:31744
v_mfma_f32_32x32x16_bf16 v[48:63], v[20:23], v[208:211], v[48:63]
s_waitcnt lgkmcnt(2)
ds_read_b128 v[16:19], v64 offset:32768
v_mfma_f32_32x32x16_bf16 v[48:63], v[24:27], v[212:215], v[48:63]
s_waitcnt lgkmcnt(2)
ds_read_b128 v[20:23], v64 offset:33792
v_mfma_f32_32x32x16_bf16 v[48:63], v[8:11], v[216:219], v[48:63]
s_waitcnt lgkmcnt(2)
ds_read_b128 v[24:27], v64 offset:34816
v_mfma_f32_32x32x16_bf16 v[48:63], v[12:15], v[220:223], v[48:63]
s_waitcnt lgkmcnt(2)
ds_read_b128 v[8:11], v64 offset:35840
v_mfma_f32_32x32x16_bf16 v[48:63], v[16:19], v[224:227], v[48:63]
s_waitcnt lgkmcnt(2)
ds_read_b128 v[12:15], v64 offset:36864
v_mfma_f32_32x32x16_bf16 v[48:63], v[20:23], v[228:231], v[48:63]
s_waitcnt lgkmcnt(2)
ds_read_b128 v[16:19], v64 offset:37888
v_mfma_f32_32x32x16_bf16 v[48:63], v[24:27], v[232:235], v[48:63]
s_waitcnt lgkmcnt(2)
ds_read_b128 v[20:23], v64 offset:38912
v_mfma_f32_32x32x16_bf16 v[48:63], v[8:11], v[236:239], v[48:63]
s_waitcnt lgkmcnt(2)
ds_read_b128 v[24:27], v64 offset:39936
v_mfma_f32_32x32x16_bf16 v[48:63], v[12:15], v[240:243], v[48:63]
s_add_u32 s44, s44, 1
s_cmp_eq_u32 s44, 3
s_mov_b32 s56, 40960
s_cmov_b32 s56, -81920
s_cselect_b32 s44, 0, s44
v_add_u32 v64, s56, v64
s_waitcnt vmcnt(10) lgkmcnt(2)
s_barrier
ds_read_b128 v[8:11], v64 offset:0
v_mfma_f32_32x32x16_bf16 v[48:63], v[16:19], v[244:247], v[48:63]
s_waitcnt lgkmcnt(2)
ds_read_b128 v[12:15], v64 offset:1024
v_mfma_f32_32x32x16_bf16 v[48:63], v[20:23], v[248:251], v[48:63]
s_waitcnt lgkmcnt(2)
ds_read_b128 v[16:19], v64 offset:2048
v_mfma_f32_32x32x16_bf16 v[48:63], v[24:27], v[252:255], v[48:63]
s_waitcnt lgkmcnt(2)
ds_read_b128 v[20:23], v64 offset:3072
s_nop 9
v_cvt_pk_bf16_f32 v48, v48, v49
v_cvt_pk_bf16_f32 v49, v50, v51
v_cvt_pk_bf16_f32 v50, v52, v53
v_cvt_pk_bf16_f32 v51, v54, v55
v_cvt_pk_bf16_f32 v52, v56, v57
v_cvt_pk_bf16_f32 v53, v58, v59
v_cvt_pk_bf16_f32 v54, v60, v61
v_cvt_pk_bf16_f32 v55, v62, v63
v_accvgpr_write_b32 a152, v48
v_accvgpr_write_b32 a153, v49
v_accvgpr_write_b32 a154, v50
v_accvgpr_write_b32 a155, v51
v_accvgpr_write_b32 a156, v52
v_accvgpr_write_b32 a157, v53
v_accvgpr_write_b32 a158, v54
v_accvgpr_write_b32 a159, v55
v_bfe_u32 v72, v0, 8, 1
v_and_b32 v1, 0xf0, v0
v_lshl_add_u32 v1, v72, 10, v1
v_lshrrev_b32 v72, 9, v0
v_lshl_add_u32 v1, v72, 8, v1
s_lshl_b32 s52, s3, 10
v_add_u32 v73, s52, v0
v_mov_b32 v2, 2146435072
v_cmp_eq_u32 vcc, 0, v73
s_nop 1
v_cndmask_b32 v2, v2, 0, vcc
v_mov_b32 v3, 0xffff
v_cmp_gt_u32 vcc, 512, v73
s_nop 1
v_cndmask_b32 v3, -1, v3, vcc
v_and_b32 v7, 0x1f0, v0
v_lshrrev_b32 v28, 2, v7
v_lshlrev_b32 v7, 1, v7
v_add_u32 v7, 122880, v7
s_lshl_b32 s52, s3, 3
v_lshl_add_u32 v6, v72, 2, v7
v_add_u32 v6, s52, v6
s_lshl_b32 s52, s3, 7
s_add_u32 s52, s52, 124928
v_add_u32 v28, s52, v28
v_lshlrev_b32 v29, 4, v72
v_add_u32 v29, s52, v29
s_mov_b32 s51, 0
s_mov_b32 s50, 0
k_lay_31:
s_lshl_b32 s54, s51, 13
s_add_u32 s54, s54, 222298112
s_waitcnt vmcnt(0) lgkmcnt(0)
s_cmp_lg_u32 s3, 0
s_cbranch_scc1 k_w8d_35
v_lshlrev_b32 v8, 2, v0
k_w8_34:
buffer_load_dword v9, v8, s[4:7], s54 offen sc1
buffer_load_dword v10, v8, s[4:7], s54 offen offset:1024 sc1
s_waitcnt vmcnt(0)
v_and_b32 v9, v9, v10
v_cmp_eq_u32 vcc, 0, v9
s_cbranch_vccz k_w8d_35
s_sleep 1
s_sub_u32 s32, s32, 1
s_cmp_gt_i32 s32, 0
s_cbranch_scc1 k_w8_34
k_w8d_35:
s_barrier
s_mul_i32 s52, s3, 10240
v_add_u32 v5, s52, v0
s_mul_i32 s46, s51, 3145728
s_add_u32 s46, s46, s52
s_add_u32 s46, s46, 195035136
s_lshl_b32 s52, s57, 2
s_add_u32 s52, s52, s3
s_cmp_eq_u32 s58, 2
s_cselect_b32 s53, 11, 12
s_mov_b32 s49, 524288
s_cmov_b32 s49, 262144
s_lshl_b32 s48, s52, s53
s_cmp_eq_u32 s58, 2
s_mov_b32 s52, 41943040
s_cmov_b32 s52, 16777216
s_cselect_b32 s53, 125829120, 0
s_mul_i32 s52, s52, s51
s_add_u32 s48, s48, s52
s_add_u32 s48, s48, s53
s_lshl_b32 s60, s57, 6
s_lshl_b32 s52, s58, 2
s_add_u32 s60, s60, s52
s_add_u32 s60, s60, 222330880
s_mov_b32 s61, 0x3acccccd
s_cmp_eq_u32 s58, 1
s_cbranch_scc1 k_isv_32
s_mul_i32 s45, s3, 10240
s_mov_b32 s44, 0
v_mov_b32 v64, v0
s_add_u32 m0, s45, 0
s_add_u32 s55, s46, 0
buffer_load_dwordx4 v0, s[4:7], s55 offen offset:0 sc1 lds
buffer_load_dwordx4 v0, s[4:7], s55 offen offset:1024 sc1 lds
buffer_load_dwordx4 v0, s[4:7], s55 offen offset:2048 sc1 lds
buffer_load_dwordx4 v0, s[4:7], s55 offen offset:3072 sc1 lds
s_add_u32 m0, s45, 4096
s_add_u32 s55, s46, 4096
buffer_load_dwordx4 v0, s[4:7], s55 offen offset:0 sc1 lds
buffer_load_dwordx4 v0, s[4:7], s55 offen offset:1024 sc1 lds
buffer_load_dwordx4 v0, s[4:7], s55 offen offset:2048 sc1 lds
buffer_load_dwordx4 v0, s[4:7], s55 offen offset:3072 sc1 lds
s_add_u32 m0, s45, 8192
s_add_u32 s55, s46, 8192
buffer_load_dwordx4 v0, s[4:7], s55 offen offset:0 sc1 lds
buffer_load_dwordx4 v0, s[4:7], s55 offen offset:1024 sc1 lds
s_add_u32 s45, s45, 40960
s_cmp_ge_u32 s45, 122880
s_cselect_b32 s55, 122880, 0
s_sub_u32 s45, s45, s55
s_add_u32 s46, s46, 40960
s_add_u32 m0, s45, 0
s_add_u32 s55, s46, 0
buffer_load_dwordx4 v0, s[4:7], s55 offen offset:0 sc1 lds
buffer_load_dwordx4 v0, s[4:7], s55 offen offset:1024 sc1 lds
buffer_load_dwordx4 v0, s[4:7], s55 offen offset:2048 sc1 lds
buffer_load_dwordx4 v0, s[4:7], s55 offen offset:3072 sc1 lds
s_add_u32 m0, s45, 4096
s_add_u32 s55, s46, 4096
buffer_load_dwordx4 v0, s[4:7], s55 offen offset:0 sc1 lds
buffer_load_dwordx4 v0, s[4:7], s55 offen offset:1024 sc1 lds
buffer_load_dwordx4 v0, s[4:7], s55 offen offset:2048 sc1 lds
buffer_load_dwordx4 v0, s[4:7], s55 offen offset:3072 sc1 lds
s_add_u32 m0, s45, 8192
s_add_u32 s55, s46, 8192
buffer_load_dwordx4 v0, s[4:7], s55 offen offset:0 sc1 lds
buffer_load_dwordx4 v0, s[4:7], s55 offen offset:1024 sc1 lds
s_add_u32 s45, s45, 40960
s_cmp_ge_u32 s45, 122880
s_cselect_b32 s55, 122880, 0
s_sub_u32 s45, s45, s55
s_add_u32 s46, s46, 40960
s_waitcnt vmcnt(10)
s_barrier
ds_read_b128 v[8:11], v64 offset:0
ds_read_b128 v[12:15], v64 offset:1024
ds_read_b128 v[16:19], v64 offset:2048
ds_read_b128 v[20:23], v64 offset:3072
s_mov_b32 s59, 32
s_waitcnt lgkmcnt(3)
v_mfma_f32_32x32x16_bf16 v[32:47], a[0:3], v[8:11], 0
s_waitcnt lgkmcnt(2)
ds_read_b128 v[24:27], v64 offset:4096
v_mfma_f32_32x32x16_bf16 v[32:47], a[4:7], v[12:15], v[32:47]
s_waitcnt lgkmcnt(2)
ds_read_b128 v[8:11], v64 offset:5120
ds_read_b128 v[72:75], v5
v_mov_b32 v4, 0
ds_read_b128 v[76:79], v5 offset:1024
v_mfma_f32_32x32x16_bf16 v[32:47], a[8:11], v[16:19], v[32:47]
s_waitcnt lgkmcnt(4)
ds_read_b128 v[12:15], v64 offset:6144
s_waitcnt lgkmcnt(2)
v_and_b32 v72, v3, v72
v_dot2c_f32_bf16 v4, v72, v72
v_dot2c_f32_bf16 v4, v73, v73
v_dot2c_f32_bf16 v4, v74, v74
v_dot2c_f32_bf16 v4, v75, v75
v_mfma_f32_32x32x16_bf16 v[32:47], a[12:15], v[20:23], v[32:47]
ds_read_b128 v[16:19], v64 offset:7168
ds_read_b128 v[72:75], v5 offset:2048
s_waitcnt lgkmcnt(3)
v_dot2c_f32_bf16 v4, v76, v76
v_dot2c_f32_bf16 v4, v77, v77
v_dot2c_f32_bf16 v4, v78, v78
v_dot2c_f32_bf16 v4, v79, v79
v_mfma_f32_32x32x16_bf16 v[32:47], a[16:19], v[24:27], v[32:47]
ds_read_b128 v[20:23], v64 offset:8192
ds_read_b128 v[76:79], v5 offset:3072
s_waitcnt lgkmcnt(2)
v_dot2c_f32_bf16 v4, v72, v72
v_dot2c_f32_bf16 v4, v73, v73
v_dot2c_f32_bf16 v4, v74, v74
v_dot2c_f32_bf16 v4, v75, v75
v_mfma_f32_32x32x16_bf16 v[32:47], a[20:23], v[8:11], v[32:47]
ds_read_b128 v[24:27], v64 offset:9216
ds_read_b128 v[72:75], v5 offset:4096
s_waitcnt lgkmcnt(2)
v_dot2c_f32_bf16 v4, v76, v76
v_dot2c_f32_bf16 v4, v77, v77
v_dot2c_f32_bf16 v4, v78, v78
v_dot2c_f32_bf16 v4, v79, v79
v_mfma_f32_32x32x16_bf16 v[32:47], a[24:27], v[12:15], v[32:47]
ds_read_b128 v[8:11], v64 offset:10240
ds_read_b128 v[76:79], v5 offset:5120
s_waitcnt lgkmcnt(2)
v_dot2c_f32_bf16 v4, v72, v72
v_dot2c_f32_bf16 v4, v73, v73
v_dot2c_f32_bf16 v4, v74, v74
v_dot2c_f32_bf16 v4, v75, v75
v_mfma_f32_32x32x16_bf16 v[32:47], a[28:31], v[16:19], v[32:47]
ds_read_b128 v[12:15], v64 offset:11264
ds_read_b128 v[72:75], v5 offset:6144
s_waitcnt lgkmcnt(2)
v_dot2c_f32_bf16 v4, v76, v76
v_dot2c_f32_bf16 v4, v77, v77
v_dot2c_f32_bf16 v4, v78, v78
v_dot2c_f32_bf16 v4, v79, v79
v_mfma_f32_32x32x16_bf16 v[32:47], a[32:35], v[20:23], v[32:47]
ds_read_b128 v[16:19], v64 offset:12288
ds_read_b128 v[76:79], v5 offset:7168
s_waitcnt lgkmcnt(2)
v_dot2c_f32_bf16 v4, v72, v72
v_dot2c_f32_bf16 v4, v73, v73
v_dot2c_f32_bf16 v4, v74, v74
v_dot2c_f32_bf16 v4, v75, v75
v_mfma_f32_32x32x16_bf16 v[32:47], a[36:39], v[24:27], v[32:47]
ds_read_b128 v[20:23], v64 offset:13312
ds_read_b128 v[72:75], v5 offset:8192
s_waitcnt lgkmcnt(2)
v_dot2c_f32_bf16 v4, v76, v76
v_dot2c_f32_bf16 v4, v77, v77
v_dot2c_f32_bf16 v4, v78, v78
v_dot2c_f32_bf16 v4, v79, v79
v_mfma_f32_32x32x16_bf16 v[32:47], a[40:43], v[8:11], v[32:47]
ds_read_b128 v[24:27], v64 offset:14336
ds_read_b128 v[76:79], v5 offset:9216
s_waitcnt lgkmcnt(2)
v_dot2c_f32_bf16 v4, v72, v72
v_dot2c_f32_bf16 v4, v73, v73
v_dot2c_f32_bf16 v4, v74, v74
v_dot2c_f32_bf16 v4, v75, v75
v_mfma_f32_32x32x16_bf16 v[32:47], a[44:47], v[12:15], v[32:47]
ds_read_b128 v[8:11], v64 offset:15360
s_waitcnt lgkmcnt(1)
v_dot2c_f32_bf16 v4, v76, v76
v_dot2c_f32_bf16 v4, v77, v77
v_dot2c_f32_bf16 v4, v78, v78
v_dot2c_f32_bf16 v4, v79, v79
s_nop 2
ds_write_b32 v6, v4 offset:0
v_mfma_f32_32x32x16_bf16 v[32:47], a[48:51], v[16:19], v[32:47]
ds_read_b128 v[12:15], v64 offset:16384
s_add_u32 m0, s45, 0
s_add_u32 s55, s46, 0
buffer_load_dwordx4 v0, s[4:7], s55 offen offset:0 sc1 lds
buffer_load_dwordx4 v0, s[4:7], s55 offen offset:1024 sc1 lds
v_mfma_f32_32x32x16_bf16 v[32:47], a[52:55], v[20:23], v[32:47]
ds_read_b128 v[16:19], v64 offset:17408
buffer_load_dwordx4 v0, s[4:7], s55 offen offset:2048 sc1 lds
buffer_load_dwordx4 v0, s[4:7], s55 offen offset:3072 sc1 lds
v_mfma_f32_32x32x16_bf16 v[32:47], a[56:59], v[24:27], v[32:47]
s_waitcnt lgkmcnt(3)
ds_read_b128 v[20:23], v64 offset:18432
s_add_u32 m0, s45, 4096
s_add_u32 s55, s46, 4096
buffer_load_dwordx4 v0, s[4:7], s55 offen offset:0 sc1 lds
buffer_load_dwordx4 v0, s[4:7], s55 offen offset:1024 sc1 lds
v_mfma_f32_32x32x16_bf16 v[32:47], a[60:63], v[8:11], v[32:47]
s_waitcnt lgkmcnt(2)
ds_read_b128 v[24:27], v64 offset:19456
buffer_load_dwordx4 v0, s[4:7], s55 offen offset:2048 sc1 lds
buffer_load_dwordx4 v0, s[4:7], s55 offen offset:3072 sc1 lds
v_mfma_f32_32x32x16_bf16 v[32:47], a[64:67], v[12:15], v[32:47]
s_waitcnt lgkmcnt(2)
ds_read_b128 v[8:11], v64 offset:20480
s_add_u32 m0, s45, 8192
s_add_u32 s55, s46, 8192
buffer_load_dwordx4 v0, s[4:7], s55 offen offset:0 sc1 lds
buffer_load_dwordx4 v0, s[4:7], s55 offen offset:1024 sc1 lds
v_mfma_f32_32x32x16_bf16 v[32:47], a[68:71], v[16:19], v[32:47]
s_waitcnt lgkmcnt(2)
ds_read_b128 v[12:15], v64 offset:21504
s_add_u32 s45, s45, 40960
s_cmp_ge_u32 s45, 122880
s_cselect_b32 s55, 122880, 0
s_sub_u32 s45, s45, s55
s_add_u32 s46, s46, 40960
v_mfma_f32_32x32x16_bf16 v[32:47], a[72:75], v[20:23], v[32:47]
s_waitcnt lgkmcnt(2)
ds_read_b128 v[16:19], v64 offset:22528
v_mfma_f32_32x32x16_bf16 v[32:47], a[76:79], v[24:27], v[32:47]
s_waitcnt lgkmcnt(2)
ds_read_b128 v[20:23], v64 offset:23552
v_mfma_f32_32x32x16_bf16 v[32:47], a[80:83], v[8:11], v[32:47]
s_waitcnt lgkmcnt(2)
ds_read_b128 v[24:27], v64 offset:24576
v_mfma_f32_32x32x16_bf16 v[32:47], a[84:87], v[12:15], v[32:47]
s_waitcnt lgkmcnt(2)
ds_read_b128 v[8:11], v64 offset:25600
v_mfma_f32_32x32x16_bf16 v[32:47], a[88:91], v[16:19], v[32:47]
s_waitcnt lgkmcnt(2)
ds_read_b128 v[12:15], v64 offset:26624
v_mfma_f32_32x32x16_bf16 v[32:47], a[92:95], v[20:23], v[32:47]
s_waitcnt lgkmcnt(2)
ds_read_b128 v[16:19], v64 offset:27648
v_mfma_f32_32x32x16_bf16 v[32:47], a[96:99], v[24:27], v[32:47]
s_waitcnt lgkmcnt(2)
ds_read_b128 v[20:23], v64 offset:28672
v_mfma_f32_32x32x16_bf16 v[32:47], a[100:103], v[8:11], v[32:47]
s_waitcnt lgkmcnt(2)
ds_read_b128 v[24:27], v64 offset:29696
v_mfma_f32_32x32x16_bf16 v[32:47], a[104:107], v[12:15], v[32:47]
s_waitcnt lgkmcnt(2)
ds_read_b128 v[8:11], v64 offset:30720
v_mfma_f32_32x32x16_bf16 v[32:47], a[108:111], v[16:19], v[32:47]
s_waitcnt lgkmcnt(2)
ds_read_b128 v[12:15], v64 offset:31744
v_mfma_f32_32x32x16_bf16 v[32:47], a[112:115], v[20:23], v[32:47]
s_waitcnt lgkmcnt(2)
ds_read_b128 v[16:19], v64 offset:32768
v_mfma_f32_32x32x16_bf16 v[32:47], a[116:119], v[24:27], v[32:47]
s_waitcnt lgkmcnt(2)
ds_read_b128 v[20:23], v64 offset:33792
v_mfma_f32_32x32x16_bf16 v[32:47], a[120:123], v[8:11], v[32:47]
s_waitcnt lgkmcnt(2)
ds_read_b128 v[24:27], v64 offset:34816
v_mfma_f32_32x32x16_bf16 v[32:47], a[124:127], v[12:15], v[32:47]
s_waitcnt lgkmcnt(2)
ds_read_b128 v[8:11], v64 offset:35840
v_mfma_f32_32x32x16_bf16 v[32:47], a[128:131], v[16:19], v[32:47]
s_waitcnt lgkmcnt(2)
ds_read_b128 v[12:15], v64 offset:36864
v_mfma_f32_32x32x16_bf16 v[32:47], a[132:135], v[20:23], v[32:47]
s_waitcnt lgkmcnt(2)
ds_read_b128 v[16:19], v64 offset:37888
v_mfma_f32_32x32x16_bf16 v[32:47], a[136:139], v[24:27], v[32:47]
s_waitcnt lgkmcnt(2)
ds_read_b128 v[20:23], v64 offset:38912
v_mfma_f32_32x32x16_bf16 v[32:47], a[140:143], v[8:11], v[32:47]
s_waitcnt lgkmcnt(2)
ds_read_b128 v[24:27], v64 offset:39936
v_mfma_f32_32x32x16_bf16 v[32:47], a[144:147], v[12:15], v[32:47]
s_add_u32 s44, s44, 1
s_cmp_eq_u32 s44, 3
s_mov_b32 s56, 40960
s_cmov_b32 s56, -81920
s_cselect_b32 s44, 0, s44
v_add_u32 v64, s56, v64
v_add_u32 v5, s56, v5
s_waitcnt vmcnt(10) lgkmcnt(2)
s_barrier
ds_read_b128 v[8:11], v64 offset:0
v_mfma_f32_32x32x16_bf16 v[32:47], a[148:151], v[16:19], v[32:47]
s_waitcnt lgkmcnt(2)
ds_read_b128 v[12:15], v64 offset:1024
v_mfma_f32_32x32x16_bf16 v[32:47], a[152:155], v[20:23], v[32:47]
s_waitcnt lgkmcnt(2)
ds_read_b128 v[16:19], v64 offset:2048
v_mfma_f32_32x32x16_bf16 v[32:47], a[156:159], v[24:27], v[32:47]
s_waitcnt lgkmcnt(2)
ds_read_b128 v[20:23], v64 offset:3072
k_st_36:
v_mfma_f32_32x32x16_bf16 v[48:63], a[0:3], v[8:11], 0
s_waitcnt lgkmcnt(2)
ds_read_b128 v[24:27], v64 offset:4096
v_mfma_f32_32x32x16_bf16 v[48:63], a[4:7], v[12:15], v[48:63]
s_waitcnt lgkmcnt(2)
ds_read_b128 v[8:11], v64 offset:5120
ds_read_b128 v[80:83], v7 offset:0
ds_read_b128 v[84:87], v7 offset:16
v_mov_b32 v88, 0x3727c5ac
v_mfma_f32_32x32x16_bf16 v[48:63], a[8:11], v[16:19], v[48:63]
s_waitcnt lgkmcnt(4)
ds_read_b128 v[12:15], v64 offset:6144
s_waitcnt lgkmcnt(1)
v_add_f32 v80, v80, v84
v_add_f32 v81, v81, v85
v_add_f32 v82, v82, v86
v_add_f32 v83, v83, v87
v_add_f32 v80, v80, v81
v_add_f32 v82, v82, v83
v_add_f32 v80, v80, v82
v_mfma_f32_32x32x16_bf16 v[48:63], a[12:15], v[20:23], v[48:63]
ds_read_b128 v[16:19], v64 offset:7168
v_fma_f32 v80, v80, s61, v88
v_rsq_f32 v80, v80
s_nop 0
v_mul_f32 v32, v80, v32
v_mul_f32 v33, v80, v33
v_cvt_pk_bf16_f32 v32, v32, v33
v_mfma_f32_32x32x16_bf16 v[48:63], a[16:19], v[24:27], v[48:63]
ds_read_b128 v[20:23], v64 offset:8192
v_mul_f32 v34, v80, v34
v_mul_f32 v35, v80, v35
v_cvt_pk_bf16_f32 v33, v34, v35
v_mul_f32 v36, v80, v36
v_mul_f32 v37, v80, v37
v_cvt_pk_bf16_f32 v34, v36, v37
v_mfma_f32_32x32x16_bf16 v[48:63], a[20:23], v[8:11], v[48:63]
s_waitcnt lgkmcnt(2)
ds_read_b128 v[24:27], v64 offset:9216
v_mul_f32 v38, v80, v38
v_mul_f32 v39, v80, v39
v_cvt_pk_bf16_f32 v35, v38, v39
v_mul_f32 v40, v80, v40
v_mul_f32 v41, v80, v41
v_cvt_pk_bf16_f32 v36, v40, v41
v_mfma_f32_32x32x16_bf16 v[48:63], a[24:27], v[12:15], v[48:63]
s_waitcnt lgkmcnt(2)
ds_read_b128 v[8:11], v64 offset:10240
v_mul_f32 v42, v80, v42
v_mul_f32 v43, v80, v43
v_cvt_pk_bf16_f32 v37, v42, v43
v_mul_f32 v44, v80, v44
v_mul_f32 v45, v80, v45
v_cvt_pk_bf16_f32 v38, v44, v45
v_mfma_f32_32x32x16_bf16 v[48:63], a[28:31], v[16:19], v[48:63]
s_waitcnt lgkmcnt(2)
ds_read_b128 v[12:15], v64 offset:11264
v_mul_f32 v46, v80, v46
v_mul_f32 v47, v80, v47
v_cvt_pk_bf16_f32 v39, v46, v47
buffer_store_dwordx4 v[32:35], v1, s[4:7], s48 offen offset:0 sc1
v_mfma_f32_32x32x16_bf16 v[48:63], a[32:35], v[20:23], v[48:63]
s_waitcnt lgkmcnt(2)
ds_read_b128 v[16:19], v64 offset:12288
buffer_store_dwordx4 v[36:39], v1, s[4:7], s48 offen offset:512 sc1
s_add_u32 s48, s48, s49
v_mfma_f32_32x32x16_bf16 v[48:63], a[36:39], v[24:27], v[48:63]
s_waitcnt lgkmcnt(2)
ds_read_b128 v[20:23], v64 offset:13312
ds_read_b128 v[72:75], v5
v_mov_b32 v4, 0
ds_read_b128 v[76:79], v5 offset:1024
v_mfma_f32_32x32x16_bf16 v[48:63], a[40:43], v[8:11], v[48:63]
s_waitcnt lgkmcnt(4)
ds_read_b128 v[24:27], v64 offset:14336
s_waitcnt lgkmcnt(2)
v_and_b32 v72, v3, v72
v_dot2c_f32_bf16 v4, v72, v72
v_dot2c_f32_bf16 v4, v73, v73
v_dot2c_f32_bf16 v4, v74, v74
v_dot2c_f32_bf16 v4, v75, v75
v_mfma_f32_32x32x16_bf16 v[48:63], a[44:47], v[12:15], v[48:63]
ds_read_b128 v[8:11], v64 offset:15360
ds_read_b128 v[72:75], v5 offset:2048
s_waitcnt lgkmcnt(3)
v_dot2c_f32_bf16 v4, v76, v76
v_dot2c_f32_bf16 v4, v77, v77
v_dot2c_f32_bf16 v4, v78, v78
v_dot2c_f32_bf16 v4, v79, v79
v_mfma_f32_32x32x16_bf16 v[48:63], a[48:51], v[16:19], v[48:63]
ds_read_b128 v[12:15], v64 offset:16384
ds_read_b128 v[76:79], v5 offset:3072
s_waitcnt lgkmcnt(2)
v_dot2c_f32_bf16 v4, v72, v72
v_dot2c_f32_bf16 v4, v73, v73
v_dot2c_f32_bf16 v4, v74, v74
v_dot2c_f32_bf16 v4, v75, v75
v_mfma_f32_32x32x16_bf16 v[48:63], a[52:55], v[20:23], v[48:63]
ds_read_b128 v[16:19], v64 offset:17408
ds_read_b128 v[72:75], v5 offset:4096
s_waitcnt lgkmcnt(2)
v_dot2c_f32_bf16 v4, v76, v76
v_dot2c_f32_bf16 v4, v77, v77
v_dot2c_f32_bf16 v4, v78, v78
v_dot2c_f32_bf16 v4, v79, v79
v_mfma_f32_32x32x16_bf16 v[48:63], a[56:59], v[24:27], v[48:63]
ds_read_b128 v[20:23], v64 offset:18432
ds_read_b128 v[76:79], v5 offset:5120
s_waitcnt lgkmcnt(2)
v_dot2c_f32_bf16 v4, v72, v72
v_dot2c_f32_bf16 v4, v73, v73
v_dot2c_f32_bf16 v4, v74, v74
v_dot2c_f32_bf16 v4, v75, v75
v_mfma_f32_32x32x16_bf16 v[48:63], a[60:63], v[8:11], v[48:63]
ds_read_b128 v[24:27], v64 offset:19456
ds_read_b128 v[72:75], v5 offset:6144
s_waitcnt lgkmcnt(2)
v_dot2c_f32_bf16 v4, v76, v76
v_dot2c_f32_bf16 v4, v77, v77
v_dot2c_f32_bf16 v4, v78, v78
v_dot2c_f32_bf16 v4, v79, v79
v_mfma_f32_32x32x16_bf16 v[48:63], a[64:67], v[12:15], v[48:63]
ds_read_b128 v[8:11], v64 offset:20480
ds_read_b128 v[76:79], v5 offset:7168
s_waitcnt lgkmcnt(2)
v_dot2c_f32_bf16 v4, v72, v72
v_dot2c_f32_bf16 v4, v73, v73
v_dot2c_f32_bf16 v4, v74, v74
v_dot2c_f32_bf16 v4, v75, v75
v_mfma_f32_32x32x16_bf16 v[48:63], a[68:71], v[16:19], v[48:63]
ds_read_b128 v[12:15], v64 offset:21504
ds_read_b128 v[72:75], v5 offset:8192
s_waitcnt lgkmcnt(2)
v_dot2c_f32_bf16 v4, v76, v76
v_dot2c_f32_bf16 v4, v77, v77
v_dot2c_f32_bf16 v4, v78, v78
v_dot2c_f32_bf16 v4, v79, v79
v_mfma_f32_32x32x16_bf16 v[48:63], a[72:75], v[20:23], v[48:63]
ds_read_b128 v[16:19], v64 offset:22528
ds_read_b128 v[76:79], v5 offset:9216
s_waitcnt lgkmcnt(2)
v_dot2c_f32_bf16 v4, v72, v72
v_dot2c_f32_bf16 v4, v73, v73
v_dot2c_f32_bf16 v4, v74, v74
v_dot2c_f32_bf16 v4, v75, v75
v_mfma_f32_32x32x16_bf16 v[48:63], a[76:79], v[24:27], v[48:63]
ds_read_b128 v[20:23], v64 offset:23552
s_waitcnt lgkmcnt(1)
v_dot2c_f32_bf16 v4, v76, v76
v_dot2c_f32_bf16 v4, v77, v77
v_dot2c_f32_bf16 v4, v78, v78
v_dot2c_f32_bf16 v4, v79, v79
s_nop 2
ds_write_b32 v6, v4 offset:1024
v_mfma_f32_32x32x16_bf16 v[48:63], a[80:83], v[8:11], v[48:63]
ds_read_b128 v[24:27], v64 offset:24576
s_add_u32 m0, s45, 0
s_add_u32 s55, s46, 0
buffer_load_dwordx4 v0, s[4:7], s55 offen offset:0 sc1 lds
buffer_load_dwordx4 v0, s[4:7], s55 offen offset:1024 sc1 lds
v_mfma_f32_32x32x16_bf16 v[48:63], a[84:87], v[12:15], v[48:63]
ds_read_b128 v[8:11], v64 offset:25600
buffer_load_dwordx4 v0, s[4:7], s55 offen offset:2048 sc1 lds
buffer_load_dwordx4 v0, s[4:7], s55 offen offset:3072 sc1 lds
v_mfma_f32_32x32x16_bf16 v[48:63], a[88:91], v[16:19], v[48:63]
s_waitcnt lgkmcnt(3)
ds_read_b128 v[12:15], v64 offset:26624
s_add_u32 m0, s45, 4096
s_add_u32 s55, s46, 4096
buffer_load_dwordx4 v0, s[4:7], s55 offen offset:0 sc1 lds
buffer_load_dwordx4 v0, s[4:7], s55 offen offset:1024 sc1 lds
v_mfma_f32_32x32x16_bf16 v[48:63], a[92:95], v[20:23], v[48:63]
s_waitcnt lgkmcnt(2)
ds_read_b128 v[16:19], v64 offset:27648
buffer_load_dwordx4 v0, s[4:7], s55 offen offset:2048 sc1 lds
buffer_load_dwordx4 v0, s[4:7], s55 offen offset:3072 sc1 lds
v_mfma_f32_32x32x16_bf16 v[48:63], a[96:99], v[24:27], v[48:63]
s_waitcnt lgkmcnt(2)
ds_read_b128 v[20:23], v64 offset:28672
s_add_u32 m0, s45, 8192
s_add_u32 s55, s46, 8192
buffer_load_dwordx4 v0, s[4:7], s55 offen offset:0 sc1 lds
buffer_load_dwordx4 v0, s[4:7], s55 offen offset:1024 sc1 lds
v_mfma_f32_32x32x16_bf16 v[48:63], a[100:103], v[8:11], v[48:63]
s_waitcnt lgkmcnt(2)
ds_read_b128 v[24:27], v64 offset:29696
s_add_u32 s45, s45, 40960
s_cmp_ge_u32 s45, 122880
s_cselect_b32 s55, 122880, 0
s_sub_u32 s45, s45, s55
s_add_u32 s46, s46, 40960
v_mfma_f32_32x32x16_bf16 v[48:63], a[104:107], v[12:15], v[48:63]
s_waitcnt lgkmcnt(2)
ds_read_b128 v[8:11], v64 offset:30720
v_mfma_f32_32x32x16_bf16 v[48:63], a[108:111], v[16:19], v[48:63]
s_waitcnt lgkmcnt(2)
ds_read_b128 v[12:15], v64 offset:31744
v_mfma_f32_32x32x16_bf16 v[48:63], a[112:115], v[20:23], v[48:63]
s_waitcnt lgkmcnt(2)
ds_read_b128 v[16:19], v64 offset:32768
v_mfma_f32_32x32x16_bf16 v[48:63], a[116:119], v[24:27], v[48:63]
s_waitcnt lgkmcnt(2)
ds_read_b128 v[20:23], v64 offset:33792
v_mfma_f32_32x32x16_bf16 v[48:63], a[120:123], v[8:11], v[48:63]
s_waitcnt lgkmcnt(2)
ds_read_b128 v[24:27], v64 offset:34816
v_mfma_f32_32x32x16_bf16 v[48:63], a[124:127], v[12:15], v[48:63]
s_waitcnt lgkmcnt(2)
ds_read_b128 v[8:11], v64 offset:35840
v_mfma_f32_32x32x16_bf16 v[48:63], a[128:131], v[16:19], v[48:63]
s_waitcnt lgkmcnt(2)
ds_read_b128 v[12:15], v64 offset:36864
v_mfma_f32_32x32x16_bf16 v[48:63], a[132:135], v[20:23], v[48:63]
s_waitcnt lgkmcnt(2)
ds_read_b128 v[16:19], v64 offset:37888
v_mfma_f32_32x32x16_bf16 v[48:63], a[136:139], v[24:27], v[48:63]
s_waitcnt lgkmcnt(2)
ds_read_b128 v[20:23], v64 offset:38912
v_mfma_f32_32x32x16_bf16 v[48:63], a[140:143], v[8:11], v[48:63]
s_waitcnt lgkmcnt(2)
ds_read_b128 v[24:27], v64 offset:39936
v_mfma_f32_32x32x16_bf16 v[48:63], a[144:147], v[12:15], v[48:63]
s_add_u32 s44, s44, 1
s_cmp_eq_u32 s44, 3
s_mov_b32 s56, 40960
s_cmov_b32 s56, -81920
s_cselect_b32 s44, 0, s44
v_add_u32 v64, s56, v64
v_add_u32 v5, s56, v5
s_waitcnt vmcnt(10) lgkmcnt(2)
s_barrier
s_add_u32 s50, s50, 1
v_mov_b32 v4, s50
buffer_store_dword v4, v2, s[4:7], s60 offen sc1
ds_read_b128 v[8:11], v64 offset:0
v_mfma_f32_32x32x16_bf16 v[48:63], a[148:151], v[16:19], v[48:63]
s_waitcnt lgkmcnt(2)
ds_read_b128 v[12:15], v64 offset:1024
v_mfma_f32_32x32x16_bf16 v[48:63], a[152:155], v[20:23], v[48:63]
s_waitcnt lgkmcnt(2)
ds_read_b128 v[16:19], v64 offset:2048
v_mfma_f32_32x32x16_bf16 v[48:63], a[156:159], v[24:27], v[48:63]
s_waitcnt lgkmcnt(2)
ds_read_b128 v[20:23], v64 offset:3072
s_sub_u32 s59, s59, 1
s_cmp_eq_u32 s59, 0
s_cbranch_scc1 k_so_37
v_mfma_f32_32x32x16_bf16 v[32:47], a[0:3], v[8:11], 0
s_waitcnt lgkmcnt(2)
ds_read_b128 v[24:27], v64 offset:4096
v_mfma_f32_32x32x16_bf16 v[32:47], a[4:7], v[12:15], v[32:47]
s_waitcnt lgkmcnt(2)
ds_read_b128 v[8:11], v64 offset:5120
ds_read_b128 v[80:83], v7 offset:1024
ds_read_b128 v[84:87], v7 offset:1040
v_mov_b32 v88, 0x3727c5ac
v_mfma_f32_32x32x16_bf16 v[32:47], a[8:11], v[16:19], v[32:47]
s_waitcnt lgkmcnt(4)
ds_read_b128 v[12:15], v64 offset:6144
s_waitcnt lgkmcnt(1)
v_add_f32 v80, v80, v84
v_add_f32 v81, v81, v85
v_add_f32 v82, v82, v86
v_add_f32 v83, v83, v87
v_add_f32 v80, v80, v81
v_add_f32 v82, v82, v83
v_add_f32 v80, v80, v82
v_mfma_f32_32x32x16_bf16 v[32:47], a[12:15], v[20:23], v[32:47]
ds_read_b128 v[16:19], v64 offset:7168
v_fma_f32 v80, v80, s61, v88
v_rsq_f32 v80, v80
s_nop 0
v_mul_f32 v48, v80, v48
v_mul_f32 v49, v80, v49
v_cvt_pk_bf16_f32 v48, v48, v49
v_mfma_f32_32x32x16_bf16 v[32:47], a[16:19], v[24:27], v[32:47]
ds_read_b128 v[20:23], v64 offset:8192
v_mul_f32 v50, v80, v50
v_mul_f32 v51, v80, v51
v_cvt_pk_bf16_f32 v49, v50, v51
v_mul_f32 v52, v80, v52
v_mul_f32 v53, v80, v53
v_cvt_pk_bf16_f32 v50, v52, v53
v_mfma_f32_32x32x16_bf16 v[32:47], a[20:23], v[8:11], v[32:47]
s_waitcnt lgkmcnt(2)
ds_read_b128 v[24:27], v64 offset:9216
v_mul_f32 v54, v80, v54
v_mul_f32 v55, v80, v55
v_cvt_pk_bf16_f32 v51, v54, v55
v_mul_f32 v56, v80, v56
v_mul_f32 v57, v80, v57
v_cvt_pk_bf16_f32 v52, v56, v57
v_mfma_f32_32x32x16_bf16 v[32:47], a[24:27], v[12:15], v[32:47]
s_waitcnt lgkmcnt(2)
ds_read_b128 v[8:11], v64 offset:10240
v_mul_f32 v58, v80, v58
v_mul_f32 v59, v80, v59
v_cvt_pk_bf16_f32 v53, v58, v59
v_mul_f32 v60, v80, v60
v_mul_f32 v61, v80, v61
v_cvt_pk_bf16_f32 v54, v60, v61
v_mfma_f32_32x32x16_bf16 v[32:47], a[28:31], v[16:19], v[32:47]
s_waitcnt lgkmcnt(2)
ds_read_b128 v[12:15], v64 offset:11264
v_mul_f32 v62, v80, v62
v_mul_f32 v63, v80, v63
v_cvt_pk_bf16_f32 v55, v62, v63
buffer_store_dwordx4 v[48:51], v1, s[4:7], s48 offen offset:0 sc1
v_mfma_f32_32x32x16_bf16 v[32:47], a[32:35], v[20:23], v[32:47]
s_waitcnt lgkmcnt(2)
ds_read_b128 v[16:19], v64 offset:12288
buffer_store_dwordx4 v[52:55], v1, s[4:7], s48 offen offset:512 sc1
s_add_u32 s48, s48, s49
v_mfma_f32_32x32x16_bf16 v[32:47], a[36:39], v[24:27], v[32:47]
s_waitcnt lgkmcnt(2)
ds_read_b128 v[20:23], v64 offset:13312
ds_read_b128 v[72:75], v5
v_mov_b32 v4, 0
ds_read_b128 v[76:79], v5 offset:1024
v_mfma_f32_32x32x16_bf16 v[32:47], a[40:43], v[8:11], v[32:47]
s_waitcnt lgkmcnt(4)
ds_read_b128 v[24:27], v64 offset:14336
s_waitcnt lgkmcnt(2)
v_and_b32 v72, v3, v72
v_dot2c_f32_bf16 v4, v72, v72
v_dot2c_f32_bf16 v4, v73, v73
v_dot2c_f32_bf16 v4, v74, v74
v_dot2c_f32_bf16 v4, v75, v75
v_mfma_f32_32x32x16_bf16 v[32:47], a[44:47], v[12:15], v[32:47]
ds_read_b128 v[8:11], v64 offset:15360
ds_read_b128 v[72:75], v5 offset:2048
s_waitcnt lgkmcnt(3)
v_dot2c_f32_bf16 v4, v76, v76
v_dot2c_f32_bf16 v4, v77, v77
v_dot2c_f32_bf16 v4, v78, v78
v_dot2c_f32_bf16 v4, v79, v79
v_mfma_f32_32x32x16_bf16 v[32:47], a[48:51], v[16:19], v[32:47]
ds_read_b128 v[12:15], v64 offset:16384
ds_read_b128 v[76:79], v5 offset:3072
s_waitcnt lgkmcnt(2)
v_dot2c_f32_bf16 v4, v72, v72
v_dot2c_f32_bf16 v4, v73, v73
v_dot2c_f32_bf16 v4, v74, v74
v_dot2c_f32_bf16 v4, v75, v75
v_mfma_f32_32x32x16_bf16 v[32:47], a[52:55], v[20:23], v[32:47]
ds_read_b128 v[16:19], v64 offset:17408
ds_read_b128 v[72:75], v5 offset:4096
s_waitcnt lgkmcnt(2)
v_dot2c_f32_bf16 v4, v76, v76
v_dot2c_f32_bf16 v4, v77, v77
v_dot2c_f32_bf16 v4, v78, v78
v_dot2c_f32_bf16 v4, v79, v79
v_mfma_f32_32x32x16_bf16 v[32:47], a[56:59], v[24:27], v[32:47]
ds_read_b128 v[20:23], v64 offset:18432
ds_read_b128 v[76:79], v5 offset:5120
s_waitcnt lgkmcnt(2)
v_dot2c_f32_bf16 v4, v72, v72
v_dot2c_f32_bf16 v4, v73, v73
v_dot2c_f32_bf16 v4, v74, v74
v_dot2c_f32_bf16 v4, v75, v75
v_mfma_f32_32x32x16_bf16 v[32:47], a[60:63], v[8:11], v[32:47]
ds_read_b128 v[24:27], v64 offset:19456
ds_read_b128 v[72:75], v5 offset:6144
s_waitcnt lgkmcnt(2)
v_dot2c_f32_bf16 v4, v76, v76
v_dot2c_f32_bf16 v4, v77, v77
v_dot2c_f32_bf16 v4, v78, v78
v_dot2c_f32_bf16 v4, v79, v79
v_mfma_f32_32x32x16_bf16 v[32:47], a[64:67], v[12:15], v[32:47]
ds_read_b128 v[8:11], v64 offset:20480
ds_read_b128 v[76:79], v5 offset:7168
s_waitcnt lgkmcnt(2)
v_dot2c_f32_bf16 v4, v72, v72
v_dot2c_f32_bf16 v4, v73, v73
v_dot2c_f32_bf16 v4, v74, v74
v_dot2c_f32_bf16 v4, v75, v75
v_mfma_f32_32x32x16_bf16 v[32:47], a[68:71], v[16:19], v[32:47]
ds_read_b128 v[12:15], v64 offset:21504
ds_read_b128 v[72:75], v5 offset:8192
s_waitcnt lgkmcnt(2)
v_dot2c_f32_bf16 v4, v76, v76
v_dot2c_f32_bf16 v4, v77, v77
v_dot2c_f32_bf16 v4, v78, v78
v_dot2c_f32_bf16 v4, v79, v79
v_mfma_f32_32x32x16_bf16 v[32:47], a[72:75], v[20:23], v[32:47]
ds_read_b128 v[16:19], v64 offset:22528
ds_read_b128 v[76:79], v5 offset:9216
s_waitcnt lgkmcnt(2)
v_dot2c_f32_bf16 v4, v72, v72
v_dot2c_f32_bf16 v4, v73, v73
v_dot2c_f32_bf16 v4, v74, v74
v_dot2c_f32_bf16 v4, v75, v75
v_mfma_f32_32x32x16_bf16 v[32:47], a[76:79], v[24:27], v[32:47]
ds_read_b128 v[20:23], v64 offset:23552
s_waitcnt lgkmcnt(1)
v_dot2c_f32_bf16 v4, v76, v76
v_dot2c_f32_bf16 v4, v77, v77
v_dot2c_f32_bf16 v4, v78, v78
v_dot2c_f32_bf16 v4, v79, v79
s_nop 2
ds_write_b32 v6, v4 offset:0
v_mfma_f32_32x32x16_bf16 v[32:47], a[80:83], v[8:11], v[32:47]
ds_read_b128 v[24:27], v64 offset:24576
s_add_u32 m0, s45, 0
s_add_u32 s55, s46, 0
buffer_load_dwordx4 v0, s[4:7], s55 offen offset:0 sc1 lds
buffer_load_dwordx4 v0, s[4:7], s55 offen offset:1024 sc1 lds
v_mfma_f32_32x32x16_bf16 v[32:47], a[84:87], v[12:15], v[32:47]
ds_read_b128 v[8:11], v64 offset:25600
buffer_load_dwordx4 v0, s[4:7], s55 offen offset:2048 sc1 lds
buffer_load_dwordx4 v0, s[4:7], s55 offen offset:3072 sc1 lds
v_mfma_f32_32x32x16_bf16 v[32:47], a[88:91], v[16:19], v[32:47]
s_waitcnt lgkmcnt(3)
ds_read_b128 v[12:15], v64 offset:26624
s_add_u32 m0, s45, 4096
s_add_u32 s55, s46, 4096
buffer_load_dwordx4 v0, s[4:7], s55 offen offset:0 sc1 lds
buffer_load_dwordx4 v0, s[4:7], s55 offen offset:1024 sc1 lds
v_mfma_f32_32x32x16_bf16 v[32:47], a[92:95], v[20:23], v[32:47]
s_waitcnt lgkmcnt(2)
ds_read_b128 v[16:19], v64 offset:27648
buffer_load_dwordx4 v0, s[4:7], s55 offen offset:2048 sc1 lds
buffer_load_dwordx4 v0, s[4:7], s55 offen offset:3072 sc1 lds
v_mfma_f32_32x32x16_bf16 v[32:47], a[96:99], v[24:27], v[32:47]
s_waitcnt lgkmcnt(2)
ds_read_b128 v[20:23], v64 offset:28672
s_add_u32 m0, s45, 8192
s_add_u32 s55, s46, 8192
buffer_load_dwordx4 v0, s[4:7], s55 offen offset:0 sc1 lds
buffer_load_dwordx4 v0, s[4:7], s55 offen offset:1024 sc1 lds
v_mfma_f32_32x32x16_bf16 v[32:47], a[100:103], v[8:11], v[32:47]
s_waitcnt lgkmcnt(2)
ds_read_b128 v[24:27], v64 offset:29696
s_add_u32 s45, s45, 40960
s_cmp_ge_u32 s45, 122880
s_cselect_b32 s55, 122880, 0
s_sub_u32 s45, s45, s55
s_add_u32 s46, s46, 40960
v_mfma_f32_32x32x16_bf16 v[32:47], a[104:107], v[12:15], v[32:47]
s_waitcnt lgkmcnt(2)
ds_read_b128 v[8:11], v64 offset:30720
v_mfma_f32_32x32x16_bf16 v[32:47], a[108:111], v[16:19], v[32:47]
s_waitcnt lgkmcnt(2)
ds_read_b128 v[12:15], v64 offset:31744
v_mfma_f32_32x32x16_bf16 v[32:47], a[112:115], v[20:23], v[32:47]
s_waitcnt lgkmcnt(2)
ds_read_b128 v[16:19], v64 offset:32768
v_mfma_f32_32x32x16_bf16 v[32:47], a[116:119], v[24:27], v[32:47]
s_waitcnt lgkmcnt(2)
ds_read_b128 v[20:23], v64 offset:33792
v_mfma_f32_32x32x16_bf16 v[32:47], a[120:123], v[8:11], v[32:47]
s_waitcnt lgkmcnt(2)
ds_read_b128 v[24:27], v64 offset:34816
v_mfma_f32_32x32x16_bf16 v[32:47], a[124:127], v[12:15], v[32:47]
s_waitcnt lgkmcnt(2)
ds_read_b128 v[8:11], v64 offset:35840
v_mfma_f32_32x32x16_bf16 v[32:47], a[128:131], v[16:19], v[32:47]
s_waitcnt lgkmcnt(2)
ds_read_b128 v[12:15], v64 offset:36864
v_mfma_f32_32x32x16_bf16 v[32:47], a[132:135], v[20:23], v[32:47]
s_waitcnt lgkmcnt(2)
ds_read_b128 v[16:19], v64 offset:37888
v_mfma_f32_32x32x16_bf16 v[32:47], a[136:139], v[24:27], v[32:47]
s_waitcnt lgkmcnt(2)
ds_read_b128 v[20:23], v64 offset:38912
v_mfma_f32_32x32x16_bf16 v[32:47], a[140:143], v[8:11], v[32:47]
s_waitcnt lgkmcnt(2)
ds_read_b128 v[24:27], v64 offset:39936
v_mfma_f32_32x32x16_bf16 v[32:47], a[144:147], v[12:15], v[32:47]
s_add_u32 s44, s44, 1
s_cmp_eq_u32 s44, 3
s_mov_b32 s56, 40960
s_cmov_b32 s56, -81920
s_cselect_b32 s44, 0, s44
v_add_u32 v64, s56, v64
v_add_u32 v5, s56, v5
s_waitcnt vmcnt(10) lgkmcnt(2)
s_barrier
s_add_u32 s50, s50, 1
v_mov_b32 v4, s50
buffer_store_dword v4, v2, s[4:7], s60 offen sc1
ds_read_b128 v[8:11], v64 offset:0
v_mfma_f32_32x32x16_bf16 v[32:47], a[148:151], v[16:19], v[32:47]
s_waitcnt lgkmcnt(2)
ds_read_b128 v[12:15], v64 offset:1024
v_mfma_f32_32x32x16_bf16 v[32:47], a[152:155], v[20:23], v[32:47]
s_waitcnt lgkmcnt(2)
ds_read_b128 v[16:19], v64 offset:2048
v_mfma_f32_32x32x16_bf16 v[32:47], a[156:159], v[24:27], v[32:47]
s_waitcnt lgkmcnt(2)
ds_read_b128 v[20:23], v64 offset:3072
s_branch k_st_36
k_so_37:
ds_read_b128 v[80:83], v7 offset:1024
ds_read_b128 v[84:87], v7 offset:1040
v_mov_b32 v88, 0x3727c5ac
s_waitcnt lgkmcnt(0)
v_add_f32 v80, v80, v84
v_add_f32 v81, v81, v85
v_add_f32 v82, v82, v86
v_add_f32 v83, v83, v87
v_add_f32 v80, v80, v81
v_add_f32 v82, v82, v83
v_add_f32 v80, v80, v82
v_fma_f32 v80, v80, s61, v88
v_rsq_f32 v80, v80
s_nop 0
v_mul_f32 v48, v80, v48
v_mul_f32 v49, v80, v49
v_cvt_pk_bf16_f32 v48, v48, v49
v_mul_f32 v50, v80, v50
v_mul_f32 v51, v80, v51
v_cvt_pk_bf16_f32 v49, v50, v51
v_mul_f32 v52, v80, v52
v_mul_f32 v53, v80, v53
v_cvt_pk_bf16_f32 v50, v52, v53
v_mul_f32 v54, v80, v54
v_mul_f32 v55, v80, v55
v_cvt_pk_bf16_f32 v51, v54, v55
v_mul_f32 v56, v80, v56
v_mul_f32 v57, v80, v57
v_cvt_pk_bf16_f32 v52, v56, v57
v_mul_f32 v58, v80, v58
v_mul_f32 v59, v80, v59
v_cvt_pk_bf16_f32 v53, v58, v59
v_mul_f32 v60, v80, v60
v_mul_f32 v61, v80, v61
v_cvt_pk_bf16_f32 v54, v60, v61
v_mul_f32 v62, v80, v62
v_mul_f32 v63, v80, v63
v_cvt_pk_bf16_f32 v55, v62, v63
buffer_store_dwordx4 v[48:51], v1, s[4:7], s48 offen offset:0 sc1
buffer_store_dwordx4 v[52:55], v1, s[4:7], s48 offen offset:512 sc1
s_add_u32 s48, s48, s49
s_branch k_join_33
k_isv_32:
s_mul_i32 s45, s3, 10240
s_mov_b32 s44, 0
v_mov_b32 v64, v0
s_add_u32 m0, s45, 0
s_add_u32 s55, s46, 0
buffer_load_dwordx4 v0, s[4:7], s55 offen offset:0 sc1 lds
buffer_load_dwordx4 v0, s[4:7], s55 offen offset:1024 sc1 lds
buffer_load_dwordx4 v0, s[4:7], s55 offen offset:2048 sc1 lds
buffer_load_dwordx4 v0, s[4:7], s55 offen offset:3072 sc1 lds
s_add_u32 m0, s45, 4096
s_add_u32 s55, s46, 4096
buffer_load_dwordx4 v0, s[4:7], s55 offen offset:0 sc1 lds
buffer_load_dwordx4 v0, s[4:7], s55 offen offset:1024 sc1 lds
buffer_load_dwordx4 v0, s[4:7], s55 offen offset:2048 sc1 lds
buffer_load_dwordx4 v0, s[4:7], s55 offen offset:3072 sc1 lds
s_add_u32 m0, s45, 8192
s_add_u32 s55, s46, 8192
buffer_load_dwordx4 v0, s[4:7], s55 offen offset:0 sc1 lds
buffer_load_dwordx4 v0, s[4:7], s55 offen offset:1024 sc1 lds
s_add_u32 s45, s45, 40960
s_cmp_ge_u32 s45, 122880
s_cselect_b32 s55, 122880, 0
s_sub_u32 s45, s45, s55
s_add_u32 s46, s46, 40960
s_add_u32 m0, s45, 0
s_add_u32 s55, s46, 0
buffer_load_dwordx4 v0, s[4:7], s55 offen offset:0 sc1 lds
buffer_load_dwordx4 v0, s[4:7], s55 offen offset:1024 sc1 lds
buffer_load_dwordx4 v0, s[4:7], s55 offen offset:2048 sc1 lds
buffer_load_dwordx4 v0, s[4:7], s55 offen offset:3072 sc1 lds
s_add_u32 m0, s45, 4096
s_add_u32 s55, s46, 4096
buffer_load_dwordx4 v0, s[4:7], s55 offen offset:0 sc1 lds
buffer_load_dwordx4 v0, s[4:7], s55 offen offset:1024 sc1 lds
buffer_load_dwordx4 v0, s[4:7], s55 offen offset:2048 sc1 lds
buffer_load_dwordx4 v0, s[4:7], s55 offen offset:3072 sc1 lds
s_add_u32 m0, s45, 8192
s_add_u32 s55, s46, 8192
buffer_load_dwordx4 v0, s[4:7], s55 offen offset:0 sc1 lds
buffer_load_dwordx4 v0, s[4:7], s55 offen offset:1024 sc1 lds
s_add_u32 s45, s45, 40960
s_cmp_ge_u32 s45, 122880
s_cselect_b32 s55, 122880, 0
s_sub_u32 s45, s45, s55
s_add_u32 s46, s46, 40960
s_waitcnt vmcnt(10)
s_barrier
ds_read_b128 v[8:11], v64 offset:0
ds_read_b128 v[12:15], v64 offset:1024
ds_read_b128 v[16:19], v64 offset:2048
ds_read_b128 v[20:23], v64 offset:3072
s_mov_b32 s59, 32
s_waitcnt lgkmcnt(3)
v_mfma_f32_32x32x16_bf16 v[32:47], v[8:11], a[0:3], 0
s_waitcnt lgkmcnt(2)
ds_read_b128 v[24:27], v64 offset:4096
v_mfma_f32_32x32x16_bf16 v[32:47], v[12:15], a[4:7], v[32:47]
s_waitcnt lgkmcnt(2)
ds_read_b128 v[8:11], v64 offset:5120
ds_read_b128 v[72:75], v5
v_mov_b32 v4, 0
ds_read_b128 v[76:79], v5 offset:1024
v_mfma_f32_32x32x16_bf16 v[32:47], v[16:19], a[8:11], v[32:47]
s_waitcnt lgkmcnt(4)
ds_read_b128 v[12:15], v64 offset:6144
s_waitcnt lgkmcnt(2)
v_and_b32 v72, v3, v72
v_dot2c_f32_bf16 v4, v72, v72
v_dot2c_f32_bf16 v4, v73, v73
v_dot2c_f32_bf16 v4, v74, v74
v_dot2c_f32_bf16 v4, v75, v75
v_mfma_f32_32x32x16_bf16 v[32:47], v[20:23], a[12:15], v[32:47]
ds_read_b128 v[16:19], v64 offset:7168
ds_read_b128 v[72:75], v5 offset:2048
s_waitcnt lgkmcnt(3)
v_dot2c_f32_bf16 v4, v76, v76
v_dot2c_f32_bf16 v4, v77, v77
v_dot2c_f32_bf16 v4, v78, v78
v_dot2c_f32_bf16 v4, v79, v79
v_mfma_f32_32x32x16_bf16 v[32:47], v[24:27], a[16:19], v[32:47]
ds_read_b128 v[20:23], v64 offset:8192
ds_read_b128 v[76:79], v5 offset:3072
s_waitcnt lgkmcnt(2)
v_dot2c_f32_bf16 v4, v72, v72
v_dot2c_f32_bf16 v4, v73, v73
v_dot2c_f32_bf16 v4, v74, v74
v_dot2c_f32_bf16 v4, v75, v75
v_mfma_f32_32x32x16_bf16 v[32:47], v[8:11], a[20:23], v[32:47]
ds_read_b128 v[24:27], v64 offset:9216
ds_read_b128 v[72:75], v5 offset:4096
s_waitcnt lgkmcnt(2)
v_dot2c_f32_bf16 v4, v76, v76
v_dot2c_f32_bf16 v4, v77, v77
v_dot2c_f32_bf16 v4, v78, v78
v_dot2c_f32_bf16 v4, v79, v79
v_mfma_f32_32x32x16_bf16 v[32:47], v[12:15], a[24:27], v[32:47]
ds_read_b128 v[8:11], v64 offset:10240
ds_read_b128 v[76:79], v5 offset:5120
s_waitcnt lgkmcnt(2)
v_dot2c_f32_bf16 v4, v72, v72
v_dot2c_f32_bf16 v4, v73, v73
v_dot2c_f32_bf16 v4, v74, v74
v_dot2c_f32_bf16 v4, v75, v75
v_mfma_f32_32x32x16_bf16 v[32:47], v[16:19], a[28:31], v[32:47]
ds_read_b128 v[12:15], v64 offset:11264
ds_read_b128 v[72:75], v5 offset:6144
s_waitcnt lgkmcnt(2)
v_dot2c_f32_bf16 v4, v76, v76
v_dot2c_f32_bf16 v4, v77, v77
v_dot2c_f32_bf16 v4, v78, v78
v_dot2c_f32_bf16 v4, v79, v79
v_mfma_f32_32x32x16_bf16 v[32:47], v[20:23], a[32:35], v[32:47]
ds_read_b128 v[16:19], v64 offset:12288
ds_read_b128 v[76:79], v5 offset:7168
s_waitcnt lgkmcnt(2)
v_dot2c_f32_bf16 v4, v72, v72
v_dot2c_f32_bf16 v4, v73, v73
v_dot2c_f32_bf16 v4, v74, v74
v_dot2c_f32_bf16 v4, v75, v75
v_mfma_f32_32x32x16_bf16 v[32:47], v[24:27], a[36:39], v[32:47]
ds_read_b128 v[20:23], v64 offset:13312
ds_read_b128 v[72:75], v5 offset:8192
s_waitcnt lgkmcnt(2)
v_dot2c_f32_bf16 v4, v76, v76
v_dot2c_f32_bf16 v4, v77, v77
v_dot2c_f32_bf16 v4, v78, v78
v_dot2c_f32_bf16 v4, v79, v79
v_mfma_f32_32x32x16_bf16 v[32:47], v[8:11], a[40:43], v[32:47]
ds_read_b128 v[24:27], v64 offset:14336
ds_read_b128 v[76:79], v5 offset:9216
s_waitcnt lgkmcnt(2)
v_dot2c_f32_bf16 v4, v72, v72
v_dot2c_f32_bf16 v4, v73, v73
v_dot2c_f32_bf16 v4, v74, v74
v_dot2c_f32_bf16 v4, v75, v75
v_mfma_f32_32x32x16_bf16 v[32:47], v[12:15], a[44:47], v[32:47]
ds_read_b128 v[8:11], v64 offset:15360
s_waitcnt lgkmcnt(1)
v_dot2c_f32_bf16 v4, v76, v76
v_dot2c_f32_bf16 v4, v77, v77
v_dot2c_f32_bf16 v4, v78, v78
v_dot2c_f32_bf16 v4, v79, v79
s_nop 2
ds_write_b32 v6, v4 offset:0
v_mfma_f32_32x32x16_bf16 v[32:47], v[16:19], a[48:51], v[32:47]
ds_read_b128 v[12:15], v64 offset:16384
s_add_u32 m0, s45, 0
s_add_u32 s55, s46, 0
buffer_load_dwordx4 v0, s[4:7], s55 offen offset:0 sc1 lds
buffer_load_dwordx4 v0, s[4:7], s55 offen offset:1024 sc1 lds
v_mfma_f32_32x32x16_bf16 v[32:47], v[20:23], a[52:55], v[32:47]
ds_read_b128 v[16:19], v64 offset:17408
buffer_load_dwordx4 v0, s[4:7], s55 offen offset:2048 sc1 lds
buffer_load_dwordx4 v0, s[4:7], s55 offen offset:3072 sc1 lds
v_mfma_f32_32x32x16_bf16 v[32:47], v[24:27], a[56:59], v[32:47]
s_waitcnt lgkmcnt(3)
ds_read_b128 v[20:23], v64 offset:18432
s_add_u32 m0, s45, 4096
s_add_u32 s55, s46, 4096
buffer_load_dwordx4 v0, s[4:7], s55 offen offset:0 sc1 lds
buffer_load_dwordx4 v0, s[4:7], s55 offen offset:1024 sc1 lds
v_mfma_f32_32x32x16_bf16 v[32:47], v[8:11], a[60:63], v[32:47]
s_waitcnt lgkmcnt(2)
ds_read_b128 v[24:27], v64 offset:19456
buffer_load_dwordx4 v0, s[4:7], s55 offen offset:2048 sc1 lds
buffer_load_dwordx4 v0, s[4:7], s55 offen offset:3072 sc1 lds
v_mfma_f32_32x32x16_bf16 v[32:47], v[12:15], a[64:67], v[32:47]
s_waitcnt lgkmcnt(2)
ds_read_b128 v[8:11], v64 offset:20480
s_add_u32 m0, s45, 8192
s_add_u32 s55, s46, 8192
buffer_load_dwordx4 v0, s[4:7], s55 offen offset:0 sc1 lds
buffer_load_dwordx4 v0, s[4:7], s55 offen offset:1024 sc1 lds
v_mfma_f32_32x32x16_bf16 v[32:47], v[16:19], a[68:71], v[32:47]
s_waitcnt lgkmcnt(2)
ds_read_b128 v[12:15], v64 offset:21504
s_add_u32 s45, s45, 40960
s_cmp_ge_u32 s45, 122880
s_cselect_b32 s55, 122880, 0
s_sub_u32 s45, s45, s55
s_add_u32 s46, s46, 40960
v_mfma_f32_32x32x16_bf16 v[32:47], v[20:23], a[72:75], v[32:47]
s_waitcnt lgkmcnt(2)
ds_read_b128 v[16:19], v64 offset:22528
v_mfma_f32_32x32x16_bf16 v[32:47], v[24:27], a[76:79], v[32:47]
s_waitcnt lgkmcnt(2)
ds_read_b128 v[20:23], v64 offset:23552
v_mfma_f32_32x32x16_bf16 v[32:47], v[8:11], a[80:83], v[32:47]
s_waitcnt lgkmcnt(2)
ds_read_b128 v[24:27], v64 offset:24576
v_mfma_f32_32x32x16_bf16 v[32:47], v[12:15], a[84:87], v[32:47]
s_waitcnt lgkmcnt(2)
ds_read_b128 v[8:11], v64 offset:25600
v_mfma_f32_32x32x16_bf16 v[32:47], v[16:19], a[88:91], v[32:47]
s_waitcnt lgkmcnt(2)
ds_read_b128 v[12:15], v64 offset:26624
v_mfma_f32_32x32x16_bf16 v[32:47], v[20:23], a[92:95], v[32:47]
s_waitcnt lgkmcnt(2)
ds_read_b128 v[16:19], v64 offset:27648
v_mfma_f32_32x32x16_bf16 v[32:47], v[24:27], a[96:99], v[32:47]
s_waitcnt lgkmcnt(2)
ds_read_b128 v[20:23], v64 offset:28672
v_mfma_f32_32x32x16_bf16 v[32:47], v[8:11], a[100:103], v[32:47]
s_waitcnt lgkmcnt(2)
ds_read_b128 v[24:27], v64 offset:29696
v_mfma_f32_32x32x16_bf16 v[32:47], v[12:15], a[104:107], v[32:47]
s_waitcnt lgkmcnt(2)
ds_read_b128 v[8:11], v64 offset:30720
v_mfma_f32_32x32x16_bf16 v[32:47], v[16:19], a[108:111], v[32:47]
s_waitcnt lgkmcnt(2)
ds_read_b128 v[12:15], v64 offset:31744
v_mfma_f32_32x32x16_bf16 v[32:47], v[20:23], a[112:115], v[32:47]
s_waitcnt lgkmcnt(2)
ds_read_b128 v[16:19], v64 offset:32768
v_mfma_f32_32x32x16_bf16 v[32:47], v[24:27], a[116:119], v[32:47]
s_waitcnt lgkmcnt(2)
ds_read_b128 v[20:23], v64 offset:33792
v_mfma_f32_32x32x16_bf16 v[32:47], v[8:11], a[120:123], v[32:47]
s_waitcnt lgkmcnt(2)
ds_read_b128 v[24:27], v64 offset:34816
v_mfma_f32_32x32x16_bf16 v[32:47], v[12:15], a[124:127], v[32:47]
s_waitcnt lgkmcnt(2)
ds_read_b128 v[8:11], v64 offset:35840
v_mfma_f32_32x32x16_bf16 v[32:47], v[16:19], a[128:131], v[32:47]
s_waitcnt lgkmcnt(2)
ds_read_b128 v[12:15], v64 offset:36864
v_mfma_f32_32x32x16_bf16 v[32:47], v[20:23], a[132:135], v[32:47]
s_waitcnt lgkmcnt(2)
ds_read_b128 v[16:19], v64 offset:37888
v_mfma_f32_32x32x16_bf16 v[32:47], v[24:27], a[136:139], v[32:47]
s_waitcnt lgkmcnt(2)
ds_read_b128 v[20:23], v64 offset:38912
v_mfma_f32_32x32x16_bf16 v[32:47], v[8:11], a[140:143], v[32:47]
s_waitcnt lgkmcnt(2)
ds_read_b128 v[24:27], v64 offset:39936
v_mfma_f32_32x32x16_bf16 v[32:47], v[12:15], a[144:147], v[32:47]
s_add_u32 s44, s44, 1
s_cmp_eq_u32 s44, 3
s_mov_b32 s56, 40960
s_cmov_b32 s56, -81920
s_cselect_b32 s44, 0, s44
v_add_u32 v64, s56, v64
v_add_u32 v5, s56, v5
s_waitcnt vmcnt(10) lgkmcnt(2)
s_barrier
ds_read_b128 v[8:11], v64 offset:0
v_mfma_f32_32x32x16_bf16 v[32:47], v[16:19], a[148:151], v[32:47]
s_waitcnt lgkmcnt(2)
ds_read_b128 v[12:15], v64 offset:1024
v_mfma_f32_32x32x16_bf16 v[32:47], v[20:23], a[152:155], v[32:47]
s_waitcnt lgkmcnt(2)
ds_read_b128 v[16:19], v64 offset:2048
v_mfma_f32_32x32x16_bf16 v[32:47], v[24:27], a[156:159], v[32:47]
s_waitcnt lgkmcnt(2)
ds_read_b128 v[20:23], v64 offset:3072
k_st_38:
v_mfma_f32_32x32x16_bf16 v[48:63], v[8:11], a[0:3], 0
s_waitcnt lgkmcnt(2)
ds_read_b128 v[24:27], v64 offset:4096
v_mfma_f32_32x32x16_bf16 v[48:63], v[12:15], a[4:7], v[48:63]
s_waitcnt lgkmcnt(2)
ds_read_b128 v[8:11], v64 offset:5120
ds_read_b128 v[80:83], v7 offset:0
ds_read_b128 v[84:87], v7 offset:16
v_mov_b32 v88, 0x3727c5ac
v_mfma_f32_32x32x16_bf16 v[48:63], v[16:19], a[8:11], v[48:63]
s_waitcnt lgkmcnt(4)
ds_read_b128 v[12:15], v64 offset:6144
s_waitcnt lgkmcnt(1)
v_add_f32 v80, v80, v84
v_add_f32 v81, v81, v85
v_add_f32 v82, v82, v86
v_add_f32 v83, v83, v87
v_add_f32 v80, v80, v81
v_add_f32 v82, v82, v83
v_add_f32 v80, v80, v82
v_mfma_f32_32x32x16_bf16 v[48:63], v[20:23], a[12:15], v[48:63]
ds_read_b128 v[16:19], v64 offset:7168
v_fma_f32 v80, v80, s61, v88
v_rsq_f32 v80, v80
ds_write_b32 v28, v80
v_mfma_f32_32x32x16_bf16 v[48:63], v[24:27], a[16:19], v[48:63]
ds_read_b128 v[20:23], v64 offset:8192
ds_read_b128 v[80:83], v29 offset:0
ds_read_b128 v[84:87], v29 offset:32
ds_read_b128 v[88:91], v29 offset:64
ds_read_b128 v[92:95], v29 offset:96
v_mfma_f32_32x32x16_bf16 v[48:63], v[8:11], a[20:23], v[48:63]
s_waitcnt lgkmcnt(7)
ds_read_b128 v[24:27], v64 offset:9216
s_waitcnt lgkmcnt(4)
v_mul_f32 v80, v80, v32
v_mul_f32 v81, v81, v33
v_mul_f32 v82, v82, v34
v_mul_f32 v83, v83, v35
v_mfma_f32_32x32x16_bf16 v[48:63], v[12:15], a[24:27], v[48:63]
ds_read_b128 v[8:11], v64 offset:10240
s_waitcnt lgkmcnt(4)
v_mul_f32 v84, v84, v36
v_mul_f32 v85, v85, v37
v_mul_f32 v86, v86, v38
v_mul_f32 v87, v87, v39
v_mfma_f32_32x32x16_bf16 v[48:63], v[16:19], a[28:31], v[48:63]
ds_read_b128 v[12:15], v64 offset:11264
s_waitcnt lgkmcnt(4)
v_mul_f32 v88, v88, v40
v_mul_f32 v89, v89, v41
v_mul_f32 v90, v90, v42
v_mul_f32 v91, v91, v43
v_mfma_f32_32x32x16_bf16 v[48:63], v[20:23], a[32:35], v[48:63]
s_waitcnt lgkmcnt(2)
ds_read_b128 v[16:19], v64 offset:12288
v_mul_f32 v92, v92, v44
v_mul_f32 v93, v93, v45
v_mul_f32 v94, v94, v46
v_mul_f32 v95, v95, v47
v_mfma_f32_32x32x16_bf16 v[48:63], v[24:27], a[36:39], v[48:63]
s_waitcnt lgkmcnt(2)
ds_read_b128 v[20:23], v64 offset:13312
v_cvt_pk_bf16_f32 v32, v80, v81
v_cvt_pk_bf16_f32 v33, v82, v83
v_mfma_f32_32x32x16_bf16 v[48:63], v[8:11], a[40:43], v[48:63]
s_waitcnt lgkmcnt(2)
ds_read_b128 v[24:27], v64 offset:14336
v_cvt_pk_bf16_f32 v36, v84, v85
v_cvt_pk_bf16_f32 v37, v86, v87
v_mfma_f32_32x32x16_bf16 v[48:63], v[12:15], a[44:47], v[48:63]
s_waitcnt lgkmcnt(2)
ds_read_b128 v[8:11], v64 offset:15360
v_cvt_pk_bf16_f32 v34, v88, v89
v_cvt_pk_bf16_f32 v35, v90, v91
v_mfma_f32_32x32x16_bf16 v[48:63], v[16:19], a[48:51], v[48:63]
s_waitcnt lgkmcnt(2)
ds_read_b128 v[12:15], v64 offset:16384
v_cvt_pk_bf16_f32 v38, v92, v93
v_cvt_pk_bf16_f32 v39, v94, v95
v_mfma_f32_32x32x16_bf16 v[48:63], v[20:23], a[52:55], v[48:63]
s_waitcnt lgkmcnt(2)
ds_read_b128 v[16:19], v64 offset:17408
buffer_store_dwordx4 v[32:35], v1, s[4:7], s48 offen offset:2048 sc1
buffer_store_dwordx4 v[36:39], v1, s[4:7], s48 offen offset:2560 sc1
v_mfma_f32_32x32x16_bf16 v[48:63], v[24:27], a[56:59], v[48:63]
s_waitcnt lgkmcnt(2)
ds_read_b128 v[20:23], v64 offset:18432
s_add_u32 s48, s48, s49
ds_read_b128 v[72:75], v5
v_mov_b32 v4, 0
v_mfma_f32_32x32x16_bf16 v[48:63], v[8:11], a[60:63], v[48:63]
s_waitcnt lgkmcnt(3)
ds_read_b128 v[24:27], v64 offset:19456
ds_read_b128 v[76:79], v5 offset:1024
s_waitcnt lgkmcnt(2)
v_and_b32 v72, v3, v72
v_mfma_f32_32x32x16_bf16 v[48:63], v[12:15], a[64:67], v[48:63]
ds_read_b128 v[8:11], v64 offset:20480
v_dot2c_f32_bf16 v4, v72, v72
v_dot2c_f32_bf16 v4, v73, v73
v_dot2c_f32_bf16 v4, v74, v74
v_dot2c_f32_bf16 v4, v75, v75
ds_read_b128 v[72:75], v5 offset:2048
v_mfma_f32_32x32x16_bf16 v[48:63], v[16:19], a[68:71], v[48:63]
ds_read_b128 v[12:15], v64 offset:21504
s_waitcnt lgkmcnt(3)
v_dot2c_f32_bf16 v4, v76, v76
v_dot2c_f32_bf16 v4, v77, v77
v_dot2c_f32_bf16 v4, v78, v78
v_dot2c_f32_bf16 v4, v79, v79
ds_read_b128 v[76:79], v5 offset:3072
v_mfma_f32_32x32x16_bf16 v[48:63], v[20:23], a[72:75], v[48:63]
ds_read_b128 v[16:19], v64 offset:22528
s_waitcnt lgkmcnt(3)
v_dot2c_f32_bf16 v4, v72, v72
v_dot2c_f32_bf16 v4, v73, v73
v_dot2c_f32_bf16 v4, v74, v74
v_dot2c_f32_bf16 v4, v75, v75
ds_read_b128 v[72:75], v5 offset:4096
v_mfma_f32_32x32x16_bf16 v[48:63], v[24:27], a[76:79], v[48:63]
ds_read_b128 v[20:23], v64 offset:23552
s_waitcnt lgkmcnt(3)
v_dot2c_f32_bf16 v4, v76, v76
v_dot2c_f32_bf16 v4, v77, v77
v_dot2c_f32_bf16 v4, v78, v78
v_dot2c_f32_bf16 v4, v79, v79
ds_read_b128 v[76:79], v5 offset:5120
v_mfma_f32_32x32x16_bf16 v[48:63], v[8:11], a[80:83], v[48:63]
ds_read_b128 v[24:27], v64 offset:24576
s_waitcnt lgkmcnt(3)
v_dot2c_f32_bf16 v4, v72, v72
v_dot2c_f32_bf16 v4, v73, v73
v_dot2c_f32_bf16 v4, v74, v74
v_dot2c_f32_bf16 v4, v75, v75
ds_read_b128 v[72:75], v5 offset:6144
v_mfma_f32_32x32x16_bf16 v[48:63], v[12:15], a[84:87], v[48:63]
ds_read_b128 v[8:11], v64 offset:25600
s_waitcnt lgkmcnt(3)
v_dot2c_f32_bf16 v4, v76, v76
v_dot2c_f32_bf16 v4, v77, v77
v_dot2c_f32_bf16 v4, v78, v78
v_dot2c_f32_bf16 v4, v79, v79
ds_read_b128 v[76:79], v5 offset:7168
v_mfma_f32_32x32x16_bf16 v[48:63], v[16:19], a[88:91], v[48:63]
ds_read_b128 v[12:15], v64 offset:26624
s_waitcnt lgkmcnt(3)
v_dot2c_f32_bf16 v4, v72, v72
v_dot2c_f32_bf16 v4, v73, v73
v_dot2c_f32_bf16 v4, v74, v74
v_dot2c_f32_bf16 v4, v75, v75
ds_read_b128 v[72:75], v5 offset:8192
v_mfma_f32_32x32x16_bf16 v[48:63], v[20:23], a[92:95], v[48:63]
ds_read_b128 v[16:19], v64 offset:27648
s_waitcnt lgkmcnt(3)
v_dot2c_f32_bf16 v4, v76, v76
v_dot2c_f32_bf16 v4, v77, v77
v_dot2c_f32_bf16 v4, v78, v78
v_dot2c_f32_bf16 v4, v79, v79
ds_read_b128 v[76:79], v5 offset:9216
v_mfma_f32_32x32x16_bf16 v[48:63], v[24:27], a[96:99], v[48:63]
ds_read_b128 v[20:23], v64 offset:28672
s_waitcnt lgkmcnt(3)
v_dot2c_f32_bf16 v4, v72, v72
v_dot2c_f32_bf16 v4, v73, v73
v_dot2c_f32_bf16 v4, v74, v74
v_dot2c_f32_bf16 v4, v75, v75
s_waitcnt lgkmcnt(1)
v_dot2c_f32_bf16 v4, v76, v76
v_dot2c_f32_bf16 v4, v77, v77
v_dot2c_f32_bf16 v4, v78, v78
v_dot2c_f32_bf16 v4, v79, v79
v_mfma_f32_32x32x16_bf16 v[48:63], v[8:11], a[100:103], v[48:63]
ds_read_b128 v[24:27], v64 offset:29696
s_nop 0
ds_write_b32 v6, v4 offset:1024
s_add_u32 m0, s45, 0
s_add_u32 s55, s46, 0
buffer_load_dwordx4 v0, s[4:7], s55 offen offset:0 sc1 lds
v_mfma_f32_32x32x16_bf16 v[48:63], v[12:15], a[104:107], v[48:63]
ds_read_b128 v[8:11], v64 offset:30720
buffer_load_dwordx4 v0, s[4:7], s55 offen offset:1024 sc1 lds
buffer_load_dwordx4 v0, s[4:7], s55 offen offset:2048 sc1 lds
v_mfma_f32_32x32x16_bf16 v[48:63], v[16:19], a[108:111], v[48:63]
s_waitcnt lgkmcnt(3)
ds_read_b128 v[12:15], v64 offset:31744
buffer_load_dwordx4 v0, s[4:7], s55 offen offset:3072 sc1 lds
s_add_u32 m0, s45, 4096
s_add_u32 s55, s46, 4096
buffer_load_dwordx4 v0, s[4:7], s55 offen offset:0 sc1 lds
v_mfma_f32_32x32x16_bf16 v[48:63], v[20:23], a[112:115], v[48:63]
s_waitcnt lgkmcnt(3)
ds_read_b128 v[16:19], v64 offset:32768
buffer_load_dwordx4 v0, s[4:7], s55 offen offset:1024 sc1 lds
buffer_load_dwordx4 v0, s[4:7], s55 offen offset:2048 sc1 lds
v_mfma_f32_32x32x16_bf16 v[48:63], v[24:27], a[116:119], v[48:63]
s_waitcnt lgkmcnt(2)
ds_read_b128 v[20:23], v64 offset:33792
buffer_load_dwordx4 v0, s[4:7], s55 offen offset:3072 sc1 lds
s_add_u32 m0, s45, 8192
s_add_u32 s55, s46, 8192
buffer_load_dwordx4 v0, s[4:7], s55 offen offset:0 sc1 lds
v_mfma_f32_32x32x16_bf16 v[48:63], v[8:11], a[120:123], v[48:63]
s_waitcnt lgkmcnt(2)
ds_read_b128 v[24:27], v64 offset:34816
buffer_load_dwordx4 v0, s[4:7], s55 offen offset:1024 sc1 lds
s_add_u32 s45, s45, 40960
s_cmp_ge_u32 s45, 122880
s_cselect_b32 s55, 122880, 0
s_sub_u32 s45, s45, s55
v_mfma_f32_32x32x16_bf16 v[48:63], v[12:15], a[124:127], v[48:63]
s_waitcnt lgkmcnt(2)
ds_read_b128 v[8:11], v64 offset:35840
s_add_u32 s46, s46, 40960
v_mfma_f32_32x32x16_bf16 v[48:63], v[16:19], a[128:131], v[48:63]
s_waitcnt lgkmcnt(2)
ds_read_b128 v[12:15], v64 offset:36864
v_mfma_f32_32x32x16_bf16 v[48:63], v[20:23], a[132:135], v[48:63]
s_waitcnt lgkmcnt(2)
ds_read_b128 v[16:19], v64 offset:37888
v_mfma_f32_32x32x16_bf16 v[48:63], v[24:27], a[136:139], v[48:63]
s_waitcnt lgkmcnt(2)
ds_read_b128 v[20:23], v64 offset:38912
v_mfma_f32_32x32x16_bf16 v[48:63], v[8:11], a[140:143], v[48:63]
s_waitcnt lgkmcnt(2)
ds_read_b128 v[24:27], v64 offset:39936
v_mfma_f32_32x32x16_bf16 v[48:63], v[12:15], a[144:147], v[48:63]
s_add_u32 s44, s44, 1
s_cmp_eq_u32 s44, 3
s_mov_b32 s56, 40960
s_cmov_b32 s56, -81920
s_cselect_b32 s44, 0, s44
v_add_u32 v64, s56, v64
v_add_u32 v5, s56, v5
s_waitcnt vmcnt(10) lgkmcnt(2)
s_barrier
s_add_u32 s50, s50, 1
v_mov_b32 v4, s50
buffer_store_dword v4, v2, s[4:7], s60 offen sc1
ds_read_b128 v[8:11], v64 offset:0
v_mfma_f32_32x32x16_bf16 v[48:63], v[16:19], a[148:151], v[48:63]
s_waitcnt lgkmcnt(2)
ds_read_b128 v[12:15], v64 offset:1024
v_mfma_f32_32x32x16_bf16 v[48:63], v[20:23], a[152:155], v[48:63]
s_waitcnt lgkmcnt(2)
ds_read_b128 v[16:19], v64 offset:2048
v_mfma_f32_32x32x16_bf16 v[48:63], v[24:27], a[156:159], v[48:63]
s_waitcnt lgkmcnt(2)
ds_read_b128 v[20:23], v64 offset:3072
s_sub_u32 s59, s59, 1
s_cmp_eq_u32 s59, 0
s_cbranch_scc1 k_so_39
v_mfma_f32_32x32x16_bf16 v[32:47], v[8:11], a[0:3], 0
s_waitcnt lgkmcnt(2)
ds_read_b128 v[24:27], v64 offset:4096
v_mfma_f32_32x32x16_bf16 v[32:47], v[12:15], a[4:7], v[32:47]
s_waitcnt lgkmcnt(2)
ds_read_b128 v[8:11], v64 offset:5120
ds_read_b128 v[80:83], v7 offset:1024
ds_read_b128 v[84:87], v7 offset:1040
v_mov_b32 v88, 0x3727c5ac
v_mfma_f32_32x32x16_bf16 v[32:47], v[16:19], a[8:11], v[32:47]
s_waitcnt lgkmcnt(4)
ds_read_b128 v[12:15], v64 offset:6144
s_waitcnt lgkmcnt(1)
v_add_f32 v80, v80, v84
v_add_f32 v81, v81, v85
v_add_f32 v82, v82, v86
v_add_f32 v83, v83, v87
v_add_f32 v80, v80, v81
v_add_f32 v82, v82, v83
v_add_f32 v80, v80, v82
v_mfma_f32_32x32x16_bf16 v[32:47], v[20:23], a[12:15], v[32:47]
ds_read_b128 v[16:19], v64 offset:7168
v_fma_f32 v80, v80, s61, v88
v_rsq_f32 v80, v80
ds_write_b32 v28, v80
v_mfma_f32_32x32x16_bf16 v[32:47], v[24:27], a[16:19], v[32:47]
ds_read_b128 v[20:23], v64 offset:8192
ds_read_b128 v[80:83], v29 offset:0
ds_read_b128 v[84:87], v29 offset:32
ds_read_b128 v[88:91], v29 offset:64
ds_read_b128 v[92:95], v29 offset:96
v_mfma_f32_32x32x16_bf16 v[32:47], v[8:11], a[20:23], v[32:47]
s_waitcnt lgkmcnt(7)
ds_read_b128 v[24:27], v64 offset:9216
s_waitcnt lgkmcnt(4)
v_mul_f32 v80, v80, v48
v_mul_f32 v81, v81, v49
v_mul_f32 v82, v82, v50
v_mul_f32 v83, v83, v51
v_mfma_f32_32x32x16_bf16 v[32:47], v[12:15], a[24:27], v[32:47]
ds_read_b128 v[8:11], v64 offset:10240
s_waitcnt lgkmcnt(4)
v_mul_f32 v84, v84, v52
v_mul_f32 v85, v85, v53
v_mul_f32 v86, v86, v54
v_mul_f32 v87, v87, v55
v_mfma_f32_32x32x16_bf16 v[32:47], v[16:19], a[28:31], v[32:47]
ds_read_b128 v[12:15], v64 offset:11264
s_waitcnt lgkmcnt(4)
v_mul_f32 v88, v88, v56
v_mul_f32 v89, v89, v57
v_mul_f32 v90, v90, v58
v_mul_f32 v91, v91, v59
v_mfma_f32_32x32x16_bf16 v[32:47], v[20:23], a[32:35], v[32:47]
s_waitcnt lgkmcnt(2)
ds_read_b128 v[16:19], v64 offset:12288
v_mul_f32 v92, v92, v60
v_mul_f32 v93, v93, v61
v_mul_f32 v94, v94, v62
v_mul_f32 v95, v95, v63
v_mfma_f32_32x32x16_bf16 v[32:47], v[24:27], a[36:39], v[32:47]
s_waitcnt lgkmcnt(2)
ds_read_b128 v[20:23], v64 offset:13312
v_cvt_pk_bf16_f32 v48, v80, v81
v_cvt_pk_bf16_f32 v49, v82, v83
v_mfma_f32_32x32x16_bf16 v[32:47], v[8:11], a[40:43], v[32:47]
s_waitcnt lgkmcnt(2)
ds_read_b128 v[24:27], v64 offset:14336
v_cvt_pk_bf16_f32 v52, v84, v85
v_cvt_pk_bf16_f32 v53, v86, v87
v_mfma_f32_32x32x16_bf16 v[32:47], v[12:15], a[44:47], v[32:47]
s_waitcnt lgkmcnt(2)
ds_read_b128 v[8:11], v64 offset:15360
v_cvt_pk_bf16_f32 v50, v88, v89
v_cvt_pk_bf16_f32 v51, v90, v91
v_mfma_f32_32x32x16_bf16 v[32:47], v[16:19], a[48:51], v[32:47]
s_waitcnt lgkmcnt(2)
ds_read_b128 v[12:15], v64 offset:16384
v_cvt_pk_bf16_f32 v54, v92, v93
v_cvt_pk_bf16_f32 v55, v94, v95
v_mfma_f32_32x32x16_bf16 v[32:47], v[20:23], a[52:55], v[32:47]
s_waitcnt lgkmcnt(2)
ds_read_b128 v[16:19], v64 offset:17408
buffer_store_dwordx4 v[48:51], v1, s[4:7], s48 offen offset:2048 sc1
buffer_store_dwordx4 v[52:55], v1, s[4:7], s48 offen offset:2560 sc1
v_mfma_f32_32x32x16_bf16 v[32:47], v[24:27], a[56:59], v[32:47]
s_waitcnt lgkmcnt(2)
ds_read_b128 v[20:23], v64 offset:18432
s_add_u32 s48, s48, s49
ds_read_b128 v[72:75], v5
v_mov_b32 v4, 0
v_mfma_f32_32x32x16_bf16 v[32:47], v[8:11], a[60:63], v[32:47]
s_waitcnt lgkmcnt(3)
ds_read_b128 v[24:27], v64 offset:19456
ds_read_b128 v[76:79], v5 offset:1024
s_waitcnt lgkmcnt(2)
v_and_b32 v72, v3, v72
v_mfma_f32_32x32x16_bf16 v[32:47], v[12:15], a[64:67], v[32:47]
ds_read_b128 v[8:11], v64 offset:20480
v_dot2c_f32_bf16 v4, v72, v72
v_dot2c_f32_bf16 v4, v73, v73
v_dot2c_f32_bf16 v4, v74, v74
v_dot2c_f32_bf16 v4, v75, v75
ds_read_b128 v[72:75], v5 offset:2048
v_mfma_f32_32x32x16_bf16 v[32:47], v[16:19], a[68:71], v[32:47]
ds_read_b128 v[12:15], v64 offset:21504
s_waitcnt lgkmcnt(3)
v_dot2c_f32_bf16 v4, v76, v76
v_dot2c_f32_bf16 v4, v77, v77
v_dot2c_f32_bf16 v4, v78, v78
v_dot2c_f32_bf16 v4, v79, v79
ds_read_b128 v[76:79], v5 offset:3072
v_mfma_f32_32x32x16_bf16 v[32:47], v[20:23], a[72:75], v[32:47]
ds_read_b128 v[16:19], v64 offset:22528
s_waitcnt lgkmcnt(3)
v_dot2c_f32_bf16 v4, v72, v72
v_dot2c_f32_bf16 v4, v73, v73
v_dot2c_f32_bf16 v4, v74, v74
v_dot2c_f32_bf16 v4, v75, v75
ds_read_b128 v[72:75], v5 offset:4096
v_mfma_f32_32x32x16_bf16 v[32:47], v[24:27], a[76:79], v[32:47]
ds_read_b128 v[20:23], v64 offset:23552
s_waitcnt lgkmcnt(3)
v_dot2c_f32_bf16 v4, v76, v76
v_dot2c_f32_bf16 v4, v77, v77
v_dot2c_f32_bf16 v4, v78, v78
v_dot2c_f32_bf16 v4, v79, v79
ds_read_b128 v[76:79], v5 offset:5120
v_mfma_f32_32x32x16_bf16 v[32:47], v[8:11], a[80:83], v[32:47]
ds_read_b128 v[24:27], v64 offset:24576
s_waitcnt lgkmcnt(3)
v_dot2c_f32_bf16 v4, v72, v72
v_dot2c_f32_bf16 v4, v73, v73
v_dot2c_f32_bf16 v4, v74, v74
v_dot2c_f32_bf16 v4, v75, v75
ds_read_b128 v[72:75], v5 offset:6144
v_mfma_f32_32x32x16_bf16 v[32:47], v[12:15], a[84:87], v[32:47]
ds_read_b128 v[8:11], v64 offset:25600
s_waitcnt lgkmcnt(3)
v_dot2c_f32_bf16 v4, v76, v76
v_dot2c_f32_bf16 v4, v77, v77
v_dot2c_f32_bf16 v4, v78, v78
v_dot2c_f32_bf16 v4, v79, v79
ds_read_b128 v[76:79], v5 offset:7168
v_mfma_f32_32x32x16_bf16 v[32:47], v[16:19], a[88:91], v[32:47]
ds_read_b128 v[12:15], v64 offset:26624
s_waitcnt lgkmcnt(3)
v_dot2c_f32_bf16 v4, v72, v72
v_dot2c_f32_bf16 v4, v73, v73
v_dot2c_f32_bf16 v4, v74, v74
v_dot2c_f32_bf16 v4, v75, v75
ds_read_b128 v[72:75], v5 offset:8192
v_mfma_f32_32x32x16_bf16 v[32:47], v[20:23], a[92:95], v[32:47]
ds_read_b128 v[16:19], v64 offset:27648
s_waitcnt lgkmcnt(3)
v_dot2c_f32_bf16 v4, v76, v76
v_dot2c_f32_bf16 v4, v77, v77
v_dot2c_f32_bf16 v4, v78, v78
v_dot2c_f32_bf16 v4, v79, v79
ds_read_b128 v[76:79], v5 offset:9216
v_mfma_f32_32x32x16_bf16 v[32:47], v[24:27], a[96:99], v[32:47]
ds_read_b128 v[20:23], v64 offset:28672
s_waitcnt lgkmcnt(3)
v_dot2c_f32_bf16 v4, v72, v72
v_dot2c_f32_bf16 v4, v73, v73
v_dot2c_f32_bf16 v4, v74, v74
v_dot2c_f32_bf16 v4, v75, v75
s_waitcnt lgkmcnt(1)
v_dot2c_f32_bf16 v4, v76, v76
v_dot2c_f32_bf16 v4, v77, v77
v_dot2c_f32_bf16 v4, v78, v78
v_dot2c_f32_bf16 v4, v79, v79
v_mfma_f32_32x32x16_bf16 v[32:47], v[8:11], a[100:103], v[32:47]
ds_read_b128 v[24:27], v64 offset:29696
s_nop 0
ds_write_b32 v6, v4 offset:0
s_add_u32 m0, s45, 0
s_add_u32 s55, s46, 0
buffer_load_dwordx4 v0, s[4:7], s55 offen offset:0 sc1 lds
v_mfma_f32_32x32x16_bf16 v[32:47], v[12:15], a[104:107], v[32:47]
ds_read_b128 v[8:11], v64 offset:30720
buffer_load_dwordx4 v0, s[4:7], s55 offen offset:1024 sc1 lds
buffer_load_dwordx4 v0, s[4:7], s55 offen offset:2048 sc1 lds
v_mfma_f32_32x32x16_bf16 v[32:47], v[16:19], a[108:111], v[32:47]
s_waitcnt lgkmcnt(3)
ds_read_b128 v[12:15], v64 offset:31744
buffer_load_dwordx4 v0, s[4:7], s55 offen offset:3072 sc1 lds
s_add_u32 m0, s45, 4096
s_add_u32 s55, s46, 4096
buffer_load_dwordx4 v0, s[4:7], s55 offen offset:0 sc1 lds
v_mfma_f32_32x32x16_bf16 v[32:47], v[20:23], a[112:115], v[32:47]
s_waitcnt lgkmcnt(3)
ds_read_b128 v[16:19], v64 offset:32768
buffer_load_dwordx4 v0, s[4:7], s55 offen offset:1024 sc1 lds
buffer_load_dwordx4 v0, s[4:7], s55 offen offset:2048 sc1 lds
v_mfma_f32_32x32x16_bf16 v[32:47], v[24:27], a[116:119], v[32:47]
s_waitcnt lgkmcnt(2)
ds_read_b128 v[20:23], v64 offset:33792
buffer_load_dwordx4 v0, s[4:7], s55 offen offset:3072 sc1 lds
s_add_u32 m0, s45, 8192
s_add_u32 s55, s46, 8192
buffer_load_dwordx4 v0, s[4:7], s55 offen offset:0 sc1 lds
v_mfma_f32_32x32x16_bf16 v[32:47], v[8:11], a[120:123], v[32:47]
s_waitcnt lgkmcnt(2)
ds_read_b128 v[24:27], v64 offset:34816
buffer_load_dwordx4 v0, s[4:7], s55 offen offset:1024 sc1 lds
s_add_u32 s45, s45, 40960
s_cmp_ge_u32 s45, 122880
s_cselect_b32 s55, 122880, 0
s_sub_u32 s45, s45, s55
v_mfma_f32_32x32x16_bf16 v[32:47], v[12:15], a[124:127], v[32:47]
s_waitcnt lgkmcnt(2)
ds_read_b128 v[8:11], v64 offset:35840
s_add_u32 s46, s46, 40960
v_mfma_f32_32x32x16_bf16 v[32:47], v[16:19], a[128:131], v[32:47]
s_waitcnt lgkmcnt(2)
ds_read_b128 v[12:15], v64 offset:36864
v_mfma_f32_32x32x16_bf16 v[32:47], v[20:23], a[132:135], v[32:47]
s_waitcnt lgkmcnt(2)
ds_read_b128 v[16:19], v64 offset:37888
v_mfma_f32_32x32x16_bf16 v[32:47], v[24:27], a[136:139], v[32:47]
s_waitcnt lgkmcnt(2)
ds_read_b128 v[20:23], v64 offset:38912
v_mfma_f32_32x32x16_bf16 v[32:47], v[8:11], a[140:143], v[32:47]
s_waitcnt lgkmcnt(2)
ds_read_b128 v[24:27], v64 offset:39936
v_mfma_f32_32x32x16_bf16 v[32:47], v[12:15], a[144:147], v[32:47]
s_add_u32 s44, s44, 1
s_cmp_eq_u32 s44, 3
s_mov_b32 s56, 40960
s_cmov_b32 s56, -81920
s_cselect_b32 s44, 0, s44
v_add_u32 v64, s56, v64
v_add_u32 v5, s56, v5
s_waitcnt vmcnt(10) lgkmcnt(2)
s_barrier
s_add_u32 s50, s50, 1
v_mov_b32 v4, s50
buffer_store_dword v4, v2, s[4:7], s60 offen sc1
ds_read_b128 v[8:11], v64 offset:0
v_mfma_f32_32x32x16_bf16 v[32:47], v[16:19], a[148:151], v[32:47]
s_waitcnt lgkmcnt(2)
ds_read_b128 v[12:15], v64 offset:1024
v_mfma_f32_32x32x16_bf16 v[32:47], v[20:23], a[152:155], v[32:47]
s_waitcnt lgkmcnt(2)
ds_read_b128 v[16:19], v64 offset:2048
v_mfma_f32_32x32x16_bf16 v[32:47], v[24:27], a[156:159], v[32:47]
s_waitcnt lgkmcnt(2)
ds_read_b128 v[20:23], v64 offset:3072
s_branch k_st_38
k_so_39:
ds_read_b128 v[80:83], v7 offset:1024
ds_read_b128 v[84:87], v7 offset:1040
v_mov_b32 v88, 0x3727c5ac
s_waitcnt lgkmcnt(0)
v_add_f32 v80, v80, v84
v_add_f32 v81, v81, v85
v_add_f32 v82, v82, v86
v_add_f32 v83, v83, v87
v_add_f32 v80, v80, v81
v_add_f32 v82, v82, v83
v_add_f32 v80, v80, v82
v_fma_f32 v80, v80, s61, v88
v_rsq_f32 v80, v80
ds_write_b32 v28, v80
ds_read_b128 v[80:83], v29 offset:0
ds_read_b128 v[84:87], v29 offset:32
ds_read_b128 v[88:91], v29 offset:64
ds_read_b128 v[92:95], v29 offset:96
s_waitcnt lgkmcnt(3)
v_mul_f32 v80, v80, v48
v_mul_f32 v81, v81, v49
v_mul_f32 v82, v82, v50
v_mul_f32 v83, v83, v51
s_waitcnt lgkmcnt(2)
v_mul_f32 v84, v84, v52
v_mul_f32 v85, v85, v53
v_mul_f32 v86, v86, v54
v_mul_f32 v87, v87, v55
s_waitcnt lgkmcnt(1)
v_mul_f32 v88, v88, v56
v_mul_f32 v89, v89, v57
v_mul_f32 v90, v90, v58
v_mul_f32 v91, v91, v59
s_waitcnt lgkmcnt(0)
v_mul_f32 v92, v92, v60
v_mul_f32 v93, v93, v61
v_mul_f32 v94, v94, v62
v_mul_f32 v95, v95, v63
v_cvt_pk_bf16_f32 v48, v80, v81
v_cvt_pk_bf16_f32 v49, v82, v83
v_cvt_pk_bf16_f32 v52, v84, v85
v_cvt_pk_bf16_f32 v53, v86, v87
v_cvt_pk_bf16_f32 v50, v88, v89
v_cvt_pk_bf16_f32 v51, v90, v91
v_cvt_pk_bf16_f32 v54, v92, v93
v_cvt_pk_bf16_f32 v55, v94, v95
buffer_store_dwordx4 v[48:51], v1, s[4:7], s48 offen offset:2048 sc1
buffer_store_dwordx4 v[52:55], v1, s[4:7], s48 offen offset:2560 sc1
s_add_u32 s48, s48, s49
k_join_33:
s_waitcnt vmcnt(0) lgkmcnt(0)
s_barrier
s_add_u32 s50, s50, 1
v_mov_b32 v4, s50
buffer_store_dword v4, v2, s[4:7], s60 offen sc1
s_cmp_ge_u32 s30, 80
s_cbranch_scc1 k_fend_40
v_bfe_u32 v8, v0, 4, 5
v_lshrrev_b32 v9, 9, v0
s_lshl_b32 s52, s30, 2
s_add_u32 s52, s52, s3
s_cmp_eq_u32 s52, 0
s_cselect_b32 s47, 0xffff, -1
s_cselect_b32 s53, 0x30000, 0
s_cmov_b32 s52, 320
v_add_u32 v26, s53, v0
s_cmp_lg_u32 s51, 0
s_cbranch_scc1 k_fnog_41
s_load_dwordx2 s[36:37], s[0:1], 64
s_mov_b32 s38, 1314816
s_mov_b32 s39, 0x20000
s_load_dwordx2 s[40:41], s[0:1], 72
s_mov_b32 s42, 1314816
s_mov_b32 s43, 0x20000
v_lshl_add_u32 v20, v9, 8, v8
v_mul_u32_u24 v20, 642, v20
s_lshl_b32 s52, s52, 1
v_add_u32 v22, s52, v20
s_waitcnt lgkmcnt(0)
s_mov_b32 s53, 0
buffer_load_ushort v192, v22, s[36:39], s53 offen
buffer_load_ushort v208, v22, s[40:43], s53 offen
s_mov_b32 s53, 41088
buffer_load_ushort v193, v22, s[36:39], s53 offen
buffer_load_ushort v209, v22, s[40:43], s53 offen
s_mov_b32 s53, 82176
buffer_load_ushort v194, v22, s[36:39], s53 offen
buffer_load_ushort v210, v22, s[40:43], s53 offen
s_mov_b32 s53, 123264
buffer_load_ushort v195, v22, s[36:39], s53 offen
buffer_load_ushort v211, v22, s[40:43], s53 offen
s_mov_b32 s53, 328704
buffer_load_ushort v196, v22, s[36:39], s53 offen
buffer_load_ushort v212, v22, s[40:43], s53 offen
s_mov_b32 s53, 369792
buffer_load_ushort v197, v22, s[36:39], s53 offen
buffer_load_ushort v213, v22, s[40:43], s53 offen
s_mov_b32 s53, 410880
buffer_load_ushort v198, v22, s[36:39], s53 offen
buffer_load_ushort v214, v22, s[40:43], s53 offen
s_mov_b32 s53, 451968
buffer_load_ushort v199, v22, s[36:39], s53 offen
buffer_load_ushort v215, v22, s[40:43], s53 offen
s_mov_b32 s53, 657408
buffer_load_ushort v200, v22, s[36:39], s53 offen
buffer_load_ushort v216, v22, s[40:43], s53 offen
s_mov_b32 s53, 698496
buffer_load_ushort v201, v22, s[36:39], s53 offen
buffer_load_ushort v217, v22, s[40:43], s53 offen
s_mov_b32 s53, 739584
buffer_load_ushort v202, v22, s[36:39], s53 offen
buffer_load_ushort v218, v22, s[40:43], s53 offen
s_mov_b32 s53, 780672
buffer_load_ushort v203, v22, s[36:39], s53 offen
buffer_load_ushort v219, v22, s[40:43], s53 offen
s_mov_b32 s53, 986112
buffer_load_ushort v204, v22, s[36:39], s53 offen
buffer_load_ushort v220, v22, s[40:43], s53 offen
s_mov_b32 s53, 1027200
buffer_load_ushort v205, v22, s[36:39], s53 offen
buffer_load_ushort v221, v22, s[40:43], s53 offen
s_mov_b32 s53, 1068288
buffer_load_ushort v206, v22, s[36:39], s53 offen
buffer_load_ushort v222, v22, s[40:43], s53 offen
s_mov_b32 s53, 1109376
buffer_load_ushort v207, v22, s[36:39], s53 offen
buffer_load_ushort v223, v22, s[40:43], s53 offen
s_mov_b32 s53, 20544
buffer_load_ushort v224, v22, s[36:39], s53 offen
buffer_load_ushort v240, v22, s[40:43], s53 offen
s_mov_b32 s53, 61632
buffer_load_ushort v225, v22, s[36:39], s53 offen
buffer_load_ushort v241, v22, s[40:43], s53 offen
s_mov_b32 s53, 102720
buffer_load_ushort v226, v22, s[36:39], s53 offen
buffer_load_ushort v242, v22, s[40:43], s53 offen
s_mov_b32 s53, 143808
buffer_load_ushort v227, v22, s[36:39], s53 offen
buffer_load_ushort v243, v22, s[40:43], s53 offen
s_mov_b32 s53, 349248
buffer_load_ushort v228, v22, s[36:39], s53 offen
buffer_load_ushort v244, v22, s[40:43], s53 offen
s_mov_b32 s53, 390336
buffer_load_ushort v229, v22, s[36:39], s53 offen
buffer_load_ushort v245, v22, s[40:43], s53 offen
s_mov_b32 s53, 431424
buffer_load_ushort v230, v22, s[36:39], s53 offen
buffer_load_ushort v246, v22, s[40:43], s53 offen
s_mov_b32 s53, 472512
buffer_load_ushort v231, v22, s[36:39], s53 offen
buffer_load_ushort v247, v22, s[40:43], s53 offen
s_mov_b32 s53, 677952
buffer_load_ushort v232, v22, s[36:39], s53 offen
buffer_load_ushort v248, v22, s[40:43], s53 offen
s_mov_b32 s53, 719040
buffer_load_ushort v233, v22, s[36:39], s53 offen
buffer_load_ushort v249, v22, s[40:43], s53 offen
s_mov_b32 s53, 760128
buffer_load_ushort v234, v22, s[36:39], s53 offen
buffer_load_ushort v250, v22, s[40:43], s53 offen
s_mov_b32 s53, 801216
buffer_load_ushort v235, v22, s[36:39], s53 offen
buffer_load_ushort v251, v22, s[40:43], s53 offen
s_mov_b32 s53, 1006656
buffer_load_ushort v236, v22, s[36:39], s53 offen
buffer_load_ushort v252, v22, s[40:43], s53 offen
s_mov_b32 s53, 1047744
buffer_load_ushort v237, v22, s[36:39], s53 offen
buffer_load_ushort v253, v22, s[40:43], s53 offen
s_mov_b32 s53, 1088832
buffer_load_ushort v238, v22, s[36:39], s53 offen
buffer_load_ushort v254, v22, s[40:43], s53 offen
s_mov_b32 s53, 1129920
buffer_load_ushort v239, v22, s[36:39], s53 offen
buffer_load_ushort v255, v22, s[40:43], s53 offen
v_lshl_add_u32 v10, v9, 2, 0
v_mul_u32_u24 v10, v10, v8
v_and_b32 v20, 31, v10
v_cvt_f32_u32 v20, v20
v_mul_f32 v20, 0x3d000000, v20
v_sin_f32 v21, v20
v_cos_f32 v20, v20
v_add_u32 v10, v8, v10
v_cvt_pk_bf16_f32 v32, v20, v21
v_cvt_pk_bf16_f32 v36, -v21, v20
v_and_b32 v20, 31, v10
v_cvt_f32_u32 v20, v20
v_mul_f32 v20, 0x3d000000, v20
v_sin_f32 v21, v20
v_cos_f32 v20, v20
v_add_u32 v10, v8, v10
v_cvt_pk_bf16_f32 v33, v20, v21
v_cvt_pk_bf16_f32 v37, -v21, v20
v_and_b32 v20, 31, v10
v_cvt_f32_u32 v20, v20
v_mul_f32 v20, 0x3d000000, v20
v_sin_f32 v21, v20
v_cos_f32 v20, v20
v_add_u32 v10, v8, v10
v_cvt_pk_bf16_f32 v34, v20, v21
v_cvt_pk_bf16_f32 v38, -v21, v20
v_and_b32 v20, 31, v10
v_cvt_f32_u32 v20, v20
v_mul_f32 v20, 0x3d000000, v20
v_sin_f32 v21, v20
v_cos_f32 v20, v20
v_add_u32 v10, v8, v10
v_cvt_pk_bf16_f32 v35, v20, v21
v_cvt_pk_bf16_f32 v39, -v21, v20
v_accvgpr_write_b32 a160, v32
v_accvgpr_write_b32 a161, v33
v_accvgpr_write_b32 a162, v34
v_accvgpr_write_b32 a163, v35
v_accvgpr_write_b32 a164, v36
v_accvgpr_write_b32 a165, v37
v_accvgpr_write_b32 a166, v38
v_accvgpr_write_b32 a167, v39
v_lshl_add_u32 v10, v9, 2, 8
v_mul_u32_u24 v10, v10, v8
v_and_b32 v20, 31, v10
v_cvt_f32_u32 v20, v20
v_mul_f32 v20, 0x3d000000, v20
v_sin_f32 v21, v20
v_cos_f32 v20, v20
v_add_u32 v10, v8, v10
v_cvt_pk_bf16_f32 v32, v20, v21
v_cvt_pk_bf16_f32 v36, -v21, v20
v_and_b32 v20, 31, v10
v_cvt_f32_u32 v20, v20
v_mul_f32 v20, 0x3d000000, v20
v_sin_f32 v21, v20
v_cos_f32 v20, v20
v_add_u32 v10, v8, v10
v_cvt_pk_bf16_f32 v33, v20, v21
v_cvt_pk_bf16_f32 v37, -v21, v20
v_and_b32 v20, 31, v10
v_cvt_f32_u32 v20, v20
v_mul_f32 v20, 0x3d000000, v20
v_sin_f32 v21, v20
v_cos_f32 v20, v20
v_add_u32 v10, v8, v10
v_cvt_pk_bf16_f32 v34, v20, v21
v_cvt_pk_bf16_f32 v38, -v21, v20
v_and_b32 v20, 31, v10
v_cvt_f32_u32 v20, v20
v_mul_f32 v20, 0x3d000000, v20
v_sin_f32 v21, v20
v_cos_f32 v20, v20
v_add_u32 v10, v8, v10
v_cvt_pk_bf16_f32 v35, v20, v21
v_cvt_pk_bf16_f32 v39, -v21, v20
v_accvgpr_write_b32 a168, v32
v_accvgpr_write_b32 a169, v33
v_accvgpr_write_b32 a170, v34
v_accvgpr_write_b32 a171, v35
v_accvgpr_write_b32 a172, v36
v_accvgpr_write_b32 a173, v37
v_accvgpr_write_b32 a174, v38
v_accvgpr_write_b32 a175, v39
v_lshl_add_u32 v10, v9, 2, 16
v_mul_u32_u24 v10, v10, v8
v_and_b32 v20, 31, v10
v_cvt_f32_u32 v20, v20
v_mul_f32 v20, 0x3d000000, v20
v_sin_f32 v21, v20
v_cos_f32 v20, v20
v_add_u32 v10, v8, v10
v_cvt_pk_bf16_f32 v32, v20, v21
v_cvt_pk_bf16_f32 v36, -v21, v20
v_and_b32 v20, 31, v10
v_cvt_f32_u32 v20, v20
v_mul_f32 v20, 0x3d000000, v20
v_sin_f32 v21, v20
v_cos_f32 v20, v20
v_add_u32 v10, v8, v10
v_cvt_pk_bf16_f32 v33, v20, v21
v_cvt_pk_bf16_f32 v37, -v21, v20
v_and_b32 v20, 31, v10
v_cvt_f32_u32 v20, v20
v_mul_f32 v20, 0x3d000000, v20
v_sin_f32 v21, v20
v_cos_f32 v20, v20
v_add_u32 v10, v8, v10
v_cvt_pk_bf16_f32 v34, v20, v21
v_cvt_pk_bf16_f32 v38, -v21, v20
v_and_b32 v20, 31, v10
v_cvt_f32_u32 v20, v20
v_mul_f32 v20, 0x3d000000, v20
v_sin_f32 v21, v20
v_cos_f32 v20, v20
v_add_u32 v10, v8, v10
v_cvt_pk_bf16_f32 v35, v20, v21
v_cvt_pk_bf16_f32 v39, -v21, v20
v_accvgpr_write_b32 a176, v32
v_accvgpr_write_b32 a177, v33
v_accvgpr_write_b32 a178, v34
v_accvgpr_write_b32 a179, v35
v_accvgpr_write_b32 a180, v36
v_accvgpr_write_b32 a181, v37
v_accvgpr_write_b32 a182, v38
v_accvgpr_write_b32 a183, v39
v_lshl_add_u32 v10, v9, 2, 24
v_mul_u32_u24 v10, v10, v8
v_and_b32 v20, 31, v10
v_cvt_f32_u32 v20, v20
v_mul_f32 v20, 0x3d000000, v20
v_sin_f32 v21, v20
v_cos_f32 v20, v20
v_add_u32 v10, v8, v10
v_cvt_pk_bf16_f32 v32, v20, v21
v_cvt_pk_bf16_f32 v36, -v21, v20
v_and_b32 v20, 31, v10
v_cvt_f32_u32 v20, v20
v_mul_f32 v20, 0x3d000000, v20
v_sin_f32 v21, v20
v_cos_f32 v20, v20
v_add_u32 v10, v8, v10
v_cvt_pk_bf16_f32 v33, v20, v21
v_cvt_pk_bf16_f32 v37, -v21, v20
v_and_b32 v20, 31, v10
v_cvt_f32_u32 v20, v20
v_mul_f32 v20, 0x3d000000, v20
v_sin_f32 v21, v20
v_cos_f32 v20, v20
v_add_u32 v10, v8, v10
v_cvt_pk_bf16_f32 v34, v20, v21
v_cvt_pk_bf16_f32 v38, -v21, v20
v_and_b32 v20, 31, v10
v_cvt_f32_u32 v20, v20
v_mul_f32 v20, 0x3d000000, v20
v_sin_f32 v21, v20
v_cos_f32 v20, v20
v_add_u32 v10, v8, v10
v_cvt_pk_bf16_f32 v35, v20, v21
v_cvt_pk_bf16_f32 v39, -v21, v20
v_accvgpr_write_b32 a184, v32
v_accvgpr_write_b32 a185, v33
v_accvgpr_write_b32 a186, v34
v_accvgpr_write_b32 a187, v35
v_accvgpr_write_b32 a188, v36
v_accvgpr_write_b32 a189, v37
v_accvgpr_write_b32 a190, v38
v_accvgpr_write_b32 a191, v39
s_waitcnt vmcnt(63)
v_lshlrev_b32 v192, 16, v192
v_mul_f32 v192, 0x3a000000, v192
s_waitcnt vmcnt(61)
v_lshlrev_b32 v193, 16, v193
v_mul_f32 v193, 0x3a000000, v193
s_waitcnt vmcnt(59)
v_lshlrev_b32 v194, 16, v194
v_mul_f32 v194, 0x3a000000, v194
s_waitcnt vmcnt(57)
v_lshlrev_b32 v195, 16, v195
v_mul_f32 v195, 0x3a000000, v195
s_waitcnt vmcnt(55)
v_lshlrev_b32 v196, 16, v196
v_mul_f32 v196, 0x3a000000, v196
s_waitcnt vmcnt(53)
v_lshlrev_b32 v197, 16, v197
v_mul_f32 v197, 0x3a000000, v197
s_waitcnt vmcnt(51)
v_lshlrev_b32 v198, 16, v198
v_mul_f32 v198, 0x3a000000, v198
s_waitcnt vmcnt(49)
v_lshlrev_b32 v199, 16, v199
v_mul_f32 v199, 0x3a000000, v199
s_waitcnt vmcnt(47)
v_lshlrev_b32 v200, 16, v200
v_mul_f32 v200, 0x3a000000, v200
s_waitcnt vmcnt(45)
v_lshlrev_b32 v201, 16, v201
v_mul_f32 v201, 0x3a000000, v201
s_waitcnt vmcnt(43)
v_lshlrev_b32 v202, 16, v202
v_mul_f32 v202, 0x3a000000, v202
s_waitcnt vmcnt(41)
v_lshlrev_b32 v203, 16, v203
v_mul_f32 v203, 0x3a000000, v203
s_waitcnt vmcnt(39)
v_lshlrev_b32 v204, 16, v204
v_mul_f32 v204, 0x3a000000, v204
s_waitcnt vmcnt(37)
v_lshlrev_b32 v205, 16, v205
v_mul_f32 v205, 0x3a000000, v205
s_waitcnt vmcnt(35)
v_lshlrev_b32 v206, 16, v206
v_mul_f32 v206, 0x3a000000, v206
s_waitcnt vmcnt(33)
v_lshlrev_b32 v207, 16, v207
v_mul_f32 v207, 0x3a000000, v207
v_lshlrev_b32 v208, 16, v208
v_mul_f32 v208, 0x3a000000, v208
v_lshlrev_b32 v209, 16, v209
v_mul_f32 v209, 0x3a000000, v209
v_lshlrev_b32 v210, 16, v210
v_mul_f32 v210, 0x3a000000, v210
v_lshlrev_b32 v211, 16, v211
v_mul_f32 v211, 0x3a000000, v211
v_lshlrev_b32 v212, 16, v212
v_mul_f32 v212, 0x3a000000, v212
v_lshlrev_b32 v213, 16, v213
v_mul_f32 v213, 0x3a000000, v213
v_lshlrev_b32 v214, 16, v214
v_mul_f32 v214, 0x3a000000, v214
v_lshlrev_b32 v215, 16, v215
v_mul_f32 v215, 0x3a000000, v215
v_lshlrev_b32 v216, 16, v216
v_mul_f32 v216, 0x3a000000, v216
v_lshlrev_b32 v217, 16, v217
v_mul_f32 v217, 0x3a000000, v217
v_lshlrev_b32 v218, 16, v218
v_mul_f32 v218, 0x3a000000, v218
v_lshlrev_b32 v219, 16, v219
v_mul_f32 v219, 0x3a000000, v219
v_lshlrev_b32 v220, 16, v220
v_mul_f32 v220, 0x3a000000, v220
v_lshlrev_b32 v221, 16, v221
v_mul_f32 v221, 0x3a000000, v221
v_lshlrev_b32 v222, 16, v222
v_mul_f32 v222, 0x3a000000, v222
s_waitcnt vmcnt(32)
v_lshlrev_b32 v223, 16, v223
v_mul_f32 v223, 0x3a000000, v223
s_waitcnt vmcnt(31)
v_lshlrev_b32 v224, 16, v224
v_mul_f32 v224, 0x3a000000, v224
s_waitcnt vmcnt(29)
v_lshlrev_b32 v225, 16, v225
v_mul_f32 v225, 0x3a000000, v225
s_waitcnt vmcnt(27)
v_lshlrev_b32 v226, 16, v226
v_mul_f32 v226, 0x3a000000, v226
s_waitcnt vmcnt(25)
v_lshlrev_b32 v227, 16, v227
v_mul_f32 v227, 0x3a000000, v227
s_waitcnt vmcnt(23)
v_lshlrev_b32 v228, 16, v228
v_mul_f32 v228, 0x3a000000, v228
s_waitcnt vmcnt(21)
v_lshlrev_b32 v229, 16, v229
v_mul_f32 v229, 0x3a000000, v229
s_waitcnt vmcnt(19)
v_lshlrev_b32 v230, 16, v230
v_mul_f32 v230, 0x3a000000, v230
s_waitcnt vmcnt(17)
v_lshlrev_b32 v231, 16, v231
v_mul_f32 v231, 0x3a000000, v231
s_waitcnt vmcnt(15)
v_lshlrev_b32 v232, 16, v232
v_mul_f32 v232, 0x3a000000, v232
s_waitcnt vmcnt(13)
v_lshlrev_b32 v233, 16, v233
v_mul_f32 v233, 0x3a000000, v233
s_waitcnt vmcnt(11)
v_lshlrev_b32 v234, 16, v234
v_mul_f32 v234, 0x3a000000, v234
s_waitcnt vmcnt(9)
v_lshlrev_b32 v235, 16, v235
v_mul_f32 v235, 0x3a000000, v235
s_waitcnt vmcnt(7)
v_lshlrev_b32 v236, 16, v236
v_mul_f32 v236, 0x3a000000, v236
s_waitcnt vmcnt(5)
v_lshlrev_b32 v237, 16, v237
v_mul_f32 v237, 0x3a000000, v237
s_waitcnt vmcnt(3)
v_lshlrev_b32 v238, 16, v238
v_mul_f32 v238, 0x3a000000, v238
s_waitcnt vmcnt(1)
v_lshlrev_b32 v239, 16, v239
v_mul_f32 v239, 0x3a000000, v239
v_lshlrev_b32 v240, 16, v240
v_mul_f32 v240, 0x3a000000, v240
v_lshlrev_b32 v241, 16, v241
v_mul_f32 v241, 0x3a000000, v241
v_lshlrev_b32 v242, 16, v242
v_mul_f32 v242, 0x3a000000, v242
v_lshlrev_b32 v243, 16, v243
v_mul_f32 v243, 0x3a000000, v243
v_lshlrev_b32 v244, 16, v244
v_mul_f32 v244, 0x3a000000, v244
v_lshlrev_b32 v245, 16, v245
v_mul_f32 v245, 0x3a000000, v245
v_lshlrev_b32 v246, 16, v246
v_mul_f32 v246, 0x3a000000, v246
v_lshlrev_b32 v247, 16, v247
v_mul_f32 v247, 0x3a000000, v247
v_lshlrev_b32 v248, 16, v248
v_mul_f32 v248, 0x3a000000, v248
v_lshlrev_b32 v249, 16, v249
v_mul_f32 v249, 0x3a000000, v249
v_lshlrev_b32 v250, 16, v250
v_mul_f32 v250, 0x3a000000, v250
v_lshlrev_b32 v251, 16, v251
v_mul_f32 v251, 0x3a000000, v251
v_lshlrev_b32 v252, 16, v252
v_mul_f32 v252, 0x3a000000, v252
v_lshlrev_b32 v253, 16, v253
v_mul_f32 v253, 0x3a000000, v253
v_lshlrev_b32 v254, 16, v254
v_mul_f32 v254, 0x3a000000, v254
s_waitcnt vmcnt(0)
v_lshlrev_b32 v255, 16, v255
v_mul_f32 v255, 0x3a000000, v255
k_fnog_41:
s_lshl_b32 s52, s3, 13
v_add_u32 v12, s52, v0
s_lshl_b32 s52, s3, 4
v_lshl_add_u32 v10, v9, 2, s52
v_add_u32 v10, 0, v10
v_add_u32 v11, 0, v8
v_mul_u32_u24 v10, v10, v11
v_and_b32 v20, 63, v10
v_cvt_f32_u32 v20, v20
v_mul_f32 v20, 0x3c800000, v20
v_sin_f32 v21, v20
v_cos_f32 v20, v20
v_add_u32 v10, v11, v10
v_cvt_pk_bf16_f32 v32, v20, v21
v_cvt_pk_bf16_f32 v36, -v21, v20
v_and_b32 v20, 63, v10
v_cvt_f32_u32 v20, v20
v_mul_f32 v20, 0x3c800000, v20
v_sin_f32 v21, v20
v_cos_f32 v20, v20
v_add_u32 v10, v11, v10
v_cvt_pk_bf16_f32 v33, v20, v21
v_cvt_pk_bf16_f32 v37, -v21, v20
v_and_b32 v20, 63, v10
v_cvt_f32_u32 v20, v20
v_mul_f32 v20, 0x3c800000, v20
v_sin_f32 v21, v20
v_cos_f32 v20, v20
v_add_u32 v10, v11, v10
v_cvt_pk_bf16_f32 v34, v20, v21
v_cvt_pk_bf16_f32 v38, -v21, v20
v_and_b32 v20, 63, v10
v_cvt_f32_u32 v20, v20
v_mul_f32 v20, 0x3c800000, v20
v_sin_f32 v21, v20
v_cos_f32 v20, v20
v_add_u32 v10, v11, v10
v_cvt_pk_bf16_f32 v35, v20, v21
v_cvt_pk_bf16_f32 v39, -v21, v20
ds_write_b128 v12, v[32:35] offset:0
ds_write_b128 v12, v[36:39] offset:1024
v_lshl_add_u32 v10, v9, 2, s52
v_add_u32 v10, 0, v10
v_add_u32 v11, 32, v8
v_mul_u32_u24 v10, v10, v11
v_and_b32 v20, 63, v10
v_cvt_f32_u32 v20, v20
v_mul_f32 v20, 0x3c800000, v20
v_sin_f32 v21, v20
v_cos_f32 v20, v20
v_add_u32 v10, v11, v10
v_cvt_pk_bf16_f32 v40, v20, v21
v_cvt_pk_bf16_f32 v44, -v21, v20
v_and_b32 v20, 63, v10
v_cvt_f32_u32 v20, v20
v_mul_f32 v20, 0x3c800000, v20
v_sin_f32 v21, v20
v_cos_f32 v20, v20
v_add_u32 v10, v11, v10
v_cvt_pk_bf16_f32 v41, v20, v21
v_cvt_pk_bf16_f32 v45, -v21, v20
v_and_b32 v20, 63, v10
v_cvt_f32_u32 v20, v20
v_mul_f32 v20, 0x3c800000, v20
v_sin_f32 v21, v20
v_cos_f32 v20, v20
v_add_u32 v10, v11, v10
v_cvt_pk_bf16_f32 v42, v20, v21
v_cvt_pk_bf16_f32 v46, -v21, v20
v_and_b32 v20, 63, v10
v_cvt_f32_u32 v20, v20
v_mul_f32 v20, 0x3c800000, v20
v_sin_f32 v21, v20
v_cos_f32 v20, v20
v_add_u32 v10, v11, v10
v_cvt_pk_bf16_f32 v43, v20, v21
v_cvt_pk_bf16_f32 v47, -v21, v20
ds_write_b128 v12, v[40:43] offset:2048
ds_write_b128 v12, v[44:47] offset:3072
v_lshl_add_u32 v10, v9, 2, s52
v_add_u32 v10, 8, v10
v_add_u32 v11, 0, v8
v_mul_u32_u24 v10, v10, v11
v_and_b32 v20, 63, v10
v_cvt_f32_u32 v20, v20
v_mul_f32 v20, 0x3c800000, v20
v_sin_f32 v21, v20
v_cos_f32 v20, v20
v_add_u32 v10, v11, v10
v_cvt_pk_bf16_f32 v48, v20, v21
v_cvt_pk_bf16_f32 v52, -v21, v20
v_and_b32 v20, 63, v10
v_cvt_f32_u32 v20, v20
v_mul_f32 v20, 0x3c800000, v20
v_sin_f32 v21, v20
v_cos_f32 v20, v20
v_add_u32 v10, v11, v10
v_cvt_pk_bf16_f32 v49, v20, v21
v_cvt_pk_bf16_f32 v53, -v21, v20
v_and_b32 v20, 63, v10
v_cvt_f32_u32 v20, v20
v_mul_f32 v20, 0x3c800000, v20
v_sin_f32 v21, v20
v_cos_f32 v20, v20
v_add_u32 v10, v11, v10
v_cvt_pk_bf16_f32 v50, v20, v21
v_cvt_pk_bf16_f32 v54, -v21, v20
v_and_b32 v20, 63, v10
v_cvt_f32_u32 v20, v20
v_mul_f32 v20, 0x3c800000, v20
v_sin_f32 v21, v20
v_cos_f32 v20, v20
v_add_u32 v10, v11, v10
v_cvt_pk_bf16_f32 v51, v20, v21
v_cvt_pk_bf16_f32 v55, -v21, v20
ds_write_b128 v12, v[48:51] offset:4096
ds_write_b128 v12, v[52:55] offset:5120
v_lshl_add_u32 v10, v9, 2, s52
v_add_u32 v10, 8, v10
v_add_u32 v11, 32, v8
v_mul_u32_u24 v10, v10, v11
v_and_b32 v20, 63, v10
v_cvt_f32_u32 v20, v20
v_mul_f32 v20, 0x3c800000, v20
v_sin_f32 v21, v20
v_cos_f32 v20, v20
v_add_u32 v10, v11, v10
v_cvt_pk_bf16_f32 v56, v20, v21
v_cvt_pk_bf16_f32 v60, -v21, v20
v_and_b32 v20, 63, v10
v_cvt_f32_u32 v20, v20
v_mul_f32 v20, 0x3c800000, v20
v_sin_f32 v21, v20
v_cos_f32 v20, v20
v_add_u32 v10, v11, v10
v_cvt_pk_bf16_f32 v57, v20, v21
v_cvt_pk_bf16_f32 v61, -v21, v20
v_and_b32 v20, 63, v10
v_cvt_f32_u32 v20, v20
v_mul_f32 v20, 0x3c800000, v20
v_sin_f32 v21, v20
v_cos_f32 v20, v20
v_add_u32 v10, v11, v10
v_cvt_pk_bf16_f32 v58, v20, v21
v_cvt_pk_bf16_f32 v62, -v21, v20
v_and_b32 v20, 63, v10
v_cvt_f32_u32 v20, v20
v_mul_f32 v20, 0x3c800000, v20
v_sin_f32 v21, v20
v_cos_f32 v20, v20
v_add_u32 v10, v11, v10
v_cvt_pk_bf16_f32 v59, v20, v21
v_cvt_pk_bf16_f32 v63, -v21, v20
ds_write_b128 v12, v[56:59] offset:6144
ds_write_b128 v12, v[60:63] offset:7168
s_lshl_b32 s52, s3, 11
v_add_u32 v12, s52, v0
s_lshl_b32 s52, s3, 3
v_lshl_add_u32 v10, v9, 2, s52
v_add_u32 v10, 0, v10
v_add_u32 v11, 0, v8
v_mul_u32_u24 v10, v10, v11
v_cvt_f32_u32 v20, v10
v_mul_f32 v20, 0x3a000000, v20
v_add_u32 v10, v11, v10
v_cos_f32 v64, v20
v_sin_f32 v68, v20
v_cvt_f32_u32 v20, v10
v_mul_f32 v20, 0x3a000000, v20
v_add_u32 v10, v11, v10
v_cos_f32 v65, v20
v_sin_f32 v69, v20
v_cvt_f32_u32 v20, v10
v_mul_f32 v20, 0x3a000000, v20
v_add_u32 v10, v11, v10
v_cos_f32 v66, v20
v_sin_f32 v70, v20
v_cvt_f32_u32 v20, v10
v_mul_f32 v20, 0x3a000000, v20
v_add_u32 v10, v11, v10
v_cos_f32 v67, v20
v_sin_f32 v71, v20
ds_write_b128 v12, v[64:67] offset:32768
ds_write_b128 v12, v[68:71] offset:33792
v_lshl_add_u32 v10, v9, 2, s52
v_add_u32 v10, 0, v10
v_add_u32 v11, 32, v8
v_mul_u32_u24 v10, v10, v11
v_cvt_f32_u32 v20, v10
v_mul_f32 v20, 0x3a000000, v20
v_add_u32 v10, v11, v10
v_cos_f32 v72, v20
v_sin_f32 v76, v20
v_cvt_f32_u32 v20, v10
v_mul_f32 v20, 0x3a000000, v20
v_add_u32 v10, v11, v10
v_cos_f32 v73, v20
v_sin_f32 v77, v20
v_cvt_f32_u32 v20, v10
v_mul_f32 v20, 0x3a000000, v20
v_add_u32 v10, v11, v10
v_cos_f32 v74, v20
v_sin_f32 v78, v20
v_cvt_f32_u32 v20, v10
v_mul_f32 v20, 0x3a000000, v20
v_add_u32 v10, v11, v10
v_cos_f32 v75, v20
v_sin_f32 v79, v20
ds_write_b128 v12, v[72:75] offset:40960
ds_write_b128 v12, v[76:79] offset:41984
v_lshl_add_u32 v10, v9, 2, s52
v_add_u32 v10, 32, v10
v_add_u32 v11, 0, v8
v_mul_u32_u24 v10, v10, v11
v_cvt_f32_u32 v20, v10
v_mul_f32 v20, 0x3a000000, v20
v_add_u32 v10, v11, v10
v_cos_f32 v80, v20
v_sin_f32 v84, v20
v_cvt_f32_u32 v20, v10
v_mul_f32 v20, 0x3a000000, v20
v_add_u32 v10, v11, v10
v_cos_f32 v81, v20
v_sin_f32 v85, v20
v_cvt_f32_u32 v20, v10
v_mul_f32 v20, 0x3a000000, v20
v_add_u32 v10, v11, v10
v_cos_f32 v82, v20
v_sin_f32 v86, v20
v_cvt_f32_u32 v20, v10
v_mul_f32 v20, 0x3a000000, v20
v_add_u32 v10, v11, v10
v_cos_f32 v83, v20
v_sin_f32 v87, v20
ds_write_b128 v12, v[80:83] offset:49152
ds_write_b128 v12, v[84:87] offset:50176
s_lshl_b32 s52, s3, 2
v_lshl_add_u32 v30, v8, 4, s52
v_lshl_add_u32 v30, v9, 11, v30
v_mul_u32_u24 v31, 2560, v9
v_lshl_add_u32 v31, v8, 2, v31
s_lshr_b32 s52, s3, 1
s_lshl_b32 s52, s52, 9
s_and_b32 s53, s3, 1
s_lshl_b32 s53, s53, 3
s_add_u32 s52, s52, s53
v_lshl_add_u32 v24, v8, 4, s52
v_lshl_add_u32 v24, v9, 2, v24
s_mov_b32 s52, 163840
v_mul_lo_u32 v25, v9, s52
v_lshl_add_u32 v25, v8, 4, v25
s_mul_i32 s44, s51, 3145728
s_lshl_b32 s52, s30, 15
s_add_u32 s44, s44, s52
s_add_u32 s44, s44, 205520896
s_mul_i32 s45, s51, 1048576
s_mul_i32 s52, s3, 5120
s_add_u32 s45, s45, s52
s_add_u32 s45, s45, 211812352
s_mul_i32 s48, s51, 3145728
s_lshl_b32 s52, s30, 9
s_add_u32 s48, s48, s52
s_mul_i32 s52, s3, 327680
s_add_u32 s48, s48, s52
s_add_u32 s48, s48, 198180864
s_mov_b32 s49, 0x3acccccd
v_mov_b32 v27, 0x3727c5ac
s_waitcnt vmcnt(0) lgkmcnt(0)
s_barrier
ds_read_b128 v[112:115], v0 offset:0
ds_read_b128 v[116:119], v0 offset:1024
ds_read_b128 v[120:123], v0 offset:2048
ds_read_b128 v[124:127], v0 offset:3072
k_pr_42:
buffer_load_dword v18, v30, s[4:7], s44 offen offset:1024 sc1
s_waitcnt vmcnt(0)
v_cmp_eq_u32 vcc, -1, v18
s_cbranch_vccz k_prd_43
s_sleep 8
s_sub_u32 s32, s32, 1
s_cmp_gt_i32 s32, 0
s_cbranch_scc1 k_pr_42
k_prd_43:
k_ps_44:
buffer_load_dword v96, v31, s[4:7], s45 offen offset:0 sc1
buffer_load_dword v97, v31, s[4:7], s45 offen offset:128 sc1
buffer_load_dword v98, v31, s[4:7], s45 offen offset:256 sc1
buffer_load_dword v99, v31, s[4:7], s45 offen offset:384 sc1
buffer_load_dword v100, v31, s[4:7], s45 offen offset:512 sc1
buffer_load_dword v101, v31, s[4:7], s45 offen offset:640 sc1
buffer_load_dword v102, v31, s[4:7], s45 offen offset:768 sc1
buffer_load_dword v103, v31, s[4:7], s45 offen offset:896 sc1
buffer_load_dword v104, v31, s[4:7], s45 offen offset:1024 sc1
buffer_load_dword v105, v31, s[4:7], s45 offen offset:1152 sc1
buffer_load_dword v106, v31, s[4:7], s45 offen offset:1280 sc1
buffer_load_dword v107, v31, s[4:7], s45 offen offset:1408 sc1
buffer_load_dword v108, v31, s[4:7], s45 offen offset:1536 sc1
buffer_load_dword v109, v31, s[4:7], s45 offen offset:1664 sc1
buffer_load_dword v110, v31, s[4:7], s45 offen offset:1792 sc1
buffer_load_dword v111, v31, s[4:7], s45 offen offset:1920 sc1
buffer_load_dword v20, v31, s[4:7], s45 offen offset:2048 sc1
buffer_load_dword v21, v31, s[4:7], s45 offen offset:2176 sc1
buffer_load_dword v22, v31, s[4:7], s45 offen offset:2304 sc1
buffer_load_dword v23, v31, s[4:7], s45 offen offset:2432 sc1
buffer_load_dword v16, v30, s[4:7], s44 offen offset:0 sc1
buffer_load_dword v17, v30, s[4:7], s44 offen offset:512 sc1
buffer_load_dword v19, v30, s[4:7], s44 offen offset:1536 sc1
s_waitcnt vmcnt(21)
v_add_f32 v96, v96, v97
s_waitcnt vmcnt(20)
v_add_f32 v96, v96, v98
s_waitcnt vmcnt(19)
v_add_f32 v96, v96, v99
s_waitcnt vmcnt(18)
v_add_f32 v96, v96, v100
s_waitcnt vmcnt(17)
v_add_f32 v96, v96, v101
s_waitcnt vmcnt(16)
v_add_f32 v96, v96, v102
s_waitcnt vmcnt(15)
v_add_f32 v96, v96, v103
s_waitcnt vmcnt(14)
v_add_f32 v96, v96, v104
s_waitcnt vmcnt(13)
v_add_f32 v96, v96, v105
s_waitcnt vmcnt(12)
v_add_f32 v96, v96, v106
s_waitcnt vmcnt(11)
v_add_f32 v96, v96, v107
s_waitcnt vmcnt(10)
v_add_f32 v96, v96, v108
s_waitcnt vmcnt(9)
v_add_f32 v96, v96, v109
s_waitcnt vmcnt(8)
v_add_f32 v96, v96, v110
s_waitcnt vmcnt(7)
v_add_f32 v96, v96, v111
s_waitcnt vmcnt(6)
v_add_f32 v96, v96, v20
s_waitcnt vmcnt(5)
v_add_f32 v96, v96, v21
s_waitcnt vmcnt(4)
v_add_f32 v96, v96, v22
s_waitcnt vmcnt(3)
v_add_f32 v96, v96, v23
v_cmp_u_f32 vcc, v96, v96
v_fma_f32 v96, v96, s49, v27
s_cbranch_vccz k_psd_45
s_sub_u32 s32, s32, 1
s_cmp_gt_i32 s32, 0
s_cbranch_scc1 k_ps_44
k_psd_45:
v_rsq_f32 v96, v96
s_add_u32 s45, s45, 20480
ds_write_b32 v24, v96 offset:57344
s_branch k_pyd_47
k_py_46:
buffer_load_dword v16, v30, s[4:7], s44 offen offset:0 sc1
buffer_load_dword v17, v30, s[4:7], s44 offen offset:512 sc1
buffer_load_dword v19, v30, s[4:7], s44 offen offset:1536 sc1
s_sub_u32 s32, s32, 1
k_pyd_47:
s_waitcnt vmcnt(0)
v_max3_u32 v20, v16, v17, v19
v_cmp_eq_u32 vcc, -1, v20
s_cmp_gt_i32 s32, 0
s_cselect_b64 vcc, vcc, 0
s_cbranch_vccnz k_py_46
s_add_u32 s44, s44, 4096
s_waitcnt lgkmcnt(0)
s_barrier
ds_read_b128 v[12:15], v0 offset:57344
v_lshlrev_b32 v144, 16, v16
v_and_b32 v128, 0xffff0000, v16
v_lshlrev_b32 v145, 16, v17
v_and_b32 v129, 0xffff0000, v17
v_lshlrev_b32 v146, 16, v18
v_and_b32 v130, 0xffff0000, v18
v_lshlrev_b32 v147, 16, v19
v_and_b32 v131, 0xffff0000, v19
s_waitcnt lgkmcnt(0)
v_mul_f32 v8, v12, v144
v_mul_f32 v12, v12, v128
v_cvt_pk_bf16_f32 v8, v8, v12
v_and_b32 v8, s47, v8
v_mul_f32 v9, v13, v145
v_mul_f32 v13, v13, v129
v_cvt_pk_bf16_f32 v9, v9, v13
v_and_b32 v9, s47, v9
v_mul_f32 v10, v14, v146
v_mul_f32 v14, v14, v130
v_cvt_pk_bf16_f32 v10, v10, v14
v_and_b32 v10, s47, v10
v_mul_f32 v11, v15, v147
v_mul_f32 v15, v15, v131
v_cvt_pk_bf16_f32 v11, v11, v15
v_and_b32 v11, s47, v11
s_nop 1
v_mfma_f32_32x32x16_bf16 v[32:47], v[8:11], v[112:115], 0
v_mfma_f32_32x32x16_bf16 v[48:63], v[8:11], v[116:119], 0
v_mfma_f32_32x32x16_bf16 v[64:79], v[8:11], v[120:123], 0
v_mfma_f32_32x32x16_bf16 v[80:95], v[8:11], v[124:127], 0
ds_read_b128 v[112:115], v0 offset:4096
ds_read_b128 v[116:119], v0 offset:5120
ds_read_b128 v[120:123], v0 offset:6144
ds_read_b128 v[124:127], v0 offset:7168
k_pr_48:
buffer_load_dword v18, v30, s[4:7], s44 offen offset:1024 sc1
s_waitcnt vmcnt(0)
v_cmp_eq_u32 vcc, -1, v18
s_cbranch_vccz k_prd_49
s_sleep 8
s_sub_u32 s32, s32, 1
s_cmp_gt_i32 s32, 0
s_cbranch_scc1 k_pr_48
k_prd_49:
k_ps_50:
buffer_load_dword v96, v31, s[4:7], s45 offen offset:0 sc1
buffer_load_dword v97, v31, s[4:7], s45 offen offset:128 sc1
buffer_load_dword v98, v31, s[4:7], s45 offen offset:256 sc1
buffer_load_dword v99, v31, s[4:7], s45 offen offset:384 sc1
buffer_load_dword v100, v31, s[4:7], s45 offen offset:512 sc1
buffer_load_dword v101, v31, s[4:7], s45 offen offset:640 sc1
buffer_load_dword v102, v31, s[4:7], s45 offen offset:768 sc1
buffer_load_dword v103, v31, s[4:7], s45 offen offset:896 sc1
buffer_load_dword v104, v31, s[4:7], s45 offen offset:1024 sc1
buffer_load_dword v105, v31, s[4:7], s45 offen offset:1152 sc1
buffer_load_dword v106, v31, s[4:7], s45 offen offset:1280 sc1
buffer_load_dword v107, v31, s[4:7], s45 offen offset:1408 sc1
buffer_load_dword v108, v31, s[4:7], s45 offen offset:1536 sc1
buffer_load_dword v109, v31, s[4:7], s45 offen offset:1664 sc1
buffer_load_dword v110, v31, s[4:7], s45 offen offset:1792 sc1
buffer_load_dword v111, v31, s[4:7], s45 offen offset:1920 sc1
buffer_load_dword v20, v31, s[4:7], s45 offen offset:2048 sc1
buffer_load_dword v21, v31, s[4:7], s45 offen offset:2176 sc1
buffer_load_dword v22, v31, s[4:7], s45 offen offset:2304 sc1
buffer_load_dword v23, v31, s[4:7], s45 offen offset:2432 sc1
buffer_load_dword v16, v30, s[4:7], s44 offen offset:0 sc1
buffer_load_dword v17, v30, s[4:7], s44 offen offset:512 sc1
buffer_load_dword v19, v30, s[4:7], s44 offen offset:1536 sc1
s_waitcnt vmcnt(21)
v_add_f32 v96, v96, v97
s_waitcnt vmcnt(20)
v_add_f32 v96, v96, v98
s_waitcnt vmcnt(19)
v_add_f32 v96, v96, v99
s_waitcnt vmcnt(18)
v_add_f32 v96, v96, v100
s_waitcnt vmcnt(17)
v_add_f32 v96, v96, v101
s_waitcnt vmcnt(16)
v_add_f32 v96, v96, v102
s_waitcnt vmcnt(15)
v_add_f32 v96, v96, v103
s_waitcnt vmcnt(14)
v_add_f32 v96, v96, v104
s_waitcnt vmcnt(13)
v_add_f32 v96, v96, v105
s_waitcnt vmcnt(12)
v_add_f32 v96, v96, v106
s_waitcnt vmcnt(11)
v_add_f32 v96, v96, v107
s_waitcnt vmcnt(10)
v_add_f32 v96, v96, v108
s_waitcnt vmcnt(9)
v_add_f32 v96, v96, v109
s_waitcnt vmcnt(8)
v_add_f32 v96, v96, v110
s_waitcnt vmcnt(7)
v_add_f32 v96, v96, v111
s_waitcnt vmcnt(6)
v_add_f32 v96, v96, v20
s_waitcnt vmcnt(5)
v_add_f32 v96, v96, v21
s_waitcnt vmcnt(4)
v_add_f32 v96, v96, v22
s_waitcnt vmcnt(3)
v_add_f32 v96, v96, v23
v_cmp_u_f32 vcc, v96, v96
v_fma_f32 v96, v96, s49, v27
s_cbranch_vccz k_psd_51
s_sub_u32 s32, s32, 1
s_cmp_gt_i32 s32, 0
s_cbranch_scc1 k_ps_50
k_psd_51:
v_rsq_f32 v96, v96
s_add_u32 s45, s45, 20480
ds_write_b32 v24, v96 offset:58368
s_branch k_pyd_53
k_py_52:
buffer_load_dword v16, v30, s[4:7], s44 offen offset:0 sc1
buffer_load_dword v17, v30, s[4:7], s44 offen offset:512 sc1
buffer_load_dword v19, v30, s[4:7], s44 offen offset:1536 sc1
s_sub_u32 s32, s32, 1
k_pyd_53:
s_waitcnt vmcnt(0)
v_max3_u32 v20, v16, v17, v19
v_cmp_eq_u32 vcc, -1, v20
s_cmp_gt_i32 s32, 0
s_cselect_b64 vcc, vcc, 0
s_cbranch_vccnz k_py_52
s_add_u32 s44, s44, 4096
s_waitcnt lgkmcnt(0)
s_barrier
ds_read_b128 v[12:15], v0 offset:58368
v_lshlrev_b32 v148, 16, v16
v_and_b32 v132, 0xffff0000, v16
v_lshlrev_b32 v149, 16, v17
v_and_b32 v133, 0xffff0000, v17
v_lshlrev_b32 v150, 16, v18
v_and_b32 v134, 0xffff0000, v18
v_lshlrev_b32 v151, 16, v19
v_and_b32 v135, 0xffff0000, v19
s_waitcnt lgkmcnt(0)
v_mul_f32 v8, v12, v148
v_mul_f32 v12, v12, v132
v_cvt_pk_bf16_f32 v8, v8, v12
v_and_b32 v8, s47, v8
v_mul_f32 v9, v13, v149
v_mul_f32 v13, v13, v133
v_cvt_pk_bf16_f32 v9, v9, v13
v_and_b32 v9, s47, v9
v_mul_f32 v10, v14, v150
v_mul_f32 v14, v14, v134
v_cvt_pk_bf16_f32 v10, v10, v14
v_and_b32 v10, s47, v10
v_mul_f32 v11, v15, v151
v_mul_f32 v15, v15, v135
v_cvt_pk_bf16_f32 v11, v11, v15
v_and_b32 v11, s47, v11
s_nop 1
v_mfma_f32_32x32x16_bf16 v[32:47], v[8:11], v[112:115], v[32:47]
v_mfma_f32_32x32x16_bf16 v[48:63], v[8:11], v[116:119], v[48:63]
v_mfma_f32_32x32x16_bf16 v[64:79], v[8:11], v[120:123], v[64:79]
v_mfma_f32_32x32x16_bf16 v[80:95], v[8:11], v[124:127], v[80:95]
ds_read_b128 v[112:115], v0 offset:8192
ds_read_b128 v[116:119], v0 offset:9216
ds_read_b128 v[120:123], v0 offset:10240
ds_read_b128 v[124:127], v0 offset:11264
k_pr_54:
buffer_load_dword v18, v30, s[4:7], s44 offen offset:1024 sc1
s_waitcnt vmcnt(0)
v_cmp_eq_u32 vcc, -1, v18
s_cbranch_vccz k_prd_55
s_sleep 8
s_sub_u32 s32, s32, 1
s_cmp_gt_i32 s32, 0
s_cbranch_scc1 k_pr_54
k_prd_55:
k_ps_56:
buffer_load_dword v96, v31, s[4:7], s45 offen offset:0 sc1
buffer_load_dword v97, v31, s[4:7], s45 offen offset:128 sc1
buffer_load_dword v98, v31, s[4:7], s45 offen offset:256 sc1
buffer_load_dword v99, v31, s[4:7], s45 offen offset:384 sc1
buffer_load_dword v100, v31, s[4:7], s45 offen offset:512 sc1
buffer_load_dword v101, v31, s[4:7], s45 offen offset:640 sc1
buffer_load_dword v102, v31, s[4:7], s45 offen offset:768 sc1
buffer_load_dword v103, v31, s[4:7], s45 offen offset:896 sc1
buffer_load_dword v104, v31, s[4:7], s45 offen offset:1024 sc1
buffer_load_dword v105, v31, s[4:7], s45 offen offset:1152 sc1
buffer_load_dword v106, v31, s[4:7], s45 offen offset:1280 sc1
buffer_load_dword v107, v31, s[4:7], s45 offen offset:1408 sc1
buffer_load_dword v108, v31, s[4:7], s45 offen offset:1536 sc1
buffer_load_dword v109, v31, s[4:7], s45 offen offset:1664 sc1
buffer_load_dword v110, v31, s[4:7], s45 offen offset:1792 sc1
buffer_load_dword v111, v31, s[4:7], s45 offen offset:1920 sc1
buffer_load_dword v20, v31, s[4:7], s45 offen offset:2048 sc1
buffer_load_dword v21, v31, s[4:7], s45 offen offset:2176 sc1
buffer_load_dword v22, v31, s[4:7], s45 offen offset:2304 sc1
buffer_load_dword v23, v31, s[4:7], s45 offen offset:2432 sc1
buffer_load_dword v16, v30, s[4:7], s44 offen offset:0 sc1
buffer_load_dword v17, v30, s[4:7], s44 offen offset:512 sc1
buffer_load_dword v19, v30, s[4:7], s44 offen offset:1536 sc1
s_waitcnt vmcnt(21)
v_add_f32 v96, v96, v97
s_waitcnt vmcnt(20)
v_add_f32 v96, v96, v98
s_waitcnt vmcnt(19)
v_add_f32 v96, v96, v99
s_waitcnt vmcnt(18)
v_add_f32 v96, v96, v100
s_waitcnt vmcnt(17)
v_add_f32 v96, v96, v101
s_waitcnt vmcnt(16)
v_add_f32 v96, v96, v102
s_waitcnt vmcnt(15)
v_add_f32 v96, v96, v103
s_waitcnt vmcnt(14)
v_add_f32 v96, v96, v104
s_waitcnt vmcnt(13)
v_add_f32 v96, v96, v105
s_waitcnt vmcnt(12)
v_add_f32 v96, v96, v106
s_waitcnt vmcnt(11)
v_add_f32 v96, v96, v107
s_waitcnt vmcnt(10)
v_add_f32 v96, v96, v108
s_waitcnt vmcnt(9)
v_add_f32 v96, v96, v109
s_waitcnt vmcnt(8)
v_add_f32 v96, v96, v110
s_waitcnt vmcnt(7)
v_add_f32 v96, v96, v111
s_waitcnt vmcnt(6)
v_add_f32 v96, v96, v20
s_waitcnt vmcnt(5)
v_add_f32 v96, v96, v21
s_waitcnt vmcnt(4)
v_add_f32 v96, v96, v22
s_waitcnt vmcnt(3)
v_add_f32 v96, v96, v23
v_cmp_u_f32 vcc, v96, v96
v_fma_f32 v96, v96, s49, v27
s_cbranch_vccz k_psd_57
s_sub_u32 s32, s32, 1
s_cmp_gt_i32 s32, 0
s_cbranch_scc1 k_ps_56
k_psd_57:
v_rsq_f32 v96, v96
s_add_u32 s45, s45, 20480
ds_write_b32 v24, v96 offset:57344
s_branch k_pyd_59
k_py_58:
buffer_load_dword v16, v30, s[4:7], s44 offen offset:0 sc1
buffer_load_dword v17, v30, s[4:7], s44 offen offset:512 sc1
buffer_load_dword v19, v30, s[4:7], s44 offen offset:1536 sc1
s_sub_u32 s32, s32, 1
k_pyd_59:
s_waitcnt vmcnt(0)
v_max3_u32 v20, v16, v17, v19
v_cmp_eq_u32 vcc, -1, v20
s_cmp_gt_i32 s32, 0
s_cselect_b64 vcc, vcc, 0
s_cbranch_vccnz k_py_58
s_add_u32 s44, s44, 4096
s_waitcnt lgkmcnt(0)
s_barrier
ds_read_b128 v[12:15], v0 offset:57344
v_lshlrev_b32 v152, 16, v16
v_and_b32 v136, 0xffff0000, v16
v_lshlrev_b32 v153, 16, v17
v_and_b32 v137, 0xffff0000, v17
v_lshlrev_b32 v154, 16, v18
v_and_b32 v138, 0xffff0000, v18
v_lshlrev_b32 v155, 16, v19
v_and_b32 v139, 0xffff0000, v19
s_waitcnt lgkmcnt(0)
v_mul_f32 v8, v12, v152
v_mul_f32 v12, v12, v136
v_cvt_pk_bf16_f32 v8, v8, v12
v_and_b32 v8, s47, v8
v_mul_f32 v9, v13, v153
v_mul_f32 v13, v13, v137
v_cvt_pk_bf16_f32 v9, v9, v13
v_and_b32 v9, s47, v9
v_mul_f32 v10, v14, v154
v_mul_f32 v14, v14, v138
v_cvt_pk_bf16_f32 v10, v10, v14
v_and_b32 v10, s47, v10
v_mul_f32 v11, v15, v155
v_mul_f32 v15, v15, v139
v_cvt_pk_bf16_f32 v11, v11, v15
v_and_b32 v11, s47, v11
s_nop 1
v_mfma_f32_32x32x16_bf16 v[32:47], v[8:11], v[112:115], v[32:47]
v_mfma_f32_32x32x16_bf16 v[48:63], v[8:11], v[116:119], v[48:63]
v_mfma_f32_32x32x16_bf16 v[64:79], v[8:11], v[120:123], v[64:79]
v_mfma_f32_32x32x16_bf16 v[80:95], v[8:11], v[124:127], v[80:95]
ds_read_b128 v[112:115], v0 offset:12288
ds_read_b128 v[116:119], v0 offset:13312
ds_read_b128 v[120:123], v0 offset:14336
ds_read_b128 v[124:127], v0 offset:15360
k_pr_60:
buffer_load_dword v18, v30, s[4:7], s44 offen offset:1024 sc1
s_waitcnt vmcnt(0)
v_cmp_eq_u32 vcc, -1, v18
s_cbranch_vccz k_prd_61
s_sleep 8
s_sub_u32 s32, s32, 1
s_cmp_gt_i32 s32, 0
s_cbranch_scc1 k_pr_60
k_prd_61:
k_ps_62:
buffer_load_dword v96, v31, s[4:7], s45 offen offset:0 sc1
buffer_load_dword v97, v31, s[4:7], s45 offen offset:128 sc1
buffer_load_dword v98, v31, s[4:7], s45 offen offset:256 sc1
buffer_load_dword v99, v31, s[4:7], s45 offen offset:384 sc1
buffer_load_dword v100, v31, s[4:7], s45 offen offset:512 sc1
buffer_load_dword v101, v31, s[4:7], s45 offen offset:640 sc1
buffer_load_dword v102, v31, s[4:7], s45 offen offset:768 sc1
buffer_load_dword v103, v31, s[4:7], s45 offen offset:896 sc1
buffer_load_dword v104, v31, s[4:7], s45 offen offset:1024 sc1
buffer_load_dword v105, v31, s[4:7], s45 offen offset:1152 sc1
buffer_load_dword v106, v31, s[4:7], s45 offen offset:1280 sc1
buffer_load_dword v107, v31, s[4:7], s45 offen offset:1408 sc1
buffer_load_dword v108, v31, s[4:7], s45 offen offset:1536 sc1
buffer_load_dword v109, v31, s[4:7], s45 offen offset:1664 sc1
buffer_load_dword v110, v31, s[4:7], s45 offen offset:1792 sc1
buffer_load_dword v111, v31, s[4:7], s45 offen offset:1920 sc1
buffer_load_dword v20, v31, s[4:7], s45 offen offset:2048 sc1
buffer_load_dword v21, v31, s[4:7], s45 offen offset:2176 sc1
buffer_load_dword v22, v31, s[4:7], s45 offen offset:2304 sc1
buffer_load_dword v23, v31, s[4:7], s45 offen offset:2432 sc1
buffer_load_dword v16, v30, s[4:7], s44 offen offset:0 sc1
buffer_load_dword v17, v30, s[4:7], s44 offen offset:512 sc1
buffer_load_dword v19, v30, s[4:7], s44 offen offset:1536 sc1
s_waitcnt vmcnt(21)
v_add_f32 v96, v96, v97
s_waitcnt vmcnt(20)
v_add_f32 v96, v96, v98
s_waitcnt vmcnt(19)
v_add_f32 v96, v96, v99
s_waitcnt vmcnt(18)
v_add_f32 v96, v96, v100
s_waitcnt vmcnt(17)
v_add_f32 v96, v96, v101
s_waitcnt vmcnt(16)
v_add_f32 v96, v96, v102
s_waitcnt vmcnt(15)
v_add_f32 v96, v96, v103
s_waitcnt vmcnt(14)
v_add_f32 v96, v96, v104
s_waitcnt vmcnt(13)
v_add_f32 v96, v96, v105
s_waitcnt vmcnt(12)
v_add_f32 v96, v96, v106
s_waitcnt vmcnt(11)
v_add_f32 v96, v96, v107
s_waitcnt vmcnt(10)
v_add_f32 v96, v96, v108
s_waitcnt vmcnt(9)
v_add_f32 v96, v96, v109
s_waitcnt vmcnt(8)
v_add_f32 v96, v96, v110
s_waitcnt vmcnt(7)
v_add_f32 v96, v96, v111
s_waitcnt vmcnt(6)
v_add_f32 v96, v96, v20
s_waitcnt vmcnt(5)
v_add_f32 v96, v96, v21
s_waitcnt vmcnt(4)
v_add_f32 v96, v96, v22
s_waitcnt vmcnt(3)
v_add_f32 v96, v96, v23
v_cmp_u_f32 vcc, v96, v96
v_fma_f32 v96, v96, s49, v27
s_cbranch_vccz k_psd_63
s_sub_u32 s32, s32, 1
s_cmp_gt_i32 s32, 0
s_cbranch_scc1 k_ps_62
k_psd_63:
v_rsq_f32 v96, v96
s_add_u32 s45, s45, 20480
ds_write_b32 v24, v96 offset:58368
s_branch k_pyd_65
k_py_64:
buffer_load_dword v16, v30, s[4:7], s44 offen offset:0 sc1
buffer_load_dword v17, v30, s[4:7], s44 offen offset:512 sc1
buffer_load_dword v19, v30, s[4:7], s44 offen offset:1536 sc1
s_sub_u32 s32, s32, 1
k_pyd_65:
s_waitcnt vmcnt(0)
v_max3_u32 v20, v16, v17, v19
v_cmp_eq_u32 vcc, -1, v20
s_cmp_gt_i32 s32, 0
s_cselect_b64 vcc, vcc, 0
s_cbranch_vccnz k_py_64
s_add_u32 s44, s44, 4096
s_waitcnt lgkmcnt(0)
s_barrier
ds_read_b128 v[12:15], v0 offset:58368
v_lshlrev_b32 v156, 16, v16
v_and_b32 v140, 0xffff0000, v16
v_lshlrev_b32 v157, 16, v17
v_and_b32 v141, 0xffff0000, v17
v_lshlrev_b32 v158, 16, v18
v_and_b32 v142, 0xffff0000, v18
v_lshlrev_b32 v159, 16, v19
v_and_b32 v143, 0xffff0000, v19
s_waitcnt lgkmcnt(0)
v_mul_f32 v8, v12, v156
v_mul_f32 v12, v12, v140
v_cvt_pk_bf16_f32 v8, v8, v12
v_and_b32 v8, s47, v8
v_mul_f32 v9, v13, v157
v_mul_f32 v13, v13, v141
v_cvt_pk_bf16_f32 v9, v9, v13
v_and_b32 v9, s47, v9
v_mul_f32 v10, v14, v158
v_mul_f32 v14, v14, v142
v_cvt_pk_bf16_f32 v10, v10, v14
v_and_b32 v10, s47, v10
v_mul_f32 v11, v15, v159
v_mul_f32 v15, v15, v143
v_cvt_pk_bf16_f32 v11, v11, v15
v_and_b32 v11, s47, v11
s_nop 1
v_mfma_f32_32x32x16_bf16 v[32:47], v[8:11], v[112:115], v[32:47]
v_mfma_f32_32x32x16_bf16 v[48:63], v[8:11], v[116:119], v[48:63]
v_mfma_f32_32x32x16_bf16 v[64:79], v[8:11], v[120:123], v[64:79]
v_mfma_f32_32x32x16_bf16 v[80:95], v[8:11], v[124:127], v[80:95]
ds_read_b128 v[112:115], v0 offset:16384
ds_read_b128 v[116:119], v0 offset:17408
ds_read_b128 v[120:123], v0 offset:18432
ds_read_b128 v[124:127], v0 offset:19456
k_pr_66:
buffer_load_dword v18, v30, s[4:7], s44 offen offset:1024 sc1
s_waitcnt vmcnt(0)
v_cmp_eq_u32 vcc, -1, v18
s_cbranch_vccz k_prd_67
s_sleep 8
s_sub_u32 s32, s32, 1
s_cmp_gt_i32 s32, 0
s_cbranch_scc1 k_pr_66
k_prd_67:
k_ps_68:
buffer_load_dword v96, v31, s[4:7], s45 offen offset:0 sc1
buffer_load_dword v97, v31, s[4:7], s45 offen offset:128 sc1
buffer_load_dword v98, v31, s[4:7], s45 offen offset:256 sc1
buffer_load_dword v99, v31, s[4:7], s45 offen offset:384 sc1
buffer_load_dword v100, v31, s[4:7], s45 offen offset:512 sc1
buffer_load_dword v101, v31, s[4:7], s45 offen offset:640 sc1
buffer_load_dword v102, v31, s[4:7], s45 offen offset:768 sc1
buffer_load_dword v103, v31, s[4:7], s45 offen offset:896 sc1
buffer_load_dword v104, v31, s[4:7], s45 offen offset:1024 sc1
buffer_load_dword v105, v31, s[4:7], s45 offen offset:1152 sc1
buffer_load_dword v106, v31, s[4:7], s45 offen offset:1280 sc1
buffer_load_dword v107, v31, s[4:7], s45 offen offset:1408 sc1
buffer_load_dword v108, v31, s[4:7], s45 offen offset:1536 sc1
buffer_load_dword v109, v31, s[4:7], s45 offen offset:1664 sc1
buffer_load_dword v110, v31, s[4:7], s45 offen offset:1792 sc1
buffer_load_dword v111, v31, s[4:7], s45 offen offset:1920 sc1
buffer_load_dword v20, v31, s[4:7], s45 offen offset:2048 sc1
buffer_load_dword v21, v31, s[4:7], s45 offen offset:2176 sc1
buffer_load_dword v22, v31, s[4:7], s45 offen offset:2304 sc1
buffer_load_dword v23, v31, s[4:7], s45 offen offset:2432 sc1
buffer_load_dword v16, v30, s[4:7], s44 offen offset:0 sc1
buffer_load_dword v17, v30, s[4:7], s44 offen offset:512 sc1
buffer_load_dword v19, v30, s[4:7], s44 offen offset:1536 sc1
s_waitcnt vmcnt(21)
v_add_f32 v96, v96, v97
s_waitcnt vmcnt(20)
v_add_f32 v96, v96, v98
s_waitcnt vmcnt(19)
v_add_f32 v96, v96, v99
s_waitcnt vmcnt(18)
v_add_f32 v96, v96, v100
s_waitcnt vmcnt(17)
v_add_f32 v96, v96, v101
s_waitcnt vmcnt(16)
v_add_f32 v96, v96, v102
s_waitcnt vmcnt(15)
v_add_f32 v96, v96, v103
s_waitcnt vmcnt(14)
v_add_f32 v96, v96, v104
s_waitcnt vmcnt(13)
v_add_f32 v96, v96, v105
s_waitcnt vmcnt(12)
v_add_f32 v96, v96, v106
s_waitcnt vmcnt(11)
v_add_f32 v96, v96, v107
s_waitcnt vmcnt(10)
v_add_f32 v96, v96, v108
s_waitcnt vmcnt(9)
v_add_f32 v96, v96, v109
s_waitcnt vmcnt(8)
v_add_f32 v96, v96, v110
s_waitcnt vmcnt(7)
v_add_f32 v96, v96, v111
s_waitcnt vmcnt(6)
v_add_f32 v96, v96, v20
s_waitcnt vmcnt(5)
v_add_f32 v96, v96, v21
s_waitcnt vmcnt(4)
v_add_f32 v96, v96, v22
s_waitcnt vmcnt(3)
v_add_f32 v96, v96, v23
v_cmp_u_f32 vcc, v96, v96
v_fma_f32 v96, v96, s49, v27
s_cbranch_vccz k_psd_69
s_sub_u32 s32, s32, 1
s_cmp_gt_i32 s32, 0
s_cbranch_scc1 k_ps_68
k_psd_69:
v_rsq_f32 v96, v96
s_add_u32 s45, s45, 20480
ds_write_b32 v24, v96 offset:57344
s_branch k_pyd_71
k_py_70:
buffer_load_dword v16, v30, s[4:7], s44 offen offset:0 sc1
buffer_load_dword v17, v30, s[4:7], s44 offen offset:512 sc1
buffer_load_dword v19, v30, s[4:7], s44 offen offset:1536 sc1
s_sub_u32 s32, s32, 1
k_pyd_71:
s_waitcnt vmcnt(0)
v_max3_u32 v20, v16, v17, v19
v_cmp_eq_u32 vcc, -1, v20
s_cmp_gt_i32 s32, 0
s_cselect_b64 vcc, vcc, 0
s_cbranch_vccnz k_py_70
s_add_u32 s44, s44, 4096
s_waitcnt lgkmcnt(0)
s_barrier
ds_read_b128 v[12:15], v0 offset:57344
v_lshlrev_b32 v176, 16, v16
v_and_b32 v160, 0xffff0000, v16
v_lshlrev_b32 v177, 16, v17
v_and_b32 v161, 0xffff0000, v17
v_lshlrev_b32 v178, 16, v18
v_and_b32 v162, 0xffff0000, v18
v_lshlrev_b32 v179, 16, v19
v_and_b32 v163, 0xffff0000, v19
s_waitcnt lgkmcnt(0)
v_mul_f32 v8, v12, v176
v_mul_f32 v12, v12, v160
v_cvt_pk_bf16_f32 v8, v8, v12
v_and_b32 v8, s47, v8
v_mul_f32 v9, v13, v177
v_mul_f32 v13, v13, v161
v_cvt_pk_bf16_f32 v9, v9, v13
v_and_b32 v9, s47, v9
v_mul_f32 v10, v14, v178
v_mul_f32 v14, v14, v162
v_cvt_pk_bf16_f32 v10, v10, v14
v_and_b32 v10, s47, v10
v_mul_f32 v11, v15, v179
v_mul_f32 v15, v15, v163
v_cvt_pk_bf16_f32 v11, v11, v15
v_and_b32 v11, s47, v11
s_nop 1
v_mfma_f32_32x32x16_bf16 v[32:47], v[8:11], v[112:115], v[32:47]
v_mfma_f32_32x32x16_bf16 v[48:63], v[8:11], v[116:119], v[48:63]
v_mfma_f32_32x32x16_bf16 v[64:79], v[8:11], v[120:123], v[64:79]
v_mfma_f32_32x32x16_bf16 v[80:95], v[8:11], v[124:127], v[80:95]
ds_read_b128 v[112:115], v0 offset:20480
ds_read_b128 v[116:119], v0 offset:21504
ds_read_b128 v[120:123], v0 offset:22528
ds_read_b128 v[124:127], v0 offset:23552
k_pr_72:
buffer_load_dword v18, v30, s[4:7], s44 offen offset:1024 sc1
s_waitcnt vmcnt(0)
v_cmp_eq_u32 vcc, -1, v18
s_cbranch_vccz k_prd_73
s_sleep 8
s_sub_u32 s32, s32, 1
s_cmp_gt_i32 s32, 0
s_cbranch_scc1 k_pr_72
k_prd_73:
k_ps_74:
buffer_load_dword v96, v31, s[4:7], s45 offen offset:0 sc1
buffer_load_dword v97, v31, s[4:7], s45 offen offset:128 sc1
buffer_load_dword v98, v31, s[4:7], s45 offen offset:256 sc1
buffer_load_dword v99, v31, s[4:7], s45 offen offset:384 sc1
buffer_load_dword v100, v31, s[4:7], s45 offen offset:512 sc1
buffer_load_dword v101, v31, s[4:7], s45 offen offset:640 sc1
buffer_load_dword v102, v31, s[4:7], s45 offen offset:768 sc1
buffer_load_dword v103, v31, s[4:7], s45 offen offset:896 sc1
buffer_load_dword v104, v31, s[4:7], s45 offen offset:1024 sc1
buffer_load_dword v105, v31, s[4:7], s45 offen offset:1152 sc1
buffer_load_dword v106, v31, s[4:7], s45 offen offset:1280 sc1
buffer_load_dword v107, v31, s[4:7], s45 offen offset:1408 sc1
buffer_load_dword v108, v31, s[4:7], s45 offen offset:1536 sc1
buffer_load_dword v109, v31, s[4:7], s45 offen offset:1664 sc1
buffer_load_dword v110, v31, s[4:7], s45 offen offset:1792 sc1
buffer_load_dword v111, v31, s[4:7], s45 offen offset:1920 sc1
buffer_load_dword v20, v31, s[4:7], s45 offen offset:2048 sc1
buffer_load_dword v21, v31, s[4:7], s45 offen offset:2176 sc1
buffer_load_dword v22, v31, s[4:7], s45 offen offset:2304 sc1
buffer_load_dword v23, v31, s[4:7], s45 offen offset:2432 sc1
buffer_load_dword v16, v30, s[4:7], s44 offen offset:0 sc1
buffer_load_dword v17, v30, s[4:7], s44 offen offset:512 sc1
buffer_load_dword v19, v30, s[4:7], s44 offen offset:1536 sc1
s_waitcnt vmcnt(21)
v_add_f32 v96, v96, v97
s_waitcnt vmcnt(20)
v_add_f32 v96, v96, v98
s_waitcnt vmcnt(19)
v_add_f32 v96, v96, v99
s_waitcnt vmcnt(18)
v_add_f32 v96, v96, v100
s_waitcnt vmcnt(17)
v_add_f32 v96, v96, v101
s_waitcnt vmcnt(16)
v_add_f32 v96, v96, v102
s_waitcnt vmcnt(15)
v_add_f32 v96, v96, v103
s_waitcnt vmcnt(14)
v_add_f32 v96, v96, v104
s_waitcnt vmcnt(13)
v_add_f32 v96, v96, v105
s_waitcnt vmcnt(12)
v_add_f32 v96, v96, v106
s_waitcnt vmcnt(11)
v_add_f32 v96, v96, v107
s_waitcnt vmcnt(10)
v_add_f32 v96, v96, v108
s_waitcnt vmcnt(9)
v_add_f32 v96, v96, v109
s_waitcnt vmcnt(8)
v_add_f32 v96, v96, v110
s_waitcnt vmcnt(7)
v_add_f32 v96, v96, v111
s_waitcnt vmcnt(6)
v_add_f32 v96, v96, v20
s_waitcnt vmcnt(5)
v_add_f32 v96, v96, v21
s_waitcnt vmcnt(4)
v_add_f32 v96, v96, v22
s_waitcnt vmcnt(3)
v_add_f32 v96, v96, v23
v_cmp_u_f32 vcc, v96, v96
v_fma_f32 v96, v96, s49, v27
s_cbranch_vccz k_psd_75
s_sub_u32 s32, s32, 1
s_cmp_gt_i32 s32, 0
s_cbranch_scc1 k_ps_74
k_psd_75:
v_rsq_f32 v96, v96
s_add_u32 s45, s45, 20480
ds_write_b32 v24, v96 offset:58368
s_branch k_pyd_77
k_py_76:
buffer_load_dword v16, v30, s[4:7], s44 offen offset:0 sc1
buffer_load_dword v17, v30, s[4:7], s44 offen offset:512 sc1
buffer_load_dword v19, v30, s[4:7], s44 offen offset:1536 sc1
s_sub_u32 s32, s32, 1
k_pyd_77:
s_waitcnt vmcnt(0)
v_max3_u32 v20, v16, v17, v19
v_cmp_eq_u32 vcc, -1, v20
s_cmp_gt_i32 s32, 0
s_cselect_b64 vcc, vcc, 0
s_cbranch_vccnz k_py_76
s_add_u32 s44, s44, 4096
s_waitcnt lgkmcnt(0)
s_barrier
ds_read_b128 v[12:15], v0 offset:58368
v_lshlrev_b32 v180, 16, v16
v_and_b32 v164, 0xffff0000, v16
v_lshlrev_b32 v181, 16, v17
v_and_b32 v165, 0xffff0000, v17
v_lshlrev_b32 v182, 16, v18
v_and_b32 v166, 0xffff0000, v18
v_lshlrev_b32 v183, 16, v19
v_and_b32 v167, 0xffff0000, v19
s_waitcnt lgkmcnt(0)
v_mul_f32 v8, v12, v180
v_mul_f32 v12, v12, v164
v_cvt_pk_bf16_f32 v8, v8, v12
v_and_b32 v8, s47, v8
v_mul_f32 v9, v13, v181
v_mul_f32 v13, v13, v165
v_cvt_pk_bf16_f32 v9, v9, v13
v_and_b32 v9, s47, v9
v_mul_f32 v10, v14, v182
v_mul_f32 v14, v14, v166
v_cvt_pk_bf16_f32 v10, v10, v14
v_and_b32 v10, s47, v10
v_mul_f32 v11, v15, v183
v_mul_f32 v15, v15, v167
v_cvt_pk_bf16_f32 v11, v11, v15
v_and_b32 v11, s47, v11
s_nop 1
v_mfma_f32_32x32x16_bf16 v[32:47], v[8:11], v[112:115], v[32:47]
v_mfma_f32_32x32x16_bf16 v[48:63], v[8:11], v[116:119], v[48:63]
v_mfma_f32_32x32x16_bf16 v[64:79], v[8:11], v[120:123], v[64:79]
v_mfma_f32_32x32x16_bf16 v[80:95], v[8:11], v[124:127], v[80:95]
ds_read_b128 v[112:115], v0 offset:24576
ds_read_b128 v[116:119], v0 offset:25600
ds_read_b128 v[120:123], v0 offset:26624
ds_read_b128 v[124:127], v0 offset:27648
k_pr_78:
buffer_load_dword v18, v30, s[4:7], s44 offen offset:1024 sc1
s_waitcnt vmcnt(0)
v_cmp_eq_u32 vcc, -1, v18
s_cbranch_vccz k_prd_79
s_sleep 8
s_sub_u32 s32, s32, 1
s_cmp_gt_i32 s32, 0
s_cbranch_scc1 k_pr_78
k_prd_79:
k_ps_80:
buffer_load_dword v96, v31, s[4:7], s45 offen offset:0 sc1
buffer_load_dword v97, v31, s[4:7], s45 offen offset:128 sc1
buffer_load_dword v98, v31, s[4:7], s45 offen offset:256 sc1
buffer_load_dword v99, v31, s[4:7], s45 offen offset:384 sc1
buffer_load_dword v100, v31, s[4:7], s45 offen offset:512 sc1
buffer_load_dword v101, v31, s[4:7], s45 offen offset:640 sc1
buffer_load_dword v102, v31, s[4:7], s45 offen offset:768 sc1
buffer_load_dword v103, v31, s[4:7], s45 offen offset:896 sc1
buffer_load_dword v104, v31, s[4:7], s45 offen offset:1024 sc1
buffer_load_dword v105, v31, s[4:7], s45 offen offset:1152 sc1
buffer_load_dword v106, v31, s[4:7], s45 offen offset:1280 sc1
buffer_load_dword v107, v31, s[4:7], s45 offen offset:1408 sc1
buffer_load_dword v108, v31, s[4:7], s45 offen offset:1536 sc1
buffer_load_dword v109, v31, s[4:7], s45 offen offset:1664 sc1
buffer_load_dword v110, v31, s[4:7], s45 offen offset:1792 sc1
buffer_load_dword v111, v31, s[4:7], s45 offen offset:1920 sc1
buffer_load_dword v20, v31, s[4:7], s45 offen offset:2048 sc1
buffer_load_dword v21, v31, s[4:7], s45 offen offset:2176 sc1
buffer_load_dword v22, v31, s[4:7], s45 offen offset:2304 sc1
buffer_load_dword v23, v31, s[4:7], s45 offen offset:2432 sc1
buffer_load_dword v16, v30, s[4:7], s44 offen offset:0 sc1
buffer_load_dword v17, v30, s[4:7], s44 offen offset:512 sc1
buffer_load_dword v19, v30, s[4:7], s44 offen offset:1536 sc1
s_waitcnt vmcnt(21)
v_add_f32 v96, v96, v97
s_waitcnt vmcnt(20)
v_add_f32 v96, v96, v98
s_waitcnt vmcnt(19)
v_add_f32 v96, v96, v99
s_waitcnt vmcnt(18)
v_add_f32 v96, v96, v100
s_waitcnt vmcnt(17)
v_add_f32 v96, v96, v101
s_waitcnt vmcnt(16)
v_add_f32 v96, v96, v102
s_waitcnt vmcnt(15)
v_add_f32 v96, v96, v103
s_waitcnt vmcnt(14)
v_add_f32 v96, v96, v104
s_waitcnt vmcnt(13)
v_add_f32 v96, v96, v105
s_waitcnt vmcnt(12)
v_add_f32 v96, v96, v106
s_waitcnt vmcnt(11)
v_add_f32 v96, v96, v107
s_waitcnt vmcnt(10)
v_add_f32 v96, v96, v108
s_waitcnt vmcnt(9)
v_add_f32 v96, v96, v109
s_waitcnt vmcnt(8)
v_add_f32 v96, v96, v110
s_waitcnt vmcnt(7)
v_add_f32 v96, v96, v111
s_waitcnt vmcnt(6)
v_add_f32 v96, v96, v20
s_waitcnt vmcnt(5)
v_add_f32 v96, v96, v21
s_waitcnt vmcnt(4)
v_add_f32 v96, v96, v22
s_waitcnt vmcnt(3)
v_add_f32 v96, v96, v23
v_cmp_u_f32 vcc, v96, v96
v_fma_f32 v96, v96, s49, v27
s_cbranch_vccz k_psd_81
s_sub_u32 s32, s32, 1
s_cmp_gt_i32 s32, 0
s_cbranch_scc1 k_ps_80
k_psd_81:
v_rsq_f32 v96, v96
s_add_u32 s45, s45, 20480
ds_write_b32 v24, v96 offset:57344
s_branch k_pyd_83
k_py_82:
buffer_load_dword v16, v30, s[4:7], s44 offen offset:0 sc1
buffer_load_dword v17, v30, s[4:7], s44 offen offset:512 sc1
buffer_load_dword v19, v30, s[4:7], s44 offen offset:1536 sc1
s_sub_u32 s32, s32, 1
k_pyd_83:
s_waitcnt vmcnt(0)
v_max3_u32 v20, v16, v17, v19
v_cmp_eq_u32 vcc, -1, v20
s_cmp_gt_i32 s32, 0
s_cselect_b64 vcc, vcc, 0
s_cbranch_vccnz k_py_82
s_add_u32 s44, s44, 4096
s_waitcnt lgkmcnt(0)
s_barrier
ds_read_b128 v[12:15], v0 offset:57344
v_lshlrev_b32 v184, 16, v16
v_and_b32 v168, 0xffff0000, v16
v_lshlrev_b32 v185, 16, v17
v_and_b32 v169, 0xffff0000, v17
v_lshlrev_b32 v186, 16, v18
v_and_b32 v170, 0xffff0000, v18
v_lshlrev_b32 v187, 16, v19
v_and_b32 v171, 0xffff0000, v19
s_waitcnt lgkmcnt(0)
v_mul_f32 v8, v12, v184
v_mul_f32 v12, v12, v168
v_cvt_pk_bf16_f32 v8, v8, v12
v_and_b32 v8, s47, v8
v_mul_f32 v9, v13, v185
v_mul_f32 v13, v13, v169
v_cvt_pk_bf16_f32 v9, v9, v13
v_and_b32 v9, s47, v9
v_mul_f32 v10, v14, v186
v_mul_f32 v14, v14, v170
v_cvt_pk_bf16_f32 v10, v10, v14
v_and_b32 v10, s47, v10
v_mul_f32 v11, v15, v187
v_mul_f32 v15, v15, v171
v_cvt_pk_bf16_f32 v11, v11, v15
v_and_b32 v11, s47, v11
s_nop 1
v_mfma_f32_32x32x16_bf16 v[32:47], v[8:11], v[112:115], v[32:47]
v_mfma_f32_32x32x16_bf16 v[48:63], v[8:11], v[116:119], v[48:63]
v_mfma_f32_32x32x16_bf16 v[64:79], v[8:11], v[120:123], v[64:79]
v_mfma_f32_32x32x16_bf16 v[80:95], v[8:11], v[124:127], v[80:95]
ds_read_b128 v[112:115], v0 offset:28672
ds_read_b128 v[116:119], v0 offset:29696
ds_read_b128 v[120:123], v0 offset:30720
ds_read_b128 v[124:127], v0 offset:31744
k_pr_84:
buffer_load_dword v18, v30, s[4:7], s44 offen offset:1024 sc1
s_waitcnt vmcnt(0)
v_cmp_eq_u32 vcc, -1, v18
s_cbranch_vccz k_prd_85
s_sleep 8
s_sub_u32 s32, s32, 1
s_cmp_gt_i32 s32, 0
s_cbranch_scc1 k_pr_84
k_prd_85:
k_ps_86:
buffer_load_dword v96, v31, s[4:7], s45 offen offset:0 sc1
buffer_load_dword v97, v31, s[4:7], s45 offen offset:128 sc1
buffer_load_dword v98, v31, s[4:7], s45 offen offset:256 sc1
buffer_load_dword v99, v31, s[4:7], s45 offen offset:384 sc1
buffer_load_dword v100, v31, s[4:7], s45 offen offset:512 sc1
buffer_load_dword v101, v31, s[4:7], s45 offen offset:640 sc1
buffer_load_dword v102, v31, s[4:7], s45 offen offset:768 sc1
buffer_load_dword v103, v31, s[4:7], s45 offen offset:896 sc1
buffer_load_dword v104, v31, s[4:7], s45 offen offset:1024 sc1
buffer_load_dword v105, v31, s[4:7], s45 offen offset:1152 sc1
buffer_load_dword v106, v31, s[4:7], s45 offen offset:1280 sc1
buffer_load_dword v107, v31, s[4:7], s45 offen offset:1408 sc1
buffer_load_dword v108, v31, s[4:7], s45 offen offset:1536 sc1
buffer_load_dword v109, v31, s[4:7], s45 offen offset:1664 sc1
buffer_load_dword v110, v31, s[4:7], s45 offen offset:1792 sc1
buffer_load_dword v111, v31, s[4:7], s45 offen offset:1920 sc1
buffer_load_dword v20, v31, s[4:7], s45 offen offset:2048 sc1
buffer_load_dword v21, v31, s[4:7], s45 offen offset:2176 sc1
buffer_load_dword v22, v31, s[4:7], s45 offen offset:2304 sc1
buffer_load_dword v23, v31, s[4:7], s45 offen offset:2432 sc1
buffer_load_dword v16, v30, s[4:7], s44 offen offset:0 sc1
buffer_load_dword v17, v30, s[4:7], s44 offen offset:512 sc1
buffer_load_dword v19, v30, s[4:7], s44 offen offset:1536 sc1
s_waitcnt vmcnt(21)
v_add_f32 v96, v96, v97
s_waitcnt vmcnt(20)
v_add_f32 v96, v96, v98
s_waitcnt vmcnt(19)
v_add_f32 v96, v96, v99
s_waitcnt vmcnt(18)
v_add_f32 v96, v96, v100
s_waitcnt vmcnt(17)
v_add_f32 v96, v96, v101
s_waitcnt vmcnt(16)
v_add_f32 v96, v96, v102
s_waitcnt vmcnt(15)
v_add_f32 v96, v96, v103
s_waitcnt vmcnt(14)
v_add_f32 v96, v96, v104
s_waitcnt vmcnt(13)
v_add_f32 v96, v96, v105
s_waitcnt vmcnt(12)
v_add_f32 v96, v96, v106
s_waitcnt vmcnt(11)
v_add_f32 v96, v96, v107
s_waitcnt vmcnt(10)
v_add_f32 v96, v96, v108
s_waitcnt vmcnt(9)
v_add_f32 v96, v96, v109
s_waitcnt vmcnt(8)
v_add_f32 v96, v96, v110
s_waitcnt vmcnt(7)
v_add_f32 v96, v96, v111
s_waitcnt vmcnt(6)
v_add_f32 v96, v96, v20
s_waitcnt vmcnt(5)
v_add_f32 v96, v96, v21
s_waitcnt vmcnt(4)
v_add_f32 v96, v96, v22
s_waitcnt vmcnt(3)
v_add_f32 v96, v96, v23
v_cmp_u_f32 vcc, v96, v96
v_fma_f32 v96, v96, s49, v27
s_cbranch_vccz k_psd_87
s_sub_u32 s32, s32, 1
s_cmp_gt_i32 s32, 0
s_cbranch_scc1 k_ps_86
k_psd_87:
v_rsq_f32 v96, v96
s_add_u32 s45, s45, 20480
ds_write_b32 v24, v96 offset:58368
s_branch k_pyd_89
k_py_88:
buffer_load_dword v16, v30, s[4:7], s44 offen offset:0 sc1
buffer_load_dword v17, v30, s[4:7], s44 offen offset:512 sc1
buffer_load_dword v19, v30, s[4:7], s44 offen offset:1536 sc1
s_sub_u32 s32, s32, 1
k_pyd_89:
s_waitcnt vmcnt(0)
v_max3_u32 v20, v16, v17, v19
v_cmp_eq_u32 vcc, -1, v20
s_cmp_gt_i32 s32, 0
s_cselect_b64 vcc, vcc, 0
s_cbranch_vccnz k_py_88
s_add_u32 s44, s44, 4096
s_waitcnt lgkmcnt(0)
s_barrier
ds_read_b128 v[12:15], v0 offset:58368
v_lshlrev_b32 v188, 16, v16
v_and_b32 v172, 0xffff0000, v16
v_lshlrev_b32 v189, 16, v17
v_and_b32 v173, 0xffff0000, v17
v_lshlrev_b32 v190, 16, v18
v_and_b32 v174, 0xffff0000, v18
v_lshlrev_b32 v191, 16, v19
v_and_b32 v175, 0xffff0000, v19
s_waitcnt lgkmcnt(0)
v_mul_f32 v8, v12, v188
v_mul_f32 v12, v12, v172
v_cvt_pk_bf16_f32 v8, v8, v12
v_and_b32 v8, s47, v8
v_mul_f32 v9, v13, v189
v_mul_f32 v13, v13, v173
v_cvt_pk_bf16_f32 v9, v9, v13
v_and_b32 v9, s47, v9
v_mul_f32 v10, v14, v190
v_mul_f32 v14, v14, v174
v_cvt_pk_bf16_f32 v10, v10, v14
v_and_b32 v10, s47, v10
v_mul_f32 v11, v15, v191
v_mul_f32 v15, v15, v175
v_cvt_pk_bf16_f32 v11, v11, v15
v_and_b32 v11, s47, v11
s_nop 1
v_mfma_f32_32x32x16_bf16 v[32:47], v[8:11], v[112:115], v[32:47]
v_mfma_f32_32x32x16_bf16 v[48:63], v[8:11], v[116:119], v[48:63]
v_mfma_f32_32x32x16_bf16 v[64:79], v[8:11], v[120:123], v[64:79]
v_mfma_f32_32x32x16_bf16 v[80:95], v[8:11], v[124:127], v[80:95]
ds_read_b128 v[112:115], v0 offset:32768
ds_read_b128 v[116:119], v0 offset:33792
ds_read_b128 v[120:123], v0 offset:34816
ds_read_b128 v[124:127], v0 offset:35840
s_waitcnt lgkmcnt(3)
v_mul_f32 v8, v32, v112
v_mul_f32 v9, v48, v112
s_waitcnt lgkmcnt(2)
v_fmac_f32 v8, v48, v116
v_fma_f32 v9, -v32, v116, v9
v_cvt_pk_bf16_f32 v32, v8, v9
v_mul_f32 v10, v33, v113
v_mul_f32 v11, v49, v113
v_fmac_f32 v10, v49, v117
v_fma_f32 v11, -v33, v117, v11
v_cvt_pk_bf16_f32 v33, v10, v11
v_mul_f32 v8, v34, v114
v_mul_f32 v9, v50, v114
v_fmac_f32 v8, v50, v118
v_fma_f32 v9, -v34, v118, v9
v_cvt_pk_bf16_f32 v34, v8, v9
v_mul_f32 v10, v35, v115
v_mul_f32 v11, v51, v115
v_fmac_f32 v10, v51, v119
v_fma_f32 v11, -v35, v119, v11
v_cvt_pk_bf16_f32 v35, v10, v11
ds_read_b128 v[112:115], v0 offset:36864
ds_read_b128 v[116:119], v0 offset:37888
s_waitcnt lgkmcnt(3)
v_mul_f32 v8, v36, v120
v_mul_f32 v9, v52, v120
s_waitcnt lgkmcnt(2)
v_fmac_f32 v8, v52, v124
v_fma_f32 v9, -v36, v124, v9
v_cvt_pk_bf16_f32 v36, v8, v9
v_mul_f32 v10, v37, v121
v_mul_f32 v11, v53, v121
v_fmac_f32 v10, v53, v125
v_fma_f32 v11, -v37, v125, v11
v_cvt_pk_bf16_f32 v37, v10, v11
v_mul_f32 v8, v38, v122
v_mul_f32 v9, v54, v122
v_fmac_f32 v8, v54, v126
v_fma_f32 v9, -v38, v126, v9
v_cvt_pk_bf16_f32 v38, v8, v9
v_mul_f32 v10, v39, v123
v_mul_f32 v11, v55, v123
v_fmac_f32 v10, v55, v127
v_fma_f32 v11, -v39, v127, v11
v_cvt_pk_bf16_f32 v39, v10, v11
ds_read_b128 v[120:123], v0 offset:38912
ds_read_b128 v[124:127], v0 offset:39936
s_waitcnt lgkmcnt(3)
v_mul_f32 v8, v40, v112
v_mul_f32 v9, v56, v112
s_waitcnt lgkmcnt(2)
v_fmac_f32 v8, v56, v116
v_fma_f32 v9, -v40, v116, v9
v_cvt_pk_bf16_f32 v40, v8, v9
v_mul_f32 v10, v41, v113
v_mul_f32 v11, v57, v113
v_fmac_f32 v10, v57, v117
v_fma_f32 v11, -v41, v117, v11
v_cvt_pk_bf16_f32 v41, v10, v11
v_mul_f32 v8, v42, v114
v_mul_f32 v9, v58, v114
v_fmac_f32 v8, v58, v118
v_fma_f32 v9, -v42, v118, v9
v_cvt_pk_bf16_f32 v42, v8, v9
v_mul_f32 v10, v43, v115
v_mul_f32 v11, v59, v115
v_fmac_f32 v10, v59, v119
v_fma_f32 v11, -v43, v119, v11
v_cvt_pk_bf16_f32 v43, v10, v11
ds_read_b128 v[112:115], v0 offset:40960
ds_read_b128 v[116:119], v0 offset:41984
s_waitcnt lgkmcnt(3)
v_mul_f32 v8, v44, v120
v_mul_f32 v9, v60, v120
s_waitcnt lgkmcnt(2)
v_fmac_f32 v8, v60, v124
v_fma_f32 v9, -v44, v124, v9
v_cvt_pk_bf16_f32 v44, v8, v9
v_mul_f32 v10, v45, v121
v_mul_f32 v11, v61, v121
v_fmac_f32 v10, v61, v125
v_fma_f32 v11, -v45, v125, v11
v_cvt_pk_bf16_f32 v45, v10, v11
v_mul_f32 v8, v46, v122
v_mul_f32 v9, v62, v122
v_fmac_f32 v8, v62, v126
v_fma_f32 v9, -v46, v126, v9
v_cvt_pk_bf16_f32 v46, v8, v9
v_mul_f32 v10, v47, v123
v_mul_f32 v11, v63, v123
v_fmac_f32 v10, v63, v127
v_fma_f32 v11, -v47, v127, v11
v_cvt_pk_bf16_f32 v47, v10, v11
ds_read_b128 v[120:123], v0 offset:43008
ds_read_b128 v[124:127], v0 offset:44032
v_mfma_f32_32x32x16_bf16 v[48:63], a[160:163], v[32:35], 0
s_waitcnt lgkmcnt(3)
v_mul_f32 v8, v64, v112
v_mul_f32 v9, v80, v112
s_waitcnt lgkmcnt(2)
v_fmac_f32 v8, v80, v116
v_fma_f32 v9, -v64, v116, v9
v_cvt_pk_bf16_f32 v64, v8, v9
v_mul_f32 v10, v65, v113
v_mul_f32 v11, v81, v113
v_fmac_f32 v10, v81, v117
v_mfma_f32_32x32x16_bf16 v[96:111], a[164:167], v[32:35], 0
v_fma_f32 v11, -v65, v117, v11
v_cvt_pk_bf16_f32 v65, v10, v11
v_mul_f32 v8, v66, v114
v_mul_f32 v9, v82, v114
v_fmac_f32 v8, v82, v118
v_fma_f32 v9, -v66, v118, v9
v_cvt_pk_bf16_f32 v66, v8, v9
v_mul_f32 v10, v67, v115
v_mfma_f32_32x32x16_bf16 v[48:63], a[168:171], v[36:39], v[48:63]
v_mul_f32 v11, v83, v115
v_fmac_f32 v10, v83, v119
v_fma_f32 v11, -v67, v119, v11
v_cvt_pk_bf16_f32 v67, v10, v11
ds_read_b128 v[112:115], v0 offset:45056
ds_read_b128 v[116:119], v0 offset:46080
s_waitcnt lgkmcnt(3)
v_mul_f32 v8, v68, v120
v_mul_f32 v9, v84, v120
v_mfma_f32_32x32x16_bf16 v[96:111], a[172:175], v[36:39], v[96:111]
s_waitcnt lgkmcnt(2)
v_fmac_f32 v8, v84, v124
v_fma_f32 v9, -v68, v124, v9
v_cvt_pk_bf16_f32 v68, v8, v9
v_mul_f32 v10, v69, v121
v_mul_f32 v11, v85, v121
v_fmac_f32 v10, v85, v125
v_fma_f32 v11, -v69, v125, v11
v_cvt_pk_bf16_f32 v69, v10, v11
v_mfma_f32_32x32x16_bf16 v[48:63], a[176:179], v[40:43], v[48:63]
v_mul_f32 v8, v70, v122
v_mul_f32 v9, v86, v122
v_fmac_f32 v8, v86, v126
v_fma_f32 v9, -v70, v126, v9
v_cvt_pk_bf16_f32 v70, v8, v9
v_mul_f32 v10, v71, v123
v_mul_f32 v11, v87, v123
v_fmac_f32 v10, v87, v127
v_mfma_f32_32x32x16_bf16 v[96:111], a[180:183], v[40:43], v[96:111]
v_fma_f32 v11, -v71, v127, v11
v_cvt_pk_bf16_f32 v71, v10, v11
ds_read_b128 v[120:123], v0 offset:47104
ds_read_b128 v[124:127], v0 offset:48128
s_waitcnt lgkmcnt(3)
v_mul_f32 v8, v72, v112
v_mul_f32 v9, v88, v112
s_waitcnt lgkmcnt(2)
v_fmac_f32 v8, v88, v116
v_fma_f32 v9, -v72, v116, v9
v_mfma_f32_32x32x16_bf16 v[48:63], a[184:187], v[44:47], v[48:63]
v_cvt_pk_bf16_f32 v72, v8, v9
v_mul_f32 v10, v73, v113
v_mul_f32 v11, v89, v113
v_fmac_f32 v10, v89, v117
v_fma_f32 v11, -v73, v117, v11
v_cvt_pk_bf16_f32 v73, v10, v11
v_mul_f32 v8, v74, v114
v_mul_f32 v9, v90, v114
v_mfma_f32_32x32x16_bf16 v[96:111], a[188:191], v[44:47], v[96:111]
v_fmac_f32 v8, v90, v118
v_fma_f32 v9, -v74, v118, v9
v_cvt_pk_bf16_f32 v74, v8, v9
v_mul_f32 v10, v75, v115
v_mul_f32 v11, v91, v115
v_fmac_f32 v10, v91, v119
v_fma_f32 v11, -v75, v119, v11
v_cvt_pk_bf16_f32 v75, v10, v11
ds_read_b128 v[112:115], v0 offset:32768
ds_read_b128 v[116:119], v0 offset:33792
s_waitcnt lgkmcnt(3)
v_mul_f32 v8, v76, v120
v_mul_f32 v9, v92, v120
s_waitcnt lgkmcnt(2)
v_fmac_f32 v8, v92, v124
v_fma_f32 v9, -v76, v124, v9
v_cvt_pk_bf16_f32 v76, v8, v9
v_mul_f32 v10, v77, v121
v_mul_f32 v11, v93, v121
v_fmac_f32 v10, v93, v125
v_fma_f32 v11, -v77, v125, v11
v_cvt_pk_bf16_f32 v77, v10, v11
v_mul_f32 v8, v78, v122
v_mul_f32 v9, v94, v122
v_fmac_f32 v8, v94, v126
v_fma_f32 v9, -v78, v126, v9
v_cvt_pk_bf16_f32 v78, v8, v9
v_mul_f32 v10, v79, v123
v_mul_f32 v11, v95, v123
v_fmac_f32 v10, v95, v127
v_fma_f32 v11, -v79, v127, v11
v_cvt_pk_bf16_f32 v79, v10, v11
ds_read_b128 v[120:123], v0 offset:34816
ds_read_b128 v[124:127], v0 offset:35840
v_mfma_f32_32x32x16_bf16 v[80:95], a[160:163], v[64:67], 0
v_mul_f32 v8, v48, v208
v_mul_f32 v9, v96, v208
v_fmac_f32 v8, v96, v192
v_fma_f32 v9, v48, v192, -v9
v_cvt_pk_bf16_f32 v48, v8, v9
v_mul_f32 v10, v49, v209
v_mul_f32 v11, v97, v209
v_fmac_f32 v10, v97, v193
v_mfma_f32_32x32x16_bf16 v[32:47], a[164:167], v[64:67], 0
v_fma_f32 v11, v49, v193, -v11
v_cvt_pk_bf16_f32 v49, v10, v11
v_mul_f32 v8, v50, v210
v_mul_f32 v9, v98, v210
v_fmac_f32 v8, v98, v194
v_fma_f32 v9, v50, v194, -v9
v_cvt_pk_bf16_f32 v50, v8, v9
v_mul_f32 v10, v51, v211
v_mfma_f32_32x32x16_bf16 v[80:95], a[168:171], v[68:71], v[80:95]
v_mul_f32 v11, v99, v211
v_fmac_f32 v10, v99, v195
v_fma_f32 v11, v51, v195, -v11
v_cvt_pk_bf16_f32 v51, v10, v11
v_mul_f32 v8, v52, v212
v_mul_f32 v9, v100, v212
v_fmac_f32 v8, v100, v196
v_fma_f32 v9, v52, v196, -v9
v_mfma_f32_32x32x16_bf16 v[32:47], a[172:175], v[68:71], v[32:47]
v_cvt_pk_bf16_f32 v52, v8, v9
v_mul_f32 v10, v53, v213
v_mul_f32 v11, v101, v213
v_fmac_f32 v10, v101, v197
v_fma_f32 v11, v53, v197, -v11
v_cvt_pk_bf16_f32 v53, v10, v11
v_mul_f32 v8, v54, v214
v_mul_f32 v9, v102, v214
v_mfma_f32_32x32x16_bf16 v[80:95], a[176:179], v[72:75], v[80:95]
v_fmac_f32 v8, v102, v198
v_fma_f32 v9, v54, v198, -v9
v_cvt_pk_bf16_f32 v54, v8, v9
v_mul_f32 v10, v55, v215
v_mul_f32 v11, v103, v215
v_fmac_f32 v10, v103, v199
v_fma_f32 v11, v55, v199, -v11
v_cvt_pk_bf16_f32 v55, v10, v11
v_mfma_f32_32x32x16_bf16 v[32:47], a[180:183], v[72:75], v[32:47]
v_mul_f32 v8, v56, v216
v_mul_f32 v9, v104, v216
v_fmac_f32 v8, v104, v200
v_fma_f32 v9, v56, v200, -v9
v_cvt_pk_bf16_f32 v56, v8, v9
v_mul_f32 v10, v57, v217
v_mul_f32 v11, v105, v217
v_fmac_f32 v10, v105, v201
v_mfma_f32_32x32x16_bf16 v[80:95], a[184:187], v[76:79], v[80:95]
v_fma_f32 v11, v57, v201, -v11
v_cvt_pk_bf16_f32 v57, v10, v11
v_mul_f32 v8, v58, v218
v_mul_f32 v9, v106, v218
v_fmac_f32 v8, v106, v202
v_fma_f32 v9, v58, v202, -v9
v_cvt_pk_bf16_f32 v58, v8, v9
v_mul_f32 v10, v59, v219
v_mfma_f32_32x32x16_bf16 v[32:47], a[188:191], v[76:79], v[32:47]
v_mul_f32 v11, v107, v219
v_fmac_f32 v10, v107, v203
v_fma_f32 v11, v59, v203, -v11
v_cvt_pk_bf16_f32 v59, v10, v11
v_mul_f32 v8, v60, v220
v_mul_f32 v9, v108, v220
v_fmac_f32 v8, v108, v204
v_fma_f32 v9, v60, v204, -v9
v_cvt_pk_bf16_f32 v60, v8, v9
v_mul_f32 v10, v61, v221
v_mul_f32 v11, v109, v221
v_fmac_f32 v10, v109, v205
v_fma_f32 v11, v61, v205, -v11
v_cvt_pk_bf16_f32 v61, v10, v11
v_mul_f32 v8, v62, v222
v_mul_f32 v9, v110, v222
v_fmac_f32 v8, v110, v206
v_fma_f32 v9, v62, v206, -v9
v_cvt_pk_bf16_f32 v62, v8, v9
v_mul_f32 v10, v63, v223
v_mul_f32 v11, v111, v223
v_fmac_f32 v10, v111, v207
v_fma_f32 v11, v63, v207, -v11
v_cvt_pk_bf16_f32 v63, v10, v11
v_mfma_f32_32x32x16_bf16 v[96:111], v[48:51], a[160:163], 0
v_mul_f32 v8, v80, v240
v_mul_f32 v9, v32, v240
v_fmac_f32 v8, v32, v224
v_fma_f32 v9, v80, v224, -v9
v_cvt_pk_bf16_f32 v80, v8, v9
v_mul_f32 v10, v81, v241
v_mul_f32 v11, v33, v241
v_fmac_f32 v10, v33, v225
v_mfma_f32_32x32x16_bf16 v[64:79], v[48:51], a[164:167], 0
v_fma_f32 v11, v81, v225, -v11
v_cvt_pk_bf16_f32 v81, v10, v11
v_mul_f32 v8, v82, v242
v_mul_f32 v9, v34, v242
v_fmac_f32 v8, v34, v226
v_fma_f32 v9, v82, v226, -v9
v_cvt_pk_bf16_f32 v82, v8, v9
v_mul_f32 v10, v83, v243
v_mfma_f32_32x32x16_bf16 v[96:111], v[52:55], a[168:171], v[96:111]
v_mul_f32 v11, v35, v243
v_fmac_f32 v10, v35, v227
v_fma_f32 v11, v83, v227, -v11
v_cvt_pk_bf16_f32 v83, v10, v11
v_mul_f32 v8, v84, v244
v_mul_f32 v9, v36, v244
v_fmac_f32 v8, v36, v228
v_fma_f32 v9, v84, v228, -v9
v_mfma_f32_32x32x16_bf16 v[64:79], v[52:55], a[172:175], v[64:79]
v_cvt_pk_bf16_f32 v84, v8, v9
v_mul_f32 v10, v85, v245
v_mul_f32 v11, v37, v245
v_fmac_f32 v10, v37, v229
v_fma_f32 v11, v85, v229, -v11
v_cvt_pk_bf16_f32 v85, v10, v11
v_mul_f32 v8, v86, v246
v_mul_f32 v9, v38, v246
v_mfma_f32_32x32x16_bf16 v[96:111], v[56:59], a[176:179], v[96:111]
v_fmac_f32 v8, v38, v230
v_fma_f32 v9, v86, v230, -v9
v_cvt_pk_bf16_f32 v86, v8, v9
v_mul_f32 v10, v87, v247
v_mul_f32 v11, v39, v247
v_fmac_f32 v10, v39, v231
v_fma_f32 v11, v87, v231, -v11
v_cvt_pk_bf16_f32 v87, v10, v11
v_mfma_f32_32x32x16_bf16 v[64:79], v[56:59], a[180:183], v[64:79]
v_mul_f32 v8, v88, v248
v_mul_f32 v9, v40, v248
v_fmac_f32 v8, v40, v232
v_fma_f32 v9, v88, v232, -v9
v_cvt_pk_bf16_f32 v88, v8, v9
v_mul_f32 v10, v89, v249
v_mul_f32 v11, v41, v249
v_fmac_f32 v10, v41, v233
v_mfma_f32_32x32x16_bf16 v[96:111], v[60:63], a[184:187], v[96:111]
v_fma_f32 v11, v89, v233, -v11
v_cvt_pk_bf16_f32 v89, v10, v11
v_mul_f32 v8, v90, v250
v_mul_f32 v9, v42, v250
v_fmac_f32 v8, v42, v234
v_fma_f32 v9, v90, v234, -v9
v_cvt_pk_bf16_f32 v90, v8, v9
v_mul_f32 v10, v91, v251
v_mfma_f32_32x32x16_bf16 v[64:79], v[60:63], a[188:191], v[64:79]
v_mul_f32 v11, v43, v251
v_fmac_f32 v10, v43, v235
v_fma_f32 v11, v91, v235, -v11
v_cvt_pk_bf16_f32 v91, v10, v11
v_mul_f32 v8, v92, v252
v_mul_f32 v9, v44, v252
v_fmac_f32 v8, v44, v236
v_fma_f32 v9, v92, v236, -v9
v_cvt_pk_bf16_f32 v92, v8, v9
v_mul_f32 v10, v93, v253
v_mul_f32 v11, v45, v253
v_fmac_f32 v10, v45, v237
v_fma_f32 v11, v93, v237, -v11
v_cvt_pk_bf16_f32 v93, v10, v11
v_mul_f32 v8, v94, v254
v_mul_f32 v9, v46, v254
v_fmac_f32 v8, v46, v238
v_fma_f32 v9, v94, v238, -v9
v_cvt_pk_bf16_f32 v94, v8, v9
v_mul_f32 v10, v95, v255
v_mul_f32 v11, v47, v255
v_fmac_f32 v10, v47, v239
v_fma_f32 v11, v95, v239, -v11
v_cvt_pk_bf16_f32 v95, v10, v11
v_mfma_f32_32x32x16_bf16 v[32:47], v[80:83], a[160:163], 0
s_waitcnt lgkmcnt(3)
v_mul_f32 v8, v96, v112
v_mul_f32 v9, v64, v112
s_waitcnt lgkmcnt(2)
v_fmac_f32 v8, v64, v116
v_fma_f32 v9, -v96, v116, v9
v_cvt_pk_bf16_f32 v96, v8, v9
v_mul_f32 v10, v97, v113
v_mul_f32 v11, v65, v113
v_fmac_f32 v10, v65, v117
v_mfma_f32_32x32x16_bf16 v[48:63], v[80:83], a[164:167], 0
v_fma_f32 v11, -v97, v117, v11
v_cvt_pk_bf16_f32 v97, v10, v11
v_mul_f32 v8, v98, v114
v_mul_f32 v9, v66, v114
v_fmac_f32 v8, v66, v118
v_fma_f32 v9, -v98, v118, v9
v_cvt_pk_bf16_f32 v98, v8, v9
v_mul_f32 v10, v99, v115
v_mfma_f32_32x32x16_bf16 v[32:47], v[84:87], a[168:171], v[32:47]
v_mul_f32 v11, v67, v115
v_fmac_f32 v10, v67, v119
v_fma_f32 v11, -v99, v119, v11
v_cvt_pk_bf16_f32 v99, v10, v11
ds_read_b128 v[112:115], v0 offset:36864
ds_read_b128 v[116:119], v0 offset:37888
s_waitcnt lgkmcnt(3)
v_mul_f32 v8, v100, v120
v_mul_f32 v9, v68, v120
v_mfma_f32_32x32x16_bf16 v[48:63], v[84:87], a[172:175], v[48:63]
s_waitcnt lgkmcnt(2)
v_fmac_f32 v8, v68, v124
v_fma_f32 v9, -v100, v124, v9
v_cvt_pk_bf16_f32 v100, v8, v9
v_mul_f32 v10, v101, v121
v_mul_f32 v11, v69, v121
v_fmac_f32 v10, v69, v125
v_fma_f32 v11, -v101, v125, v11
v_cvt_pk_bf16_f32 v101, v10, v11
v_mfma_f32_32x32x16_bf16 v[32:47], v[88:91], a[176:179], v[32:47]
v_mul_f32 v8, v102, v122
v_mul_f32 v9, v70, v122
v_fmac_f32 v8, v70, v126
v_fma_f32 v9, -v102, v126, v9
v_cvt_pk_bf16_f32 v102, v8, v9
v_mul_f32 v10, v103, v123
v_mul_f32 v11, v71, v123
v_fmac_f32 v10, v71, v127
v_mfma_f32_32x32x16_bf16 v[48:63], v[88:91], a[180:183], v[48:63]
v_fma_f32 v11, -v103, v127, v11
v_cvt_pk_bf16_f32 v103, v10, v11
ds_read_b128 v[120:123], v0 offset:38912
ds_read_b128 v[124:127], v0 offset:39936
s_waitcnt lgkmcnt(3)
v_mul_f32 v8, v104, v112
v_mul_f32 v9, v72, v112
s_waitcnt lgkmcnt(2)
v_fmac_f32 v8, v72, v116
v_fma_f32 v9, -v104, v116, v9
v_mfma_f32_32x32x16_bf16 v[32:47], v[92:95], a[184:187], v[32:47]
v_cvt_pk_bf16_f32 v104, v8, v9
v_mul_f32 v10, v105, v113
v_mul_f32 v11, v73, v113
v_fmac_f32 v10, v73, v117
v_fma_f32 v11, -v105, v117, v11
v_cvt_pk_bf16_f32 v105, v10, v11
v_mul_f32 v8, v106, v114
v_mul_f32 v9, v74, v114
v_mfma_f32_32x32x16_bf16 v[48:63], v[92:95], a[188:191], v[48:63]
v_fmac_f32 v8, v74, v118
v_fma_f32 v9, -v106, v118, v9
v_cvt_pk_bf16_f32 v106, v8, v9
v_mul_f32 v10, v107, v115
v_mul_f32 v11, v75, v115
v_fmac_f32 v10, v75, v119
v_fma_f32 v11, -v107, v119, v11
v_cvt_pk_bf16_f32 v107, v10, v11
ds_read_b128 v[112:115], v0 offset:49152
ds_read_b128 v[116:119], v0 offset:50176
s_waitcnt lgkmcnt(3)
v_mul_f32 v8, v108, v120
v_mul_f32 v9, v76, v120
s_waitcnt lgkmcnt(2)
v_fmac_f32 v8, v76, v124
v_fma_f32 v9, -v108, v124, v9
v_cvt_pk_bf16_f32 v108, v8, v9
v_mul_f32 v10, v109, v121
v_mul_f32 v11, v77, v121
v_fmac_f32 v10, v77, v125
v_fma_f32 v11, -v109, v125, v11
v_cvt_pk_bf16_f32 v109, v10, v11
v_mul_f32 v8, v110, v122
v_mul_f32 v9, v78, v122
v_fmac_f32 v8, v78, v126
v_fma_f32 v9, -v110, v126, v9
v_cvt_pk_bf16_f32 v110, v8, v9
v_mul_f32 v10, v111, v123
v_mul_f32 v11, v79, v123
v_fmac_f32 v10, v79, v127
v_fma_f32 v11, -v111, v127, v11
v_cvt_pk_bf16_f32 v111, v10, v11
ds_read_b128 v[120:123], v0 offset:51200
ds_read_b128 v[124:127], v0 offset:52224
ds_read_b128 v[80:83], v26 offset:0
ds_read_b128 v[84:87], v0 offset:1024
ds_read_b128 v[88:91], v26 offset:2048
ds_read_b128 v[92:95], v0 offset:3072
ds_read_b128 v[64:67], v26 offset:4096
ds_read_b128 v[68:71], v0 offset:5120
s_lshl_b32 s52, s3, 10
v_add_u32 v20, s52, v0
v_add_u32 v20, 65536, v20
s_waitcnt lgkmcnt(5)
v_mfma_f32_32x32x16_bf16 v[128:143], v[80:83], v[96:99], v[128:143]
ds_read_b128 v[72:75], v26 offset:6144
v_mul_f32 v8, v32, v112
v_mul_f32 v9, v48, v112
v_fmac_f32 v8, v48, v116
v_fma_f32 v9, -v32, v116, v9
v_cvt_pk_bf16_f32 v32, v8, v9
v_mul_f32 v10, v33, v113
s_waitcnt lgkmcnt(5)
v_mfma_f32_32x32x16_bf16 v[144:159], v[84:87], v[96:99], v[144:159]
ds_read_b128 v[76:79], v0 offset:7168
v_mul_f32 v11, v49, v113
v_fmac_f32 v10, v49, v117
v_fma_f32 v11, -v33, v117, v11
v_cvt_pk_bf16_f32 v33, v10, v11
v_mul_f32 v8, v34, v114
v_mul_f32 v9, v50, v114
s_waitcnt lgkmcnt(5)
v_mfma_f32_32x32x16_bf16 v[160:175], v[88:91], v[96:99], v[160:175]
ds_read_b128 v[80:83], v26 offset:8192
v_fmac_f32 v8, v50, v118
v_fma_f32 v9, -v34, v118, v9
v_cvt_pk_bf16_f32 v34, v8, v9
v_mul_f32 v10, v35, v115
v_mul_f32 v11, v51, v115
v_fmac_f32 v10, v51, v119
s_waitcnt lgkmcnt(5)
v_mfma_f32_32x32x16_bf16 v[176:191], v[92:95], v[96:99], v[176:191]
ds_read_b128 v[84:87], v0 offset:9216
v_fma_f32 v11, -v35, v119, v11
v_cvt_pk_bf16_f32 v35, v10, v11
ds_read_b128 v[112:115], v0 offset:53248
ds_read_b128 v[116:119], v0 offset:54272
v_mul_f32 v8, v36, v120
v_mul_f32 v9, v52, v120
s_waitcnt lgkmcnt(7)
v_mfma_f32_32x32x16_bf16 v[128:143], v[64:67], v[100:103], v[128:143]
ds_read_b128 v[88:91], v26 offset:10240
v_fmac_f32 v8, v52, v124
v_fma_f32 v9, -v36, v124, v9
v_cvt_pk_bf16_f32 v36, v8, v9
v_mul_f32 v10, v37, v121
v_mul_f32 v11, v53, v121
v_fmac_f32 v10, v53, v125
s_waitcnt lgkmcnt(7)
v_mfma_f32_32x32x16_bf16 v[144:159], v[68:71], v[100:103], v[144:159]
ds_read_b128 v[92:95], v0 offset:11264
v_fma_f32 v11, -v37, v125, v11
v_cvt_pk_bf16_f32 v37, v10, v11
v_mul_f32 v8, v38, v122
v_mul_f32 v9, v54, v122
v_fmac_f32 v8, v54, v126
v_fma_f32 v9, -v38, v126, v9
s_waitcnt lgkmcnt(7)
v_mfma_f32_32x32x16_bf16 v[160:175], v[72:75], v[100:103], v[160:175]
ds_read_b128 v[64:67], v26 offset:12288
v_cvt_pk_bf16_f32 v38, v8, v9
v_mul_f32 v10, v39, v123
v_mul_f32 v11, v55, v123
v_fmac_f32 v10, v55, v127
v_fma_f32 v11, -v39, v127, v11
v_cvt_pk_bf16_f32 v39, v10, v11
s_waitcnt lgkmcnt(7)
v_mfma_f32_32x32x16_bf16 v[176:191], v[76:79], v[100:103], v[176:191]
ds_read_b128 v[68:71], v0 offset:13312
ds_read_b128 v[120:123], v0 offset:55296
ds_read_b128 v[124:127], v0 offset:56320
s_waitcnt lgkmcnt(7)
v_mul_f32 v8, v40, v112
v_mul_f32 v9, v56, v112
s_waitcnt lgkmcnt(6)
v_fmac_f32 v8, v56, v116
v_fma_f32 v9, -v40, v116, v9
v_mfma_f32_32x32x16_bf16 v[128:143], v[80:83], v[104:107], v[128:143]
ds_read_b128 v[72:75], v26 offset:14336
v_cvt_pk_bf16_f32 v40, v8, v9
v_mul_f32 v10, v41, v113
v_mul_f32 v11, v57, v113
v_fmac_f32 v10, v57, v117
v_fma_f32 v11, -v41, v117, v11
v_cvt_pk_bf16_f32 v41, v10, v11
v_mfma_f32_32x32x16_bf16 v[144:159], v[84:87], v[104:107], v[144:159]
ds_read_b128 v[76:79], v0 offset:15360
v_mul_f32 v8, v42, v114
v_mul_f32 v9, v58, v114
v_fmac_f32 v8, v58, v118
v_fma_f32 v9, -v42, v118, v9
v_cvt_pk_bf16_f32 v42, v8, v9
v_mul_f32 v10, v43, v115
s_waitcnt lgkmcnt(7)
v_mfma_f32_32x32x16_bf16 v[160:175], v[88:91], v[104:107], v[160:175]
ds_read_b128 v[80:83], v26 offset:16384
v_mul_f32 v11, v59, v115
v_fmac_f32 v10, v59, v119
v_fma_f32 v11, -v43, v119, v11
v_cvt_pk_bf16_f32 v43, v10, v11
s_waitcnt lgkmcnt(4)
v_mul_f32 v8, v44, v120
v_mul_f32 v9, v60, v120
v_mfma_f32_32x32x16_bf16 v[176:191], v[92:95], v[104:107], v[176:191]
ds_read_b128 v[84:87], v0 offset:17408
s_waitcnt lgkmcnt(4)
v_fmac_f32 v8, v60, v124
v_fma_f32 v9, -v44, v124, v9
v_cvt_pk_bf16_f32 v44, v8, v9
v_mul_f32 v10, v45, v121
v_mul_f32 v11, v61, v121
v_fmac_f32 v10, v61, v125
v_mfma_f32_32x32x16_bf16 v[128:143], v[64:67], v[108:111], v[128:143]
ds_read_b128 v[88:91], v26 offset:20480
v_fma_f32 v11, -v45, v125, v11
v_cvt_pk_bf16_f32 v45, v10, v11
v_mul_f32 v8, v46, v122
v_mul_f32 v9, v62, v122
v_fmac_f32 v8, v62, v126
v_fma_f32 v9, -v46, v126, v9
v_mfma_f32_32x32x16_bf16 v[144:159], v[68:71], v[108:111], v[144:159]
ds_read_b128 v[92:95], v0 offset:21504
v_cvt_pk_bf16_f32 v46, v8, v9
v_mul_f32 v10, v47, v123
v_mul_f32 v11, v63, v123
v_fmac_f32 v10, v63, v127
v_fma_f32 v11, -v47, v127, v11
v_cvt_pk_bf16_f32 v47, v10, v11
s_waitcnt lgkmcnt(5)
v_mfma_f32_32x32x16_bf16 v[160:175], v[72:75], v[108:111], v[160:175]
ds_read_b128 v[64:67], v26 offset:24576
s_waitcnt lgkmcnt(5)
v_mfma_f32_32x32x16_bf16 v[176:191], v[76:79], v[108:111], v[176:191]
ds_read_b128 v[68:71], v0 offset:25600
s_waitcnt lgkmcnt(5)
v_mfma_f32_32x32x16_bf16 v[128:143], v[80:83], v[32:35], v[128:143]
ds_read_b128 v[72:75], v26 offset:28672
s_waitcnt lgkmcnt(5)
v_mfma_f32_32x32x16_bf16 v[144:159], v[84:87], v[32:35], v[144:159]
ds_read_b128 v[76:79], v0 offset:29696
s_waitcnt lgkmcnt(5)
v_mfma_f32_32x32x16_bf16 v[128:143], v[88:91], v[36:39], v[128:143]
ds_read_b128 v[80:83], v26 offset:18432
s_waitcnt lgkmcnt(5)
v_mfma_f32_32x32x16_bf16 v[144:159], v[92:95], v[36:39], v[144:159]
ds_read_b128 v[84:87], v0 offset:19456
s_waitcnt lgkmcnt(5)
v_mfma_f32_32x32x16_bf16 v[128:143], v[64:67], v[40:43], v[128:143]
ds_read_b128 v[88:91], v26 offset:22528
s_waitcnt lgkmcnt(5)
v_mfma_f32_32x32x16_bf16 v[144:159], v[68:71], v[40:43], v[144:159]
ds_read_b128 v[92:95], v0 offset:23552
s_waitcnt lgkmcnt(5)
v_mfma_f32_32x32x16_bf16 v[128:143], v[72:75], v[44:47], v[128:143]
ds_read_b128 v[64:67], v26 offset:26624
s_waitcnt lgkmcnt(5)
v_mfma_f32_32x32x16_bf16 v[144:159], v[76:79], v[44:47], v[144:159]
ds_read_b128 v[68:71], v0 offset:27648
s_waitcnt lgkmcnt(5)
v_mfma_f32_32x32x16_bf16 v[160:175], v[80:83], v[32:35], v[160:175]
ds_read_b128 v[72:75], v26 offset:30720
s_waitcnt lgkmcnt(5)
v_mfma_f32_32x32x16_bf16 v[176:191], v[84:87], v[32:35], v[176:191]
ds_read_b128 v[76:79], v0 offset:31744
v_cvt_pk_bf16_f32 v128, v144, v128
v_cvt_pk_bf16_f32 v129, v145, v129
v_cvt_pk_bf16_f32 v130, v146, v130
v_cvt_pk_bf16_f32 v131, v147, v131
ds_write_b128 v20, v[128:131] offset:0
v_cvt_pk_bf16_f32 v132, v148, v132
s_waitcnt lgkmcnt(6)
v_mfma_f32_32x32x16_bf16 v[160:175], v[88:91], v[36:39], v[160:175]
v_cvt_pk_bf16_f32 v133, v149, v133
v_cvt_pk_bf16_f32 v134, v150, v134
v_cvt_pk_bf16_f32 v135, v151, v135
ds_write_b128 v20, v[132:135] offset:4096
v_cvt_pk_bf16_f32 v136, v152, v136
v_cvt_pk_bf16_f32 v137, v153, v137
s_waitcnt lgkmcnt(6)
v_mfma_f32_32x32x16_bf16 v[176:191], v[92:95], v[36:39], v[176:191]
v_cvt_pk_bf16_f32 v138, v154, v138
v_cvt_pk_bf16_f32 v139, v155, v139
ds_write_b128 v20, v[136:139] offset:8192
v_cvt_pk_bf16_f32 v140, v156, v140
v_cvt_pk_bf16_f32 v141, v157, v141
v_cvt_pk_bf16_f32 v142, v158, v142
s_waitcnt lgkmcnt(6)
v_mfma_f32_32x32x16_bf16 v[160:175], v[64:67], v[40:43], v[160:175]
v_cvt_pk_bf16_f32 v143, v159, v143
ds_write_b128 v20, v[140:143] offset:12288
s_waitcnt lgkmcnt(6)
v_mfma_f32_32x32x16_bf16 v[176:191], v[68:71], v[40:43], v[176:191]
s_waitcnt lgkmcnt(5)
v_mfma_f32_32x32x16_bf16 v[160:175], v[72:75], v[44:47], v[160:175]
s_waitcnt lgkmcnt(4)
v_mfma_f32_32x32x16_bf16 v[176:191], v[76:79], v[44:47], v[176:191]
s_nop 11
v_cvt_pk_bf16_f32 v160, v176, v160
v_cvt_pk_bf16_f32 v161, v177, v161
v_cvt_pk_bf16_f32 v162, v178, v162
v_cvt_pk_bf16_f32 v163, v179, v163
ds_write_b128 v20, v[160:163] offset:16384
v_cvt_pk_bf16_f32 v164, v180, v164
v_cvt_pk_bf16_f32 v165, v181, v165
v_cvt_pk_bf16_f32 v166, v182, v166
v_cvt_pk_bf16_f32 v167, v183, v167
ds_write_b128 v20, v[164:167] offset:20480
v_cvt_pk_bf16_f32 v168, v184, v168
v_cvt_pk_bf16_f32 v169, v185, v169
v_cvt_pk_bf16_f32 v170, v186, v170
v_cvt_pk_bf16_f32 v171, v187, v171
ds_write_b128 v20, v[168:171] offset:24576
v_cvt_pk_bf16_f32 v172, v188, v172
v_cvt_pk_bf16_f32 v173, v189, v173
v_cvt_pk_bf16_f32 v174, v190, v174
v_cvt_pk_bf16_f32 v175, v191, v175
ds_write_b128 v20, v[172:175] offset:28672
s_lshl_b32 s52, s3, 12
s_add_u32 s52, s52, 65536
v_add_u32 v20, s52, v0
s_waitcnt lgkmcnt(0)
s_barrier
ds_read_b128 v[32:35], v20 offset:0
ds_read_b128 v[36:39], v20 offset:1024
ds_read_b128 v[40:43], v20 offset:2048
ds_read_b128 v[44:47], v20 offset:3072
ds_read_b128 v[48:51], v20 offset:16384
ds_read_b128 v[52:55], v20 offset:17408
ds_read_b128 v[56:59], v20 offset:18432
ds_read_b128 v[60:63], v20 offset:19456
s_waitcnt lgkmcnt(6)
v_swap_b32 v33, v36
s_waitcnt lgkmcnt(5)
v_swap_b32 v34, v40
s_waitcnt lgkmcnt(4)
v_swap_b32 v35, v44
buffer_store_dwordx4 v[32:35], v25, s[4:7], s48 offen sc1
s_add_u32 s48, s48, 40960
v_swap_b32 v38, v41
v_swap_b32 v39, v45
buffer_store_dwordx4 v[36:39], v25, s[4:7], s48 offen sc1
s_add_u32 s48, s48, 40960
v_swap_b32 v43, v46
buffer_store_dwordx4 v[40:43], v25, s[4:7], s48 offen sc1
s_add_u32 s48, s48, 40960
buffer_store_dwordx4 v[44:47], v25, s[4:7], s48 offen sc1
s_add_u32 s48, s48, 1187840
s_waitcnt lgkmcnt(2)
v_swap_b32 v49, v52
s_waitcnt lgkmcnt(1)
v_swap_b32 v50, v56
s_waitcnt lgkmcnt(0)
v_swap_b32 v51, v60
buffer_store_dwordx4 v[48:51], v25, s[4:7], s48 offen sc1
s_add_u32 s48, s48, 40960
v_swap_b32 v54, v57
v_swap_b32 v55, v61
buffer_store_dwordx4 v[52:55], v25, s[4:7], s48 offen sc1
s_add_u32 s48, s48, 40960
v_swap_b32 v59, v62
buffer_store_dwordx4 v[56:59], v25, s[4:7], s48 offen sc1
s_add_u32 s48, s48, 40960
buffer_store_dwordx4 v[60:63], v25, s[4:7], s48 offen sc1
s_add_u32 s48, s48, 1187840
s_lshl_b32 s54, s51, 13
s_lshl_b32 s52, s30, 6
s_add_u32 s54, s54, s52
s_add_u32 s54, s54, 222306304
s_waitcnt vmcnt(0)
s_barrier
s_cmp_lg_u32 s3, 0
s_cbranch_scc1 k_s8_90
s_mov_b64 exec, 1
v_mov_b32 v8, 1
buffer_store_dword v8, off, s[4:7], s54 sc1
s_mov_b64 exec, -1
k_s8_90:
k_fend_40:
s_add_u32 s51, s51, 1
s_cmp_lt_u32 s51, 2
s_cbranch_scc1 k_lay_31
s_add_u32 s30, s30, 64
s_cmp_ge_u32 s30, 144
s_cbranch_scc1 k_fin_7
s_endpgm
k_o_4:
s_load_dwordx2 s[36:37], s[0:1], 0
s_mov_b32 s38, 2621440
s_mov_b32 s39, 0x20000
s_mul_i32 s57, s30, 52429
s_lshr_b32 s57, s57, 18
s_mul_i32 s52, s57, 5
s_sub_u32 s58, s30, s52
s_lshl_b32 s58, s58, 2
s_add_u32 s58, s58, s3
v_mov_b64 v[4:5], -1
v_mov_b64 v[6:7], -1
s_lshl_b32 s52, s30, 2
s_add_u32 s52, s52, s3
s_lshl_b32 s53, s52, 13
s_lshl_b32 s52, s52, 9
v_lshrrev_b32 v2, 1, v0
s_add_u32 s54, s52, 211812352
buffer_store_dwordx2 v[4:5], v2, s[4:7], s54 offen sc1
s_add_u32 s54, s53, 205520896
buffer_store_dwordx4 v[4:7], v0, s[4:7], s54 offen offset:0 sc1
buffer_store_dwordx4 v[4:7], v0, s[4:7], s54 offen offset:1024 sc1
buffer_store_dwordx4 v[4:7], v0, s[4:7], s54 offen offset:2048 sc1
buffer_store_dwordx4 v[4:7], v0, s[4:7], s54 offen offset:3072 sc1
s_add_u32 s54, s53, 205524992
buffer_store_dwordx4 v[4:7], v0, s[4:7], s54 offen offset:0 sc1
buffer_store_dwordx4 v[4:7], v0, s[4:7], s54 offen offset:1024 sc1
buffer_store_dwordx4 v[4:7], v0, s[4:7], s54 offen offset:2048 sc1
buffer_store_dwordx4 v[4:7], v0, s[4:7], s54 offen offset:3072 sc1
s_add_u32 s54, s52, 212860928
buffer_store_dwordx2 v[4:5], v2, s[4:7], s54 offen sc1
s_add_u32 s54, s53, 208666624
buffer_store_dwordx4 v[4:7], v0, s[4:7], s54 offen offset:0 sc1
buffer_store_dwordx4 v[4:7], v0, s[4:7], s54 offen offset:1024 sc1
buffer_store_dwordx4 v[4:7], v0, s[4:7], s54 offen offset:2048 sc1
buffer_store_dwordx4 v[4:7], v0, s[4:7], s54 offen offset:3072 sc1
s_add_u32 s54, s53, 208670720
buffer_store_dwordx4 v[4:7], v0, s[4:7], s54 offen offset:0 sc1
buffer_store_dwordx4 v[4:7], v0, s[4:7], s54 offen offset:1024 sc1
buffer_store_dwordx4 v[4:7], v0, s[4:7], s54 offen offset:2048 sc1
buffer_store_dwordx4 v[4:7], v0, s[4:7], s54 offen offset:3072 sc1
s_mul_i32 s52, s3, 640
v_lshrrev_b32 v8, 4, v0
v_add_u32 v8, s52, v8
s_mov_b32 s53, 52429
v_add_u32 v9, 0, v8
v_mul_u32_u24 v10, s53, v9
v_lshrrev_b32 v10, 22, v10
v_mul_u32_u24 v11, 80, v10
v_sub_u32 v9, v9, v11
v_and_b32 v11, 15, v10
v_xor_b32 v9, v9, v11
v_mul_u32_u24 v10, 1280, v10
v_lshl_add_u32 v72, v9, 4, v10
v_add_u32 v9, 64, v8
v_mul_u32_u24 v10, s53, v9
v_lshrrev_b32 v10, 22, v10
v_mul_u32_u24 v11, 80, v10
v_sub_u32 v9, v9, v11
v_and_b32 v11, 15, v10
v_xor_b32 v9, v9, v11
v_mul_u32_u24 v10, 1280, v10
v_lshl_add_u32 v73, v9, 4, v10
v_add_u32 v9, 128, v8
v_mul_u32_u24 v10, s53, v9
v_lshrrev_b32 v10, 22, v10
v_mul_u32_u24 v11, 80, v10
v_sub_u32 v9, v9, v11
v_and_b32 v11, 15, v10
v_xor_b32 v9, v9, v11
v_mul_u32_u24 v10, 1280, v10
v_lshl_add_u32 v74, v9, 4, v10
v_add_u32 v9, 192, v8
v_mul_u32_u24 v10, s53, v9
v_lshrrev_b32 v10, 22, v10
v_mul_u32_u24 v11, 80, v10
v_sub_u32 v9, v9, v11
v_and_b32 v11, 15, v10
v_xor_b32 v9, v9, v11
v_mul_u32_u24 v10, 1280, v10
v_lshl_add_u32 v75, v9, 4, v10
v_add_u32 v9, 256, v8
v_mul_u32_u24 v10, s53, v9
v_lshrrev_b32 v10, 22, v10
v_mul_u32_u24 v11, 80, v10
v_sub_u32 v9, v9, v11
v_and_b32 v11, 15, v10
v_xor_b32 v9, v9, v11
v_mul_u32_u24 v10, 1280, v10
v_lshl_add_u32 v76, v9, 4, v10
v_add_u32 v9, 320, v8
v_mul_u32_u24 v10, s53, v9
v_lshrrev_b32 v10, 22, v10
v_mul_u32_u24 v11, 80, v10
v_sub_u32 v9, v9, v11
v_and_b32 v11, 15, v10
v_xor_b32 v9, v9, v11
v_mul_u32_u24 v10, 1280, v10
v_lshl_add_u32 v77, v9, 4, v10
v_add_u32 v9, 384, v8
v_mul_u32_u24 v10, s53, v9
v_lshrrev_b32 v10, 22, v10
v_mul_u32_u24 v11, 80, v10
v_sub_u32 v9, v9, v11
v_and_b32 v11, 15, v10
v_xor_b32 v9, v9, v11
v_mul_u32_u24 v10, 1280, v10
v_lshl_add_u32 v78, v9, 4, v10
v_add_u32 v9, 448, v8
v_mul_u32_u24 v10, s53, v9
v_lshrrev_b32 v10, 22, v10
v_mul_u32_u24 v11, 80, v10
v_sub_u32 v9, v9, v11
v_and_b32 v11, 15, v10
v_xor_b32 v9, v9, v11
v_mul_u32_u24 v10, 1280, v10
v_lshl_add_u32 v79, v9, 4, v10
v_add_u32 v9, 512, v8
v_mul_u32_u24 v10, s53, v9
v_lshrrev_b32 v10, 22, v10
v_mul_u32_u24 v11, 80, v10
v_sub_u32 v9, v9, v11
v_and_b32 v11, 15, v10
v_xor_b32 v9, v9, v11
v_mul_u32_u24 v10, 1280, v10
v_lshl_add_u32 v80, v9, 4, v10
v_add_u32 v9, 576, v8
v_mul_u32_u24 v10, s53, v9
v_lshrrev_b32 v10, 22, v10
v_mul_u32_u24 v11, 80, v10
v_sub_u32 v9, v9, v11
v_and_b32 v11, 15, v10
v_xor_b32 v9, v9, v11
v_mul_u32_u24 v10, 1280, v10
v_lshl_add_u32 v81, v9, 4, v10
s_cmp_lg_u32 s3, 0
s_cbranch_scc1 k_wdd_92
v_mov_b32 v2, 128
k_wd_91:
global_load_dword v3, v2, s[28:29] sc1
s_waitcnt vmcnt(0)
v_readfirstlane_b32 s52, v3
s_cmp_ge_u32 s52, 32
s_cbranch_scc1 k_wdd_92
s_sleep 2
s_sub_u32 s32, s32, 1
s_cmp_gt_i32 s32, 0
s_cbranch_scc1 k_wd_91
k_wdd_92:
s_barrier
s_mul_i32 s53, s58, 40960
s_add_u32 s53, s53, 213909504
buffer_load_dwordx4 v[96:99], v0, s[4:7], s53 offen offset:0 sc1
buffer_load_dwordx4 v[100:103], v0, s[4:7], s53 offen offset:1024 sc1
buffer_load_dwordx4 v[104:107], v0, s[4:7], s53 offen offset:2048 sc1
buffer_load_dwordx4 v[108:111], v0, s[4:7], s53 offen offset:3072 sc1
s_add_u32 s53, s53, 4096
buffer_load_dwordx4 v[112:115], v0, s[4:7], s53 offen offset:0 sc1
buffer_load_dwordx4 v[116:119], v0, s[4:7], s53 offen offset:1024 sc1
buffer_load_dwordx4 v[120:123], v0, s[4:7], s53 offen offset:2048 sc1
buffer_load_dwordx4 v[124:127], v0, s[4:7], s53 offen offset:3072 sc1
s_add_u32 s53, s53, 4096
buffer_load_dwordx4 v[128:131], v0, s[4:7], s53 offen offset:0 sc1
buffer_load_dwordx4 v[132:135], v0, s[4:7], s53 offen offset:1024 sc1
buffer_load_dwordx4 v[136:139], v0, s[4:7], s53 offen offset:2048 sc1
buffer_load_dwordx4 v[140:143], v0, s[4:7], s53 offen offset:3072 sc1
s_add_u32 s53, s53, 4096
buffer_load_dwordx4 v[144:147], v0, s[4:7], s53 offen offset:0 sc1
buffer_load_dwordx4 v[148:151], v0, s[4:7], s53 offen offset:1024 sc1
buffer_load_dwordx4 v[152:155], v0, s[4:7], s53 offen offset:2048 sc1
buffer_load_dwordx4 v[156:159], v0, s[4:7], s53 offen offset:3072 sc1
s_add_u32 s53, s53, 4096
buffer_load_dwordx4 v[160:163], v0, s[4:7], s53 offen offset:0 sc1
buffer_load_dwordx4 v[164:167], v0, s[4:7], s53 offen offset:1024 sc1
buffer_load_dwordx4 v[168:171], v0, s[4:7], s53 offen offset:2048 sc1
buffer_load_dwordx4 v[172:175], v0, s[4:7], s53 offen offset:3072 sc1
s_add_u32 s53, s53, 4096
buffer_load_dwordx4 v[176:179], v0, s[4:7], s53 offen offset:0 sc1
buffer_load_dwordx4 v[180:183], v0, s[4:7], s53 offen offset:1024 sc1
buffer_load_dwordx4 v[184:187], v0, s[4:7], s53 offen offset:2048 sc1
buffer_load_dwordx4 v[188:191], v0, s[4:7], s53 offen offset:3072 sc1
s_add_u32 s53, s53, 4096
buffer_load_dwordx4 v[192:195], v0, s[4:7], s53 offen offset:0 sc1
buffer_load_dwordx4 v[196:199], v0, s[4:7], s53 offen offset:1024 sc1
buffer_load_dwordx4 v[200:203], v0, s[4:7], s53 offen offset:2048 sc1
buffer_load_dwordx4 v[204:207], v0, s[4:7], s53 offen offset:3072 sc1
s_add_u32 s53, s53, 4096
buffer_load_dwordx4 v[208:211], v0, s[4:7], s53 offen offset:0 sc1
buffer_load_dwordx4 v[212:215], v0, s[4:7], s53 offen offset:1024 sc1
buffer_load_dwordx4 v[216:219], v0, s[4:7], s53 offen offset:2048 sc1
buffer_load_dwordx4 v[220:223], v0, s[4:7], s53 offen offset:3072 sc1
s_add_u32 s53, s53, 4096
buffer_load_dwordx4 v[224:227], v0, s[4:7], s53 offen offset:0 sc1
buffer_load_dwordx4 v[228:231], v0, s[4:7], s53 offen offset:1024 sc1
buffer_load_dwordx4 v[232:235], v0, s[4:7], s53 offen offset:2048 sc1
buffer_load_dwordx4 v[236:239], v0, s[4:7], s53 offen offset:3072 sc1
s_add_u32 s53, s53, 4096
buffer_load_dwordx4 v[240:243], v0, s[4:7], s53 offen offset:0 sc1
buffer_load_dwordx4 v[244:247], v0, s[4:7], s53 offen offset:1024 sc1
buffer_load_dwordx4 v[248:251], v0, s[4:7], s53 offen offset:2048 sc1
buffer_load_dwordx4 v[252:255], v0, s[4:7], s53 offen offset:3072 sc1
s_mul_i32 s46, s57, 163840
s_lshl_b32 s48, s58, 11
s_add_u32 s48, s48, s46
s_add_u32 s48, s48, 195035136
s_mov_b32 s47, 0
s_waitcnt lgkmcnt(0)
s_mul_i32 s45, s3, 10240
s_mov_b32 s44, 0
v_bfe_u32 v8, v0, 4, 5
v_mul_u32_u24 v9, 1280, v8
v_and_b32 v8, 15, v8
v_lshrrev_b32 v10, 9, v0
v_xor_b32 v8, v8, v10
v_xor_b32 v10, 0, v8
v_lshl_add_u32 v64, v10, 4, v9
v_xor_b32 v10, 2, v8
v_lshl_add_u32 v65, v10, 4, v9
v_xor_b32 v10, 4, v8
v_lshl_add_u32 v66, v10, 4, v9
v_xor_b32 v10, 6, v8
v_lshl_add_u32 v67, v10, 4, v9
v_xor_b32 v10, 8, v8
v_lshl_add_u32 v68, v10, 4, v9
v_xor_b32 v10, 10, v8
v_lshl_add_u32 v69, v10, 4, v9
v_xor_b32 v10, 12, v8
v_lshl_add_u32 v70, v10, 4, v9
v_xor_b32 v10, 14, v8
v_lshl_add_u32 v71, v10, 4, v9
s_add_u32 m0, s45, 0
s_nop 0
buffer_load_dwordx4 v72, s[36:39], s46 offen lds
s_add_u32 m0, s45, 1024
s_nop 0
buffer_load_dwordx4 v73, s[36:39], s46 offen lds
s_add_u32 m0, s45, 2048
s_nop 0
buffer_load_dwordx4 v74, s[36:39], s46 offen lds
s_add_u32 m0, s45, 3072
s_nop 0
buffer_load_dwordx4 v75, s[36:39], s46 offen lds
s_add_u32 m0, s45, 4096
s_nop 0
buffer_load_dwordx4 v76, s[36:39], s46 offen lds
s_add_u32 m0, s45, 5120
s_nop 0
buffer_load_dwordx4 v77, s[36:39], s46 offen lds
s_add_u32 m0, s45, 6144
s_nop 0
buffer_load_dwordx4 v78, s[36:39], s46 offen lds
s_add_u32 m0, s45, 7168
s_nop 0
buffer_load_dwordx4 v79, s[36:39], s46 offen lds
s_add_u32 m0, s45, 8192
s_nop 0
buffer_load_dwordx4 v80, s[36:39], s46 offen lds
s_add_u32 m0, s45, 9216
s_nop 0
buffer_load_dwordx4 v81, s[36:39], s46 offen lds
s_add_u32 s45, s45, 40960
s_cmp_ge_u32 s45, 122880
s_cselect_b32 s55, 122880, 0
s_sub_u32 s45, s45, s55
s_add_u32 s47, s47, 1
s_cmp_lt_u32 s47, 4
s_cselect_b32 s55, 40960, 0
s_add_u32 s46, s46, s55
s_add_u32 m0, s45, 0
s_nop 0
buffer_load_dwordx4 v72, s[36:39], s46 offen lds
s_add_u32 m0, s45, 1024
s_nop 0
buffer_load_dwordx4 v73, s[36:39], s46 offen lds
s_add_u32 m0, s45, 2048
s_nop 0
buffer_load_dwordx4 v74, s[36:39], s46 offen lds
s_add_u32 m0, s45, 3072
s_nop 0
buffer_load_dwordx4 v75, s[36:39], s46 offen lds
s_add_u32 m0, s45, 4096
s_nop 0
buffer_load_dwordx4 v76, s[36:39], s46 offen lds
s_add_u32 m0, s45, 5120
s_nop 0
buffer_load_dwordx4 v77, s[36:39], s46 offen lds
s_add_u32 m0, s45, 6144
s_nop 0
buffer_load_dwordx4 v78, s[36:39], s46 offen lds
s_add_u32 m0, s45, 7168
s_nop 0
buffer_load_dwordx4 v79, s[36:39], s46 offen lds
s_add_u32 m0, s45, 8192
s_nop 0
buffer_load_dwordx4 v80, s[36:39], s46 offen lds
s_add_u32 m0, s45, 9216
s_nop 0
buffer_load_dwordx4 v81, s[36:39], s46 offen lds
s_add_u32 s45, s45, 40960
s_cmp_ge_u32 s45, 122880
s_cselect_b32 s55, 122880, 0
s_sub_u32 s45, s45, s55
s_add_u32 s47, s47, 1
s_cmp_lt_u32 s47, 4
s_cselect_b32 s55, 40960, 0
s_add_u32 s46, s46, s55
s_waitcnt vmcnt(10)
s_barrier
ds_read_b128 v[8:11], v64 offset:0
ds_read_b128 v[12:15], v65 offset:0
ds_read_b128 v[16:19], v66 offset:0
ds_read_b128 v[20:23], v67 offset:0
s_mov_b32 s59, 2
s_waitcnt lgkmcnt(3)
v_mfma_f32_32x32x16_bf16 v[32:47], v[96:99], v[8:11], 0
s_waitcnt lgkmcnt(2)
ds_read_b128 v[24:27], v68 offset:0
v_mfma_f32_32x32x16_bf16 v[32:47], v[100:103], v[12:15], v[32:47]
s_waitcnt lgkmcnt(2)
ds_read_b128 v[8:11], v69 offset:0
s_add_u32 m0, s45, 0
s_nop 0
buffer_load_dwordx4 v72, s[36:39], s46 offen lds
s_add_u32 m0, s45, 1024
s_nop 0
buffer_load_dwordx4 v73, s[36:39], s46 offen lds
v_mfma_f32_32x32x16_bf16 v[32:47], v[104:107], v[16:19], v[32:47]
s_waitcnt lgkmcnt(2)
ds_read_b128 v[12:15], v70 offset:0
s_add_u32 m0, s45, 2048
s_nop 0
buffer_load_dwordx4 v74, s[36:39], s46 offen lds
s_add_u32 m0, s45, 3072
s_nop 0
buffer_load_dwordx4 v75, s[36:39], s46 offen lds
v_mfma_f32_32x32x16_bf16 v[32:47], v[108:111], v[20:23], v[32:47]
s_waitcnt lgkmcnt(2)
ds_read_b128 v[16:19], v71 offset:0
s_add_u32 m0, s45, 4096
s_nop 0
buffer_load_dwordx4 v76, s[36:39], s46 offen lds
s_add_u32 m0, s45, 5120
s_nop 0
buffer_load_dwordx4 v77, s[36:39], s46 offen lds
v_mfma_f32_32x32x16_bf16 v[32:47], v[112:115], v[24:27], v[32:47]
s_waitcnt lgkmcnt(2)
ds_read_b128 v[20:23], v64 offset:256
s_add_u32 m0, s45, 6144
s_nop 0
buffer_load_dwordx4 v78, s[36:39], s46 offen lds
s_add_u32 m0, s45, 7168
s_nop 0
buffer_load_dwordx4 v79, s[36:39], s46 offen lds
v_mfma_f32_32x32x16_bf16 v[32:47], v[116:119], v[8:11], v[32:47]
s_waitcnt lgkmcnt(2)
ds_read_b128 v[24:27], v65 offset:256
s_add_u32 m0, s45, 8192
s_nop 0
buffer_load_dwordx4 v80, s[36:39], s46 offen lds
s_add_u32 m0, s45, 9216
s_nop 0
buffer_load_dwordx4 v81, s[36:39], s46 offen lds
v_mfma_f32_32x32x16_bf16 v[32:47], v[120:123], v[12:15], v[32:47]
s_waitcnt lgkmcnt(2)
ds_read_b128 v[8:11], v66 offset:256
s_add_u32 s45, s45, 40960
s_cmp_ge_u32 s45, 122880
s_cselect_b32 s55, 122880, 0
s_sub_u32 s45, s45, s55
s_add_u32 s47, s47, 1
s_cmp_lt_u32 s47, 4
s_cselect_b32 s55, 40960, 0
s_add_u32 s46, s46, s55
v_mfma_f32_32x32x16_bf16 v[32:47], v[124:127], v[16:19], v[32:47]
s_waitcnt lgkmcnt(2)
ds_read_b128 v[12:15], v67 offset:256
v_mfma_f32_32x32x16_bf16 v[32:47], v[128:131], v[20:23], v[32:47]
s_waitcnt lgkmcnt(2)
ds_read_b128 v[16:19], v68 offset:256
v_mfma_f32_32x32x16_bf16 v[32:47], v[132:135], v[24:27], v[32:47]
s_waitcnt lgkmcnt(2)
ds_read_b128 v[20:23], v69 offset:256
v_mfma_f32_32x32x16_bf16 v[32:47], v[136:139], v[8:11], v[32:47]
s_waitcnt lgkmcnt(2)
ds_read_b128 v[24:27], v70 offset:256
v_mfma_f32_32x32x16_bf16 v[32:47], v[140:143], v[12:15], v[32:47]
s_waitcnt lgkmcnt(2)
ds_read_b128 v[8:11], v71 offset:256
v_mfma_f32_32x32x16_bf16 v[32:47], v[144:147], v[16:19], v[32:47]
s_waitcnt lgkmcnt(2)
ds_read_b128 v[12:15], v64 offset:512
v_mfma_f32_32x32x16_bf16 v[32:47], v[148:151], v[20:23], v[32:47]
s_waitcnt lgkmcnt(2)
ds_read_b128 v[16:19], v65 offset:512
v_mfma_f32_32x32x16_bf16 v[32:47], v[152:155], v[24:27], v[32:47]
s_waitcnt lgkmcnt(2)
ds_read_b128 v[20:23], v66 offset:512
v_mfma_f32_32x32x16_bf16 v[32:47], v[156:159], v[8:11], v[32:47]
s_waitcnt lgkmcnt(2)
ds_read_b128 v[24:27], v67 offset:512
v_mfma_f32_32x32x16_bf16 v[32:47], v[160:163], v[12:15], v[32:47]
s_waitcnt lgkmcnt(2)
ds_read_b128 v[8:11], v68 offset:512
v_mfma_f32_32x32x16_bf16 v[32:47], v[164:167], v[16:19], v[32:47]
s_waitcnt lgkmcnt(2)
ds_read_b128 v[12:15], v69 offset:512
v_mfma_f32_32x32x16_bf16 v[32:47], v[168:171], v[20:23], v[32:47]
s_waitcnt lgkmcnt(2)
ds_read_b128 v[16:19], v70 offset:512
v_mfma_f32_32x32x16_bf16 v[32:47], v[172:175], v[24:27], v[32:47]
s_waitcnt lgkmcnt(2)
ds_read_b128 v[20:23], v71 offset:512
v_mfma_f32_32x32x16_bf16 v[32:47], v[176:179], v[8:11], v[32:47]
s_waitcnt lgkmcnt(2)
ds_read_b128 v[24:27], v64 offset:768
v_mfma_f32_32x32x16_bf16 v[32:47], v[180:183], v[12:15], v[32:47]
s_waitcnt lgkmcnt(2)
ds_read_b128 v[8:11], v65 offset:768
v_mfma_f32_32x32x16_bf16 v[32:47], v[184:187], v[16:19], v[32:47]
s_waitcnt lgkmcnt(2)
ds_read_b128 v[12:15], v66 offset:768
v_mfma_f32_32x32x16_bf16 v[32:47], v[188:191], v[20:23], v[32:47]
s_waitcnt lgkmcnt(2)
ds_read_b128 v[16:19], v67 offset:768
v_mfma_f32_32x32x16_bf16 v[32:47], v[192:195], v[24:27], v[32:47]
s_waitcnt lgkmcnt(2)
ds_read_b128 v[20:23], v68 offset:768
v_mfma_f32_32x32x16_bf16 v[32:47], v[196:199], v[8:11], v[32:47]
s_waitcnt lgkmcnt(2)
ds_read_b128 v[24:27], v69 offset:768
v_mfma_f32_32x32x16_bf16 v[32:47], v[200:203], v[12:15], v[32:47]
s_waitcnt lgkmcnt(2)
ds_read_b128 v[8:11], v70 offset:768
v_mfma_f32_32x32x16_bf16 v[32:47], v[204:207], v[16:19], v[32:47]
s_waitcnt lgkmcnt(2)
ds_read_b128 v[12:15], v71 offset:768
v_mfma_f32_32x32x16_bf16 v[32:47], v[208:211], v[20:23], v[32:47]
s_waitcnt lgkmcnt(2)
ds_read_b128 v[16:19], v64 offset:1024
v_mfma_f32_32x32x16_bf16 v[32:47], v[212:215], v[24:27], v[32:47]
s_waitcnt lgkmcnt(2)
ds_read_b128 v[20:23], v65 offset:1024
v_mfma_f32_32x32x16_bf16 v[32:47], v[216:219], v[8:11], v[32:47]
s_waitcnt lgkmcnt(2)
ds_read_b128 v[24:27], v66 offset:1024
v_mfma_f32_32x32x16_bf16 v[32:47], v[220:223], v[12:15], v[32:47]
s_waitcnt lgkmcnt(2)
ds_read_b128 v[8:11], v67 offset:1024
v_mfma_f32_32x32x16_bf16 v[32:47], v[224:227], v[16:19], v[32:47]
s_waitcnt lgkmcnt(2)
ds_read_b128 v[12:15], v68 offset:1024
v_mfma_f32_32x32x16_bf16 v[32:47], v[228:231], v[20:23], v[32:47]
s_waitcnt lgkmcnt(2)
ds_read_b128 v[16:19], v69 offset:1024
v_mfma_f32_32x32x16_bf16 v[32:47], v[232:235], v[24:27], v[32:47]
s_waitcnt lgkmcnt(2)
ds_read_b128 v[20:23], v70 offset:1024
v_mfma_f32_32x32x16_bf16 v[32:47], v[236:239], v[8:11], v[32:47]
s_waitcnt lgkmcnt(2)
ds_read_b128 v[24:27], v71 offset:1024
v_mfma_f32_32x32x16_bf16 v[32:47], v[240:243], v[12:15], v[32:47]
s_add_u32 s44, s44, 1
s_cmp_eq_u32 s44, 3
s_mov_b32 s56, 40960
s_cmov_b32 s56, -81920
s_cselect_b32 s44, 0, s44
v_add_u32 v64, s56, v64
v_add_u32 v65, s56, v65
v_add_u32 v66, s56, v66
v_add_u32 v67, s56, v67
v_add_u32 v68, s56, v68
v_add_u32 v69, s56, v69
v_add_u32 v70, s56, v70
v_add_u32 v71, s56, v71
s_waitcnt vmcnt(10) lgkmcnt(2)
s_barrier
ds_read_b128 v[8:11], v64 offset:0
v_mfma_f32_32x32x16_bf16 v[32:47], v[244:247], v[16:19], v[32:47]
s_waitcnt lgkmcnt(2)
ds_read_b128 v[12:15], v65 offset:0
v_mfma_f32_32x32x16_bf16 v[32:47], v[248:251], v[20:23], v[32:47]
s_waitcnt lgkmcnt(2)
ds_read_b128 v[16:19], v66 offset:0
v_mfma_f32_32x32x16_bf16 v[32:47], v[252:255], v[24:27], v[32:47]
s_waitcnt lgkmcnt(2)
ds_read_b128 v[20:23], v67 offset:0
k_st_93:
v_mfma_f32_32x32x16_bf16 v[48:63], v[96:99], v[8:11], 0
s_waitcnt lgkmcnt(2)
ds_read_b128 v[24:27], v68 offset:0
v_mfma_f32_32x32x16_bf16 v[48:63], v[100:103], v[12:15], v[48:63]
s_waitcnt lgkmcnt(2)
ds_read_b128 v[8:11], v69 offset:0
v_cvt_pk_bf16_f32 v32, v32, v33
v_cvt_pk_bf16_f32 v33, v34, v35
v_mfma_f32_32x32x16_bf16 v[48:63], v[104:107], v[16:19], v[48:63]
s_waitcnt lgkmcnt(2)
ds_read_b128 v[12:15], v70 offset:0
v_cvt_pk_bf16_f32 v34, v36, v37
v_cvt_pk_bf16_f32 v35, v38, v39
v_mfma_f32_32x32x16_bf16 v[48:63], v[108:111], v[20:23], v[48:63]
s_waitcnt lgkmcnt(2)
ds_read_b128 v[16:19], v71 offset:0
v_cvt_pk_bf16_f32 v36, v40, v41
v_cvt_pk_bf16_f32 v37, v42, v43
v_mfma_f32_32x32x16_bf16 v[48:63], v[112:115], v[24:27], v[48:63]
s_waitcnt lgkmcnt(2)
ds_read_b128 v[20:23], v64 offset:256
v_cvt_pk_bf16_f32 v38, v44, v45
v_cvt_pk_bf16_f32 v39, v46, v47
v_mfma_f32_32x32x16_bf16 v[48:63], v[116:119], v[8:11], v[48:63]
s_waitcnt lgkmcnt(2)
ds_read_b128 v[24:27], v65 offset:256
buffer_store_dwordx4 v[32:35], v0, s[4:7], s48 offen offset:0 sc1
buffer_store_dwordx4 v[36:39], v0, s[4:7], s48 offen offset:1024 sc1
v_mfma_f32_32x32x16_bf16 v[48:63], v[120:123], v[12:15], v[48:63]
s_waitcnt lgkmcnt(2)
ds_read_b128 v[8:11], v66 offset:256
s_add_u32 s48, s48, 40960
s_add_u32 m0, s45, 0
s_nop 0
buffer_load_dwordx4 v72, s[36:39], s46 offen lds
v_mfma_f32_32x32x16_bf16 v[48:63], v[124:127], v[16:19], v[48:63]
s_waitcnt lgkmcnt(2)
ds_read_b128 v[12:15], v67 offset:256
s_add_u32 m0, s45, 1024
s_nop 0
buffer_load_dwordx4 v73, s[36:39], s46 offen lds
s_add_u32 m0, s45, 2048
s_nop 0
buffer_load_dwordx4 v74, s[36:39], s46 offen lds
v_mfma_f32_32x32x16_bf16 v[48:63], v[128:131], v[20:23], v[48:63]
s_waitcnt lgkmcnt(2)
ds_read_b128 v[16:19], v68 offset:256
s_add_u32 m0, s45, 3072
s_nop 0
buffer_load_dwordx4 v75, s[36:39], s46 offen lds
s_add_u32 m0, s45, 4096
s_nop 0
buffer_load_dwordx4 v76, s[36:39], s46 offen lds
v_mfma_f32_32x32x16_bf16 v[48:63], v[132:135], v[24:27], v[48:63]
s_waitcnt lgkmcnt(2)
ds_read_b128 v[20:23], v69 offset:256
s_add_u32 m0, s45, 5120
s_nop 0
buffer_load_dwordx4 v77, s[36:39], s46 offen lds
s_add_u32 m0, s45, 6144
s_nop 0
buffer_load_dwordx4 v78, s[36:39], s46 offen lds
v_mfma_f32_32x32x16_bf16 v[48:63], v[136:139], v[8:11], v[48:63]
s_waitcnt lgkmcnt(2)
ds_read_b128 v[24:27], v70 offset:256
s_add_u32 m0, s45, 7168
s_nop 0
buffer_load_dwordx4 v79, s[36:39], s46 offen lds
s_add_u32 m0, s45, 8192
s_nop 0
buffer_load_dwordx4 v80, s[36:39], s46 offen lds
v_mfma_f32_32x32x16_bf16 v[48:63], v[140:143], v[12:15], v[48:63]
s_waitcnt lgkmcnt(2)
ds_read_b128 v[8:11], v71 offset:256
s_add_u32 m0, s45, 9216
s_nop 0
buffer_load_dwordx4 v81, s[36:39], s46 offen lds
s_add_u32 s45, s45, 40960
s_cmp_ge_u32 s45, 122880
s_cselect_b32 s55, 122880, 0
s_sub_u32 s45, s45, s55
v_mfma_f32_32x32x16_bf16 v[48:63], v[144:147], v[16:19], v[48:63]
s_waitcnt lgkmcnt(2)
ds_read_b128 v[12:15], v64 offset:512
s_add_u32 s47, s47, 1
s_cmp_lt_u32 s47, 4
s_cselect_b32 s55, 40960, 0
s_add_u32 s46, s46, s55
v_mfma_f32_32x32x16_bf16 v[48:63], v[148:151], v[20:23], v[48:63]
s_waitcnt lgkmcnt(2)
ds_read_b128 v[16:19], v65 offset:512
v_mfma_f32_32x32x16_bf16 v[48:63], v[152:155], v[24:27], v[48:63]
s_waitcnt lgkmcnt(2)
ds_read_b128 v[20:23], v66 offset:512
v_mfma_f32_32x32x16_bf16 v[48:63], v[156:159], v[8:11], v[48:63]
s_waitcnt lgkmcnt(2)
ds_read_b128 v[24:27], v67 offset:512
v_mfma_f32_32x32x16_bf16 v[48:63], v[160:163], v[12:15], v[48:63]
s_waitcnt lgkmcnt(2)
ds_read_b128 v[8:11], v68 offset:512
v_mfma_f32_32x32x16_bf16 v[48:63], v[164:167], v[16:19], v[48:63]
s_waitcnt lgkmcnt(2)
ds_read_b128 v[12:15], v69 offset:512
v_mfma_f32_32x32x16_bf16 v[48:63], v[168:171], v[20:23], v[48:63]
s_waitcnt lgkmcnt(2)
ds_read_b128 v[16:19], v70 offset:512
v_mfma_f32_32x32x16_bf16 v[48:63], v[172:175], v[24:27], v[48:63]
s_waitcnt lgkmcnt(2)
ds_read_b128 v[20:23], v71 offset:512
v_mfma_f32_32x32x16_bf16 v[48:63], v[176:179], v[8:11], v[48:63]
s_waitcnt lgkmcnt(2)
ds_read_b128 v[24:27], v64 offset:768
v_mfma_f32_32x32x16_bf16 v[48:63], v[180:183], v[12:15], v[48:63]
s_waitcnt lgkmcnt(2)
ds_read_b128 v[8:11], v65 offset:768
v_mfma_f32_32x32x16_bf16 v[48:63], v[184:187], v[16:19], v[48:63]
s_waitcnt lgkmcnt(2)
ds_read_b128 v[12:15], v66 offset:768
v_mfma_f32_32x32x16_bf16 v[48:63], v[188:191], v[20:23], v[48:63]
s_waitcnt lgkmcnt(2)
ds_read_b128 v[16:19], v67 offset:768
v_mfma_f32_32x32x16_bf16 v[48:63], v[192:195], v[24:27], v[48:63]
s_waitcnt lgkmcnt(2)
ds_read_b128 v[20:23], v68 offset:768
v_mfma_f32_32x32x16_bf16 v[48:63], v[196:199], v[8:11], v[48:63]
s_waitcnt lgkmcnt(2)
ds_read_b128 v[24:27], v69 offset:768
v_mfma_f32_32x32x16_bf16 v[48:63], v[200:203], v[12:15], v[48:63]
s_waitcnt lgkmcnt(2)
ds_read_b128 v[8:11], v70 offset:768
v_mfma_f32_32x32x16_bf16 v[48:63], v[204:207], v[16:19], v[48:63]
s_waitcnt lgkmcnt(2)
ds_read_b128 v[12:15], v71 offset:768
v_mfma_f32_32x32x16_bf16 v[48:63], v[208:211], v[20:23], v[48:63]
s_waitcnt lgkmcnt(2)
ds_read_b128 v[16:19], v64 offset:1024
v_mfma_f32_32x32x16_bf16 v[48:63], v[212:215], v[24:27], v[48:63]
s_waitcnt lgkmcnt(2)
ds_read_b128 v[20:23], v65 offset:1024
v_mfma_f32_32x32x16_bf16 v[48:63], v[216:219], v[8:11], v[48:63]
s_waitcnt lgkmcnt(2)
ds_read_b128 v[24:27], v66 offset:1024
v_mfma_f32_32x32x16_bf16 v[48:63], v[220:223], v[12:15], v[48:63]
s_waitcnt lgkmcnt(2)
ds_read_b128 v[8:11], v67 offset:1024
v_mfma_f32_32x32x16_bf16 v[48:63], v[224:227], v[16:19], v[48:63]
s_waitcnt lgkmcnt(2)
ds_read_b128 v[12:15], v68 offset:1024
v_mfma_f32_32x32x16_bf16 v[48:63], v[228:231], v[20:23], v[48:63]
s_waitcnt lgkmcnt(2)
ds_read_b128 v[16:19], v69 offset:1024
v_mfma_f32_32x32x16_bf16 v[48:63], v[232:235], v[24:27], v[48:63]
s_waitcnt lgkmcnt(2)
ds_read_b128 v[20:23], v70 offset:1024
v_mfma_f32_32x32x16_bf16 v[48:63], v[236:239], v[8:11], v[48:63]
s_waitcnt lgkmcnt(2)
ds_read_b128 v[24:27], v71 offset:1024
v_mfma_f32_32x32x16_bf16 v[48:63], v[240:243], v[12:15], v[48:63]
s_add_u32 s44, s44, 1
s_cmp_eq_u32 s44, 3
s_mov_b32 s56, 40960
s_cmov_b32 s56, -81920
s_cselect_b32 s44, 0, s44
v_add_u32 v64, s56, v64
v_add_u32 v65, s56, v65
v_add_u32 v66, s56, v66
v_add_u32 v67, s56, v67
v_add_u32 v68, s56, v68
v_add_u32 v69, s56, v69
v_add_u32 v70, s56, v70
v_add_u32 v71, s56, v71
s_waitcnt vmcnt(10) lgkmcnt(2)
s_barrier
ds_read_b128 v[8:11], v64 offset:0
v_mfma_f32_32x32x16_bf16 v[48:63], v[244:247], v[16:19], v[48:63]
s_waitcnt lgkmcnt(2)
ds_read_b128 v[12:15], v65 offset:0
v_mfma_f32_32x32x16_bf16 v[48:63], v[248:251], v[20:23], v[48:63]
s_waitcnt lgkmcnt(2)
ds_read_b128 v[16:19], v66 offset:0
v_mfma_f32_32x32x16_bf16 v[48:63], v[252:255], v[24:27], v[48:63]
s_waitcnt lgkmcnt(2)
ds_read_b128 v[20:23], v67 offset:0
s_sub_u32 s59, s59, 1
s_cmp_eq_u32 s59, 0
s_cbranch_scc1 k_so_94
v_mfma_f32_32x32x16_bf16 v[32:47], v[96:99], v[8:11], 0
s_waitcnt lgkmcnt(2)
ds_read_b128 v[24:27], v68 offset:0
v_mfma_f32_32x32x16_bf16 v[32:47], v[100:103], v[12:15], v[32:47]
s_waitcnt lgkmcnt(2)
ds_read_b128 v[8:11], v69 offset:0
v_cvt_pk_bf16_f32 v48, v48, v49
v_cvt_pk_bf16_f32 v49, v50, v51
v_mfma_f32_32x32x16_bf16 v[32:47], v[104:107], v[16:19], v[32:47]
s_waitcnt lgkmcnt(2)
ds_read_b128 v[12:15], v70 offset:0
v_cvt_pk_bf16_f32 v50, v52, v53
v_cvt_pk_bf16_f32 v51, v54, v55
v_mfma_f32_32x32x16_bf16 v[32:47], v[108:111], v[20:23], v[32:47]
s_waitcnt lgkmcnt(2)
ds_read_b128 v[16:19], v71 offset:0
v_cvt_pk_bf16_f32 v52, v56, v57
v_cvt_pk_bf16_f32 v53, v58, v59
v_mfma_f32_32x32x16_bf16 v[32:47], v[112:115], v[24:27], v[32:47]
s_waitcnt lgkmcnt(2)
ds_read_b128 v[20:23], v64 offset:256
v_cvt_pk_bf16_f32 v54, v60, v61
v_cvt_pk_bf16_f32 v55, v62, v63
v_mfma_f32_32x32x16_bf16 v[32:47], v[116:119], v[8:11], v[32:47]
s_waitcnt lgkmcnt(2)
ds_read_b128 v[24:27], v65 offset:256
buffer_store_dwordx4 v[48:51], v0, s[4:7], s48 offen offset:0 sc1
buffer_store_dwordx4 v[52:55], v0, s[4:7], s48 offen offset:1024 sc1
v_mfma_f32_32x32x16_bf16 v[32:47], v[120:123], v[12:15], v[32:47]
s_waitcnt lgkmcnt(2)
ds_read_b128 v[8:11], v66 offset:256
s_add_u32 s48, s48, 40960
s_add_u32 m0, s45, 0
s_nop 0
buffer_load_dwordx4 v72, s[36:39], s46 offen lds
v_mfma_f32_32x32x16_bf16 v[32:47], v[124:127], v[16:19], v[32:47]
s_waitcnt lgkmcnt(2)
ds_read_b128 v[12:15], v67 offset:256
s_add_u32 m0, s45, 1024
s_nop 0
buffer_load_dwordx4 v73, s[36:39], s46 offen lds
s_add_u32 m0, s45, 2048
s_nop 0
buffer_load_dwordx4 v74, s[36:39], s46 offen lds
v_mfma_f32_32x32x16_bf16 v[32:47], v[128:131], v[20:23], v[32:47]
s_waitcnt lgkmcnt(2)
ds_read_b128 v[16:19], v68 offset:256
s_add_u32 m0, s45, 3072
s_nop 0
buffer_load_dwordx4 v75, s[36:39], s46 offen lds
s_add_u32 m0, s45, 4096
s_nop 0
buffer_load_dwordx4 v76, s[36:39], s46 offen lds
v_mfma_f32_32x32x16_bf16 v[32:47], v[132:135], v[24:27], v[32:47]
s_waitcnt lgkmcnt(2)
ds_read_b128 v[20:23], v69 offset:256
s_add_u32 m0, s45, 5120
s_nop 0
buffer_load_dwordx4 v77, s[36:39], s46 offen lds
s_add_u32 m0, s45, 6144
s_nop 0
buffer_load_dwordx4 v78, s[36:39], s46 offen lds
v_mfma_f32_32x32x16_bf16 v[32:47], v[136:139], v[8:11], v[32:47]
s_waitcnt lgkmcnt(2)
ds_read_b128 v[24:27], v70 offset:256
s_add_u32 m0, s45, 7168
s_nop 0
buffer_load_dwordx4 v79, s[36:39], s46 offen lds
s_add_u32 m0, s45, 8192
s_nop 0
buffer_load_dwordx4 v80, s[36:39], s46 offen lds
v_mfma_f32_32x32x16_bf16 v[32:47], v[140:143], v[12:15], v[32:47]
s_waitcnt lgkmcnt(2)
ds_read_b128 v[8:11], v71 offset:256
s_add_u32 m0, s45, 9216
s_nop 0
buffer_load_dwordx4 v81, s[36:39], s46 offen lds
s_add_u32 s45, s45, 40960
s_cmp_ge_u32 s45, 122880
s_cselect_b32 s55, 122880, 0
s_sub_u32 s45, s45, s55
v_mfma_f32_32x32x16_bf16 v[32:47], v[144:147], v[16:19], v[32:47]
s_waitcnt lgkmcnt(2)
ds_read_b128 v[12:15], v64 offset:512
s_add_u32 s47, s47, 1
s_cmp_lt_u32 s47, 4
s_cselect_b32 s55, 40960, 0
s_add_u32 s46, s46, s55
v_mfma_f32_32x32x16_bf16 v[32:47], v[148:151], v[20:23], v[32:47]
s_waitcnt lgkmcnt(2)
ds_read_b128 v[16:19], v65 offset:512
v_mfma_f32_32x32x16_bf16 v[32:47], v[152:155], v[24:27], v[32:47]
s_waitcnt lgkmcnt(2)
ds_read_b128 v[20:23], v66 offset:512
v_mfma_f32_32x32x16_bf16 v[32:47], v[156:159], v[8:11], v[32:47]
s_waitcnt lgkmcnt(2)
ds_read_b128 v[24:27], v67 offset:512
v_mfma_f32_32x32x16_bf16 v[32:47], v[160:163], v[12:15], v[32:47]
s_waitcnt lgkmcnt(2)
ds_read_b128 v[8:11], v68 offset:512
v_mfma_f32_32x32x16_bf16 v[32:47], v[164:167], v[16:19], v[32:47]
s_waitcnt lgkmcnt(2)
ds_read_b128 v[12:15], v69 offset:512
v_mfma_f32_32x32x16_bf16 v[32:47], v[168:171], v[20:23], v[32:47]
s_waitcnt lgkmcnt(2)
ds_read_b128 v[16:19], v70 offset:512
v_mfma_f32_32x32x16_bf16 v[32:47], v[172:175], v[24:27], v[32:47]
s_waitcnt lgkmcnt(2)
ds_read_b128 v[20:23], v71 offset:512
v_mfma_f32_32x32x16_bf16 v[32:47], v[176:179], v[8:11], v[32:47]
s_waitcnt lgkmcnt(2)
ds_read_b128 v[24:27], v64 offset:768
v_mfma_f32_32x32x16_bf16 v[32:47], v[180:183], v[12:15], v[32:47]
s_waitcnt lgkmcnt(2)
ds_read_b128 v[8:11], v65 offset:768
v_mfma_f32_32x32x16_bf16 v[32:47], v[184:187], v[16:19], v[32:47]
s_waitcnt lgkmcnt(2)
ds_read_b128 v[12:15], v66 offset:768
v_mfma_f32_32x32x16_bf16 v[32:47], v[188:191], v[20:23], v[32:47]
s_waitcnt lgkmcnt(2)
ds_read_b128 v[16:19], v67 offset:768
v_mfma_f32_32x32x16_bf16 v[32:47], v[192:195], v[24:27], v[32:47]
s_waitcnt lgkmcnt(2)
ds_read_b128 v[20:23], v68 offset:768
v_mfma_f32_32x32x16_bf16 v[32:47], v[196:199], v[8:11], v[32:47]
s_waitcnt lgkmcnt(2)
ds_read_b128 v[24:27], v69 offset:768
v_mfma_f32_32x32x16_bf16 v[32:47], v[200:203], v[12:15], v[32:47]
s_waitcnt lgkmcnt(2)
ds_read_b128 v[8:11], v70 offset:768
v_mfma_f32_32x32x16_bf16 v[32:47], v[204:207], v[16:19], v[32:47]
s_waitcnt lgkmcnt(2)
ds_read_b128 v[12:15], v71 offset:768
v_mfma_f32_32x32x16_bf16 v[32:47], v[208:211], v[20:23], v[32:47]
s_waitcnt lgkmcnt(2)
ds_read_b128 v[16:19], v64 offset:1024
v_mfma_f32_32x32x16_bf16 v[32:47], v[212:215], v[24:27], v[32:47]
s_waitcnt lgkmcnt(2)
ds_read_b128 v[20:23], v65 offset:1024
v_mfma_f32_32x32x16_bf16 v[32:47], v[216:219], v[8:11], v[32:47]
s_waitcnt lgkmcnt(2)
ds_read_b128 v[24:27], v66 offset:1024
v_mfma_f32_32x32x16_bf16 v[32:47], v[220:223], v[12:15], v[32:47]
s_waitcnt lgkmcnt(2)
ds_read_b128 v[8:11], v67 offset:1024
v_mfma_f32_32x32x16_bf16 v[32:47], v[224:227], v[16:19], v[32:47]
s_waitcnt lgkmcnt(2)
ds_read_b128 v[12:15], v68 offset:1024
v_mfma_f32_32x32x16_bf16 v[32:47], v[228:231], v[20:23], v[32:47]
s_waitcnt lgkmcnt(2)
ds_read_b128 v[16:19], v69 offset:1024
v_mfma_f32_32x32x16_bf16 v[32:47], v[232:235], v[24:27], v[32:47]
s_waitcnt lgkmcnt(2)
ds_read_b128 v[20:23], v70 offset:1024
v_mfma_f32_32x32x16_bf16 v[32:47], v[236:239], v[8:11], v[32:47]
s_waitcnt lgkmcnt(2)
ds_read_b128 v[24:27], v71 offset:1024
v_mfma_f32_32x32x16_bf16 v[32:47], v[240:243], v[12:15], v[32:47]
s_add_u32 s44, s44, 1
s_cmp_eq_u32 s44, 3
s_mov_b32 s56, 40960
s_cmov_b32 s56, -81920
s_cselect_b32 s44, 0, s44
v_add_u32 v64, s56, v64
v_add_u32 v65, s56, v65
v_add_u32 v66, s56, v66
v_add_u32 v67, s56, v67
v_add_u32 v68, s56, v68
v_add_u32 v69, s56, v69
v_add_u32 v70, s56, v70
v_add_u32 v71, s56, v71
s_waitcnt vmcnt(10) lgkmcnt(2)
s_barrier
ds_read_b128 v[8:11], v64 offset:0
v_mfma_f32_32x32x16_bf16 v[32:47], v[244:247], v[16:19], v[32:47]
s_waitcnt lgkmcnt(2)
ds_read_b128 v[12:15], v65 offset:0
v_mfma_f32_32x32x16_bf16 v[32:47], v[248:251], v[20:23], v[32:47]
s_waitcnt lgkmcnt(2)
ds_read_b128 v[16:19], v66 offset:0
v_mfma_f32_32x32x16_bf16 v[32:47], v[252:255], v[24:27], v[32:47]
s_waitcnt lgkmcnt(2)
ds_read_b128 v[20:23], v67 offset:0
s_branch k_st_93
k_so_94:
s_nop 6
v_cvt_pk_bf16_f32 v48, v48, v49
v_cvt_pk_bf16_f32 v49, v50, v51
v_cvt_pk_bf16_f32 v50, v52, v53
v_cvt_pk_bf16_f32 v51, v54, v55
v_cvt_pk_bf16_f32 v52, v56, v57
v_cvt_pk_bf16_f32 v53, v58, v59
v_cvt_pk_bf16_f32 v54, v60, v61
v_cvt_pk_bf16_f32 v55, v62, v63
buffer_store_dwordx4 v[48:51], v0, s[4:7], s48 offen offset:0 sc1
buffer_store_dwordx4 v[52:55], v0, s[4:7], s48 offen offset:1024 sc1
s_add_u32 s48, s48, 40960
s_lshl_b32 s54, s30, 6
s_add_u32 s54, s54, 222298112
s_waitcnt lgkmcnt(0)
s_waitcnt vmcnt(0)
s_barrier
s_cmp_lg_u32 s3, 0
s_cbranch_scc1 k_s8_95
s_mov_b64 exec, 1
v_mov_b32 v2, 1
buffer_store_dword v2, off, s[4:7], s54 sc1
s_mov_b64 exec, -1
k_s8_95:
s_mul_i32 s52, s3, 640
v_lshrrev_b32 v8, 4, v0
v_add_u32 v8, s52, v8
s_mov_b32 s53, 52429
v_add_u32 v9, 0, v8
v_mul_u32_u24 v10, s53, v9
v_lshrrev_b32 v10, 22, v10
v_mul_u32_u24 v11, 80, v10
v_sub_u32 v9, v9, v11
v_and_b32 v11, 15, v10
v_xor_b32 v9, v9, v11
v_and_b32 v11, 1, v10
v_bfe_u32 v12, v10, 1, 1
v_lshl_add_u32 v11, v12, 4, v11
v_bfe_u32 v12, v10, 2, 1
v_lshl_add_u32 v11, v12, 6, v11
v_bfe_u32 v12, v10, 3, 1
v_lshl_add_u32 v11, v12, 1, v11
v_bfe_u32 v12, v10, 4, 1
v_lshl_add_u32 v10, v12, 3, v11
v_mul_u32_u24 v10, 1280, v10
v_lshl_add_u32 v72, v9, 4, v10
v_add_u32 v9, 64, v8
v_mul_u32_u24 v10, s53, v9
v_lshrrev_b32 v10, 22, v10
v_mul_u32_u24 v11, 80, v10
v_sub_u32 v9, v9, v11
v_and_b32 v11, 15, v10
v_xor_b32 v9, v9, v11
v_and_b32 v11, 1, v10
v_bfe_u32 v12, v10, 1, 1
v_lshl_add_u32 v11, v12, 4, v11
v_bfe_u32 v12, v10, 2, 1
v_lshl_add_u32 v11, v12, 6, v11
v_bfe_u32 v12, v10, 3, 1
v_lshl_add_u32 v11, v12, 1, v11
v_bfe_u32 v12, v10, 4, 1
v_lshl_add_u32 v10, v12, 3, v11
v_mul_u32_u24 v10, 1280, v10
v_lshl_add_u32 v73, v9, 4, v10
v_add_u32 v9, 128, v8
v_mul_u32_u24 v10, s53, v9
v_lshrrev_b32 v10, 22, v10
v_mul_u32_u24 v11, 80, v10
v_sub_u32 v9, v9, v11
v_and_b32 v11, 15, v10
v_xor_b32 v9, v9, v11
v_and_b32 v11, 1, v10
v_bfe_u32 v12, v10, 1, 1
v_lshl_add_u32 v11, v12, 4, v11
v_bfe_u32 v12, v10, 2, 1
v_lshl_add_u32 v11, v12, 6, v11
v_bfe_u32 v12, v10, 3, 1
v_lshl_add_u32 v11, v12, 1, v11
v_bfe_u32 v12, v10, 4, 1
v_lshl_add_u32 v10, v12, 3, v11
v_mul_u32_u24 v10, 1280, v10
v_lshl_add_u32 v74, v9, 4, v10
v_add_u32 v9, 192, v8
v_mul_u32_u24 v10, s53, v9
v_lshrrev_b32 v10, 22, v10
v_mul_u32_u24 v11, 80, v10
v_sub_u32 v9, v9, v11
v_and_b32 v11, 15, v10
v_xor_b32 v9, v9, v11
v_and_b32 v11, 1, v10
v_bfe_u32 v12, v10, 1, 1
v_lshl_add_u32 v11, v12, 4, v11
v_bfe_u32 v12, v10, 2, 1
v_lshl_add_u32 v11, v12, 6, v11
v_bfe_u32 v12, v10, 3, 1
v_lshl_add_u32 v11, v12, 1, v11
v_bfe_u32 v12, v10, 4, 1
v_lshl_add_u32 v10, v12, 3, v11
v_mul_u32_u24 v10, 1280, v10
v_lshl_add_u32 v75, v9, 4, v10
v_add_u32 v9, 256, v8
v_mul_u32_u24 v10, s53, v9
v_lshrrev_b32 v10, 22, v10
v_mul_u32_u24 v11, 80, v10
v_sub_u32 v9, v9, v11
v_and_b32 v11, 15, v10
v_xor_b32 v9, v9, v11
v_and_b32 v11, 1, v10
v_bfe_u32 v12, v10, 1, 1
v_lshl_add_u32 v11, v12, 4, v11
v_bfe_u32 v12, v10, 2, 1
v_lshl_add_u32 v11, v12, 6, v11
v_bfe_u32 v12, v10, 3, 1
v_lshl_add_u32 v11, v12, 1, v11
v_bfe_u32 v12, v10, 4, 1
v_lshl_add_u32 v10, v12, 3, v11
v_mul_u32_u24 v10, 1280, v10
v_lshl_add_u32 v76, v9, 4, v10
v_add_u32 v9, 320, v8
v_mul_u32_u24 v10, s53, v9
v_lshrrev_b32 v10, 22, v10
v_mul_u32_u24 v11, 80, v10
v_sub_u32 v9, v9, v11
v_and_b32 v11, 15, v10
v_xor_b32 v9, v9, v11
v_and_b32 v11, 1, v10
v_bfe_u32 v12, v10, 1, 1
v_lshl_add_u32 v11, v12, 4, v11
v_bfe_u32 v12, v10, 2, 1
v_lshl_add_u32 v11, v12, 6, v11
v_bfe_u32 v12, v10, 3, 1
v_lshl_add_u32 v11, v12, 1, v11
v_bfe_u32 v12, v10, 4, 1
v_lshl_add_u32 v10, v12, 3, v11
v_mul_u32_u24 v10, 1280, v10
v_lshl_add_u32 v77, v9, 4, v10
v_add_u32 v9, 384, v8
v_mul_u32_u24 v10, s53, v9
v_lshrrev_b32 v10, 22, v10
v_mul_u32_u24 v11, 80, v10
v_sub_u32 v9, v9, v11
v_and_b32 v11, 15, v10
v_xor_b32 v9, v9, v11
v_and_b32 v11, 1, v10
v_bfe_u32 v12, v10, 1, 1
v_lshl_add_u32 v11, v12, 4, v11
v_bfe_u32 v12, v10, 2, 1
v_lshl_add_u32 v11, v12, 6, v11
v_bfe_u32 v12, v10, 3, 1
v_lshl_add_u32 v11, v12, 1, v11
v_bfe_u32 v12, v10, 4, 1
v_lshl_add_u32 v10, v12, 3, v11
v_mul_u32_u24 v10, 1280, v10
v_lshl_add_u32 v78, v9, 4, v10
v_add_u32 v9, 448, v8
v_mul_u32_u24 v10, s53, v9
v_lshrrev_b32 v10, 22, v10
v_mul_u32_u24 v11, 80, v10
v_sub_u32 v9, v9, v11
v_and_b32 v11, 15, v10
v_xor_b32 v9, v9, v11
v_and_b32 v11, 1, v10
v_bfe_u32 v12, v10, 1, 1
v_lshl_add_u32 v11, v12, 4, v11
v_bfe_u32 v12, v10, 2, 1
v_lshl_add_u32 v11, v12, 6, v11
v_bfe_u32 v12, v10, 3, 1
v_lshl_add_u32 v11, v12, 1, v11
v_bfe_u32 v12, v10, 4, 1
v_lshl_add_u32 v10, v12, 3, v11
v_mul_u32_u24 v10, 1280, v10
v_lshl_add_u32 v79, v9, 4, v10
v_add_u32 v9, 512, v8
v_mul_u32_u24 v10, s53, v9
v_lshrrev_b32 v10, 22, v10
v_mul_u32_u24 v11, 80, v10
v_sub_u32 v9, v9, v11
v_and_b32 v11, 15, v10
v_xor_b32 v9, v9, v11
v_and_b32 v11, 1, v10
v_bfe_u32 v12, v10, 1, 1
v_lshl_add_u32 v11, v12, 4, v11
v_bfe_u32 v12, v10, 2, 1
v_lshl_add_u32 v11, v12, 6, v11
v_bfe_u32 v12, v10, 3, 1
v_lshl_add_u32 v11, v12, 1, v11
v_bfe_u32 v12, v10, 4, 1
v_lshl_add_u32 v10, v12, 3, v11
v_mul_u32_u24 v10, 1280, v10
v_lshl_add_u32 v80, v9, 4, v10
v_add_u32 v9, 576, v8
v_mul_u32_u24 v10, s53, v9
v_lshrrev_b32 v10, 22, v10
v_mul_u32_u24 v11, 80, v10
v_sub_u32 v9, v9, v11
v_and_b32 v11, 15, v10
v_xor_b32 v9, v9, v11
v_and_b32 v11, 1, v10
v_bfe_u32 v12, v10, 1, 1
v_lshl_add_u32 v11, v12, 4, v11
v_bfe_u32 v12, v10, 2, 1
v_lshl_add_u32 v11, v12, 6, v11
v_bfe_u32 v12, v10, 3, 1
v_lshl_add_u32 v11, v12, 1, v11
v_bfe_u32 v12, v10, 4, 1
v_lshl_add_u32 v10, v12, 3, v11
v_mul_u32_u24 v10, 1280, v10
v_lshl_add_u32 v81, v9, 4, v10
s_mul_i32 s49, s57, 327680
s_mov_b32 s46, s49
s_mov_b32 s47, 0
s_lshl_b32 s48, s58, 18
s_lshl_b32 s52, s57, 14
s_add_u32 s48, s48, s52
s_add_u32 s48, s48, 216006656
s_mov_b32 s50, 512
v_bfe_u32 v2, v0, 6, 1
v_bfe_u32 v3, v0, 7, 1
v_and_b32 v1, 0x30, v0
v_lshl_add_u32 v1, v2, 7, v1
v_lshl_add_u32 v1, v3, 6, v1
v_bfe_u32 v2, v0, 8, 1
v_lshl_add_u32 v1, v2, 11, v1
v_bfe_u32 v2, v0, 9, 1
v_lshl_add_u32 v1, v2, 8, v1
s_mul_i32 s45, s3, 10240
s_mov_b32 s44, 0
v_bfe_u32 v8, v0, 4, 5
v_mul_u32_u24 v9, 1280, v8
v_and_b32 v8, 15, v8
v_lshrrev_b32 v10, 9, v0
v_xor_b32 v8, v8, v10
v_xor_b32 v10, 0, v8
v_lshl_add_u32 v64, v10, 4, v9
v_xor_b32 v10, 2, v8
v_lshl_add_u32 v65, v10, 4, v9
v_xor_b32 v10, 4, v8
v_lshl_add_u32 v66, v10, 4, v9
v_xor_b32 v10, 6, v8
v_lshl_add_u32 v67, v10, 4, v9
v_xor_b32 v10, 8, v8
v_lshl_add_u32 v68, v10, 4, v9
v_xor_b32 v10, 10, v8
v_lshl_add_u32 v69, v10, 4, v9
v_xor_b32 v10, 12, v8
v_lshl_add_u32 v70, v10, 4, v9
v_xor_b32 v10, 14, v8
v_lshl_add_u32 v71, v10, 4, v9
s_add_u32 m0, s45, 0
s_nop 0
buffer_load_dwordx4 v72, s[20:23], s46 offen lds
s_add_u32 m0, s45, 1024
s_nop 0
buffer_load_dwordx4 v73, s[20:23], s46 offen lds
s_add_u32 m0, s45, 2048
s_nop 0
buffer_load_dwordx4 v74, s[20:23], s46 offen lds
s_add_u32 m0, s45, 3072
s_nop 0
buffer_load_dwordx4 v75, s[20:23], s46 offen lds
s_add_u32 m0, s45, 4096
s_nop 0
buffer_load_dwordx4 v76, s[20:23], s46 offen lds
s_add_u32 m0, s45, 5120
s_nop 0
buffer_load_dwordx4 v77, s[20:23], s46 offen lds
s_add_u32 m0, s45, 6144
s_nop 0
buffer_load_dwordx4 v78, s[20:23], s46 offen lds
s_add_u32 m0, s45, 7168
s_nop 0
buffer_load_dwordx4 v79, s[20:23], s46 offen lds
s_add_u32 m0, s45, 8192
s_nop 0
buffer_load_dwordx4 v80, s[20:23], s46 offen lds
s_add_u32 m0, s45, 9216
s_nop 0
buffer_load_dwordx4 v81, s[20:23], s46 offen lds
s_add_u32 s45, s45, 40960
s_cmp_ge_u32 s45, 122880
s_cselect_b32 s55, 122880, 0
s_sub_u32 s45, s45, s55
s_add_u32 s47, s47, 1
s_and_b32 s55, s47, 1
s_mul_i32 s46, s55, 5120
s_and_b32 s55, s47, 2
s_mul_i32 s55, s55, 20480
s_add_u32 s46, s46, s55
s_and_b32 s55, s47, 4
s_mul_i32 s55, s55, 40960
s_add_u32 s46, s46, s55
s_add_u32 s46, s46, s49
s_add_u32 m0, s45, 0
s_nop 0
buffer_load_dwordx4 v72, s[20:23], s46 offen lds
s_add_u32 m0, s45, 1024
s_nop 0
buffer_load_dwordx4 v73, s[20:23], s46 offen lds
s_add_u32 m0, s45, 2048
s_nop 0
buffer_load_dwordx4 v74, s[20:23], s46 offen lds
s_add_u32 m0, s45, 3072
s_nop 0
buffer_load_dwordx4 v75, s[20:23], s46 offen lds
s_add_u32 m0, s45, 4096
s_nop 0
buffer_load_dwordx4 v76, s[20:23], s46 offen lds
s_add_u32 m0, s45, 5120
s_nop 0
buffer_load_dwordx4 v77, s[20:23], s46 offen lds
s_add_u32 m0, s45, 6144
s_nop 0
buffer_load_dwordx4 v78, s[20:23], s46 offen lds
s_add_u32 m0, s45, 7168
s_nop 0
buffer_load_dwordx4 v79, s[20:23], s46 offen lds
s_add_u32 m0, s45, 8192
s_nop 0
buffer_load_dwordx4 v80, s[20:23], s46 offen lds
s_add_u32 m0, s45, 9216
s_nop 0
buffer_load_dwordx4 v81, s[20:23], s46 offen lds
s_add_u32 s45, s45, 40960
s_cmp_ge_u32 s45, 122880
s_cselect_b32 s55, 122880, 0
s_sub_u32 s45, s45, s55
s_add_u32 s47, s47, 1
s_and_b32 s55, s47, 1
s_mul_i32 s46, s55, 5120
s_and_b32 s55, s47, 2
s_mul_i32 s55, s55, 20480
s_add_u32 s46, s46, s55
s_and_b32 s55, s47, 4
s_mul_i32 s55, s55, 40960
s_add_u32 s46, s46, s55
s_add_u32 s46, s46, s49
s_waitcnt vmcnt(10)
s_barrier
ds_read_b128 v[8:11], v64 offset:0
ds_read_b128 v[12:15], v65 offset:0
ds_read_b128 v[16:19], v66 offset:0
ds_read_b128 v[20:23], v67 offset:0
s_mov_b32 s59, 4
s_waitcnt lgkmcnt(3)
v_mfma_f32_32x32x16_bf16 v[32:47], v[8:11], v[96:99], 0
s_waitcnt lgkmcnt(2)
ds_read_b128 v[24:27], v68 offset:0
v_mfma_f32_32x32x16_bf16 v[32:47], v[12:15], v[100:103], v[32:47]
s_waitcnt lgkmcnt(2)
ds_read_b128 v[8:11], v69 offset:0
s_add_u32 m0, s45, 0
s_nop 0
buffer_load_dwordx4 v72, s[20:23], s46 offen lds
s_add_u32 m0, s45, 1024
s_nop 0
buffer_load_dwordx4 v73, s[20:23], s46 offen lds
v_mfma_f32_32x32x16_bf16 v[32:47], v[16:19], v[104:107], v[32:47]
s_waitcnt lgkmcnt(2)
ds_read_b128 v[12:15], v70 offset:0
s_add_u32 m0, s45, 2048
s_nop 0
buffer_load_dwordx4 v74, s[20:23], s46 offen lds
s_add_u32 m0, s45, 3072
s_nop 0
buffer_load_dwordx4 v75, s[20:23], s46 offen lds
v_mfma_f32_32x32x16_bf16 v[32:47], v[20:23], v[108:111], v[32:47]
s_waitcnt lgkmcnt(2)
ds_read_b128 v[16:19], v71 offset:0
s_add_u32 m0, s45, 4096
s_nop 0
buffer_load_dwordx4 v76, s[20:23], s46 offen lds
s_add_u32 m0, s45, 5120
s_nop 0
buffer_load_dwordx4 v77, s[20:23], s46 offen lds
v_mfma_f32_32x32x16_bf16 v[32:47], v[24:27], v[112:115], v[32:47]
s_waitcnt lgkmcnt(2)
ds_read_b128 v[20:23], v64 offset:256
s_add_u32 m0, s45, 6144
s_nop 0
buffer_load_dwordx4 v78, s[20:23], s46 offen lds
s_add_u32 m0, s45, 7168
s_nop 0
buffer_load_dwordx4 v79, s[20:23], s46 offen lds
v_mfma_f32_32x32x16_bf16 v[32:47], v[8:11], v[116:119], v[32:47]
s_waitcnt lgkmcnt(2)
ds_read_b128 v[24:27], v65 offset:256
s_add_u32 m0, s45, 8192
s_nop 0
buffer_load_dwordx4 v80, s[20:23], s46 offen lds
s_add_u32 m0, s45, 9216
s_nop 0
buffer_load_dwordx4 v81, s[20:23], s46 offen lds
v_mfma_f32_32x32x16_bf16 v[32:47], v[12:15], v[120:123], v[32:47]
s_waitcnt lgkmcnt(2)
ds_read_b128 v[8:11], v66 offset:256
s_add_u32 s45, s45, 40960
s_cmp_ge_u32 s45, 122880
s_cselect_b32 s55, 122880, 0
s_sub_u32 s45, s45, s55
s_add_u32 s47, s47, 1
s_and_b32 s55, s47, 1
s_mul_i32 s46, s55, 5120
s_and_b32 s55, s47, 2
s_mul_i32 s55, s55, 20480
s_add_u32 s46, s46, s55
s_and_b32 s55, s47, 4
s_mul_i32 s55, s55, 40960
s_add_u32 s46, s46, s55
s_add_u32 s46, s46, s49
v_mfma_f32_32x32x16_bf16 v[32:47], v[16:19], v[124:127], v[32:47]
s_waitcnt lgkmcnt(2)
ds_read_b128 v[12:15], v67 offset:256
v_mfma_f32_32x32x16_bf16 v[32:47], v[20:23], v[128:131], v[32:47]
s_waitcnt lgkmcnt(2)
ds_read_b128 v[16:19], v68 offset:256
v_mfma_f32_32x32x16_bf16 v[32:47], v[24:27], v[132:135], v[32:47]
s_waitcnt lgkmcnt(2)
ds_read_b128 v[20:23], v69 offset:256
v_mfma_f32_32x32x16_bf16 v[32:47], v[8:11], v[136:139], v[32:47]
s_waitcnt lgkmcnt(2)
ds_read_b128 v[24:27], v70 offset:256
v_mfma_f32_32x32x16_bf16 v[32:47], v[12:15], v[140:143], v[32:47]
s_waitcnt lgkmcnt(2)
ds_read_b128 v[8:11], v71 offset:256
v_mfma_f32_32x32x16_bf16 v[32:47], v[16:19], v[144:147], v[32:47]
s_waitcnt lgkmcnt(2)
ds_read_b128 v[12:15], v64 offset:512
v_mfma_f32_32x32x16_bf16 v[32:47], v[20:23], v[148:151], v[32:47]
s_waitcnt lgkmcnt(2)
ds_read_b128 v[16:19], v65 offset:512
v_mfma_f32_32x32x16_bf16 v[32:47], v[24:27], v[152:155], v[32:47]
s_waitcnt lgkmcnt(2)
ds_read_b128 v[20:23], v66 offset:512
v_mfma_f32_32x32x16_bf16 v[32:47], v[8:11], v[156:159], v[32:47]
s_waitcnt lgkmcnt(2)
ds_read_b128 v[24:27], v67 offset:512
v_mfma_f32_32x32x16_bf16 v[32:47], v[12:15], v[160:163], v[32:47]
s_waitcnt lgkmcnt(2)
ds_read_b128 v[8:11], v68 offset:512
v_mfma_f32_32x32x16_bf16 v[32:47], v[16:19], v[164:167], v[32:47]
s_waitcnt lgkmcnt(2)
ds_read_b128 v[12:15], v69 offset:512
v_mfma_f32_32x32x16_bf16 v[32:47], v[20:23], v[168:171], v[32:47]
s_waitcnt lgkmcnt(2)
ds_read_b128 v[16:19], v70 offset:512
v_mfma_f32_32x32x16_bf16 v[32:47], v[24:27], v[172:175], v[32:47]
s_waitcnt lgkmcnt(2)
ds_read_b128 v[20:23], v71 offset:512
v_mfma_f32_32x32x16_bf16 v[32:47], v[8:11], v[176:179], v[32:47]
s_waitcnt lgkmcnt(2)
ds_read_b128 v[24:27], v64 offset:768
v_mfma_f32_32x32x16_bf16 v[32:47], v[12:15], v[180:183], v[32:47]
s_waitcnt lgkmcnt(2)
ds_read_b128 v[8:11], v65 offset:768
v_mfma_f32_32x32x16_bf16 v[32:47], v[16:19], v[184:187], v[32:47]
s_waitcnt lgkmcnt(2)
ds_read_b128 v[12:15], v66 offset:768
v_mfma_f32_32x32x16_bf16 v[32:47], v[20:23], v[188:191], v[32:47]
s_waitcnt lgkmcnt(2)
ds_read_b128 v[16:19], v67 offset:768
v_mfma_f32_32x32x16_bf16 v[32:47], v[24:27], v[192:195], v[32:47]
s_waitcnt lgkmcnt(2)
ds_read_b128 v[20:23], v68 offset:768
v_mfma_f32_32x32x16_bf16 v[32:47], v[8:11], v[196:199], v[32:47]
s_waitcnt lgkmcnt(2)
ds_read_b128 v[24:27], v69 offset:768
v_mfma_f32_32x32x16_bf16 v[32:47], v[12:15], v[200:203], v[32:47]
s_waitcnt lgkmcnt(2)
ds_read_b128 v[8:11], v70 offset:768
v_mfma_f32_32x32x16_bf16 v[32:47], v[16:19], v[204:207], v[32:47]
s_waitcnt lgkmcnt(2)
ds_read_b128 v[12:15], v71 offset:768
v_mfma_f32_32x32x16_bf16 v[32:47], v[20:23], v[208:211], v[32:47]
s_waitcnt lgkmcnt(2)
ds_read_b128 v[16:19], v64 offset:1024
v_mfma_f32_32x32x16_bf16 v[32:47], v[24:27], v[212:215], v[32:47]
s_waitcnt lgkmcnt(2)
ds_read_b128 v[20:23], v65 offset:1024
v_mfma_f32_32x32x16_bf16 v[32:47], v[8:11], v[216:219], v[32:47]
s_waitcnt lgkmcnt(2)
ds_read_b128 v[24:27], v66 offset:1024
v_mfma_f32_32x32x16_bf16 v[32:47], v[12:15], v[220:223], v[32:47]
s_waitcnt lgkmcnt(2)
ds_read_b128 v[8:11], v67 offset:1024
v_mfma_f32_32x32x16_bf16 v[32:47], v[16:19], v[224:227], v[32:47]
s_waitcnt lgkmcnt(2)
ds_read_b128 v[12:15], v68 offset:1024
v_mfma_f32_32x32x16_bf16 v[32:47], v[20:23], v[228:231], v[32:47]
s_waitcnt lgkmcnt(2)
ds_read_b128 v[16:19], v69 offset:1024
v_mfma_f32_32x32x16_bf16 v[32:47], v[24:27], v[232:235], v[32:47]
s_waitcnt lgkmcnt(2)
ds_read_b128 v[20:23], v70 offset:1024
v_mfma_f32_32x32x16_bf16 v[32:47], v[8:11], v[236:239], v[32:47]
s_waitcnt lgkmcnt(2)
ds_read_b128 v[24:27], v71 offset:1024
v_mfma_f32_32x32x16_bf16 v[32:47], v[12:15], v[240:243], v[32:47]
s_add_u32 s44, s44, 1
s_cmp_eq_u32 s44, 3
s_mov_b32 s56, 40960
s_cmov_b32 s56, -81920
s_cselect_b32 s44, 0, s44
v_add_u32 v64, s56, v64
v_add_u32 v65, s56, v65
v_add_u32 v66, s56, v66
v_add_u32 v67, s56, v67
v_add_u32 v68, s56, v68
v_add_u32 v69, s56, v69
v_add_u32 v70, s56, v70
v_add_u32 v71, s56, v71
s_waitcnt vmcnt(10) lgkmcnt(2)
s_barrier
ds_read_b128 v[8:11], v64 offset:0
v_mfma_f32_32x32x16_bf16 v[32:47], v[16:19], v[244:247], v[32:47]
s_waitcnt lgkmcnt(2)
ds_read_b128 v[12:15], v65 offset:0
v_mfma_f32_32x32x16_bf16 v[32:47], v[20:23], v[248:251], v[32:47]
s_waitcnt lgkmcnt(2)
ds_read_b128 v[16:19], v66 offset:0
v_mfma_f32_32x32x16_bf16 v[32:47], v[24:27], v[252:255], v[32:47]
s_waitcnt lgkmcnt(2)
ds_read_b128 v[20:23], v67 offset:0
k_st_96:
v_mfma_f32_32x32x16_bf16 v[48:63], v[8:11], v[96:99], 0
s_waitcnt lgkmcnt(2)
ds_read_b128 v[24:27], v68 offset:0
v_mfma_f32_32x32x16_bf16 v[48:63], v[12:15], v[100:103], v[48:63]
s_waitcnt lgkmcnt(2)
ds_read_b128 v[8:11], v69 offset:0
v_cvt_pk_bf16_f32 v32, v32, v33
v_cvt_pk_bf16_f32 v33, v34, v35
v_mfma_f32_32x32x16_bf16 v[48:63], v[16:19], v[104:107], v[48:63]
s_waitcnt lgkmcnt(2)
ds_read_b128 v[12:15], v70 offset:0
v_cvt_pk_bf16_f32 v34, v36, v37
v_cvt_pk_bf16_f32 v35, v38, v39
v_mfma_f32_32x32x16_bf16 v[48:63], v[20:23], v[108:111], v[48:63]
s_waitcnt lgkmcnt(2)
ds_read_b128 v[16:19], v71 offset:0
v_cvt_pk_bf16_f32 v36, v40, v41
v_cvt_pk_bf16_f32 v37, v42, v43
v_mfma_f32_32x32x16_bf16 v[48:63], v[24:27], v[112:115], v[48:63]
s_waitcnt lgkmcnt(2)
ds_read_b128 v[20:23], v64 offset:256
v_cvt_pk_bf16_f32 v38, v44, v45
v_cvt_pk_bf16_f32 v39, v46, v47
v_mfma_f32_32x32x16_bf16 v[48:63], v[8:11], v[116:119], v[48:63]
s_waitcnt lgkmcnt(2)
ds_read_b128 v[24:27], v65 offset:256
buffer_store_dwordx4 v[32:35], v1, s[4:7], s48 offen offset:0 sc1
buffer_store_dwordx4 v[36:39], v1, s[4:7], s48 offen offset:1024 sc1
v_mfma_f32_32x32x16_bf16 v[48:63], v[12:15], v[120:123], v[48:63]
s_waitcnt lgkmcnt(2)
ds_read_b128 v[8:11], v66 offset:256
s_add_u32 s48, s48, s50
s_sub_u32 s50, 4096, s50
s_add_u32 m0, s45, 0
s_nop 0
buffer_load_dwordx4 v72, s[20:23], s46 offen lds
v_mfma_f32_32x32x16_bf16 v[48:63], v[16:19], v[124:127], v[48:63]
s_waitcnt lgkmcnt(2)
ds_read_b128 v[12:15], v67 offset:256
s_add_u32 m0, s45, 1024
s_nop 0
buffer_load_dwordx4 v73, s[20:23], s46 offen lds
s_add_u32 m0, s45, 2048
s_nop 0
buffer_load_dwordx4 v74, s[20:23], s46 offen lds
v_mfma_f32_32x32x16_bf16 v[48:63], v[20:23], v[128:131], v[48:63]
s_waitcnt lgkmcnt(2)
ds_read_b128 v[16:19], v68 offset:256
s_add_u32 m0, s45, 3072
s_nop 0
buffer_load_dwordx4 v75, s[20:23], s46 offen lds
s_add_u32 m0, s45, 4096
s_nop 0
buffer_load_dwordx4 v76, s[20:23], s46 offen lds
v_mfma_f32_32x32x16_bf16 v[48:63], v[24:27], v[132:135], v[48:63]
s_waitcnt lgkmcnt(2)
ds_read_b128 v[20:23], v69 offset:256
s_add_u32 m0, s45, 5120
s_nop 0
buffer_load_dwordx4 v77, s[20:23], s46 offen lds
s_add_u32 m0, s45, 6144
s_nop 0
buffer_load_dwordx4 v78, s[20:23], s46 offen lds
v_mfma_f32_32x32x16_bf16 v[48:63], v[8:11], v[136:139], v[48:63]
s_waitcnt lgkmcnt(2)
ds_read_b128 v[24:27], v70 offset:256
s_add_u32 m0, s45, 7168
s_nop 0
buffer_load_dwordx4 v79, s[20:23], s46 offen lds
s_add_u32 m0, s45, 8192
s_nop 0
buffer_load_dwordx4 v80, s[20:23], s46 offen lds
v_mfma_f32_32x32x16_bf16 v[48:63], v[12:15], v[140:143], v[48:63]
s_waitcnt lgkmcnt(2)
ds_read_b128 v[8:11], v71 offset:256
s_add_u32 m0, s45, 9216
s_nop 0
buffer_load_dwordx4 v81, s[20:23], s46 offen lds
s_add_u32 s45, s45, 40960
s_cmp_ge_u32 s45, 122880
s_cselect_b32 s55, 122880, 0
s_sub_u32 s45, s45, s55
v_mfma_f32_32x32x16_bf16 v[48:63], v[16:19], v[144:147], v[48:63]
s_waitcnt lgkmcnt(2)
ds_read_b128 v[12:15], v64 offset:512
s_add_u32 s47, s47, 1
s_and_b32 s55, s47, 1
s_mul_i32 s46, s55, 5120
s_and_b32 s55, s47, 2
s_mul_i32 s55, s55, 20480
s_add_u32 s46, s46, s55
s_and_b32 s55, s47, 4
s_mul_i32 s55, s55, 40960
s_add_u32 s46, s46, s55
s_add_u32 s46, s46, s49
v_mfma_f32_32x32x16_bf16 v[48:63], v[20:23], v[148:151], v[48:63]
s_waitcnt lgkmcnt(2)
ds_read_b128 v[16:19], v65 offset:512
v_mfma_f32_32x32x16_bf16 v[48:63], v[24:27], v[152:155], v[48:63]
s_waitcnt lgkmcnt(2)
ds_read_b128 v[20:23], v66 offset:512
v_mfma_f32_32x32x16_bf16 v[48:63], v[8:11], v[156:159], v[48:63]
s_waitcnt lgkmcnt(2)
ds_read_b128 v[24:27], v67 offset:512
v_mfma_f32_32x32x16_bf16 v[48:63], v[12:15], v[160:163], v[48:63]
s_waitcnt lgkmcnt(2)
ds_read_b128 v[8:11], v68 offset:512
v_mfma_f32_32x32x16_bf16 v[48:63], v[16:19], v[164:167], v[48:63]
s_waitcnt lgkmcnt(2)
ds_read_b128 v[12:15], v69 offset:512
v_mfma_f32_32x32x16_bf16 v[48:63], v[20:23], v[168:171], v[48:63]
s_waitcnt lgkmcnt(2)
ds_read_b128 v[16:19], v70 offset:512
v_mfma_f32_32x32x16_bf16 v[48:63], v[24:27], v[172:175], v[48:63]
s_waitcnt lgkmcnt(2)
ds_read_b128 v[20:23], v71 offset:512
v_mfma_f32_32x32x16_bf16 v[48:63], v[8:11], v[176:179], v[48:63]
s_waitcnt lgkmcnt(2)
ds_read_b128 v[24:27], v64 offset:768
v_mfma_f32_32x32x16_bf16 v[48:63], v[12:15], v[180:183], v[48:63]
s_waitcnt lgkmcnt(2)
ds_read_b128 v[8:11], v65 offset:768
v_mfma_f32_32x32x16_bf16 v[48:63], v[16:19], v[184:187], v[48:63]
s_waitcnt lgkmcnt(2)
ds_read_b128 v[12:15], v66 offset:768
v_mfma_f32_32x32x16_bf16 v[48:63], v[20:23], v[188:191], v[48:63]
s_waitcnt lgkmcnt(2)
ds_read_b128 v[16:19], v67 offset:768
v_mfma_f32_32x32x16_bf16 v[48:63], v[24:27], v[192:195], v[48:63]
s_waitcnt lgkmcnt(2)
ds_read_b128 v[20:23], v68 offset:768
v_mfma_f32_32x32x16_bf16 v[48:63], v[8:11], v[196:199], v[48:63]
s_waitcnt lgkmcnt(2)
ds_read_b128 v[24:27], v69 offset:768
v_mfma_f32_32x32x16_bf16 v[48:63], v[12:15], v[200:203], v[48:63]
s_waitcnt lgkmcnt(2)
ds_read_b128 v[8:11], v70 offset:768
v_mfma_f32_32x32x16_bf16 v[48:63], v[16:19], v[204:207], v[48:63]
s_waitcnt lgkmcnt(2)
ds_read_b128 v[12:15], v71 offset:768
v_mfma_f32_32x32x16_bf16 v[48:63], v[20:23], v[208:211], v[48:63]
s_waitcnt lgkmcnt(2)
ds_read_b128 v[16:19], v64 offset:1024
v_mfma_f32_32x32x16_bf16 v[48:63], v[24:27], v[212:215], v[48:63]
s_waitcnt lgkmcnt(2)
ds_read_b128 v[20:23], v65 offset:1024
v_mfma_f32_32x32x16_bf16 v[48:63], v[8:11], v[216:219], v[48:63]
s_waitcnt lgkmcnt(2)
ds_read_b128 v[24:27], v66 offset:1024
v_mfma_f32_32x32x16_bf16 v[48:63], v[12:15], v[220:223], v[48:63]
s_waitcnt lgkmcnt(2)
ds_read_b128 v[8:11], v67 offset:1024
v_mfma_f32_32x32x16_bf16 v[48:63], v[16:19], v[224:227], v[48:63]
s_waitcnt lgkmcnt(2)
ds_read_b128 v[12:15], v68 offset:1024
v_mfma_f32_32x32x16_bf16 v[48:63], v[20:23], v[228:231], v[48:63]
s_waitcnt lgkmcnt(2)
ds_read_b128 v[16:19], v69 offset:1024
v_mfma_f32_32x32x16_bf16 v[48:63], v[24:27], v[232:235], v[48:63]
s_waitcnt lgkmcnt(2)
ds_read_b128 v[20:23], v70 offset:1024
v_mfma_f32_32x32x16_bf16 v[48:63], v[8:11], v[236:239], v[48:63]
s_waitcnt lgkmcnt(2)
ds_read_b128 v[24:27], v71 offset:1024
v_mfma_f32_32x32x16_bf16 v[48:63], v[12:15], v[240:243], v[48:63]
s_add_u32 s44, s44, 1
s_cmp_eq_u32 s44, 3
s_mov_b32 s56, 40960
s_cmov_b32 s56, -81920
s_cselect_b32 s44, 0, s44
v_add_u32 v64, s56, v64
v_add_u32 v65, s56, v65
v_add_u32 v66, s56, v66
v_add_u32 v67, s56, v67
v_add_u32 v68, s56, v68
v_add_u32 v69, s56, v69
v_add_u32 v70, s56, v70
v_add_u32 v71, s56, v71
s_waitcnt vmcnt(10) lgkmcnt(2)
s_barrier
ds_read_b128 v[8:11], v64 offset:0
v_mfma_f32_32x32x16_bf16 v[48:63], v[16:19], v[244:247], v[48:63]
s_waitcnt lgkmcnt(2)
ds_read_b128 v[12:15], v65 offset:0
v_mfma_f32_32x32x16_bf16 v[48:63], v[20:23], v[248:251], v[48:63]
s_waitcnt lgkmcnt(2)
ds_read_b128 v[16:19], v66 offset:0
v_mfma_f32_32x32x16_bf16 v[48:63], v[24:27], v[252:255], v[48:63]
s_waitcnt lgkmcnt(2)
ds_read_b128 v[20:23], v67 offset:0
s_sub_u32 s59, s59, 1
s_cmp_eq_u32 s59, 0
s_cbranch_scc1 k_so_97
v_mfma_f32_32x32x16_bf16 v[32:47], v[8:11], v[96:99], 0
s_waitcnt lgkmcnt(2)
ds_read_b128 v[24:27], v68 offset:0
v_mfma_f32_32x32x16_bf16 v[32:47], v[12:15], v[100:103], v[32:47]
s_waitcnt lgkmcnt(2)
ds_read_b128 v[8:11], v69 offset:0
v_cvt_pk_bf16_f32 v48, v48, v49
v_cvt_pk_bf16_f32 v49, v50, v51
v_mfma_f32_32x32x16_bf16 v[32:47], v[16:19], v[104:107], v[32:47]
s_waitcnt lgkmcnt(2)
ds_read_b128 v[12:15], v70 offset:0
v_cvt_pk_bf16_f32 v50, v52, v53
v_cvt_pk_bf16_f32 v51, v54, v55
v_mfma_f32_32x32x16_bf16 v[32:47], v[20:23], v[108:111], v[32:47]
s_waitcnt lgkmcnt(2)
ds_read_b128 v[16:19], v71 offset:0
v_cvt_pk_bf16_f32 v52, v56, v57
v_cvt_pk_bf16_f32 v53, v58, v59
v_mfma_f32_32x32x16_bf16 v[32:47], v[24:27], v[112:115], v[32:47]
s_waitcnt lgkmcnt(2)
ds_read_b128 v[20:23], v64 offset:256
v_cvt_pk_bf16_f32 v54, v60, v61
v_cvt_pk_bf16_f32 v55, v62, v63
v_mfma_f32_32x32x16_bf16 v[32:47], v[8:11], v[116:119], v[32:47]
s_waitcnt lgkmcnt(2)
ds_read_b128 v[24:27], v65 offset:256
buffer_store_dwordx4 v[48:51], v1, s[4:7], s48 offen offset:0 sc1
buffer_store_dwordx4 v[52:55], v1, s[4:7], s48 offen offset:1024 sc1
v_mfma_f32_32x32x16_bf16 v[32:47], v[12:15], v[120:123], v[32:47]
s_waitcnt lgkmcnt(2)
ds_read_b128 v[8:11], v66 offset:256
s_add_u32 s48, s48, s50
s_sub_u32 s50, 4096, s50
s_add_u32 m0, s45, 0
s_nop 0
buffer_load_dwordx4 v72, s[20:23], s46 offen lds
v_mfma_f32_32x32x16_bf16 v[32:47], v[16:19], v[124:127], v[32:47]
s_waitcnt lgkmcnt(2)
ds_read_b128 v[12:15], v67 offset:256
s_add_u32 m0, s45, 1024
s_nop 0
buffer_load_dwordx4 v73, s[20:23], s46 offen lds
s_add_u32 m0, s45, 2048
s_nop 0
buffer_load_dwordx4 v74, s[20:23], s46 offen lds
v_mfma_f32_32x32x16_bf16 v[32:47], v[20:23], v[128:131], v[32:47]
s_waitcnt lgkmcnt(2)
ds_read_b128 v[16:19], v68 offset:256
s_add_u32 m0, s45, 3072
s_nop 0
buffer_load_dwordx4 v75, s[20:23], s46 offen lds
s_add_u32 m0, s45, 4096
s_nop 0
buffer_load_dwordx4 v76, s[20:23], s46 offen lds
v_mfma_f32_32x32x16_bf16 v[32:47], v[24:27], v[132:135], v[32:47]
s_waitcnt lgkmcnt(2)
ds_read_b128 v[20:23], v69 offset:256
s_add_u32 m0, s45, 5120
s_nop 0
buffer_load_dwordx4 v77, s[20:23], s46 offen lds
s_add_u32 m0, s45, 6144
s_nop 0
buffer_load_dwordx4 v78, s[20:23], s46 offen lds
v_mfma_f32_32x32x16_bf16 v[32:47], v[8:11], v[136:139], v[32:47]
s_waitcnt lgkmcnt(2)
ds_read_b128 v[24:27], v70 offset:256
s_add_u32 m0, s45, 7168
s_nop 0
buffer_load_dwordx4 v79, s[20:23], s46 offen lds
s_add_u32 m0, s45, 8192
s_nop 0
buffer_load_dwordx4 v80, s[20:23], s46 offen lds
v_mfma_f32_32x32x16_bf16 v[32:47], v[12:15], v[140:143], v[32:47]
s_waitcnt lgkmcnt(2)
ds_read_b128 v[8:11], v71 offset:256
s_add_u32 m0, s45, 9216
s_nop 0
buffer_load_dwordx4 v81, s[20:23], s46 offen lds
s_add_u32 s45, s45, 40960
s_cmp_ge_u32 s45, 122880
s_cselect_b32 s55, 122880, 0
s_sub_u32 s45, s45, s55
v_mfma_f32_32x32x16_bf16 v[32:47], v[16:19], v[144:147], v[32:47]
s_waitcnt lgkmcnt(2)
ds_read_b128 v[12:15], v64 offset:512
s_add_u32 s47, s47, 1
s_and_b32 s55, s47, 1
s_mul_i32 s46, s55, 5120
s_and_b32 s55, s47, 2
s_mul_i32 s55, s55, 20480
s_add_u32 s46, s46, s55
s_and_b32 s55, s47, 4
s_mul_i32 s55, s55, 40960
s_add_u32 s46, s46, s55
s_add_u32 s46, s46, s49
v_mfma_f32_32x32x16_bf16 v[32:47], v[20:23], v[148:151], v[32:47]
s_waitcnt lgkmcnt(2)
ds_read_b128 v[16:19], v65 offset:512
v_mfma_f32_32x32x16_bf16 v[32:47], v[24:27], v[152:155], v[32:47]
s_waitcnt lgkmcnt(2)
ds_read_b128 v[20:23], v66 offset:512
v_mfma_f32_32x32x16_bf16 v[32:47], v[8:11], v[156:159], v[32:47]
s_waitcnt lgkmcnt(2)
ds_read_b128 v[24:27], v67 offset:512
v_mfma_f32_32x32x16_bf16 v[32:47], v[12:15], v[160:163], v[32:47]
s_waitcnt lgkmcnt(2)
ds_read_b128 v[8:11], v68 offset:512
v_mfma_f32_32x32x16_bf16 v[32:47], v[16:19], v[164:167], v[32:47]
s_waitcnt lgkmcnt(2)
ds_read_b128 v[12:15], v69 offset:512
v_mfma_f32_32x32x16_bf16 v[32:47], v[20:23], v[168:171], v[32:47]
s_waitcnt lgkmcnt(2)
ds_read_b128 v[16:19], v70 offset:512
v_mfma_f32_32x32x16_bf16 v[32:47], v[24:27], v[172:175], v[32:47]
s_waitcnt lgkmcnt(2)
ds_read_b128 v[20:23], v71 offset:512
v_mfma_f32_32x32x16_bf16 v[32:47], v[8:11], v[176:179], v[32:47]
s_waitcnt lgkmcnt(2)
ds_read_b128 v[24:27], v64 offset:768
v_mfma_f32_32x32x16_bf16 v[32:47], v[12:15], v[180:183], v[32:47]
s_waitcnt lgkmcnt(2)
ds_read_b128 v[8:11], v65 offset:768
v_mfma_f32_32x32x16_bf16 v[32:47], v[16:19], v[184:187], v[32:47]
s_waitcnt lgkmcnt(2)
ds_read_b128 v[12:15], v66 offset:768
v_mfma_f32_32x32x16_bf16 v[32:47], v[20:23], v[188:191], v[32:47]
s_waitcnt lgkmcnt(2)
ds_read_b128 v[16:19], v67 offset:768
v_mfma_f32_32x32x16_bf16 v[32:47], v[24:27], v[192:195], v[32:47]
s_waitcnt lgkmcnt(2)
ds_read_b128 v[20:23], v68 offset:768
v_mfma_f32_32x32x16_bf16 v[32:47], v[8:11], v[196:199], v[32:47]
s_waitcnt lgkmcnt(2)
ds_read_b128 v[24:27], v69 offset:768
v_mfma_f32_32x32x16_bf16 v[32:47], v[12:15], v[200:203], v[32:47]
s_waitcnt lgkmcnt(2)
ds_read_b128 v[8:11], v70 offset:768
v_mfma_f32_32x32x16_bf16 v[32:47], v[16:19], v[204:207], v[32:47]
s_waitcnt lgkmcnt(2)
ds_read_b128 v[12:15], v71 offset:768
v_mfma_f32_32x32x16_bf16 v[32:47], v[20:23], v[208:211], v[32:47]
s_waitcnt lgkmcnt(2)
ds_read_b128 v[16:19], v64 offset:1024
v_mfma_f32_32x32x16_bf16 v[32:47], v[24:27], v[212:215], v[32:47]
s_waitcnt lgkmcnt(2)
ds_read_b128 v[20:23], v65 offset:1024
v_mfma_f32_32x32x16_bf16 v[32:47], v[8:11], v[216:219], v[32:47]
s_waitcnt lgkmcnt(2)
ds_read_b128 v[24:27], v66 offset:1024
v_mfma_f32_32x32x16_bf16 v[32:47], v[12:15], v[220:223], v[32:47]
s_waitcnt lgkmcnt(2)
ds_read_b128 v[8:11], v67 offset:1024
v_mfma_f32_32x32x16_bf16 v[32:47], v[16:19], v[224:227], v[32:47]
s_waitcnt lgkmcnt(2)
ds_read_b128 v[12:15], v68 offset:1024
v_mfma_f32_32x32x16_bf16 v[32:47], v[20:23], v[228:231], v[32:47]
s_waitcnt lgkmcnt(2)
ds_read_b128 v[16:19], v69 offset:1024
v_mfma_f32_32x32x16_bf16 v[32:47], v[24:27], v[232:235], v[32:47]
s_waitcnt lgkmcnt(2)
ds_read_b128 v[20:23], v70 offset:1024
v_mfma_f32_32x32x16_bf16 v[32:47], v[8:11], v[236:239], v[32:47]
s_waitcnt lgkmcnt(2)
ds_read_b128 v[24:27], v71 offset:1024
v_mfma_f32_32x32x16_bf16 v[32:47], v[12:15], v[240:243], v[32:47]
s_add_u32 s44, s44, 1
s_cmp_eq_u32 s44, 3
s_mov_b32 s56, 40960
s_cmov_b32 s56, -81920
s_cselect_b32 s44, 0, s44
v_add_u32 v64, s56, v64
v_add_u32 v65, s56, v65
v_add_u32 v66, s56, v66
v_add_u32 v67, s56, v67
v_add_u32 v68, s56, v68
v_add_u32 v69, s56, v69
v_add_u32 v70, s56, v70
v_add_u32 v71, s56, v71
s_waitcnt vmcnt(10) lgkmcnt(2)
s_barrier
ds_read_b128 v[8:11], v64 offset:0
v_mfma_f32_32x32x16_bf16 v[32:47], v[16:19], v[244:247], v[32:47]
s_waitcnt lgkmcnt(2)
ds_read_b128 v[12:15], v65 offset:0
v_mfma_f32_32x32x16_bf16 v[32:47], v[20:23], v[248:251], v[32:47]
s_waitcnt lgkmcnt(2)
ds_read_b128 v[16:19], v66 offset:0
v_mfma_f32_32x32x16_bf16 v[32:47], v[24:27], v[252:255], v[32:47]
s_waitcnt lgkmcnt(2)
ds_read_b128 v[20:23], v67 offset:0
s_branch k_st_96
k_so_97:
s_nop 6
v_cvt_pk_bf16_f32 v48, v48, v49
v_cvt_pk_bf16_f32 v49, v50, v51
v_cvt_pk_bf16_f32 v50, v52, v53
v_cvt_pk_bf16_f32 v51, v54, v55
v_cvt_pk_bf16_f32 v52, v56, v57
v_cvt_pk_bf16_f32 v53, v58, v59
v_cvt_pk_bf16_f32 v54, v60, v61
v_cvt_pk_bf16_f32 v55, v62, v63
buffer_store_dwordx4 v[48:51], v1, s[4:7], s48 offen offset:0 sc1
buffer_store_dwordx4 v[52:55], v1, s[4:7], s48 offen offset:1024 sc1
s_add_u32 s48, s48, s50
s_sub_u32 s50, 4096, s50
s_lshl_b32 s54, s30, 6
s_add_u32 s54, s54, 222322688
s_waitcnt lgkmcnt(0)
s_waitcnt vmcnt(0)
s_barrier
s_cmp_lg_u32 s3, 0
s_cbranch_scc1 k_s8_98
s_mov_b64 exec, 1
v_mov_b32 v2, 1
buffer_store_dword v2, off, s[4:7], s54 sc1
s_mov_b64 exec, -1
k_s8_98:
s_mul_i32 s57, s30, 3277
s_lshr_b32 s57, s57, 16
s_mul_i32 s52, s57, 20
s_sub_u32 s58, s30, s52
s_mov_b32 s54, 222322688
v_add_u32 v10, 4096, v0
v_add_u32 v11, 8192, v0
v_add_u32 v12, 12288, v0
s_cmp_lg_u32 s3, 0
s_cbranch_scc1 k_w8d_100
v_lshlrev_b32 v96, 2, v0
k_w8_99:
buffer_load_dword v97, v96, s[4:7], s54 offen sc1
buffer_load_dword v98, v96, s[4:7], s54 offen offset:1024 sc1
s_waitcnt vmcnt(0)
v_and_b32 v97, v97, v98
v_cmp_eq_u32 vcc, 0, v97
s_cbranch_vccz k_w8d_100
s_sleep 1
s_sub_u32 s32, s32, 1
s_cmp_gt_i32 s32, 0
s_cbranch_scc1 k_w8_99
k_w8d_100:
s_barrier
s_lshl_b32 s52, s58, 2
s_add_u32 s52, s52, s3
s_lshl_b32 s52, s52, 16
s_add_u32 s52, s52, 216006656
buffer_load_dwordx4 a[0:3], v0, s[4:7], s52 offen offset:0 sc1
buffer_load_dwordx4 a[4:7], v0, s[4:7], s52 offen offset:1024 sc1
buffer_load_dwordx4 a[8:11], v0, s[4:7], s52 offen offset:2048 sc1
buffer_load_dwordx4 a[12:15], v0, s[4:7], s52 offen offset:3072 sc1
buffer_load_dwordx4 a[16:19], v10, s[4:7], s52 offen offset:0 sc1
buffer_load_dwordx4 a[20:23], v10, s[4:7], s52 offen offset:1024 sc1
buffer_load_dwordx4 a[24:27], v10, s[4:7], s52 offen offset:2048 sc1
buffer_load_dwordx4 a[28:31], v10, s[4:7], s52 offen offset:3072 sc1
buffer_load_dwordx4 a[32:35], v11, s[4:7], s52 offen offset:0 sc1
buffer_load_dwordx4 a[36:39], v11, s[4:7], s52 offen offset:1024 sc1
buffer_load_dwordx4 a[40:43], v11, s[4:7], s52 offen offset:2048 sc1
buffer_load_dwordx4 a[44:47], v11, s[4:7], s52 offen offset:3072 sc1
buffer_load_dwordx4 a[48:51], v12, s[4:7], s52 offen offset:0 sc1
buffer_load_dwordx4 a[52:55], v12, s[4:7], s52 offen offset:1024 sc1
buffer_load_dwordx4 a[56:59], v12, s[4:7], s52 offen offset:2048 sc1
buffer_load_dwordx4 a[60:63], v12, s[4:7], s52 offen offset:3072 sc1
s_add_u32 s52, s52, 16384
buffer_load_dwordx4 a[64:67], v0, s[4:7], s52 offen offset:0 sc1
buffer_load_dwordx4 a[68:71], v0, s[4:7], s52 offen offset:1024 sc1
buffer_load_dwordx4 a[72:75], v0, s[4:7], s52 offen offset:2048 sc1
buffer_load_dwordx4 a[76:79], v0, s[4:7], s52 offen offset:3072 sc1
buffer_load_dwordx4 a[80:83], v10, s[4:7], s52 offen offset:0 sc1
buffer_load_dwordx4 a[84:87], v10, s[4:7], s52 offen offset:1024 sc1
buffer_load_dwordx4 a[88:91], v10, s[4:7], s52 offen offset:2048 sc1
buffer_load_dwordx4 a[92:95], v10, s[4:7], s52 offen offset:3072 sc1
buffer_load_dwordx4 a[96:99], v11, s[4:7], s52 offen offset:0 sc1
buffer_load_dwordx4 a[100:103], v11, s[4:7], s52 offen offset:1024 sc1
buffer_load_dwordx4 a[104:107], v11, s[4:7], s52 offen offset:2048 sc1
buffer_load_dwordx4 a[108:111], v11, s[4:7], s52 offen offset:3072 sc1
buffer_load_dwordx4 a[112:115], v12, s[4:7], s52 offen offset:0 sc1
buffer_load_dwordx4 a[116:119], v12, s[4:7], s52 offen offset:1024 sc1
buffer_load_dwordx4 a[120:123], v12, s[4:7], s52 offen offset:2048 sc1
buffer_load_dwordx4 a[124:127], v12, s[4:7], s52 offen offset:3072 sc1
s_waitcnt vmcnt(0)
s_add_u32 s52, s52, 16384
buffer_load_dwordx4 a[128:131], v0, s[4:7], s52 offen offset:0 sc1
buffer_load_dwordx4 a[132:135], v0, s[4:7], s52 offen offset:1024 sc1
buffer_load_dwordx4 a[136:139], v0, s[4:7], s52 offen offset:2048 sc1
buffer_load_dwordx4 a[140:143], v0, s[4:7], s52 offen offset:3072 sc1
buffer_load_dwordx4 a[144:147], v10, s[4:7], s52 offen offset:0 sc1
buffer_load_dwordx4 a[148:151], v10, s[4:7], s52 offen offset:1024 sc1
buffer_load_dwordx4 a[152:155], v10, s[4:7], s52 offen offset:2048 sc1
buffer_load_dwordx4 a[156:159], v10, s[4:7], s52 offen offset:3072 sc1
buffer_load_dwordx4 a[160:163], v11, s[4:7], s52 offen offset:0 sc1
buffer_load_dwordx4 a[164:167], v11, s[4:7], s52 offen offset:1024 sc1
buffer_load_dwordx4 a[168:171], v11, s[4:7], s52 offen offset:2048 sc1
buffer_load_dwordx4 a[172:175], v11, s[4:7], s52 offen offset:3072 sc1
buffer_load_dwordx4 a[176:179], v12, s[4:7], s52 offen offset:0 sc1
buffer_load_dwordx4 a[180:183], v12, s[4:7], s52 offen offset:1024 sc1
buffer_load_dwordx4 a[184:187], v12, s[4:7], s52 offen offset:2048 sc1
buffer_load_dwordx4 a[188:191], v12, s[4:7], s52 offen offset:3072 sc1
s_add_u32 s52, s52, 16384
buffer_load_dwordx4 a[192:195], v0, s[4:7], s52 offen offset:0 sc1
buffer_load_dwordx4 a[196:199], v0, s[4:7], s52 offen offset:1024 sc1
buffer_load_dwordx4 a[200:203], v0, s[4:7], s52 offen offset:2048 sc1
buffer_load_dwordx4 a[204:207], v0, s[4:7], s52 offen offset:3072 sc1
buffer_load_dwordx4 a[208:211], v10, s[4:7], s52 offen offset:0 sc1
buffer_load_dwordx4 a[212:215], v10, s[4:7], s52 offen offset:1024 sc1
buffer_load_dwordx4 a[216:219], v10, s[4:7], s52 offen offset:2048 sc1
buffer_load_dwordx4 a[220:223], v10, s[4:7], s52 offen offset:3072 sc1
buffer_load_dwordx4 a[224:227], v11, s[4:7], s52 offen offset:0 sc1
buffer_load_dwordx4 a[228:231], v11, s[4:7], s52 offen offset:1024 sc1
buffer_load_dwordx4 a[232:235], v11, s[4:7], s52 offen offset:2048 sc1
buffer_load_dwordx4 a[236:239], v11, s[4:7], s52 offen offset:3072 sc1
buffer_load_dwordx4 a[240:243], v12, s[4:7], s52 offen offset:0 sc1
buffer_load_dwordx4 a[244:247], v12, s[4:7], s52 offen offset:1024 sc1
buffer_load_dwordx4 a[248:251], v12, s[4:7], s52 offen offset:2048 sc1
buffer_load_dwordx4 a[252:255], v12, s[4:7], s52 offen offset:3072 sc1
s_waitcnt vmcnt(0)
s_lshl_b32 s46, s57, 16
s_lshl_b32 s52, s3, 14
s_add_u32 s46, s46, s52
s_add_u32 s46, s46, 159383552
s_lshl_b32 s53, s57, 7
s_lshl_b32 s44, s58, 11
s_add_u32 s44, s44, s53
s_add_u32 s44, s44, 195035136
s_lshl_b32 s45, s58, 17
s_add_u32 s45, s45, s53
s_add_u32 s45, s45, 205520896
s_lshl_b32 s48, s58, 7
s_lshl_b32 s53, s57, 5
s_add_u32 s48, s48, s53
s_add_u32 s48, s48, 211812352
s_lshr_b32 s49, s57, 1
s_lshl_b32 s49, s49, 8
s_lshl_b32 s53, s3, 5
s_add_u32 s49, s49, s53
s_add_u32 s49, s49, 222339072
s_mov_b32 s50, 1
v_lshrrev_b32 v96, 4, v0
v_and_b32 v97, 8, v96
v_cmp_ne_u32 vcc, 0, v97
v_mov_b32 v1, 0x4444
v_mov_b32 v97, 0xeeee
v_cndmask_b32 v1, v1, v97, vcc
v_and_b32 v97, 7, v96
v_lshrrev_b32 v98, 3, v96
v_lshlrev_b32 v2, 2, v97
v_mul_u32_u24 v4, 144, v98
v_lshl_add_u32 v4, v97, 4, v4
v_and_b32 v99, 1, v96
v_lshlrev_b32 v99, 3, v99
v_lshl_add_u32 v99, v98, 4, v99
v_bfe_u32 v100, v96, 1, 2
v_lshl_add_u32 v5, v100, 9, v99
v_lshl_add_u32 v6, v100, 15, v99
v_lshlrev_b32 v7, 2, v98
v_mov_b32 v99, 2146435072
v_cmp_eq_u32 vcc, 0, v97
s_nop 1
v_cndmask_b32 v7, v99, v7, vcc
v_add_u32 v97, s58, v97
v_cmp_eq_u32 vcc, 0, v97
s_nop 1
v_cndmask_b32 v9, 1.0, 0, vcc
v_and_b32 v3, 15, v96
v_bfe_u32 v97, v96, 4, 1
v_mul_u32_u24 v97, 144, v97
v_add_u32 v3, v3, v97
v_lshrrev_b32 v97, 5, v96
v_lshl_add_u32 v3, v97, 4, v3
v_lshlrev_b32 v3, 2, v3
s_mul_i32 s52, s3, 1152
v_add_u32 v3, s52, v3
s_mov_b32 s56, 8192
k_poll_102:
buffer_load_dword v8, v2, s[4:7], s49 offen sc1
s_waitcnt vmcnt(0)
v_cmp_gt_u32 vcc, s50, v8
s_cbranch_vccz k_pd_103
s_sleep 1
s_sub_u32 s32, s32, 1
s_cmp_gt_i32 s32, 0
s_cbranch_scc1 k_poll_102
k_pd_103:
buffer_load_dwordx2 v[14:15], v5, s[4:7], s44 offen sc1
buffer_load_dwordx4 v[32:35], v0, s[4:7], s46 offen offset:0 sc1
buffer_load_dwordx4 v[36:39], v0, s[4:7], s46 offen offset:1024 sc1
buffer_load_dwordx4 v[40:43], v0, s[4:7], s46 offen offset:2048 sc1
buffer_load_dwordx4 v[44:47], v0, s[4:7], s46 offen offset:3072 sc1
buffer_load_dwordx4 v[48:51], v10, s[4:7], s46 offen offset:0 sc1
buffer_load_dwordx4 v[52:55], v10, s[4:7], s46 offen offset:1024 sc1
buffer_load_dwordx4 v[56:59], v10, s[4:7], s46 offen offset:2048 sc1
buffer_load_dwordx4 v[60:63], v10, s[4:7], s46 offen offset:3072 sc1
buffer_load_dwordx4 v[64:67], v11, s[4:7], s46 offen offset:0 sc1
buffer_load_dwordx4 v[68:71], v11, s[4:7], s46 offen offset:1024 sc1
buffer_load_dwordx4 v[72:75], v11, s[4:7], s46 offen offset:2048 sc1
buffer_load_dwordx4 v[76:79], v11, s[4:7], s46 offen offset:3072 sc1
buffer_load_dwordx4 v[80:83], v12, s[4:7], s46 offen offset:0 sc1
buffer_load_dwordx4 v[84:87], v12, s[4:7], s46 offen offset:1024 sc1
buffer_load_dwordx4 v[88:91], v12, s[4:7], s46 offen offset:2048 sc1
buffer_load_dwordx4 v[92:95], v12, s[4:7], s46 offen offset:3072 sc1
s_xor_b32 s49, s49, 512
buffer_load_dword v8, v2, s[4:7], s49 offen sc1
k_top_101:
v_mov_b64 v[24:25], 0
v_mov_b64 v[26:27], 0
v_mov_b64 v[28:29], 0
v_mov_b64 v[30:31], 0
s_add_u32 s50, s50, 1
s_add_u32 s46, s46, 262144
s_add_u32 s44, s44, 40960
s_cmp_eq_u32 s50, 65
s_cselect_b32 s52, 1048576, 0
s_cselect_b32 s53, 524288, 0
s_add_u32 s46, s46, s52
s_add_u32 s44, s44, s53
s_waitcnt vmcnt(17)
v_lshlrev_b32 v16, 16, v14
v_and_b32 v17, 0xffff0000, v14
v_lshlrev_b32 v18, 16, v15
v_and_b32 v19, 0xffff0000, v15
s_waitcnt vmcnt(16)
v_smfmac_f32_16x16x64_bf16 v[24:27], v[32:35], a[0:7], v1
v_smfmac_f32_16x16x64_bf16 v[28:31], v[32:35], a[8:15], v1
s_waitcnt vmcnt(15)
v_smfmac_f32_16x16x64_bf16 v[24:27], v[36:39], a[16:23], v1
v_smfmac_f32_16x16x64_bf16 v[28:31], v[36:39], a[24:31], v1
s_waitcnt vmcnt(14)
v_smfmac_f32_16x16x64_bf16 v[24:27], v[40:43], a[32:39], v1
v_smfmac_f32_16x16x64_bf16 v[28:31], v[40:43], a[40:47], v1
s_waitcnt vmcnt(13)
v_smfmac_f32_16x16x64_bf16 v[24:27], v[44:47], a[48:55], v1
v_smfmac_f32_16x16x64_bf16 v[28:31], v[44:47], a[56:63], v1
s_waitcnt vmcnt(12)
v_smfmac_f32_16x16x64_bf16 v[24:27], v[48:51], a[64:71], v1
v_smfmac_f32_16x16x64_bf16 v[28:31], v[48:51], a[72:79], v1
s_waitcnt vmcnt(11)
v_smfmac_f32_16x16x64_bf16 v[24:27], v[52:55], a[80:87], v1
v_smfmac_f32_16x16x64_bf16 v[28:31], v[52:55], a[88:95], v1
s_waitcnt vmcnt(10)
v_smfmac_f32_16x16x64_bf16 v[24:27], v[56:59], a[96:103], v1
v_smfmac_f32_16x16x64_bf16 v[28:31], v[56:59], a[104:111], v1
s_waitcnt vmcnt(9)
v_smfmac_f32_16x16x64_bf16 v[24:27], v[60:63], a[112:119], v1
v_smfmac_f32_16x16x64_bf16 v[28:31], v[60:63], a[120:127], v1
s_waitcnt vmcnt(8)
v_smfmac_f32_16x16x64_bf16 v[24:27], v[64:67], a[128:135], v1
v_smfmac_f32_16x16x64_bf16 v[28:31], v[64:67], a[136:143], v1
s_waitcnt vmcnt(7)
v_smfmac_f32_16x16x64_bf16 v[24:27], v[68:71], a[144:151], v1
v_smfmac_f32_16x16x64_bf16 v[28:31], v[68:71], a[152:159], v1
s_waitcnt vmcnt(6)
v_smfmac_f32_16x16x64_bf16 v[24:27], v[72:75], a[160:167], v1
v_smfmac_f32_16x16x64_bf16 v[28:31], v[72:75], a[168:175], v1
s_waitcnt vmcnt(5)
v_smfmac_f32_16x16x64_bf16 v[24:27], v[76:79], a[176:183], v1
v_smfmac_f32_16x16x64_bf16 v[28:31], v[76:79], a[184:191], v1
s_waitcnt vmcnt(4)
v_smfmac_f32_16x16x64_bf16 v[24:27], v[80:83], a[192:199], v1
v_smfmac_f32_16x16x64_bf16 v[28:31], v[80:83], a[200:207], v1
s_waitcnt vmcnt(3)
v_smfmac_f32_16x16x64_bf16 v[24:27], v[84:87], a[208:215], v1
v_smfmac_f32_16x16x64_bf16 v[28:31], v[84:87], a[216:223], v1
s_waitcnt vmcnt(2)
v_smfmac_f32_16x16x64_bf16 v[24:27], v[88:91], a[224:231], v1
v_smfmac_f32_16x16x64_bf16 v[28:31], v[88:91], a[232:239], v1
s_waitcnt vmcnt(1)
v_smfmac_f32_16x16x64_bf16 v[24:27], v[92:95], a[240:247], v1
v_smfmac_f32_16x16x64_bf16 v[28:31], v[92:95], a[248:255], v1
s_waitcnt vmcnt(0)
v_cmp_gt_u32 vcc, s50, v8
s_mov_b32 s47, 0
s_cbranch_vccnz k_nr_104
s_mov_b32 s47, 1
buffer_load_dwordx2 v[14:15], v5, s[4:7], s44 offen sc1
buffer_load_dwordx4 v[32:35], v0, s[4:7], s46 offen offset:0 sc1
buffer_load_dwordx4 v[36:39], v0, s[4:7], s46 offen offset:1024 sc1
buffer_load_dwordx4 v[40:43], v0, s[4:7], s46 offen offset:2048 sc1
buffer_load_dwordx4 v[44:47], v0, s[4:7], s46 offen offset:3072 sc1
buffer_load_dwordx4 v[48:51], v10, s[4:7], s46 offen offset:0 sc1
buffer_load_dwordx4 v[52:55], v10, s[4:7], s46 offen offset:1024 sc1
buffer_load_dwordx4 v[56:59], v10, s[4:7], s46 offen offset:2048 sc1
buffer_load_dwordx4 v[60:63], v10, s[4:7], s46 offen offset:3072 sc1
buffer_load_dwordx4 v[64:67], v11, s[4:7], s46 offen offset:0 sc1
buffer_load_dwordx4 v[68:71], v11, s[4:7], s46 offen offset:1024 sc1
buffer_load_dwordx4 v[72:75], v11, s[4:7], s46 offen offset:2048 sc1
buffer_load_dwordx4 v[76:79], v11, s[4:7], s46 offen offset:3072 sc1
buffer_load_dwordx4 v[80:83], v12, s[4:7], s46 offen offset:0 sc1
buffer_load_dwordx4 v[84:87], v12, s[4:7], s46 offen offset:1024 sc1
buffer_load_dwordx4 v[88:91], v12, s[4:7], s46 offen offset:2048 sc1
buffer_load_dwordx4 v[92:95], v12, s[4:7], s46 offen offset:3072 sc1
s_xor_b32 s49, s49, 512
buffer_load_dword v8, v2, s[4:7], s49 offen sc1
k_nr_104:
s_nop 3
v_permlane32_swap_b32 v24, v28
v_permlane32_swap_b32 v25, v29
v_permlane32_swap_b32 v26, v30
v_permlane32_swap_b32 v27, v31
v_add_f32 v24, v24, v28
ds_write_b32 v3, v24 offset:0
v_add_f32 v25, v25, v29
ds_write_b32 v3, v25 offset:144
v_add_f32 v26, v26, v30
ds_write_b32 v3, v26 offset:288
v_add_f32 v27, v27, v31
ds_write_b32 v3, v27 offset:432
v_add_u32 v3, s56, v3
s_waitcnt lgkmcnt(0)
s_barrier
s_cmp_lg_u32 s3, 0
s_cbranch_scc1 k_ne_105
ds_read_b128 v[96:99], v4 offset:0
ds_read_b128 v[100:103], v4 offset:1152
ds_read_b128 v[104:107], v4 offset:2304
ds_read_b128 v[108:111], v4 offset:3456
v_add_u32 v4, s56, v4
s_waitcnt lgkmcnt(3)
v_add_f32 v16, v16, v96
v_add_f32 v17, v17, v97
v_add_f32 v18, v18, v98
v_add_f32 v19, v19, v99
s_waitcnt lgkmcnt(2)
v_add_f32 v16, v16, v100
v_add_f32 v17, v17, v101
v_add_f32 v18, v18, v102
v_add_f32 v19, v19, v103
s_waitcnt lgkmcnt(1)
v_add_f32 v16, v16, v104
v_add_f32 v17, v17, v105
v_add_f32 v18, v18, v106
v_add_f32 v19, v19, v107
s_waitcnt lgkmcnt(0)
v_add_f32 v16, v16, v108
v_add_f32 v17, v17, v109
v_add_f32 v18, v18, v110
v_add_f32 v19, v19, v111
v_cvt_pk_bf16_f32 v96, v16, v17
v_cvt_pk_bf16_f32 v97, v18, v19
buffer_store_dwordx2 v[96:97], v6, s[4:7], s45 offen sc1
v_mul_f32 v17, v9, v17
v_mul_f32 v16, v16, v16
v_fmac_f32 v16, v17, v17
v_fmac_f32 v16, v18, v18
v_fmac_f32 v16, v19, v19
s_nop 1
v_add_f32_dpp v16, v16, v16 quad_perm:[1,0,3,2] row_mask:0xf bank_mask:0xf
s_nop 1
v_add_f32_dpp v16, v16, v16 quad_perm:[2,3,0,1] row_mask:0xf bank_mask:0xf
s_nop 1
v_add_f32_dpp v16, v16, v16 row_half_mirror row_mask:0xf bank_mask:0xf
buffer_store_dword v16, v7, s[4:7], s48 offen sc1
s_add_u32 s45, s45, 512
s_add_u32 s48, s48, 2560
s_cmp_eq_u32 s50, 65
s_cbranch_scc0 k_ne_105
s_add_u32 s45, s45, 3112960
s_add_u32 s48, s48, 884736
k_ne_105:
s_sub_u32 s56, 0, s56
s_cmp_eq_u32 s47, 1
s_cbranch_scc1 k_top_101
s_cmp_le_u32 s50, 128
s_cbranch_scc1 k_poll_102
s_waitcnt vmcnt(0) lgkmcnt(0)
s_barrier
k_fin_7:
s_mul_i32 s57, s30, 52429
s_lshr_b32 s57, s57, 18
s_mul_i32 s52, s57, 5
s_sub_u32 s58, s30, s52
s_lshl_b32 s58, s58, 2
s_add_u32 s58, s58, s3
s_mul_i32 s53, s58, 40960
s_add_u32 s53, s53, 214958080
s_load_dwordx2 s[36:37], s[0:1], 80
s_mov_b32 s38, 2621440
s_mov_b32 s39, 0x20000
buffer_load_dwordx4 v[96:99], v0, s[4:7], s53 offen offset:0 sc1
buffer_load_dwordx4 v[100:103], v0, s[4:7], s53 offen offset:1024 sc1
buffer_load_dwordx4 v[104:107], v0, s[4:7], s53 offen offset:2048 sc1
buffer_load_dwordx4 v[108:111], v0, s[4:7], s53 offen offset:3072 sc1
s_add_u32 s53, s53, 4096
buffer_load_dwordx4 v[112:115], v0, s[4:7], s53 offen offset:0 sc1
buffer_load_dwordx4 v[116:119], v0, s[4:7], s53 offen offset:1024 sc1
buffer_load_dwordx4 v[120:123], v0, s[4:7], s53 offen offset:2048 sc1
buffer_load_dwordx4 v[124:127], v0, s[4:7], s53 offen offset:3072 sc1
s_add_u32 s53, s53, 4096
buffer_load_dwordx4 v[128:131], v0, s[4:7], s53 offen offset:0 sc1
buffer_load_dwordx4 v[132:135], v0, s[4:7], s53 offen offset:1024 sc1
buffer_load_dwordx4 v[136:139], v0, s[4:7], s53 offen offset:2048 sc1
buffer_load_dwordx4 v[140:143], v0, s[4:7], s53 offen offset:3072 sc1
s_add_u32 s53, s53, 4096
buffer_load_dwordx4 v[144:147], v0, s[4:7], s53 offen offset:0 sc1
buffer_load_dwordx4 v[148:151], v0, s[4:7], s53 offen offset:1024 sc1
buffer_load_dwordx4 v[152:155], v0, s[4:7], s53 offen offset:2048 sc1
buffer_load_dwordx4 v[156:159], v0, s[4:7], s53 offen offset:3072 sc1
s_add_u32 s53, s53, 4096
buffer_load_dwordx4 v[160:163], v0, s[4:7], s53 offen offset:0 sc1
buffer_load_dwordx4 v[164:167], v0, s[4:7], s53 offen offset:1024 sc1
buffer_load_dwordx4 v[168:171], v0, s[4:7], s53 offen offset:2048 sc1
buffer_load_dwordx4 v[172:175], v0, s[4:7], s53 offen offset:3072 sc1
s_add_u32 s53, s53, 4096
buffer_load_dwordx4 v[176:179], v0, s[4:7], s53 offen offset:0 sc1
buffer_load_dwordx4 v[180:183], v0, s[4:7], s53 offen offset:1024 sc1
buffer_load_dwordx4 v[184:187], v0, s[4:7], s53 offen offset:2048 sc1
buffer_load_dwordx4 v[188:191], v0, s[4:7], s53 offen offset:3072 sc1
s_add_u32 s53, s53, 4096
buffer_load_dwordx4 v[192:195], v0, s[4:7], s53 offen offset:0 sc1
buffer_load_dwordx4 v[196:199], v0, s[4:7], s53 offen offset:1024 sc1
buffer_load_dwordx4 v[200:203], v0, s[4:7], s53 offen offset:2048 sc1
buffer_load_dwordx4 v[204:207], v0, s[4:7], s53 offen offset:3072 sc1
s_add_u32 s53, s53, 4096
buffer_load_dwordx4 v[208:211], v0, s[4:7], s53 offen offset:0 sc1
buffer_load_dwordx4 v[212:215], v0, s[4:7], s53 offen offset:1024 sc1
buffer_load_dwordx4 v[216:219], v0, s[4:7], s53 offen offset:2048 sc1
buffer_load_dwordx4 v[220:223], v0, s[4:7], s53 offen offset:3072 sc1
s_add_u32 s53, s53, 4096
buffer_load_dwordx4 v[224:227], v0, s[4:7], s53 offen offset:0 sc1
buffer_load_dwordx4 v[228:231], v0, s[4:7], s53 offen offset:1024 sc1
buffer_load_dwordx4 v[232:235], v0, s[4:7], s53 offen offset:2048 sc1
buffer_load_dwordx4 v[236:239], v0, s[4:7], s53 offen offset:3072 sc1
s_add_u32 s53, s53, 4096
buffer_load_dwordx4 v[240:243], v0, s[4:7], s53 offen offset:0 sc1
buffer_load_dwordx4 v[244:247], v0, s[4:7], s53 offen offset:1024 sc1
buffer_load_dwordx4 v[248:251], v0, s[4:7], s53 offen offset:2048 sc1
buffer_load_dwordx4 v[252:255], v0, s[4:7], s53 offen offset:3072 sc1
s_mul_i32 s48, s57, 40960
s_mul_i32 s52, s3, 10240
s_add_u32 s46, s48, s52
s_add_u32 s46, s46, 201326592
s_lshl_b32 s58, s58, 6
s_add_u32 s48, s48, s58
v_bfe_u32 v1, v0, 4, 5
v_mul_u32_u24 v1, 1280, v1
v_lshrrev_b32 v2, 9, v0
v_lshl_add_u32 v1, v2, 5, v1
s_mov_b32 s49, 1310720
s_mov_b32 s54, 222314496
s_waitcnt vmcnt(0) lgkmcnt(0)
s_cmp_lg_u32 s3, 0
s_cbranch_scc1 k_w8d_109
v_lshlrev_b32 v2, 2, v0
k_w8_108:
buffer_load_dword v3, v2, s[4:7], s54 offen sc1
buffer_load_dword v4, v2, s[4:7], s54 offen offset:1024 sc1
s_waitcnt vmcnt(0)
v_and_b32 v3, v3, v4
v_cmp_eq_u32 vcc, 0, v3
s_cbranch_vccz k_w8d_109
s_sleep 1
s_sub_u32 s32, s32, 1
s_cmp_gt_i32 s32, 0
s_cbranch_scc1 k_w8_108
k_w8d_109:
s_barrier
s_mul_i32 s45, s3, 10240
s_mov_b32 s44, 0
v_mov_b32 v64, v0
s_add_u32 m0, s45, 0
s_add_u32 s55, s46, 0
buffer_load_dwordx4 v0, s[4:7], s55 offen offset:0 sc1 lds
buffer_load_dwordx4 v0, s[4:7], s55 offen offset:1024 sc1 lds
buffer_load_dwordx4 v0, s[4:7], s55 offen offset:2048 sc1 lds
buffer_load_dwordx4 v0, s[4:7], s55 offen offset:3072 sc1 lds
s_add_u32 m0, s45, 4096
s_add_u32 s55, s46, 4096
buffer_load_dwordx4 v0, s[4:7], s55 offen offset:0 sc1 lds
buffer_load_dwordx4 v0, s[4:7], s55 offen offset:1024 sc1 lds
buffer_load_dwordx4 v0, s[4:7], s55 offen offset:2048 sc1 lds
buffer_load_dwordx4 v0, s[4:7], s55 offen offset:3072 sc1 lds
s_add_u32 m0, s45, 8192
s_add_u32 s55, s46, 8192
buffer_load_dwordx4 v0, s[4:7], s55 offen offset:0 sc1 lds
buffer_load_dwordx4 v0, s[4:7], s55 offen offset:1024 sc1 lds
s_add_u32 s45, s45, 40960
s_cmp_ge_u32 s45, 122880
s_cselect_b32 s55, 122880, 0
s_sub_u32 s45, s45, s55
s_add_u32 s46, s46, s49
s_mov_b32 s49, 0
s_add_u32 m0, s45, 0
s_add_u32 s55, s46, 0
buffer_load_dwordx4 v0, s[4:7], s55 offen offset:0 sc1 lds
buffer_load_dwordx4 v0, s[4:7], s55 offen offset:1024 sc1 lds
buffer_load_dwordx4 v0, s[4:7], s55 offen offset:2048 sc1 lds
buffer_load_dwordx4 v0, s[4:7], s55 offen offset:3072 sc1 lds
s_add_u32 m0, s45, 4096
s_add_u32 s55, s46, 4096
buffer_load_dwordx4 v0, s[4:7], s55 offen offset:0 sc1 lds
buffer_load_dwordx4 v0, s[4:7], s55 offen offset:1024 sc1 lds
buffer_load_dwordx4 v0, s[4:7], s55 offen offset:2048 sc1 lds
buffer_load_dwordx4 v0, s[4:7], s55 offen offset:3072 sc1 lds
s_add_u32 m0, s45, 8192
s_add_u32 s55, s46, 8192
buffer_load_dwordx4 v0, s[4:7], s55 offen offset:0 sc1 lds
buffer_load_dwordx4 v0, s[4:7], s55 offen offset:1024 sc1 lds
s_add_u32 s45, s45, 40960
s_cmp_ge_u32 s45, 122880
s_cselect_b32 s55, 122880, 0
s_sub_u32 s45, s45, s55
s_add_u32 s46, s46, s49
s_mov_b32 s49, 0
s_waitcnt vmcnt(10)
s_barrier
ds_read_b128 v[8:11], v64 offset:0
ds_read_b128 v[12:15], v64 offset:1024
ds_read_b128 v[16:19], v64 offset:2048
ds_read_b128 v[20:23], v64 offset:3072
s_mov_b32 s59, 1
s_waitcnt lgkmcnt(3)
v_mfma_f32_32x32x16_bf16 v[32:47], v[96:99], v[8:11], 0
s_waitcnt lgkmcnt(2)
ds_read_b128 v[24:27], v64 offset:4096
v_mfma_f32_32x32x16_bf16 v[32:47], v[100:103], v[12:15], v[32:47]
s_waitcnt lgkmcnt(2)
ds_read_b128 v[8:11], v64 offset:5120
s_add_u32 m0, s45, 0
s_add_u32 s55, s46, 0
buffer_load_dwordx4 v0, s[4:7], s55 offen offset:0 sc1 lds
buffer_load_dwordx4 v0, s[4:7], s55 offen offset:1024 sc1 lds
v_mfma_f32_32x32x16_bf16 v[32:47], v[104:107], v[16:19], v[32:47]
s_waitcnt lgkmcnt(2)
ds_read_b128 v[12:15], v64 offset:6144
buffer_load_dwordx4 v0, s[4:7], s55 offen offset:2048 sc1 lds
buffer_load_dwordx4 v0, s[4:7], s55 offen offset:3072 sc1 lds
v_mfma_f32_32x32x16_bf16 v[32:47], v[108:111], v[20:23], v[32:47]
s_waitcnt lgkmcnt(2)
ds_read_b128 v[16:19], v64 offset:7168
s_add_u32 m0, s45, 4096
s_add_u32 s55, s46, 4096
buffer_load_dwordx4 v0, s[4:7], s55 offen offset:0 sc1 lds
buffer_load_dwordx4 v0, s[4:7], s55 offen offset:1024 sc1 lds
v_mfma_f32_32x32x16_bf16 v[32:47], v[112:115], v[24:27], v[32:47]
s_waitcnt lgkmcnt(2)
ds_read_b128 v[20:23], v64 offset:8192
buffer_load_dwordx4 v0, s[4:7], s55 offen offset:2048 sc1 lds
buffer_load_dwordx4 v0, s[4:7], s55 offen offset:3072 sc1 lds
v_mfma_f32_32x32x16_bf16 v[32:47], v[116:119], v[8:11], v[32:47]
s_waitcnt lgkmcnt(2)
ds_read_b128 v[24:27], v64 offset:9216
s_add_u32 m0, s45, 8192
s_add_u32 s55, s46, 8192
buffer_load_dwordx4 v0, s[4:7], s55 offen offset:0 sc1 lds
buffer_load_dwordx4 v0, s[4:7], s55 offen offset:1024 sc1 lds
v_mfma_f32_32x32x16_bf16 v[32:47], v[120:123], v[12:15], v[32:47]
s_waitcnt lgkmcnt(2)
ds_read_b128 v[8:11], v64 offset:10240
s_add_u32 s45, s45, 40960
s_cmp_ge_u32 s45, 122880
s_cselect_b32 s55, 122880, 0
s_sub_u32 s45, s45, s55
s_add_u32 s46, s46, s49
s_mov_b32 s49, 0
v_mfma_f32_32x32x16_bf16 v[32:47], v[124:127], v[16:19], v[32:47]
s_waitcnt lgkmcnt(2)
ds_read_b128 v[12:15], v64 offset:11264
v_mfma_f32_32x32x16_bf16 v[32:47], v[128:131], v[20:23], v[32:47]
s_waitcnt lgkmcnt(2)
ds_read_b128 v[16:19], v64 offset:12288
v_mfma_f32_32x32x16_bf16 v[32:47], v[132:135], v[24:27], v[32:47]
s_waitcnt lgkmcnt(2)
ds_read_b128 v[20:23], v64 offset:13312
v_mfma_f32_32x32x16_bf16 v[32:47], v[136:139], v[8:11], v[32:47]
s_waitcnt lgkmcnt(2)
ds_read_b128 v[24:27], v64 offset:14336
v_mfma_f32_32x32x16_bf16 v[32:47], v[140:143], v[12:15], v[32:47]
s_waitcnt lgkmcnt(2)
ds_read_b128 v[8:11], v64 offset:15360
v_mfma_f32_32x32x16_bf16 v[32:47], v[144:147], v[16:19], v[32:47]
s_waitcnt lgkmcnt(2)
ds_read_b128 v[12:15], v64 offset:16384
v_mfma_f32_32x32x16_bf16 v[32:47], v[148:151], v[20:23], v[32:47]
s_waitcnt lgkmcnt(2)
ds_read_b128 v[16:19], v64 offset:17408
v_mfma_f32_32x32x16_bf16 v[32:47], v[152:155], v[24:27], v[32:47]
s_waitcnt lgkmcnt(2)
ds_read_b128 v[20:23], v64 offset:18432
v_mfma_f32_32x32x16_bf16 v[32:47], v[156:159], v[8:11], v[32:47]
s_waitcnt lgkmcnt(2)
ds_read_b128 v[24:27], v64 offset:19456
v_mfma_f32_32x32x16_bf16 v[32:47], v[160:163], v[12:15], v[32:47]
s_waitcnt lgkmcnt(2)
ds_read_b128 v[8:11], v64 offset:20480
v_mfma_f32_32x32x16_bf16 v[32:47], v[164:167], v[16:19], v[32:47]
s_waitcnt lgkmcnt(2)
ds_read_b128 v[12:15], v64 offset:21504
v_mfma_f32_32x32x16_bf16 v[32:47], v[168:171], v[20:23], v[32:47]
s_waitcnt lgkmcnt(2)
ds_read_b128 v[16:19], v64 offset:22528
v_mfma_f32_32x32x16_bf16 v[32:47], v[172:175], v[24:27], v[32:47]
s_waitcnt lgkmcnt(2)
ds_read_b128 v[20:23], v64 offset:23552
v_mfma_f32_32x32x16_bf16 v[32:47], v[176:179], v[8:11], v[32:47]
s_waitcnt lgkmcnt(2)
ds_read_b128 v[24:27], v64 offset:24576
v_mfma_f32_32x32x16_bf16 v[32:47], v[180:183], v[12:15], v[32:47]
s_waitcnt lgkmcnt(2)
ds_read_b128 v[8:11], v64 offset:25600
v_mfma_f32_32x32x16_bf16 v[32:47], v[184:187], v[16:19], v[32:47]
s_waitcnt lgkmcnt(2)
ds_read_b128 v[12:15], v64 offset:26624
v_mfma_f32_32x32x16_bf16 v[32:47], v[188:191], v[20:23], v[32:47]
s_waitcnt lgkmcnt(2)
ds_read_b128 v[16:19], v64 offset:27648
v_mfma_f32_32x32x16_bf16 v[32:47], v[192:195], v[24:27], v[32:47]
s_waitcnt lgkmcnt(2)
ds_read_b128 v[20:23], v64 offset:28672
v_mfma_f32_32x32x16_bf16 v[32:47], v[196:199], v[8:11], v[32:47]
s_waitcnt lgkmcnt(2)
ds_read_b128 v[24:27], v64 offset:29696
v_mfma_f32_32x32x16_bf16 v[32:47], v[200:203], v[12:15], v[32:47]
s_waitcnt lgkmcnt(2)
ds_read_b128 v[8:11], v64 offset:30720
v_mfma_f32_32x32x16_bf16 v[32:47], v[204:207], v[16:19], v[32:47]
s_waitcnt lgkmcnt(2)
ds_read_b128 v[12:15], v64 offset:31744
v_mfma_f32_32x32x16_bf16 v[32:47], v[208:211], v[20:23], v[32:47]
s_waitcnt lgkmcnt(2)
ds_read_b128 v[16:19], v64 offset:32768
v_mfma_f32_32x32x16_bf16 v[32:47], v[212:215], v[24:27], v[32:47]
s_waitcnt lgkmcnt(2)
ds_read_b128 v[20:23], v64 offset:33792
v_mfma_f32_32x32x16_bf16 v[32:47], v[216:219], v[8:11], v[32:47]
s_waitcnt lgkmcnt(2)
ds_read_b128 v[24:27], v64 offset:34816
v_mfma_f32_32x32x16_bf16 v[32:47], v[220:223], v[12:15], v[32:47]
s_waitcnt lgkmcnt(2)
ds_read_b128 v[8:11], v64 offset:35840
v_mfma_f32_32x32x16_bf16 v[32:47], v[224:227], v[16:19], v[32:47]
s_waitcnt lgkmcnt(2)
ds_read_b128 v[12:15], v64 offset:36864
v_mfma_f32_32x32x16_bf16 v[32:47], v[228:231], v[20:23], v[32:47]
s_waitcnt lgkmcnt(2)
ds_read_b128 v[16:19], v64 offset:37888
v_mfma_f32_32x32x16_bf16 v[32:47], v[232:235], v[24:27], v[32:47]
s_waitcnt lgkmcnt(2)
ds_read_b128 v[20:23], v64 offset:38912
v_mfma_f32_32x32x16_bf16 v[32:47], v[236:239], v[8:11], v[32:47]
s_waitcnt lgkmcnt(2)
ds_read_b128 v[24:27], v64 offset:39936
v_mfma_f32_32x32x16_bf16 v[32:47], v[240:243], v[12:15], v[32:47]
s_add_u32 s44, s44, 1
s_cmp_eq_u32 s44, 3
s_mov_b32 s56, 40960
s_cmov_b32 s56, -81920
s_cselect_b32 s44, 0, s44
v_add_u32 v64, s56, v64
s_waitcnt vmcnt(10) lgkmcnt(2)
s_barrier
ds_read_b128 v[8:11], v64 offset:0
v_mfma_f32_32x32x16_bf16 v[32:47], v[244:247], v[16:19], v[32:47]
s_waitcnt lgkmcnt(2)
ds_read_b128 v[12:15], v64 offset:1024
v_mfma_f32_32x32x16_bf16 v[32:47], v[248:251], v[20:23], v[32:47]
s_waitcnt lgkmcnt(2)
ds_read_b128 v[16:19], v64 offset:2048
v_mfma_f32_32x32x16_bf16 v[32:47], v[252:255], v[24:27], v[32:47]
s_waitcnt lgkmcnt(2)
ds_read_b128 v[20:23], v64 offset:3072
k_st_110:
v_mfma_f32_32x32x16_bf16 v[48:63], v[96:99], v[8:11], 0
s_waitcnt lgkmcnt(2)
ds_read_b128 v[24:27], v64 offset:4096
v_mfma_f32_32x32x16_bf16 v[48:63], v[100:103], v[12:15], v[48:63]
s_waitcnt lgkmcnt(2)
ds_read_b128 v[8:11], v64 offset:5120
v_cvt_pk_bf16_f32 v32, v32, v33
v_cvt_pk_bf16_f32 v33, v34, v35
v_mfma_f32_32x32x16_bf16 v[48:63], v[104:107], v[16:19], v[48:63]
s_waitcnt lgkmcnt(2)
ds_read_b128 v[12:15], v64 offset:6144
v_cvt_pk_bf16_f32 v34, v36, v37
v_cvt_pk_bf16_f32 v35, v38, v39
v_mfma_f32_32x32x16_bf16 v[48:63], v[108:111], v[20:23], v[48:63]
s_waitcnt lgkmcnt(2)
ds_read_b128 v[16:19], v64 offset:7168
v_cvt_pk_bf16_f32 v36, v40, v41
v_cvt_pk_bf16_f32 v37, v42, v43
v_mfma_f32_32x32x16_bf16 v[48:63], v[112:115], v[24:27], v[48:63]
s_waitcnt lgkmcnt(2)
ds_read_b128 v[20:23], v64 offset:8192
v_cvt_pk_bf16_f32 v38, v44, v45
v_cvt_pk_bf16_f32 v39, v46, v47
v_mfma_f32_32x32x16_bf16 v[48:63], v[116:119], v[8:11], v[48:63]
s_waitcnt lgkmcnt(2)
ds_read_b128 v[24:27], v64 offset:9216
buffer_store_dwordx4 v[32:35], v1, s[36:39], s48 offen offset:0
buffer_store_dwordx4 v[36:39], v1, s[36:39], s48 offen offset:16
v_mfma_f32_32x32x16_bf16 v[48:63], v[120:123], v[12:15], v[48:63]
s_waitcnt lgkmcnt(2)
ds_read_b128 v[8:11], v64 offset:10240
s_add_u32 s48, s48, 1310720
s_add_u32 m0, s45, 0
s_add_u32 s55, s46, 0
buffer_load_dwordx4 v0, s[4:7], s55 offen offset:0 sc1 lds
v_mfma_f32_32x32x16_bf16 v[48:63], v[124:127], v[16:19], v[48:63]
s_waitcnt lgkmcnt(2)
ds_read_b128 v[12:15], v64 offset:11264
buffer_load_dwordx4 v0, s[4:7], s55 offen offset:1024 sc1 lds
buffer_load_dwordx4 v0, s[4:7], s55 offen offset:2048 sc1 lds
v_mfma_f32_32x32x16_bf16 v[48:63], v[128:131], v[20:23], v[48:63]
s_waitcnt lgkmcnt(2)
ds_read_b128 v[16:19], v64 offset:12288
buffer_load_dwordx4 v0, s[4:7], s55 offen offset:3072 sc1 lds
s_add_u32 m0, s45, 4096
s_add_u32 s55, s46, 4096
buffer_load_dwordx4 v0, s[4:7], s55 offen offset:0 sc1 lds
v_mfma_f32_32x32x16_bf16 v[48:63], v[132:135], v[24:27], v[48:63]
s_waitcnt lgkmcnt(2)
ds_read_b128 v[20:23], v64 offset:13312
buffer_load_dwordx4 v0, s[4:7], s55 offen offset:1024 sc1 lds
buffer_load_dwordx4 v0, s[4:7], s55 offen offset:2048 sc1 lds
v_mfma_f32_32x32x16_bf16 v[48:63], v[136:139], v[8:11], v[48:63]
s_waitcnt lgkmcnt(2)
ds_read_b128 v[24:27], v64 offset:14336
buffer_load_dwordx4 v0, s[4:7], s55 offen offset:3072 sc1 lds
s_add_u32 m0, s45, 8192
s_add_u32 s55, s46, 8192
buffer_load_dwordx4 v0, s[4:7], s55 offen offset:0 sc1 lds
v_mfma_f32_32x32x16_bf16 v[48:63], v[140:143], v[12:15], v[48:63]
s_waitcnt lgkmcnt(2)
ds_read_b128 v[8:11], v64 offset:15360
buffer_load_dwordx4 v0, s[4:7], s55 offen offset:1024 sc1 lds
s_add_u32 s45, s45, 40960
s_cmp_ge_u32 s45, 122880
s_cselect_b32 s55, 122880, 0
s_sub_u32 s45, s45, s55
v_mfma_f32_32x32x16_bf16 v[48:63], v[144:147], v[16:19], v[48:63]
s_waitcnt lgkmcnt(2)
ds_read_b128 v[12:15], v64 offset:16384
s_add_u32 s46, s46, s49
s_mov_b32 s49, 0
v_mfma_f32_32x32x16_bf16 v[48:63], v[148:151], v[20:23], v[48:63]
s_waitcnt lgkmcnt(2)
ds_read_b128 v[16:19], v64 offset:17408
v_mfma_f32_32x32x16_bf16 v[48:63], v[152:155], v[24:27], v[48:63]
s_waitcnt lgkmcnt(2)
ds_read_b128 v[20:23], v64 offset:18432
v_mfma_f32_32x32x16_bf16 v[48:63], v[156:159], v[8:11], v[48:63]
s_waitcnt lgkmcnt(2)
ds_read_b128 v[24:27], v64 offset:19456
v_mfma_f32_32x32x16_bf16 v[48:63], v[160:163], v[12:15], v[48:63]
s_waitcnt lgkmcnt(2)
ds_read_b128 v[8:11], v64 offset:20480
v_mfma_f32_32x32x16_bf16 v[48:63], v[164:167], v[16:19], v[48:63]
s_waitcnt lgkmcnt(2)
ds_read_b128 v[12:15], v64 offset:21504
v_mfma_f32_32x32x16_bf16 v[48:63], v[168:171], v[20:23], v[48:63]
s_waitcnt lgkmcnt(2)
ds_read_b128 v[16:19], v64 offset:22528
v_mfma_f32_32x32x16_bf16 v[48:63], v[172:175], v[24:27], v[48:63]
s_waitcnt lgkmcnt(2)
ds_read_b128 v[20:23], v64 offset:23552
v_mfma_f32_32x32x16_bf16 v[48:63], v[176:179], v[8:11], v[48:63]
s_waitcnt lgkmcnt(2)
ds_read_b128 v[24:27], v64 offset:24576
v_mfma_f32_32x32x16_bf16 v[48:63], v[180:183], v[12:15], v[48:63]
s_waitcnt lgkmcnt(2)
ds_read_b128 v[8:11], v64 offset:25600
v_mfma_f32_32x32x16_bf16 v[48:63], v[184:187], v[16:19], v[48:63]
s_waitcnt lgkmcnt(2)
ds_read_b128 v[12:15], v64 offset:26624
v_mfma_f32_32x32x16_bf16 v[48:63], v[188:191], v[20:23], v[48:63]
s_waitcnt lgkmcnt(2)
ds_read_b128 v[16:19], v64 offset:27648
v_mfma_f32_32x32x16_bf16 v[48:63], v[192:195], v[24:27], v[48:63]
s_waitcnt lgkmcnt(2)
ds_read_b128 v[20:23], v64 offset:28672
v_mfma_f32_32x32x16_bf16 v[48:63], v[196:199], v[8:11], v[48:63]
s_waitcnt lgkmcnt(2)
ds_read_b128 v[24:27], v64 offset:29696
v_mfma_f32_32x32x16_bf16 v[48:63], v[200:203], v[12:15], v[48:63]
s_waitcnt lgkmcnt(2)
ds_read_b128 v[8:11], v64 offset:30720
v_mfma_f32_32x32x16_bf16 v[48:63], v[204:207], v[16:19], v[48:63]
s_waitcnt lgkmcnt(2)
ds_read_b128 v[12:15], v64 offset:31744
v_mfma_f32_32x32x16_bf16 v[48:63], v[208:211], v[20:23], v[48:63]
s_waitcnt lgkmcnt(2)
ds_read_b128 v[16:19], v64 offset:32768
v_mfma_f32_32x32x16_bf16 v[48:63], v[212:215], v[24:27], v[48:63]
s_waitcnt lgkmcnt(2)
ds_read_b128 v[20:23], v64 offset:33792
v_mfma_f32_32x32x16_bf16 v[48:63], v[216:219], v[8:11], v[48:63]
s_waitcnt lgkmcnt(2)
ds_read_b128 v[24:27], v64 offset:34816
v_mfma_f32_32x32x16_bf16 v[48:63], v[220:223], v[12:15], v[48:63]
s_waitcnt lgkmcnt(2)
ds_read_b128 v[8:11], v64 offset:35840
v_mfma_f32_32x32x16_bf16 v[48:63], v[224:227], v[16:19], v[48:63]
s_waitcnt lgkmcnt(2)
ds_read_b128 v[12:15], v64 offset:36864
v_mfma_f32_32x32x16_bf16 v[48:63], v[228:231], v[20:23], v[48:63]
s_waitcnt lgkmcnt(2)
ds_read_b128 v[16:19], v64 offset:37888
v_mfma_f32_32x32x16_bf16 v[48:63], v[232:235], v[24:27], v[48:63]
s_waitcnt lgkmcnt(2)
ds_read_b128 v[20:23], v64 offset:38912
v_mfma_f32_32x32x16_bf16 v[48:63], v[236:239], v[8:11], v[48:63]
s_waitcnt lgkmcnt(2)
ds_read_b128 v[24:27], v64 offset:39936
v_mfma_f32_32x32x16_bf16 v[48:63], v[240:243], v[12:15], v[48:63]
s_add_u32 s44, s44, 1
s_cmp_eq_u32 s44, 3
s_mov_b32 s56, 40960
s_cmov_b32 s56, -81920
s_cselect_b32 s44, 0, s44
v_add_u32 v64, s56, v64
s_waitcnt vmcnt(10) lgkmcnt(2)
s_barrier
ds_read_b128 v[8:11], v64 offset:0
v_mfma_f32_32x32x16_bf16 v[48:63], v[244:247], v[16:19], v[48:63]
s_waitcnt lgkmcnt(2)
ds_read_b128 v[12:15], v64 offset:1024
v_mfma_f32_32x32x16_bf16 v[48:63], v[248:251], v[20:23], v[48:63]
s_waitcnt lgkmcnt(2)
ds_read_b128 v[16:19], v64 offset:2048
v_mfma_f32_32x32x16_bf16 v[48:63], v[252:255], v[24:27], v[48:63]
s_waitcnt lgkmcnt(2)
ds_read_b128 v[20:23], v64 offset:3072
s_nop 9
v_cvt_pk_bf16_f32 v48, v48, v49
v_cvt_pk_bf16_f32 v49, v50, v51
v_cvt_pk_bf16_f32 v50, v52, v53
v_cvt_pk_bf16_f32 v51, v54, v55
v_cvt_pk_bf16_f32 v52, v56, v57
v_cvt_pk_bf16_f32 v53, v58, v59
v_cvt_pk_bf16_f32 v54, v60, v61
v_cvt_pk_bf16_f32 v55, v62, v63
buffer_store_dwordx4 v[48:51], v1, s[36:39], s48 offen offset:0
buffer_store_dwordx4 v[52:55], v1, s[36:39], s48 offen offset:16
s_add_u32 s48, s48, 1310720
s_waitcnt vmcnt(0)
s_endpgm
k_team_3:
s_cmp_eq_u32 s3, 1
s_cbranch_scc1 k_w1_113
s_cmp_eq_u32 s3, 2
s_cbranch_scc1 k_w2_114
s_cmp_eq_u32 s3, 3
s_cbranch_scc1 k_w3_115
k_w0_112:
v_lshrrev_b32 v10, 3, v0
v_lshlrev_b32 v8, 13, v10
v_bfe_u32 v10, v0, 1, 2
v_lshrrev_b32 v11, 4, v0
v_xor_b32 v10, v10, v11
v_lshl_add_u32 v8, v10, 5, v8
v_and_b32 v12, 1, v0
v_lshl_add_u32 v8, v12, 4, v8
v_mul_u32_u24 v9, 1280, v11
v_bfe_u32 v10, v0, 1, 3
v_and_b32 v11, 1, v11
v_lshlrev_b32 v11, 1, v11
v_xor_b32 v10, v10, v11
v_xor_b32 v10, 0, v10
v_lshl_add_u32 v9, v10, 5, v9
v_lshl_add_u32 v9, v12, 4, v9
v_bfe_u32 v10, v0, 5, 1
v_lshlrev_b32 v10, 4, v10
v_bfe_u32 v11, v0, 4, 1
v_lshl_add_u32 v10, v11, 1, v10
v_bfe_u32 v11, v0, 2, 1
v_lshl_add_u32 v10, v11, 2, v10
v_bfe_u32 v11, v0, 3, 1
v_add_u32 v10, v11, v10
v_bfe_u32 v11, v10, 1, 2
v_xor_b32 v11, 0, v11
v_lshlrev_b32 v11, 5, v11
v_lshl_add_u32 v1, v10, 7, v11
v_and_b32 v12, 3, v0
v_lshl_add_u32 v1, v12, 3, v1
v_add_u32 v2, 0x10000, v1
v_add_u32 v3, 0x20000, v1
v_bfe_u32 v10, v0, 4, 1
v_lshlrev_b32 v11, 4, v10
v_lshlrev_b32 v10, 2, v10
v_bfe_u32 v6, v0, 5, 1
v_lshl_add_u32 v11, v6, 2, v11
v_bfe_u32 v6, v0, 2, 1
v_add_u32 v11, v6, v11
v_lshl_add_u32 v10, v6, 1, v10
v_bfe_u32 v6, v0, 3, 1
v_add_u32 v6, 0, v6
v_xor_b32 v10, v10, v6
v_lshlrev_b32 v10, 5, v10
v_lshl_add_u32 v5, v11, 8, v10
v_lshl_add_u32 v5, v12, 3, v5
v_add_u32 v6, 0x10000, v5
v_add_u32 v7, 0x20000, v5
v_lshlrev_b32 v0, 4, v0
v_add_u32 v4, 98304, v0
s_lshl_b32 s56, s30, 8
s_mul_i32 s57, s30, 163840
s_mul_i32 s39, s30, 131072
s_add_u32 s39, s39, 120586240
s_add_u32 s60, s39, 0
s_add_u32 s61, s39, 4096
s_add_u32 s62, s39, 8192
s_add_u32 s63, s39, 12288
s_add_u32 s64, s39, 16384
s_add_u32 s65, s39, 20480
s_add_u32 s66, s39, 24576
s_add_u32 s67, s39, 28672
s_mov_b32 m0, 0
s_add_u32 s41, s56, 0
buffer_load_dwordx4 v8, s[8:11], s41 offen lds
s_mov_b32 m0, 1024
s_add_u32 s41, s56, 65536
buffer_load_dwordx4 v8, s[8:11], s41 offen lds
s_mov_b32 m0, 8192
s_add_u32 s41, s56, 128
buffer_load_dwordx4 v8, s[8:11], s41 offen lds
s_mov_b32 m0, 9216
s_add_u32 s41, s56, 65664
buffer_load_dwordx4 v8, s[8:11], s41 offen lds
s_mov_b32 m0, 16384
s_add_u32 s41, s56, 524288
buffer_load_dwordx4 v8, s[8:11], s41 offen lds
s_mov_b32 m0, 17408
s_add_u32 s41, s56, 589824
buffer_load_dwordx4 v8, s[8:11], s41 offen lds
s_mov_b32 m0, 24576
s_add_u32 s41, s56, 524416
buffer_load_dwordx4 v8, s[8:11], s41 offen lds
s_mov_b32 m0, 25600
s_add_u32 s41, s56, 589952
buffer_load_dwordx4 v8, s[8:11], s41 offen lds
s_mov_b32 m0, 32768
s_add_u32 s41, s56, 1048576
buffer_load_dwordx4 v8, s[8:11], s41 offen lds
s_mov_b32 m0, 33792
s_add_u32 s41, s56, 1114112
buffer_load_dwordx4 v8, s[8:11], s41 offen lds
s_mov_b32 m0, 40960
s_add_u32 s41, s56, 1048704
buffer_load_dwordx4 v8, s[8:11], s41 offen lds
s_mov_b32 m0, 41984
s_add_u32 s41, s56, 1114240
buffer_load_dwordx4 v8, s[8:11], s41 offen lds
s_mov_b32 m0, 49152
s_add_u32 s41, s56, 1572864
buffer_load_dwordx4 v8, s[8:11], s41 offen lds
s_mov_b32 m0, 50176
s_add_u32 s41, s56, 1638400
buffer_load_dwordx4 v8, s[8:11], s41 offen lds
s_mov_b32 m0, 57344
s_add_u32 s41, s56, 1572992
buffer_load_dwordx4 v8, s[8:11], s41 offen lds
s_mov_b32 m0, 58368
s_add_u32 s41, s56, 1638528
buffer_load_dwordx4 v8, s[8:11], s41 offen lds
s_mov_b32 m0, 65536
s_add_u32 s41, s56, 2097152
buffer_load_dwordx4 v8, s[8:11], s41 offen lds
s_mov_b32 m0, 66560
s_add_u32 s41, s56, 2162688
buffer_load_dwordx4 v8, s[8:11], s41 offen lds
s_mov_b32 m0, 73728
s_add_u32 s41, s56, 2097280
buffer_load_dwordx4 v8, s[8:11], s41 offen lds
s_mov_b32 m0, 74752
s_add_u32 s41, s56, 2162816
buffer_load_dwordx4 v8, s[8:11], s41 offen lds
s_mov_b32 m0, 81920
s_add_u32 s41, s56, 2621440
buffer_load_dwordx4 v8, s[8:11], s41 offen lds
s_mov_b32 m0, 82944
s_add_u32 s41, s56, 2686976
buffer_load_dwordx4 v8, s[8:11], s41 offen lds
s_mov_b32 m0, 90112
s_add_u32 s41, s56, 2621568
buffer_load_dwordx4 v8, s[8:11], s41 offen lds
s_mov_b32 m0, 91136
s_add_u32 s41, s56, 2687104
buffer_load_dwordx4 v8, s[8:11], s41 offen lds
s_mov_b32 m0, 98304
s_add_u32 s41, s56, 3145728
buffer_load_dwordx4 v8, s[8:11], s41 offen lds
s_mov_b32 m0, 99328
s_add_u32 s41, s56, 3211264
buffer_load_dwordx4 v8, s[8:11], s41 offen lds
s_mov_b32 m0, 106496
s_add_u32 s41, s56, 3145856
buffer_load_dwordx4 v8, s[8:11], s41 offen lds
s_mov_b32 m0, 107520
s_add_u32 s41, s56, 3211392
buffer_load_dwordx4 v8, s[8:11], s41 offen lds
s_mov_b32 m0, 114688
s_add_u32 s41, s56, 3670016
buffer_load_dwordx4 v8, s[8:11], s41 offen lds
s_mov_b32 m0, 115712
s_add_u32 s41, s56, 3735552
buffer_load_dwordx4 v8, s[8:11], s41 offen lds
s_mov_b32 m0, 122880
s_add_u32 s41, s56, 3670144
buffer_load_dwordx4 v8, s[8:11], s41 offen lds
s_mov_b32 m0, 123904
s_add_u32 s41, s56, 3735680
buffer_load_dwordx4 v8, s[8:11], s41 offen lds
s_waitcnt vmcnt(24)
s_barrier
s_mov_b32 m0, 131072
s_add_u32 s41, s56, 4194304
buffer_load_dwordx4 v8, s[8:11], s41 offen lds
s_mov_b32 m0, 132096
s_add_u32 s41, s56, 4259840
buffer_load_dwordx4 v8, s[8:11], s41 offen lds
s_mov_b32 m0, 139264
s_add_u32 s41, s56, 4194432
buffer_load_dwordx4 v8, s[8:11], s41 offen lds
s_mov_b32 m0, 140288
s_add_u32 s41, s56, 4259968
buffer_load_dwordx4 v8, s[8:11], s41 offen lds
s_mov_b32 m0, 147456
s_add_u32 s41, s56, 4718592
buffer_load_dwordx4 v8, s[8:11], s41 offen lds
s_mov_b32 m0, 148480
s_add_u32 s41, s56, 4784128
buffer_load_dwordx4 v8, s[8:11], s41 offen lds
s_mov_b32 m0, 155648
s_add_u32 s41, s56, 4718720
buffer_load_dwordx4 v8, s[8:11], s41 offen lds
s_mov_b32 m0, 156672
s_add_u32 s41, s56, 4784256
buffer_load_dwordx4 v8, s[8:11], s41 offen lds
ds_read_b64_tr_b16 v[16:17], v1 offset:0
ds_read_b64_tr_b16 v[18:19], v1 offset:1024
ds_read_b64_tr_b16 v[20:21], v1 offset:4096
ds_read_b64_tr_b16 v[22:23], v1 offset:5120
ds_read_b64_tr_b16 v[24:25], v1 offset:8192
ds_read_b64_tr_b16 v[26:27], v1 offset:9216
ds_read_b64_tr_b16 v[28:29], v1 offset:12288
ds_read_b64_tr_b16 v[30:31], v1 offset:13312
ds_read_b64_tr_b16 v[32:33], v1 offset:16384
ds_read_b64_tr_b16 v[34:35], v1 offset:17408
ds_read_b64_tr_b16 v[36:37], v1 offset:20480
ds_read_b64_tr_b16 v[38:39], v1 offset:21504
ds_read_b64_tr_b16 v[40:41], v1 offset:24576
ds_read_b64_tr_b16 v[42:43], v1 offset:25600
ds_read_b64_tr_b16 v[44:45], v1 offset:28672
ds_read_b64_tr_b16 v[46:47], v1 offset:29696
s_waitcnt lgkmcnt(0)
buffer_store_dwordx4 v[16:19], v0, s[4:7], s60 offen offset:0
buffer_store_dwordx4 v[20:23], v0, s[4:7], s60 offen offset:1024
buffer_store_dwordx4 v[24:27], v0, s[4:7], s60 offen offset:2048
buffer_store_dwordx4 v[28:31], v0, s[4:7], s60 offen offset:3072
buffer_store_dwordx4 v[32:35], v0, s[4:7], s61 offen offset:0
buffer_store_dwordx4 v[36:39], v0, s[4:7], s61 offen offset:1024
buffer_store_dwordx4 v[40:43], v0, s[4:7], s61 offen offset:2048
buffer_store_dwordx4 v[44:47], v0, s[4:7], s61 offen offset:3072
s_waitcnt vmcnt(32)
s_barrier
s_mov_b32 m0, 0
s_add_u32 s41, s56, 0
buffer_load_dwordx4 v8, s[12:15], s41 offen lds
s_mov_b32 m0, 1024
s_add_u32 s41, s56, 65536
buffer_load_dwordx4 v8, s[12:15], s41 offen lds
s_mov_b32 m0, 8192
s_add_u32 s41, s56, 524288
buffer_load_dwordx4 v8, s[12:15], s41 offen lds
s_mov_b32 m0, 9216
s_add_u32 s41, s56, 589824
buffer_load_dwordx4 v8, s[12:15], s41 offen lds
s_mov_b32 m0, 16384
s_add_u32 s41, s56, 1048576
buffer_load_dwordx4 v8, s[12:15], s41 offen lds
s_mov_b32 m0, 17408
s_add_u32 s41, s56, 1114112
buffer_load_dwordx4 v8, s[12:15], s41 offen lds
s_mov_b32 m0, 24576
s_add_u32 s41, s56, 1048704
buffer_load_dwordx4 v8, s[12:15], s41 offen lds
s_mov_b32 m0, 25600
s_add_u32 s41, s56, 1114240
buffer_load_dwordx4 v8, s[12:15], s41 offen lds
ds_read_b64_tr_b16 v[16:17], v1 offset:32768
ds_read_b64_tr_b16 v[18:19], v1 offset:33792
ds_read_b64_tr_b16 v[20:21], v1 offset:36864
ds_read_b64_tr_b16 v[22:23], v1 offset:37888
ds_read_b64_tr_b16 a[0:1], v1 offset:40960
ds_read_b64_tr_b16 a[2:3], v1 offset:41984
ds_read_b64_tr_b16 a[4:5], v1 offset:45056
ds_read_b64_tr_b16 a[6:7], v1 offset:46080
ds_read_b64_tr_b16 a[8:9], v1 offset:49152
ds_read_b64_tr_b16 a[10:11], v1 offset:50176
ds_read_b64_tr_b16 a[12:13], v1 offset:53248
ds_read_b64_tr_b16 a[14:15], v1 offset:54272
ds_read_b64_tr_b16 a[16:17], v1 offset:57344
ds_read_b64_tr_b16 a[18:19], v1 offset:58368
ds_read_b64_tr_b16 a[20:21], v1 offset:61440
ds_read_b64_tr_b16 a[22:23], v1 offset:62464
s_waitcnt lgkmcnt(0)
buffer_store_dwordx4 v[16:19], v0, s[4:7], s62 offen offset:0
buffer_store_dwordx4 v[20:23], v0, s[4:7], s62 offen offset:1024
s_waitcnt vmcnt(34)
s_barrier
s_mov_b32 m0, 32768
s_add_u32 s41, s56, 1572864
buffer_load_dwordx4 v8, s[12:15], s41 offen lds
s_mov_b32 m0, 33792
s_add_u32 s41, s56, 1638400
buffer_load_dwordx4 v8, s[12:15], s41 offen lds
s_mov_b32 m0, 40960
s_add_u32 s41, s56, 2097152
buffer_load_dwordx4 v8, s[12:15], s41 offen lds
s_mov_b32 m0, 41984
s_add_u32 s41, s56, 2162688
buffer_load_dwordx4 v8, s[12:15], s41 offen lds
s_mov_b32 m0, 49152
s_add_u32 s41, s56, 2621440
buffer_load_dwordx4 v8, s[12:15], s41 offen lds
s_mov_b32 m0, 50176
s_add_u32 s41, s56, 2686976
buffer_load_dwordx4 v8, s[12:15], s41 offen lds
s_mov_b32 m0, 57344
s_add_u32 s41, s56, 3145728
buffer_load_dwordx4 v8, s[12:15], s41 offen lds
s_mov_b32 m0, 58368
s_add_u32 s41, s56, 3211264
buffer_load_dwordx4 v8, s[12:15], s41 offen lds
ds_read_b64_tr_b16 a[24:25], v2 offset:0
ds_read_b64_tr_b16 a[26:27], v2 offset:1024
ds_read_b64_tr_b16 a[28:29], v2 offset:4096
ds_read_b64_tr_b16 a[30:31], v2 offset:5120
ds_read_b64_tr_b16 a[128:129], v2 offset:8192
ds_read_b64_tr_b16 a[130:131], v2 offset:9216
ds_read_b64_tr_b16 a[132:133], v2 offset:12288
ds_read_b64_tr_b16 a[134:135], v2 offset:13312
ds_read_b64_tr_b16 a[32:33], v2 offset:16384
ds_read_b64_tr_b16 a[34:35], v2 offset:17408
ds_read_b64_tr_b16 a[36:37], v2 offset:20480
ds_read_b64_tr_b16 a[38:39], v2 offset:21504
ds_read_b64_tr_b16 a[40:41], v2 offset:24576
ds_read_b64_tr_b16 a[42:43], v2 offset:25600
ds_read_b64_tr_b16 a[44:45], v2 offset:28672
ds_read_b64_tr_b16 a[46:47], v2 offset:29696
s_waitcnt lgkmcnt(0)
s_waitcnt vmcnt(34)
s_barrier
s_mov_b32 m0, 65536
s_add_u32 s41, s56, 3145856
buffer_load_dwordx4 v8, s[12:15], s41 offen lds
s_mov_b32 m0, 66560
s_add_u32 s41, s56, 3211392
buffer_load_dwordx4 v8, s[12:15], s41 offen lds
s_mov_b32 m0, 73728
s_add_u32 s41, s56, 3670016
buffer_load_dwordx4 v8, s[12:15], s41 offen lds
s_mov_b32 m0, 74752
s_add_u32 s41, s56, 3735552
buffer_load_dwordx4 v8, s[12:15], s41 offen lds
s_mov_b32 m0, 81920
s_add_u32 s41, s56, 4194304
buffer_load_dwordx4 v8, s[12:15], s41 offen lds
s_mov_b32 m0, 82944
s_add_u32 s41, s56, 4259840
buffer_load_dwordx4 v8, s[12:15], s41 offen lds
s_mov_b32 m0, 90112
s_add_u32 s41, s56, 4718592
buffer_load_dwordx4 v8, s[12:15], s41 offen lds
s_mov_b32 m0, 91136
s_add_u32 s41, s56, 4784128
buffer_load_dwordx4 v8, s[12:15], s41 offen lds
ds_read_b64_tr_b16 a[168:169], v2 offset:32768
ds_read_b64_tr_b16 a[170:171], v2 offset:33792
ds_read_b64_tr_b16 a[172:173], v2 offset:36864
ds_read_b64_tr_b16 a[174:175], v2 offset:37888
ds_read_b64_tr_b16 a[48:49], v2 offset:40960
ds_read_b64_tr_b16 a[50:51], v2 offset:41984
ds_read_b64_tr_b16 a[52:53], v2 offset:45056
ds_read_b64_tr_b16 a[54:55], v2 offset:46080
ds_read_b64_tr_b16 a[56:57], v2 offset:49152
ds_read_b64_tr_b16 a[58:59], v2 offset:50176
ds_read_b64_tr_b16 a[60:61], v2 offset:53248
ds_read_b64_tr_b16 a[62:63], v2 offset:54272
ds_read_b64_tr_b16 a[200:201], v2 offset:57344
ds_read_b64_tr_b16 a[202:203], v2 offset:58368
ds_read_b64_tr_b16 a[204:205], v2 offset:61440
ds_read_b64_tr_b16 a[206:207], v2 offset:62464
s_waitcnt lgkmcnt(0)
s_waitcnt vmcnt(34)
s_barrier
s_mov_b32 m0, 98304
s_add_u32 s41, s56, 4718720
buffer_load_dwordx4 v8, s[12:15], s41 offen lds
s_mov_b32 m0, 99328
s_add_u32 s41, s56, 4784256
buffer_load_dwordx4 v8, s[12:15], s41 offen lds
s_mov_b32 m0, 106496
s_add_u32 s41, s56, 0
buffer_load_dwordx4 v8, s[16:19], s41 offen lds
s_mov_b32 m0, 107520
s_add_u32 s41, s56, 65536
buffer_load_dwordx4 v8, s[16:19], s41 offen lds
s_mov_b32 m0, 114688
s_add_u32 s41, s56, 524288
buffer_load_dwordx4 v8, s[16:19], s41 offen lds
s_mov_b32 m0, 115712
s_add_u32 s41, s56, 589824
buffer_load_dwordx4 v8, s[16:19], s41 offen lds
s_mov_b32 m0, 122880
s_add_u32 s41, s56, 1048576
buffer_load_dwordx4 v8, s[16:19], s41 offen lds
s_mov_b32 m0, 123904
s_add_u32 s41, s56, 1114112
buffer_load_dwordx4 v8, s[16:19], s41 offen lds
ds_read_b64_tr_b16 a[64:65], v3 offset:0
ds_read_b64_tr_b16 a[66:67], v3 offset:1024
ds_read_b64_tr_b16 a[68:69], v3 offset:4096
ds_read_b64_tr_b16 a[70:71], v3 offset:5120
ds_read_b64_tr_b16 a[72:73], v3 offset:8192
ds_read_b64_tr_b16 a[74:75], v3 offset:9216
ds_read_b64_tr_b16 a[76:77], v3 offset:12288
ds_read_b64_tr_b16 a[78:79], v3 offset:13312
ds_read_b64_tr_b16 v[80:81], v3 offset:16384
ds_read_b64_tr_b16 v[82:83], v3 offset:17408
ds_read_b64_tr_b16 v[84:85], v3 offset:20480
ds_read_b64_tr_b16 v[86:87], v3 offset:21504
ds_read_b64_tr_b16 a[80:81], v3 offset:24576
ds_read_b64_tr_b16 a[82:83], v3 offset:25600
ds_read_b64_tr_b16 a[84:85], v3 offset:28672
ds_read_b64_tr_b16 a[86:87], v3 offset:29696
s_waitcnt lgkmcnt(0)
s_waitcnt vmcnt(26)
s_barrier
s_mov_b32 m0, 131072
s_add_u32 s41, s56, 1048704
buffer_load_dwordx4 v8, s[16:19], s41 offen lds
s_mov_b32 m0, 132096
s_add_u32 s41, s56, 1114240
buffer_load_dwordx4 v8, s[16:19], s41 offen lds
s_mov_b32 m0, 139264
s_add_u32 s41, s56, 1572864
buffer_load_dwordx4 v8, s[16:19], s41 offen lds
s_mov_b32 m0, 140288
s_add_u32 s41, s56, 1638400
buffer_load_dwordx4 v8, s[16:19], s41 offen lds
s_mov_b32 m0, 147456
s_add_u32 s41, s56, 1572992
buffer_load_dwordx4 v8, s[16:19], s41 offen lds
s_mov_b32 m0, 148480
s_add_u32 s41, s56, 1638528
buffer_load_dwordx4 v8, s[16:19], s41 offen lds
s_mov_b32 m0, 155648
s_add_u32 s41, s56, 2097152
buffer_load_dwordx4 v8, s[16:19], s41 offen lds
s_mov_b32 m0, 156672
s_add_u32 s41, s56, 2162688
buffer_load_dwordx4 v8, s[16:19], s41 offen lds
ds_read_b64_tr_b16 a[88:89], v1 offset:0
ds_read_b64_tr_b16 a[90:91], v1 offset:1024
ds_read_b64_tr_b16 a[92:93], v1 offset:4096
ds_read_b64_tr_b16 a[94:95], v1 offset:5120
ds_read_b64_tr_b16 a[104:105], v1 offset:8192
ds_read_b64_tr_b16 a[106:107], v1 offset:9216
ds_read_b64_tr_b16 a[108:109], v1 offset:12288
ds_read_b64_tr_b16 a[110:111], v1 offset:13312
ds_read_b64_tr_b16 a[112:113], v1 offset:16384
ds_read_b64_tr_b16 a[114:115], v1 offset:17408
ds_read_b64_tr_b16 a[116:117], v1 offset:20480
ds_read_b64_tr_b16 a[118:119], v1 offset:21504
ds_read_b64_tr_b16 a[96:97], v1 offset:24576
ds_read_b64_tr_b16 a[98:99], v1 offset:25600
ds_read_b64_tr_b16 a[100:101], v1 offset:28672
ds_read_b64_tr_b16 a[102:103], v1 offset:29696
s_waitcnt lgkmcnt(0)
s_waitcnt vmcnt(24)
s_barrier
s_mov_b32 m0, 0
s_add_u32 s41, s56, 2621440
buffer_load_dwordx4 v8, s[16:19], s41 offen lds
s_mov_b32 m0, 1024
s_add_u32 s41, s56, 2686976
buffer_load_dwordx4 v8, s[16:19], s41 offen lds
s_mov_b32 m0, 8192
s_add_u32 s41, s56, 3145728
buffer_load_dwordx4 v8, s[16:19], s41 offen lds
s_mov_b32 m0, 9216
s_add_u32 s41, s56, 3211264
buffer_load_dwordx4 v8, s[16:19], s41 offen lds
s_mov_b32 m0, 16384
s_add_u32 s41, s56, 3145856
buffer_load_dwordx4 v8, s[16:19], s41 offen lds
s_mov_b32 m0, 17408
s_add_u32 s41, s56, 3211392
buffer_load_dwordx4 v8, s[16:19], s41 offen lds
s_mov_b32 m0, 24576
s_add_u32 s41, s56, 3670016
buffer_load_dwordx4 v8, s[16:19], s41 offen lds
s_mov_b32 m0, 25600
s_add_u32 s41, s56, 3735552
buffer_load_dwordx4 v8, s[16:19], s41 offen lds
ds_read_b64_tr_b16 a[120:121], v1 offset:32768
ds_read_b64_tr_b16 a[122:123], v1 offset:33792
ds_read_b64_tr_b16 a[124:125], v1 offset:36864
ds_read_b64_tr_b16 a[126:127], v1 offset:37888
ds_read_b64_tr_b16 a[136:137], v1 offset:40960
ds_read_b64_tr_b16 a[138:139], v1 offset:41984
ds_read_b64_tr_b16 a[140:141], v1 offset:45056
ds_read_b64_tr_b16 a[142:143], v1 offset:46080
ds_read_b64_tr_b16 a[144:145], v1 offset:49152
ds_read_b64_tr_b16 a[146:147], v1 offset:50176
ds_read_b64_tr_b16 a[148:149], v1 offset:53248
ds_read_b64_tr_b16 a[150:151], v1 offset:54272
ds_read_b64_tr_b16 v[40:41], v1 offset:57344
ds_read_b64_tr_b16 v[42:43], v1 offset:58368
ds_read_b64_tr_b16 v[44:45], v1 offset:61440
ds_read_b64_tr_b16 v[46:47], v1 offset:62464
s_waitcnt lgkmcnt(0)
buffer_store_dwordx4 v[40:43], v0, s[4:7], s62 offen offset:2048
buffer_store_dwordx4 v[44:47], v0, s[4:7], s62 offen offset:3072
s_waitcnt vmcnt(26)
s_barrier
s_mov_b32 m0, 32768
s_add_u32 s41, s56, 4194304
buffer_load_dwordx4 v8, s[16:19], s41 offen lds
s_mov_b32 m0, 33792
s_add_u32 s41, s56, 4259840
buffer_load_dwordx4 v8, s[16:19], s41 offen lds
s_mov_b32 m0, 40960
s_add_u32 s41, s56, 4718592
buffer_load_dwordx4 v8, s[16:19], s41 offen lds
s_mov_b32 m0, 41984
s_add_u32 s41, s56, 4784128
buffer_load_dwordx4 v8, s[16:19], s41 offen lds
s_mov_b32 m0, 49152
s_add_u32 s41, s56, 4718720
buffer_load_dwordx4 v8, s[16:19], s41 offen lds
s_mov_b32 m0, 50176
s_add_u32 s41, s56, 4784256
buffer_load_dwordx4 v8, s[16:19], s41 offen lds
s_mov_b32 m0, 57344
s_add_u32 s41, s57, 20736
buffer_load_dwordx4 v9, s[20:23], s41 offen lds
s_mov_b32 m0, 58368
s_add_u32 s41, s57, 25856
buffer_load_dwordx4 v9, s[20:23], s41 offen lds
ds_read_b64_tr_b16 a[152:153], v2 offset:0
ds_read_b64_tr_b16 a[154:155], v2 offset:1024
ds_read_b64_tr_b16 a[156:157], v2 offset:4096
ds_read_b64_tr_b16 a[158:159], v2 offset:5120
ds_read_b64_tr_b16 a[160:161], v2 offset:8192
ds_read_b64_tr_b16 a[162:163], v2 offset:9216
ds_read_b64_tr_b16 a[164:165], v2 offset:12288
ds_read_b64_tr_b16 a[166:167], v2 offset:13312
ds_read_b64_tr_b16 v[128:129], v2 offset:16384
ds_read_b64_tr_b16 v[130:131], v2 offset:17408
ds_read_b64_tr_b16 v[132:133], v2 offset:20480
ds_read_b64_tr_b16 v[134:135], v2 offset:21504
ds_read_b64_tr_b16 a[176:177], v2 offset:24576
ds_read_b64_tr_b16 a[178:179], v2 offset:25600
ds_read_b64_tr_b16 a[180:181], v2 offset:28672
ds_read_b64_tr_b16 a[182:183], v2 offset:29696
s_waitcnt lgkmcnt(0)
s_waitcnt vmcnt(26)
s_barrier
s_mov_b32 m0, 65536
s_add_u32 s41, s57, 41216
buffer_load_dwordx4 v9, s[20:23], s41 offen lds
s_mov_b32 m0, 66560
s_add_u32 s41, s57, 46336
buffer_load_dwordx4 v9, s[20:23], s41 offen lds
s_mov_b32 m0, 73728
s_add_u32 s41, s57, 61696
buffer_load_dwordx4 v9, s[20:23], s41 offen lds
s_mov_b32 m0, 74752
s_add_u32 s41, s57, 66816
buffer_load_dwordx4 v9, s[20:23], s41 offen lds
s_mov_b32 m0, 81920
s_add_u32 s41, s57, 512
buffer_load_dwordx4 v9, s[20:23], s41 offen lds
s_mov_b32 m0, 82944
s_add_u32 s41, s57, 5632
buffer_load_dwordx4 v9, s[20:23], s41 offen lds
s_mov_b32 m0, 90112
s_add_u32 s41, s57, 20992
buffer_load_dwordx4 v9, s[20:23], s41 offen lds
s_mov_b32 m0, 91136
s_add_u32 s41, s57, 26112
buffer_load_dwordx4 v9, s[20:23], s41 offen lds
ds_read_b64_tr_b16 a[184:185], v2 offset:32768
ds_read_b64_tr_b16 a[186:187], v2 offset:33792
ds_read_b64_tr_b16 a[188:189], v2 offset:36864
ds_read_b64_tr_b16 a[190:191], v2 offset:37888
ds_read_b64_tr_b16 a[192:193], v2 offset:40960
ds_read_b64_tr_b16 a[194:195], v2 offset:41984
ds_read_b64_tr_b16 a[196:197], v2 offset:45056
ds_read_b64_tr_b16 a[198:199], v2 offset:46080
ds_read_b64_tr_b16 a[208:209], v2 offset:49152
ds_read_b64_tr_b16 a[210:211], v2 offset:50176
ds_read_b64_tr_b16 a[212:213], v2 offset:53248
ds_read_b64_tr_b16 a[214:215], v2 offset:54272
ds_read_b64_tr_b16 a[216:217], v2 offset:57344
ds_read_b64_tr_b16 a[218:219], v2 offset:58368
ds_read_b64_tr_b16 a[220:221], v2 offset:61440
ds_read_b64_tr_b16 a[222:223], v2 offset:62464
s_waitcnt lgkmcnt(0)
s_waitcnt vmcnt(26)
s_barrier
s_mov_b32 m0, 98304
s_add_u32 s41, s57, 41472
buffer_load_dwordx4 v9, s[20:23], s41 offen lds
s_mov_b32 m0, 99328
s_add_u32 s41, s57, 46592
buffer_load_dwordx4 v9, s[20:23], s41 offen lds
s_mov_b32 m0, 106496
s_add_u32 s41, s57, 61952
buffer_load_dwordx4 v9, s[20:23], s41 offen lds
s_mov_b32 m0, 107520
s_add_u32 s41, s57, 67072
buffer_load_dwordx4 v9, s[20:23], s41 offen lds
s_mov_b32 m0, 114688
s_add_u32 s41, s57, 768
buffer_load_dwordx4 v9, s[20:23], s41 offen lds
s_mov_b32 m0, 115712
s_add_u32 s41, s57, 5888
buffer_load_dwordx4 v9, s[20:23], s41 offen lds
s_mov_b32 m0, 122880
s_add_u32 s41, s57, 21248
buffer_load_dwordx4 v9, s[20:23], s41 offen lds
s_mov_b32 m0, 123904
s_add_u32 s41, s57, 26368
buffer_load_dwordx4 v9, s[20:23], s41 offen lds
ds_read_b64_tr_b16 a[224:225], v3 offset:0
ds_read_b64_tr_b16 a[226:227], v3 offset:1024
ds_read_b64_tr_b16 a[228:229], v3 offset:4096
ds_read_b64_tr_b16 a[230:231], v3 offset:5120
ds_read_b64_tr_b16 a[232:233], v3 offset:8192
ds_read_b64_tr_b16 a[234:235], v3 offset:9216
ds_read_b64_tr_b16 a[236:237], v3 offset:12288
ds_read_b64_tr_b16 a[238:239], v3 offset:13312
ds_read_b64_tr_b16 a[240:241], v3 offset:16384
ds_read_b64_tr_b16 a[242:243], v3 offset:17408
ds_read_b64_tr_b16 a[244:245], v3 offset:20480
ds_read_b64_tr_b16 a[246:247], v3 offset:21504
ds_read_b64_tr_b16 a[248:249], v3 offset:24576
ds_read_b64_tr_b16 a[250:251], v3 offset:25600
ds_read_b64_tr_b16 a[252:253], v3 offset:28672
ds_read_b64_tr_b16 a[254:255], v3 offset:29696
s_waitcnt lgkmcnt(0)
s_waitcnt vmcnt(26)
s_barrier
s_mov_b32 m0, 131072
s_add_u32 s41, s57, 41728
buffer_load_dwordx4 v9, s[20:23], s41 offen lds
s_mov_b32 m0, 132096
s_add_u32 s41, s57, 46848
buffer_load_dwordx4 v9, s[20:23], s41 offen lds
s_mov_b32 m0, 139264
s_add_u32 s41, s57, 62208
buffer_load_dwordx4 v9, s[20:23], s41 offen lds
s_mov_b32 m0, 140288
s_add_u32 s41, s57, 67328
buffer_load_dwordx4 v9, s[20:23], s41 offen lds
s_mov_b32 m0, 147456
s_add_u32 s41, s57, 1024
buffer_load_dwordx4 v9, s[20:23], s41 offen lds
s_mov_b32 m0, 148480
s_add_u32 s41, s57, 6144
buffer_load_dwordx4 v9, s[20:23], s41 offen lds
s_mov_b32 m0, 155648
s_add_u32 s41, s57, 21504
buffer_load_dwordx4 v9, s[20:23], s41 offen lds
s_mov_b32 m0, 156672
s_add_u32 s41, s57, 26624
buffer_load_dwordx4 v9, s[20:23], s41 offen lds
ds_read_b64_tr_b16 v[88:89], v1 offset:0
ds_read_b64_tr_b16 v[90:91], v1 offset:1024
ds_read_b64_tr_b16 v[92:93], v1 offset:4096
ds_read_b64_tr_b16 v[94:95], v1 offset:5120
ds_read_b64_tr_b16 v[96:97], v1 offset:8192
ds_read_b64_tr_b16 v[98:99], v1 offset:9216
ds_read_b64_tr_b16 v[100:101], v1 offset:12288
ds_read_b64_tr_b16 v[102:103], v1 offset:13312
ds_read_b64_tr_b16 v[104:105], v1 offset:16384
ds_read_b64_tr_b16 v[106:107], v1 offset:17408
ds_read_b64_tr_b16 v[108:109], v1 offset:20480
ds_read_b64_tr_b16 v[110:111], v1 offset:21504
ds_read_b64_tr_b16 v[112:113], v1 offset:24576
ds_read_b64_tr_b16 v[114:115], v1 offset:25600
ds_read_b64_tr_b16 v[116:117], v1 offset:28672
ds_read_b64_tr_b16 v[118:119], v1 offset:29696
s_waitcnt lgkmcnt(0)
s_waitcnt vmcnt(24)
s_barrier
s_mov_b32 m0, 0
s_add_u32 s41, s57, 41984
buffer_load_dwordx4 v9, s[20:23], s41 offen lds
s_mov_b32 m0, 1024
s_add_u32 s41, s57, 47104
buffer_load_dwordx4 v9, s[20:23], s41 offen lds
s_mov_b32 m0, 8192
s_add_u32 s41, s57, 62464
buffer_load_dwordx4 v9, s[20:23], s41 offen lds
s_mov_b32 m0, 9216
s_add_u32 s41, s57, 67584
buffer_load_dwordx4 v9, s[20:23], s41 offen lds
s_mov_b32 m0, 16384
s_add_u32 s41, s56, 128
buffer_load_dwordx4 v8, s[12:15], s41 offen lds
s_mov_b32 m0, 17408
s_add_u32 s41, s56, 65664
buffer_load_dwordx4 v8, s[12:15], s41 offen lds
s_mov_b32 m0, 24576
s_add_u32 s41, s56, 524416
buffer_load_dwordx4 v8, s[12:15], s41 offen lds
s_mov_b32 m0, 25600
s_add_u32 s41, s56, 589952
buffer_load_dwordx4 v8, s[12:15], s41 offen lds
ds_read_b64_tr_b16 v[120:121], v1 offset:32768
ds_read_b64_tr_b16 v[122:123], v1 offset:33792
ds_read_b64_tr_b16 v[124:125], v1 offset:36864
ds_read_b64_tr_b16 v[126:127], v1 offset:37888
ds_read_b64_tr_b16 v[136:137], v1 offset:40960
ds_read_b64_tr_b16 v[138:139], v1 offset:41984
ds_read_b64_tr_b16 v[140:141], v1 offset:45056
ds_read_b64_tr_b16 v[142:143], v1 offset:46080
ds_read_b64_tr_b16 v[144:145], v1 offset:49152
ds_read_b64_tr_b16 v[146:147], v1 offset:50176
ds_read_b64_tr_b16 v[148:149], v1 offset:53248
ds_read_b64_tr_b16 v[150:151], v1 offset:54272
ds_read_b64_tr_b16 v[160:161], v5 offset:57344
ds_read_b64_tr_b16 v[162:163], v5 offset:57856
ds_read_b64_tr_b16 v[164:165], v5 offset:59392
ds_read_b64_tr_b16 v[166:167], v5 offset:59904
s_waitcnt lgkmcnt(0)
s_waitcnt vmcnt(24)
s_barrier
s_mov_b32 m0, 32768
s_add_u32 s41, s56, 2097280
buffer_load_dwordx4 v8, s[12:15], s41 offen lds
s_mov_b32 m0, 33792
s_add_u32 s41, s56, 2162816
buffer_load_dwordx4 v8, s[12:15], s41 offen lds
s_mov_b32 m0, 40960
s_add_u32 s41, s56, 3670144
buffer_load_dwordx4 v8, s[12:15], s41 offen lds
s_mov_b32 m0, 41984
s_add_u32 s41, s56, 3735680
buffer_load_dwordx4 v8, s[12:15], s41 offen lds
s_mov_b32 m0, 49152
s_add_u32 s41, s56, 1572992
buffer_load_dwordx4 v8, s[12:15], s41 offen lds
s_mov_b32 m0, 50176
s_add_u32 s41, s56, 1638528
buffer_load_dwordx4 v8, s[12:15], s41 offen lds
s_mov_b32 m0, 57344
s_add_u32 s41, s56, 2621568
buffer_load_dwordx4 v8, s[12:15], s41 offen lds
s_mov_b32 m0, 58368
s_add_u32 s41, s56, 2687104
buffer_load_dwordx4 v8, s[12:15], s41 offen lds
ds_read_b64_tr_b16 v[168:169], v6 offset:0
ds_read_b64_tr_b16 v[170:171], v6 offset:512
ds_read_b64_tr_b16 v[172:173], v6 offset:2048
ds_read_b64_tr_b16 v[174:175], v6 offset:2560
ds_read_b64_tr_b16 v[152:153], v6 offset:8192
ds_read_b64_tr_b16 v[154:155], v6 offset:8704
ds_read_b64_tr_b16 v[156:157], v6 offset:10240
ds_read_b64_tr_b16 v[158:159], v6 offset:10752
ds_read_b64_tr_b16 v[176:177], v6 offset:16384
ds_read_b64_tr_b16 v[178:179], v6 offset:16896
ds_read_b64_tr_b16 v[180:181], v6 offset:18432
ds_read_b64_tr_b16 v[182:183], v6 offset:18944
ds_read_b64_tr_b16 v[184:185], v6 offset:24576
ds_read_b64_tr_b16 v[186:187], v6 offset:25088
ds_read_b64_tr_b16 v[188:189], v6 offset:26624
ds_read_b64_tr_b16 v[190:191], v6 offset:27136
s_waitcnt lgkmcnt(0)
s_waitcnt vmcnt(24)
s_barrier
s_mov_b32 m0, 65536
s_add_u32 s41, s56, 4194432
buffer_load_dwordx4 v8, s[12:15], s41 offen lds
s_mov_b32 m0, 66560
s_add_u32 s41, s56, 4259968
buffer_load_dwordx4 v8, s[12:15], s41 offen lds
s_mov_b32 m0, 73728
s_add_u32 s41, s56, 128
buffer_load_dwordx4 v8, s[16:19], s41 offen lds
s_mov_b32 m0, 74752
s_add_u32 s41, s56, 65664
buffer_load_dwordx4 v8, s[16:19], s41 offen lds
s_mov_b32 m0, 81920
s_add_u32 s41, s56, 524416
buffer_load_dwordx4 v8, s[16:19], s41 offen lds
s_mov_b32 m0, 82944
s_add_u32 s41, s56, 589952
buffer_load_dwordx4 v8, s[16:19], s41 offen lds
s_mov_b32 m0, 90112
s_add_u32 s41, s56, 2097280
buffer_load_dwordx4 v8, s[16:19], s41 offen lds
s_mov_b32 m0, 91136
s_add_u32 s41, s56, 2162816
buffer_load_dwordx4 v8, s[16:19], s41 offen lds
ds_read_b64_tr_b16 v[192:193], v6 offset:32768
ds_read_b64_tr_b16 v[194:195], v6 offset:33280
ds_read_b64_tr_b16 v[196:197], v6 offset:34816
ds_read_b64_tr_b16 v[198:199], v6 offset:35328
ds_read_b64_tr_b16 v[24:25], v6 offset:40960
ds_read_b64_tr_b16 v[26:27], v6 offset:41472
ds_read_b64_tr_b16 v[28:29], v6 offset:43008
ds_read_b64_tr_b16 v[30:31], v6 offset:43520
ds_read_b64_tr_b16 v[200:201], v6 offset:49152
ds_read_b64_tr_b16 v[202:203], v6 offset:49664
ds_read_b64_tr_b16 v[204:205], v6 offset:51200
ds_read_b64_tr_b16 v[206:207], v6 offset:51712
ds_read_b64_tr_b16 v[208:209], v6 offset:57344
ds_read_b64_tr_b16 v[210:211], v6 offset:57856
ds_read_b64_tr_b16 v[212:213], v6 offset:59392
ds_read_b64_tr_b16 v[214:215], v6 offset:59904
s_waitcnt lgkmcnt(0)
buffer_store_dwordx4 v[24:27], v0, s[4:7], s63 offen offset:0
buffer_store_dwordx4 v[28:31], v0, s[4:7], s63 offen offset:1024
s_waitcnt vmcnt(26)
s_barrier
s_mov_b32 m0, 98304
s_add_u32 s41, s56, 2621568
buffer_load_dwordx4 v8, s[16:19], s41 offen lds
s_mov_b32 m0, 99328
s_add_u32 s41, s56, 2687104
buffer_load_dwordx4 v8, s[16:19], s41 offen lds
s_mov_b32 m0, 106496
s_add_u32 s41, s56, 3670144
buffer_load_dwordx4 v8, s[16:19], s41 offen lds
s_mov_b32 m0, 107520
s_add_u32 s41, s56, 3735680
buffer_load_dwordx4 v8, s[16:19], s41 offen lds
s_mov_b32 m0, 114688
s_add_u32 s41, s56, 4194432
buffer_load_dwordx4 v8, s[16:19], s41 offen lds
s_mov_b32 m0, 115712
s_add_u32 s41, s56, 4259968
buffer_load_dwordx4 v8, s[16:19], s41 offen lds
s_mov_b32 m0, 122880
s_add_u32 s41, s57, 0
buffer_load_dwordx4 v9, s[20:23], s41 offen lds
s_mov_b32 m0, 123904
s_add_u32 s41, s57, 5120
buffer_load_dwordx4 v9, s[20:23], s41 offen lds
ds_read_b64_tr_b16 v[216:217], v7 offset:0
ds_read_b64_tr_b16 v[218:219], v7 offset:512
ds_read_b64_tr_b16 v[220:221], v7 offset:2048
ds_read_b64_tr_b16 v[222:223], v7 offset:2560
ds_read_b64_tr_b16 v[224:225], v7 offset:8192
ds_read_b64_tr_b16 v[226:227], v7 offset:8704
ds_read_b64_tr_b16 v[228:229], v7 offset:10240
ds_read_b64_tr_b16 v[230:231], v7 offset:10752
ds_read_b64_tr_b16 v[232:233], v7 offset:16384
ds_read_b64_tr_b16 v[234:235], v7 offset:16896
ds_read_b64_tr_b16 v[236:237], v7 offset:18432
ds_read_b64_tr_b16 v[238:239], v7 offset:18944
ds_read_b64_tr_b16 v[240:241], v7 offset:24576
ds_read_b64_tr_b16 v[242:243], v7 offset:25088
ds_read_b64_tr_b16 v[244:245], v7 offset:26624
ds_read_b64_tr_b16 v[246:247], v7 offset:27136
s_waitcnt lgkmcnt(0)
s_waitcnt vmcnt(30)
s_barrier
s_mov_b32 m0, 131072
s_add_u32 s41, s57, 20480
buffer_load_dwordx4 v9, s[20:23], s41 offen lds
s_mov_b32 m0, 132096
s_add_u32 s41, s57, 25600
buffer_load_dwordx4 v9, s[20:23], s41 offen lds
s_mov_b32 m0, 139264
s_add_u32 s41, s57, 40960
buffer_load_dwordx4 v9, s[20:23], s41 offen lds
s_mov_b32 m0, 140288
s_add_u32 s41, s57, 46080
buffer_load_dwordx4 v9, s[20:23], s41 offen lds
s_mov_b32 m0, 147456
s_add_u32 s41, s57, 61440
buffer_load_dwordx4 v9, s[20:23], s41 offen lds
s_mov_b32 m0, 148480
s_add_u32 s41, s57, 66560
buffer_load_dwordx4 v9, s[20:23], s41 offen lds
s_mov_b32 m0, 155648
s_add_u32 s41, s57, 256
buffer_load_dwordx4 v9, s[20:23], s41 offen lds
s_mov_b32 m0, 156672
s_add_u32 s41, s57, 5376
buffer_load_dwordx4 v9, s[20:23], s41 offen lds
ds_read_b64_tr_b16 v[248:249], v5 offset:0
ds_read_b64_tr_b16 v[250:251], v5 offset:512
ds_read_b64_tr_b16 v[252:253], v5 offset:2048
ds_read_b64_tr_b16 v[254:255], v5 offset:2560
ds_read_b64_tr_b16 v[24:25], v5 offset:8192
ds_read_b64_tr_b16 v[26:27], v5 offset:8704
ds_read_b64_tr_b16 v[28:29], v5 offset:10240
ds_read_b64_tr_b16 v[30:31], v5 offset:10752
s_waitcnt lgkmcnt(0)
buffer_store_dwordx4 v[24:27], v0, s[4:7], s63 offen offset:2048
buffer_store_dwordx4 v[28:31], v0, s[4:7], s63 offen offset:3072
s_waitcnt vmcnt(22)
s_barrier
ds_read_b64_tr_b16 v[8:9], v1 offset:16384
ds_read_b64_tr_b16 v[10:11], v1 offset:17408
ds_read_b64_tr_b16 v[12:13], v1 offset:20480
ds_read_b64_tr_b16 v[14:15], v1 offset:21504
ds_read_b64_tr_b16 v[16:17], v1 offset:24576
ds_read_b64_tr_b16 v[18:19], v1 offset:25600
ds_read_b64_tr_b16 v[20:21], v1 offset:28672
ds_read_b64_tr_b16 v[22:23], v1 offset:29696
ds_read_b64_tr_b16 v[24:25], v1 offset:32768
ds_read_b64_tr_b16 v[26:27], v1 offset:33792
ds_read_b64_tr_b16 v[28:29], v1 offset:36864
ds_read_b64_tr_b16 v[30:31], v1 offset:37888
ds_read_b64_tr_b16 v[32:33], v1 offset:40960
ds_read_b64_tr_b16 v[34:35], v1 offset:41984
ds_read_b64_tr_b16 v[36:37], v1 offset:45056
ds_read_b64_tr_b16 v[38:39], v1 offset:46080
ds_read_b64_tr_b16 v[40:41], v1 offset:49152
ds_read_b64_tr_b16 v[42:43], v1 offset:50176
ds_read_b64_tr_b16 v[44:45], v1 offset:53248
ds_read_b64_tr_b16 v[46:47], v1 offset:54272
ds_read_b64_tr_b16 v[48:49], v1 offset:57344
ds_read_b64_tr_b16 v[50:51], v1 offset:58368
ds_read_b64_tr_b16 v[52:53], v1 offset:61440
ds_read_b64_tr_b16 v[54:55], v1 offset:62464
ds_read_b64_tr_b16 v[56:57], v2 offset:0
ds_read_b64_tr_b16 v[58:59], v2 offset:1024
ds_read_b64_tr_b16 v[60:61], v2 offset:4096
ds_read_b64_tr_b16 v[62:63], v2 offset:5120
ds_read_b64_tr_b16 v[64:65], v2 offset:8192
ds_read_b64_tr_b16 v[66:67], v2 offset:9216
ds_read_b64_tr_b16 v[68:69], v2 offset:12288
ds_read_b64_tr_b16 v[70:71], v2 offset:13312
ds_read_b64_tr_b16 v[72:73], v2 offset:16384
ds_read_b64_tr_b16 v[74:75], v2 offset:17408
ds_read_b64_tr_b16 v[76:77], v2 offset:20480
ds_read_b64_tr_b16 v[78:79], v2 offset:21504
s_waitcnt lgkmcnt(0)
s_barrier
ds_write_b128 v0, a[96:99] offset:16384
ds_write_b128 v0, a[100:103] offset:17408
ds_write_b128 v0, v[16:19] offset:18432
ds_write_b128 v0, v[20:23] offset:19456
ds_write_b128 v0, v[24:27] offset:20480
ds_write_b128 v0, v[28:31] offset:21504
ds_write_b128 v0, v[32:35] offset:22528
ds_write_b128 v0, v[36:39] offset:23552
ds_write_b128 v0, a[128:131] offset:24576
ds_write_b128 v0, a[132:135] offset:25600
ds_write_b128 v0, v[48:51] offset:26624
ds_write_b128 v0, v[52:55] offset:27648
ds_write_b128 v0, a[168:171] offset:28672
ds_write_b128 v0, a[172:175] offset:29696
ds_write_b128 v0, a[200:203] offset:30720
ds_write_b128 v0, a[204:207] offset:31744
ds_write_b128 v0, v[72:75] offset:32768
ds_write_b128 v0, v[76:79] offset:33792
s_waitcnt lgkmcnt(0)
v_accvgpr_write_b32 a96, v8
v_accvgpr_write_b32 a97, v9
v_accvgpr_write_b32 a98, v10
v_accvgpr_write_b32 a99, v11
v_accvgpr_write_b32 a100, v12
v_accvgpr_write_b32 a101, v13
v_accvgpr_write_b32 a102, v14
v_accvgpr_write_b32 a103, v15
v_accvgpr_write_b32 a128, v40
v_accvgpr_write_b32 a129, v41
v_accvgpr_write_b32 a130, v42
v_accvgpr_write_b32 a131, v43
v_accvgpr_write_b32 a132, v44
v_accvgpr_write_b32 a133, v45
v_accvgpr_write_b32 a134, v46
v_accvgpr_write_b32 a135, v47
v_accvgpr_write_b32 a168, v56
v_accvgpr_write_b32 a169, v57
v_accvgpr_write_b32 a170, v58
v_accvgpr_write_b32 a171, v59
v_accvgpr_write_b32 a172, v60
v_accvgpr_write_b32 a173, v61
v_accvgpr_write_b32 a174, v62
v_accvgpr_write_b32 a175, v63
v_accvgpr_write_b32 a200, v64
v_accvgpr_write_b32 a201, v65
v_accvgpr_write_b32 a202, v66
v_accvgpr_write_b32 a203, v67
v_accvgpr_write_b32 a204, v68
v_accvgpr_write_b32 a205, v69
v_accvgpr_write_b32 a206, v70
v_accvgpr_write_b32 a207, v71
s_waitcnt vmcnt(2)
s_barrier
ds_read_b64_tr_b16 v[8:9], v2 offset:24576
ds_read_b64_tr_b16 v[10:11], v2 offset:25600
ds_read_b64_tr_b16 v[12:13], v2 offset:28672
ds_read_b64_tr_b16 v[14:15], v2 offset:29696
ds_read_b64_tr_b16 v[16:17], v2 offset:32768
ds_read_b64_tr_b16 v[18:19], v2 offset:33792
ds_read_b64_tr_b16 v[20:21], v2 offset:36864
ds_read_b64_tr_b16 v[22:23], v2 offset:37888
ds_read_b64_tr_b16 v[24:25], v2 offset:40960
ds_read_b64_tr_b16 v[26:27], v2 offset:41984
ds_read_b64_tr_b16 v[28:29], v2 offset:45056
ds_read_b64_tr_b16 v[30:31], v2 offset:46080
ds_read_b64_tr_b16 v[32:33], v2 offset:49152
ds_read_b64_tr_b16 v[34:35], v2 offset:50176
ds_read_b64_tr_b16 v[36:37], v2 offset:53248
ds_read_b64_tr_b16 v[38:39], v2 offset:54272
ds_read_b64_tr_b16 v[40:41], v6 offset:57344
ds_read_b64_tr_b16 v[42:43], v6 offset:57856
ds_read_b64_tr_b16 v[44:45], v6 offset:59392
ds_read_b64_tr_b16 v[46:47], v6 offset:59904
ds_read_b64_tr_b16 v[48:49], v7 offset:0
ds_read_b64_tr_b16 v[50:51], v7 offset:512
ds_read_b64_tr_b16 v[52:53], v7 offset:2048
ds_read_b64_tr_b16 v[54:55], v7 offset:2560
ds_read_b64_tr_b16 v[56:57], v7 offset:8192
ds_read_b64_tr_b16 v[58:59], v7 offset:8704
ds_read_b64_tr_b16 v[60:61], v7 offset:10240
ds_read_b64_tr_b16 v[62:63], v7 offset:10752
ds_read_b64_tr_b16 v[64:65], v7 offset:16384
ds_read_b64_tr_b16 v[66:67], v7 offset:16896
ds_read_b64_tr_b16 v[68:69], v7 offset:18432
ds_read_b64_tr_b16 v[70:71], v7 offset:18944
ds_read_b64_tr_b16 v[72:73], v7 offset:24576
ds_read_b64_tr_b16 v[74:75], v7 offset:25088
ds_read_b64_tr_b16 v[76:77], v7 offset:26624
ds_read_b64_tr_b16 v[78:79], v7 offset:27136
s_waitcnt lgkmcnt(0)
s_barrier
ds_write_b128 v4, v[80:83] offset:28672
ds_write_b128 v4, v[84:87] offset:29696
ds_write_b128 v4, v[16:19] offset:30720
ds_write_b128 v4, v[20:23] offset:31744
ds_write_b128 v4, v[24:27] offset:32768
ds_write_b128 v4, v[28:31] offset:33792
ds_write_b128 v4, v[128:131] offset:34816
ds_write_b128 v4, v[132:135] offset:35840
ds_write_b128 v4, v[40:43] offset:36864
ds_write_b128 v4, v[44:47] offset:37888
ds_write_b128 v4, v[144:147] offset:38912
ds_write_b128 v4, v[148:151] offset:39936
ds_write_b128 v4, v[152:155] offset:40960
ds_write_b128 v4, v[156:159] offset:41984
ds_write_b128 v4, v[64:67] offset:43008
ds_write_b128 v4, v[68:71] offset:44032
ds_write_b128 v4, v[72:75] offset:45056
ds_write_b128 v4, v[76:79] offset:46080
s_waitcnt lgkmcnt(0)
v_mov_b32 v80, v8
v_mov_b32 v81, v9
v_mov_b32 v82, v10
v_mov_b32 v83, v11
v_mov_b32 v84, v12
v_mov_b32 v85, v13
v_mov_b32 v86, v14
v_mov_b32 v87, v15
v_mov_b32 v128, v32
v_mov_b32 v129, v33
v_mov_b32 v130, v34
v_mov_b32 v131, v35
v_mov_b32 v132, v36
v_mov_b32 v133, v37
v_mov_b32 v134, v38
v_mov_b32 v135, v39
v_mov_b32 v144, v48
v_mov_b32 v145, v49
v_mov_b32 v146, v50
v_mov_b32 v147, v51
v_mov_b32 v148, v52
v_mov_b32 v149, v53
v_mov_b32 v150, v54
v_mov_b32 v151, v55
v_mov_b32 v152, v56
v_mov_b32 v153, v57
v_mov_b32 v154, v58
v_mov_b32 v155, v59
v_mov_b32 v156, v60
v_mov_b32 v157, v61
v_mov_b32 v158, v62
v_mov_b32 v159, v63
v_lshrrev_b32 v8, 4, v0
v_and_b32 v9, 8, v8
v_cmp_ne_u32 s[42:43], 0, v9
v_and_b32 v9, 1, v8
v_cmp_ne_u32 s[44:45], 0, v9
v_bfe_u32 v9, v8, 1, 2
v_cmp_eq_u32 s[46:47], 0, v9
v_cmp_eq_u32 s[48:49], 1, v9
v_cmp_eq_u32 s[50:51], 2, v9
v_cmp_eq_u32 s[52:53], 3, v9
v_mov_b32 v1, 0x4444
v_mov_b32 v10, 0xeeee
v_cndmask_b32 v1, v1, v10, s[42:43]
v_mov_b32 v10, 0x3f80
v_cndmask_b32 v10, v10, 1.0, s[44:45]
v_bfe_u32 v11, v8, 4, 1
v_lshlrev_b32 v11, 1, v11
v_sub_u32 v9, v9, v11
v_cmp_eq_u32 vcc, 0, v9
s_nop 1
v_cndmask_b32 v2, 0, v10, vcc
v_cmp_eq_u32 vcc, 1, v9
s_nop 1
v_cndmask_b32 v3, 0, v10, vcc
v_lshrrev_b32 v9, 4, v8
v_and_b32 v10, 15, v8
v_lshlrev_b32 v10, 3, v10
v_lshl_add_u32 v5, v9, 12, v10
v_lshlrev_b32 v6, 2, v9
v_and_b32 v10, 3, v8
v_lshl_add_u32 v6, v10, 4, v6
v_bfe_u32 v10, v8, 2, 1
v_lshl_add_u32 v6, v10, 7, v6
v_and_b32 v7, 511, v0
s_mov_b32 s54, 0x3e0293ee
s_cmp_lg_u32 s3, 0
s_cbranch_scc1 k_wdd_117
v_mov_b32 v8, 192
k_wd_116:
global_load_dword v9, v8, s[28:29] sc1
s_waitcnt vmcnt(0)
v_readfirstlane_b32 s41, v9
s_cmp_ge_u32 s41, 32
s_cbranch_scc1 k_wdd_117
s_sleep 2
s_sub_u32 s32, s32, 1
s_cmp_gt_i32 s32, 0
s_cbranch_scc1 k_wd_116
k_wdd_117:
s_barrier
s_mov_b32 s68, 0
s_mov_b32 s31, 0
s_mov_b32 s33, 117440512
s_mov_b32 s34, 117440512
s_lshl_b32 s35, s30, 14
s_add_u32 s35, s35, 0
s_lshl_b32 s40, s30, 13
s_add_u32 s40, s40, 83886080
s_lshl_b32 s36, s30, 7
s_add_u32 s36, s36, 119537664
s_mov_b32 s55, 327680
s_add_u32 s41, s30, 0
s_lshl_b32 s37, s41, 12
s_add_u32 s37, s37, 119537664
s_add_u32 s59, s37, 327680
s_lshr_b32 s56, s41, 1
s_and_b32 s41, s41, 1
s_lshl_b32 s38, s56, 8
s_lshl_b32 s57, s41, 6
s_add_u32 s38, s38, s57
s_add_u32 s38, s38, 117440512
s_mul_i32 s41, s41, 5120
s_lshl_b32 s56, s56, 5
s_add_u32 s41, s41, s56
v_lshrrev_b32 v8, 4, v0
v_and_b32 v9, 3, v8
v_mul_u32_u24 v9, 1280, v9
v_bfe_u32 v10, v8, 2, 1
v_lshl_add_u32 v9, v10, 1, v9
v_bfe_u32 v10, v8, 4, 1
v_lshl_add_u32 v9, v10, 4, v9
v_bfe_u32 v10, v8, 5, 1
v_lshl_add_u32 v9, v10, 2, v9
buffer_load_ushort v10, v9, s[24:27], s41 offen
buffer_load_ushort v11, v9, s[24:27], s41 offen offset:8
v_mov_b64 v[12:13], -1
v_mov_b64 v[14:15], -1
s_waitcnt vmcnt(0)
v_lshl_or_b32 v10, v11, 16, v10
buffer_store_dword v10, v6, s[4:7], s38 offen
s_add_u32 s38, s38, 10240
buffer_store_dword v12, v6, s[4:7], s38 offen
s_add_u32 s58, s38, 10240
buffer_store_dwordx4 v[12:15], v0, s[4:7], s37 offen offset:0
buffer_store_dwordx4 v[12:15], v0, s[4:7], s37 offen offset:1024
buffer_store_dwordx4 v[12:15], v0, s[4:7], s37 offen offset:2048
buffer_store_dwordx4 v[12:15], v0, s[4:7], s37 offen offset:3072
k_nored_118:
s_waitcnt vmcnt(0)
s_barrier
s_mov_b64 exec, 1
v_mov_b32 v8, 160
v_mov_b32 v9, 1
global_atomic_add v8, v9, s[28:29] sc1
k_tb_119:
global_load_dword v9, v8, s[28:29] sc1
s_waitcnt vmcnt(0)
v_readfirstlane_b32 s41, v9
s_cmp_ge_u32 s41, 32
s_cbranch_scc1 k_tbd_120
s_sub_u32 s32, s32, 1
s_cmp_gt_i32 s32, 0
s_cbranch_scc1 k_tb_119
k_tbd_120:
s_mov_b64 exec, -1
s_barrier
buffer_load_dwordx4 v[40:43], v0, s[4:7], s60 offen offset:0
buffer_load_dwordx4 v[44:47], v0, s[4:7], s60 offen offset:1024
buffer_load_dwordx4 v[48:51], v0, s[4:7], s60 offen offset:2048
buffer_load_dwordx4 v[52:55], v0, s[4:7], s60 offen offset:3072
buffer_load_dwordx4 v[64:67], v0, s[4:7], s61 offen offset:0
buffer_load_dwordx4 v[68:71], v0, s[4:7], s61 offen offset:1024
buffer_load_dwordx4 v[72:75], v0, s[4:7], s61 offen offset:2048
buffer_load_dwordx4 v[76:79], v0, s[4:7], s61 offen offset:3072
buffer_load_dwordx4 v[56:59], v0, s[4:7], s62 offen offset:0
buffer_load_dwordx4 v[60:63], v0, s[4:7], s62 offen offset:1024
v_mov_b64 v[24:25], 0
v_mov_b64 v[26:27], 0
v_mov_b64 v[28:29], 0
v_mov_b64 v[30:31], 0
v_mov_b64 v[32:33], 0
v_mov_b64 v[34:35], 0
v_mov_b64 v[36:37], 0
v_mov_b64 v[38:39], 0
k_top_121:
s_add_u32 s41, s31, 0
s_cmp_gt_u32 s68, s41
s_cbranch_scc1 k_cd_130
s_lshl_b32 s56, s30, 6
s_add_u32 s56, s56, 222330880
k_ck_129:
buffer_load_dwordx2 v[8:9], off, s[4:7], s56 sc1
s_waitcnt vmcnt(0)
v_min_u32 v8, v8, v9
s_nop 0
v_readfirstlane_b32 s68, v8
s_cmp_gt_u32 s68, s41
s_cbranch_scc1 k_cd_130
s_sub_u32 s32, s32, 1
s_cmp_gt_i32 s32, 0
s_cbranch_scc1 k_ck_129
k_cd_130:
k_poll2_122:
buffer_load_dwordx4 v[12:15], v0, s[4:7], s33 offen offset:0 sc1
buffer_load_dwordx4 v[16:19], v0, s[4:7], s33 offen offset:1024 sc1
buffer_load_dwordx4 v[20:23], v0, s[4:7], s33 offen offset:2048 sc1
s_waitcnt vmcnt(2)
v_max3_u32 v8, v12, v13, v14
v_max_u32 v8, v8, v15
s_waitcnt vmcnt(1)
v_max3_u32 v8, v8, v16, v17
v_max3_u32 v8, v8, v18, v19
s_waitcnt vmcnt(0)
v_max3_u32 v8, v8, v20, v21
v_max3_u32 v8, v8, v22, v23
v_cmp_eq_u32 vcc, -1, v8
s_cbranch_vccnz k_retry2_123
k_poll2_122_ok:
ds_write_b128 v0, v[12:15] offset:0
v_smfmac_f32_16x16x64_bf16 v[24:27], v[16:19], v[64:71], v1
ds_write_b128 v0, v[16:19] offset:1024
v_smfmac_f32_16x16x64_bf16 v[28:31], v[16:19], v[72:79], v1
ds_write_b128 v0, v[20:23] offset:2048
v_smfmac_f32_16x16x64_bf16 v[24:27], v[12:15], v[40:47], v1
ds_read_b128 v[64:67], v0 offset:18432
v_smfmac_f32_16x16x64_bf16 v[28:31], v[12:15], v[48:55], v1
ds_read_b128 v[68:71], v0 offset:19456
v_smfmac_f32_16x16x64_bf16 v[24:27], v[20:23], v[56:63], v1
ds_read_b128 v[72:75], v0 offset:16384
v_smfmac_f32_16x16x64_bf16 v[28:31], v[20:23], a[0:7], v1
ds_read_b128 v[76:79], v0 offset:17408
v_smfmac_f32_16x16x64_bf16 v[32:35], v[12:15], a[88:95], v1
buffer_load_dwordx4 v[40:43], v0, s[4:7], s62 offen offset:2048
v_smfmac_f32_16x16x64_bf16 v[36:39], v[12:15], a[96:103], v1
buffer_load_dwordx4 v[44:47], v0, s[4:7], s62 offen offset:3072
s_waitcnt lgkmcnt(4)
s_barrier
ds_read_b128 v[8:11], v0 offset:3072
v_smfmac_f32_16x16x64_bf16 v[32:35], v[16:19], a[104:111], v1
s_waitcnt lgkmcnt(3)
ds_read_b128 v[12:15], v0 offset:4096
v_smfmac_f32_16x16x64_bf16 v[36:39], v[16:19], v[64:71], v1
ds_read_b128 v[16:19], v0 offset:5120
buffer_load_dwordx4 v[48:51], v0, s[4:7], s35 offen offset:0 sc1
v_smfmac_f32_16x16x64_bf16 v[32:35], v[20:23], a[112:119], v1
s_waitcnt lgkmcnt(3)
buffer_load_dwordx4 v[52:55], v0, s[4:7], s35 offen offset:1024 sc1
ds_read_b128 v[64:67], v0 offset:24576
v_smfmac_f32_16x16x64_bf16 v[36:39], v[20:23], v[72:79], v1
s_waitcnt lgkmcnt(3)
ds_read_b128 v[68:71], v0 offset:25600
ds_read_b128 v[20:23], v0 offset:6144
v_smfmac_f32_16x16x64_bf16 v[24:27], v[8:11], a[8:15], v1
ds_read_b128 v[72:75], v0 offset:28672
v_smfmac_f32_16x16x64_bf16 v[28:31], v[8:11], a[16:23], v1
s_waitcnt lgkmcnt(5)
ds_read_b128 v[8:11], v0 offset:7168
v_smfmac_f32_16x16x64_bf16 v[24:27], v[12:15], a[24:31], v1
s_waitcnt lgkmcnt(3)
ds_read_b128 v[76:79], v0 offset:29696
v_smfmac_f32_16x16x64_bf16 v[28:31], v[12:15], v[64:71], v1
ds_read_b128 v[12:15], v0 offset:8192
v_smfmac_f32_16x16x64_bf16 v[24:27], v[16:19], a[32:39], v1
ds_read_b128 v[64:67], v0 offset:30720
v_smfmac_f32_16x16x64_bf16 v[28:31], v[16:19], a[40:47], v1
s_waitcnt lgkmcnt(2)
ds_read_b128 v[16:19], v0 offset:9216
v_smfmac_f32_16x16x64_bf16 v[24:27], v[20:23], v[72:79], v1
ds_read_b128 v[68:71], v0 offset:31744
v_smfmac_f32_16x16x64_bf16 v[28:31], v[20:23], a[48:55], v1
buffer_load_dwordx4 v[56:59], v0, s[4:7], s35 offen offset:2048 sc1
v_smfmac_f32_16x16x64_bf16 v[24:27], v[8:11], a[56:63], v1
s_waitcnt lgkmcnt(0)
buffer_load_dwordx4 v[60:63], v0, s[4:7], s35 offen offset:3072 sc1
v_smfmac_f32_16x16x64_bf16 v[28:31], v[8:11], v[64:71], v1
ds_read_b128 v[72:75], v4 offset:28672
v_smfmac_f32_16x16x64_bf16 v[24:27], v[12:15], a[64:71], v1
ds_read_b128 v[76:79], v4 offset:29696
v_smfmac_f32_16x16x64_bf16 v[28:31], v[12:15], a[72:79], v1
s_waitcnt lgkmcnt(0)
ds_read_b128 v[64:67], v4 offset:34816
v_smfmac_f32_16x16x64_bf16 v[24:27], v[16:19], v[72:79], v1
ds_read_b128 v[68:71], v4 offset:35840
v_smfmac_f32_16x16x64_bf16 v[28:31], v[16:19], a[80:87], v1
ds_read_b128 v[72:75], v0 offset:22528
v_smfmac_f32_16x16x64_bf16 v[32:35], v[16:19], a[176:183], v1
ds_read_b128 v[76:79], v0 offset:23552
v_smfmac_f32_16x16x64_bf16 v[36:39], v[16:19], a[184:191], v1
s_waitcnt lgkmcnt(2)
ds_read_b128 v[16:19], v0 offset:5120
v_cvt_pk_bf16_f32 v24, v24, v25
v_smfmac_f32_16x16x64_bf16 v[32:35], v[12:15], v[64:71], v1
ds_read_b128 v[64:67], v0 offset:26624
v_cvt_pk_bf16_f32 v25, v26, v27
v_smfmac_f32_16x16x64_bf16 v[36:39], v[12:15], a[168:175], v1
ds_read_b128 v[68:71], v0 offset:27648
v_cvt_pk_bf16_f32 v28, v28, v29
v_mfma_f32_16x16x16_bf16 v[24:27], v[24:25], v[2:3], 0
ds_read_b128 v[12:15], v0 offset:4096
v_cvt_pk_bf16_f32 v29, v30, v31
v_smfmac_f32_16x16x64_bf16 v[32:35], v[8:11], a[160:167], v1
v_mfma_f32_16x16x16_bf16 v[28:31], v[28:29], v[2:3], 0
s_waitcnt lgkmcnt(4)
v_smfmac_f32_16x16x64_bf16 v[36:39], v[8:11], v[72:79], v1
s_waitcnt vmcnt(4)
ds_read_b128 v[72:75], v0 offset:20480
v_cvt_pk_bf16_f32 v24, v24, v25
v_smfmac_f32_16x16x64_bf16 v[32:35], v[20:23], v[40:47], v1
ds_read_b128 v[76:79], v0 offset:21504
v_cvt_pk_bf16_f32 v25, v26, v27
v_smfmac_f32_16x16x64_bf16 v[36:39], v[20:23], a[152:159], v1
ds_read_b128 v[20:23], v0 offset:3072
v_cvt_pk_bf16_f32 v26, v28, v29
v_cvt_pk_bf16_f32 v27, v30, v31
s_waitcnt lgkmcnt(6)
v_smfmac_f32_16x16x64_bf16 v[32:35], v[16:19], a[144:151], v1
s_waitcnt vmcnt(3)
v_mov_b64 v[40:41], -1
v_mfma_f32_16x16x32_bf16 v[28:31], v[48:51], v[24:27], 0
s_waitcnt vmcnt(2)
v_mov_b64 v[42:43], -1
v_mfma_f32_16x16x32_bf16 v[8:11], v[52:55], v[24:27], 0
buffer_store_dwordx4 v[40:43], v0, s[4:7], s59 offen offset:0
buffer_store_dwordx4 v[40:43], v0, s[4:7], s59 offen offset:1024
buffer_store_dwordx4 v[40:43], v0, s[4:7], s59 offen offset:2048
buffer_store_dwordx4 v[40:43], v0, s[4:7], s59 offen offset:3072
buffer_store_dword v40, v6, s[4:7], s58 offen
s_waitcnt lgkmcnt(4)
v_smfmac_f32_16x16x64_bf16 v[36:39], v[16:19], v[64:71], v1
s_waitcnt lgkmcnt(3)
ds_read_b128 v[64:67], v4 offset:30720
v_mov_b64 v[44:45], 0
v_smfmac_f32_16x16x64_bf16 v[32:35], v[12:15], a[136:143], v1
s_waitcnt lgkmcnt(2)
ds_read_b128 v[68:71], v4 offset:31744
v_mov_b64 v[46:47], 0
v_smfmac_f32_16x16x64_bf16 v[36:39], v[12:15], v[72:79], v1
ds_read_b128 v[72:75], v4 offset:32768
v_cndmask_b32 v28, v28, v8, s[42:43]
v_cndmask_b32 v29, v29, v9, s[42:43]
s_waitcnt lgkmcnt(3)
v_smfmac_f32_16x16x64_bf16 v[32:35], v[20:23], a[120:127], v1
ds_read_b128 v[76:79], v4 offset:33792
v_cndmask_b32 v30, v30, v10, s[42:43]
v_cndmask_b32 v31, v31, v11, s[42:43]
v_smfmac_f32_16x16x64_bf16 v[36:39], v[20:23], a[128:135], v1
ds_write_b128 v0, v[28:31] offset:10240
v_mov_b64 v[40:41], 0
v_mov_b64 v[42:43], 0
v_smfmac_f32_16x16x64_bf16 v[44:47], v[20:23], a[240:247], v1
v_cvt_pk_bf16_f32 v32, v32, v33
v_cvt_pk_bf16_f32 v33, v34, v35
v_smfmac_f32_16x16x64_bf16 v[40:43], v[20:23], a[232:239], v1
ds_read_b128 v[20:23], v0 offset:6144
v_mfma_f32_16x16x16_bf16 v[32:35], v[32:33], v[2:3], 0
v_cvt_pk_bf16_f32 v36, v36, v37
v_cvt_pk_bf16_f32 v37, v38, v39
s_waitcnt lgkmcnt(0)
s_barrier
v_mfma_f32_16x16x16_bf16 v[36:39], v[36:37], v[2:3], 0
ds_read_b128 v[48:51], v0 offset:11264
v_smfmac_f32_16x16x64_bf16 v[40:43], v[12:15], a[248:255], v1
ds_read_b128 v[52:55], v0 offset:12288
v_cvt_pk_bf16_f32 v32, v32, v33
v_cvt_pk_bf16_f32 v33, v34, v35
v_smfmac_f32_16x16x64_bf16 v[44:47], v[12:15], v[80:87], v1
ds_read_b128 v[12:15], v0 offset:7168
v_cvt_pk_bf16_f32 v34, v36, v37
v_cvt_pk_bf16_f32 v35, v38, v39
s_nop 1
v_mfma_f32_16x16x32_bf16 v[36:39], v[32:35], v[24:27], 0
ds_read_b128 v[8:11], v0 offset:13312
v_smfmac_f32_16x16x64_bf16 v[40:43], v[16:19], v[88:95], v1
buffer_store_dwordx4 v[32:35], v0, s[4:7], s40 offen sc1
s_waitcnt lgkmcnt(3)
v_add_f32 v28, v28, v48
v_add_f32 v29, v29, v49
v_smfmac_f32_16x16x64_bf16 v[44:47], v[16:19], v[64:71], v1
ds_write_b128 v7, v[36:39] offset:14336
v_smfmac_f32_16x16x64_bf16 v[40:43], v[20:23], v[96:103], v1
ds_read_b128 v[16:19], v0 offset:8192
v_add_f32 v30, v30, v50
v_add_f32 v31, v31, v51
v_smfmac_f32_16x16x64_bf16 v[44:47], v[20:23], v[104:111], v1
ds_read_b128 v[20:23], v0 offset:9216
s_waitcnt lgkmcnt(5)
v_add_f32 v28, v28, v52
v_add_f32 v29, v29, v53
s_waitcnt lgkmcnt(4)
v_smfmac_f32_16x16x64_bf16 v[40:43], v[12:15], v[112:119], v1
ds_read_b128 v[64:67], v4 offset:38912
v_add_f32 v30, v30, v54
v_add_f32 v31, v31, v55
v_smfmac_f32_16x16x64_bf16 v[44:47], v[12:15], v[72:79], v1
ds_read_b128 v[12:15], v0 offset:0
s_waitcnt lgkmcnt(5)
v_add_f32 v28, v28, v8
v_add_f32 v29, v29, v9
s_waitcnt lgkmcnt(3)
v_smfmac_f32_16x16x64_bf16 v[40:43], v[16:19], v[120:127], v1
ds_read_b128 v[68:71], v4 offset:39936
v_add_f32 v30, v30, v10
v_add_f32 v31, v31, v11
s_waitcnt lgkmcnt(0)
s_barrier
ds_read_b128 v[48:51], v7 offset:14848
ds_read_b128 v[52:55], v7 offset:15360
ds_read_b128 v[8:11], v7 offset:15872
v_smfmac_f32_16x16x64_bf16 v[44:47], v[16:19], v[128:135], v1
ds_read_b128 v[16:19], v0 offset:1024
v_max3_f32 v24, v28, v29, v30
v_smfmac_f32_16x16x64_bf16 v[40:43], v[20:23], v[136:143], v1
ds_read_b128 v[72:75], v0 offset:32768
v_max_f32 v24, v24, v31
v_smfmac_f32_16x16x64_bf16 v[44:47], v[20:23], v[64:71], v1
ds_read_b128 v[20:23], v0 offset:2048
v_max_f32_dpp v24, v24, v24 row_ror:8 row_mask:0xf bank_mask:0xf
v_smfmac_f32_16x16x64_bf16 v[40:43], v[12:15], a[192:199], v1
ds_read_b128 v[76:79], v0 offset:33792
v_mov_b32 v25, v24
v_smfmac_f32_16x16x64_bf16 v[44:47], v[12:15], a[200:207], v1
s_waitcnt lgkmcnt(3)
ds_read_b128 v[64:67], v4 offset:36864
v_permlane32_swap_b32 v24, v25
v_smfmac_f32_16x16x64_bf16 v[40:43], v[16:19], a[208:215], v1
s_waitcnt lgkmcnt(1)
ds_read_b128 v[68:71], v4 offset:37888
v_max_f32 v24, v24, v25
v_smfmac_f32_16x16x64_bf16 v[44:47], v[16:19], v[72:79], v1
ds_read_b128 v[72:75], v4 offset:45056
v_smfmac_f32_16x16x64_bf16 v[40:43], v[20:23], a[216:223], v1
ds_read_b128 v[76:79], v4 offset:46080
v_smfmac_f32_16x16x64_bf16 v[44:47], v[20:23], a[224:231], v1
v_add_f32 v36, v36, v48
v_add_f32 v37, v37, v49
v_add_f32 v38, v38, v50
v_add_f32 v39, v39, v51
v_add_f32 v36, v36, v52
v_add_f32 v37, v37, v53
v_add_f32 v38, v38, v54
v_add_f32 v39, v39, v55
v_add_f32 v36, v36, v8
v_add_f32 v37, v37, v9
v_add_f32 v38, v38, v10
v_add_f32 v39, v39, v11
buffer_load_dwordx4 v[48:51], v0, s[4:7], s63 offen offset:0
buffer_load_dwordx4 v[52:55], v0, s[4:7], s63 offen offset:1024
v_max3_f32 v24, v24, v36, v37
v_max3_f32 v24, v24, v38, v39
v_mov_b32 v25, v24
v_cvt_pk_bf16_f32 v40, v40, v41
v_cvt_pk_bf16_f32 v41, v42, v43
v_permlane16_swap_b32 v24, v25
v_max_f32 v24, v24, v25
v_mul_f32 v24, s54, v24
v_fma_f32 v28, v28, s54, -v24
v_exp_f32 v28, v28
v_fma_f32 v29, v29, s54, -v24
v_exp_f32 v29, v29
v_fma_f32 v30, v30, s54, -v24
v_exp_f32 v30, v30
v_fma_f32 v31, v31, s54, -v24
v_exp_f32 v31, v31
v_fma_f32 v36, v36, s54, -v24
v_exp_f32 v36, v36
v_fma_f32 v37, v37, s54, -v24
v_exp_f32 v37, v37
v_fma_f32 v38, v38, s54, -v24
v_exp_f32 v38, v38
v_fma_f32 v39, v39, s54, -v24
v_exp_f32 v39, v39
v_cvt_pk_bf16_f32 v24, v28, v29
v_cvt_pk_bf16_f32 v25, v30, v31
v_cvt_pk_bf16_f32 v26, v28, v29
v_cvt_pk_bf16_f32 v27, v30, v31
v_cvt_pk_bf16_f32 v32, v36, v37
v_cvt_pk_bf16_f32 v33, v38, v39
v_mov_b32_dpp v24, v26 row_ror:8 row_mask:0xf bank_mask:0xc
v_mov_b32_dpp v25, v27 row_ror:8 row_mask:0xf bank_mask:0xc
v_mov_b32_dpp v26, v26 row_ror:8 row_mask:0xf bank_mask:0x3
v_mov_b32_dpp v27, v27 row_ror:8 row_mask:0xf bank_mask:0x3
v_cvt_pk_bf16_f32 v42, v44, v45
v_cvt_pk_bf16_f32 v43, v46, v47
v_mov_b32 v8, 0x40004000
v_mov_b32 v9, 0x40004000
v_mov_b32 v10, 0x40004000
v_mov_b32 v11, 0x40004000
v_mov_b32 v34, 0x3f803f80
v_mov_b32 v35, 0x3f803f80
buffer_store_dwordx4 v[40:43], v0, s[4:7], s40 offen offset:1024 sc1
s_cmp_eq_u32 s31, 63
s_cbranch_scc1 k_done_124
v_mfma_f32_16x16x32_bf16 v[20:23], v[8:11], v[24:27], 0
s_waitcnt vmcnt(10)
v_mov_b64 v[28:29], 0
v_mov_b64 v[30:31], 0
v_mfma_f32_16x16x32_bf16 v[12:15], v[56:59], v[24:27], 0
v_mov_b64 v[36:37], 0
v_mov_b64 v[38:39], 0
v_mfma_f32_16x16x16_bf16 v[20:23], v[34:35], v[32:33], v[20:23]
s_waitcnt vmcnt(9)
v_mov_b64 v[44:45], 0
v_mov_b64 v[46:47], 0
v_mfma_f32_16x16x32_bf16 v[16:19], v[60:63], v[24:27], 0
buffer_load_dwordx4 v[56:59], v0, s[4:7], s63 offen offset:2048
v_mov_b64 v[24:25], 0
v_mfma_f32_16x16x16_bf16 v[12:15], v[40:41], v[32:33], v[12:15]
buffer_load_dwordx4 v[60:63], v0, s[4:7], s63 offen offset:3072
v_rcp_f32 v20, v20
v_mfma_f32_16x16x16_bf16 v[16:19], v[42:43], v[32:33], v[16:19]
v_mov_b64 v[26:27], 0
s_nop 1
v_mul_f32 v12, v12, v20
v_mul_f32 v13, v13, v20
v_mul_f32 v14, v14, v20
v_mul_f32 v15, v15, v20
v_cvt_pk_bf16_f32 v8, v12, v13
v_cvt_pk_bf16_f32 v9, v14, v15
v_mul_f32 v16, v16, v20
v_mul_f32 v17, v17, v20
v_mul_f32 v18, v18, v20
v_mul_f32 v19, v19, v20
v_cvt_pk_bf16_f32 v10, v16, v17
v_cvt_pk_bf16_f32 v11, v18, v19
ds_write_b128 v0, v[8:11] offset:10240
s_waitcnt lgkmcnt(3)
v_smfmac_f32_16x16x64_bf16 v[44:47], v[8:11], v[64:71], v1
s_waitcnt lgkmcnt(1)
v_mov_b64 v[32:33], 0
v_smfmac_f32_16x16x64_bf16 v[28:31], v[8:11], v[72:79], v1
v_mov_b64 v[34:35], 0
v_smfmac_f32_16x16x64_bf16 v[36:39], v[8:11], v[176:183], v1
s_waitcnt lgkmcnt(0)
s_barrier
ds_read_b128 v[12:15], v0 offset:11264
v_smfmac_f32_16x16x64_bf16 v[24:27], v[8:11], v[200:207], v1
ds_read_b128 v[16:19], v0 offset:12288
ds_read_b128 v[20:23], v0 offset:13312
v_smfmac_f32_16x16x64_bf16 v[32:35], v[8:11], v[232:239], v1
ds_read_b128 v[64:67], v4 offset:43008
ds_read_b128 v[68:71], v4 offset:44032
ds_read_b128 v[72:75], v4 offset:40960
ds_read_b128 v[76:79], v4 offset:41984
s_mov_b32 s41, s36
s_waitcnt lgkmcnt(6)
v_smfmac_f32_16x16x64_bf16 v[44:47], v[12:15], v[144:151], v1
s_waitcnt lgkmcnt(5)
v_smfmac_f32_16x16x64_bf16 v[44:47], v[16:19], v[152:159], v1
s_waitcnt lgkmcnt(2)
v_smfmac_f32_16x16x64_bf16 v[44:47], v[20:23], v[64:71], v1
v_smfmac_f32_16x16x64_bf16 v[28:31], v[12:15], v[160:167], v1
buffer_load_dwordx4 v[64:67], v0, s[4:7], s61 offen offset:0
v_smfmac_f32_16x16x64_bf16 v[28:31], v[16:19], v[168:175], v1
buffer_load_dwordx4 v[68:71], v0, s[4:7], s61 offen offset:1024
v_cvt_pk_bf16_f32 v44, v44, v45
v_cvt_pk_bf16_f32 v45, v46, v47
buffer_store_dwordx2 v[44:45], v5, s[4:7], s41 offen
s_add_u32 s41, s41, 65536
s_waitcnt lgkmcnt(0)
v_smfmac_f32_16x16x64_bf16 v[28:31], v[20:23], v[72:79], v1
buffer_load_dwordx4 v[40:43], v0, s[4:7], s60 offen offset:0
v_smfmac_f32_16x16x64_bf16 v[36:39], v[12:15], v[184:191], v1
buffer_load_dwordx4 v[44:47], v0, s[4:7], s60 offen offset:1024
v_smfmac_f32_16x16x64_bf16 v[36:39], v[16:19], v[192:199], v1
buffer_load_dwordx4 v[72:75], v0, s[4:7], s61 offen offset:2048
v_cvt_pk_bf16_f32 v28, v28, v29
v_cvt_pk_bf16_f32 v29, v30, v31
buffer_store_dwordx2 v[28:29], v5, s[4:7], s41 offen
s_add_u32 s41, s41, 65536
s_waitcnt vmcnt(10)
v_smfmac_f32_16x16x64_bf16 v[36:39], v[20:23], v[48:55], v1
buffer_load_dwordx4 v[76:79], v0, s[4:7], s61 offen offset:3072
v_smfmac_f32_16x16x64_bf16 v[24:27], v[12:15], v[208:215], v1
buffer_load_dwordx4 v[48:51], v0, s[4:7], s60 offen offset:2048
v_smfmac_f32_16x16x64_bf16 v[24:27], v[16:19], v[216:223], v1
buffer_load_dwordx4 v[52:55], v0, s[4:7], s60 offen offset:3072
v_cvt_pk_bf16_f32 v36, v36, v37
v_cvt_pk_bf16_f32 v37, v38, v39
buffer_store_dwordx2 v[36:37], v5, s[4:7], s41 offen
s_add_u32 s41, s41, 65536
v_smfmac_f32_16x16x64_bf16 v[24:27], v[20:23], v[224:231], v1
v_smfmac_f32_16x16x64_bf16 v[32:35], v[12:15], v[240:247], v1
v_smfmac_f32_16x16x64_bf16 v[32:35], v[16:19], v[248:255], v1
v_cvt_pk_bf16_f32 v24, v24, v25
v_cvt_pk_bf16_f32 v25, v26, v27
buffer_store_dwordx2 v[24:25], v5, s[4:7], s41 offen
s_add_u32 s41, s41, 65536
s_waitcnt vmcnt(12)
v_smfmac_f32_16x16x64_bf16 v[32:35], v[20:23], v[56:63], v1
s_nop 6
v_cvt_pk_bf16_f32 v32, v32, v33
v_cvt_pk_bf16_f32 v33, v34, v35
buffer_store_dwordx2 v[32:33], v5, s[4:7], s41 offen
s_add_u32 s41, s41, 65536
buffer_load_dwordx4 v[56:59], v0, s[4:7], s62 offen offset:0
buffer_load_dwordx4 v[60:63], v0, s[4:7], s62 offen offset:1024
s_add_u32 s31, s31, 1
s_add_u32 s33, s33, 10240
s_add_u32 s34, s34, 10240
s_add_u32 s35, s35, 524288
s_add_u32 s40, s40, 262144
s_add_u32 s36, s36, s55
v_mov_b32 v28, 0x4000
v_cndmask_b32 v28, v28, 2.0, s[44:45]
v_cndmask_b32 v24, 0, v28, s[46:47]
v_cndmask_b32 v25, 0, v28, s[48:49]
v_cndmask_b32 v26, 0, v28, s[50:51]
v_cndmask_b32 v27, 0, v28, s[52:53]
k_poll1_125:
buffer_load_dwordx4 v[8:11], v0, s[4:7], s37 offen offset:0 sc1
buffer_load_dwordx4 v[12:15], v0, s[4:7], s37 offen offset:1024 sc1
buffer_load_dwordx4 v[16:19], v0, s[4:7], s37 offen offset:2048 sc1
buffer_load_dwordx4 v[20:23], v0, s[4:7], s37 offen offset:3072 sc1
s_waitcnt vmcnt(3)
v_mfma_f32_16x16x32_bf16 v[28:31], v[8:11], v[24:27], 0
s_waitcnt vmcnt(2)
v_mfma_f32_16x16x32_bf16 v[28:31], v[12:15], v[24:27], v[28:31]
s_waitcnt vmcnt(1)
v_mfma_f32_16x16x32_bf16 v[28:31], v[16:19], v[24:27], v[28:31]
s_waitcnt vmcnt(0)
v_mfma_f32_16x16x32_bf16 v[28:31], v[20:23], v[24:27], v[28:31]
s_nop 7
v_permlane32_swap_b32 v28, v29
v_permlane32_swap_b32 v30, v31
v_add_f32 v28, v28, v29
v_add_f32 v29, v30, v31
v_cmp_u_f32 vcc, v28, v29
v_cvt_pk_bf16_f32 v28, v28, v29
s_cbranch_vccnz k_retry1_126
k_poll1_125_ok:
buffer_store_dword v28, v6, s[4:7], s38 offen
s_mov_b32 s59, s37
s_add_u32 s37, s37, s55
s_add_u32 s38, s38, 10240
s_add_u32 s58, s58, 10240
k_nored_127:
s_sub_u32 s55, 0, s55
v_mov_b64 v[24:25], 0
v_mov_b64 v[26:27], 0
v_mov_b64 v[28:29], 0
v_mov_b64 v[30:31], 0
v_mov_b64 v[32:33], 0
v_mov_b64 v[34:35], 0
v_mov_b64 v[36:37], 0
v_mov_b64 v[38:39], 0
s_branch k_top_121
k_retry2_123:
s_add_u32 s75, s75, 1
s_sub_u32 s32, s32, 1
s_cmp_gt_i32 s32, 0
s_cbranch_scc1 k_poll2_122
s_branch k_poll2_122_ok
k_retry1_126:
s_add_u32 s76, s76, 1
s_sub_u32 s32, s32, 1
s_cmp_gt_i32 s32, 0
s_cbranch_scc1 k_poll1_125
s_branch k_poll1_125_ok
k_done_124:
s_mov_b32 s31, 0
s_mov_b32 s33, 118489088
s_mov_b32 s34, 118489088
s_lshl_b32 s35, s30, 14
s_add_u32 s35, s35, 41943040
s_lshl_b32 s40, s30, 13
s_add_u32 s40, s40, 100663296
s_lshl_b32 s36, s30, 7
s_add_u32 s36, s36, 119537664
s_mov_b32 s55, 327680
s_add_u32 s41, s30, 0
s_lshl_b32 s37, s41, 12
s_add_u32 s37, s37, 119537664
s_add_u32 s59, s37, 327680
s_lshr_b32 s56, s41, 1
s_and_b32 s41, s41, 1
s_lshl_b32 s38, s56, 8
s_lshl_b32 s57, s41, 6
s_add_u32 s38, s38, s57
s_add_u32 s38, s38, 118489088
s_mul_i32 s41, s41, 5120
s_lshl_b32 s56, s56, 5
s_add_u32 s41, s41, s56
v_lshrrev_b32 v8, 4, v0
v_and_b32 v9, 3, v8
v_mul_u32_u24 v9, 1280, v9
v_bfe_u32 v10, v8, 2, 1
v_lshl_add_u32 v9, v10, 1, v9
v_bfe_u32 v10, v8, 4, 1
v_lshl_add_u32 v9, v10, 4, v9
v_bfe_u32 v10, v8, 5, 1
v_lshl_add_u32 v9, v10, 2, v9
buffer_load_ushort v10, v9, s[24:27], s41 offen
buffer_load_ushort v11, v9, s[24:27], s41 offen offset:8
v_mov_b64 v[12:13], -1
v_mov_b64 v[14:15], -1
s_waitcnt vmcnt(0)
v_lshl_or_b32 v10, v11, 16, v10
buffer_store_dword v10, v6, s[4:7], s38 offen
s_add_u32 s38, s38, 10240
buffer_store_dword v12, v6, s[4:7], s38 offen
s_add_u32 s58, s38, 10240
buffer_store_dwordx4 v[12:15], v0, s[4:7], s37 offen offset:0
buffer_store_dwordx4 v[12:15], v0, s[4:7], s37 offen offset:1024
buffer_store_dwordx4 v[12:15], v0, s[4:7], s37 offen offset:2048
buffer_store_dwordx4 v[12:15], v0, s[4:7], s37 offen offset:3072
k_nored_131:
s_waitcnt vmcnt(0)
s_barrier
s_mov_b64 exec, 1
v_mov_b32 v8, 160
v_mov_b32 v9, 1
global_atomic_add v8, v9, s[28:29] sc1
k_tb_132:
global_load_dword v9, v8, s[28:29] sc1
s_waitcnt vmcnt(0)
v_readfirstlane_b32 s41, v9
s_cmp_ge_u32 s41, 64
s_cbranch_scc1 k_tbd_133
s_sub_u32 s32, s32, 1
s_cmp_gt_i32 s32, 0
s_cbranch_scc1 k_tb_132
k_tbd_133:
s_mov_b64 exec, -1
s_barrier
buffer_load_dwordx4 v[40:43], v0, s[4:7], s60 offen offset:0
buffer_load_dwordx4 v[44:47], v0, s[4:7], s60 offen offset:1024
buffer_load_dwordx4 v[48:51], v0, s[4:7], s60 offen offset:2048
buffer_load_dwordx4 v[52:55], v0, s[4:7], s60 offen offset:3072
s_waitcnt lgkmcnt(3)
buffer_load_dwordx4 v[64:67], v0, s[4:7], s61 offen offset:0
s_waitcnt lgkmcnt(2)
buffer_load_dwordx4 v[68:71], v0, s[4:7], s61 offen offset:1024
s_waitcnt lgkmcnt(1)
buffer_load_dwordx4 v[72:75], v0, s[4:7], s61 offen offset:2048
s_waitcnt lgkmcnt(0)
buffer_load_dwordx4 v[76:79], v0, s[4:7], s61 offen offset:3072
buffer_load_dwordx4 v[56:59], v0, s[4:7], s62 offen offset:0
buffer_load_dwordx4 v[60:63], v0, s[4:7], s62 offen offset:1024
v_mov_b64 v[24:25], 0
v_mov_b64 v[26:27], 0
v_mov_b64 v[28:29], 0
v_mov_b64 v[30:31], 0
v_mov_b64 v[32:33], 0
v_mov_b64 v[34:35], 0
v_mov_b64 v[36:37], 0
v_mov_b64 v[38:39], 0
k_top_134:
s_add_u32 s41, s31, 64
s_cmp_gt_u32 s68, s41
s_cbranch_scc1 k_cd_143
s_lshl_b32 s56, s30, 6
s_add_u32 s56, s56, 222330880
k_ck_142:
buffer_load_dwordx2 v[8:9], off, s[4:7], s56 sc1
s_waitcnt vmcnt(0)
v_min_u32 v8, v8, v9
s_nop 0
v_readfirstlane_b32 s68, v8
s_cmp_gt_u32 s68, s41
s_cbranch_scc1 k_cd_143
s_sub_u32 s32, s32, 1
s_cmp_gt_i32 s32, 0
s_cbranch_scc1 k_ck_142
k_cd_143:
k_poll2_135:
buffer_load_dwordx4 v[12:15], v0, s[4:7], s33 offen offset:0 sc1
buffer_load_dwordx4 v[16:19], v0, s[4:7], s33 offen offset:1024 sc1
buffer_load_dwordx4 v[20:23], v0, s[4:7], s33 offen offset:2048 sc1
s_waitcnt vmcnt(2)
v_max3_u32 v8, v12, v13, v14
v_max_u32 v8, v8, v15
s_waitcnt vmcnt(1)
v_max3_u32 v8, v8, v16, v17
v_max3_u32 v8, v8, v18, v19
s_waitcnt vmcnt(0)
v_max3_u32 v8, v8, v20, v21
v_max3_u32 v8, v8, v22, v23
v_cmp_eq_u32 vcc, -1, v8
s_cbranch_vccnz k_retry2_136
k_poll2_135_ok:
ds_write_b128 v0, v[12:15] offset:0
v_smfmac_f32_16x16x64_bf16 v[24:27], v[16:19], v[64:71], v1
ds_write_b128 v0, v[16:19] offset:1024
v_smfmac_f32_16x16x64_bf16 v[28:31], v[16:19], v[72:79], v1
ds_write_b128 v0, v[20:23] offset:2048
v_smfmac_f32_16x16x64_bf16 v[24:27], v[12:15], v[40:47], v1
ds_read_b128 v[64:67], v0 offset:18432
v_smfmac_f32_16x16x64_bf16 v[28:31], v[12:15], v[48:55], v1
ds_read_b128 v[68:71], v0 offset:19456
v_smfmac_f32_16x16x64_bf16 v[24:27], v[20:23], v[56:63], v1
ds_read_b128 v[72:75], v0 offset:16384
v_smfmac_f32_16x16x64_bf16 v[28:31], v[20:23], a[0:7], v1
ds_read_b128 v[76:79], v0 offset:17408
v_smfmac_f32_16x16x64_bf16 v[32:35], v[12:15], a[88:95], v1
buffer_load_dwordx4 v[40:43], v0, s[4:7], s62 offen offset:2048
v_smfmac_f32_16x16x64_bf16 v[36:39], v[12:15], a[96:103], v1
buffer_load_dwordx4 v[44:47], v0, s[4:7], s62 offen offset:3072
s_waitcnt lgkmcnt(4)
s_barrier
ds_read_b128 v[8:11], v0 offset:3072
v_smfmac_f32_16x16x64_bf16 v[32:35], v[16:19], a[104:111], v1
s_waitcnt lgkmcnt(3)
ds_read_b128 v[12:15], v0 offset:4096
v_smfmac_f32_16x16x64_bf16 v[36:39], v[16:19], v[64:71], v1
ds_read_b128 v[16:19], v0 offset:5120
buffer_load_dwordx4 v[48:51], v0, s[4:7], s35 offen offset:0 sc1
v_smfmac_f32_16x16x64_bf16 v[32:35], v[20:23], a[112:119], v1
s_waitcnt lgkmcnt(3)
buffer_load_dwordx4 v[52:55], v0, s[4:7], s35 offen offset:1024 sc1
ds_read_b128 v[64:67], v0 offset:24576
v_smfmac_f32_16x16x64_bf16 v[36:39], v[20:23], v[72:79], v1
s_waitcnt lgkmcnt(3)
ds_read_b128 v[68:71], v0 offset:25600
ds_read_b128 v[20:23], v0 offset:6144
v_smfmac_f32_16x16x64_bf16 v[24:27], v[8:11], a[8:15], v1
ds_read_b128 v[72:75], v0 offset:28672
v_smfmac_f32_16x16x64_bf16 v[28:31], v[8:11], a[16:23], v1
s_waitcnt lgkmcnt(5)
ds_read_b128 v[8:11], v0 offset:7168
v_smfmac_f32_16x16x64_bf16 v[24:27], v[12:15], a[24:31], v1
s_waitcnt lgkmcnt(3)
ds_read_b128 v[76:79], v0 offset:29696
v_smfmac_f32_16x16x64_bf16 v[28:31], v[12:15], v[64:71], v1
ds_read_b128 v[12:15], v0 offset:8192
v_smfmac_f32_16x16x64_bf16 v[24:27], v[16:19], a[32:39], v1
ds_read_b128 v[64:67], v0 offset:30720
v_smfmac_f32_16x16x64_bf16 v[28:31], v[16:19], a[40:47], v1
s_waitcnt lgkmcnt(2)
ds_read_b128 v[16:19], v0 offset:9216
v_smfmac_f32_16x16x64_bf16 v[24:27], v[20:23], v[72:79], v1
ds_read_b128 v[68:71], v0 offset:31744
v_smfmac_f32_16x16x64_bf16 v[28:31], v[20:23], a[48:55], v1
buffer_load_dwordx4 v[56:59], v0, s[4:7], s35 offen offset:2048 sc1
v_smfmac_f32_16x16x64_bf16 v[24:27], v[8:11], a[56:63], v1
s_waitcnt lgkmcnt(0)
buffer_load_dwordx4 v[60:63], v0, s[4:7], s35 offen offset:3072 sc1
v_smfmac_f32_16x16x64_bf16 v[28:31], v[8:11], v[64:71], v1
ds_read_b128 v[72:75], v4 offset:28672
v_smfmac_f32_16x16x64_bf16 v[24:27], v[12:15], a[64:71], v1
ds_read_b128 v[76:79], v4 offset:29696
v_smfmac_f32_16x16x64_bf16 v[28:31], v[12:15], a[72:79], v1
s_waitcnt lgkmcnt(0)
ds_read_b128 v[64:67], v4 offset:34816
v_smfmac_f32_16x16x64_bf16 v[24:27], v[16:19], v[72:79], v1
ds_read_b128 v[68:71], v4 offset:35840
v_smfmac_f32_16x16x64_bf16 v[28:31], v[16:19], a[80:87], v1
ds_read_b128 v[72:75], v0 offset:22528
v_smfmac_f32_16x16x64_bf16 v[32:35], v[16:19], a[176:183], v1
ds_read_b128 v[76:79], v0 offset:23552
v_smfmac_f32_16x16x64_bf16 v[36:39], v[16:19], a[184:191], v1
s_waitcnt lgkmcnt(2)
ds_read_b128 v[16:19], v0 offset:5120
v_cvt_pk_bf16_f32 v24, v24, v25
v_smfmac_f32_16x16x64_bf16 v[32:35], v[12:15], v[64:71], v1
ds_read_b128 v[64:67], v0 offset:26624
v_cvt_pk_bf16_f32 v25, v26, v27
v_smfmac_f32_16x16x64_bf16 v[36:39], v[12:15], a[168:175], v1
ds_read_b128 v[68:71], v0 offset:27648
v_cvt_pk_bf16_f32 v28, v28, v29
v_mfma_f32_16x16x16_bf16 v[24:27], v[24:25], v[2:3], 0
ds_read_b128 v[12:15], v0 offset:4096
v_cvt_pk_bf16_f32 v29, v30, v31
v_smfmac_f32_16x16x64_bf16 v[32:35], v[8:11], a[160:167], v1
v_mfma_f32_16x16x16_bf16 v[28:31], v[28:29], v[2:3], 0
s_waitcnt lgkmcnt(4)
v_smfmac_f32_16x16x64_bf16 v[36:39], v[8:11], v[72:79], v1
s_waitcnt vmcnt(4)
ds_read_b128 v[72:75], v0 offset:20480
v_cvt_pk_bf16_f32 v24, v24, v25
v_smfmac_f32_16x16x64_bf16 v[32:35], v[20:23], v[40:47], v1
ds_read_b128 v[76:79], v0 offset:21504
v_cvt_pk_bf16_f32 v25, v26, v27
v_smfmac_f32_16x16x64_bf16 v[36:39], v[20:23], a[152:159], v1
ds_read_b128 v[20:23], v0 offset:3072
v_cvt_pk_bf16_f32 v26, v28, v29
v_cvt_pk_bf16_f32 v27, v30, v31
s_waitcnt lgkmcnt(6)
v_smfmac_f32_16x16x64_bf16 v[32:35], v[16:19], a[144:151], v1
s_waitcnt vmcnt(3)
v_mov_b64 v[40:41], -1
v_mfma_f32_16x16x32_bf16 v[28:31], v[48:51], v[24:27], 0
s_waitcnt vmcnt(2)
v_mov_b64 v[42:43], -1
v_mfma_f32_16x16x32_bf16 v[8:11], v[52:55], v[24:27], 0
buffer_store_dwordx4 v[40:43], v0, s[4:7], s59 offen offset:0
buffer_store_dwordx4 v[40:43], v0, s[4:7], s59 offen offset:1024
buffer_store_dwordx4 v[40:43], v0, s[4:7], s59 offen offset:2048
buffer_store_dwordx4 v[40:43], v0, s[4:7], s59 offen offset:3072
buffer_store_dword v40, v6, s[4:7], s58 offen
s_waitcnt lgkmcnt(4)
v_smfmac_f32_16x16x64_bf16 v[36:39], v[16:19], v[64:71], v1
s_waitcnt lgkmcnt(3)
ds_read_b128 v[64:67], v4 offset:30720
v_mov_b64 v[44:45], 0
v_smfmac_f32_16x16x64_bf16 v[32:35], v[12:15], a[136:143], v1
s_waitcnt lgkmcnt(2)
ds_read_b128 v[68:71], v4 offset:31744
v_mov_b64 v[46:47], 0
v_smfmac_f32_16x16x64_bf16 v[36:39], v[12:15], v[72:79], v1
ds_read_b128 v[72:75], v4 offset:32768
v_cndmask_b32 v28, v28, v8, s[42:43]
v_cndmask_b32 v29, v29, v9, s[42:43]
s_waitcnt lgkmcnt(3)
v_smfmac_f32_16x16x64_bf16 v[32:35], v[20:23], a[120:127], v1
ds_read_b128 v[76:79], v4 offset:33792
v_cndmask_b32 v30, v30, v10, s[42:43]
v_cndmask_b32 v31, v31, v11, s[42:43]
v_smfmac_f32_16x16x64_bf16 v[36:39], v[20:23], a[128:135], v1
ds_write_b128 v0, v[28:31] offset:10240
v_mov_b64 v[40:41], 0
v_mov_b64 v[42:43], 0
v_smfmac_f32_16x16x64_bf16 v[44:47], v[20:23], a[240:247], v1
v_cvt_pk_bf16_f32 v32, v32, v33
v_cvt_pk_bf16_f32 v33, v34, v35
v_smfmac_f32_16x16x64_bf16 v[40:43], v[20:23], a[232:239], v1
ds_read_b128 v[20:23], v0 offset:6144
v_mfma_f32_16x16x16_bf16 v[32:35], v[32:33], v[2:3], 0
v_cvt_pk_bf16_f32 v36, v36, v37
v_cvt_pk_bf16_f32 v37, v38, v39
s_waitcnt lgkmcnt(0)
s_barrier
v_mfma_f32_16x16x16_bf16 v[36:39], v[36:37], v[2:3], 0
ds_read_b128 v[48:51], v0 offset:11264
v_smfmac_f32_16x16x64_bf16 v[40:43], v[12:15], a[248:255], v1
ds_read_b128 v[52:55], v0 offset:12288
v_cvt_pk_bf16_f32 v32, v32, v33
v_cvt_pk_bf16_f32 v33, v34, v35
v_smfmac_f32_16x16x64_bf16 v[44:47], v[12:15], v[80:87], v1
ds_read_b128 v[12:15], v0 offset:7168
v_cvt_pk_bf16_f32 v34, v36, v37
v_cvt_pk_bf16_f32 v35, v38, v39
s_nop 1
v_mfma_f32_16x16x32_bf16 v[36:39], v[32:35], v[24:27], 0
ds_read_b128 v[8:11], v0 offset:13312
v_smfmac_f32_16x16x64_bf16 v[40:43], v[16:19], v[88:95], v1
buffer_store_dwordx4 v[32:35], v0, s[4:7], s40 offen sc1
s_waitcnt lgkmcnt(3)
v_add_f32 v28, v28, v48
v_add_f32 v29, v29, v49
v_smfmac_f32_16x16x64_bf16 v[44:47], v[16:19], v[64:71], v1
ds_write_b128 v7, v[36:39] offset:14336
v_smfmac_f32_16x16x64_bf16 v[40:43], v[20:23], v[96:103], v1
ds_read_b128 v[16:19], v0 offset:8192
v_add_f32 v30, v30, v50
v_add_f32 v31, v31, v51
v_smfmac_f32_16x16x64_bf16 v[44:47], v[20:23], v[104:111], v1
ds_read_b128 v[20:23], v0 offset:9216
s_waitcnt lgkmcnt(5)
v_add_f32 v28, v28, v52
v_add_f32 v29, v29, v53
s_waitcnt lgkmcnt(4)
v_smfmac_f32_16x16x64_bf16 v[40:43], v[12:15], v[112:119], v1
ds_read_b128 v[64:67], v4 offset:38912
v_add_f32 v30, v30, v54
v_add_f32 v31, v31, v55
v_smfmac_f32_16x16x64_bf16 v[44:47], v[12:15], v[72:79], v1
ds_read_b128 v[12:15], v0 offset:0
s_waitcnt lgkmcnt(5)
v_add_f32 v28, v28, v8
v_add_f32 v29, v29, v9
s_waitcnt lgkmcnt(3)
v_smfmac_f32_16x16x64_bf16 v[40:43], v[16:19], v[120:127], v1
ds_read_b128 v[68:71], v4 offset:39936
v_add_f32 v30, v30, v10
v_add_f32 v31, v31, v11
s_waitcnt lgkmcnt(0)
s_barrier
ds_read_b128 v[48:51], v7 offset:14848
ds_read_b128 v[52:55], v7 offset:15360
ds_read_b128 v[8:11], v7 offset:15872
v_smfmac_f32_16x16x64_bf16 v[44:47], v[16:19], v[128:135], v1
ds_read_b128 v[16:19], v0 offset:1024
v_max3_f32 v24, v28, v29, v30
v_smfmac_f32_16x16x64_bf16 v[40:43], v[20:23], v[136:143], v1
ds_read_b128 v[72:75], v0 offset:32768
v_max_f32 v24, v24, v31
v_smfmac_f32_16x16x64_bf16 v[44:47], v[20:23], v[64:71], v1
ds_read_b128 v[20:23], v0 offset:2048
v_max_f32_dpp v24, v24, v24 row_ror:8 row_mask:0xf bank_mask:0xf
v_smfmac_f32_16x16x64_bf16 v[40:43], v[12:15], a[192:199], v1
ds_read_b128 v[76:79], v0 offset:33792
v_mov_b32 v25, v24
v_smfmac_f32_16x16x64_bf16 v[44:47], v[12:15], a[200:207], v1
s_waitcnt lgkmcnt(3)
ds_read_b128 v[64:67], v4 offset:36864
v_permlane32_swap_b32 v24, v25
v_smfmac_f32_16x16x64_bf16 v[40:43], v[16:19], a[208:215], v1
s_waitcnt lgkmcnt(1)
ds_read_b128 v[68:71], v4 offset:37888
v_max_f32 v24, v24, v25
v_smfmac_f32_16x16x64_bf16 v[44:47], v[16:19], v[72:79], v1
ds_read_b128 v[72:75], v4 offset:45056
v_smfmac_f32_16x16x64_bf16 v[40:43], v[20:23], a[216:223], v1
ds_read_b128 v[76:79], v4 offset:46080
v_smfmac_f32_16x16x64_bf16 v[44:47], v[20:23], a[224:231], v1
v_add_f32 v36, v36, v48
v_add_f32 v37, v37, v49
v_add_f32 v38, v38, v50
v_add_f32 v39, v39, v51
v_add_f32 v36, v36, v52
v_add_f32 v37, v37, v53
v_add_f32 v38, v38, v54
v_add_f32 v39, v39, v55
v_add_f32 v36, v36, v8
v_add_f32 v37, v37, v9
v_add_f32 v38, v38, v10
v_add_f32 v39, v39, v11
buffer_load_dwordx4 v[48:51], v0, s[4:7], s63 offen offset:0
buffer_load_dwordx4 v[52:55], v0, s[4:7], s63 offen offset:1024
v_max3_f32 v24, v24, v36, v37
v_max3_f32 v24, v24, v38, v39
v_mov_b32 v25, v24
v_cvt_pk_bf16_f32 v40, v40, v41
v_cvt_pk_bf16_f32 v41, v42, v43
v_permlane16_swap_b32 v24, v25
v_max_f32 v24, v24, v25
v_mul_f32 v24, s54, v24
v_fma_f32 v28, v28, s54, -v24
v_exp_f32 v28, v28
v_fma_f32 v29, v29, s54, -v24
v_exp_f32 v29, v29
v_fma_f32 v30, v30, s54, -v24
v_exp_f32 v30, v30
v_fma_f32 v31, v31, s54, -v24
v_exp_f32 v31, v31
v_fma_f32 v36, v36, s54, -v24
v_exp_f32 v36, v36
v_fma_f32 v37, v37, s54, -v24
v_exp_f32 v37, v37
v_fma_f32 v38, v38, s54, -v24
v_exp_f32 v38, v38
v_fma_f32 v39, v39, s54, -v24
v_exp_f32 v39, v39
v_cvt_pk_bf16_f32 v24, v28, v29
v_cvt_pk_bf16_f32 v25, v30, v31
v_cvt_pk_bf16_f32 v26, v28, v29
v_cvt_pk_bf16_f32 v27, v30, v31
v_cvt_pk_bf16_f32 v32, v36, v37
v_cvt_pk_bf16_f32 v33, v38, v39
v_mov_b32_dpp v24, v26 row_ror:8 row_mask:0xf bank_mask:0xc
v_mov_b32_dpp v25, v27 row_ror:8 row_mask:0xf bank_mask:0xc
v_mov_b32_dpp v26, v26 row_ror:8 row_mask:0xf bank_mask:0x3
v_mov_b32_dpp v27, v27 row_ror:8 row_mask:0xf bank_mask:0x3
v_cvt_pk_bf16_f32 v42, v44, v45
v_cvt_pk_bf16_f32 v43, v46, v47
v_mov_b32 v8, 0x40004000
v_mov_b32 v9, 0x40004000
v_mov_b32 v10, 0x40004000
v_mov_b32 v11, 0x40004000
v_mov_b32 v34, 0x3f803f80
v_mov_b32 v35, 0x3f803f80
buffer_store_dwordx4 v[40:43], v0, s[4:7], s40 offen offset:1024 sc1
s_cmp_eq_u32 s31, 63
s_cbranch_scc1 k_done_137
v_mfma_f32_16x16x32_bf16 v[20:23], v[8:11], v[24:27], 0
s_waitcnt vmcnt(10)
v_mov_b64 v[28:29], 0
v_mov_b64 v[30:31], 0
v_mfma_f32_16x16x32_bf16 v[12:15], v[56:59], v[24:27], 0
v_mov_b64 v[36:37], 0
v_mov_b64 v[38:39], 0
v_mfma_f32_16x16x16_bf16 v[20:23], v[34:35], v[32:33], v[20:23]
s_waitcnt vmcnt(9)
v_mov_b64 v[44:45], 0
v_mov_b64 v[46:47], 0
v_mfma_f32_16x16x32_bf16 v[16:19], v[60:63], v[24:27], 0
buffer_load_dwordx4 v[56:59], v0, s[4:7], s63 offen offset:2048
v_mov_b64 v[24:25], 0
v_mfma_f32_16x16x16_bf16 v[12:15], v[40:41], v[32:33], v[12:15]
buffer_load_dwordx4 v[60:63], v0, s[4:7], s63 offen offset:3072
v_rcp_f32 v20, v20
v_mfma_f32_16x16x16_bf16 v[16:19], v[42:43], v[32:33], v[16:19]
v_mov_b64 v[26:27], 0
s_nop 1
v_mul_f32 v12, v12, v20
v_mul_f32 v13, v13, v20
v_mul_f32 v14, v14, v20
v_mul_f32 v15, v15, v20
v_cvt_pk_bf16_f32 v8, v12, v13
v_cvt_pk_bf16_f32 v9, v14, v15
v_mul_f32 v16, v16, v20
v_mul_f32 v17, v17, v20
v_mul_f32 v18, v18, v20
v_mul_f32 v19, v19, v20
v_cvt_pk_bf16_f32 v10, v16, v17
v_cvt_pk_bf16_f32 v11, v18, v19
ds_write_b128 v0, v[8:11] offset:10240
s_waitcnt lgkmcnt(3)
v_smfmac_f32_16x16x64_bf16 v[44:47], v[8:11], v[64:71], v1
s_waitcnt lgkmcnt(1)
v_mov_b64 v[32:33], 0
v_smfmac_f32_16x16x64_bf16 v[28:31], v[8:11], v[72:79], v1
v_mov_b64 v[34:35], 0
v_smfmac_f32_16x16x64_bf16 v[36:39], v[8:11], v[176:183], v1
s_waitcnt lgkmcnt(0)
s_barrier
ds_read_b128 v[12:15], v0 offset:11264
v_smfmac_f32_16x16x64_bf16 v[24:27], v[8:11], v[200:207], v1
ds_read_b128 v[16:19], v0 offset:12288
ds_read_b128 v[20:23], v0 offset:13312
v_smfmac_f32_16x16x64_bf16 v[32:35], v[8:11], v[232:239], v1
ds_read_b128 v[64:67], v4 offset:43008
ds_read_b128 v[68:71], v4 offset:44032
ds_read_b128 v[72:75], v4 offset:40960
ds_read_b128 v[76:79], v4 offset:41984
s_mov_b32 s41, s36
s_waitcnt lgkmcnt(6)
v_smfmac_f32_16x16x64_bf16 v[44:47], v[12:15], v[144:151], v1
s_waitcnt lgkmcnt(5)
v_smfmac_f32_16x16x64_bf16 v[44:47], v[16:19], v[152:159], v1
s_waitcnt lgkmcnt(2)
v_smfmac_f32_16x16x64_bf16 v[44:47], v[20:23], v[64:71], v1
v_smfmac_f32_16x16x64_bf16 v[28:31], v[12:15], v[160:167], v1
buffer_load_dwordx4 v[64:67], v0, s[4:7], s61 offen offset:0
v_smfmac_f32_16x16x64_bf16 v[28:31], v[16:19], v[168:175], v1
buffer_load_dwordx4 v[68:71], v0, s[4:7], s61 offen offset:1024
v_cvt_pk_bf16_f32 v44, v44, v45
v_cvt_pk_bf16_f32 v45, v46, v47
buffer_store_dwordx2 v[44:45], v5, s[4:7], s41 offen
s_add_u32 s41, s41, 65536
s_waitcnt lgkmcnt(0)
v_smfmac_f32_16x16x64_bf16 v[28:31], v[20:23], v[72:79], v1
buffer_load_dwordx4 v[40:43], v0, s[4:7], s60 offen offset:0
v_smfmac_f32_16x16x64_bf16 v[36:39], v[12:15], v[184:191], v1
buffer_load_dwordx4 v[44:47], v0, s[4:7], s60 offen offset:1024
v_smfmac_f32_16x16x64_bf16 v[36:39], v[16:19], v[192:199], v1
buffer_load_dwordx4 v[72:75], v0, s[4:7], s61 offen offset:2048
v_cvt_pk_bf16_f32 v28, v28, v29
v_cvt_pk_bf16_f32 v29, v30, v31
buffer_store_dwordx2 v[28:29], v5, s[4:7], s41 offen
s_add_u32 s41, s41, 65536
s_waitcnt vmcnt(10)
v_smfmac_f32_16x16x64_bf16 v[36:39], v[20:23], v[48:55], v1
buffer_load_dwordx4 v[76:79], v0, s[4:7], s61 offen offset:3072
v_smfmac_f32_16x16x64_bf16 v[24:27], v[12:15], v[208:215], v1
buffer_load_dwordx4 v[48:51], v0, s[4:7], s60 offen offset:2048
v_smfmac_f32_16x16x64_bf16 v[24:27], v[16:19], v[216:223], v1
buffer_load_dwordx4 v[52:55], v0, s[4:7], s60 offen offset:3072
v_cvt_pk_bf16_f32 v36, v36, v37
v_cvt_pk_bf16_f32 v37, v38, v39
buffer_store_dwordx2 v[36:37], v5, s[4:7], s41 offen
s_add_u32 s41, s41, 65536
v_smfmac_f32_16x16x64_bf16 v[24:27], v[20:23], v[224:231], v1
v_smfmac_f32_16x16x64_bf16 v[32:35], v[12:15], v[240:247], v1
v_smfmac_f32_16x16x64_bf16 v[32:35], v[16:19], v[248:255], v1
v_cvt_pk_bf16_f32 v24, v24, v25
v_cvt_pk_bf16_f32 v25, v26, v27
buffer_store_dwordx2 v[24:25], v5, s[4:7], s41 offen
s_add_u32 s41, s41, 65536
s_waitcnt vmcnt(12)
v_smfmac_f32_16x16x64_bf16 v[32:35], v[20:23], v[56:63], v1
s_nop 6
v_cvt_pk_bf16_f32 v32, v32, v33
v_cvt_pk_bf16_f32 v33, v34, v35
buffer_store_dwordx2 v[32:33], v5, s[4:7], s41 offen
s_add_u32 s41, s41, 65536
buffer_load_dwordx4 v[56:59], v0, s[4:7], s62 offen offset:0
buffer_load_dwordx4 v[60:63], v0, s[4:7], s62 offen offset:1024
s_add_u32 s31, s31, 1
s_add_u32 s33, s33, 10240
s_add_u32 s34, s34, 10240
s_add_u32 s35, s35, 524288
s_add_u32 s40, s40, 262144
s_add_u32 s36, s36, s55
v_mov_b32 v28, 0x4000
v_cndmask_b32 v28, v28, 2.0, s[44:45]
v_cndmask_b32 v24, 0, v28, s[46:47]
v_cndmask_b32 v25, 0, v28, s[48:49]
v_cndmask_b32 v26, 0, v28, s[50:51]
v_cndmask_b32 v27, 0, v28, s[52:53]
k_poll1_138:
buffer_load_dwordx4 v[8:11], v0, s[4:7], s37 offen offset:0 sc1
buffer_load_dwordx4 v[12:15], v0, s[4:7], s37 offen offset:1024 sc1
buffer_load_dwordx4 v[16:19], v0, s[4:7], s37 offen offset:2048 sc1
buffer_load_dwordx4 v[20:23], v0, s[4:7], s37 offen offset:3072 sc1
s_waitcnt vmcnt(3)
v_mfma_f32_16x16x32_bf16 v[28:31], v[8:11], v[24:27], 0
s_waitcnt vmcnt(2)
v_mfma_f32_16x16x32_bf16 v[28:31], v[12:15], v[24:27], v[28:31]
s_waitcnt vmcnt(1)
v_mfma_f32_16x16x32_bf16 v[28:31], v[16:19], v[24:27], v[28:31]
s_waitcnt vmcnt(0)
v_mfma_f32_16x16x32_bf16 v[28:31], v[20:23], v[24:27], v[28:31]
s_nop 7
v_permlane32_swap_b32 v28, v29
v_permlane32_swap_b32 v30, v31
v_add_f32 v28, v28, v29
v_add_f32 v29, v30, v31
v_cmp_u_f32 vcc, v28, v29
v_cvt_pk_bf16_f32 v28, v28, v29
s_cbranch_vccnz k_retry1_139
k_poll1_138_ok:
buffer_store_dword v28, v6, s[4:7], s38 offen
s_mov_b32 s59, s37
s_add_u32 s37, s37, s55
s_add_u32 s38, s38, 10240
s_add_u32 s58, s58, 10240
k_nored_140:
s_sub_u32 s55, 0, s55
v_mov_b64 v[24:25], 0
v_mov_b64 v[26:27], 0
v_mov_b64 v[28:29], 0
v_mov_b64 v[30:31], 0
v_mov_b64 v[32:33], 0
v_mov_b64 v[34:35], 0
v_mov_b64 v[36:37], 0
v_mov_b64 v[38:39], 0
s_branch k_top_134
k_retry2_136:
s_add_u32 s75, s75, 1
s_sub_u32 s32, s32, 1
s_cmp_gt_i32 s32, 0
s_cbranch_scc1 k_poll2_135
s_branch k_poll2_135_ok
k_retry1_139:
s_add_u32 s76, s76, 1
s_sub_u32 s32, s32, 1
s_cmp_gt_i32 s32, 0
s_cbranch_scc1 k_poll1_138
s_branch k_poll1_138_ok
k_done_137:
s_add_u32 s30, s30, 112
s_waitcnt vmcnt(0) lgkmcnt(0)
s_barrier
s_branch k_fin_7
k_w1_113:
v_lshrrev_b32 v10, 3, v0
v_lshlrev_b32 v8, 13, v10
v_bfe_u32 v10, v0, 1, 2
v_lshrrev_b32 v11, 4, v0
v_xor_b32 v10, v10, v11
v_lshl_add_u32 v8, v10, 5, v8
v_and_b32 v12, 1, v0
v_lshl_add_u32 v8, v12, 4, v8
v_mul_u32_u24 v9, 1280, v11
v_bfe_u32 v10, v0, 1, 3
v_and_b32 v11, 1, v11
v_lshlrev_b32 v11, 1, v11
v_xor_b32 v10, v10, v11
v_xor_b32 v10, 0, v10
v_lshl_add_u32 v9, v10, 5, v9
v_lshl_add_u32 v9, v12, 4, v9
v_bfe_u32 v10, v0, 5, 1
v_lshlrev_b32 v10, 4, v10
v_bfe_u32 v11, v0, 4, 1
v_lshl_add_u32 v10, v11, 1, v10
v_bfe_u32 v11, v0, 2, 1
v_lshl_add_u32 v10, v11, 2, v10
v_bfe_u32 v11, v0, 3, 1
v_add_u32 v10, v11, v10
v_bfe_u32 v11, v10, 1, 2
v_xor_b32 v11, 1, v11
v_lshlrev_b32 v11, 5, v11
v_lshl_add_u32 v1, v10, 7, v11
v_and_b32 v12, 3, v0
v_lshl_add_u32 v1, v12, 3, v1
v_add_u32 v2, 0x10000, v1
v_add_u32 v3, 0x20000, v1
v_bfe_u32 v10, v0, 4, 1
v_lshlrev_b32 v11, 4, v10
v_lshlrev_b32 v10, 2, v10
v_bfe_u32 v6, v0, 5, 1
v_lshl_add_u32 v11, v6, 2, v11
v_bfe_u32 v6, v0, 2, 1
v_add_u32 v11, v6, v11
v_lshl_add_u32 v10, v6, 1, v10
v_bfe_u32 v6, v0, 3, 1
v_add_u32 v6, 2, v6
v_xor_b32 v10, v10, v6
v_lshlrev_b32 v10, 5, v10
v_lshl_add_u32 v5, v11, 8, v10
v_lshl_add_u32 v5, v12, 3, v5
v_add_u32 v6, 0x10000, v5
v_add_u32 v7, 0x20000, v5
v_lshlrev_b32 v0, 4, v0
v_add_u32 v4, 98304, v0
s_lshl_b32 s56, s30, 8
s_mul_i32 s57, s30, 163840
s_mul_i32 s39, s30, 131072
s_add_u32 s39, s39, 120619008
s_add_u32 s60, s39, 0
s_add_u32 s61, s39, 4096
s_add_u32 s62, s39, 8192
s_add_u32 s63, s39, 12288
s_add_u32 s64, s39, 16384
s_add_u32 s65, s39, 20480
s_add_u32 s66, s39, 24576
s_add_u32 s67, s39, 28672
s_mov_b32 m0, 2048
s_add_u32 s41, s56, 131072
buffer_load_dwordx4 v8, s[8:11], s41 offen lds
s_mov_b32 m0, 3072
s_add_u32 s41, s56, 196608
buffer_load_dwordx4 v8, s[8:11], s41 offen lds
s_mov_b32 m0, 10240
s_add_u32 s41, s56, 131200
buffer_load_dwordx4 v8, s[8:11], s41 offen lds
s_mov_b32 m0, 11264
s_add_u32 s41, s56, 196736
buffer_load_dwordx4 v8, s[8:11], s41 offen lds
s_mov_b32 m0, 18432
s_add_u32 s41, s56, 655360
buffer_load_dwordx4 v8, s[8:11], s41 offen lds
s_mov_b32 m0, 19456
s_add_u32 s41, s56, 720896
buffer_load_dwordx4 v8, s[8:11], s41 offen lds
s_mov_b32 m0, 26624
s_add_u32 s41, s56, 655488
buffer_load_dwordx4 v8, s[8:11], s41 offen lds
s_mov_b32 m0, 27648
s_add_u32 s41, s56, 721024
buffer_load_dwordx4 v8, s[8:11], s41 offen lds
s_mov_b32 m0, 34816
s_add_u32 s41, s56, 1179648
buffer_load_dwordx4 v8, s[8:11], s41 offen lds
s_mov_b32 m0, 35840
s_add_u32 s41, s56, 1245184
buffer_load_dwordx4 v8, s[8:11], s41 offen lds
s_mov_b32 m0, 43008
s_add_u32 s41, s56, 1179776
buffer_load_dwordx4 v8, s[8:11], s41 offen lds
s_mov_b32 m0, 44032
s_add_u32 s41, s56, 1245312
buffer_load_dwordx4 v8, s[8:11], s41 offen lds
s_mov_b32 m0, 51200
s_add_u32 s41, s56, 1703936
buffer_load_dwordx4 v8, s[8:11], s41 offen lds
s_mov_b32 m0, 52224
s_add_u32 s41, s56, 1769472
buffer_load_dwordx4 v8, s[8:11], s41 offen lds
s_mov_b32 m0, 59392
s_add_u32 s41, s56, 1704064
buffer_load_dwordx4 v8, s[8:11], s41 offen lds
s_mov_b32 m0, 60416
s_add_u32 s41, s56, 1769600
buffer_load_dwordx4 v8, s[8:11], s41 offen lds
s_mov_b32 m0, 67584
s_add_u32 s41, s56, 2228224
buffer_load_dwordx4 v8, s[8:11], s41 offen lds
s_mov_b32 m0, 68608
s_add_u32 s41, s56, 2293760
buffer_load_dwordx4 v8, s[8:11], s41 offen lds
s_mov_b32 m0, 75776
s_add_u32 s41, s56, 2228352
buffer_load_dwordx4 v8, s[8:11], s41 offen lds
s_mov_b32 m0, 76800
s_add_u32 s41, s56, 2293888
buffer_load_dwordx4 v8, s[8:11], s41 offen lds
s_mov_b32 m0, 83968
s_add_u32 s41, s56, 2752512
buffer_load_dwordx4 v8, s[8:11], s41 offen lds
s_mov_b32 m0, 84992
s_add_u32 s41, s56, 2818048
buffer_load_dwordx4 v8, s[8:11], s41 offen lds
s_mov_b32 m0, 92160
s_add_u32 s41, s56, 2752640
buffer_load_dwordx4 v8, s[8:11], s41 offen lds
s_mov_b32 m0, 93184
s_add_u32 s41, s56, 2818176
buffer_load_dwordx4 v8, s[8:11], s41 offen lds
s_mov_b32 m0, 100352
s_add_u32 s41, s56, 3276800
buffer_load_dwordx4 v8, s[8:11], s41 offen lds
s_mov_b32 m0, 101376
s_add_u32 s41, s56, 3342336
buffer_load_dwordx4 v8, s[8:11], s41 offen lds
s_mov_b32 m0, 108544
s_add_u32 s41, s56, 3276928
buffer_load_dwordx4 v8, s[8:11], s41 offen lds
s_mov_b32 m0, 109568
s_add_u32 s41, s56, 3342464
buffer_load_dwordx4 v8, s[8:11], s41 offen lds
s_mov_b32 m0, 116736
s_add_u32 s41, s56, 3801088
buffer_load_dwordx4 v8, s[8:11], s41 offen lds
s_mov_b32 m0, 117760
s_add_u32 s41, s56, 3866624
buffer_load_dwordx4 v8, s[8:11], s41 offen lds
s_mov_b32 m0, 124928
s_add_u32 s41, s56, 3801216
buffer_load_dwordx4 v8, s[8:11], s41 offen lds
s_mov_b32 m0, 125952
s_add_u32 s41, s56, 3866752
buffer_load_dwordx4 v8, s[8:11], s41 offen lds
s_waitcnt vmcnt(24)
s_barrier
s_mov_b32 m0, 133120
s_add_u32 s41, s56, 4325376
buffer_load_dwordx4 v8, s[8:11], s41 offen lds
s_mov_b32 m0, 134144
s_add_u32 s41, s56, 4390912
buffer_load_dwordx4 v8, s[8:11], s41 offen lds
s_mov_b32 m0, 141312
s_add_u32 s41, s56, 4325504
buffer_load_dwordx4 v8, s[8:11], s41 offen lds
s_mov_b32 m0, 142336
s_add_u32 s41, s56, 4391040
buffer_load_dwordx4 v8, s[8:11], s41 offen lds
s_mov_b32 m0, 149504
s_add_u32 s41, s56, 4849664
buffer_load_dwordx4 v8, s[8:11], s41 offen lds
s_mov_b32 m0, 150528
s_add_u32 s41, s56, 4915200
buffer_load_dwordx4 v8, s[8:11], s41 offen lds
s_mov_b32 m0, 157696
s_add_u32 s41, s56, 4849792
buffer_load_dwordx4 v8, s[8:11], s41 offen lds
s_mov_b32 m0, 158720
s_add_u32 s41, s56, 4915328
buffer_load_dwordx4 v8, s[8:11], s41 offen lds
ds_read_b64_tr_b16 a[56:57], v1 offset:0
ds_read_b64_tr_b16 a[58:59], v1 offset:1024
ds_read_b64_tr_b16 a[60:61], v1 offset:4096
ds_read_b64_tr_b16 a[62:63], v1 offset:5120
ds_read_b64_tr_b16 v[128:129], v1 offset:8192
ds_read_b64_tr_b16 v[130:131], v1 offset:9216
ds_read_b64_tr_b16 v[132:133], v1 offset:12288
ds_read_b64_tr_b16 v[134:135], v1 offset:13312
ds_read_b64_tr_b16 a[64:65], v1 offset:16384
ds_read_b64_tr_b16 a[66:67], v1 offset:17408
ds_read_b64_tr_b16 a[68:69], v1 offset:20480
ds_read_b64_tr_b16 a[70:71], v1 offset:21504
ds_read_b64_tr_b16 a[72:73], v1 offset:24576
ds_read_b64_tr_b16 a[74:75], v1 offset:25600
ds_read_b64_tr_b16 a[76:77], v1 offset:28672
ds_read_b64_tr_b16 a[78:79], v1 offset:29696
s_waitcnt lgkmcnt(0)
s_waitcnt vmcnt(24)
s_barrier
s_mov_b32 m0, 2048
s_add_u32 s41, s56, 131072
buffer_load_dwordx4 v8, s[12:15], s41 offen lds
s_mov_b32 m0, 3072
s_add_u32 s41, s56, 196608
buffer_load_dwordx4 v8, s[12:15], s41 offen lds
s_mov_b32 m0, 10240
s_add_u32 s41, s56, 655360
buffer_load_dwordx4 v8, s[12:15], s41 offen lds
s_mov_b32 m0, 11264
s_add_u32 s41, s56, 720896
buffer_load_dwordx4 v8, s[12:15], s41 offen lds
s_mov_b32 m0, 18432
s_add_u32 s41, s56, 1179648
buffer_load_dwordx4 v8, s[12:15], s41 offen lds
s_mov_b32 m0, 19456
s_add_u32 s41, s56, 1245184
buffer_load_dwordx4 v8, s[12:15], s41 offen lds
s_mov_b32 m0, 26624
s_add_u32 s41, s56, 1179776
buffer_load_dwordx4 v8, s[12:15], s41 offen lds
s_mov_b32 m0, 27648
s_add_u32 s41, s56, 1245312
buffer_load_dwordx4 v8, s[12:15], s41 offen lds
ds_read_b64_tr_b16 a[224:225], v1 offset:32768
ds_read_b64_tr_b16 a[226:227], v1 offset:33792
ds_read_b64_tr_b16 a[228:229], v1 offset:36864
ds_read_b64_tr_b16 a[230:231], v1 offset:37888
ds_read_b64_tr_b16 a[80:81], v1 offset:40960
ds_read_b64_tr_b16 a[82:83], v1 offset:41984
ds_read_b64_tr_b16 a[84:85], v1 offset:45056
ds_read_b64_tr_b16 a[86:87], v1 offset:46080
ds_read_b64_tr_b16 v[32:33], v1 offset:49152
ds_read_b64_tr_b16 v[34:35], v1 offset:50176
ds_read_b64_tr_b16 v[36:37], v1 offset:53248
ds_read_b64_tr_b16 v[38:39], v1 offset:54272
ds_read_b64_tr_b16 v[40:41], v1 offset:57344
ds_read_b64_tr_b16 v[42:43], v1 offset:58368
ds_read_b64_tr_b16 v[44:45], v1 offset:61440
ds_read_b64_tr_b16 v[46:47], v1 offset:62464
s_waitcnt lgkmcnt(0)
buffer_store_dwordx4 v[32:35], v0, s[4:7], s60 offen offset:0
buffer_store_dwordx4 v[36:39], v0, s[4:7], s60 offen offset:1024
buffer_store_dwordx4 v[40:43], v0, s[4:7], s60 offen offset:2048
buffer_store_dwordx4 v[44:47], v0, s[4:7], s60 offen offset:3072
s_waitcnt vmcnt(28)
s_barrier
s_mov_b32 m0, 34816
s_add_u32 s41, s56, 1703936
buffer_load_dwordx4 v8, s[12:15], s41 offen lds
s_mov_b32 m0, 35840
s_add_u32 s41, s56, 1769472
buffer_load_dwordx4 v8, s[12:15], s41 offen lds
s_mov_b32 m0, 43008
s_add_u32 s41, s56, 2228224
buffer_load_dwordx4 v8, s[12:15], s41 offen lds
s_mov_b32 m0, 44032
s_add_u32 s41, s56, 2293760
buffer_load_dwordx4 v8, s[12:15], s41 offen lds
s_mov_b32 m0, 51200
s_add_u32 s41, s56, 2752512
buffer_load_dwordx4 v8, s[12:15], s41 offen lds
s_mov_b32 m0, 52224
s_add_u32 s41, s56, 2818048
buffer_load_dwordx4 v8, s[12:15], s41 offen lds
s_mov_b32 m0, 59392
s_add_u32 s41, s56, 3276800
buffer_load_dwordx4 v8, s[12:15], s41 offen lds
s_mov_b32 m0, 60416
s_add_u32 s41, s56, 3342336
buffer_load_dwordx4 v8, s[12:15], s41 offen lds
ds_read_b64_tr_b16 v[16:17], v2 offset:0
ds_read_b64_tr_b16 v[18:19], v2 offset:1024
ds_read_b64_tr_b16 v[20:21], v2 offset:4096
ds_read_b64_tr_b16 v[22:23], v2 offset:5120
ds_read_b64_tr_b16 v[24:25], v2 offset:8192
ds_read_b64_tr_b16 v[26:27], v2 offset:9216
ds_read_b64_tr_b16 v[28:29], v2 offset:12288
ds_read_b64_tr_b16 v[30:31], v2 offset:13312
ds_read_b64_tr_b16 v[32:33], v2 offset:16384
ds_read_b64_tr_b16 v[34:35], v2 offset:17408
ds_read_b64_tr_b16 v[36:37], v2 offset:20480
ds_read_b64_tr_b16 v[38:39], v2 offset:21504
ds_read_b64_tr_b16 a[0:1], v2 offset:24576
ds_read_b64_tr_b16 a[2:3], v2 offset:25600
ds_read_b64_tr_b16 a[4:5], v2 offset:28672
ds_read_b64_tr_b16 a[6:7], v2 offset:29696
s_waitcnt lgkmcnt(0)
buffer_store_dwordx4 v[16:19], v0, s[4:7], s61 offen offset:0
buffer_store_dwordx4 v[20:23], v0, s[4:7], s61 offen offset:1024
buffer_store_dwordx4 v[24:27], v0, s[4:7], s61 offen offset:2048
buffer_store_dwordx4 v[28:31], v0, s[4:7], s61 offen offset:3072
buffer_store_dwordx4 v[32:35], v0, s[4:7], s62 offen offset:0
buffer_store_dwordx4 v[36:39], v0, s[4:7], s62 offen offset:1024
s_waitcnt vmcnt(34)
s_barrier
s_mov_b32 m0, 67584
s_add_u32 s41, s56, 3276928
buffer_load_dwordx4 v8, s[12:15], s41 offen lds
s_mov_b32 m0, 68608
s_add_u32 s41, s56, 3342464
buffer_load_dwordx4 v8, s[12:15], s41 offen lds
s_mov_b32 m0, 75776
s_add_u32 s41, s56, 3801088
buffer_load_dwordx4 v8, s[12:15], s41 offen lds
s_mov_b32 m0, 76800
s_add_u32 s41, s56, 3866624
buffer_load_dwordx4 v8, s[12:15], s41 offen lds
s_mov_b32 m0, 83968
s_add_u32 s41, s56, 4325376
buffer_load_dwordx4 v8, s[12:15], s41 offen lds
s_mov_b32 m0, 84992
s_add_u32 s41, s56, 4390912
buffer_load_dwordx4 v8, s[12:15], s41 offen lds
s_mov_b32 m0, 92160
s_add_u32 s41, s56, 4849664
buffer_load_dwordx4 v8, s[12:15], s41 offen lds
s_mov_b32 m0, 93184
s_add_u32 s41, s56, 4915200
buffer_load_dwordx4 v8, s[12:15], s41 offen lds
ds_read_b64_tr_b16 a[8:9], v2 offset:32768
ds_read_b64_tr_b16 a[10:11], v2 offset:33792
ds_read_b64_tr_b16 a[12:13], v2 offset:36864
ds_read_b64_tr_b16 a[14:15], v2 offset:37888
ds_read_b64_tr_b16 a[16:17], v2 offset:40960
ds_read_b64_tr_b16 a[18:19], v2 offset:41984
ds_read_b64_tr_b16 a[20:21], v2 offset:45056
ds_read_b64_tr_b16 a[22:23], v2 offset:46080
ds_read_b64_tr_b16 a[24:25], v2 offset:49152
ds_read_b64_tr_b16 a[26:27], v2 offset:50176
ds_read_b64_tr_b16 a[28:29], v2 offset:53248
ds_read_b64_tr_b16 a[30:31], v2 offset:54272
ds_read_b64_tr_b16 a[168:169], v2 offset:57344
ds_read_b64_tr_b16 a[170:171], v2 offset:58368
ds_read_b64_tr_b16 a[172:173], v2 offset:61440
ds_read_b64_tr_b16 a[174:175], v2 offset:62464
s_waitcnt lgkmcnt(0)
s_waitcnt vmcnt(34)
s_barrier
s_mov_b32 m0, 100352
s_add_u32 s41, s56, 4849792
buffer_load_dwordx4 v8, s[12:15], s41 offen lds
s_mov_b32 m0, 101376
s_add_u32 s41, s56, 4915328
buffer_load_dwordx4 v8, s[12:15], s41 offen lds
s_mov_b32 m0, 108544
s_add_u32 s41, s56, 131072
buffer_load_dwordx4 v8, s[16:19], s41 offen lds
s_mov_b32 m0, 109568
s_add_u32 s41, s56, 196608
buffer_load_dwordx4 v8, s[16:19], s41 offen lds
s_mov_b32 m0, 116736
s_add_u32 s41, s56, 655360
buffer_load_dwordx4 v8, s[16:19], s41 offen lds
s_mov_b32 m0, 117760
s_add_u32 s41, s56, 720896
buffer_load_dwordx4 v8, s[16:19], s41 offen lds
s_mov_b32 m0, 124928
s_add_u32 s41, s56, 1179648
buffer_load_dwordx4 v8, s[16:19], s41 offen lds
s_mov_b32 m0, 125952
s_add_u32 s41, s56, 1245184
buffer_load_dwordx4 v8, s[16:19], s41 offen lds
ds_read_b64_tr_b16 a[32:33], v3 offset:0
ds_read_b64_tr_b16 a[34:35], v3 offset:1024
ds_read_b64_tr_b16 a[36:37], v3 offset:4096
ds_read_b64_tr_b16 a[38:39], v3 offset:5120
ds_read_b64_tr_b16 a[40:41], v3 offset:8192
ds_read_b64_tr_b16 a[42:43], v3 offset:9216
ds_read_b64_tr_b16 a[44:45], v3 offset:12288
ds_read_b64_tr_b16 a[46:47], v3 offset:13312
ds_read_b64_tr_b16 a[96:97], v3 offset:16384
ds_read_b64_tr_b16 a[98:99], v3 offset:17408
ds_read_b64_tr_b16 a[100:101], v3 offset:20480
ds_read_b64_tr_b16 a[102:103], v3 offset:21504
ds_read_b64_tr_b16 a[48:49], v3 offset:24576
ds_read_b64_tr_b16 a[50:51], v3 offset:25600
ds_read_b64_tr_b16 a[52:53], v3 offset:28672
ds_read_b64_tr_b16 a[54:55], v3 offset:29696
s_waitcnt lgkmcnt(0)
s_waitcnt vmcnt(34)
s_barrier
s_mov_b32 m0, 133120
s_add_u32 s41, s56, 1179776
buffer_load_dwordx4 v8, s[16:19], s41 offen lds
s_mov_b32 m0, 134144
s_add_u32 s41, s56, 1245312
buffer_load_dwordx4 v8, s[16:19], s41 offen lds
s_mov_b32 m0, 141312
s_add_u32 s41, s56, 1703936
buffer_load_dwordx4 v8, s[16:19], s41 offen lds
s_mov_b32 m0, 142336
s_add_u32 s41, s56, 1769472
buffer_load_dwordx4 v8, s[16:19], s41 offen lds
s_mov_b32 m0, 149504
s_add_u32 s41, s56, 1704064
buffer_load_dwordx4 v8, s[16:19], s41 offen lds
s_mov_b32 m0, 150528
s_add_u32 s41, s56, 1769600
buffer_load_dwordx4 v8, s[16:19], s41 offen lds
s_mov_b32 m0, 157696
s_add_u32 s41, s56, 2228224
buffer_load_dwordx4 v8, s[16:19], s41 offen lds
s_mov_b32 m0, 158720
s_add_u32 s41, s56, 2293760
buffer_load_dwordx4 v8, s[16:19], s41 offen lds
ds_read_b64_tr_b16 a[160:161], v1 offset:0
ds_read_b64_tr_b16 a[162:163], v1 offset:1024
ds_read_b64_tr_b16 a[164:165], v1 offset:4096
ds_read_b64_tr_b16 a[166:167], v1 offset:5120
ds_read_b64_tr_b16 v[80:81], v1 offset:8192
ds_read_b64_tr_b16 v[82:83], v1 offset:9216
ds_read_b64_tr_b16 v[84:85], v1 offset:12288
ds_read_b64_tr_b16 v[86:87], v1 offset:13312
ds_read_b64_tr_b16 a[176:177], v1 offset:16384
ds_read_b64_tr_b16 a[178:179], v1 offset:17408
ds_read_b64_tr_b16 a[180:181], v1 offset:20480
ds_read_b64_tr_b16 a[182:183], v1 offset:21504
ds_read_b64_tr_b16 a[184:185], v1 offset:24576
ds_read_b64_tr_b16 a[186:187], v1 offset:25600
ds_read_b64_tr_b16 a[188:189], v1 offset:28672
ds_read_b64_tr_b16 a[190:191], v1 offset:29696
s_waitcnt lgkmcnt(0)
s_waitcnt vmcnt(30)
s_barrier
s_mov_b32 m0, 2048
s_add_u32 s41, s56, 2752512
buffer_load_dwordx4 v8, s[16:19], s41 offen lds
s_mov_b32 m0, 3072
s_add_u32 s41, s56, 2818048
buffer_load_dwordx4 v8, s[16:19], s41 offen lds
s_mov_b32 m0, 10240
s_add_u32 s41, s56, 3276800
buffer_load_dwordx4 v8, s[16:19], s41 offen lds
s_mov_b32 m0, 11264
s_add_u32 s41, s56, 3342336
buffer_load_dwordx4 v8, s[16:19], s41 offen lds
s_mov_b32 m0, 18432
s_add_u32 s41, s56, 3276928
buffer_load_dwordx4 v8, s[16:19], s41 offen lds
s_mov_b32 m0, 19456
s_add_u32 s41, s56, 3342464
buffer_load_dwordx4 v8, s[16:19], s41 offen lds
s_mov_b32 m0, 26624
s_add_u32 s41, s56, 3801088
buffer_load_dwordx4 v8, s[16:19], s41 offen lds
s_mov_b32 m0, 27648
s_add_u32 s41, s56, 3866624
buffer_load_dwordx4 v8, s[16:19], s41 offen lds
ds_read_b64_tr_b16 a[88:89], v1 offset:32768
ds_read_b64_tr_b16 a[90:91], v1 offset:33792
ds_read_b64_tr_b16 a[92:93], v1 offset:36864
ds_read_b64_tr_b16 a[94:95], v1 offset:37888
ds_read_b64_tr_b16 a[104:105], v1 offset:40960
ds_read_b64_tr_b16 a[106:107], v1 offset:41984
ds_read_b64_tr_b16 a[108:109], v1 offset:45056
ds_read_b64_tr_b16 a[110:111], v1 offset:46080
ds_read_b64_tr_b16 a[112:113], v1 offset:49152
ds_read_b64_tr_b16 a[114:115], v1 offset:50176
ds_read_b64_tr_b16 a[116:117], v1 offset:53248
ds_read_b64_tr_b16 a[118:119], v1 offset:54272
ds_read_b64_tr_b16 a[120:121], v1 offset:57344
ds_read_b64_tr_b16 a[122:123], v1 offset:58368
ds_read_b64_tr_b16 a[124:125], v1 offset:61440
ds_read_b64_tr_b16 a[126:127], v1 offset:62464
s_waitcnt lgkmcnt(0)
s_waitcnt vmcnt(24)
s_barrier
s_mov_b32 m0, 34816
s_add_u32 s41, s56, 4325376
buffer_load_dwordx4 v8, s[16:19], s41 offen lds
s_mov_b32 m0, 35840
s_add_u32 s41, s56, 4390912
buffer_load_dwordx4 v8, s[16:19], s41 offen lds
s_mov_b32 m0, 43008
s_add_u32 s41, s56, 4849664
buffer_load_dwordx4 v8, s[16:19], s41 offen lds
s_mov_b32 m0, 44032
s_add_u32 s41, s56, 4915200
buffer_load_dwordx4 v8, s[16:19], s41 offen lds
s_mov_b32 m0, 51200
s_add_u32 s41, s56, 4849792
buffer_load_dwordx4 v8, s[16:19], s41 offen lds
s_mov_b32 m0, 52224
s_add_u32 s41, s56, 4915328
buffer_load_dwordx4 v8, s[16:19], s41 offen lds
s_mov_b32 m0, 59392
s_add_u32 s41, s57, 30976
buffer_load_dwordx4 v9, s[20:23], s41 offen lds
s_mov_b32 m0, 60416
s_add_u32 s41, s57, 36096
buffer_load_dwordx4 v9, s[20:23], s41 offen lds
ds_read_b64_tr_b16 a[128:129], v2 offset:0
ds_read_b64_tr_b16 a[130:131], v2 offset:1024
ds_read_b64_tr_b16 a[132:133], v2 offset:4096
ds_read_b64_tr_b16 a[134:135], v2 offset:5120
ds_read_b64_tr_b16 a[136:137], v2 offset:8192
ds_read_b64_tr_b16 a[138:139], v2 offset:9216
ds_read_b64_tr_b16 a[140:141], v2 offset:12288
ds_read_b64_tr_b16 a[142:143], v2 offset:13312
ds_read_b64_tr_b16 a[144:145], v2 offset:16384
ds_read_b64_tr_b16 a[146:147], v2 offset:17408
ds_read_b64_tr_b16 a[148:149], v2 offset:20480
ds_read_b64_tr_b16 a[150:151], v2 offset:21504
ds_read_b64_tr_b16 v[40:41], v2 offset:24576
ds_read_b64_tr_b16 v[42:43], v2 offset:25600
ds_read_b64_tr_b16 v[44:45], v2 offset:28672
ds_read_b64_tr_b16 v[46:47], v2 offset:29696
s_waitcnt lgkmcnt(0)
buffer_store_dwordx4 v[40:43], v0, s[4:7], s62 offen offset:2048
buffer_store_dwordx4 v[44:47], v0, s[4:7], s62 offen offset:3072
s_waitcnt vmcnt(26)
s_barrier
s_mov_b32 m0, 67584
s_add_u32 s41, s57, 51456
buffer_load_dwordx4 v9, s[20:23], s41 offen lds
s_mov_b32 m0, 68608
s_add_u32 s41, s57, 56576
buffer_load_dwordx4 v9, s[20:23], s41 offen lds
s_mov_b32 m0, 75776
s_add_u32 s41, s57, 71936
buffer_load_dwordx4 v9, s[20:23], s41 offen lds
s_mov_b32 m0, 76800
s_add_u32 s41, s57, 77056
buffer_load_dwordx4 v9, s[20:23], s41 offen lds
s_mov_b32 m0, 83968
s_add_u32 s41, s57, 10752
buffer_load_dwordx4 v9, s[20:23], s41 offen lds
s_mov_b32 m0, 84992
s_add_u32 s41, s57, 15872
buffer_load_dwordx4 v9, s[20:23], s41 offen lds
s_mov_b32 m0, 92160
s_add_u32 s41, s57, 31232
buffer_load_dwordx4 v9, s[20:23], s41 offen lds
s_mov_b32 m0, 93184
s_add_u32 s41, s57, 36352
buffer_load_dwordx4 v9, s[20:23], s41 offen lds
ds_read_b64_tr_b16 a[152:153], v2 offset:32768
ds_read_b64_tr_b16 a[154:155], v2 offset:33792
ds_read_b64_tr_b16 a[156:157], v2 offset:36864
ds_read_b64_tr_b16 a[158:159], v2 offset:37888
ds_read_b64_tr_b16 v[112:113], v2 offset:40960
ds_read_b64_tr_b16 v[114:115], v2 offset:41984
ds_read_b64_tr_b16 v[116:117], v2 offset:45056
ds_read_b64_tr_b16 v[118:119], v2 offset:46080
ds_read_b64_tr_b16 v[120:121], v2 offset:49152
ds_read_b64_tr_b16 v[122:123], v2 offset:50176
ds_read_b64_tr_b16 v[124:125], v2 offset:53248
ds_read_b64_tr_b16 v[126:127], v2 offset:54272
ds_read_b64_tr_b16 v[136:137], v2 offset:57344
ds_read_b64_tr_b16 v[138:139], v2 offset:58368
ds_read_b64_tr_b16 v[140:141], v2 offset:61440
ds_read_b64_tr_b16 v[142:143], v2 offset:62464
s_waitcnt lgkmcnt(0)
s_waitcnt vmcnt(26)
s_barrier
s_mov_b32 m0, 100352
s_add_u32 s41, s57, 51712
buffer_load_dwordx4 v9, s[20:23], s41 offen lds
s_mov_b32 m0, 101376
s_add_u32 s41, s57, 56832
buffer_load_dwordx4 v9, s[20:23], s41 offen lds
s_mov_b32 m0, 108544
s_add_u32 s41, s57, 72192
buffer_load_dwordx4 v9, s[20:23], s41 offen lds
s_mov_b32 m0, 109568
s_add_u32 s41, s57, 77312
buffer_load_dwordx4 v9, s[20:23], s41 offen lds
s_mov_b32 m0, 116736
s_add_u32 s41, s57, 11008
buffer_load_dwordx4 v9, s[20:23], s41 offen lds
s_mov_b32 m0, 117760
s_add_u32 s41, s57, 16128
buffer_load_dwordx4 v9, s[20:23], s41 offen lds
s_mov_b32 m0, 124928
s_add_u32 s41, s57, 31488
buffer_load_dwordx4 v9, s[20:23], s41 offen lds
s_mov_b32 m0, 125952
s_add_u32 s41, s57, 36608
buffer_load_dwordx4 v9, s[20:23], s41 offen lds
ds_read_b64_tr_b16 v[144:145], v3 offset:0
ds_read_b64_tr_b16 v[146:147], v3 offset:1024
ds_read_b64_tr_b16 v[148:149], v3 offset:4096
ds_read_b64_tr_b16 v[150:151], v3 offset:5120
ds_read_b64_tr_b16 a[192:193], v3 offset:8192
ds_read_b64_tr_b16 a[194:195], v3 offset:9216
ds_read_b64_tr_b16 a[196:197], v3 offset:12288
ds_read_b64_tr_b16 a[198:199], v3 offset:13312
ds_read_b64_tr_b16 a[200:201], v3 offset:16384
ds_read_b64_tr_b16 a[202:203], v3 offset:17408
ds_read_b64_tr_b16 a[204:205], v3 offset:20480
ds_read_b64_tr_b16 a[206:207], v3 offset:21504
ds_read_b64_tr_b16 a[208:209], v3 offset:24576
ds_read_b64_tr_b16 a[210:211], v3 offset:25600
ds_read_b64_tr_b16 a[212:213], v3 offset:28672
ds_read_b64_tr_b16 a[214:215], v3 offset:29696
s_waitcnt lgkmcnt(0)
s_waitcnt vmcnt(26)
s_barrier
s_mov_b32 m0, 133120
s_add_u32 s41, s57, 51968
buffer_load_dwordx4 v9, s[20:23], s41 offen lds
s_mov_b32 m0, 134144
s_add_u32 s41, s57, 57088
buffer_load_dwordx4 v9, s[20:23], s41 offen lds
s_mov_b32 m0, 141312
s_add_u32 s41, s57, 72448
buffer_load_dwordx4 v9, s[20:23], s41 offen lds
s_mov_b32 m0, 142336
s_add_u32 s41, s57, 77568
buffer_load_dwordx4 v9, s[20:23], s41 offen lds
s_mov_b32 m0, 149504
s_add_u32 s41, s57, 11264
buffer_load_dwordx4 v9, s[20:23], s41 offen lds
s_mov_b32 m0, 150528
s_add_u32 s41, s57, 16384
buffer_load_dwordx4 v9, s[20:23], s41 offen lds
s_mov_b32 m0, 157696
s_add_u32 s41, s57, 31744
buffer_load_dwordx4 v9, s[20:23], s41 offen lds
s_mov_b32 m0, 158720
s_add_u32 s41, s57, 36864
buffer_load_dwordx4 v9, s[20:23], s41 offen lds
ds_read_b64_tr_b16 a[216:217], v1 offset:0
ds_read_b64_tr_b16 a[218:219], v1 offset:1024
ds_read_b64_tr_b16 a[220:221], v1 offset:4096
ds_read_b64_tr_b16 a[222:223], v1 offset:5120
ds_read_b64_tr_b16 a[232:233], v1 offset:8192
ds_read_b64_tr_b16 a[234:235], v1 offset:9216
ds_read_b64_tr_b16 a[236:237], v1 offset:12288
ds_read_b64_tr_b16 a[238:239], v1 offset:13312
ds_read_b64_tr_b16 a[240:241], v1 offset:16384
ds_read_b64_tr_b16 a[242:243], v1 offset:17408
ds_read_b64_tr_b16 a[244:245], v1 offset:20480
ds_read_b64_tr_b16 a[246:247], v1 offset:21504
ds_read_b64_tr_b16 a[248:249], v1 offset:24576
ds_read_b64_tr_b16 a[250:251], v1 offset:25600
ds_read_b64_tr_b16 a[252:253], v1 offset:28672
ds_read_b64_tr_b16 a[254:255], v1 offset:29696
s_waitcnt lgkmcnt(0)
s_waitcnt vmcnt(26)
s_barrier
s_mov_b32 m0, 2048
s_add_u32 s41, s57, 52224
buffer_load_dwordx4 v9, s[20:23], s41 offen lds
s_mov_b32 m0, 3072
s_add_u32 s41, s57, 57344
buffer_load_dwordx4 v9, s[20:23], s41 offen lds
s_mov_b32 m0, 10240
s_add_u32 s41, s57, 72704
buffer_load_dwordx4 v9, s[20:23], s41 offen lds
s_mov_b32 m0, 11264
s_add_u32 s41, s57, 77824
buffer_load_dwordx4 v9, s[20:23], s41 offen lds
s_mov_b32 m0, 18432
s_add_u32 s41, s56, 131200
buffer_load_dwordx4 v8, s[12:15], s41 offen lds
s_mov_b32 m0, 19456
s_add_u32 s41, s56, 196736
buffer_load_dwordx4 v8, s[12:15], s41 offen lds
s_mov_b32 m0, 26624
s_add_u32 s41, s56, 655488
buffer_load_dwordx4 v8, s[12:15], s41 offen lds
s_mov_b32 m0, 27648
s_add_u32 s41, s56, 721024
buffer_load_dwordx4 v8, s[12:15], s41 offen lds
ds_read_b64_tr_b16 v[88:89], v1 offset:32768
ds_read_b64_tr_b16 v[90:91], v1 offset:33792
ds_read_b64_tr_b16 v[92:93], v1 offset:36864
ds_read_b64_tr_b16 v[94:95], v1 offset:37888
ds_read_b64_tr_b16 v[96:97], v1 offset:40960
ds_read_b64_tr_b16 v[98:99], v1 offset:41984
ds_read_b64_tr_b16 v[100:101], v1 offset:45056
ds_read_b64_tr_b16 v[102:103], v1 offset:46080
ds_read_b64_tr_b16 v[104:105], v1 offset:49152
ds_read_b64_tr_b16 v[106:107], v1 offset:50176
ds_read_b64_tr_b16 v[108:109], v1 offset:53248
ds_read_b64_tr_b16 v[110:111], v1 offset:54272
ds_read_b64_tr_b16 v[152:153], v5 offset:57344
ds_read_b64_tr_b16 v[154:155], v5 offset:57856
ds_read_b64_tr_b16 v[156:157], v5 offset:59392
ds_read_b64_tr_b16 v[158:159], v5 offset:59904
s_waitcnt lgkmcnt(0)
s_waitcnt vmcnt(24)
s_barrier
s_mov_b32 m0, 34816
s_add_u32 s41, s56, 2228352
buffer_load_dwordx4 v8, s[12:15], s41 offen lds
s_mov_b32 m0, 35840
s_add_u32 s41, s56, 2293888
buffer_load_dwordx4 v8, s[12:15], s41 offen lds
s_mov_b32 m0, 43008
s_add_u32 s41, s56, 3801216
buffer_load_dwordx4 v8, s[12:15], s41 offen lds
s_mov_b32 m0, 44032
s_add_u32 s41, s56, 3866752
buffer_load_dwordx4 v8, s[12:15], s41 offen lds
s_mov_b32 m0, 51200
s_add_u32 s41, s56, 1704064
buffer_load_dwordx4 v8, s[12:15], s41 offen lds
s_mov_b32 m0, 52224
s_add_u32 s41, s56, 1769600
buffer_load_dwordx4 v8, s[12:15], s41 offen lds
s_mov_b32 m0, 59392
s_add_u32 s41, s56, 2752640
buffer_load_dwordx4 v8, s[12:15], s41 offen lds
s_mov_b32 m0, 60416
s_add_u32 s41, s56, 2818176
buffer_load_dwordx4 v8, s[12:15], s41 offen lds
ds_read_b64_tr_b16 v[160:161], v6 offset:0
ds_read_b64_tr_b16 v[162:163], v6 offset:512
ds_read_b64_tr_b16 v[164:165], v6 offset:2048
ds_read_b64_tr_b16 v[166:167], v6 offset:2560
ds_read_b64_tr_b16 v[168:169], v6 offset:8192
ds_read_b64_tr_b16 v[170:171], v6 offset:8704
ds_read_b64_tr_b16 v[172:173], v6 offset:10240
ds_read_b64_tr_b16 v[174:175], v6 offset:10752
ds_read_b64_tr_b16 v[32:33], v6 offset:16384
ds_read_b64_tr_b16 v[34:35], v6 offset:16896
ds_read_b64_tr_b16 v[36:37], v6 offset:18432
ds_read_b64_tr_b16 v[38:39], v6 offset:18944
ds_read_b64_tr_b16 v[176:177], v6 offset:24576
ds_read_b64_tr_b16 v[178:179], v6 offset:25088
ds_read_b64_tr_b16 v[180:181], v6 offset:26624
ds_read_b64_tr_b16 v[182:183], v6 offset:27136
s_waitcnt lgkmcnt(0)
buffer_store_dwordx4 v[32:35], v0, s[4:7], s63 offen offset:0
buffer_store_dwordx4 v[36:39], v0, s[4:7], s63 offen offset:1024
s_waitcnt vmcnt(26)
s_barrier
s_mov_b32 m0, 67584
s_add_u32 s41, s56, 4325504
buffer_load_dwordx4 v8, s[12:15], s41 offen lds
s_mov_b32 m0, 68608
s_add_u32 s41, s56, 4391040
buffer_load_dwordx4 v8, s[12:15], s41 offen lds
s_mov_b32 m0, 75776
s_add_u32 s41, s56, 131200
buffer_load_dwordx4 v8, s[16:19], s41 offen lds
s_mov_b32 m0, 76800
s_add_u32 s41, s56, 196736
buffer_load_dwordx4 v8, s[16:19], s41 offen lds
s_mov_b32 m0, 83968
s_add_u32 s41, s56, 655488
buffer_load_dwordx4 v8, s[16:19], s41 offen lds
s_mov_b32 m0, 84992
s_add_u32 s41, s56, 721024
buffer_load_dwordx4 v8, s[16:19], s41 offen lds
s_mov_b32 m0, 92160
s_add_u32 s41, s56, 2228352
buffer_load_dwordx4 v8, s[16:19], s41 offen lds
s_mov_b32 m0, 93184
s_add_u32 s41, s56, 2293888
buffer_load_dwordx4 v8, s[16:19], s41 offen lds
ds_read_b64_tr_b16 v[184:185], v6 offset:32768
ds_read_b64_tr_b16 v[186:187], v6 offset:33280
ds_read_b64_tr_b16 v[188:189], v6 offset:34816
ds_read_b64_tr_b16 v[190:191], v6 offset:35328
ds_read_b64_tr_b16 v[192:193], v6 offset:40960
ds_read_b64_tr_b16 v[194:195], v6 offset:41472
ds_read_b64_tr_b16 v[196:197], v6 offset:43008
ds_read_b64_tr_b16 v[198:199], v6 offset:43520
ds_read_b64_tr_b16 v[224:225], v6 offset:49152
ds_read_b64_tr_b16 v[226:227], v6 offset:49664
ds_read_b64_tr_b16 v[228:229], v6 offset:51200
ds_read_b64_tr_b16 v[230:231], v6 offset:51712
ds_read_b64_tr_b16 v[200:201], v6 offset:57344
ds_read_b64_tr_b16 v[202:203], v6 offset:57856
ds_read_b64_tr_b16 v[204:205], v6 offset:59392
ds_read_b64_tr_b16 v[206:207], v6 offset:59904
s_waitcnt lgkmcnt(0)
s_waitcnt vmcnt(26)
s_barrier
s_mov_b32 m0, 100352
s_add_u32 s41, s56, 2752640
buffer_load_dwordx4 v8, s[16:19], s41 offen lds
s_mov_b32 m0, 101376
s_add_u32 s41, s56, 2818176
buffer_load_dwordx4 v8, s[16:19], s41 offen lds
s_mov_b32 m0, 108544
s_add_u32 s41, s56, 3801216
buffer_load_dwordx4 v8, s[16:19], s41 offen lds
s_mov_b32 m0, 109568
s_add_u32 s41, s56, 3866752
buffer_load_dwordx4 v8, s[16:19], s41 offen lds
s_mov_b32 m0, 116736
s_add_u32 s41, s56, 4325504
buffer_load_dwordx4 v8, s[16:19], s41 offen lds
s_mov_b32 m0, 117760
s_add_u32 s41, s56, 4391040
buffer_load_dwordx4 v8, s[16:19], s41 offen lds
s_mov_b32 m0, 124928
s_add_u32 s41, s57, 10240
buffer_load_dwordx4 v9, s[20:23], s41 offen lds
s_mov_b32 m0, 125952
s_add_u32 s41, s57, 15360
buffer_load_dwordx4 v9, s[20:23], s41 offen lds
ds_read_b64_tr_b16 v[208:209], v7 offset:0
ds_read_b64_tr_b16 v[210:211], v7 offset:512
ds_read_b64_tr_b16 v[212:213], v7 offset:2048
ds_read_b64_tr_b16 v[214:215], v7 offset:2560
ds_read_b64_tr_b16 v[216:217], v7 offset:8192
ds_read_b64_tr_b16 v[218:219], v7 offset:8704
ds_read_b64_tr_b16 v[220:221], v7 offset:10240
ds_read_b64_tr_b16 v[222:223], v7 offset:10752
ds_read_b64_tr_b16 v[32:33], v7 offset:16384
ds_read_b64_tr_b16 v[34:35], v7 offset:16896
ds_read_b64_tr_b16 v[36:37], v7 offset:18432
ds_read_b64_tr_b16 v[38:39], v7 offset:18944
ds_read_b64_tr_b16 v[232:233], v7 offset:24576
ds_read_b64_tr_b16 v[234:235], v7 offset:25088
ds_read_b64_tr_b16 v[236:237], v7 offset:26624
ds_read_b64_tr_b16 v[238:239], v7 offset:27136
s_waitcnt lgkmcnt(0)
buffer_store_dwordx4 v[32:35], v0, s[4:7], s63 offen offset:2048
buffer_store_dwordx4 v[36:39], v0, s[4:7], s63 offen offset:3072
s_waitcnt vmcnt(32)
s_barrier
s_mov_b32 m0, 133120
s_add_u32 s41, s57, 30720
buffer_load_dwordx4 v9, s[20:23], s41 offen lds
s_mov_b32 m0, 134144
s_add_u32 s41, s57, 35840
buffer_load_dwordx4 v9, s[20:23], s41 offen lds
s_mov_b32 m0, 141312
s_add_u32 s41, s57, 51200
buffer_load_dwordx4 v9, s[20:23], s41 offen lds
s_mov_b32 m0, 142336
s_add_u32 s41, s57, 56320
buffer_load_dwordx4 v9, s[20:23], s41 offen lds
s_mov_b32 m0, 149504
s_add_u32 s41, s57, 71680
buffer_load_dwordx4 v9, s[20:23], s41 offen lds
s_mov_b32 m0, 150528
s_add_u32 s41, s57, 76800
buffer_load_dwordx4 v9, s[20:23], s41 offen lds
s_mov_b32 m0, 157696
s_add_u32 s41, s57, 10496
buffer_load_dwordx4 v9, s[20:23], s41 offen lds
s_mov_b32 m0, 158720
s_add_u32 s41, s57, 15616
buffer_load_dwordx4 v9, s[20:23], s41 offen lds
ds_read_b64_tr_b16 v[240:241], v5 offset:0
ds_read_b64_tr_b16 v[242:243], v5 offset:512
ds_read_b64_tr_b16 v[244:245], v5 offset:2048
ds_read_b64_tr_b16 v[246:247], v5 offset:2560
ds_read_b64_tr_b16 v[248:249], v5 offset:8192
ds_read_b64_tr_b16 v[250:251], v5 offset:8704
ds_read_b64_tr_b16 v[252:253], v5 offset:10240
ds_read_b64_tr_b16 v[254:255], v5 offset:10752
s_waitcnt lgkmcnt(0)
s_waitcnt vmcnt(20)
s_barrier
ds_read_b64_tr_b16 v[8:9], v1 offset:16384
ds_read_b64_tr_b16 v[10:11], v1 offset:17408
ds_read_b64_tr_b16 v[12:13], v1 offset:20480
ds_read_b64_tr_b16 v[14:15], v1 offset:21504
ds_read_b64_tr_b16 v[16:17], v1 offset:24576
ds_read_b64_tr_b16 v[18:19], v1 offset:25600
ds_read_b64_tr_b16 v[20:21], v1 offset:28672
ds_read_b64_tr_b16 v[22:23], v1 offset:29696
ds_read_b64_tr_b16 v[24:25], v1 offset:32768
ds_read_b64_tr_b16 v[26:27], v1 offset:33792
ds_read_b64_tr_b16 v[28:29], v1 offset:36864
ds_read_b64_tr_b16 v[30:31], v1 offset:37888
ds_read_b64_tr_b16 v[32:33], v1 offset:40960
ds_read_b64_tr_b16 v[34:35], v1 offset:41984
ds_read_b64_tr_b16 v[36:37], v1 offset:45056
ds_read_b64_tr_b16 v[38:39], v1 offset:46080
ds_read_b64_tr_b16 v[40:41], v1 offset:49152
ds_read_b64_tr_b16 v[42:43], v1 offset:50176
ds_read_b64_tr_b16 v[44:45], v1 offset:53248
ds_read_b64_tr_b16 v[46:47], v1 offset:54272
ds_read_b64_tr_b16 v[48:49], v1 offset:57344
ds_read_b64_tr_b16 v[50:51], v1 offset:58368
ds_read_b64_tr_b16 v[52:53], v1 offset:61440
ds_read_b64_tr_b16 v[54:55], v1 offset:62464
ds_read_b64_tr_b16 v[56:57], v2 offset:0
ds_read_b64_tr_b16 v[58:59], v2 offset:1024
ds_read_b64_tr_b16 v[60:61], v2 offset:4096
ds_read_b64_tr_b16 v[62:63], v2 offset:5120
ds_read_b64_tr_b16 v[64:65], v2 offset:8192
ds_read_b64_tr_b16 v[66:67], v2 offset:9216
ds_read_b64_tr_b16 v[68:69], v2 offset:12288
ds_read_b64_tr_b16 v[70:71], v2 offset:13312
ds_read_b64_tr_b16 v[72:73], v2 offset:16384
ds_read_b64_tr_b16 v[74:75], v2 offset:17408
ds_read_b64_tr_b16 v[76:77], v2 offset:20480
ds_read_b64_tr_b16 v[78:79], v2 offset:21504
s_waitcnt lgkmcnt(0)
s_barrier
ds_write_b128 v0, v[8:11] offset:34816
ds_write_b128 v0, v[12:15] offset:35840
ds_write_b128 v0, a[168:171] offset:36864
ds_write_b128 v0, a[172:175] offset:37888
ds_write_b128 v0, v[24:27] offset:38912
ds_write_b128 v0, v[28:31] offset:39936
ds_write_b128 v0, v[32:35] offset:40960
ds_write_b128 v0, v[36:39] offset:41984
ds_write_b128 v0, a[96:99] offset:43008
ds_write_b128 v0, a[100:103] offset:44032
ds_write_b128 v0, v[48:51] offset:45056
ds_write_b128 v0, v[52:55] offset:46080
ds_write_b128 v0, v[56:59] offset:47104
ds_write_b128 v0, v[60:63] offset:48128
ds_write_b128 v0, v[64:67] offset:49152
ds_write_b128 v0, v[68:71] offset:50176
ds_write_b128 v0, v[128:131] offset:51200
ds_write_b128 v0, v[132:135] offset:52224
s_waitcnt lgkmcnt(0)
v_accvgpr_write_b32 a168, v16
v_accvgpr_write_b32 a169, v17
v_accvgpr_write_b32 a170, v18
v_accvgpr_write_b32 a171, v19
v_accvgpr_write_b32 a172, v20
v_accvgpr_write_b32 a173, v21
v_accvgpr_write_b32 a174, v22
v_accvgpr_write_b32 a175, v23
v_accvgpr_write_b32 a96, v40
v_accvgpr_write_b32 a97, v41
v_accvgpr_write_b32 a98, v42
v_accvgpr_write_b32 a99, v43
v_accvgpr_write_b32 a100, v44
v_accvgpr_write_b32 a101, v45
v_accvgpr_write_b32 a102, v46
v_accvgpr_write_b32 a103, v47
v_mov_b32 v128, v72
v_mov_b32 v129, v73
v_mov_b32 v130, v74
v_mov_b32 v131, v75
v_mov_b32 v132, v76
v_mov_b32 v133, v77
v_mov_b32 v134, v78
v_mov_b32 v135, v79
s_waitcnt vmcnt(0)
s_barrier
ds_read_b64_tr_b16 v[8:9], v2 offset:24576
ds_read_b64_tr_b16 v[10:11], v2 offset:25600
ds_read_b64_tr_b16 v[12:13], v2 offset:28672
ds_read_b64_tr_b16 v[14:15], v2 offset:29696
ds_read_b64_tr_b16 v[16:17], v2 offset:32768
ds_read_b64_tr_b16 v[18:19], v2 offset:33792
ds_read_b64_tr_b16 v[20:21], v2 offset:36864
ds_read_b64_tr_b16 v[22:23], v2 offset:37888
ds_read_b64_tr_b16 v[24:25], v2 offset:40960
ds_read_b64_tr_b16 v[26:27], v2 offset:41984
ds_read_b64_tr_b16 v[28:29], v2 offset:45056
ds_read_b64_tr_b16 v[30:31], v2 offset:46080
ds_read_b64_tr_b16 v[32:33], v2 offset:49152
ds_read_b64_tr_b16 v[34:35], v2 offset:50176
ds_read_b64_tr_b16 v[36:37], v2 offset:53248
ds_read_b64_tr_b16 v[38:39], v2 offset:54272
ds_read_b64_tr_b16 v[40:41], v6 offset:57344
ds_read_b64_tr_b16 v[42:43], v6 offset:57856
ds_read_b64_tr_b16 v[44:45], v6 offset:59392
ds_read_b64_tr_b16 v[46:47], v6 offset:59904
ds_read_b64_tr_b16 v[48:49], v7 offset:0
ds_read_b64_tr_b16 v[50:51], v7 offset:512
ds_read_b64_tr_b16 v[52:53], v7 offset:2048
ds_read_b64_tr_b16 v[54:55], v7 offset:2560
ds_read_b64_tr_b16 v[56:57], v7 offset:8192
ds_read_b64_tr_b16 v[58:59], v7 offset:8704
ds_read_b64_tr_b16 v[60:61], v7 offset:10240
ds_read_b64_tr_b16 v[62:63], v7 offset:10752
ds_read_b64_tr_b16 v[64:65], v7 offset:16384
ds_read_b64_tr_b16 v[66:67], v7 offset:16896
ds_read_b64_tr_b16 v[68:69], v7 offset:18432
ds_read_b64_tr_b16 v[70:71], v7 offset:18944
ds_read_b64_tr_b16 v[72:73], v7 offset:24576
ds_read_b64_tr_b16 v[74:75], v7 offset:25088
ds_read_b64_tr_b16 v[76:77], v7 offset:26624
ds_read_b64_tr_b16 v[78:79], v7 offset:27136
s_waitcnt lgkmcnt(0)
s_barrier
ds_write_b128 v4, v[8:11] offset:47104
ds_write_b128 v4, v[12:15] offset:48128
ds_write_b128 v4, a[224:227] offset:49152
ds_write_b128 v4, a[228:231] offset:50176
ds_write_b128 v4, v[80:83] offset:51200
ds_write_b128 v4, v[84:87] offset:52224
ds_write_b128 v4, v[32:35] offset:53248
ds_write_b128 v4, v[36:39] offset:54272
ds_write_b128 v4, v[40:43] offset:55296
ds_write_b128 v4, v[44:47] offset:56320
ds_write_b128 v4, v[48:51] offset:57344
ds_write_b128 v4, v[52:55] offset:58368
ds_write_b128 v4, v[144:147] offset:59392
ds_write_b128 v4, v[148:151] offset:60416
ds_write_b128 v4, v[152:155] offset:61440
ds_write_b128 v4, v[156:159] offset:62464
ds_write_b128 v4, v[72:75] offset:63488
ds_write_b128 v4, v[76:79] offset:64512
s_waitcnt lgkmcnt(0)
v_accvgpr_write_b32 a224, v16
v_accvgpr_write_b32 a225, v17
v_accvgpr_write_b32 a226, v18
v_accvgpr_write_b32 a227, v19
v_accvgpr_write_b32 a228, v20
v_accvgpr_write_b32 a229, v21
v_accvgpr_write_b32 a230, v22
v_accvgpr_write_b32 a231, v23
v_mov_b32 v80, v24
v_mov_b32 v81, v25
v_mov_b32 v82, v26
v_mov_b32 v83, v27
v_mov_b32 v84, v28
v_mov_b32 v85, v29
v_mov_b32 v86, v30
v_mov_b32 v87, v31
v_mov_b32 v144, v56
v_mov_b32 v145, v57
v_mov_b32 v146, v58
v_mov_b32 v147, v59
v_mov_b32 v148, v60
v_mov_b32 v149, v61
v_mov_b32 v150, v62
v_mov_b32 v151, v63
v_mov_b32 v152, v64
v_mov_b32 v153, v65
v_mov_b32 v154, v66
v_mov_b32 v155, v67
v_mov_b32 v156, v68
v_mov_b32 v157, v69
v_mov_b32 v158, v70
v_mov_b32 v159, v71
v_lshrrev_b32 v8, 4, v0
v_and_b32 v9, 8, v8
v_cmp_ne_u32 s[42:43], 0, v9
v_and_b32 v9, 1, v8
v_cmp_ne_u32 s[44:45], 0, v9
v_bfe_u32 v9, v8, 1, 2
v_cmp_eq_u32 s[46:47], 0, v9
v_cmp_eq_u32 s[48:49], 1, v9
v_cmp_eq_u32 s[50:51], 2, v9
v_cmp_eq_u32 s[52:53], 3, v9
v_mov_b32 v1, 0x4444
v_mov_b32 v10, 0xeeee
v_cndmask_b32 v1, v1, v10, s[42:43]
v_mov_b32 v10, 0x3f80
v_cndmask_b32 v10, v10, 1.0, s[44:45]
v_bfe_u32 v11, v8, 4, 1
v_lshlrev_b32 v11, 1, v11
v_sub_u32 v9, v9, v11
v_cmp_eq_u32 vcc, 0, v9
s_nop 1
v_cndmask_b32 v2, 0, v10, vcc
v_cmp_eq_u32 vcc, 1, v9
s_nop 1
v_cndmask_b32 v3, 0, v10, vcc
v_lshrrev_b32 v9, 4, v8
v_and_b32 v10, 15, v8
v_lshlrev_b32 v10, 3, v10
v_lshl_add_u32 v5, v9, 12, v10
v_lshlrev_b32 v6, 2, v9
v_and_b32 v10, 3, v8
v_lshl_add_u32 v6, v10, 4, v6
v_bfe_u32 v10, v8, 2, 1
v_lshl_add_u32 v6, v10, 7, v6
v_and_b32 v7, 511, v0
s_mov_b32 s54, 0x3e0293ee
s_cmp_lg_u32 s3, 0
s_cbranch_scc1 k_wdd_145
v_mov_b32 v8, 192
k_wd_144:
global_load_dword v9, v8, s[28:29] sc1
s_waitcnt vmcnt(0)
v_readfirstlane_b32 s41, v9
s_cmp_ge_u32 s41, 32
s_cbranch_scc1 k_wdd_145
s_sleep 2
s_sub_u32 s32, s32, 1
s_cmp_gt_i32 s32, 0
s_cbranch_scc1 k_wd_144
k_wdd_145:
s_barrier
s_mov_b32 s68, 0
s_mov_b32 s31, 0
s_mov_b32 s33, 117443584
s_mov_b32 s34, 117440512
s_lshl_b32 s35, s30, 14
s_add_u32 s35, s35, 4096
s_lshl_b32 s40, s30, 13
s_add_u32 s40, s40, 83888128
s_lshl_b32 s36, s30, 7
s_add_u32 s36, s36, 119554048
s_mov_b32 s55, 327680
s_add_u32 s41, s30, 32
s_lshl_b32 s37, s41, 12
s_add_u32 s37, s37, 119537664
s_add_u32 s59, s37, 327680
s_lshr_b32 s56, s41, 1
s_and_b32 s41, s41, 1
s_lshl_b32 s38, s56, 8
s_lshl_b32 s57, s41, 6
s_add_u32 s38, s38, s57
s_add_u32 s38, s38, 117440512
s_mul_i32 s41, s41, 5120
s_lshl_b32 s56, s56, 5
s_add_u32 s41, s41, s56
v_lshrrev_b32 v8, 4, v0
v_and_b32 v9, 3, v8
v_mul_u32_u24 v9, 1280, v9
v_bfe_u32 v10, v8, 2, 1
v_lshl_add_u32 v9, v10, 1, v9
v_bfe_u32 v10, v8, 4, 1
v_lshl_add_u32 v9, v10, 4, v9
v_bfe_u32 v10, v8, 5, 1
v_lshl_add_u32 v9, v10, 2, v9
buffer_load_ushort v10, v9, s[24:27], s41 offen
buffer_load_ushort v11, v9, s[24:27], s41 offen offset:8
v_mov_b64 v[12:13], -1
v_mov_b64 v[14:15], -1
s_waitcnt vmcnt(0)
v_lshl_or_b32 v10, v11, 16, v10
buffer_store_dword v10, v6, s[4:7], s38 offen
s_add_u32 s38, s38, 10240
buffer_store_dword v12, v6, s[4:7], s38 offen
s_add_u32 s58, s38, 10240
buffer_store_dwordx4 v[12:15], v0, s[4:7], s37 offen offset:0
buffer_store_dwordx4 v[12:15], v0, s[4:7], s37 offen offset:1024
buffer_store_dwordx4 v[12:15], v0, s[4:7], s37 offen offset:2048
buffer_store_dwordx4 v[12:15], v0, s[4:7], s37 offen offset:3072
k_nored_146:
s_waitcnt vmcnt(0)
s_barrier
s_barrier
buffer_load_dwordx4 v[40:43], v0, s[4:7], s60 offen offset:0
buffer_load_dwordx4 v[44:47], v0, s[4:7], s60 offen offset:1024
buffer_load_dwordx4 v[48:51], v0, s[4:7], s60 offen offset:2048
buffer_load_dwordx4 v[52:55], v0, s[4:7], s60 offen offset:3072
buffer_load_dwordx4 v[64:67], v0, s[4:7], s61 offen offset:0
buffer_load_dwordx4 v[68:71], v0, s[4:7], s61 offen offset:1024
buffer_load_dwordx4 v[72:75], v0, s[4:7], s61 offen offset:2048
buffer_load_dwordx4 v[76:79], v0, s[4:7], s61 offen offset:3072
buffer_load_dwordx4 v[56:59], v0, s[4:7], s62 offen offset:0
buffer_load_dwordx4 v[60:63], v0, s[4:7], s62 offen offset:1024
v_mov_b64 v[24:25], 0
v_mov_b64 v[26:27], 0
v_mov_b64 v[28:29], 0
v_mov_b64 v[30:31], 0
v_mov_b64 v[32:33], 0
v_mov_b64 v[34:35], 0
v_mov_b64 v[36:37], 0
v_mov_b64 v[38:39], 0
k_top_147:
s_add_u32 s41, s31, 0
s_cmp_gt_u32 s68, s41
s_cbranch_scc1 k_cd_156
s_lshl_b32 s56, s30, 6
s_add_u32 s56, s56, 222330880
k_ck_155:
buffer_load_dwordx2 v[8:9], off, s[4:7], s56 sc1
s_waitcnt vmcnt(0)
v_min_u32 v8, v8, v9
s_nop 0
v_readfirstlane_b32 s68, v8
s_cmp_gt_u32 s68, s41
s_cbranch_scc1 k_cd_156
s_sub_u32 s32, s32, 1
s_cmp_gt_i32 s32, 0
s_cbranch_scc1 k_ck_155
k_cd_156:
k_poll2_148:
buffer_load_dwordx4 v[12:15], v0, s[4:7], s33 offen offset:0 sc1
buffer_load_dwordx4 v[16:19], v0, s[4:7], s33 offen offset:1024 sc1
buffer_load_dwordx4 v[20:23], v0, s[4:7], s33 offen offset:2048 sc1
s_waitcnt vmcnt(2)
v_max3_u32 v8, v12, v13, v14
v_max_u32 v8, v8, v15
s_waitcnt vmcnt(1)
v_max3_u32 v8, v8, v16, v17
v_max3_u32 v8, v8, v18, v19
s_waitcnt vmcnt(0)
v_max3_u32 v8, v8, v20, v21
v_max3_u32 v8, v8, v22, v23
v_cmp_eq_u32 vcc, -1, v8
s_cbranch_vccnz k_retry2_149
k_poll2_148_ok:
ds_write_b128 v0, v[12:15] offset:3072
v_smfmac_f32_16x16x64_bf16 v[24:27], v[16:19], v[64:71], v1
ds_write_b128 v0, v[16:19] offset:4096
v_smfmac_f32_16x16x64_bf16 v[28:31], v[16:19], v[72:79], v1
ds_write_b128 v0, v[20:23] offset:5120
v_smfmac_f32_16x16x64_bf16 v[24:27], v[12:15], v[40:47], v1
ds_read_b128 v[64:67], v0 offset:38912
v_smfmac_f32_16x16x64_bf16 v[28:31], v[12:15], v[48:55], v1
ds_read_b128 v[68:71], v0 offset:39936
v_smfmac_f32_16x16x64_bf16 v[24:27], v[20:23], v[56:63], v1
ds_read_b128 v[72:75], v0 offset:45056
v_smfmac_f32_16x16x64_bf16 v[28:31], v[20:23], a[0:7], v1
ds_read_b128 v[76:79], v0 offset:46080
v_smfmac_f32_16x16x64_bf16 v[32:35], v[12:15], a[88:95], v1
buffer_load_dwordx4 v[40:43], v0, s[4:7], s62 offen offset:2048
v_smfmac_f32_16x16x64_bf16 v[36:39], v[12:15], a[96:103], v1
buffer_load_dwordx4 v[44:47], v0, s[4:7], s62 offen offset:3072
s_waitcnt lgkmcnt(4)
s_barrier
ds_read_b128 v[8:11], v0 offset:6144
v_smfmac_f32_16x16x64_bf16 v[32:35], v[16:19], a[104:111], v1
s_waitcnt lgkmcnt(3)
ds_read_b128 v[12:15], v0 offset:7168
v_smfmac_f32_16x16x64_bf16 v[36:39], v[16:19], v[64:71], v1
ds_read_b128 v[16:19], v0 offset:8192
buffer_load_dwordx4 v[48:51], v0, s[4:7], s35 offen offset:0 sc1
v_smfmac_f32_16x16x64_bf16 v[32:35], v[20:23], a[112:119], v1
s_waitcnt lgkmcnt(3)
buffer_load_dwordx4 v[52:55], v0, s[4:7], s35 offen offset:1024 sc1
ds_read_b128 v[64:67], v0 offset:36864
v_smfmac_f32_16x16x64_bf16 v[36:39], v[20:23], v[72:79], v1
s_waitcnt lgkmcnt(3)
ds_read_b128 v[68:71], v0 offset:37888
ds_read_b128 v[20:23], v0 offset:9216
v_smfmac_f32_16x16x64_bf16 v[24:27], v[8:11], a[8:15], v1
ds_read_b128 v[72:75], v0 offset:43008
v_smfmac_f32_16x16x64_bf16 v[28:31], v[8:11], a[16:23], v1
s_waitcnt lgkmcnt(5)
ds_read_b128 v[8:11], v0 offset:0
v_smfmac_f32_16x16x64_bf16 v[24:27], v[12:15], a[24:31], v1
s_waitcnt lgkmcnt(3)
ds_read_b128 v[76:79], v0 offset:44032
v_smfmac_f32_16x16x64_bf16 v[28:31], v[12:15], v[64:71], v1
ds_read_b128 v[12:15], v0 offset:1024
v_smfmac_f32_16x16x64_bf16 v[24:27], v[16:19], a[32:39], v1
ds_read_b128 v[64:67], v0 offset:51200
v_smfmac_f32_16x16x64_bf16 v[28:31], v[16:19], a[40:47], v1
s_waitcnt lgkmcnt(2)
ds_read_b128 v[16:19], v0 offset:2048
v_smfmac_f32_16x16x64_bf16 v[24:27], v[20:23], v[72:79], v1
ds_read_b128 v[68:71], v0 offset:52224
v_smfmac_f32_16x16x64_bf16 v[28:31], v[20:23], a[48:55], v1
buffer_load_dwordx4 v[56:59], v0, s[4:7], s35 offen offset:2048 sc1
v_smfmac_f32_16x16x64_bf16 v[24:27], v[8:11], a[56:63], v1
s_waitcnt lgkmcnt(0)
buffer_load_dwordx4 v[60:63], v0, s[4:7], s35 offen offset:3072 sc1
v_smfmac_f32_16x16x64_bf16 v[28:31], v[8:11], v[64:71], v1
ds_read_b128 v[72:75], v4 offset:49152
v_smfmac_f32_16x16x64_bf16 v[24:27], v[12:15], a[64:71], v1
ds_read_b128 v[76:79], v4 offset:50176
v_smfmac_f32_16x16x64_bf16 v[28:31], v[12:15], a[72:79], v1
s_waitcnt lgkmcnt(0)
ds_read_b128 v[64:67], v4 offset:51200
v_smfmac_f32_16x16x64_bf16 v[24:27], v[16:19], v[72:79], v1
ds_read_b128 v[68:71], v4 offset:52224
v_smfmac_f32_16x16x64_bf16 v[28:31], v[16:19], a[80:87], v1
ds_read_b128 v[72:75], v0 offset:34816
v_smfmac_f32_16x16x64_bf16 v[32:35], v[16:19], a[176:183], v1
ds_read_b128 v[76:79], v0 offset:35840
v_smfmac_f32_16x16x64_bf16 v[36:39], v[16:19], a[184:191], v1
s_waitcnt lgkmcnt(2)
ds_read_b128 v[16:19], v0 offset:8192
v_cvt_pk_bf16_f32 v24, v24, v25
v_smfmac_f32_16x16x64_bf16 v[32:35], v[12:15], v[64:71], v1
ds_read_b128 v[64:67], v0 offset:47104
v_cvt_pk_bf16_f32 v25, v26, v27
v_smfmac_f32_16x16x64_bf16 v[36:39], v[12:15], a[168:175], v1
ds_read_b128 v[68:71], v0 offset:48128
v_cvt_pk_bf16_f32 v28, v28, v29
v_mfma_f32_16x16x16_bf16 v[24:27], v[24:25], v[2:3], 0
ds_read_b128 v[12:15], v0 offset:7168
v_cvt_pk_bf16_f32 v29, v30, v31
v_smfmac_f32_16x16x64_bf16 v[32:35], v[8:11], a[160:167], v1
v_mfma_f32_16x16x16_bf16 v[28:31], v[28:29], v[2:3], 0
s_waitcnt lgkmcnt(4)
v_smfmac_f32_16x16x64_bf16 v[36:39], v[8:11], v[72:79], v1
s_waitcnt vmcnt(4)
ds_read_b128 v[72:75], v0 offset:40960
v_cvt_pk_bf16_f32 v24, v24, v25
v_smfmac_f32_16x16x64_bf16 v[32:35], v[20:23], v[40:47], v1
ds_read_b128 v[76:79], v0 offset:41984
v_cvt_pk_bf16_f32 v25, v26, v27
v_smfmac_f32_16x16x64_bf16 v[36:39], v[20:23], a[152:159], v1
ds_read_b128 v[20:23], v0 offset:6144
v_cvt_pk_bf16_f32 v26, v28, v29
v_cvt_pk_bf16_f32 v27, v30, v31
s_waitcnt lgkmcnt(6)
v_smfmac_f32_16x16x64_bf16 v[32:35], v[16:19], a[144:151], v1
s_waitcnt vmcnt(3)
v_mov_b64 v[40:41], -1
v_mfma_f32_16x16x32_bf16 v[28:31], v[48:51], v[24:27], 0
s_waitcnt vmcnt(2)
v_mov_b64 v[42:43], -1
v_mfma_f32_16x16x32_bf16 v[8:11], v[52:55], v[24:27], 0
buffer_store_dwordx4 v[40:43], v0, s[4:7], s59 offen offset:0
buffer_store_dwordx4 v[40:43], v0, s[4:7], s59 offen offset:1024
buffer_store_dwordx4 v[40:43], v0, s[4:7], s59 offen offset:2048
buffer_store_dwordx4 v[40:43], v0, s[4:7], s59 offen offset:3072
buffer_store_dword v40, v6, s[4:7], s58 offen
s_waitcnt lgkmcnt(4)
v_smfmac_f32_16x16x64_bf16 v[36:39], v[16:19], v[64:71], v1
s_waitcnt lgkmcnt(3)
ds_read_b128 v[64:67], v4 offset:53248
v_mov_b64 v[44:45], 0
v_smfmac_f32_16x16x64_bf16 v[32:35], v[12:15], a[136:143], v1
s_waitcnt lgkmcnt(2)
ds_read_b128 v[68:71], v4 offset:54272
v_mov_b64 v[46:47], 0
v_smfmac_f32_16x16x64_bf16 v[36:39], v[12:15], v[72:79], v1
ds_read_b128 v[72:75], v0 offset:49152
v_cndmask_b32 v28, v28, v8, s[42:43]
v_cndmask_b32 v29, v29, v9, s[42:43]
s_waitcnt lgkmcnt(3)
v_smfmac_f32_16x16x64_bf16 v[32:35], v[20:23], a[120:127], v1
ds_read_b128 v[76:79], v0 offset:50176
v_cndmask_b32 v30, v30, v10, s[42:43]
v_cndmask_b32 v31, v31, v11, s[42:43]
v_smfmac_f32_16x16x64_bf16 v[36:39], v[20:23], a[128:135], v1
ds_write_b128 v0, v[28:31] offset:11264
v_mov_b64 v[40:41], 0
v_mov_b64 v[42:43], 0
v_smfmac_f32_16x16x64_bf16 v[44:47], v[20:23], a[240:247], v1
v_cvt_pk_bf16_f32 v32, v32, v33
v_cvt_pk_bf16_f32 v33, v34, v35
v_smfmac_f32_16x16x64_bf16 v[40:43], v[20:23], a[232:239], v1
ds_read_b128 v[20:23], v0 offset:9216
v_mfma_f32_16x16x16_bf16 v[32:35], v[32:33], v[2:3], 0
v_cvt_pk_bf16_f32 v36, v36, v37
v_cvt_pk_bf16_f32 v37, v38, v39
s_waitcnt lgkmcnt(0)
s_barrier
v_mfma_f32_16x16x16_bf16 v[36:39], v[36:37], v[2:3], 0
ds_read_b128 v[48:51], v0 offset:12288
v_smfmac_f32_16x16x64_bf16 v[40:43], v[12:15], a[248:255], v1
ds_read_b128 v[52:55], v0 offset:13312
v_cvt_pk_bf16_f32 v32, v32, v33
v_cvt_pk_bf16_f32 v33, v34, v35
v_smfmac_f32_16x16x64_bf16 v[44:47], v[12:15], v[80:87], v1
ds_read_b128 v[12:15], v0 offset:0
v_cvt_pk_bf16_f32 v34, v36, v37
v_cvt_pk_bf16_f32 v35, v38, v39
s_nop 1
v_mfma_f32_16x16x32_bf16 v[36:39], v[32:35], v[24:27], 0
ds_read_b128 v[8:11], v0 offset:10240
v_smfmac_f32_16x16x64_bf16 v[40:43], v[16:19], v[88:95], v1
buffer_store_dwordx4 v[32:35], v0, s[4:7], s40 offen sc1
s_waitcnt lgkmcnt(3)
v_add_f32 v28, v28, v48
v_add_f32 v29, v29, v49
v_smfmac_f32_16x16x64_bf16 v[44:47], v[16:19], v[64:71], v1
ds_write_b128 v7, v[36:39] offset:14848
v_smfmac_f32_16x16x64_bf16 v[40:43], v[20:23], v[96:103], v1
ds_read_b128 v[16:19], v0 offset:1024
v_add_f32 v30, v30, v50
v_add_f32 v31, v31, v51
v_smfmac_f32_16x16x64_bf16 v[44:47], v[20:23], v[104:111], v1
ds_read_b128 v[20:23], v0 offset:2048
s_waitcnt lgkmcnt(5)
v_add_f32 v28, v28, v52
v_add_f32 v29, v29, v53
s_waitcnt lgkmcnt(4)
v_smfmac_f32_16x16x64_bf16 v[40:43], v[12:15], v[112:119], v1
ds_read_b128 v[64:67], v4 offset:59392
v_add_f32 v30, v30, v54
v_add_f32 v31, v31, v55
v_smfmac_f32_16x16x64_bf16 v[44:47], v[12:15], v[72:79], v1
ds_read_b128 v[12:15], v0 offset:3072
s_waitcnt lgkmcnt(5)
v_add_f32 v28, v28, v8
v_add_f32 v29, v29, v9
s_waitcnt lgkmcnt(3)
v_smfmac_f32_16x16x64_bf16 v[40:43], v[16:19], v[120:127], v1
ds_read_b128 v[68:71], v4 offset:60416
v_add_f32 v30, v30, v10
v_add_f32 v31, v31, v11
s_waitcnt lgkmcnt(0)
s_barrier
ds_read_b128 v[48:51], v7 offset:15360
ds_read_b128 v[52:55], v7 offset:15872
ds_read_b128 v[8:11], v7 offset:14336
v_smfmac_f32_16x16x64_bf16 v[44:47], v[16:19], v[128:135], v1
ds_read_b128 v[16:19], v0 offset:4096
v_max3_f32 v24, v28, v29, v30
v_smfmac_f32_16x16x64_bf16 v[40:43], v[20:23], v[136:143], v1
ds_read_b128 v[72:75], v4 offset:47104
v_max_f32 v24, v24, v31
v_smfmac_f32_16x16x64_bf16 v[44:47], v[20:23], v[64:71], v1
ds_read_b128 v[20:23], v0 offset:5120
v_max_f32_dpp v24, v24, v24 row_ror:8 row_mask:0xf bank_mask:0xf
v_smfmac_f32_16x16x64_bf16 v[40:43], v[12:15], a[192:199], v1
ds_read_b128 v[76:79], v4 offset:48128
v_mov_b32 v25, v24
v_smfmac_f32_16x16x64_bf16 v[44:47], v[12:15], a[200:207], v1
s_waitcnt lgkmcnt(3)
ds_read_b128 v[64:67], v4 offset:57344
v_permlane32_swap_b32 v24, v25
v_smfmac_f32_16x16x64_bf16 v[40:43], v[16:19], a[208:215], v1
s_waitcnt lgkmcnt(1)
ds_read_b128 v[68:71], v4 offset:58368
v_max_f32 v24, v24, v25
v_smfmac_f32_16x16x64_bf16 v[44:47], v[16:19], v[72:79], v1
ds_read_b128 v[72:75], v4 offset:61440
v_smfmac_f32_16x16x64_bf16 v[40:43], v[20:23], a[216:223], v1
ds_read_b128 v[76:79], v4 offset:62464
v_smfmac_f32_16x16x64_bf16 v[44:47], v[20:23], a[224:231], v1
v_add_f32 v36, v36, v48
v_add_f32 v37, v37, v49
v_add_f32 v38, v38, v50
v_add_f32 v39, v39, v51
v_add_f32 v36, v36, v52
v_add_f32 v37, v37, v53
v_add_f32 v38, v38, v54
v_add_f32 v39, v39, v55
v_add_f32 v36, v36, v8
v_add_f32 v37, v37, v9
v_add_f32 v38, v38, v10
v_add_f32 v39, v39, v11
buffer_load_dwordx4 v[48:51], v0, s[4:7], s63 offen offset:0
buffer_load_dwordx4 v[52:55], v0, s[4:7], s63 offen offset:1024
v_max3_f32 v24, v24, v36, v37
v_max3_f32 v24, v24, v38, v39
v_mov_b32 v25, v24
v_cvt_pk_bf16_f32 v40, v40, v41
v_cvt_pk_bf16_f32 v41, v42, v43
v_permlane16_swap_b32 v24, v25
v_max_f32 v24, v24, v25
v_mul_f32 v24, s54, v24
v_fma_f32 v28, v28, s54, -v24
v_exp_f32 v28, v28
v_fma_f32 v29, v29, s54, -v24
v_exp_f32 v29, v29
v_fma_f32 v30, v30, s54, -v24
v_exp_f32 v30, v30
v_fma_f32 v31, v31, s54, -v24
v_exp_f32 v31, v31
v_fma_f32 v36, v36, s54, -v24
v_exp_f32 v36, v36
v_fma_f32 v37, v37, s54, -v24
v_exp_f32 v37, v37
v_fma_f32 v38, v38, s54, -v24
v_exp_f32 v38, v38
v_fma_f32 v39, v39, s54, -v24
v_exp_f32 v39, v39
v_cvt_pk_bf16_f32 v24, v28, v29
v_cvt_pk_bf16_f32 v25, v30, v31
v_cvt_pk_bf16_f32 v26, v28, v29
v_cvt_pk_bf16_f32 v27, v30, v31
v_cvt_pk_bf16_f32 v32, v36, v37
v_cvt_pk_bf16_f32 v33, v38, v39
v_mov_b32_dpp v24, v26 row_ror:8 row_mask:0xf bank_mask:0xc
v_mov_b32_dpp v25, v27 row_ror:8 row_mask:0xf bank_mask:0xc
v_mov_b32_dpp v26, v26 row_ror:8 row_mask:0xf bank_mask:0x3
v_mov_b32_dpp v27, v27 row_ror:8 row_mask:0xf bank_mask:0x3
v_cvt_pk_bf16_f32 v42, v44, v45
v_cvt_pk_bf16_f32 v43, v46, v47
v_mov_b32 v8, 0x40004000
v_mov_b32 v9, 0x40004000
v_mov_b32 v10, 0x40004000
v_mov_b32 v11, 0x40004000
v_mov_b32 v34, 0x3f803f80
v_mov_b32 v35, 0x3f803f80
buffer_store_dwordx4 v[40:43], v0, s[4:7], s40 offen offset:1024 sc1
s_cmp_eq_u32 s31, 63
s_cbranch_scc1 k_done_150
v_mfma_f32_16x16x32_bf16 v[20:23], v[8:11], v[24:27], 0
s_waitcnt vmcnt(10)
v_mov_b64 v[28:29], 0
v_mov_b64 v[30:31], 0
v_mfma_f32_16x16x32_bf16 v[12:15], v[56:59], v[24:27], 0
v_mov_b64 v[36:37], 0
v_mov_b64 v[38:39], 0
v_mfma_f32_16x16x16_bf16 v[20:23], v[34:35], v[32:33], v[20:23]
s_waitcnt vmcnt(9)
v_mov_b64 v[44:45], 0
v_mov_b64 v[46:47], 0
v_mfma_f32_16x16x32_bf16 v[16:19], v[60:63], v[24:27], 0
buffer_load_dwordx4 v[56:59], v0, s[4:7], s63 offen offset:2048
v_mov_b64 v[24:25], 0
v_mfma_f32_16x16x16_bf16 v[12:15], v[40:41], v[32:33], v[12:15]
buffer_load_dwordx4 v[60:63], v0, s[4:7], s63 offen offset:3072
v_rcp_f32 v20, v20
v_mfma_f32_16x16x16_bf16 v[16:19], v[42:43], v[32:33], v[16:19]
v_mov_b64 v[26:27], 0
s_nop 1
v_mul_f32 v12, v12, v20
v_mul_f32 v13, v13, v20
v_mul_f32 v14, v14, v20
v_mul_f32 v15, v15, v20
v_cvt_pk_bf16_f32 v8, v12, v13
v_cvt_pk_bf16_f32 v9, v14, v15
v_mul_f32 v16, v16, v20
v_mul_f32 v17, v17, v20
v_mul_f32 v18, v18, v20
v_mul_f32 v19, v19, v20
v_cvt_pk_bf16_f32 v10, v16, v17
v_cvt_pk_bf16_f32 v11, v18, v19
ds_write_b128 v0, v[8:11] offset:11264
s_waitcnt lgkmcnt(3)
v_smfmac_f32_16x16x64_bf16 v[44:47], v[8:11], v[64:71], v1
s_waitcnt lgkmcnt(1)
v_mov_b64 v[32:33], 0
v_smfmac_f32_16x16x64_bf16 v[28:31], v[8:11], v[72:79], v1
v_mov_b64 v[34:35], 0
v_smfmac_f32_16x16x64_bf16 v[36:39], v[8:11], v[176:183], v1
s_waitcnt lgkmcnt(0)
s_barrier
ds_read_b128 v[12:15], v0 offset:12288
v_smfmac_f32_16x16x64_bf16 v[24:27], v[8:11], v[200:207], v1
ds_read_b128 v[16:19], v0 offset:13312
ds_read_b128 v[20:23], v0 offset:10240
v_smfmac_f32_16x16x64_bf16 v[32:35], v[8:11], v[232:239], v1
ds_read_b128 v[64:67], v4 offset:55296
ds_read_b128 v[68:71], v4 offset:56320
ds_read_b128 v[72:75], v4 offset:63488
ds_read_b128 v[76:79], v4 offset:64512
s_mov_b32 s41, s36
s_waitcnt lgkmcnt(6)
v_smfmac_f32_16x16x64_bf16 v[44:47], v[12:15], v[144:151], v1
s_waitcnt lgkmcnt(5)
v_smfmac_f32_16x16x64_bf16 v[44:47], v[16:19], v[152:159], v1
s_waitcnt lgkmcnt(2)
v_smfmac_f32_16x16x64_bf16 v[44:47], v[20:23], v[64:71], v1
v_smfmac_f32_16x16x64_bf16 v[28:31], v[12:15], v[160:167], v1
buffer_load_dwordx4 v[64:67], v0, s[4:7], s61 offen offset:0
v_smfmac_f32_16x16x64_bf16 v[28:31], v[16:19], v[168:175], v1
buffer_load_dwordx4 v[68:71], v0, s[4:7], s61 offen offset:1024
v_cvt_pk_bf16_f32 v44, v44, v45
v_cvt_pk_bf16_f32 v45, v46, v47
buffer_store_dwordx2 v[44:45], v5, s[4:7], s41 offen
s_add_u32 s41, s41, 65536
s_waitcnt lgkmcnt(0)
v_smfmac_f32_16x16x64_bf16 v[28:31], v[20:23], v[72:79], v1
buffer_load_dwordx4 v[40:43], v0, s[4:7], s60 offen offset:0
v_smfmac_f32_16x16x64_bf16 v[36:39], v[12:15], v[184:191], v1
buffer_load_dwordx4 v[44:47], v0, s[4:7], s60 offen offset:1024
v_smfmac_f32_16x16x64_bf16 v[36:39], v[16:19], v[192:199], v1
buffer_load_dwordx4 v[72:75], v0, s[4:7], s61 offen offset:2048
v_cvt_pk_bf16_f32 v28, v28, v29
v_cvt_pk_bf16_f32 v29, v30, v31
buffer_store_dwordx2 v[28:29], v5, s[4:7], s41 offen
s_add_u32 s41, s41, 65536
s_waitcnt vmcnt(10)
v_smfmac_f32_16x16x64_bf16 v[36:39], v[20:23], v[48:55], v1
buffer_load_dwordx4 v[76:79], v0, s[4:7], s61 offen offset:3072
v_smfmac_f32_16x16x64_bf16 v[24:27], v[12:15], v[208:215], v1
buffer_load_dwordx4 v[48:51], v0, s[4:7], s60 offen offset:2048
v_smfmac_f32_16x16x64_bf16 v[24:27], v[16:19], v[216:223], v1
buffer_load_dwordx4 v[52:55], v0, s[4:7], s60 offen offset:3072
v_cvt_pk_bf16_f32 v36, v36, v37
v_cvt_pk_bf16_f32 v37, v38, v39
buffer_store_dwordx2 v[36:37], v5, s[4:7], s41 offen
s_add_u32 s41, s41, 65536
v_smfmac_f32_16x16x64_bf16 v[24:27], v[20:23], v[224:231], v1
v_smfmac_f32_16x16x64_bf16 v[32:35], v[12:15], v[240:247], v1
v_smfmac_f32_16x16x64_bf16 v[32:35], v[16:19], v[248:255], v1
v_cvt_pk_bf16_f32 v24, v24, v25
v_cvt_pk_bf16_f32 v25, v26, v27
buffer_store_dwordx2 v[24:25], v5, s[4:7], s41 offen
s_add_u32 s41, s41, 65536
s_waitcnt vmcnt(12)
v_smfmac_f32_16x16x64_bf16 v[32:35], v[20:23], v[56:63], v1
s_nop 6
v_cvt_pk_bf16_f32 v32, v32, v33
v_cvt_pk_bf16_f32 v33, v34, v35
buffer_store_dwordx2 v[32:33], v5, s[4:7], s41 offen
s_add_u32 s41, s41, 65536
buffer_load_dwordx4 v[56:59], v0, s[4:7], s62 offen offset:0
buffer_load_dwordx4 v[60:63], v0, s[4:7], s62 offen offset:1024
s_add_u32 s31, s31, 1
s_add_u32 s33, s33, 10240
s_add_u32 s34, s34, 10240
s_add_u32 s35, s35, 524288
s_add_u32 s40, s40, 262144
s_add_u32 s36, s36, s55
v_mov_b32 v28, 0x4000
v_cndmask_b32 v28, v28, 2.0, s[44:45]
v_cndmask_b32 v24, 0, v28, s[46:47]
v_cndmask_b32 v25, 0, v28, s[48:49]
v_cndmask_b32 v26, 0, v28, s[50:51]
v_cndmask_b32 v27, 0, v28, s[52:53]
k_poll1_151:
buffer_load_dwordx4 v[8:11], v0, s[4:7], s37 offen offset:0 sc1
buffer_load_dwordx4 v[12:15], v0, s[4:7], s37 offen offset:1024 sc1
buffer_load_dwordx4 v[16:19], v0, s[4:7], s37 offen offset:2048 sc1
buffer_load_dwordx4 v[20:23], v0, s[4:7], s37 offen offset:3072 sc1
s_waitcnt vmcnt(3)
v_mfma_f32_16x16x32_bf16 v[28:31], v[8:11], v[24:27], 0
s_waitcnt vmcnt(2)
v_mfma_f32_16x16x32_bf16 v[28:31], v[12:15], v[24:27], v[28:31]
s_waitcnt vmcnt(1)
v_mfma_f32_16x16x32_bf16 v[28:31], v[16:19], v[24:27], v[28:31]
s_waitcnt vmcnt(0)
v_mfma_f32_16x16x32_bf16 v[28:31], v[20:23], v[24:27], v[28:31]
s_nop 7
v_permlane32_swap_b32 v28, v29
v_permlane32_swap_b32 v30, v31
v_add_f32 v28, v28, v29
v_add_f32 v29, v30, v31
v_cmp_u_f32 vcc, v28, v29
v_cvt_pk_bf16_f32 v28, v28, v29
s_cbranch_vccnz k_retry1_152
k_poll1_151_ok:
buffer_store_dword v28, v6, s[4:7], s38 offen
s_mov_b32 s59, s37
s_add_u32 s37, s37, s55
s_add_u32 s38, s38, 10240
s_add_u32 s58, s58, 10240
k_nored_153:
s_sub_u32 s55, 0, s55
v_mov_b64 v[24:25], 0
v_mov_b64 v[26:27], 0
v_mov_b64 v[28:29], 0
v_mov_b64 v[30:31], 0
v_mov_b64 v[32:33], 0
v_mov_b64 v[34:35], 0
v_mov_b64 v[36:37], 0
v_mov_b64 v[38:39], 0
s_branch k_top_147
k_retry2_149:
s_add_u32 s75, s75, 1
s_sub_u32 s32, s32, 1
s_cmp_gt_i32 s32, 0
s_cbranch_scc1 k_poll2_148
s_branch k_poll2_148_ok
k_retry1_152:
s_add_u32 s76, s76, 1
s_sub_u32 s32, s32, 1
s_cmp_gt_i32 s32, 0
s_cbranch_scc1 k_poll1_151
s_branch k_poll1_151_ok
k_done_150:
s_mov_b32 s31, 0
s_mov_b32 s33, 118492160
s_mov_b32 s34, 118489088
s_lshl_b32 s35, s30, 14
s_add_u32 s35, s35, 41947136
s_lshl_b32 s40, s30, 13
s_add_u32 s40, s40, 100665344
s_lshl_b32 s36, s30, 7
s_add_u32 s36, s36, 119554048
s_mov_b32 s55, 327680
s_add_u32 s41, s30, 32
s_lshl_b32 s37, s41, 12
s_add_u32 s37, s37, 119537664
s_add_u32 s59, s37, 327680
s_lshr_b32 s56, s41, 1
s_and_b32 s41, s41, 1
s_lshl_b32 s38, s56, 8
s_lshl_b32 s57, s41, 6
s_add_u32 s38, s38, s57
s_add_u32 s38, s38, 118489088
s_mul_i32 s41, s41, 5120
s_lshl_b32 s56, s56, 5
s_add_u32 s41, s41, s56
v_lshrrev_b32 v8, 4, v0
v_and_b32 v9, 3, v8
v_mul_u32_u24 v9, 1280, v9
v_bfe_u32 v10, v8, 2, 1
v_lshl_add_u32 v9, v10, 1, v9
v_bfe_u32 v10, v8, 4, 1
v_lshl_add_u32 v9, v10, 4, v9
v_bfe_u32 v10, v8, 5, 1
v_lshl_add_u32 v9, v10, 2, v9
buffer_load_ushort v10, v9, s[24:27], s41 offen
buffer_load_ushort v11, v9, s[24:27], s41 offen offset:8
v_mov_b64 v[12:13], -1
v_mov_b64 v[14:15], -1
s_waitcnt vmcnt(0)
v_lshl_or_b32 v10, v11, 16, v10
buffer_store_dword v10, v6, s[4:7], s38 offen
s_add_u32 s38, s38, 10240
buffer_store_dword v12, v6, s[4:7], s38 offen
s_add_u32 s58, s38, 10240
buffer_store_dwordx4 v[12:15], v0, s[4:7], s37 offen offset:0
buffer_store_dwordx4 v[12:15], v0, s[4:7], s37 offen offset:1024
buffer_store_dwordx4 v[12:15], v0, s[4:7], s37 offen offset:2048
buffer_store_dwordx4 v[12:15], v0, s[4:7], s37 offen offset:3072
k_nored_157:
s_waitcnt vmcnt(0)
s_barrier
s_barrier
buffer_load_dwordx4 v[40:43], v0, s[4:7], s60 offen offset:0
buffer_load_dwordx4 v[44:47], v0, s[4:7], s60 offen offset:1024
buffer_load_dwordx4 v[48:51], v0, s[4:7], s60 offen offset:2048
buffer_load_dwordx4 v[52:55], v0, s[4:7], s60 offen offset:3072
s_waitcnt lgkmcnt(3)
buffer_load_dwordx4 v[64:67], v0, s[4:7], s61 offen offset:0
s_waitcnt lgkmcnt(2)
buffer_load_dwordx4 v[68:71], v0, s[4:7], s61 offen offset:1024
s_waitcnt lgkmcnt(1)
buffer_load_dwordx4 v[72:75], v0, s[4:7], s61 offen offset:2048
s_waitcnt lgkmcnt(0)
buffer_load_dwordx4 v[76:79], v0, s[4:7], s61 offen offset:3072
buffer_load_dwordx4 v[56:59], v0, s[4:7], s62 offen offset:0
buffer_load_dwordx4 v[60:63], v0, s[4:7], s62 offen offset:1024
v_mov_b64 v[24:25], 0
v_mov_b64 v[26:27], 0
v_mov_b64 v[28:29], 0
v_mov_b64 v[30:31], 0
v_mov_b64 v[32:33], 0
v_mov_b64 v[34:35], 0
v_mov_b64 v[36:37], 0
v_mov_b64 v[38:39], 0
k_top_158:
s_add_u32 s41, s31, 64
s_cmp_gt_u32 s68, s41
s_cbranch_scc1 k_cd_167
s_lshl_b32 s56, s30, 6
s_add_u32 s56, s56, 222330880
k_ck_166:
buffer_load_dwordx2 v[8:9], off, s[4:7], s56 sc1
s_waitcnt vmcnt(0)
v_min_u32 v8, v8, v9
s_nop 0
v_readfirstlane_b32 s68, v8
s_cmp_gt_u32 s68, s41
s_cbranch_scc1 k_cd_167
s_sub_u32 s32, s32, 1
s_cmp_gt_i32 s32, 0
s_cbranch_scc1 k_ck_166
k_cd_167:
k_poll2_159:
buffer_load_dwordx4 v[12:15], v0, s[4:7], s33 offen offset:0 sc1
buffer_load_dwordx4 v[16:19], v0, s[4:7], s33 offen offset:1024 sc1
buffer_load_dwordx4 v[20:23], v0, s[4:7], s33 offen offset:2048 sc1
s_waitcnt vmcnt(2)
v_max3_u32 v8, v12, v13, v14
v_max_u32 v8, v8, v15
s_waitcnt vmcnt(1)
v_max3_u32 v8, v8, v16, v17
v_max3_u32 v8, v8, v18, v19
s_waitcnt vmcnt(0)
v_max3_u32 v8, v8, v20, v21
v_max3_u32 v8, v8, v22, v23
v_cmp_eq_u32 vcc, -1, v8
s_cbranch_vccnz k_retry2_160
k_poll2_159_ok:
ds_write_b128 v0, v[12:15] offset:3072
v_smfmac_f32_16x16x64_bf16 v[24:27], v[16:19], v[64:71], v1
ds_write_b128 v0, v[16:19] offset:4096
v_smfmac_f32_16x16x64_bf16 v[28:31], v[16:19], v[72:79], v1
ds_write_b128 v0, v[20:23] offset:5120
v_smfmac_f32_16x16x64_bf16 v[24:27], v[12:15], v[40:47], v1
ds_read_b128 v[64:67], v0 offset:38912
v_smfmac_f32_16x16x64_bf16 v[28:31], v[12:15], v[48:55], v1
ds_read_b128 v[68:71], v0 offset:39936
v_smfmac_f32_16x16x64_bf16 v[24:27], v[20:23], v[56:63], v1
ds_read_b128 v[72:75], v0 offset:45056
v_smfmac_f32_16x16x64_bf16 v[28:31], v[20:23], a[0:7], v1
ds_read_b128 v[76:79], v0 offset:46080
v_smfmac_f32_16x16x64_bf16 v[32:35], v[12:15], a[88:95], v1
buffer_load_dwordx4 v[40:43], v0, s[4:7], s62 offen offset:2048
v_smfmac_f32_16x16x64_bf16 v[36:39], v[12:15], a[96:103], v1
buffer_load_dwordx4 v[44:47], v0, s[4:7], s62 offen offset:3072
s_waitcnt lgkmcnt(4)
s_barrier
ds_read_b128 v[8:11], v0 offset:6144
v_smfmac_f32_16x16x64_bf16 v[32:35], v[16:19], a[104:111], v1
s_waitcnt lgkmcnt(3)
ds_read_b128 v[12:15], v0 offset:7168
v_smfmac_f32_16x16x64_bf16 v[36:39], v[16:19], v[64:71], v1
ds_read_b128 v[16:19], v0 offset:8192
buffer_load_dwordx4 v[48:51], v0, s[4:7], s35 offen offset:0 sc1
v_smfmac_f32_16x16x64_bf16 v[32:35], v[20:23], a[112:119], v1
s_waitcnt lgkmcnt(3)
buffer_load_dwordx4 v[52:55], v0, s[4:7], s35 offen offset:1024 sc1
ds_read_b128 v[64:67], v0 offset:36864
v_smfmac_f32_16x16x64_bf16 v[36:39], v[20:23], v[72:79], v1
s_waitcnt lgkmcnt(3)
ds_read_b128 v[68:71], v0 offset:37888
ds_read_b128 v[20:23], v0 offset:9216
v_smfmac_f32_16x16x64_bf16 v[24:27], v[8:11], a[8:15], v1
ds_read_b128 v[72:75], v0 offset:43008
v_smfmac_f32_16x16x64_bf16 v[28:31], v[8:11], a[16:23], v1
s_waitcnt lgkmcnt(5)
ds_read_b128 v[8:11], v0 offset:0
v_smfmac_f32_16x16x64_bf16 v[24:27], v[12:15], a[24:31], v1
s_waitcnt lgkmcnt(3)
ds_read_b128 v[76:79], v0 offset:44032
v_smfmac_f32_16x16x64_bf16 v[28:31], v[12:15], v[64:71], v1
ds_read_b128 v[12:15], v0 offset:1024
v_smfmac_f32_16x16x64_bf16 v[24:27], v[16:19], a[32:39], v1
ds_read_b128 v[64:67], v0 offset:51200
v_smfmac_f32_16x16x64_bf16 v[28:31], v[16:19], a[40:47], v1
s_waitcnt lgkmcnt(2)
ds_read_b128 v[16:19], v0 offset:2048
v_smfmac_f32_16x16x64_bf16 v[24:27], v[20:23], v[72:79], v1
ds_read_b128 v[68:71], v0 offset:52224
v_smfmac_f32_16x16x64_bf16 v[28:31], v[20:23], a[48:55], v1
buffer_load_dwordx4 v[56:59], v0, s[4:7], s35 offen offset:2048 sc1
v_smfmac_f32_16x16x64_bf16 v[24:27], v[8:11], a[56:63], v1
s_waitcnt lgkmcnt(0)
buffer_load_dwordx4 v[60:63], v0, s[4:7], s35 offen offset:3072 sc1
v_smfmac_f32_16x16x64_bf16 v[28:31], v[8:11], v[64:71], v1
ds_read_b128 v[72:75], v4 offset:49152
v_smfmac_f32_16x16x64_bf16 v[24:27], v[12:15], a[64:71], v1
ds_read_b128 v[76:79], v4 offset:50176
v_smfmac_f32_16x16x64_bf16 v[28:31], v[12:15], a[72:79], v1
s_waitcnt lgkmcnt(0)
ds_read_b128 v[64:67], v4 offset:51200
v_smfmac_f32_16x16x64_bf16 v[24:27], v[16:19], v[72:79], v1
ds_read_b128 v[68:71], v4 offset:52224
v_smfmac_f32_16x16x64_bf16 v[28:31], v[16:19], a[80:87], v1
ds_read_b128 v[72:75], v0 offset:34816
v_smfmac_f32_16x16x64_bf16 v[32:35], v[16:19], a[176:183], v1
ds_read_b128 v[76:79], v0 offset:35840
v_smfmac_f32_16x16x64_bf16 v[36:39], v[16:19], a[184:191], v1
s_waitcnt lgkmcnt(2)
ds_read_b128 v[16:19], v0 offset:8192
v_cvt_pk_bf16_f32 v24, v24, v25
v_smfmac_f32_16x16x64_bf16 v[32:35], v[12:15], v[64:71], v1
ds_read_b128 v[64:67], v0 offset:47104
v_cvt_pk_bf16_f32 v25, v26, v27
v_smfmac_f32_16x16x64_bf16 v[36:39], v[12:15], a[168:175], v1
ds_read_b128 v[68:71], v0 offset:48128
v_cvt_pk_bf16_f32 v28, v28, v29
v_mfma_f32_16x16x16_bf16 v[24:27], v[24:25], v[2:3], 0
ds_read_b128 v[12:15], v0 offset:7168
v_cvt_pk_bf16_f32 v29, v30, v31
v_smfmac_f32_16x16x64_bf16 v[32:35], v[8:11], a[160:167], v1
v_mfma_f32_16x16x16_bf16 v[28:31], v[28:29], v[2:3], 0
s_waitcnt lgkmcnt(4)
v_smfmac_f32_16x16x64_bf16 v[36:39], v[8:11], v[72:79], v1
s_waitcnt vmcnt(4)
ds_read_b128 v[72:75], v0 offset:40960
v_cvt_pk_bf16_f32 v24, v24, v25
v_smfmac_f32_16x16x64_bf16 v[32:35], v[20:23], v[40:47], v1
ds_read_b128 v[76:79], v0 offset:41984
v_cvt_pk_bf16_f32 v25, v26, v27
v_smfmac_f32_16x16x64_bf16 v[36:39], v[20:23], a[152:159], v1
ds_read_b128 v[20:23], v0 offset:6144
v_cvt_pk_bf16_f32 v26, v28, v29
v_cvt_pk_bf16_f32 v27, v30, v31
s_waitcnt lgkmcnt(6)
v_smfmac_f32_16x16x64_bf16 v[32:35], v[16:19], a[144:151], v1
s_waitcnt vmcnt(3)
v_mov_b64 v[40:41], -1
v_mfma_f32_16x16x32_bf16 v[28:31], v[48:51], v[24:27], 0
s_waitcnt vmcnt(2)
v_mov_b64 v[42:43], -1
v_mfma_f32_16x16x32_bf16 v[8:11], v[52:55], v[24:27], 0
buffer_store_dwordx4 v[40:43], v0, s[4:7], s59 offen offset:0
buffer_store_dwordx4 v[40:43], v0, s[4:7], s59 offen offset:1024
buffer_store_dwordx4 v[40:43], v0, s[4:7], s59 offen offset:2048
buffer_store_dwordx4 v[40:43], v0, s[4:7], s59 offen offset:3072
buffer_store_dword v40, v6, s[4:7], s58 offen
s_waitcnt lgkmcnt(4)
v_smfmac_f32_16x16x64_bf16 v[36:39], v[16:19], v[64:71], v1
s_waitcnt lgkmcnt(3)
ds_read_b128 v[64:67], v4 offset:53248
v_mov_b64 v[44:45], 0
v_smfmac_f32_16x16x64_bf16 v[32:35], v[12:15], a[136:143], v1
s_waitcnt lgkmcnt(2)
ds_read_b128 v[68:71], v4 offset:54272
v_mov_b64 v[46:47], 0
v_smfmac_f32_16x16x64_bf16 v[36:39], v[12:15], v[72:79], v1
ds_read_b128 v[72:75], v0 offset:49152
v_cndmask_b32 v28, v28, v8, s[42:43]
v_cndmask_b32 v29, v29, v9, s[42:43]
s_waitcnt lgkmcnt(3)
v_smfmac_f32_16x16x64_bf16 v[32:35], v[20:23], a[120:127], v1
ds_read_b128 v[76:79], v0 offset:50176
v_cndmask_b32 v30, v30, v10, s[42:43]
v_cndmask_b32 v31, v31, v11, s[42:43]
v_smfmac_f32_16x16x64_bf16 v[36:39], v[20:23], a[128:135], v1
ds_write_b128 v0, v[28:31] offset:11264
v_mov_b64 v[40:41], 0
v_mov_b64 v[42:43], 0
v_smfmac_f32_16x16x64_bf16 v[44:47], v[20:23], a[240:247], v1
v_cvt_pk_bf16_f32 v32, v32, v33
v_cvt_pk_bf16_f32 v33, v34, v35
v_smfmac_f32_16x16x64_bf16 v[40:43], v[20:23], a[232:239], v1
ds_read_b128 v[20:23], v0 offset:9216
v_mfma_f32_16x16x16_bf16 v[32:35], v[32:33], v[2:3], 0
v_cvt_pk_bf16_f32 v36, v36, v37
v_cvt_pk_bf16_f32 v37, v38, v39
s_waitcnt lgkmcnt(0)
s_barrier
v_mfma_f32_16x16x16_bf16 v[36:39], v[36:37], v[2:3], 0
ds_read_b128 v[48:51], v0 offset:12288
v_smfmac_f32_16x16x64_bf16 v[40:43], v[12:15], a[248:255], v1
ds_read_b128 v[52:55], v0 offset:13312
v_cvt_pk_bf16_f32 v32, v32, v33
v_cvt_pk_bf16_f32 v33, v34, v35
v_smfmac_f32_16x16x64_bf16 v[44:47], v[12:15], v[80:87], v1
ds_read_b128 v[12:15], v0 offset:0
v_cvt_pk_bf16_f32 v34, v36, v37
v_cvt_pk_bf16_f32 v35, v38, v39
s_nop 1
v_mfma_f32_16x16x32_bf16 v[36:39], v[32:35], v[24:27], 0
ds_read_b128 v[8:11], v0 offset:10240
v_smfmac_f32_16x16x64_bf16 v[40:43], v[16:19], v[88:95], v1
buffer_store_dwordx4 v[32:35], v0, s[4:7], s40 offen sc1
s_waitcnt lgkmcnt(3)
v_add_f32 v28, v28, v48
v_add_f32 v29, v29, v49
v_smfmac_f32_16x16x64_bf16 v[44:47], v[16:19], v[64:71], v1
ds_write_b128 v7, v[36:39] offset:14848
v_smfmac_f32_16x16x64_bf16 v[40:43], v[20:23], v[96:103], v1
ds_read_b128 v[16:19], v0 offset:1024
v_add_f32 v30, v30, v50
v_add_f32 v31, v31, v51
v_smfmac_f32_16x16x64_bf16 v[44:47], v[20:23], v[104:111], v1
ds_read_b128 v[20:23], v0 offset:2048
s_waitcnt lgkmcnt(5)
v_add_f32 v28, v28, v52
v_add_f32 v29, v29, v53
s_waitcnt lgkmcnt(4)
v_smfmac_f32_16x16x64_bf16 v[40:43], v[12:15], v[112:119], v1
ds_read_b128 v[64:67], v4 offset:59392
v_add_f32 v30, v30, v54
v_add_f32 v31, v31, v55
v_smfmac_f32_16x16x64_bf16 v[44:47], v[12:15], v[72:79], v1
ds_read_b128 v[12:15], v0 offset:3072
s_waitcnt lgkmcnt(5)
v_add_f32 v28, v28, v8
v_add_f32 v29, v29, v9
s_waitcnt lgkmcnt(3)
v_smfmac_f32_16x16x64_bf16 v[40:43], v[16:19], v[120:127], v1
ds_read_b128 v[68:71], v4 offset:60416
v_add_f32 v30, v30, v10
v_add_f32 v31, v31, v11
s_waitcnt lgkmcnt(0)
s_barrier
ds_read_b128 v[48:51], v7 offset:15360
ds_read_b128 v[52:55], v7 offset:15872
ds_read_b128 v[8:11], v7 offset:14336
v_smfmac_f32_16x16x64_bf16 v[44:47], v[16:19], v[128:135], v1
ds_read_b128 v[16:19], v0 offset:4096
v_max3_f32 v24, v28, v29, v30
v_smfmac_f32_16x16x64_bf16 v[40:43], v[20:23], v[136:143], v1
ds_read_b128 v[72:75], v4 offset:47104
v_max_f32 v24, v24, v31
v_smfmac_f32_16x16x64_bf16 v[44:47], v[20:23], v[64:71], v1
ds_read_b128 v[20:23], v0 offset:5120
v_max_f32_dpp v24, v24, v24 row_ror:8 row_mask:0xf bank_mask:0xf
v_smfmac_f32_16x16x64_bf16 v[40:43], v[12:15], a[192:199], v1
ds_read_b128 v[76:79], v4 offset:48128
v_mov_b32 v25, v24
v_smfmac_f32_16x16x64_bf16 v[44:47], v[12:15], a[200:207], v1
s_waitcnt lgkmcnt(3)
ds_read_b128 v[64:67], v4 offset:57344
v_permlane32_swap_b32 v24, v25
v_smfmac_f32_16x16x64_bf16 v[40:43], v[16:19], a[208:215], v1
s_waitcnt lgkmcnt(1)
ds_read_b128 v[68:71], v4 offset:58368
v_max_f32 v24, v24, v25
v_smfmac_f32_16x16x64_bf16 v[44:47], v[16:19], v[72:79], v1
ds_read_b128 v[72:75], v4 offset:61440
v_smfmac_f32_16x16x64_bf16 v[40:43], v[20:23], a[216:223], v1
ds_read_b128 v[76:79], v4 offset:62464
v_smfmac_f32_16x16x64_bf16 v[44:47], v[20:23], a[224:231], v1
v_add_f32 v36, v36, v48
v_add_f32 v37, v37, v49
v_add_f32 v38, v38, v50
v_add_f32 v39, v39, v51
v_add_f32 v36, v36, v52
v_add_f32 v37, v37, v53
v_add_f32 v38, v38, v54
v_add_f32 v39, v39, v55
v_add_f32 v36, v36, v8
v_add_f32 v37, v37, v9
v_add_f32 v38, v38, v10
v_add_f32 v39, v39, v11
buffer_load_dwordx4 v[48:51], v0, s[4:7], s63 offen offset:0
buffer_load_dwordx4 v[52:55], v0, s[4:7], s63 offen offset:1024
v_max3_f32 v24, v24, v36, v37
v_max3_f32 v24, v24, v38, v39
v_mov_b32 v25, v24
v_cvt_pk_bf16_f32 v40, v40, v41
v_cvt_pk_bf16_f32 v41, v42, v43
v_permlane16_swap_b32 v24, v25
v_max_f32 v24, v24, v25
v_mul_f32 v24, s54, v24
v_fma_f32 v28, v28, s54, -v24
v_exp_f32 v28, v28
v_fma_f32 v29, v29, s54, -v24
v_exp_f32 v29, v29
v_fma_f32 v30, v30, s54, -v24
v_exp_f32 v30, v30
v_fma_f32 v31, v31, s54, -v24
v_exp_f32 v31, v31
v_fma_f32 v36, v36, s54, -v24
v_exp_f32 v36, v36
v_fma_f32 v37, v37, s54, -v24
v_exp_f32 v37, v37
v_fma_f32 v38, v38, s54, -v24
v_exp_f32 v38, v38
v_fma_f32 v39, v39, s54, -v24
v_exp_f32 v39, v39
v_cvt_pk_bf16_f32 v24, v28, v29
v_cvt_pk_bf16_f32 v25, v30, v31
v_cvt_pk_bf16_f32 v26, v28, v29
v_cvt_pk_bf16_f32 v27, v30, v31
v_cvt_pk_bf16_f32 v32, v36, v37
v_cvt_pk_bf16_f32 v33, v38, v39
v_mov_b32_dpp v24, v26 row_ror:8 row_mask:0xf bank_mask:0xc
v_mov_b32_dpp v25, v27 row_ror:8 row_mask:0xf bank_mask:0xc
v_mov_b32_dpp v26, v26 row_ror:8 row_mask:0xf bank_mask:0x3
v_mov_b32_dpp v27, v27 row_ror:8 row_mask:0xf bank_mask:0x3
v_cvt_pk_bf16_f32 v42, v44, v45
v_cvt_pk_bf16_f32 v43, v46, v47
v_mov_b32 v8, 0x40004000
v_mov_b32 v9, 0x40004000
v_mov_b32 v10, 0x40004000
v_mov_b32 v11, 0x40004000
v_mov_b32 v34, 0x3f803f80
v_mov_b32 v35, 0x3f803f80
buffer_store_dwordx4 v[40:43], v0, s[4:7], s40 offen offset:1024 sc1
s_cmp_eq_u32 s31, 63
s_cbranch_scc1 k_done_161
v_mfma_f32_16x16x32_bf16 v[20:23], v[8:11], v[24:27], 0
s_waitcnt vmcnt(10)
v_mov_b64 v[28:29], 0
v_mov_b64 v[30:31], 0
v_mfma_f32_16x16x32_bf16 v[12:15], v[56:59], v[24:27], 0
v_mov_b64 v[36:37], 0
v_mov_b64 v[38:39], 0
v_mfma_f32_16x16x16_bf16 v[20:23], v[34:35], v[32:33], v[20:23]
s_waitcnt vmcnt(9)
v_mov_b64 v[44:45], 0
v_mov_b64 v[46:47], 0
v_mfma_f32_16x16x32_bf16 v[16:19], v[60:63], v[24:27], 0
buffer_load_dwordx4 v[56:59], v0, s[4:7], s63 offen offset:2048
v_mov_b64 v[24:25], 0
v_mfma_f32_16x16x16_bf16 v[12:15], v[40:41], v[32:33], v[12:15]
buffer_load_dwordx4 v[60:63], v0, s[4:7], s63 offen offset:3072
v_rcp_f32 v20, v20
v_mfma_f32_16x16x16_bf16 v[16:19], v[42:43], v[32:33], v[16:19]
v_mov_b64 v[26:27], 0
s_nop 1
v_mul_f32 v12, v12, v20
v_mul_f32 v13, v13, v20
v_mul_f32 v14, v14, v20
v_mul_f32 v15, v15, v20
v_cvt_pk_bf16_f32 v8, v12, v13
v_cvt_pk_bf16_f32 v9, v14, v15
v_mul_f32 v16, v16, v20
v_mul_f32 v17, v17, v20
v_mul_f32 v18, v18, v20
v_mul_f32 v19, v19, v20
v_cvt_pk_bf16_f32 v10, v16, v17
v_cvt_pk_bf16_f32 v11, v18, v19
ds_write_b128 v0, v[8:11] offset:11264
s_waitcnt lgkmcnt(3)
v_smfmac_f32_16x16x64_bf16 v[44:47], v[8:11], v[64:71], v1
s_waitcnt lgkmcnt(1)
v_mov_b64 v[32:33], 0
v_smfmac_f32_16x16x64_bf16 v[28:31], v[8:11], v[72:79], v1
v_mov_b64 v[34:35], 0
v_smfmac_f32_16x16x64_bf16 v[36:39], v[8:11], v[176:183], v1
s_waitcnt lgkmcnt(0)
s_barrier
ds_read_b128 v[12:15], v0 offset:12288
v_smfmac_f32_16x16x64_bf16 v[24:27], v[8:11], v[200:207], v1
ds_read_b128 v[16:19], v0 offset:13312
ds_read_b128 v[20:23], v0 offset:10240
v_smfmac_f32_16x16x64_bf16 v[32:35], v[8:11], v[232:239], v1
ds_read_b128 v[64:67], v4 offset:55296
ds_read_b128 v[68:71], v4 offset:56320
ds_read_b128 v[72:75], v4 offset:63488
ds_read_b128 v[76:79], v4 offset:64512
s_mov_b32 s41, s36
s_waitcnt lgkmcnt(6)
v_smfmac_f32_16x16x64_bf16 v[44:47], v[12:15], v[144:151], v1
s_waitcnt lgkmcnt(5)
v_smfmac_f32_16x16x64_bf16 v[44:47], v[16:19], v[152:159], v1
s_waitcnt lgkmcnt(2)
v_smfmac_f32_16x16x64_bf16 v[44:47], v[20:23], v[64:71], v1
v_smfmac_f32_16x16x64_bf16 v[28:31], v[12:15], v[160:167], v1
buffer_load_dwordx4 v[64:67], v0, s[4:7], s61 offen offset:0
v_smfmac_f32_16x16x64_bf16 v[28:31], v[16:19], v[168:175], v1
buffer_load_dwordx4 v[68:71], v0, s[4:7], s61 offen offset:1024
v_cvt_pk_bf16_f32 v44, v44, v45
v_cvt_pk_bf16_f32 v45, v46, v47
buffer_store_dwordx2 v[44:45], v5, s[4:7], s41 offen
s_add_u32 s41, s41, 65536
s_waitcnt lgkmcnt(0)
v_smfmac_f32_16x16x64_bf16 v[28:31], v[20:23], v[72:79], v1
buffer_load_dwordx4 v[40:43], v0, s[4:7], s60 offen offset:0
v_smfmac_f32_16x16x64_bf16 v[36:39], v[12:15], v[184:191], v1
buffer_load_dwordx4 v[44:47], v0, s[4:7], s60 offen offset:1024
v_smfmac_f32_16x16x64_bf16 v[36:39], v[16:19], v[192:199], v1
buffer_load_dwordx4 v[72:75], v0, s[4:7], s61 offen offset:2048
v_cvt_pk_bf16_f32 v28, v28, v29
v_cvt_pk_bf16_f32 v29, v30, v31
buffer_store_dwordx2 v[28:29], v5, s[4:7], s41 offen
s_add_u32 s41, s41, 65536
s_waitcnt vmcnt(10)
v_smfmac_f32_16x16x64_bf16 v[36:39], v[20:23], v[48:55], v1
buffer_load_dwordx4 v[76:79], v0, s[4:7], s61 offen offset:3072
v_smfmac_f32_16x16x64_bf16 v[24:27], v[12:15], v[208:215], v1
buffer_load_dwordx4 v[48:51], v0, s[4:7], s60 offen offset:2048
v_smfmac_f32_16x16x64_bf16 v[24:27], v[16:19], v[216:223], v1
buffer_load_dwordx4 v[52:55], v0, s[4:7], s60 offen offset:3072
v_cvt_pk_bf16_f32 v36, v36, v37
v_cvt_pk_bf16_f32 v37, v38, v39
buffer_store_dwordx2 v[36:37], v5, s[4:7], s41 offen
s_add_u32 s41, s41, 65536
v_smfmac_f32_16x16x64_bf16 v[24:27], v[20:23], v[224:231], v1
v_smfmac_f32_16x16x64_bf16 v[32:35], v[12:15], v[240:247], v1
v_smfmac_f32_16x16x64_bf16 v[32:35], v[16:19], v[248:255], v1
v_cvt_pk_bf16_f32 v24, v24, v25
v_cvt_pk_bf16_f32 v25, v26, v27
buffer_store_dwordx2 v[24:25], v5, s[4:7], s41 offen
s_add_u32 s41, s41, 65536
s_waitcnt vmcnt(12)
v_smfmac_f32_16x16x64_bf16 v[32:35], v[20:23], v[56:63], v1
s_nop 6
v_cvt_pk_bf16_f32 v32, v32, v33
v_cvt_pk_bf16_f32 v33, v34, v35
buffer_store_dwordx2 v[32:33], v5, s[4:7], s41 offen
s_add_u32 s41, s41, 65536
buffer_load_dwordx4 v[56:59], v0, s[4:7], s62 offen offset:0
buffer_load_dwordx4 v[60:63], v0, s[4:7], s62 offen offset:1024
s_add_u32 s31, s31, 1
s_add_u32 s33, s33, 10240
s_add_u32 s34, s34, 10240
s_add_u32 s35, s35, 524288
s_add_u32 s40, s40, 262144
s_add_u32 s36, s36, s55
v_mov_b32 v28, 0x4000
v_cndmask_b32 v28, v28, 2.0, s[44:45]
v_cndmask_b32 v24, 0, v28, s[46:47]
v_cndmask_b32 v25, 0, v28, s[48:49]
v_cndmask_b32 v26, 0, v28, s[50:51]
v_cndmask_b32 v27, 0, v28, s[52:53]
k_poll1_162:
buffer_load_dwordx4 v[8:11], v0, s[4:7], s37 offen offset:0 sc1
buffer_load_dwordx4 v[12:15], v0, s[4:7], s37 offen offset:1024 sc1
buffer_load_dwordx4 v[16:19], v0, s[4:7], s37 offen offset:2048 sc1
buffer_load_dwordx4 v[20:23], v0, s[4:7], s37 offen offset:3072 sc1
s_waitcnt vmcnt(3)
v_mfma_f32_16x16x32_bf16 v[28:31], v[8:11], v[24:27], 0
s_waitcnt vmcnt(2)
v_mfma_f32_16x16x32_bf16 v[28:31], v[12:15], v[24:27], v[28:31]
s_waitcnt vmcnt(1)
v_mfma_f32_16x16x32_bf16 v[28:31], v[16:19], v[24:27], v[28:31]
s_waitcnt vmcnt(0)
v_mfma_f32_16x16x32_bf16 v[28:31], v[20:23], v[24:27], v[28:31]
s_nop 7
v_permlane32_swap_b32 v28, v29
v_permlane32_swap_b32 v30, v31
v_add_f32 v28, v28, v29
v_add_f32 v29, v30, v31
v_cmp_u_f32 vcc, v28, v29
v_cvt_pk_bf16_f32 v28, v28, v29
s_cbranch_vccnz k_retry1_163
k_poll1_162_ok:
buffer_store_dword v28, v6, s[4:7], s38 offen
s_mov_b32 s59, s37
s_add_u32 s37, s37, s55
s_add_u32 s38, s38, 10240
s_add_u32 s58, s58, 10240
k_nored_164:
s_sub_u32 s55, 0, s55
v_mov_b64 v[24:25], 0
v_mov_b64 v[26:27], 0
v_mov_b64 v[28:29], 0
v_mov_b64 v[30:31], 0
v_mov_b64 v[32:33], 0
v_mov_b64 v[34:35], 0
v_mov_b64 v[36:37], 0
v_mov_b64 v[38:39], 0
s_branch k_top_158
k_retry2_160:
s_add_u32 s75, s75, 1
s_sub_u32 s32, s32, 1
s_cmp_gt_i32 s32, 0
s_cbranch_scc1 k_poll2_159
s_branch k_poll2_159_ok
k_retry1_163:
s_add_u32 s76, s76, 1
s_sub_u32 s32, s32, 1
s_cmp_gt_i32 s32, 0
s_cbranch_scc1 k_poll1_162
s_branch k_poll1_162_ok
k_done_161:
s_add_u32 s30, s30, 112
s_waitcnt vmcnt(0) lgkmcnt(0)
s_barrier
s_branch k_fin_7
k_w2_114:
v_lshrrev_b32 v10, 3, v0
v_lshlrev_b32 v8, 13, v10
v_bfe_u32 v10, v0, 1, 2
v_lshrrev_b32 v11, 4, v0
v_xor_b32 v10, v10, v11
v_lshl_add_u32 v8, v10, 5, v8
v_and_b32 v12, 1, v0
v_lshl_add_u32 v8, v12, 4, v8
v_mul_u32_u24 v9, 1280, v11
v_bfe_u32 v10, v0, 1, 3
v_and_b32 v11, 1, v11
v_lshlrev_b32 v11, 1, v11
v_xor_b32 v10, v10, v11
v_xor_b32 v10, 4, v10
v_lshl_add_u32 v9, v10, 5, v9
v_lshl_add_u32 v9, v12, 4, v9
v_bfe_u32 v10, v0, 5, 1
v_lshlrev_b32 v10, 4, v10
v_bfe_u32 v11, v0, 4, 1
v_lshl_add_u32 v10, v11, 1, v10
v_bfe_u32 v11, v0, 2, 1
v_lshl_add_u32 v10, v11, 2, v10
v_bfe_u32 v11, v0, 3, 1
v_add_u32 v10, v11, v10
v_bfe_u32 v11, v10, 1, 2
v_xor_b32 v11, 2, v11
v_lshlrev_b32 v11, 5, v11
v_lshl_add_u32 v1, v10, 7, v11
v_and_b32 v12, 3, v0
v_lshl_add_u32 v1, v12, 3, v1
v_add_u32 v2, 0x10000, v1
v_add_u32 v3, 0x20000, v1
v_bfe_u32 v10, v0, 4, 1
v_lshlrev_b32 v11, 4, v10
v_lshlrev_b32 v10, 2, v10
v_bfe_u32 v6, v0, 5, 1
v_lshl_add_u32 v11, v6, 2, v11
v_bfe_u32 v6, v0, 2, 1
v_add_u32 v11, v6, v11
v_lshl_add_u32 v10, v6, 1, v10
v_bfe_u32 v6, v0, 3, 1
v_add_u32 v6, 4, v6
v_xor_b32 v10, v10, v6
v_lshlrev_b32 v10, 5, v10
v_lshl_add_u32 v5, v11, 8, v10
v_lshl_add_u32 v5, v12, 3, v5
v_add_u32 v6, 0x10000, v5
v_add_u32 v7, 0x20000, v5
v_lshlrev_b32 v0, 4, v0
v_add_u32 v4, 65536, v0
s_lshl_b32 s56, s30, 8
s_mul_i32 s57, s30, 163840
s_mul_i32 s39, s30, 131072
s_add_u32 s39, s39, 120651776
s_add_u32 s60, s39, 0
s_add_u32 s61, s39, 4096
s_add_u32 s62, s39, 8192
s_add_u32 s63, s39, 12288
s_add_u32 s64, s39, 16384
s_add_u32 s65, s39, 20480
s_add_u32 s66, s39, 24576
s_add_u32 s67, s39, 28672
s_mov_b32 m0, 4096
s_add_u32 s41, s56, 262144
buffer_load_dwordx4 v8, s[8:11], s41 offen lds
s_mov_b32 m0, 5120
s_add_u32 s41, s56, 327680
buffer_load_dwordx4 v8, s[8:11], s41 offen lds
s_mov_b32 m0, 12288
s_add_u32 s41, s56, 262272
buffer_load_dwordx4 v8, s[8:11], s41 offen lds
s_mov_b32 m0, 13312
s_add_u32 s41, s56, 327808
buffer_load_dwordx4 v8, s[8:11], s41 offen lds
s_mov_b32 m0, 20480
s_add_u32 s41, s56, 786432
buffer_load_dwordx4 v8, s[8:11], s41 offen lds
s_mov_b32 m0, 21504
s_add_u32 s41, s56, 851968
buffer_load_dwordx4 v8, s[8:11], s41 offen lds
s_mov_b32 m0, 28672
s_add_u32 s41, s56, 786560
buffer_load_dwordx4 v8, s[8:11], s41 offen lds
s_mov_b32 m0, 29696
s_add_u32 s41, s56, 852096
buffer_load_dwordx4 v8, s[8:11], s41 offen lds
s_mov_b32 m0, 36864
s_add_u32 s41, s56, 1310720
buffer_load_dwordx4 v8, s[8:11], s41 offen lds
s_mov_b32 m0, 37888
s_add_u32 s41, s56, 1376256
buffer_load_dwordx4 v8, s[8:11], s41 offen lds
s_mov_b32 m0, 45056
s_add_u32 s41, s56, 1310848
buffer_load_dwordx4 v8, s[8:11], s41 offen lds
s_mov_b32 m0, 46080
s_add_u32 s41, s56, 1376384
buffer_load_dwordx4 v8, s[8:11], s41 offen lds
s_mov_b32 m0, 53248
s_add_u32 s41, s56, 1835008
buffer_load_dwordx4 v8, s[8:11], s41 offen lds
s_mov_b32 m0, 54272
s_add_u32 s41, s56, 1900544
buffer_load_dwordx4 v8, s[8:11], s41 offen lds
s_mov_b32 m0, 61440
s_add_u32 s41, s56, 1835136
buffer_load_dwordx4 v8, s[8:11], s41 offen lds
s_mov_b32 m0, 62464
s_add_u32 s41, s56, 1900672
buffer_load_dwordx4 v8, s[8:11], s41 offen lds
s_mov_b32 m0, 69632
s_add_u32 s41, s56, 2359296
buffer_load_dwordx4 v8, s[8:11], s41 offen lds
s_mov_b32 m0, 70656
s_add_u32 s41, s56, 2424832
buffer_load_dwordx4 v8, s[8:11], s41 offen lds
s_mov_b32 m0, 77824
s_add_u32 s41, s56, 2359424
buffer_load_dwordx4 v8, s[8:11], s41 offen lds
s_mov_b32 m0, 78848
s_add_u32 s41, s56, 2424960
buffer_load_dwordx4 v8, s[8:11], s41 offen lds
s_mov_b32 m0, 86016
s_add_u32 s41, s56, 2883584
buffer_load_dwordx4 v8, s[8:11], s41 offen lds
s_mov_b32 m0, 87040
s_add_u32 s41, s56, 2949120
buffer_load_dwordx4 v8, s[8:11], s41 offen lds
s_mov_b32 m0, 94208
s_add_u32 s41, s56, 2883712
buffer_load_dwordx4 v8, s[8:11], s41 offen lds
s_mov_b32 m0, 95232
s_add_u32 s41, s56, 2949248
buffer_load_dwordx4 v8, s[8:11], s41 offen lds
s_mov_b32 m0, 102400
s_add_u32 s41, s56, 3407872
buffer_load_dwordx4 v8, s[8:11], s41 offen lds
s_mov_b32 m0, 103424
s_add_u32 s41, s56, 3473408
buffer_load_dwordx4 v8, s[8:11], s41 offen lds
s_mov_b32 m0, 110592
s_add_u32 s41, s56, 3408000
buffer_load_dwordx4 v8, s[8:11], s41 offen lds
s_mov_b32 m0, 111616
s_add_u32 s41, s56, 3473536
buffer_load_dwordx4 v8, s[8:11], s41 offen lds
s_mov_b32 m0, 118784
s_add_u32 s41, s56, 3932160
buffer_load_dwordx4 v8, s[8:11], s41 offen lds
s_mov_b32 m0, 119808
s_add_u32 s41, s56, 3997696
buffer_load_dwordx4 v8, s[8:11], s41 offen lds
s_mov_b32 m0, 126976
s_add_u32 s41, s56, 3932288
buffer_load_dwordx4 v8, s[8:11], s41 offen lds
s_mov_b32 m0, 128000
s_add_u32 s41, s56, 3997824
buffer_load_dwordx4 v8, s[8:11], s41 offen lds
s_waitcnt vmcnt(24)
s_barrier
s_mov_b32 m0, 135168
s_add_u32 s41, s56, 4456448
buffer_load_dwordx4 v8, s[8:11], s41 offen lds
s_mov_b32 m0, 136192
s_add_u32 s41, s56, 4521984
buffer_load_dwordx4 v8, s[8:11], s41 offen lds
s_mov_b32 m0, 143360
s_add_u32 s41, s56, 4456576
buffer_load_dwordx4 v8, s[8:11], s41 offen lds
s_mov_b32 m0, 144384
s_add_u32 s41, s56, 4522112
buffer_load_dwordx4 v8, s[8:11], s41 offen lds
s_mov_b32 m0, 151552
s_add_u32 s41, s56, 4980736
buffer_load_dwordx4 v8, s[8:11], s41 offen lds
s_mov_b32 m0, 152576
s_add_u32 s41, s56, 5046272
buffer_load_dwordx4 v8, s[8:11], s41 offen lds
s_mov_b32 m0, 159744
s_add_u32 s41, s56, 4980864
buffer_load_dwordx4 v8, s[8:11], s41 offen lds
s_mov_b32 m0, 160768
s_add_u32 s41, s56, 5046400
buffer_load_dwordx4 v8, s[8:11], s41 offen lds
ds_read_b64_tr_b16 a[24:25], v1 offset:0
ds_read_b64_tr_b16 a[26:27], v1 offset:1024
ds_read_b64_tr_b16 a[28:29], v1 offset:4096
ds_read_b64_tr_b16 a[30:31], v1 offset:5120
ds_read_b64_tr_b16 a[168:169], v1 offset:8192
ds_read_b64_tr_b16 a[170:171], v1 offset:9216
ds_read_b64_tr_b16 a[172:173], v1 offset:12288
ds_read_b64_tr_b16 a[174:175], v1 offset:13312
ds_read_b64_tr_b16 a[32:33], v1 offset:16384
ds_read_b64_tr_b16 a[34:35], v1 offset:17408
ds_read_b64_tr_b16 a[36:37], v1 offset:20480
ds_read_b64_tr_b16 a[38:39], v1 offset:21504
ds_read_b64_tr_b16 a[40:41], v1 offset:24576
ds_read_b64_tr_b16 a[42:43], v1 offset:25600
ds_read_b64_tr_b16 a[44:45], v1 offset:28672
ds_read_b64_tr_b16 a[46:47], v1 offset:29696
s_waitcnt lgkmcnt(0)
s_waitcnt vmcnt(24)
s_barrier
s_mov_b32 m0, 4096
s_add_u32 s41, s56, 262144
buffer_load_dwordx4 v8, s[12:15], s41 offen lds
s_mov_b32 m0, 5120
s_add_u32 s41, s56, 327680
buffer_load_dwordx4 v8, s[12:15], s41 offen lds
s_mov_b32 m0, 12288
s_add_u32 s41, s56, 786432
buffer_load_dwordx4 v8, s[12:15], s41 offen lds
s_mov_b32 m0, 13312
s_add_u32 s41, s56, 851968
buffer_load_dwordx4 v8, s[12:15], s41 offen lds
s_mov_b32 m0, 20480
s_add_u32 s41, s56, 1310720
buffer_load_dwordx4 v8, s[12:15], s41 offen lds
s_mov_b32 m0, 21504
s_add_u32 s41, s56, 1376256
buffer_load_dwordx4 v8, s[12:15], s41 offen lds
s_mov_b32 m0, 28672
s_add_u32 s41, s56, 1310848
buffer_load_dwordx4 v8, s[12:15], s41 offen lds
s_mov_b32 m0, 29696
s_add_u32 s41, s56, 1376384
buffer_load_dwordx4 v8, s[12:15], s41 offen lds
ds_read_b64_tr_b16 a[184:185], v1 offset:32768
ds_read_b64_tr_b16 a[186:187], v1 offset:33792
ds_read_b64_tr_b16 a[188:189], v1 offset:36864
ds_read_b64_tr_b16 a[190:191], v1 offset:37888
ds_read_b64_tr_b16 a[48:49], v1 offset:40960
ds_read_b64_tr_b16 a[50:51], v1 offset:41984
ds_read_b64_tr_b16 a[52:53], v1 offset:45056
ds_read_b64_tr_b16 a[54:55], v1 offset:46080
ds_read_b64_tr_b16 a[56:57], v1 offset:49152
ds_read_b64_tr_b16 a[58:59], v1 offset:50176
ds_read_b64_tr_b16 a[60:61], v1 offset:53248
ds_read_b64_tr_b16 a[62:63], v1 offset:54272
ds_read_b64_tr_b16 v[80:81], v1 offset:57344
ds_read_b64_tr_b16 v[82:83], v1 offset:58368
ds_read_b64_tr_b16 v[84:85], v1 offset:61440
ds_read_b64_tr_b16 v[86:87], v1 offset:62464
s_waitcnt lgkmcnt(0)
s_waitcnt vmcnt(24)
s_barrier
s_mov_b32 m0, 36864
s_add_u32 s41, s56, 1835008
buffer_load_dwordx4 v8, s[12:15], s41 offen lds
s_mov_b32 m0, 37888
s_add_u32 s41, s56, 1900544
buffer_load_dwordx4 v8, s[12:15], s41 offen lds
s_mov_b32 m0, 45056
s_add_u32 s41, s56, 2359296
buffer_load_dwordx4 v8, s[12:15], s41 offen lds
s_mov_b32 m0, 46080
s_add_u32 s41, s56, 2424832
buffer_load_dwordx4 v8, s[12:15], s41 offen lds
s_mov_b32 m0, 53248
s_add_u32 s41, s56, 2883584
buffer_load_dwordx4 v8, s[12:15], s41 offen lds
s_mov_b32 m0, 54272
s_add_u32 s41, s56, 2949120
buffer_load_dwordx4 v8, s[12:15], s41 offen lds
s_mov_b32 m0, 61440
s_add_u32 s41, s56, 3407872
buffer_load_dwordx4 v8, s[12:15], s41 offen lds
s_mov_b32 m0, 62464
s_add_u32 s41, s56, 3473408
buffer_load_dwordx4 v8, s[12:15], s41 offen lds
ds_read_b64_tr_b16 a[64:65], v2 offset:0
ds_read_b64_tr_b16 a[66:67], v2 offset:1024
ds_read_b64_tr_b16 a[68:69], v2 offset:4096
ds_read_b64_tr_b16 a[70:71], v2 offset:5120
ds_read_b64_tr_b16 a[72:73], v2 offset:8192
ds_read_b64_tr_b16 a[74:75], v2 offset:9216
ds_read_b64_tr_b16 a[76:77], v2 offset:12288
ds_read_b64_tr_b16 a[78:79], v2 offset:13312
ds_read_b64_tr_b16 v[128:129], v2 offset:16384
ds_read_b64_tr_b16 v[130:131], v2 offset:17408
ds_read_b64_tr_b16 v[132:133], v2 offset:20480
ds_read_b64_tr_b16 v[134:135], v2 offset:21504
ds_read_b64_tr_b16 a[80:81], v2 offset:24576
ds_read_b64_tr_b16 a[82:83], v2 offset:25600
ds_read_b64_tr_b16 a[84:85], v2 offset:28672
ds_read_b64_tr_b16 a[86:87], v2 offset:29696
s_waitcnt lgkmcnt(0)
s_waitcnt vmcnt(24)
s_barrier
s_mov_b32 m0, 69632
s_add_u32 s41, s56, 3408000
buffer_load_dwordx4 v8, s[12:15], s41 offen lds
s_mov_b32 m0, 70656
s_add_u32 s41, s56, 3473536
buffer_load_dwordx4 v8, s[12:15], s41 offen lds
s_mov_b32 m0, 77824
s_add_u32 s41, s56, 3932160
buffer_load_dwordx4 v8, s[12:15], s41 offen lds
s_mov_b32 m0, 78848
s_add_u32 s41, s56, 3997696
buffer_load_dwordx4 v8, s[12:15], s41 offen lds
s_mov_b32 m0, 86016
s_add_u32 s41, s56, 4456448
buffer_load_dwordx4 v8, s[12:15], s41 offen lds
s_mov_b32 m0, 87040
s_add_u32 s41, s56, 4521984
buffer_load_dwordx4 v8, s[12:15], s41 offen lds
s_mov_b32 m0, 94208
s_add_u32 s41, s56, 4980736
buffer_load_dwordx4 v8, s[12:15], s41 offen lds
s_mov_b32 m0, 95232
s_add_u32 s41, s56, 5046272
buffer_load_dwordx4 v8, s[12:15], s41 offen lds
ds_read_b64_tr_b16 v[16:17], v2 offset:32768
ds_read_b64_tr_b16 v[18:19], v2 offset:33792
ds_read_b64_tr_b16 v[20:21], v2 offset:36864
ds_read_b64_tr_b16 v[22:23], v2 offset:37888
ds_read_b64_tr_b16 v[24:25], v2 offset:40960
ds_read_b64_tr_b16 v[26:27], v2 offset:41984
ds_read_b64_tr_b16 v[28:29], v2 offset:45056
ds_read_b64_tr_b16 v[30:31], v2 offset:46080
ds_read_b64_tr_b16 v[32:33], v2 offset:49152
ds_read_b64_tr_b16 v[34:35], v2 offset:50176
ds_read_b64_tr_b16 v[36:37], v2 offset:53248
ds_read_b64_tr_b16 v[38:39], v2 offset:54272
ds_read_b64_tr_b16 v[40:41], v2 offset:57344
ds_read_b64_tr_b16 v[42:43], v2 offset:58368
ds_read_b64_tr_b16 v[44:45], v2 offset:61440
ds_read_b64_tr_b16 v[46:47], v2 offset:62464
s_waitcnt lgkmcnt(0)
buffer_store_dwordx4 v[16:19], v0, s[4:7], s60 offen offset:0
buffer_store_dwordx4 v[20:23], v0, s[4:7], s60 offen offset:1024
buffer_store_dwordx4 v[24:27], v0, s[4:7], s60 offen offset:2048
buffer_store_dwordx4 v[28:31], v0, s[4:7], s60 offen offset:3072
buffer_store_dwordx4 v[32:35], v0, s[4:7], s61 offen offset:0
buffer_store_dwordx4 v[36:39], v0, s[4:7], s61 offen offset:1024
buffer_store_dwordx4 v[40:43], v0, s[4:7], s61 offen offset:2048
buffer_store_dwordx4 v[44:47], v0, s[4:7], s61 offen offset:3072
s_waitcnt vmcnt(32)
s_barrier
s_mov_b32 m0, 102400
s_add_u32 s41, s56, 4980864
buffer_load_dwordx4 v8, s[12:15], s41 offen lds
s_mov_b32 m0, 103424
s_add_u32 s41, s56, 5046400
buffer_load_dwordx4 v8, s[12:15], s41 offen lds
s_mov_b32 m0, 110592
s_add_u32 s41, s56, 262144
buffer_load_dwordx4 v8, s[16:19], s41 offen lds
s_mov_b32 m0, 111616
s_add_u32 s41, s56, 327680
buffer_load_dwordx4 v8, s[16:19], s41 offen lds
s_mov_b32 m0, 118784
s_add_u32 s41, s56, 786432
buffer_load_dwordx4 v8, s[16:19], s41 offen lds
s_mov_b32 m0, 119808
s_add_u32 s41, s56, 851968
buffer_load_dwordx4 v8, s[16:19], s41 offen lds
s_mov_b32 m0, 126976
s_add_u32 s41, s56, 1310720
buffer_load_dwordx4 v8, s[16:19], s41 offen lds
s_mov_b32 m0, 128000
s_add_u32 s41, s56, 1376256
buffer_load_dwordx4 v8, s[16:19], s41 offen lds
ds_read_b64_tr_b16 v[16:17], v3 offset:0
ds_read_b64_tr_b16 v[18:19], v3 offset:1024
ds_read_b64_tr_b16 v[20:21], v3 offset:4096
ds_read_b64_tr_b16 v[22:23], v3 offset:5120
ds_read_b64_tr_b16 a[0:1], v3 offset:8192
ds_read_b64_tr_b16 a[2:3], v3 offset:9216
ds_read_b64_tr_b16 a[4:5], v3 offset:12288
ds_read_b64_tr_b16 a[6:7], v3 offset:13312
ds_read_b64_tr_b16 a[8:9], v3 offset:16384
ds_read_b64_tr_b16 a[10:11], v3 offset:17408
ds_read_b64_tr_b16 a[12:13], v3 offset:20480
ds_read_b64_tr_b16 a[14:15], v3 offset:21504
ds_read_b64_tr_b16 a[16:17], v3 offset:24576
ds_read_b64_tr_b16 a[18:19], v3 offset:25600
ds_read_b64_tr_b16 a[20:21], v3 offset:28672
ds_read_b64_tr_b16 a[22:23], v3 offset:29696
s_waitcnt lgkmcnt(0)
buffer_store_dwordx4 v[16:19], v0, s[4:7], s62 offen offset:0
buffer_store_dwordx4 v[20:23], v0, s[4:7], s62 offen offset:1024
s_waitcnt vmcnt(34)
s_barrier
s_mov_b32 m0, 135168
s_add_u32 s41, s56, 1310848
buffer_load_dwordx4 v8, s[16:19], s41 offen lds
s_mov_b32 m0, 136192
s_add_u32 s41, s56, 1376384
buffer_load_dwordx4 v8, s[16:19], s41 offen lds
s_mov_b32 m0, 143360
s_add_u32 s41, s56, 1835008
buffer_load_dwordx4 v8, s[16:19], s41 offen lds
s_mov_b32 m0, 144384
s_add_u32 s41, s56, 1900544
buffer_load_dwordx4 v8, s[16:19], s41 offen lds
s_mov_b32 m0, 151552
s_add_u32 s41, s56, 1835136
buffer_load_dwordx4 v8, s[16:19], s41 offen lds
s_mov_b32 m0, 152576
s_add_u32 s41, s56, 1900672
buffer_load_dwordx4 v8, s[16:19], s41 offen lds
s_mov_b32 m0, 159744
s_add_u32 s41, s56, 2359296
buffer_load_dwordx4 v8, s[16:19], s41 offen lds
s_mov_b32 m0, 160768
s_add_u32 s41, s56, 2424832
buffer_load_dwordx4 v8, s[16:19], s41 offen lds
ds_read_b64_tr_b16 a[136:137], v1 offset:0
ds_read_b64_tr_b16 a[138:139], v1 offset:1024
ds_read_b64_tr_b16 a[140:141], v1 offset:4096
ds_read_b64_tr_b16 a[142:143], v1 offset:5120
ds_read_b64_tr_b16 a[144:145], v1 offset:8192
ds_read_b64_tr_b16 a[146:147], v1 offset:9216
ds_read_b64_tr_b16 a[148:149], v1 offset:12288
ds_read_b64_tr_b16 a[150:151], v1 offset:13312
ds_read_b64_tr_b16 v[32:33], v1 offset:16384
ds_read_b64_tr_b16 v[34:35], v1 offset:17408
ds_read_b64_tr_b16 v[36:37], v1 offset:20480
ds_read_b64_tr_b16 v[38:39], v1 offset:21504
ds_read_b64_tr_b16 a[152:153], v1 offset:24576
ds_read_b64_tr_b16 a[154:155], v1 offset:25600
ds_read_b64_tr_b16 a[156:157], v1 offset:28672
ds_read_b64_tr_b16 a[158:159], v1 offset:29696
s_waitcnt lgkmcnt(0)
buffer_store_dwordx4 v[32:35], v0, s[4:7], s62 offen offset:2048
buffer_store_dwordx4 v[36:39], v0, s[4:7], s62 offen offset:3072
s_waitcnt vmcnt(36)
s_barrier
s_mov_b32 m0, 4096
s_add_u32 s41, s56, 2883584
buffer_load_dwordx4 v8, s[16:19], s41 offen lds
s_mov_b32 m0, 5120
s_add_u32 s41, s56, 2949120
buffer_load_dwordx4 v8, s[16:19], s41 offen lds
s_mov_b32 m0, 12288
s_add_u32 s41, s56, 3407872
buffer_load_dwordx4 v8, s[16:19], s41 offen lds
s_mov_b32 m0, 13312
s_add_u32 s41, s56, 3473408
buffer_load_dwordx4 v8, s[16:19], s41 offen lds
s_mov_b32 m0, 20480
s_add_u32 s41, s56, 3408000
buffer_load_dwordx4 v8, s[16:19], s41 offen lds
s_mov_b32 m0, 21504
s_add_u32 s41, s56, 3473536
buffer_load_dwordx4 v8, s[16:19], s41 offen lds
s_mov_b32 m0, 28672
s_add_u32 s41, s56, 3932160
buffer_load_dwordx4 v8, s[16:19], s41 offen lds
s_mov_b32 m0, 29696
s_add_u32 s41, s56, 3997696
buffer_load_dwordx4 v8, s[16:19], s41 offen lds
ds_read_b64_tr_b16 a[160:161], v1 offset:32768
ds_read_b64_tr_b16 a[162:163], v1 offset:33792
ds_read_b64_tr_b16 a[164:165], v1 offset:36864
ds_read_b64_tr_b16 a[166:167], v1 offset:37888
ds_read_b64_tr_b16 a[224:225], v1 offset:40960
ds_read_b64_tr_b16 a[226:227], v1 offset:41984
ds_read_b64_tr_b16 a[228:229], v1 offset:45056
ds_read_b64_tr_b16 a[230:231], v1 offset:46080
ds_read_b64_tr_b16 a[176:177], v1 offset:49152
ds_read_b64_tr_b16 a[178:179], v1 offset:50176
ds_read_b64_tr_b16 a[180:181], v1 offset:53248
ds_read_b64_tr_b16 a[182:183], v1 offset:54272
ds_read_b64_tr_b16 a[88:89], v1 offset:57344
ds_read_b64_tr_b16 a[90:91], v1 offset:58368
ds_read_b64_tr_b16 a[92:93], v1 offset:61440
ds_read_b64_tr_b16 a[94:95], v1 offset:62464
s_waitcnt lgkmcnt(0)
s_waitcnt vmcnt(36)
s_barrier
s_mov_b32 m0, 36864
s_add_u32 s41, s56, 4456448
buffer_load_dwordx4 v8, s[16:19], s41 offen lds
s_mov_b32 m0, 37888
s_add_u32 s41, s56, 4521984
buffer_load_dwordx4 v8, s[16:19], s41 offen lds
s_mov_b32 m0, 45056
s_add_u32 s41, s56, 4980736
buffer_load_dwordx4 v8, s[16:19], s41 offen lds
s_mov_b32 m0, 46080
s_add_u32 s41, s56, 5046272
buffer_load_dwordx4 v8, s[16:19], s41 offen lds
s_mov_b32 m0, 53248
s_add_u32 s41, s56, 4980864
buffer_load_dwordx4 v8, s[16:19], s41 offen lds
s_mov_b32 m0, 54272
s_add_u32 s41, s56, 5046400
buffer_load_dwordx4 v8, s[16:19], s41 offen lds
s_mov_b32 m0, 61440
s_add_u32 s41, s57, 102656
buffer_load_dwordx4 v9, s[20:23], s41 offen lds
s_mov_b32 m0, 62464
s_add_u32 s41, s57, 107776
buffer_load_dwordx4 v9, s[20:23], s41 offen lds
ds_read_b64_tr_b16 a[96:97], v2 offset:0
ds_read_b64_tr_b16 a[98:99], v2 offset:1024
ds_read_b64_tr_b16 a[100:101], v2 offset:4096
ds_read_b64_tr_b16 a[102:103], v2 offset:5120
ds_read_b64_tr_b16 a[104:105], v2 offset:8192
ds_read_b64_tr_b16 a[106:107], v2 offset:9216
ds_read_b64_tr_b16 a[108:109], v2 offset:12288
ds_read_b64_tr_b16 a[110:111], v2 offset:13312
ds_read_b64_tr_b16 a[112:113], v2 offset:16384
ds_read_b64_tr_b16 a[114:115], v2 offset:17408
ds_read_b64_tr_b16 a[116:117], v2 offset:20480
ds_read_b64_tr_b16 a[118:119], v2 offset:21504
ds_read_b64_tr_b16 a[120:121], v2 offset:24576
ds_read_b64_tr_b16 a[122:123], v2 offset:25600
ds_read_b64_tr_b16 a[124:125], v2 offset:28672
ds_read_b64_tr_b16 a[126:127], v2 offset:29696
s_waitcnt lgkmcnt(0)
s_waitcnt vmcnt(28)
s_barrier
s_mov_b32 m0, 69632
s_add_u32 s41, s57, 123136
buffer_load_dwordx4 v9, s[20:23], s41 offen lds
s_mov_b32 m0, 70656
s_add_u32 s41, s57, 128256
buffer_load_dwordx4 v9, s[20:23], s41 offen lds
s_mov_b32 m0, 77824
s_add_u32 s41, s57, 143616
buffer_load_dwordx4 v9, s[20:23], s41 offen lds
s_mov_b32 m0, 78848
s_add_u32 s41, s57, 148736
buffer_load_dwordx4 v9, s[20:23], s41 offen lds
s_mov_b32 m0, 86016
s_add_u32 s41, s57, 82432
buffer_load_dwordx4 v9, s[20:23], s41 offen lds
s_mov_b32 m0, 87040
s_add_u32 s41, s57, 87552
buffer_load_dwordx4 v9, s[20:23], s41 offen lds
s_mov_b32 m0, 94208
s_add_u32 s41, s57, 102912
buffer_load_dwordx4 v9, s[20:23], s41 offen lds
s_mov_b32 m0, 95232
s_add_u32 s41, s57, 108032
buffer_load_dwordx4 v9, s[20:23], s41 offen lds
ds_read_b64_tr_b16 a[128:129], v2 offset:32768
ds_read_b64_tr_b16 a[130:131], v2 offset:33792
ds_read_b64_tr_b16 a[132:133], v2 offset:36864
ds_read_b64_tr_b16 a[134:135], v2 offset:37888
ds_read_b64_tr_b16 a[248:249], v2 offset:40960
ds_read_b64_tr_b16 a[250:251], v2 offset:41984
ds_read_b64_tr_b16 a[252:253], v2 offset:45056
ds_read_b64_tr_b16 a[254:255], v2 offset:46080
ds_read_b64_tr_b16 v[88:89], v2 offset:49152
ds_read_b64_tr_b16 v[90:91], v2 offset:50176
ds_read_b64_tr_b16 v[92:93], v2 offset:53248
ds_read_b64_tr_b16 v[94:95], v2 offset:54272
ds_read_b64_tr_b16 v[96:97], v2 offset:57344
ds_read_b64_tr_b16 v[98:99], v2 offset:58368
ds_read_b64_tr_b16 v[100:101], v2 offset:61440
ds_read_b64_tr_b16 v[102:103], v2 offset:62464
s_waitcnt lgkmcnt(0)
s_waitcnt vmcnt(26)
s_barrier
s_mov_b32 m0, 102400
s_add_u32 s41, s57, 123392
buffer_load_dwordx4 v9, s[20:23], s41 offen lds
s_mov_b32 m0, 103424
s_add_u32 s41, s57, 128512
buffer_load_dwordx4 v9, s[20:23], s41 offen lds
s_mov_b32 m0, 110592
s_add_u32 s41, s57, 143872
buffer_load_dwordx4 v9, s[20:23], s41 offen lds
s_mov_b32 m0, 111616
s_add_u32 s41, s57, 148992
buffer_load_dwordx4 v9, s[20:23], s41 offen lds
s_mov_b32 m0, 118784
s_add_u32 s41, s57, 82688
buffer_load_dwordx4 v9, s[20:23], s41 offen lds
s_mov_b32 m0, 119808
s_add_u32 s41, s57, 87808
buffer_load_dwordx4 v9, s[20:23], s41 offen lds
s_mov_b32 m0, 126976
s_add_u32 s41, s57, 103168
buffer_load_dwordx4 v9, s[20:23], s41 offen lds
s_mov_b32 m0, 128000
s_add_u32 s41, s57, 108288
buffer_load_dwordx4 v9, s[20:23], s41 offen lds
ds_read_b64_tr_b16 v[104:105], v3 offset:0
ds_read_b64_tr_b16 v[106:107], v3 offset:1024
ds_read_b64_tr_b16 v[108:109], v3 offset:4096
ds_read_b64_tr_b16 v[110:111], v3 offset:5120
ds_read_b64_tr_b16 v[112:113], v3 offset:8192
ds_read_b64_tr_b16 v[114:115], v3 offset:9216
ds_read_b64_tr_b16 v[116:117], v3 offset:12288
ds_read_b64_tr_b16 v[118:119], v3 offset:13312
ds_read_b64_tr_b16 v[152:153], v3 offset:16384
ds_read_b64_tr_b16 v[154:155], v3 offset:17408
ds_read_b64_tr_b16 v[156:157], v3 offset:20480
ds_read_b64_tr_b16 v[158:159], v3 offset:21504
ds_read_b64_tr_b16 v[120:121], v3 offset:24576
ds_read_b64_tr_b16 v[122:123], v3 offset:25600
ds_read_b64_tr_b16 v[124:125], v3 offset:28672
ds_read_b64_tr_b16 v[126:127], v3 offset:29696
s_waitcnt lgkmcnt(0)
s_waitcnt vmcnt(24)
s_barrier
s_mov_b32 m0, 135168
s_add_u32 s41, s57, 123648
buffer_load_dwordx4 v9, s[20:23], s41 offen lds
s_mov_b32 m0, 136192
s_add_u32 s41, s57, 128768
buffer_load_dwordx4 v9, s[20:23], s41 offen lds
s_mov_b32 m0, 143360
s_add_u32 s41, s57, 144128
buffer_load_dwordx4 v9, s[20:23], s41 offen lds
s_mov_b32 m0, 144384
s_add_u32 s41, s57, 149248
buffer_load_dwordx4 v9, s[20:23], s41 offen lds
s_mov_b32 m0, 151552
s_add_u32 s41, s57, 82944
buffer_load_dwordx4 v9, s[20:23], s41 offen lds
s_mov_b32 m0, 152576
s_add_u32 s41, s57, 88064
buffer_load_dwordx4 v9, s[20:23], s41 offen lds
s_mov_b32 m0, 159744
s_add_u32 s41, s57, 103424
buffer_load_dwordx4 v9, s[20:23], s41 offen lds
s_mov_b32 m0, 160768
s_add_u32 s41, s57, 108544
buffer_load_dwordx4 v9, s[20:23], s41 offen lds
ds_read_b64_tr_b16 v[136:137], v1 offset:0
ds_read_b64_tr_b16 v[138:139], v1 offset:1024
ds_read_b64_tr_b16 v[140:141], v1 offset:4096
ds_read_b64_tr_b16 v[142:143], v1 offset:5120
ds_read_b64_tr_b16 a[192:193], v1 offset:8192
ds_read_b64_tr_b16 a[194:195], v1 offset:9216
ds_read_b64_tr_b16 a[196:197], v1 offset:12288
ds_read_b64_tr_b16 a[198:199], v1 offset:13312
ds_read_b64_tr_b16 a[200:201], v1 offset:16384
ds_read_b64_tr_b16 a[202:203], v1 offset:17408
ds_read_b64_tr_b16 a[204:205], v1 offset:20480
ds_read_b64_tr_b16 a[206:207], v1 offset:21504
ds_read_b64_tr_b16 a[208:209], v1 offset:24576
ds_read_b64_tr_b16 a[210:211], v1 offset:25600
ds_read_b64_tr_b16 a[212:213], v1 offset:28672
ds_read_b64_tr_b16 a[214:215], v1 offset:29696
s_waitcnt lgkmcnt(0)
s_waitcnt vmcnt(24)
s_barrier
s_mov_b32 m0, 4096
s_add_u32 s41, s57, 123904
buffer_load_dwordx4 v9, s[20:23], s41 offen lds
s_mov_b32 m0, 5120
s_add_u32 s41, s57, 129024
buffer_load_dwordx4 v9, s[20:23], s41 offen lds
s_mov_b32 m0, 12288
s_add_u32 s41, s57, 144384
buffer_load_dwordx4 v9, s[20:23], s41 offen lds
s_mov_b32 m0, 13312
s_add_u32 s41, s57, 149504
buffer_load_dwordx4 v9, s[20:23], s41 offen lds
s_mov_b32 m0, 20480
s_add_u32 s41, s56, 262272
buffer_load_dwordx4 v8, s[12:15], s41 offen lds
s_mov_b32 m0, 21504
s_add_u32 s41, s56, 327808
buffer_load_dwordx4 v8, s[12:15], s41 offen lds
s_mov_b32 m0, 28672
s_add_u32 s41, s56, 786560
buffer_load_dwordx4 v8, s[12:15], s41 offen lds
s_mov_b32 m0, 29696
s_add_u32 s41, s56, 852096
buffer_load_dwordx4 v8, s[12:15], s41 offen lds
ds_read_b64_tr_b16 a[216:217], v1 offset:32768
ds_read_b64_tr_b16 a[218:219], v1 offset:33792
ds_read_b64_tr_b16 a[220:221], v1 offset:36864
ds_read_b64_tr_b16 a[222:223], v1 offset:37888
ds_read_b64_tr_b16 a[232:233], v1 offset:40960
ds_read_b64_tr_b16 a[234:235], v1 offset:41984
ds_read_b64_tr_b16 a[236:237], v1 offset:45056
ds_read_b64_tr_b16 a[238:239], v1 offset:46080
ds_read_b64_tr_b16 a[240:241], v1 offset:49152
ds_read_b64_tr_b16 a[242:243], v1 offset:50176
ds_read_b64_tr_b16 a[244:245], v1 offset:53248
ds_read_b64_tr_b16 a[246:247], v1 offset:54272
ds_read_b64_tr_b16 v[168:169], v5 offset:57344
ds_read_b64_tr_b16 v[170:171], v5 offset:57856
ds_read_b64_tr_b16 v[172:173], v5 offset:59392
ds_read_b64_tr_b16 v[174:175], v5 offset:59904
s_waitcnt lgkmcnt(0)
s_waitcnt vmcnt(24)
s_barrier
s_mov_b32 m0, 36864
s_add_u32 s41, s56, 2359424
buffer_load_dwordx4 v8, s[12:15], s41 offen lds
s_mov_b32 m0, 37888
s_add_u32 s41, s56, 2424960
buffer_load_dwordx4 v8, s[12:15], s41 offen lds
s_mov_b32 m0, 45056
s_add_u32 s41, s56, 3932288
buffer_load_dwordx4 v8, s[12:15], s41 offen lds
s_mov_b32 m0, 46080
s_add_u32 s41, s56, 3997824
buffer_load_dwordx4 v8, s[12:15], s41 offen lds
s_mov_b32 m0, 53248
s_add_u32 s41, s56, 1835136
buffer_load_dwordx4 v8, s[12:15], s41 offen lds
s_mov_b32 m0, 54272
s_add_u32 s41, s56, 1900672
buffer_load_dwordx4 v8, s[12:15], s41 offen lds
s_mov_b32 m0, 61440
s_add_u32 s41, s56, 2883712
buffer_load_dwordx4 v8, s[12:15], s41 offen lds
s_mov_b32 m0, 62464
s_add_u32 s41, s56, 2949248
buffer_load_dwordx4 v8, s[12:15], s41 offen lds
ds_read_b64_tr_b16 v[144:145], v6 offset:0
ds_read_b64_tr_b16 v[146:147], v6 offset:512
ds_read_b64_tr_b16 v[148:149], v6 offset:2048
ds_read_b64_tr_b16 v[150:151], v6 offset:2560
ds_read_b64_tr_b16 v[160:161], v6 offset:8192
ds_read_b64_tr_b16 v[162:163], v6 offset:8704
ds_read_b64_tr_b16 v[164:165], v6 offset:10240
ds_read_b64_tr_b16 v[166:167], v6 offset:10752
ds_read_b64_tr_b16 v[192:193], v6 offset:16384
ds_read_b64_tr_b16 v[194:195], v6 offset:16896
ds_read_b64_tr_b16 v[196:197], v6 offset:18432
ds_read_b64_tr_b16 v[198:199], v6 offset:18944
ds_read_b64_tr_b16 v[40:41], v6 offset:24576
ds_read_b64_tr_b16 v[42:43], v6 offset:25088
ds_read_b64_tr_b16 v[44:45], v6 offset:26624
ds_read_b64_tr_b16 v[46:47], v6 offset:27136
s_waitcnt lgkmcnt(0)
buffer_store_dwordx4 v[40:43], v0, s[4:7], s63 offen offset:0
buffer_store_dwordx4 v[44:47], v0, s[4:7], s63 offen offset:1024
s_waitcnt vmcnt(26)
s_barrier
s_mov_b32 m0, 69632
s_add_u32 s41, s56, 4456576
buffer_load_dwordx4 v8, s[12:15], s41 offen lds
s_mov_b32 m0, 70656
s_add_u32 s41, s56, 4522112
buffer_load_dwordx4 v8, s[12:15], s41 offen lds
s_mov_b32 m0, 77824
s_add_u32 s41, s56, 262272
buffer_load_dwordx4 v8, s[16:19], s41 offen lds
s_mov_b32 m0, 78848
s_add_u32 s41, s56, 327808
buffer_load_dwordx4 v8, s[16:19], s41 offen lds
s_mov_b32 m0, 86016
s_add_u32 s41, s56, 786560
buffer_load_dwordx4 v8, s[16:19], s41 offen lds
s_mov_b32 m0, 87040
s_add_u32 s41, s56, 852096
buffer_load_dwordx4 v8, s[16:19], s41 offen lds
s_mov_b32 m0, 94208
s_add_u32 s41, s56, 2359424
buffer_load_dwordx4 v8, s[16:19], s41 offen lds
s_mov_b32 m0, 95232
s_add_u32 s41, s56, 2424960
buffer_load_dwordx4 v8, s[16:19], s41 offen lds
ds_read_b64_tr_b16 v[176:177], v6 offset:32768
ds_read_b64_tr_b16 v[178:179], v6 offset:33280
ds_read_b64_tr_b16 v[180:181], v6 offset:34816
ds_read_b64_tr_b16 v[182:183], v6 offset:35328
ds_read_b64_tr_b16 v[184:185], v6 offset:40960
ds_read_b64_tr_b16 v[186:187], v6 offset:41472
ds_read_b64_tr_b16 v[188:189], v6 offset:43008
ds_read_b64_tr_b16 v[190:191], v6 offset:43520
ds_read_b64_tr_b16 v[216:217], v6 offset:49152
ds_read_b64_tr_b16 v[218:219], v6 offset:49664
ds_read_b64_tr_b16 v[220:221], v6 offset:51200
ds_read_b64_tr_b16 v[222:223], v6 offset:51712
ds_read_b64_tr_b16 v[224:225], v6 offset:57344
ds_read_b64_tr_b16 v[226:227], v6 offset:57856
ds_read_b64_tr_b16 v[228:229], v6 offset:59392
ds_read_b64_tr_b16 v[230:231], v6 offset:59904
s_waitcnt lgkmcnt(0)
s_waitcnt vmcnt(26)
s_barrier
s_mov_b32 m0, 102400
s_add_u32 s41, s56, 2883712
buffer_load_dwordx4 v8, s[16:19], s41 offen lds
s_mov_b32 m0, 103424
s_add_u32 s41, s56, 2949248
buffer_load_dwordx4 v8, s[16:19], s41 offen lds
s_mov_b32 m0, 110592
s_add_u32 s41, s56, 3932288
buffer_load_dwordx4 v8, s[16:19], s41 offen lds
s_mov_b32 m0, 111616
s_add_u32 s41, s56, 3997824
buffer_load_dwordx4 v8, s[16:19], s41 offen lds
s_mov_b32 m0, 118784
s_add_u32 s41, s56, 4456576
buffer_load_dwordx4 v8, s[16:19], s41 offen lds
s_mov_b32 m0, 119808
s_add_u32 s41, s56, 4522112
buffer_load_dwordx4 v8, s[16:19], s41 offen lds
s_mov_b32 m0, 126976
s_add_u32 s41, s57, 81920
buffer_load_dwordx4 v9, s[20:23], s41 offen lds
s_mov_b32 m0, 128000
s_add_u32 s41, s57, 87040
buffer_load_dwordx4 v9, s[20:23], s41 offen lds
ds_read_b64_tr_b16 v[200:201], v7 offset:0
ds_read_b64_tr_b16 v[202:203], v7 offset:512
ds_read_b64_tr_b16 v[204:205], v7 offset:2048
ds_read_b64_tr_b16 v[206:207], v7 offset:2560
ds_read_b64_tr_b16 v[208:209], v7 offset:8192
ds_read_b64_tr_b16 v[210:211], v7 offset:8704
ds_read_b64_tr_b16 v[212:213], v7 offset:10240
ds_read_b64_tr_b16 v[214:215], v7 offset:10752
ds_read_b64_tr_b16 v[248:249], v7 offset:16384
ds_read_b64_tr_b16 v[250:251], v7 offset:16896
ds_read_b64_tr_b16 v[252:253], v7 offset:18432
ds_read_b64_tr_b16 v[254:255], v7 offset:18944
ds_read_b64_tr_b16 v[40:41], v7 offset:24576
ds_read_b64_tr_b16 v[42:43], v7 offset:25088
ds_read_b64_tr_b16 v[44:45], v7 offset:26624
ds_read_b64_tr_b16 v[46:47], v7 offset:27136
s_waitcnt lgkmcnt(0)
buffer_store_dwordx4 v[40:43], v0, s[4:7], s63 offen offset:2048
buffer_store_dwordx4 v[44:47], v0, s[4:7], s63 offen offset:3072
s_waitcnt vmcnt(32)
s_barrier
s_mov_b32 m0, 135168
s_add_u32 s41, s57, 102400
buffer_load_dwordx4 v9, s[20:23], s41 offen lds
s_mov_b32 m0, 136192
s_add_u32 s41, s57, 107520
buffer_load_dwordx4 v9, s[20:23], s41 offen lds
s_mov_b32 m0, 143360
s_add_u32 s41, s57, 122880
buffer_load_dwordx4 v9, s[20:23], s41 offen lds
s_mov_b32 m0, 144384
s_add_u32 s41, s57, 128000
buffer_load_dwordx4 v9, s[20:23], s41 offen lds
s_mov_b32 m0, 151552
s_add_u32 s41, s57, 143360
buffer_load_dwordx4 v9, s[20:23], s41 offen lds
s_mov_b32 m0, 152576
s_add_u32 s41, s57, 148480
buffer_load_dwordx4 v9, s[20:23], s41 offen lds
s_mov_b32 m0, 159744
s_add_u32 s41, s57, 82176
buffer_load_dwordx4 v9, s[20:23], s41 offen lds
s_mov_b32 m0, 160768
s_add_u32 s41, s57, 87296
buffer_load_dwordx4 v9, s[20:23], s41 offen lds
ds_read_b64_tr_b16 v[232:233], v5 offset:0
ds_read_b64_tr_b16 v[234:235], v5 offset:512
ds_read_b64_tr_b16 v[236:237], v5 offset:2048
ds_read_b64_tr_b16 v[238:239], v5 offset:2560
ds_read_b64_tr_b16 v[240:241], v5 offset:8192
ds_read_b64_tr_b16 v[242:243], v5 offset:8704
ds_read_b64_tr_b16 v[244:245], v5 offset:10240
ds_read_b64_tr_b16 v[246:247], v5 offset:10752
s_waitcnt lgkmcnt(0)
s_waitcnt vmcnt(20)
s_barrier
ds_read_b64_tr_b16 v[8:9], v1 offset:16384
ds_read_b64_tr_b16 v[10:11], v1 offset:17408
ds_read_b64_tr_b16 v[12:13], v1 offset:20480
ds_read_b64_tr_b16 v[14:15], v1 offset:21504
ds_read_b64_tr_b16 v[16:17], v1 offset:24576
ds_read_b64_tr_b16 v[18:19], v1 offset:25600
ds_read_b64_tr_b16 v[20:21], v1 offset:28672
ds_read_b64_tr_b16 v[22:23], v1 offset:29696
ds_read_b64_tr_b16 v[24:25], v1 offset:32768
ds_read_b64_tr_b16 v[26:27], v1 offset:33792
ds_read_b64_tr_b16 v[28:29], v1 offset:36864
ds_read_b64_tr_b16 v[30:31], v1 offset:37888
ds_read_b64_tr_b16 v[32:33], v1 offset:40960
ds_read_b64_tr_b16 v[34:35], v1 offset:41984
ds_read_b64_tr_b16 v[36:37], v1 offset:45056
ds_read_b64_tr_b16 v[38:39], v1 offset:46080
ds_read_b64_tr_b16 v[40:41], v1 offset:49152
ds_read_b64_tr_b16 v[42:43], v1 offset:50176
ds_read_b64_tr_b16 v[44:45], v1 offset:53248
ds_read_b64_tr_b16 v[46:47], v1 offset:54272
ds_read_b64_tr_b16 v[48:49], v1 offset:57344
ds_read_b64_tr_b16 v[50:51], v1 offset:58368
ds_read_b64_tr_b16 v[52:53], v1 offset:61440
ds_read_b64_tr_b16 v[54:55], v1 offset:62464
ds_read_b64_tr_b16 v[56:57], v2 offset:0
ds_read_b64_tr_b16 v[58:59], v2 offset:1024
ds_read_b64_tr_b16 v[60:61], v2 offset:4096
ds_read_b64_tr_b16 v[62:63], v2 offset:5120
ds_read_b64_tr_b16 v[64:65], v2 offset:8192
ds_read_b64_tr_b16 v[66:67], v2 offset:9216
ds_read_b64_tr_b16 v[68:69], v2 offset:12288
ds_read_b64_tr_b16 v[70:71], v2 offset:13312
ds_read_b64_tr_b16 v[72:73], v2 offset:16384
ds_read_b64_tr_b16 v[74:75], v2 offset:17408
ds_read_b64_tr_b16 v[76:77], v2 offset:20480
ds_read_b64_tr_b16 v[78:79], v2 offset:21504
s_waitcnt lgkmcnt(0)
s_barrier
ds_write_b128 v0, v[8:11] offset:53248
ds_write_b128 v0, v[12:15] offset:54272
ds_write_b128 v0, v[16:19] offset:55296
ds_write_b128 v0, v[20:23] offset:56320
ds_write_b128 v0, a[168:171] offset:57344
ds_write_b128 v0, a[172:175] offset:58368
ds_write_b128 v0, v[32:35] offset:59392
ds_write_b128 v0, v[36:39] offset:60416
ds_write_b128 v0, v[40:43] offset:61440
ds_write_b128 v0, v[44:47] offset:62464
ds_write_b128 v0, a[184:187] offset:63488
ds_write_b128 v0, a[188:191] offset:64512
ds_write_b128 v4, v[56:59] offset:0
ds_write_b128 v4, v[60:63] offset:1024
ds_write_b128 v4, v[80:83] offset:2048
ds_write_b128 v4, v[84:87] offset:3072
ds_write_b128 v4, v[72:75] offset:4096
ds_write_b128 v4, v[76:79] offset:5120
s_waitcnt lgkmcnt(0)
v_accvgpr_write_b32 a168, v24
v_accvgpr_write_b32 a169, v25
v_accvgpr_write_b32 a170, v26
v_accvgpr_write_b32 a171, v27
v_accvgpr_write_b32 a172, v28
v_accvgpr_write_b32 a173, v29
v_accvgpr_write_b32 a174, v30
v_accvgpr_write_b32 a175, v31
v_accvgpr_write_b32 a184, v48
v_accvgpr_write_b32 a185, v49
v_accvgpr_write_b32 a186, v50
v_accvgpr_write_b32 a187, v51
v_accvgpr_write_b32 a188, v52
v_accvgpr_write_b32 a189, v53
v_accvgpr_write_b32 a190, v54
v_accvgpr_write_b32 a191, v55
v_mov_b32 v80, v64
v_mov_b32 v81, v65
v_mov_b32 v82, v66
v_mov_b32 v83, v67
v_mov_b32 v84, v68
v_mov_b32 v85, v69
v_mov_b32 v86, v70
v_mov_b32 v87, v71
s_waitcnt vmcnt(0)
s_barrier
ds_read_b64_tr_b16 v[8:9], v2 offset:24576
ds_read_b64_tr_b16 v[10:11], v2 offset:25600
ds_read_b64_tr_b16 v[12:13], v2 offset:28672
ds_read_b64_tr_b16 v[14:15], v2 offset:29696
ds_read_b64_tr_b16 v[16:17], v2 offset:32768
ds_read_b64_tr_b16 v[18:19], v2 offset:33792
ds_read_b64_tr_b16 v[20:21], v2 offset:36864
ds_read_b64_tr_b16 v[22:23], v2 offset:37888
ds_read_b64_tr_b16 v[24:25], v2 offset:40960
ds_read_b64_tr_b16 v[26:27], v2 offset:41984
ds_read_b64_tr_b16 v[28:29], v2 offset:45056
ds_read_b64_tr_b16 v[30:31], v2 offset:46080
ds_read_b64_tr_b16 v[32:33], v2 offset:49152
ds_read_b64_tr_b16 v[34:35], v2 offset:50176
ds_read_b64_tr_b16 v[36:37], v2 offset:53248
ds_read_b64_tr_b16 v[38:39], v2 offset:54272
ds_read_b64_tr_b16 v[40:41], v6 offset:57344
ds_read_b64_tr_b16 v[42:43], v6 offset:57856
ds_read_b64_tr_b16 v[44:45], v6 offset:59392
ds_read_b64_tr_b16 v[46:47], v6 offset:59904
ds_read_b64_tr_b16 v[48:49], v7 offset:0
ds_read_b64_tr_b16 v[50:51], v7 offset:512
ds_read_b64_tr_b16 v[52:53], v7 offset:2048
ds_read_b64_tr_b16 v[54:55], v7 offset:2560
ds_read_b64_tr_b16 v[56:57], v7 offset:8192
ds_read_b64_tr_b16 v[58:59], v7 offset:8704
ds_read_b64_tr_b16 v[60:61], v7 offset:10240
ds_read_b64_tr_b16 v[62:63], v7 offset:10752
ds_read_b64_tr_b16 v[64:65], v7 offset:16384
ds_read_b64_tr_b16 v[66:67], v7 offset:16896
ds_read_b64_tr_b16 v[68:69], v7 offset:18432
ds_read_b64_tr_b16 v[70:71], v7 offset:18944
ds_read_b64_tr_b16 v[72:73], v7 offset:24576
ds_read_b64_tr_b16 v[74:75], v7 offset:25088
ds_read_b64_tr_b16 v[76:77], v7 offset:26624
ds_read_b64_tr_b16 v[78:79], v7 offset:27136
s_waitcnt lgkmcnt(0)
s_barrier
ds_write_b128 v4, v[128:131] offset:24576
ds_write_b128 v4, v[132:135] offset:25600
ds_write_b128 v4, v[16:19] offset:26624
ds_write_b128 v4, v[20:23] offset:27648
ds_write_b128 v4, v[24:27] offset:28672
ds_write_b128 v4, v[28:31] offset:29696
ds_write_b128 v4, a[224:227] offset:30720
ds_write_b128 v4, a[228:231] offset:31744
ds_write_b128 v4, v[152:155] offset:32768
ds_write_b128 v4, v[156:159] offset:33792
ds_write_b128 v4, v[48:51] offset:34816
ds_write_b128 v4, v[52:55] offset:35840
ds_write_b128 v4, v[56:59] offset:36864
ds_write_b128 v4, v[60:63] offset:37888
ds_write_b128 v4, v[144:147] offset:38912
ds_write_b128 v4, v[148:151] offset:39936
ds_write_b128 v4, v[168:171] offset:40960
ds_write_b128 v4, v[172:175] offset:41984
s_waitcnt lgkmcnt(0)
v_mov_b32 v128, v8
v_mov_b32 v129, v9
v_mov_b32 v130, v10
v_mov_b32 v131, v11
v_mov_b32 v132, v12
v_mov_b32 v133, v13
v_mov_b32 v134, v14
v_mov_b32 v135, v15
v_accvgpr_write_b32 a224, v32
v_accvgpr_write_b32 a225, v33
v_accvgpr_write_b32 a226, v34
v_accvgpr_write_b32 a227, v35
v_accvgpr_write_b32 a228, v36
v_accvgpr_write_b32 a229, v37
v_accvgpr_write_b32 a230, v38
v_accvgpr_write_b32 a231, v39
v_mov_b32 v152, v40
v_mov_b32 v153, v41
v_mov_b32 v154, v42
v_mov_b32 v155, v43
v_mov_b32 v156, v44
v_mov_b32 v157, v45
v_mov_b32 v158, v46
v_mov_b32 v159, v47
v_mov_b32 v144, v64
v_mov_b32 v145, v65
v_mov_b32 v146, v66
v_mov_b32 v147, v67
v_mov_b32 v148, v68
v_mov_b32 v149, v69
v_mov_b32 v150, v70
v_mov_b32 v151, v71
v_mov_b32 v168, v72
v_mov_b32 v169, v73
v_mov_b32 v170, v74
v_mov_b32 v171, v75
v_mov_b32 v172, v76
v_mov_b32 v173, v77
v_mov_b32 v174, v78
v_mov_b32 v175, v79
v_lshrrev_b32 v8, 4, v0
v_and_b32 v9, 8, v8
v_cmp_ne_u32 s[42:43], 0, v9
v_and_b32 v9, 1, v8
v_cmp_ne_u32 s[44:45], 0, v9
v_bfe_u32 v9, v8, 1, 2
v_cmp_eq_u32 s[46:47], 0, v9
v_cmp_eq_u32 s[48:49], 1, v9
v_cmp_eq_u32 s[50:51], 2, v9
v_cmp_eq_u32 s[52:53], 3, v9
v_mov_b32 v1, 0x4444
v_mov_b32 v10, 0xeeee
v_cndmask_b32 v1, v1, v10, s[42:43]
v_mov_b32 v10, 0x3f80
v_cndmask_b32 v10, v10, 1.0, s[44:45]
v_bfe_u32 v11, v8, 4, 1
v_lshlrev_b32 v11, 1, v11
v_sub_u32 v9, v9, v11
v_cmp_eq_u32 vcc, 0, v9
s_nop 1
v_cndmask_b32 v2, 0, v10, vcc
v_cmp_eq_u32 vcc, 1, v9
s_nop 1
v_cndmask_b32 v3, 0, v10, vcc
v_lshrrev_b32 v9, 4, v8
v_and_b32 v10, 15, v8
v_lshlrev_b32 v10, 3, v10
v_lshl_add_u32 v5, v9, 12, v10
v_lshlrev_b32 v6, 2, v9
v_and_b32 v10, 3, v8
v_lshl_add_u32 v6, v10, 4, v6
v_bfe_u32 v10, v8, 2, 1
v_lshl_add_u32 v6, v10, 7, v6
v_and_b32 v7, 511, v0
s_mov_b32 s54, 0x3e0293ee
s_cmp_lg_u32 s3, 0
s_cbranch_scc1 k_wdd_169
v_mov_b32 v8, 192
k_wd_168:
global_load_dword v9, v8, s[28:29] sc1
s_waitcnt vmcnt(0)
v_readfirstlane_b32 s41, v9
s_cmp_ge_u32 s41, 32
s_cbranch_scc1 k_wdd_169
s_sleep 2
s_sub_u32 s32, s32, 1
s_cmp_gt_i32 s32, 0
s_cbranch_scc1 k_wd_168
k_wdd_169:
s_barrier
s_mov_b32 s68, 0
s_mov_b32 s31, 0
s_mov_b32 s33, 117446656
s_mov_b32 s34, 117440512
s_lshl_b32 s35, s30, 14
s_add_u32 s35, s35, 8192
s_lshl_b32 s40, s30, 13
s_add_u32 s40, s40, 83890176
s_lshl_b32 s36, s30, 7
s_add_u32 s36, s36, 119570432
s_mov_b32 s55, 327680
s_cmp_ge_u32 s30, 16
s_cbranch_scc1 k_nored_170
s_add_u32 s41, s30, 64
s_lshl_b32 s37, s41, 12
s_add_u32 s37, s37, 119537664
s_add_u32 s59, s37, 327680
s_lshr_b32 s56, s41, 1
s_and_b32 s41, s41, 1
s_lshl_b32 s38, s56, 8
s_lshl_b32 s57, s41, 6
s_add_u32 s38, s38, s57
s_add_u32 s38, s38, 117440512
s_mul_i32 s41, s41, 5120
s_lshl_b32 s56, s56, 5
s_add_u32 s41, s41, s56
v_lshrrev_b32 v8, 4, v0
v_and_b32 v9, 3, v8
v_mul_u32_u24 v9, 1280, v9
v_bfe_u32 v10, v8, 2, 1
v_lshl_add_u32 v9, v10, 1, v9
v_bfe_u32 v10, v8, 4, 1
v_lshl_add_u32 v9, v10, 4, v9
v_bfe_u32 v10, v8, 5, 1
v_lshl_add_u32 v9, v10, 2, v9
buffer_load_ushort v10, v9, s[24:27], s41 offen
buffer_load_ushort v11, v9, s[24:27], s41 offen offset:8
v_mov_b64 v[12:13], -1
v_mov_b64 v[14:15], -1
s_waitcnt vmcnt(0)
v_lshl_or_b32 v10, v11, 16, v10
buffer_store_dword v10, v6, s[4:7], s38 offen
s_add_u32 s38, s38, 10240
buffer_store_dword v12, v6, s[4:7], s38 offen
s_add_u32 s58, s38, 10240
buffer_store_dwordx4 v[12:15], v0, s[4:7], s37 offen offset:0
buffer_store_dwordx4 v[12:15], v0, s[4:7], s37 offen offset:1024
buffer_store_dwordx4 v[12:15], v0, s[4:7], s37 offen offset:2048
buffer_store_dwordx4 v[12:15], v0, s[4:7], s37 offen offset:3072
k_nored_170:
s_waitcnt vmcnt(0)
s_barrier
s_barrier
buffer_load_dwordx4 v[40:43], v0, s[4:7], s60 offen offset:0
buffer_load_dwordx4 v[44:47], v0, s[4:7], s60 offen offset:1024
buffer_load_dwordx4 v[48:51], v0, s[4:7], s60 offen offset:2048
buffer_load_dwordx4 v[52:55], v0, s[4:7], s60 offen offset:3072
buffer_load_dwordx4 v[64:67], v0, s[4:7], s61 offen offset:0
buffer_load_dwordx4 v[68:71], v0, s[4:7], s61 offen offset:1024
buffer_load_dwordx4 v[72:75], v0, s[4:7], s61 offen offset:2048
buffer_load_dwordx4 v[76:79], v0, s[4:7], s61 offen offset:3072
buffer_load_dwordx4 v[56:59], v0, s[4:7], s62 offen offset:0
buffer_load_dwordx4 v[60:63], v0, s[4:7], s62 offen offset:1024
v_mov_b64 v[24:25], 0
v_mov_b64 v[26:27], 0
v_mov_b64 v[28:29], 0
v_mov_b64 v[30:31], 0
v_mov_b64 v[32:33], 0
v_mov_b64 v[34:35], 0
v_mov_b64 v[36:37], 0
v_mov_b64 v[38:39], 0
k_top_171:
s_add_u32 s41, s31, 0
s_cmp_gt_u32 s68, s41
s_cbranch_scc1 k_cd_180
s_lshl_b32 s56, s30, 6
s_add_u32 s56, s56, 222330880
k_ck_179:
buffer_load_dwordx2 v[8:9], off, s[4:7], s56 sc1
s_waitcnt vmcnt(0)
v_min_u32 v8, v8, v9
s_nop 0
v_readfirstlane_b32 s68, v8
s_cmp_gt_u32 s68, s41
s_cbranch_scc1 k_cd_180
s_sub_u32 s32, s32, 1
s_cmp_gt_i32 s32, 0
s_cbranch_scc1 k_ck_179
k_cd_180:
k_poll2_172:
buffer_load_dwordx4 v[12:15], v0, s[4:7], s33 offen offset:0 sc1
buffer_load_dwordx4 v[16:19], v0, s[4:7], s33 offen offset:1024 sc1
buffer_load_dwordx4 v[20:23], v0, s[4:7], s33 offen offset:2048 sc1
s_waitcnt vmcnt(2)
v_max3_u32 v8, v12, v13, v14
v_max_u32 v8, v8, v15
s_waitcnt vmcnt(1)
v_max3_u32 v8, v8, v16, v17
v_max3_u32 v8, v8, v18, v19
s_waitcnt vmcnt(0)
v_max3_u32 v8, v8, v20, v21
v_max3_u32 v8, v8, v22, v23
v_cmp_eq_u32 vcc, -1, v8
s_cbranch_vccnz k_retry2_173
k_poll2_172_ok:
ds_write_b128 v0, v[12:15] offset:6144
v_smfmac_f32_16x16x64_bf16 v[24:27], v[16:19], v[64:71], v1
ds_write_b128 v0, v[16:19] offset:7168
v_smfmac_f32_16x16x64_bf16 v[28:31], v[16:19], v[72:79], v1
ds_write_b128 v0, v[20:23] offset:8192
v_smfmac_f32_16x16x64_bf16 v[24:27], v[12:15], v[40:47], v1
ds_read_b128 v[64:67], v0 offset:59392
v_smfmac_f32_16x16x64_bf16 v[28:31], v[12:15], v[48:55], v1
ds_read_b128 v[68:71], v0 offset:60416
v_smfmac_f32_16x16x64_bf16 v[24:27], v[20:23], v[56:63], v1
ds_read_b128 v[72:75], v4 offset:0
v_smfmac_f32_16x16x64_bf16 v[28:31], v[20:23], a[0:7], v1
ds_read_b128 v[76:79], v4 offset:1024
v_smfmac_f32_16x16x64_bf16 v[32:35], v[12:15], a[88:95], v1
buffer_load_dwordx4 v[40:43], v0, s[4:7], s62 offen offset:2048
v_smfmac_f32_16x16x64_bf16 v[36:39], v[12:15], a[96:103], v1
buffer_load_dwordx4 v[44:47], v0, s[4:7], s62 offen offset:3072
s_waitcnt lgkmcnt(4)
s_barrier
ds_read_b128 v[8:11], v0 offset:9216
v_smfmac_f32_16x16x64_bf16 v[32:35], v[16:19], a[104:111], v1
s_waitcnt lgkmcnt(3)
ds_read_b128 v[12:15], v0 offset:0
v_smfmac_f32_16x16x64_bf16 v[36:39], v[16:19], v[64:71], v1
ds_read_b128 v[16:19], v0 offset:1024
buffer_load_dwordx4 v[48:51], v0, s[4:7], s35 offen offset:0 sc1
v_smfmac_f32_16x16x64_bf16 v[32:35], v[20:23], a[112:119], v1
s_waitcnt lgkmcnt(3)
buffer_load_dwordx4 v[52:55], v0, s[4:7], s35 offen offset:1024 sc1
ds_read_b128 v[64:67], v0 offset:57344
v_smfmac_f32_16x16x64_bf16 v[36:39], v[20:23], v[72:79], v1
s_waitcnt lgkmcnt(3)
ds_read_b128 v[68:71], v0 offset:58368
ds_read_b128 v[20:23], v0 offset:2048
v_smfmac_f32_16x16x64_bf16 v[24:27], v[8:11], a[8:15], v1
ds_read_b128 v[72:75], v0 offset:63488
v_smfmac_f32_16x16x64_bf16 v[28:31], v[8:11], a[16:23], v1
s_waitcnt lgkmcnt(5)
ds_read_b128 v[8:11], v0 offset:3072
v_smfmac_f32_16x16x64_bf16 v[24:27], v[12:15], a[24:31], v1
s_waitcnt lgkmcnt(3)
ds_read_b128 v[76:79], v0 offset:64512
v_smfmac_f32_16x16x64_bf16 v[28:31], v[12:15], v[64:71], v1
ds_read_b128 v[12:15], v0 offset:4096
v_smfmac_f32_16x16x64_bf16 v[24:27], v[16:19], a[32:39], v1
ds_read_b128 v[64:67], v4 offset:2048
v_smfmac_f32_16x16x64_bf16 v[28:31], v[16:19], a[40:47], v1
s_waitcnt lgkmcnt(2)
ds_read_b128 v[16:19], v0 offset:5120
v_smfmac_f32_16x16x64_bf16 v[24:27], v[20:23], v[72:79], v1
ds_read_b128 v[68:71], v4 offset:3072
v_smfmac_f32_16x16x64_bf16 v[28:31], v[20:23], a[48:55], v1
buffer_load_dwordx4 v[56:59], v0, s[4:7], s35 offen offset:2048 sc1
v_smfmac_f32_16x16x64_bf16 v[24:27], v[8:11], a[56:63], v1
s_waitcnt lgkmcnt(0)
buffer_load_dwordx4 v[60:63], v0, s[4:7], s35 offen offset:3072 sc1
v_smfmac_f32_16x16x64_bf16 v[28:31], v[8:11], v[64:71], v1
ds_read_b128 v[72:75], v4 offset:24576
v_smfmac_f32_16x16x64_bf16 v[24:27], v[12:15], a[64:71], v1
ds_read_b128 v[76:79], v4 offset:25600
v_smfmac_f32_16x16x64_bf16 v[28:31], v[12:15], a[72:79], v1
s_waitcnt lgkmcnt(0)
ds_read_b128 v[64:67], v4 offset:30720
v_smfmac_f32_16x16x64_bf16 v[24:27], v[16:19], v[72:79], v1
ds_read_b128 v[68:71], v4 offset:31744
v_smfmac_f32_16x16x64_bf16 v[28:31], v[16:19], a[80:87], v1
ds_read_b128 v[72:75], v0 offset:61440
v_smfmac_f32_16x16x64_bf16 v[32:35], v[16:19], a[176:183], v1
ds_read_b128 v[76:79], v0 offset:62464
v_smfmac_f32_16x16x64_bf16 v[36:39], v[16:19], a[184:191], v1
s_waitcnt lgkmcnt(2)
ds_read_b128 v[16:19], v0 offset:1024
v_cvt_pk_bf16_f32 v24, v24, v25
v_smfmac_f32_16x16x64_bf16 v[32:35], v[12:15], v[64:71], v1
ds_read_b128 v[64:67], v0 offset:55296
v_cvt_pk_bf16_f32 v25, v26, v27
v_smfmac_f32_16x16x64_bf16 v[36:39], v[12:15], a[168:175], v1
ds_read_b128 v[68:71], v0 offset:56320
v_cvt_pk_bf16_f32 v28, v28, v29
v_mfma_f32_16x16x16_bf16 v[24:27], v[24:25], v[2:3], 0
ds_read_b128 v[12:15], v0 offset:0
v_cvt_pk_bf16_f32 v29, v30, v31
v_smfmac_f32_16x16x64_bf16 v[32:35], v[8:11], a[160:167], v1
v_mfma_f32_16x16x16_bf16 v[28:31], v[28:29], v[2:3], 0
s_waitcnt lgkmcnt(4)
v_smfmac_f32_16x16x64_bf16 v[36:39], v[8:11], v[72:79], v1
s_waitcnt vmcnt(4)
ds_read_b128 v[72:75], v0 offset:53248
v_cvt_pk_bf16_f32 v24, v24, v25
v_smfmac_f32_16x16x64_bf16 v[32:35], v[20:23], v[40:47], v1
ds_read_b128 v[76:79], v0 offset:54272
v_cvt_pk_bf16_f32 v25, v26, v27
v_smfmac_f32_16x16x64_bf16 v[36:39], v[20:23], a[152:159], v1
ds_read_b128 v[20:23], v0 offset:9216
v_cvt_pk_bf16_f32 v26, v28, v29
v_cvt_pk_bf16_f32 v27, v30, v31
s_waitcnt lgkmcnt(6)
v_smfmac_f32_16x16x64_bf16 v[32:35], v[16:19], a[144:151], v1
s_waitcnt vmcnt(3)
v_mov_b64 v[40:41], -1
v_mfma_f32_16x16x32_bf16 v[28:31], v[48:51], v[24:27], 0
s_waitcnt vmcnt(2)
v_mov_b64 v[42:43], -1
v_mfma_f32_16x16x32_bf16 v[8:11], v[52:55], v[24:27], 0
s_cmp_ge_u32 s30, 16
s_cbranch_scc1 k_nored2_178
buffer_store_dwordx4 v[40:43], v0, s[4:7], s59 offen offset:0
buffer_store_dwordx4 v[40:43], v0, s[4:7], s59 offen offset:1024
buffer_store_dwordx4 v[40:43], v0, s[4:7], s59 offen offset:2048
buffer_store_dwordx4 v[40:43], v0, s[4:7], s59 offen offset:3072
buffer_store_dword v40, v6, s[4:7], s58 offen
k_nored2_178:
s_waitcnt lgkmcnt(4)
v_smfmac_f32_16x16x64_bf16 v[36:39], v[16:19], v[64:71], v1
s_waitcnt lgkmcnt(3)
ds_read_b128 v[64:67], v4 offset:4096
v_mov_b64 v[44:45], 0
v_smfmac_f32_16x16x64_bf16 v[32:35], v[12:15], a[136:143], v1
s_waitcnt lgkmcnt(2)
ds_read_b128 v[68:71], v4 offset:5120
v_mov_b64 v[46:47], 0
v_smfmac_f32_16x16x64_bf16 v[36:39], v[12:15], v[72:79], v1
ds_read_b128 v[72:75], v4 offset:32768
v_cndmask_b32 v28, v28, v8, s[42:43]
v_cndmask_b32 v29, v29, v9, s[42:43]
s_waitcnt lgkmcnt(3)
v_smfmac_f32_16x16x64_bf16 v[32:35], v[20:23], a[120:127], v1
ds_read_b128 v[76:79], v4 offset:33792
v_cndmask_b32 v30, v30, v10, s[42:43]
v_cndmask_b32 v31, v31, v11, s[42:43]
v_smfmac_f32_16x16x64_bf16 v[36:39], v[20:23], a[128:135], v1
ds_write_b128 v0, v[28:31] offset:12288
v_mov_b64 v[40:41], 0
v_mov_b64 v[42:43], 0
v_smfmac_f32_16x16x64_bf16 v[44:47], v[20:23], a[240:247], v1
v_cvt_pk_bf16_f32 v32, v32, v33
v_cvt_pk_bf16_f32 v33, v34, v35
v_smfmac_f32_16x16x64_bf16 v[40:43], v[20:23], a[232:239], v1
ds_read_b128 v[20:23], v0 offset:2048
v_mfma_f32_16x16x16_bf16 v[32:35], v[32:33], v[2:3], 0
v_cvt_pk_bf16_f32 v36, v36, v37
v_cvt_pk_bf16_f32 v37, v38, v39
s_waitcnt lgkmcnt(0)
s_barrier
v_mfma_f32_16x16x16_bf16 v[36:39], v[36:37], v[2:3], 0
ds_read_b128 v[48:51], v0 offset:13312
v_smfmac_f32_16x16x64_bf16 v[40:43], v[12:15], a[248:255], v1
ds_read_b128 v[52:55], v0 offset:10240
v_cvt_pk_bf16_f32 v32, v32, v33
v_cvt_pk_bf16_f32 v33, v34, v35
v_smfmac_f32_16x16x64_bf16 v[44:47], v[12:15], v[80:87], v1
ds_read_b128 v[12:15], v0 offset:3072
v_cvt_pk_bf16_f32 v34, v36, v37
v_cvt_pk_bf16_f32 v35, v38, v39
s_nop 1
v_mfma_f32_16x16x32_bf16 v[36:39], v[32:35], v[24:27], 0
ds_read_b128 v[8:11], v0 offset:11264
v_smfmac_f32_16x16x64_bf16 v[40:43], v[16:19], v[88:95], v1
buffer_store_dwordx4 v[32:35], v0, s[4:7], s40 offen sc1
s_waitcnt lgkmcnt(3)
v_add_f32 v28, v28, v48
v_add_f32 v29, v29, v49
v_smfmac_f32_16x16x64_bf16 v[44:47], v[16:19], v[64:71], v1
ds_write_b128 v7, v[36:39] offset:15360
v_smfmac_f32_16x16x64_bf16 v[40:43], v[20:23], v[96:103], v1
ds_read_b128 v[16:19], v0 offset:4096
v_add_f32 v30, v30, v50
v_add_f32 v31, v31, v51
v_smfmac_f32_16x16x64_bf16 v[44:47], v[20:23], v[104:111], v1
ds_read_b128 v[20:23], v0 offset:5120
s_waitcnt lgkmcnt(5)
v_add_f32 v28, v28, v52
v_add_f32 v29, v29, v53
s_waitcnt lgkmcnt(4)
v_smfmac_f32_16x16x64_bf16 v[40:43], v[12:15], v[112:119], v1
ds_read_b128 v[64:67], v4 offset:26624
v_add_f32 v30, v30, v54
v_add_f32 v31, v31, v55
v_smfmac_f32_16x16x64_bf16 v[44:47], v[12:15], v[72:79], v1
ds_read_b128 v[12:15], v0 offset:6144
s_waitcnt lgkmcnt(5)
v_add_f32 v28, v28, v8
v_add_f32 v29, v29, v9
s_waitcnt lgkmcnt(3)
v_smfmac_f32_16x16x64_bf16 v[40:43], v[16:19], v[120:127], v1
ds_read_b128 v[68:71], v4 offset:27648
v_add_f32 v30, v30, v10
v_add_f32 v31, v31, v11
s_waitcnt lgkmcnt(0)
s_barrier
ds_read_b128 v[48:51], v7 offset:15872
ds_read_b128 v[52:55], v7 offset:14336
ds_read_b128 v[8:11], v7 offset:14848
v_smfmac_f32_16x16x64_bf16 v[44:47], v[16:19], v[128:135], v1
ds_read_b128 v[16:19], v0 offset:7168
v_max3_f32 v24, v28, v29, v30
v_smfmac_f32_16x16x64_bf16 v[40:43], v[20:23], v[136:143], v1
ds_read_b128 v[72:75], v4 offset:28672
v_max_f32 v24, v24, v31
v_smfmac_f32_16x16x64_bf16 v[44:47], v[20:23], v[64:71], v1
ds_read_b128 v[20:23], v0 offset:8192
v_max_f32_dpp v24, v24, v24 row_ror:8 row_mask:0xf bank_mask:0xf
v_smfmac_f32_16x16x64_bf16 v[40:43], v[12:15], a[192:199], v1
ds_read_b128 v[76:79], v4 offset:29696
v_mov_b32 v25, v24
v_smfmac_f32_16x16x64_bf16 v[44:47], v[12:15], a[200:207], v1
s_waitcnt lgkmcnt(3)
ds_read_b128 v[64:67], v4 offset:36864
v_permlane32_swap_b32 v24, v25
v_smfmac_f32_16x16x64_bf16 v[40:43], v[16:19], a[208:215], v1
s_waitcnt lgkmcnt(1)
ds_read_b128 v[68:71], v4 offset:37888
v_max_f32 v24, v24, v25
v_smfmac_f32_16x16x64_bf16 v[44:47], v[16:19], v[72:79], v1
ds_read_b128 v[72:75], v4 offset:38912
v_smfmac_f32_16x16x64_bf16 v[40:43], v[20:23], a[216:223], v1
ds_read_b128 v[76:79], v4 offset:39936
v_smfmac_f32_16x16x64_bf16 v[44:47], v[20:23], a[224:231], v1
v_add_f32 v36, v36, v48
v_add_f32 v37, v37, v49
v_add_f32 v38, v38, v50
v_add_f32 v39, v39, v51
v_add_f32 v36, v36, v52
v_add_f32 v37, v37, v53
v_add_f32 v38, v38, v54
v_add_f32 v39, v39, v55
v_add_f32 v36, v36, v8
v_add_f32 v37, v37, v9
v_add_f32 v38, v38, v10
v_add_f32 v39, v39, v11
buffer_load_dwordx4 v[48:51], v0, s[4:7], s63 offen offset:0
buffer_load_dwordx4 v[52:55], v0, s[4:7], s63 offen offset:1024
v_max3_f32 v24, v24, v36, v37
v_max3_f32 v24, v24, v38, v39
v_mov_b32 v25, v24
v_cvt_pk_bf16_f32 v40, v40, v41
v_cvt_pk_bf16_f32 v41, v42, v43
v_permlane16_swap_b32 v24, v25
v_max_f32 v24, v24, v25
v_mul_f32 v24, s54, v24
v_fma_f32 v28, v28, s54, -v24
v_exp_f32 v28, v28
v_fma_f32 v29, v29, s54, -v24
v_exp_f32 v29, v29
v_fma_f32 v30, v30, s54, -v24
v_exp_f32 v30, v30
v_fma_f32 v31, v31, s54, -v24
v_exp_f32 v31, v31
v_fma_f32 v36, v36, s54, -v24
v_exp_f32 v36, v36
v_fma_f32 v37, v37, s54, -v24
v_exp_f32 v37, v37
v_fma_f32 v38, v38, s54, -v24
v_exp_f32 v38, v38
v_fma_f32 v39, v39, s54, -v24
v_exp_f32 v39, v39
v_cvt_pk_bf16_f32 v24, v28, v29
v_cvt_pk_bf16_f32 v25, v30, v31
v_cvt_pk_bf16_f32 v26, v28, v29
v_cvt_pk_bf16_f32 v27, v30, v31
v_cvt_pk_bf16_f32 v32, v36, v37
v_cvt_pk_bf16_f32 v33, v38, v39
v_mov_b32_dpp v24, v26 row_ror:8 row_mask:0xf bank_mask:0xc
v_mov_b32_dpp v25, v27 row_ror:8 row_mask:0xf bank_mask:0xc
v_mov_b32_dpp v26, v26 row_ror:8 row_mask:0xf bank_mask:0x3
v_mov_b32_dpp v27, v27 row_ror:8 row_mask:0xf bank_mask:0x3
v_cvt_pk_bf16_f32 v42, v44, v45
v_cvt_pk_bf16_f32 v43, v46, v47
v_mov_b32 v8, 0x40004000
v_mov_b32 v9, 0x40004000
v_mov_b32 v10, 0x40004000
v_mov_b32 v11, 0x40004000
v_mov_b32 v34, 0x3f803f80
v_mov_b32 v35, 0x3f803f80
buffer_store_dwordx4 v[40:43], v0, s[4:7], s40 offen offset:1024 sc1
s_cmp_eq_u32 s31, 63
s_cbranch_scc1 k_done_174
v_mfma_f32_16x16x32_bf16 v[20:23], v[8:11], v[24:27], 0
s_waitcnt vmcnt(5)
v_mov_b64 v[28:29], 0
v_mov_b64 v[30:31], 0
v_mfma_f32_16x16x32_bf16 v[12:15], v[56:59], v[24:27], 0
v_mov_b64 v[36:37], 0
v_mov_b64 v[38:39], 0
v_mfma_f32_16x16x16_bf16 v[20:23], v[34:35], v[32:33], v[20:23]
s_waitcnt vmcnt(4)
v_mov_b64 v[44:45], 0
v_mov_b64 v[46:47], 0
v_mfma_f32_16x16x32_bf16 v[16:19], v[60:63], v[24:27], 0
buffer_load_dwordx4 v[56:59], v0, s[4:7], s63 offen offset:2048
v_mov_b64 v[24:25], 0
v_mfma_f32_16x16x16_bf16 v[12:15], v[40:41], v[32:33], v[12:15]
buffer_load_dwordx4 v[60:63], v0, s[4:7], s63 offen offset:3072
v_rcp_f32 v20, v20
v_mfma_f32_16x16x16_bf16 v[16:19], v[42:43], v[32:33], v[16:19]
v_mov_b64 v[26:27], 0
s_nop 1
v_mul_f32 v12, v12, v20
v_mul_f32 v13, v13, v20
v_mul_f32 v14, v14, v20
v_mul_f32 v15, v15, v20
v_cvt_pk_bf16_f32 v8, v12, v13
v_cvt_pk_bf16_f32 v9, v14, v15
v_mul_f32 v16, v16, v20
v_mul_f32 v17, v17, v20
v_mul_f32 v18, v18, v20
v_mul_f32 v19, v19, v20
v_cvt_pk_bf16_f32 v10, v16, v17
v_cvt_pk_bf16_f32 v11, v18, v19
ds_write_b128 v0, v[8:11] offset:12288
s_waitcnt lgkmcnt(3)
v_smfmac_f32_16x16x64_bf16 v[44:47], v[8:11], v[64:71], v1
s_waitcnt lgkmcnt(1)
v_mov_b64 v[32:33], 0
v_smfmac_f32_16x16x64_bf16 v[28:31], v[8:11], v[72:79], v1
v_mov_b64 v[34:35], 0
v_smfmac_f32_16x16x64_bf16 v[36:39], v[8:11], v[176:183], v1
s_waitcnt lgkmcnt(0)
s_barrier
ds_read_b128 v[12:15], v0 offset:13312
v_smfmac_f32_16x16x64_bf16 v[24:27], v[8:11], v[200:207], v1
ds_read_b128 v[16:19], v0 offset:10240
ds_read_b128 v[20:23], v0 offset:11264
v_smfmac_f32_16x16x64_bf16 v[32:35], v[8:11], v[232:239], v1
ds_read_b128 v[64:67], v4 offset:34816
ds_read_b128 v[68:71], v4 offset:35840
ds_read_b128 v[72:75], v4 offset:40960
ds_read_b128 v[76:79], v4 offset:41984
s_mov_b32 s41, s36
s_waitcnt lgkmcnt(6)
v_smfmac_f32_16x16x64_bf16 v[44:47], v[12:15], v[144:151], v1
s_waitcnt lgkmcnt(5)
v_smfmac_f32_16x16x64_bf16 v[44:47], v[16:19], v[152:159], v1
s_waitcnt lgkmcnt(2)
v_smfmac_f32_16x16x64_bf16 v[44:47], v[20:23], v[64:71], v1
v_smfmac_f32_16x16x64_bf16 v[28:31], v[12:15], v[160:167], v1
buffer_load_dwordx4 v[64:67], v0, s[4:7], s61 offen offset:0
v_smfmac_f32_16x16x64_bf16 v[28:31], v[16:19], v[168:175], v1
buffer_load_dwordx4 v[68:71], v0, s[4:7], s61 offen offset:1024
v_cvt_pk_bf16_f32 v44, v44, v45
v_cvt_pk_bf16_f32 v45, v46, v47
buffer_store_dwordx2 v[44:45], v5, s[4:7], s41 offen
s_add_u32 s41, s41, 65536
s_waitcnt lgkmcnt(0)
v_smfmac_f32_16x16x64_bf16 v[28:31], v[20:23], v[72:79], v1
buffer_load_dwordx4 v[40:43], v0, s[4:7], s60 offen offset:0
v_smfmac_f32_16x16x64_bf16 v[36:39], v[12:15], v[184:191], v1
buffer_load_dwordx4 v[44:47], v0, s[4:7], s60 offen offset:1024
v_smfmac_f32_16x16x64_bf16 v[36:39], v[16:19], v[192:199], v1
buffer_load_dwordx4 v[72:75], v0, s[4:7], s61 offen offset:2048
v_cvt_pk_bf16_f32 v28, v28, v29
v_cvt_pk_bf16_f32 v29, v30, v31
buffer_store_dwordx2 v[28:29], v5, s[4:7], s41 offen
s_add_u32 s41, s41, 65536
s_waitcnt vmcnt(10)
v_smfmac_f32_16x16x64_bf16 v[36:39], v[20:23], v[48:55], v1
buffer_load_dwordx4 v[76:79], v0, s[4:7], s61 offen offset:3072
v_smfmac_f32_16x16x64_bf16 v[24:27], v[12:15], v[208:215], v1
buffer_load_dwordx4 v[48:51], v0, s[4:7], s60 offen offset:2048
v_smfmac_f32_16x16x64_bf16 v[24:27], v[16:19], v[216:223], v1
buffer_load_dwordx4 v[52:55], v0, s[4:7], s60 offen offset:3072
v_cvt_pk_bf16_f32 v36, v36, v37
v_cvt_pk_bf16_f32 v37, v38, v39
buffer_store_dwordx2 v[36:37], v5, s[4:7], s41 offen
s_add_u32 s41, s41, 65536
v_smfmac_f32_16x16x64_bf16 v[24:27], v[20:23], v[224:231], v1
v_smfmac_f32_16x16x64_bf16 v[32:35], v[12:15], v[240:247], v1
v_smfmac_f32_16x16x64_bf16 v[32:35], v[16:19], v[248:255], v1
v_cvt_pk_bf16_f32 v24, v24, v25
v_cvt_pk_bf16_f32 v25, v26, v27
buffer_store_dwordx2 v[24:25], v5, s[4:7], s41 offen
s_add_u32 s41, s41, 65536
s_waitcnt vmcnt(12)
v_smfmac_f32_16x16x64_bf16 v[32:35], v[20:23], v[56:63], v1
s_nop 6
v_cvt_pk_bf16_f32 v32, v32, v33
v_cvt_pk_bf16_f32 v33, v34, v35
buffer_store_dwordx2 v[32:33], v5, s[4:7], s41 offen
s_add_u32 s41, s41, 65536
buffer_load_dwordx4 v[56:59], v0, s[4:7], s62 offen offset:0
buffer_load_dwordx4 v[60:63], v0, s[4:7], s62 offen offset:1024
s_add_u32 s31, s31, 1
s_add_u32 s33, s33, 10240
s_add_u32 s34, s34, 10240
s_add_u32 s35, s35, 524288
s_add_u32 s40, s40, 262144
s_add_u32 s36, s36, s55
s_cmp_ge_u32 s30, 16
s_cbranch_scc1 k_nored_177
v_mov_b32 v28, 0x4000
v_cndmask_b32 v28, v28, 2.0, s[44:45]
v_cndmask_b32 v24, 0, v28, s[46:47]
v_cndmask_b32 v25, 0, v28, s[48:49]
v_cndmask_b32 v26, 0, v28, s[50:51]
v_cndmask_b32 v27, 0, v28, s[52:53]
k_poll1_175:
buffer_load_dwordx4 v[8:11], v0, s[4:7], s37 offen offset:0 sc1
buffer_load_dwordx4 v[12:15], v0, s[4:7], s37 offen offset:1024 sc1
buffer_load_dwordx4 v[16:19], v0, s[4:7], s37 offen offset:2048 sc1
buffer_load_dwordx4 v[20:23], v0, s[4:7], s37 offen offset:3072 sc1
s_waitcnt vmcnt(3)
v_mfma_f32_16x16x32_bf16 v[28:31], v[8:11], v[24:27], 0
s_waitcnt vmcnt(2)
v_mfma_f32_16x16x32_bf16 v[28:31], v[12:15], v[24:27], v[28:31]
s_waitcnt vmcnt(1)
v_mfma_f32_16x16x32_bf16 v[28:31], v[16:19], v[24:27], v[28:31]
s_waitcnt vmcnt(0)
v_mfma_f32_16x16x32_bf16 v[28:31], v[20:23], v[24:27], v[28:31]
s_nop 7
v_permlane32_swap_b32 v28, v29
v_permlane32_swap_b32 v30, v31
v_add_f32 v28, v28, v29
v_add_f32 v29, v30, v31
v_cmp_u_f32 vcc, v28, v29
v_cvt_pk_bf16_f32 v28, v28, v29
s_cbranch_vccnz k_retry1_176
k_poll1_175_ok:
buffer_store_dword v28, v6, s[4:7], s38 offen
s_mov_b32 s59, s37
s_add_u32 s37, s37, s55
s_add_u32 s38, s38, 10240
s_add_u32 s58, s58, 10240
k_nored_177:
s_sub_u32 s55, 0, s55
v_mov_b64 v[24:25], 0
v_mov_b64 v[26:27], 0
v_mov_b64 v[28:29], 0
v_mov_b64 v[30:31], 0
v_mov_b64 v[32:33], 0
v_mov_b64 v[34:35], 0
v_mov_b64 v[36:37], 0
v_mov_b64 v[38:39], 0
s_branch k_top_171
k_retry2_173:
s_add_u32 s75, s75, 1
s_sub_u32 s32, s32, 1
s_cmp_gt_i32 s32, 0
s_cbranch_scc1 k_poll2_172
s_branch k_poll2_172_ok
k_retry1_176:
s_add_u32 s76, s76, 1
s_sub_u32 s32, s32, 1
s_cmp_gt_i32 s32, 0
s_cbranch_scc1 k_poll1_175
s_branch k_poll1_175_ok
k_done_174:
s_mov_b32 s31, 0
s_mov_b32 s33, 118495232
s_mov_b32 s34, 118489088
s_lshl_b32 s35, s30, 14
s_add_u32 s35, s35, 41951232
s_lshl_b32 s40, s30, 13
s_add_u32 s40, s40, 100667392
s_lshl_b32 s36, s30, 7
s_add_u32 s36, s36, 119570432
s_mov_b32 s55, 327680
s_cmp_ge_u32 s30, 16
s_cbranch_scc1 k_nored_181
s_add_u32 s41, s30, 64
s_lshl_b32 s37, s41, 12
s_add_u32 s37, s37, 119537664
s_add_u32 s59, s37, 327680
s_lshr_b32 s56, s41, 1
s_and_b32 s41, s41, 1
s_lshl_b32 s38, s56, 8
s_lshl_b32 s57, s41, 6
s_add_u32 s38, s38, s57
s_add_u32 s38, s38, 118489088
s_mul_i32 s41, s41, 5120
s_lshl_b32 s56, s56, 5
s_add_u32 s41, s41, s56
v_lshrrev_b32 v8, 4, v0
v_and_b32 v9, 3, v8
v_mul_u32_u24 v9, 1280, v9
v_bfe_u32 v10, v8, 2, 1
v_lshl_add_u32 v9, v10, 1, v9
v_bfe_u32 v10, v8, 4, 1
v_lshl_add_u32 v9, v10, 4, v9
v_bfe_u32 v10, v8, 5, 1
v_lshl_add_u32 v9, v10, 2, v9
buffer_load_ushort v10, v9, s[24:27], s41 offen
buffer_load_ushort v11, v9, s[24:27], s41 offen offset:8
v_mov_b64 v[12:13], -1
v_mov_b64 v[14:15], -1
s_waitcnt vmcnt(0)
v_lshl_or_b32 v10, v11, 16, v10
buffer_store_dword v10, v6, s[4:7], s38 offen
s_add_u32 s38, s38, 10240
buffer_store_dword v12, v6, s[4:7], s38 offen
s_add_u32 s58, s38, 10240
buffer_store_dwordx4 v[12:15], v0, s[4:7], s37 offen offset:0
buffer_store_dwordx4 v[12:15], v0, s[4:7], s37 offen offset:1024
buffer_store_dwordx4 v[12:15], v0, s[4:7], s37 offen offset:2048
buffer_store_dwordx4 v[12:15], v0, s[4:7], s37 offen offset:3072
k_nored_181:
s_waitcnt vmcnt(0)
s_barrier
s_barrier
buffer_load_dwordx4 v[40:43], v0, s[4:7], s60 offen offset:0
buffer_load_dwordx4 v[44:47], v0, s[4:7], s60 offen offset:1024
buffer_load_dwordx4 v[48:51], v0, s[4:7], s60 offen offset:2048
buffer_load_dwordx4 v[52:55], v0, s[4:7], s60 offen offset:3072
s_waitcnt lgkmcnt(3)
buffer_load_dwordx4 v[64:67], v0, s[4:7], s61 offen offset:0
s_waitcnt lgkmcnt(2)
buffer_load_dwordx4 v[68:71], v0, s[4:7], s61 offen offset:1024
s_waitcnt lgkmcnt(1)
buffer_load_dwordx4 v[72:75], v0, s[4:7], s61 offen offset:2048
s_waitcnt lgkmcnt(0)
buffer_load_dwordx4 v[76:79], v0, s[4:7], s61 offen offset:3072
buffer_load_dwordx4 v[56:59], v0, s[4:7], s62 offen offset:0
buffer_load_dwordx4 v[60:63], v0, s[4:7], s62 offen offset:1024
v_mov_b64 v[24:25], 0
v_mov_b64 v[26:27], 0
v_mov_b64 v[28:29], 0
v_mov_b64 v[30:31], 0
v_mov_b64 v[32:33], 0
v_mov_b64 v[34:35], 0
v_mov_b64 v[36:37], 0
v_mov_b64 v[38:39], 0
k_top_182:
s_add_u32 s41, s31, 64
s_cmp_gt_u32 s68, s41
s_cbranch_scc1 k_cd_191
s_lshl_b32 s56, s30, 6
s_add_u32 s56, s56, 222330880
k_ck_190:
buffer_load_dwordx2 v[8:9], off, s[4:7], s56 sc1
s_waitcnt vmcnt(0)
v_min_u32 v8, v8, v9
s_nop 0
v_readfirstlane_b32 s68, v8
s_cmp_gt_u32 s68, s41
s_cbranch_scc1 k_cd_191
s_sub_u32 s32, s32, 1
s_cmp_gt_i32 s32, 0
s_cbranch_scc1 k_ck_190
k_cd_191:
k_poll2_183:
buffer_load_dwordx4 v[12:15], v0, s[4:7], s33 offen offset:0 sc1
buffer_load_dwordx4 v[16:19], v0, s[4:7], s33 offen offset:1024 sc1
buffer_load_dwordx4 v[20:23], v0, s[4:7], s33 offen offset:2048 sc1
s_waitcnt vmcnt(2)
v_max3_u32 v8, v12, v13, v14
v_max_u32 v8, v8, v15
s_waitcnt vmcnt(1)
v_max3_u32 v8, v8, v16, v17
v_max3_u32 v8, v8, v18, v19
s_waitcnt vmcnt(0)
v_max3_u32 v8, v8, v20, v21
v_max3_u32 v8, v8, v22, v23
v_cmp_eq_u32 vcc, -1, v8
s_cbranch_vccnz k_retry2_184
k_poll2_183_ok:
ds_write_b128 v0, v[12:15] offset:6144
v_smfmac_f32_16x16x64_bf16 v[24:27], v[16:19], v[64:71], v1
ds_write_b128 v0, v[16:19] offset:7168
v_smfmac_f32_16x16x64_bf16 v[28:31], v[16:19], v[72:79], v1
ds_write_b128 v0, v[20:23] offset:8192
v_smfmac_f32_16x16x64_bf16 v[24:27], v[12:15], v[40:47], v1
ds_read_b128 v[64:67], v0 offset:59392
v_smfmac_f32_16x16x64_bf16 v[28:31], v[12:15], v[48:55], v1
ds_read_b128 v[68:71], v0 offset:60416
v_smfmac_f32_16x16x64_bf16 v[24:27], v[20:23], v[56:63], v1
ds_read_b128 v[72:75], v4 offset:0
v_smfmac_f32_16x16x64_bf16 v[28:31], v[20:23], a[0:7], v1
ds_read_b128 v[76:79], v4 offset:1024
v_smfmac_f32_16x16x64_bf16 v[32:35], v[12:15], a[88:95], v1
buffer_load_dwordx4 v[40:43], v0, s[4:7], s62 offen offset:2048
v_smfmac_f32_16x16x64_bf16 v[36:39], v[12:15], a[96:103], v1
buffer_load_dwordx4 v[44:47], v0, s[4:7], s62 offen offset:3072
s_waitcnt lgkmcnt(4)
s_barrier
ds_read_b128 v[8:11], v0 offset:9216
v_smfmac_f32_16x16x64_bf16 v[32:35], v[16:19], a[104:111], v1
s_waitcnt lgkmcnt(3)
ds_read_b128 v[12:15], v0 offset:0
v_smfmac_f32_16x16x64_bf16 v[36:39], v[16:19], v[64:71], v1
ds_read_b128 v[16:19], v0 offset:1024
buffer_load_dwordx4 v[48:51], v0, s[4:7], s35 offen offset:0 sc1
v_smfmac_f32_16x16x64_bf16 v[32:35], v[20:23], a[112:119], v1
s_waitcnt lgkmcnt(3)
buffer_load_dwordx4 v[52:55], v0, s[4:7], s35 offen offset:1024 sc1
ds_read_b128 v[64:67], v0 offset:57344
v_smfmac_f32_16x16x64_bf16 v[36:39], v[20:23], v[72:79], v1
s_waitcnt lgkmcnt(3)
ds_read_b128 v[68:71], v0 offset:58368
ds_read_b128 v[20:23], v0 offset:2048
v_smfmac_f32_16x16x64_bf16 v[24:27], v[8:11], a[8:15], v1
ds_read_b128 v[72:75], v0 offset:63488
v_smfmac_f32_16x16x64_bf16 v[28:31], v[8:11], a[16:23], v1
s_waitcnt lgkmcnt(5)
ds_read_b128 v[8:11], v0 offset:3072
v_smfmac_f32_16x16x64_bf16 v[24:27], v[12:15], a[24:31], v1
s_waitcnt lgkmcnt(3)
ds_read_b128 v[76:79], v0 offset:64512
v_smfmac_f32_16x16x64_bf16 v[28:31], v[12:15], v[64:71], v1
ds_read_b128 v[12:15], v0 offset:4096
v_smfmac_f32_16x16x64_bf16 v[24:27], v[16:19], a[32:39], v1
ds_read_b128 v[64:67], v4 offset:2048
v_smfmac_f32_16x16x64_bf16 v[28:31], v[16:19], a[40:47], v1
s_waitcnt lgkmcnt(2)
ds_read_b128 v[16:19], v0 offset:5120
v_smfmac_f32_16x16x64_bf16 v[24:27], v[20:23], v[72:79], v1
ds_read_b128 v[68:71], v4 offset:3072
v_smfmac_f32_16x16x64_bf16 v[28:31], v[20:23], a[48:55], v1
buffer_load_dwordx4 v[56:59], v0, s[4:7], s35 offen offset:2048 sc1
v_smfmac_f32_16x16x64_bf16 v[24:27], v[8:11], a[56:63], v1
s_waitcnt lgkmcnt(0)
buffer_load_dwordx4 v[60:63], v0, s[4:7], s35 offen offset:3072 sc1
v_smfmac_f32_16x16x64_bf16 v[28:31], v[8:11], v[64:71], v1
ds_read_b128 v[72:75], v4 offset:24576
v_smfmac_f32_16x16x64_bf16 v[24:27], v[12:15], a[64:71], v1
ds_read_b128 v[76:79], v4 offset:25600
v_smfmac_f32_16x16x64_bf16 v[28:31], v[12:15], a[72:79], v1
s_waitcnt lgkmcnt(0)
ds_read_b128 v[64:67], v4 offset:30720
v_smfmac_f32_16x16x64_bf16 v[24:27], v[16:19], v[72:79], v1
ds_read_b128 v[68:71], v4 offset:31744
v_smfmac_f32_16x16x64_bf16 v[28:31], v[16:19], a[80:87], v1
ds_read_b128 v[72:75], v0 offset:61440
v_smfmac_f32_16x16x64_bf16 v[32:35], v[16:19], a[176:183], v1
ds_read_b128 v[76:79], v0 offset:62464
v_smfmac_f32_16x16x64_bf16 v[36:39], v[16:19], a[184:191], v1
s_waitcnt lgkmcnt(2)
ds_read_b128 v[16:19], v0 offset:1024
v_cvt_pk_bf16_f32 v24, v24, v25
v_smfmac_f32_16x16x64_bf16 v[32:35], v[12:15], v[64:71], v1
ds_read_b128 v[64:67], v0 offset:55296
v_cvt_pk_bf16_f32 v25, v26, v27
v_smfmac_f32_16x16x64_bf16 v[36:39], v[12:15], a[168:175], v1
ds_read_b128 v[68:71], v0 offset:56320
v_cvt_pk_bf16_f32 v28, v28, v29
v_mfma_f32_16x16x16_bf16 v[24:27], v[24:25], v[2:3], 0
ds_read_b128 v[12:15], v0 offset:0
v_cvt_pk_bf16_f32 v29, v30, v31
v_smfmac_f32_16x16x64_bf16 v[32:35], v[8:11], a[160:167], v1
v_mfma_f32_16x16x16_bf16 v[28:31], v[28:29], v[2:3], 0
s_waitcnt lgkmcnt(4)
v_smfmac_f32_16x16x64_bf16 v[36:39], v[8:11], v[72:79], v1
s_waitcnt vmcnt(4)
ds_read_b128 v[72:75], v0 offset:53248
v_cvt_pk_bf16_f32 v24, v24, v25
v_smfmac_f32_16x16x64_bf16 v[32:35], v[20:23], v[40:47], v1
ds_read_b128 v[76:79], v0 offset:54272
v_cvt_pk_bf16_f32 v25, v26, v27
v_smfmac_f32_16x16x64_bf16 v[36:39], v[20:23], a[152:159], v1
ds_read_b128 v[20:23], v0 offset:9216
v_cvt_pk_bf16_f32 v26, v28, v29
v_cvt_pk_bf16_f32 v27, v30, v31
s_waitcnt lgkmcnt(6)
v_smfmac_f32_16x16x64_bf16 v[32:35], v[16:19], a[144:151], v1
s_waitcnt vmcnt(3)
v_mov_b64 v[40:41], -1
v_mfma_f32_16x16x32_bf16 v[28:31], v[48:51], v[24:27], 0
s_waitcnt vmcnt(2)
v_mov_b64 v[42:43], -1
v_mfma_f32_16x16x32_bf16 v[8:11], v[52:55], v[24:27], 0
s_cmp_ge_u32 s30, 16
s_cbranch_scc1 k_nored2_189
buffer_store_dwordx4 v[40:43], v0, s[4:7], s59 offen offset:0
buffer_store_dwordx4 v[40:43], v0, s[4:7], s59 offen offset:1024
buffer_store_dwordx4 v[40:43], v0, s[4:7], s59 offen offset:2048
buffer_store_dwordx4 v[40:43], v0, s[4:7], s59 offen offset:3072
buffer_store_dword v40, v6, s[4:7], s58 offen
k_nored2_189:
s_waitcnt lgkmcnt(4)
v_smfmac_f32_16x16x64_bf16 v[36:39], v[16:19], v[64:71], v1
s_waitcnt lgkmcnt(3)
ds_read_b128 v[64:67], v4 offset:4096
v_mov_b64 v[44:45], 0
v_smfmac_f32_16x16x64_bf16 v[32:35], v[12:15], a[136:143], v1
s_waitcnt lgkmcnt(2)
ds_read_b128 v[68:71], v4 offset:5120
v_mov_b64 v[46:47], 0
v_smfmac_f32_16x16x64_bf16 v[36:39], v[12:15], v[72:79], v1
ds_read_b128 v[72:75], v4 offset:32768
v_cndmask_b32 v28, v28, v8, s[42:43]
v_cndmask_b32 v29, v29, v9, s[42:43]
s_waitcnt lgkmcnt(3)
v_smfmac_f32_16x16x64_bf16 v[32:35], v[20:23], a[120:127], v1
ds_read_b128 v[76:79], v4 offset:33792
v_cndmask_b32 v30, v30, v10, s[42:43]
v_cndmask_b32 v31, v31, v11, s[42:43]
v_smfmac_f32_16x16x64_bf16 v[36:39], v[20:23], a[128:135], v1
ds_write_b128 v0, v[28:31] offset:12288
v_mov_b64 v[40:41], 0
v_mov_b64 v[42:43], 0
v_smfmac_f32_16x16x64_bf16 v[44:47], v[20:23], a[240:247], v1
v_cvt_pk_bf16_f32 v32, v32, v33
v_cvt_pk_bf16_f32 v33, v34, v35
v_smfmac_f32_16x16x64_bf16 v[40:43], v[20:23], a[232:239], v1
ds_read_b128 v[20:23], v0 offset:2048
v_mfma_f32_16x16x16_bf16 v[32:35], v[32:33], v[2:3], 0
v_cvt_pk_bf16_f32 v36, v36, v37
v_cvt_pk_bf16_f32 v37, v38, v39
s_waitcnt lgkmcnt(0)
s_barrier
v_mfma_f32_16x16x16_bf16 v[36:39], v[36:37], v[2:3], 0
ds_read_b128 v[48:51], v0 offset:13312
v_smfmac_f32_16x16x64_bf16 v[40:43], v[12:15], a[248:255], v1
ds_read_b128 v[52:55], v0 offset:10240
v_cvt_pk_bf16_f32 v32, v32, v33
v_cvt_pk_bf16_f32 v33, v34, v35
v_smfmac_f32_16x16x64_bf16 v[44:47], v[12:15], v[80:87], v1
ds_read_b128 v[12:15], v0 offset:3072
v_cvt_pk_bf16_f32 v34, v36, v37
v_cvt_pk_bf16_f32 v35, v38, v39
s_nop 1
v_mfma_f32_16x16x32_bf16 v[36:39], v[32:35], v[24:27], 0
ds_read_b128 v[8:11], v0 offset:11264
v_smfmac_f32_16x16x64_bf16 v[40:43], v[16:19], v[88:95], v1
buffer_store_dwordx4 v[32:35], v0, s[4:7], s40 offen sc1
s_waitcnt lgkmcnt(3)
v_add_f32 v28, v28, v48
v_add_f32 v29, v29, v49
v_smfmac_f32_16x16x64_bf16 v[44:47], v[16:19], v[64:71], v1
ds_write_b128 v7, v[36:39] offset:15360
v_smfmac_f32_16x16x64_bf16 v[40:43], v[20:23], v[96:103], v1
ds_read_b128 v[16:19], v0 offset:4096
v_add_f32 v30, v30, v50
v_add_f32 v31, v31, v51
v_smfmac_f32_16x16x64_bf16 v[44:47], v[20:23], v[104:111], v1
ds_read_b128 v[20:23], v0 offset:5120
s_waitcnt lgkmcnt(5)
v_add_f32 v28, v28, v52
v_add_f32 v29, v29, v53
s_waitcnt lgkmcnt(4)
v_smfmac_f32_16x16x64_bf16 v[40:43], v[12:15], v[112:119], v1
ds_read_b128 v[64:67], v4 offset:26624
v_add_f32 v30, v30, v54
v_add_f32 v31, v31, v55
v_smfmac_f32_16x16x64_bf16 v[44:47], v[12:15], v[72:79], v1
ds_read_b128 v[12:15], v0 offset:6144
s_waitcnt lgkmcnt(5)
v_add_f32 v28, v28, v8
v_add_f32 v29, v29, v9
s_waitcnt lgkmcnt(3)
v_smfmac_f32_16x16x64_bf16 v[40:43], v[16:19], v[120:127], v1
ds_read_b128 v[68:71], v4 offset:27648
v_add_f32 v30, v30, v10
v_add_f32 v31, v31, v11
s_waitcnt lgkmcnt(0)
s_barrier
ds_read_b128 v[48:51], v7 offset:15872
ds_read_b128 v[52:55], v7 offset:14336
ds_read_b128 v[8:11], v7 offset:14848
v_smfmac_f32_16x16x64_bf16 v[44:47], v[16:19], v[128:135], v1
ds_read_b128 v[16:19], v0 offset:7168
v_max3_f32 v24, v28, v29, v30
v_smfmac_f32_16x16x64_bf16 v[40:43], v[20:23], v[136:143], v1
ds_read_b128 v[72:75], v4 offset:28672
v_max_f32 v24, v24, v31
v_smfmac_f32_16x16x64_bf16 v[44:47], v[20:23], v[64:71], v1
ds_read_b128 v[20:23], v0 offset:8192
v_max_f32_dpp v24, v24, v24 row_ror:8 row_mask:0xf bank_mask:0xf
v_smfmac_f32_16x16x64_bf16 v[40:43], v[12:15], a[192:199], v1
ds_read_b128 v[76:79], v4 offset:29696
v_mov_b32 v25, v24
v_smfmac_f32_16x16x64_bf16 v[44:47], v[12:15], a[200:207], v1
s_waitcnt lgkmcnt(3)
ds_read_b128 v[64:67], v4 offset:36864
v_permlane32_swap_b32 v24, v25
v_smfmac_f32_16x16x64_bf16 v[40:43], v[16:19], a[208:215], v1
s_waitcnt lgkmcnt(1)
ds_read_b128 v[68:71], v4 offset:37888
v_max_f32 v24, v24, v25
v_smfmac_f32_16x16x64_bf16 v[44:47], v[16:19], v[72:79], v1
ds_read_b128 v[72:75], v4 offset:38912
v_smfmac_f32_16x16x64_bf16 v[40:43], v[20:23], a[216:223], v1
ds_read_b128 v[76:79], v4 offset:39936
v_smfmac_f32_16x16x64_bf16 v[44:47], v[20:23], a[224:231], v1
v_add_f32 v36, v36, v48
v_add_f32 v37, v37, v49
v_add_f32 v38, v38, v50
v_add_f32 v39, v39, v51
v_add_f32 v36, v36, v52
v_add_f32 v37, v37, v53
v_add_f32 v38, v38, v54
v_add_f32 v39, v39, v55
v_add_f32 v36, v36, v8
v_add_f32 v37, v37, v9
v_add_f32 v38, v38, v10
v_add_f32 v39, v39, v11
buffer_load_dwordx4 v[48:51], v0, s[4:7], s63 offen offset:0
buffer_load_dwordx4 v[52:55], v0, s[4:7], s63 offen offset:1024
v_max3_f32 v24, v24, v36, v37
v_max3_f32 v24, v24, v38, v39
v_mov_b32 v25, v24
v_cvt_pk_bf16_f32 v40, v40, v41
v_cvt_pk_bf16_f32 v41, v42, v43
v_permlane16_swap_b32 v24, v25
v_max_f32 v24, v24, v25
v_mul_f32 v24, s54, v24
v_fma_f32 v28, v28, s54, -v24
v_exp_f32 v28, v28
v_fma_f32 v29, v29, s54, -v24
v_exp_f32 v29, v29
v_fma_f32 v30, v30, s54, -v24
v_exp_f32 v30, v30
v_fma_f32 v31, v31, s54, -v24
v_exp_f32 v31, v31
v_fma_f32 v36, v36, s54, -v24
v_exp_f32 v36, v36
v_fma_f32 v37, v37, s54, -v24
v_exp_f32 v37, v37
v_fma_f32 v38, v38, s54, -v24
v_exp_f32 v38, v38
v_fma_f32 v39, v39, s54, -v24
v_exp_f32 v39, v39
v_cvt_pk_bf16_f32 v24, v28, v29
v_cvt_pk_bf16_f32 v25, v30, v31
v_cvt_pk_bf16_f32 v26, v28, v29
v_cvt_pk_bf16_f32 v27, v30, v31
v_cvt_pk_bf16_f32 v32, v36, v37
v_cvt_pk_bf16_f32 v33, v38, v39
v_mov_b32_dpp v24, v26 row_ror:8 row_mask:0xf bank_mask:0xc
v_mov_b32_dpp v25, v27 row_ror:8 row_mask:0xf bank_mask:0xc
v_mov_b32_dpp v26, v26 row_ror:8 row_mask:0xf bank_mask:0x3
v_mov_b32_dpp v27, v27 row_ror:8 row_mask:0xf bank_mask:0x3
v_cvt_pk_bf16_f32 v42, v44, v45
v_cvt_pk_bf16_f32 v43, v46, v47
v_mov_b32 v8, 0x40004000
v_mov_b32 v9, 0x40004000
v_mov_b32 v10, 0x40004000
v_mov_b32 v11, 0x40004000
v_mov_b32 v34, 0x3f803f80
v_mov_b32 v35, 0x3f803f80
buffer_store_dwordx4 v[40:43], v0, s[4:7], s40 offen offset:1024 sc1
s_cmp_eq_u32 s31, 63
s_cbranch_scc1 k_done_185
v_mfma_f32_16x16x32_bf16 v[20:23], v[8:11], v[24:27], 0
s_waitcnt vmcnt(5)
v_mov_b64 v[28:29], 0
v_mov_b64 v[30:31], 0
v_mfma_f32_16x16x32_bf16 v[12:15], v[56:59], v[24:27], 0
v_mov_b64 v[36:37], 0
v_mov_b64 v[38:39], 0
v_mfma_f32_16x16x16_bf16 v[20:23], v[34:35], v[32:33], v[20:23]
s_waitcnt vmcnt(4)
v_mov_b64 v[44:45], 0
v_mov_b64 v[46:47], 0
v_mfma_f32_16x16x32_bf16 v[16:19], v[60:63], v[24:27], 0
buffer_load_dwordx4 v[56:59], v0, s[4:7], s63 offen offset:2048
v_mov_b64 v[24:25], 0
v_mfma_f32_16x16x16_bf16 v[12:15], v[40:41], v[32:33], v[12:15]
buffer_load_dwordx4 v[60:63], v0, s[4:7], s63 offen offset:3072
v_rcp_f32 v20, v20
v_mfma_f32_16x16x16_bf16 v[16:19], v[42:43], v[32:33], v[16:19]
v_mov_b64 v[26:27], 0
s_nop 1
v_mul_f32 v12, v12, v20
v_mul_f32 v13, v13, v20
v_mul_f32 v14, v14, v20
v_mul_f32 v15, v15, v20
v_cvt_pk_bf16_f32 v8, v12, v13
v_cvt_pk_bf16_f32 v9, v14, v15
v_mul_f32 v16, v16, v20
v_mul_f32 v17, v17, v20
v_mul_f32 v18, v18, v20
v_mul_f32 v19, v19, v20
v_cvt_pk_bf16_f32 v10, v16, v17
v_cvt_pk_bf16_f32 v11, v18, v19
ds_write_b128 v0, v[8:11] offset:12288
s_waitcnt lgkmcnt(3)
v_smfmac_f32_16x16x64_bf16 v[44:47], v[8:11], v[64:71], v1
s_waitcnt lgkmcnt(1)
v_mov_b64 v[32:33], 0
v_smfmac_f32_16x16x64_bf16 v[28:31], v[8:11], v[72:79], v1
v_mov_b64 v[34:35], 0
v_smfmac_f32_16x16x64_bf16 v[36:39], v[8:11], v[176:183], v1
s_waitcnt lgkmcnt(0)
s_barrier
ds_read_b128 v[12:15], v0 offset:13312
v_smfmac_f32_16x16x64_bf16 v[24:27], v[8:11], v[200:207], v1
ds_read_b128 v[16:19], v0 offset:10240
ds_read_b128 v[20:23], v0 offset:11264
v_smfmac_f32_16x16x64_bf16 v[32:35], v[8:11], v[232:239], v1
ds_read_b128 v[64:67], v4 offset:34816
ds_read_b128 v[68:71], v4 offset:35840
ds_read_b128 v[72:75], v4 offset:40960
ds_read_b128 v[76:79], v4 offset:41984
s_mov_b32 s41, s36
s_waitcnt lgkmcnt(6)
v_smfmac_f32_16x16x64_bf16 v[44:47], v[12:15], v[144:151], v1
s_waitcnt lgkmcnt(5)
v_smfmac_f32_16x16x64_bf16 v[44:47], v[16:19], v[152:159], v1
s_waitcnt lgkmcnt(2)
v_smfmac_f32_16x16x64_bf16 v[44:47], v[20:23], v[64:71], v1
v_smfmac_f32_16x16x64_bf16 v[28:31], v[12:15], v[160:167], v1
buffer_load_dwordx4 v[64:67], v0, s[4:7], s61 offen offset:0
v_smfmac_f32_16x16x64_bf16 v[28:31], v[16:19], v[168:175], v1
buffer_load_dwordx4 v[68:71], v0, s[4:7], s61 offen offset:1024
v_cvt_pk_bf16_f32 v44, v44, v45
v_cvt_pk_bf16_f32 v45, v46, v47
buffer_store_dwordx2 v[44:45], v5, s[4:7], s41 offen
s_add_u32 s41, s41, 65536
s_waitcnt lgkmcnt(0)
v_smfmac_f32_16x16x64_bf16 v[28:31], v[20:23], v[72:79], v1
buffer_load_dwordx4 v[40:43], v0, s[4:7], s60 offen offset:0
v_smfmac_f32_16x16x64_bf16 v[36:39], v[12:15], v[184:191], v1
buffer_load_dwordx4 v[44:47], v0, s[4:7], s60 offen offset:1024
v_smfmac_f32_16x16x64_bf16 v[36:39], v[16:19], v[192:199], v1
buffer_load_dwordx4 v[72:75], v0, s[4:7], s61 offen offset:2048
v_cvt_pk_bf16_f32 v28, v28, v29
v_cvt_pk_bf16_f32 v29, v30, v31
buffer_store_dwordx2 v[28:29], v5, s[4:7], s41 offen
s_add_u32 s41, s41, 65536
s_waitcnt vmcnt(10)
v_smfmac_f32_16x16x64_bf16 v[36:39], v[20:23], v[48:55], v1
buffer_load_dwordx4 v[76:79], v0, s[4:7], s61 offen offset:3072
v_smfmac_f32_16x16x64_bf16 v[24:27], v[12:15], v[208:215], v1
buffer_load_dwordx4 v[48:51], v0, s[4:7], s60 offen offset:2048
v_smfmac_f32_16x16x64_bf16 v[24:27], v[16:19], v[216:223], v1
buffer_load_dwordx4 v[52:55], v0, s[4:7], s60 offen offset:3072
v_cvt_pk_bf16_f32 v36, v36, v37
v_cvt_pk_bf16_f32 v37, v38, v39
buffer_store_dwordx2 v[36:37], v5, s[4:7], s41 offen
s_add_u32 s41, s41, 65536
v_smfmac_f32_16x16x64_bf16 v[24:27], v[20:23], v[224:231], v1
v_smfmac_f32_16x16x64_bf16 v[32:35], v[12:15], v[240:247], v1
v_smfmac_f32_16x16x64_bf16 v[32:35], v[16:19], v[248:255], v1
v_cvt_pk_bf16_f32 v24, v24, v25
v_cvt_pk_bf16_f32 v25, v26, v27
buffer_store_dwordx2 v[24:25], v5, s[4:7], s41 offen
s_add_u32 s41, s41, 65536
s_waitcnt vmcnt(12)
v_smfmac_f32_16x16x64_bf16 v[32:35], v[20:23], v[56:63], v1
s_nop 6
v_cvt_pk_bf16_f32 v32, v32, v33
v_cvt_pk_bf16_f32 v33, v34, v35
buffer_store_dwordx2 v[32:33], v5, s[4:7], s41 offen
s_add_u32 s41, s41, 65536
buffer_load_dwordx4 v[56:59], v0, s[4:7], s62 offen offset:0
buffer_load_dwordx4 v[60:63], v0, s[4:7], s62 offen offset:1024
s_add_u32 s31, s31, 1
s_add_u32 s33, s33, 10240
s_add_u32 s34, s34, 10240
s_add_u32 s35, s35, 524288
s_add_u32 s40, s40, 262144
s_add_u32 s36, s36, s55
s_cmp_ge_u32 s30, 16
s_cbranch_scc1 k_nored_188
v_mov_b32 v28, 0x4000
v_cndmask_b32 v28, v28, 2.0, s[44:45]
v_cndmask_b32 v24, 0, v28, s[46:47]
v_cndmask_b32 v25, 0, v28, s[48:49]
v_cndmask_b32 v26, 0, v28, s[50:51]
v_cndmask_b32 v27, 0, v28, s[52:53]
k_poll1_186:
buffer_load_dwordx4 v[8:11], v0, s[4:7], s37 offen offset:0 sc1
buffer_load_dwordx4 v[12:15], v0, s[4:7], s37 offen offset:1024 sc1
buffer_load_dwordx4 v[16:19], v0, s[4:7], s37 offen offset:2048 sc1
buffer_load_dwordx4 v[20:23], v0, s[4:7], s37 offen offset:3072 sc1
s_waitcnt vmcnt(3)
v_mfma_f32_16x16x32_bf16 v[28:31], v[8:11], v[24:27], 0
s_waitcnt vmcnt(2)
v_mfma_f32_16x16x32_bf16 v[28:31], v[12:15], v[24:27], v[28:31]
s_waitcnt vmcnt(1)
v_mfma_f32_16x16x32_bf16 v[28:31], v[16:19], v[24:27], v[28:31]
s_waitcnt vmcnt(0)
v_mfma_f32_16x16x32_bf16 v[28:31], v[20:23], v[24:27], v[28:31]
s_nop 7
v_permlane32_swap_b32 v28, v29
v_permlane32_swap_b32 v30, v31
v_add_f32 v28, v28, v29
v_add_f32 v29, v30, v31
v_cmp_u_f32 vcc, v28, v29
v_cvt_pk_bf16_f32 v28, v28, v29
s_cbranch_vccnz k_retry1_187
k_poll1_186_ok:
buffer_store_dword v28, v6, s[4:7], s38 offen
s_mov_b32 s59, s37
s_add_u32 s37, s37, s55
s_add_u32 s38, s38, 10240
s_add_u32 s58, s58, 10240
k_nored_188:
s_sub_u32 s55, 0, s55
v_mov_b64 v[24:25], 0
v_mov_b64 v[26:27], 0
v_mov_b64 v[28:29], 0
v_mov_b64 v[30:31], 0
v_mov_b64 v[32:33], 0
v_mov_b64 v[34:35], 0
v_mov_b64 v[36:37], 0
v_mov_b64 v[38:39], 0
s_branch k_top_182
k_retry2_184:
s_add_u32 s75, s75, 1
s_sub_u32 s32, s32, 1
s_cmp_gt_i32 s32, 0
s_cbranch_scc1 k_poll2_183
s_branch k_poll2_183_ok
k_retry1_187:
s_add_u32 s76, s76, 1
s_sub_u32 s32, s32, 1
s_cmp_gt_i32 s32, 0
s_cbranch_scc1 k_poll1_186
s_branch k_poll1_186_ok
k_done_185:
s_add_u32 s30, s30, 112
s_waitcnt vmcnt(0) lgkmcnt(0)
s_barrier
s_branch k_fin_7
k_w3_115:
v_lshrrev_b32 v10, 3, v0
v_lshlrev_b32 v8, 13, v10
v_bfe_u32 v10, v0, 1, 2
v_lshrrev_b32 v11, 4, v0
v_xor_b32 v10, v10, v11
v_lshl_add_u32 v8, v10, 5, v8
v_and_b32 v12, 1, v0
v_lshl_add_u32 v8, v12, 4, v8
v_mul_u32_u24 v9, 1280, v11
v_bfe_u32 v10, v0, 1, 3
v_and_b32 v11, 1, v11
v_lshlrev_b32 v11, 1, v11
v_xor_b32 v10, v10, v11
v_xor_b32 v10, 4, v10
v_lshl_add_u32 v9, v10, 5, v9
v_lshl_add_u32 v9, v12, 4, v9
v_bfe_u32 v10, v0, 5, 1
v_lshlrev_b32 v10, 4, v10
v_bfe_u32 v11, v0, 4, 1
v_lshl_add_u32 v10, v11, 1, v10
v_bfe_u32 v11, v0, 2, 1
v_lshl_add_u32 v10, v11, 2, v10
v_bfe_u32 v11, v0, 3, 1
v_add_u32 v10, v11, v10
v_bfe_u32 v11, v10, 1, 2
v_xor_b32 v11, 3, v11
v_lshlrev_b32 v11, 5, v11
v_lshl_add_u32 v1, v10, 7, v11
v_and_b32 v12, 3, v0
v_lshl_add_u32 v1, v12, 3, v1
v_add_u32 v2, 0x10000, v1
v_add_u32 v3, 0x20000, v1
v_bfe_u32 v10, v0, 4, 1
v_lshlrev_b32 v11, 4, v10
v_lshlrev_b32 v10, 2, v10
v_bfe_u32 v6, v0, 5, 1
v_lshl_add_u32 v11, v6, 2, v11
v_bfe_u32 v6, v0, 2, 1
v_add_u32 v11, v6, v11
v_lshl_add_u32 v10, v6, 1, v10
v_bfe_u32 v6, v0, 3, 1
v_add_u32 v6, 6, v6
v_xor_b32 v10, v10, v6
v_lshlrev_b32 v10, 5, v10
v_lshl_add_u32 v5, v11, 8, v10
v_lshl_add_u32 v5, v12, 3, v5
v_add_u32 v6, 0x10000, v5
v_add_u32 v7, 0x20000, v5
v_lshlrev_b32 v0, 4, v0
v_add_u32 v4, 65536, v0
s_lshl_b32 s56, s30, 8
s_mul_i32 s57, s30, 163840
s_mul_i32 s39, s30, 131072
s_add_u32 s39, s39, 120684544
s_add_u32 s60, s39, 0
s_add_u32 s61, s39, 4096
s_add_u32 s62, s39, 8192
s_add_u32 s63, s39, 12288
s_add_u32 s64, s39, 16384
s_add_u32 s65, s39, 20480
s_add_u32 s66, s39, 24576
s_add_u32 s67, s39, 28672
s_mov_b32 m0, 6144
s_add_u32 s41, s56, 393216
buffer_load_dwordx4 v8, s[8:11], s41 offen lds
s_mov_b32 m0, 7168
s_add_u32 s41, s56, 458752
buffer_load_dwordx4 v8, s[8:11], s41 offen lds
s_mov_b32 m0, 14336
s_add_u32 s41, s56, 393344
buffer_load_dwordx4 v8, s[8:11], s41 offen lds
s_mov_b32 m0, 15360
s_add_u32 s41, s56, 458880
buffer_load_dwordx4 v8, s[8:11], s41 offen lds
s_mov_b32 m0, 22528
s_add_u32 s41, s56, 917504
buffer_load_dwordx4 v8, s[8:11], s41 offen lds
s_mov_b32 m0, 23552
s_add_u32 s41, s56, 983040
buffer_load_dwordx4 v8, s[8:11], s41 offen lds
s_mov_b32 m0, 30720
s_add_u32 s41, s56, 917632
buffer_load_dwordx4 v8, s[8:11], s41 offen lds
s_mov_b32 m0, 31744
s_add_u32 s41, s56, 983168
buffer_load_dwordx4 v8, s[8:11], s41 offen lds
s_mov_b32 m0, 38912
s_add_u32 s41, s56, 1441792
buffer_load_dwordx4 v8, s[8:11], s41 offen lds
s_mov_b32 m0, 39936
s_add_u32 s41, s56, 1507328
buffer_load_dwordx4 v8, s[8:11], s41 offen lds
s_mov_b32 m0, 47104
s_add_u32 s41, s56, 1441920
buffer_load_dwordx4 v8, s[8:11], s41 offen lds
s_mov_b32 m0, 48128
s_add_u32 s41, s56, 1507456
buffer_load_dwordx4 v8, s[8:11], s41 offen lds
s_mov_b32 m0, 55296
s_add_u32 s41, s56, 1966080
buffer_load_dwordx4 v8, s[8:11], s41 offen lds
s_mov_b32 m0, 56320
s_add_u32 s41, s56, 2031616
buffer_load_dwordx4 v8, s[8:11], s41 offen lds
s_mov_b32 m0, 63488
s_add_u32 s41, s56, 1966208
buffer_load_dwordx4 v8, s[8:11], s41 offen lds
s_mov_b32 m0, 64512
s_add_u32 s41, s56, 2031744
buffer_load_dwordx4 v8, s[8:11], s41 offen lds
s_mov_b32 m0, 71680
s_add_u32 s41, s56, 2490368
buffer_load_dwordx4 v8, s[8:11], s41 offen lds
s_mov_b32 m0, 72704
s_add_u32 s41, s56, 2555904
buffer_load_dwordx4 v8, s[8:11], s41 offen lds
s_mov_b32 m0, 79872
s_add_u32 s41, s56, 2490496
buffer_load_dwordx4 v8, s[8:11], s41 offen lds
s_mov_b32 m0, 80896
s_add_u32 s41, s56, 2556032
buffer_load_dwordx4 v8, s[8:11], s41 offen lds
s_mov_b32 m0, 88064
s_add_u32 s41, s56, 3014656
buffer_load_dwordx4 v8, s[8:11], s41 offen lds
s_mov_b32 m0, 89088
s_add_u32 s41, s56, 3080192
buffer_load_dwordx4 v8, s[8:11], s41 offen lds
s_mov_b32 m0, 96256
s_add_u32 s41, s56, 3014784
buffer_load_dwordx4 v8, s[8:11], s41 offen lds
s_mov_b32 m0, 97280
s_add_u32 s41, s56, 3080320
buffer_load_dwordx4 v8, s[8:11], s41 offen lds
s_mov_b32 m0, 104448
s_add_u32 s41, s56, 3538944
buffer_load_dwordx4 v8, s[8:11], s41 offen lds
s_mov_b32 m0, 105472
s_add_u32 s41, s56, 3604480
buffer_load_dwordx4 v8, s[8:11], s41 offen lds
s_mov_b32 m0, 112640
s_add_u32 s41, s56, 3539072
buffer_load_dwordx4 v8, s[8:11], s41 offen lds
s_mov_b32 m0, 113664
s_add_u32 s41, s56, 3604608
buffer_load_dwordx4 v8, s[8:11], s41 offen lds
s_mov_b32 m0, 120832
s_add_u32 s41, s56, 4063232
buffer_load_dwordx4 v8, s[8:11], s41 offen lds
s_mov_b32 m0, 121856
s_add_u32 s41, s56, 4128768
buffer_load_dwordx4 v8, s[8:11], s41 offen lds
s_mov_b32 m0, 129024
s_add_u32 s41, s56, 4063360
buffer_load_dwordx4 v8, s[8:11], s41 offen lds
s_mov_b32 m0, 130048
s_add_u32 s41, s56, 4128896
buffer_load_dwordx4 v8, s[8:11], s41 offen lds
s_waitcnt vmcnt(24)
s_barrier
s_mov_b32 m0, 137216
s_add_u32 s41, s56, 4587520
buffer_load_dwordx4 v8, s[8:11], s41 offen lds
s_mov_b32 m0, 138240
s_add_u32 s41, s56, 4653056
buffer_load_dwordx4 v8, s[8:11], s41 offen lds
s_mov_b32 m0, 145408
s_add_u32 s41, s56, 4587648
buffer_load_dwordx4 v8, s[8:11], s41 offen lds
s_mov_b32 m0, 146432
s_add_u32 s41, s56, 4653184
buffer_load_dwordx4 v8, s[8:11], s41 offen lds
s_mov_b32 m0, 153600
s_add_u32 s41, s56, 5111808
buffer_load_dwordx4 v8, s[8:11], s41 offen lds
s_mov_b32 m0, 154624
s_add_u32 s41, s56, 5177344
buffer_load_dwordx4 v8, s[8:11], s41 offen lds
s_mov_b32 m0, 161792
s_add_u32 s41, s56, 5111936
buffer_load_dwordx4 v8, s[8:11], s41 offen lds
s_mov_b32 m0, 162816
s_add_u32 s41, s56, 5177472
buffer_load_dwordx4 v8, s[8:11], s41 offen lds
ds_read_b64_tr_b16 v[16:17], v1 offset:0
ds_read_b64_tr_b16 v[18:19], v1 offset:1024
ds_read_b64_tr_b16 v[20:21], v1 offset:4096
ds_read_b64_tr_b16 v[22:23], v1 offset:5120
ds_read_b64_tr_b16 v[24:25], v1 offset:8192
ds_read_b64_tr_b16 v[26:27], v1 offset:9216
ds_read_b64_tr_b16 v[28:29], v1 offset:12288
ds_read_b64_tr_b16 v[30:31], v1 offset:13312
ds_read_b64_tr_b16 v[32:33], v1 offset:16384
ds_read_b64_tr_b16 v[34:35], v1 offset:17408
ds_read_b64_tr_b16 v[36:37], v1 offset:20480
ds_read_b64_tr_b16 v[38:39], v1 offset:21504
ds_read_b64_tr_b16 a[0:1], v1 offset:24576
ds_read_b64_tr_b16 a[2:3], v1 offset:25600
ds_read_b64_tr_b16 a[4:5], v1 offset:28672
ds_read_b64_tr_b16 a[6:7], v1 offset:29696
s_waitcnt lgkmcnt(0)
buffer_store_dwordx4 v[16:19], v0, s[4:7], s61 offen offset:0
buffer_store_dwordx4 v[20:23], v0, s[4:7], s61 offen offset:1024
buffer_store_dwordx4 v[24:27], v0, s[4:7], s61 offen offset:2048
buffer_store_dwordx4 v[28:31], v0, s[4:7], s61 offen offset:3072
buffer_store_dwordx4 v[32:35], v0, s[4:7], s62 offen offset:0
buffer_store_dwordx4 v[36:39], v0, s[4:7], s62 offen offset:1024
s_waitcnt vmcnt(30)
s_barrier
s_mov_b32 m0, 6144
s_add_u32 s41, s56, 393216
buffer_load_dwordx4 v8, s[12:15], s41 offen lds
s_mov_b32 m0, 7168
s_add_u32 s41, s56, 458752
buffer_load_dwordx4 v8, s[12:15], s41 offen lds
s_mov_b32 m0, 14336
s_add_u32 s41, s56, 917504
buffer_load_dwordx4 v8, s[12:15], s41 offen lds
s_mov_b32 m0, 15360
s_add_u32 s41, s56, 983040
buffer_load_dwordx4 v8, s[12:15], s41 offen lds
s_mov_b32 m0, 22528
s_add_u32 s41, s56, 1441792
buffer_load_dwordx4 v8, s[12:15], s41 offen lds
s_mov_b32 m0, 23552
s_add_u32 s41, s56, 1507328
buffer_load_dwordx4 v8, s[12:15], s41 offen lds
s_mov_b32 m0, 30720
s_add_u32 s41, s56, 1441920
buffer_load_dwordx4 v8, s[12:15], s41 offen lds
s_mov_b32 m0, 31744
s_add_u32 s41, s56, 1507456
buffer_load_dwordx4 v8, s[12:15], s41 offen lds
ds_read_b64_tr_b16 a[8:9], v1 offset:32768
ds_read_b64_tr_b16 a[10:11], v1 offset:33792
ds_read_b64_tr_b16 a[12:13], v1 offset:36864
ds_read_b64_tr_b16 a[14:15], v1 offset:37888
ds_read_b64_tr_b16 a[16:17], v1 offset:40960
ds_read_b64_tr_b16 a[18:19], v1 offset:41984
ds_read_b64_tr_b16 a[20:21], v1 offset:45056
ds_read_b64_tr_b16 a[22:23], v1 offset:46080
ds_read_b64_tr_b16 a[24:25], v1 offset:49152
ds_read_b64_tr_b16 a[26:27], v1 offset:50176
ds_read_b64_tr_b16 a[28:29], v1 offset:53248
ds_read_b64_tr_b16 a[30:31], v1 offset:54272
ds_read_b64_tr_b16 a[168:169], v1 offset:57344
ds_read_b64_tr_b16 a[170:171], v1 offset:58368
ds_read_b64_tr_b16 a[172:173], v1 offset:61440
ds_read_b64_tr_b16 a[174:175], v1 offset:62464
s_waitcnt lgkmcnt(0)
s_waitcnt vmcnt(30)
s_barrier
s_mov_b32 m0, 38912
s_add_u32 s41, s56, 1966080
buffer_load_dwordx4 v8, s[12:15], s41 offen lds
s_mov_b32 m0, 39936
s_add_u32 s41, s56, 2031616
buffer_load_dwordx4 v8, s[12:15], s41 offen lds
s_mov_b32 m0, 47104
s_add_u32 s41, s56, 2490368
buffer_load_dwordx4 v8, s[12:15], s41 offen lds
s_mov_b32 m0, 48128
s_add_u32 s41, s56, 2555904
buffer_load_dwordx4 v8, s[12:15], s41 offen lds
s_mov_b32 m0, 55296
s_add_u32 s41, s56, 3014656
buffer_load_dwordx4 v8, s[12:15], s41 offen lds
s_mov_b32 m0, 56320
s_add_u32 s41, s56, 3080192
buffer_load_dwordx4 v8, s[12:15], s41 offen lds
s_mov_b32 m0, 63488
s_add_u32 s41, s56, 3538944
buffer_load_dwordx4 v8, s[12:15], s41 offen lds
s_mov_b32 m0, 64512
s_add_u32 s41, s56, 3604480
buffer_load_dwordx4 v8, s[12:15], s41 offen lds
ds_read_b64_tr_b16 a[32:33], v2 offset:0
ds_read_b64_tr_b16 a[34:35], v2 offset:1024
ds_read_b64_tr_b16 a[36:37], v2 offset:4096
ds_read_b64_tr_b16 a[38:39], v2 offset:5120
ds_read_b64_tr_b16 a[40:41], v2 offset:8192
ds_read_b64_tr_b16 a[42:43], v2 offset:9216
ds_read_b64_tr_b16 a[44:45], v2 offset:12288
ds_read_b64_tr_b16 a[46:47], v2 offset:13312
ds_read_b64_tr_b16 a[152:153], v2 offset:16384
ds_read_b64_tr_b16 a[154:155], v2 offset:17408
ds_read_b64_tr_b16 a[156:157], v2 offset:20480
ds_read_b64_tr_b16 a[158:159], v2 offset:21504
ds_read_b64_tr_b16 a[48:49], v2 offset:24576
ds_read_b64_tr_b16 a[50:51], v2 offset:25600
ds_read_b64_tr_b16 a[52:53], v2 offset:28672
ds_read_b64_tr_b16 a[54:55], v2 offset:29696
s_waitcnt lgkmcnt(0)
s_waitcnt vmcnt(30)
s_barrier
s_mov_b32 m0, 71680
s_add_u32 s41, s56, 3539072
buffer_load_dwordx4 v8, s[12:15], s41 offen lds
s_mov_b32 m0, 72704
s_add_u32 s41, s56, 3604608
buffer_load_dwordx4 v8, s[12:15], s41 offen lds
s_mov_b32 m0, 79872
s_add_u32 s41, s56, 4063232
buffer_load_dwordx4 v8, s[12:15], s41 offen lds
s_mov_b32 m0, 80896
s_add_u32 s41, s56, 4128768
buffer_load_dwordx4 v8, s[12:15], s41 offen lds
s_mov_b32 m0, 88064
s_add_u32 s41, s56, 4587520
buffer_load_dwordx4 v8, s[12:15], s41 offen lds
s_mov_b32 m0, 89088
s_add_u32 s41, s56, 4653056
buffer_load_dwordx4 v8, s[12:15], s41 offen lds
s_mov_b32 m0, 96256
s_add_u32 s41, s56, 5111808
buffer_load_dwordx4 v8, s[12:15], s41 offen lds
s_mov_b32 m0, 97280
s_add_u32 s41, s56, 5177344
buffer_load_dwordx4 v8, s[12:15], s41 offen lds
ds_read_b64_tr_b16 a[56:57], v2 offset:32768
ds_read_b64_tr_b16 a[58:59], v2 offset:33792
ds_read_b64_tr_b16 a[60:61], v2 offset:36864
ds_read_b64_tr_b16 a[62:63], v2 offset:37888
ds_read_b64_tr_b16 a[184:185], v2 offset:40960
ds_read_b64_tr_b16 a[186:187], v2 offset:41984
ds_read_b64_tr_b16 a[188:189], v2 offset:45056
ds_read_b64_tr_b16 a[190:191], v2 offset:46080
ds_read_b64_tr_b16 a[64:65], v2 offset:49152
ds_read_b64_tr_b16 a[66:67], v2 offset:50176
ds_read_b64_tr_b16 a[68:69], v2 offset:53248
ds_read_b64_tr_b16 a[70:71], v2 offset:54272
ds_read_b64_tr_b16 a[72:73], v2 offset:57344
ds_read_b64_tr_b16 a[74:75], v2 offset:58368
ds_read_b64_tr_b16 a[76:77], v2 offset:61440
ds_read_b64_tr_b16 a[78:79], v2 offset:62464
s_waitcnt lgkmcnt(0)
s_waitcnt vmcnt(30)
s_barrier
s_mov_b32 m0, 104448
s_add_u32 s41, s56, 5111936
buffer_load_dwordx4 v8, s[12:15], s41 offen lds
s_mov_b32 m0, 105472
s_add_u32 s41, s56, 5177472
buffer_load_dwordx4 v8, s[12:15], s41 offen lds
s_mov_b32 m0, 112640
s_add_u32 s41, s56, 393216
buffer_load_dwordx4 v8, s[16:19], s41 offen lds
s_mov_b32 m0, 113664
s_add_u32 s41, s56, 458752
buffer_load_dwordx4 v8, s[16:19], s41 offen lds
s_mov_b32 m0, 120832
s_add_u32 s41, s56, 917504
buffer_load_dwordx4 v8, s[16:19], s41 offen lds
s_mov_b32 m0, 121856
s_add_u32 s41, s56, 983040
buffer_load_dwordx4 v8, s[16:19], s41 offen lds
s_mov_b32 m0, 129024
s_add_u32 s41, s56, 1441792
buffer_load_dwordx4 v8, s[16:19], s41 offen lds
s_mov_b32 m0, 130048
s_add_u32 s41, s56, 1507328
buffer_load_dwordx4 v8, s[16:19], s41 offen lds
ds_read_b64_tr_b16 a[224:225], v3 offset:0
ds_read_b64_tr_b16 a[226:227], v3 offset:1024
ds_read_b64_tr_b16 a[228:229], v3 offset:4096
ds_read_b64_tr_b16 a[230:231], v3 offset:5120
ds_read_b64_tr_b16 a[80:81], v3 offset:8192
ds_read_b64_tr_b16 a[82:83], v3 offset:9216
ds_read_b64_tr_b16 a[84:85], v3 offset:12288
ds_read_b64_tr_b16 a[86:87], v3 offset:13312
ds_read_b64_tr_b16 v[32:33], v3 offset:16384
ds_read_b64_tr_b16 v[34:35], v3 offset:17408
ds_read_b64_tr_b16 v[36:37], v3 offset:20480
ds_read_b64_tr_b16 v[38:39], v3 offset:21504
ds_read_b64_tr_b16 v[40:41], v3 offset:24576
ds_read_b64_tr_b16 v[42:43], v3 offset:25600
ds_read_b64_tr_b16 v[44:45], v3 offset:28672
ds_read_b64_tr_b16 v[46:47], v3 offset:29696
s_waitcnt lgkmcnt(0)
buffer_store_dwordx4 v[32:35], v0, s[4:7], s60 offen offset:0
buffer_store_dwordx4 v[36:39], v0, s[4:7], s60 offen offset:1024
buffer_store_dwordx4 v[40:43], v0, s[4:7], s60 offen offset:2048
buffer_store_dwordx4 v[44:47], v0, s[4:7], s60 offen offset:3072
s_waitcnt vmcnt(28)
s_barrier
s_mov_b32 m0, 137216
s_add_u32 s41, s56, 1441920
buffer_load_dwordx4 v8, s[16:19], s41 offen lds
s_mov_b32 m0, 138240
s_add_u32 s41, s56, 1507456
buffer_load_dwordx4 v8, s[16:19], s41 offen lds
s_mov_b32 m0, 145408
s_add_u32 s41, s56, 1966080
buffer_load_dwordx4 v8, s[16:19], s41 offen lds
s_mov_b32 m0, 146432
s_add_u32 s41, s56, 2031616
buffer_load_dwordx4 v8, s[16:19], s41 offen lds
s_mov_b32 m0, 153600
s_add_u32 s41, s56, 1966208
buffer_load_dwordx4 v8, s[16:19], s41 offen lds
s_mov_b32 m0, 154624
s_add_u32 s41, s56, 2031744
buffer_load_dwordx4 v8, s[16:19], s41 offen lds
s_mov_b32 m0, 161792
s_add_u32 s41, s56, 2490368
buffer_load_dwordx4 v8, s[16:19], s41 offen lds
s_mov_b32 m0, 162816
s_add_u32 s41, s56, 2555904
buffer_load_dwordx4 v8, s[16:19], s41 offen lds
ds_read_b64_tr_b16 a[104:105], v1 offset:0
ds_read_b64_tr_b16 a[106:107], v1 offset:1024
ds_read_b64_tr_b16 a[108:109], v1 offset:4096
ds_read_b64_tr_b16 a[110:111], v1 offset:5120
ds_read_b64_tr_b16 a[112:113], v1 offset:8192
ds_read_b64_tr_b16 a[114:115], v1 offset:9216
ds_read_b64_tr_b16 a[116:117], v1 offset:12288
ds_read_b64_tr_b16 a[118:119], v1 offset:13312
ds_read_b64_tr_b16 a[120:121], v1 offset:16384
ds_read_b64_tr_b16 a[122:123], v1 offset:17408
ds_read_b64_tr_b16 a[124:125], v1 offset:20480
ds_read_b64_tr_b16 a[126:127], v1 offset:21504
ds_read_b64_tr_b16 a[128:129], v1 offset:24576
ds_read_b64_tr_b16 a[130:131], v1 offset:25600
ds_read_b64_tr_b16 a[132:133], v1 offset:28672
ds_read_b64_tr_b16 a[134:135], v1 offset:29696
s_waitcnt lgkmcnt(0)
s_waitcnt vmcnt(28)
s_barrier
s_mov_b32 m0, 6144
s_add_u32 s41, s56, 3014656
buffer_load_dwordx4 v8, s[16:19], s41 offen lds
s_mov_b32 m0, 7168
s_add_u32 s41, s56, 3080192
buffer_load_dwordx4 v8, s[16:19], s41 offen lds
s_mov_b32 m0, 14336
s_add_u32 s41, s56, 3538944
buffer_load_dwordx4 v8, s[16:19], s41 offen lds
s_mov_b32 m0, 15360
s_add_u32 s41, s56, 3604480
buffer_load_dwordx4 v8, s[16:19], s41 offen lds
s_mov_b32 m0, 22528
s_add_u32 s41, s56, 3539072
buffer_load_dwordx4 v8, s[16:19], s41 offen lds
s_mov_b32 m0, 23552
s_add_u32 s41, s56, 3604608
buffer_load_dwordx4 v8, s[16:19], s41 offen lds
s_mov_b32 m0, 30720
s_add_u32 s41, s56, 4063232
buffer_load_dwordx4 v8, s[16:19], s41 offen lds
s_mov_b32 m0, 31744
s_add_u32 s41, s56, 4128768
buffer_load_dwordx4 v8, s[16:19], s41 offen lds
ds_read_b64_tr_b16 a[136:137], v1 offset:32768
ds_read_b64_tr_b16 a[138:139], v1 offset:33792
ds_read_b64_tr_b16 a[140:141], v1 offset:36864
ds_read_b64_tr_b16 a[142:143], v1 offset:37888
ds_read_b64_tr_b16 a[144:145], v1 offset:40960
ds_read_b64_tr_b16 a[146:147], v1 offset:41984
ds_read_b64_tr_b16 a[148:149], v1 offset:45056
ds_read_b64_tr_b16 a[150:151], v1 offset:46080
ds_read_b64_tr_b16 v[32:33], v1 offset:49152
ds_read_b64_tr_b16 v[34:35], v1 offset:50176
ds_read_b64_tr_b16 v[36:37], v1 offset:53248
ds_read_b64_tr_b16 v[38:39], v1 offset:54272
ds_read_b64_tr_b16 a[160:161], v1 offset:57344
ds_read_b64_tr_b16 a[162:163], v1 offset:58368
ds_read_b64_tr_b16 a[164:165], v1 offset:61440
ds_read_b64_tr_b16 a[166:167], v1 offset:62464
s_waitcnt lgkmcnt(0)
buffer_store_dwordx4 v[32:35], v0, s[4:7], s62 offen offset:2048
buffer_store_dwordx4 v[36:39], v0, s[4:7], s62 offen offset:3072
s_waitcnt vmcnt(30)
s_barrier
s_mov_b32 m0, 38912
s_add_u32 s41, s56, 4587520
buffer_load_dwordx4 v8, s[16:19], s41 offen lds
s_mov_b32 m0, 39936
s_add_u32 s41, s56, 4653056
buffer_load_dwordx4 v8, s[16:19], s41 offen lds
s_mov_b32 m0, 47104
s_add_u32 s41, s56, 5111808
buffer_load_dwordx4 v8, s[16:19], s41 offen lds
s_mov_b32 m0, 48128
s_add_u32 s41, s56, 5177344
buffer_load_dwordx4 v8, s[16:19], s41 offen lds
s_mov_b32 m0, 55296
s_add_u32 s41, s56, 5111936
buffer_load_dwordx4 v8, s[16:19], s41 offen lds
s_mov_b32 m0, 56320
s_add_u32 s41, s56, 5177472
buffer_load_dwordx4 v8, s[16:19], s41 offen lds
s_mov_b32 m0, 63488
s_add_u32 s41, s57, 112896
buffer_load_dwordx4 v9, s[20:23], s41 offen lds
s_mov_b32 m0, 64512
s_add_u32 s41, s57, 118016
buffer_load_dwordx4 v9, s[20:23], s41 offen lds
ds_read_b64_tr_b16 v[128:129], v2 offset:0
ds_read_b64_tr_b16 v[130:131], v2 offset:1024
ds_read_b64_tr_b16 v[132:133], v2 offset:4096
ds_read_b64_tr_b16 v[134:135], v2 offset:5120
ds_read_b64_tr_b16 v[104:105], v2 offset:8192
ds_read_b64_tr_b16 v[106:107], v2 offset:9216
ds_read_b64_tr_b16 v[108:109], v2 offset:12288
ds_read_b64_tr_b16 v[110:111], v2 offset:13312
ds_read_b64_tr_b16 a[176:177], v2 offset:16384
ds_read_b64_tr_b16 a[178:179], v2 offset:17408
ds_read_b64_tr_b16 a[180:181], v2 offset:20480
ds_read_b64_tr_b16 a[182:183], v2 offset:21504
ds_read_b64_tr_b16 a[88:89], v2 offset:24576
ds_read_b64_tr_b16 a[90:91], v2 offset:25600
ds_read_b64_tr_b16 a[92:93], v2 offset:28672
ds_read_b64_tr_b16 a[94:95], v2 offset:29696
s_waitcnt lgkmcnt(0)
s_waitcnt vmcnt(30)
s_barrier
s_mov_b32 m0, 71680
s_add_u32 s41, s57, 133376
buffer_load_dwordx4 v9, s[20:23], s41 offen lds
s_mov_b32 m0, 72704
s_add_u32 s41, s57, 138496
buffer_load_dwordx4 v9, s[20:23], s41 offen lds
s_mov_b32 m0, 79872
s_add_u32 s41, s57, 153856
buffer_load_dwordx4 v9, s[20:23], s41 offen lds
s_mov_b32 m0, 80896
s_add_u32 s41, s57, 158976
buffer_load_dwordx4 v9, s[20:23], s41 offen lds
s_mov_b32 m0, 88064
s_add_u32 s41, s57, 92672
buffer_load_dwordx4 v9, s[20:23], s41 offen lds
s_mov_b32 m0, 89088
s_add_u32 s41, s57, 97792
buffer_load_dwordx4 v9, s[20:23], s41 offen lds
s_mov_b32 m0, 96256
s_add_u32 s41, s57, 113152
buffer_load_dwordx4 v9, s[20:23], s41 offen lds
s_mov_b32 m0, 97280
s_add_u32 s41, s57, 118272
buffer_load_dwordx4 v9, s[20:23], s41 offen lds
ds_read_b64_tr_b16 a[96:97], v2 offset:32768
ds_read_b64_tr_b16 a[98:99], v2 offset:33792
ds_read_b64_tr_b16 a[100:101], v2 offset:36864
ds_read_b64_tr_b16 a[102:103], v2 offset:37888
ds_read_b64_tr_b16 a[208:209], v2 offset:40960
ds_read_b64_tr_b16 a[210:211], v2 offset:41984
ds_read_b64_tr_b16 a[212:213], v2 offset:45056
ds_read_b64_tr_b16 a[214:215], v2 offset:46080
ds_read_b64_tr_b16 a[216:217], v2 offset:49152
ds_read_b64_tr_b16 a[218:219], v2 offset:50176
ds_read_b64_tr_b16 a[220:221], v2 offset:53248
ds_read_b64_tr_b16 a[222:223], v2 offset:54272
ds_read_b64_tr_b16 a[232:233], v2 offset:57344
ds_read_b64_tr_b16 a[234:235], v2 offset:58368
ds_read_b64_tr_b16 a[236:237], v2 offset:61440
ds_read_b64_tr_b16 a[238:239], v2 offset:62464
s_waitcnt lgkmcnt(0)
s_waitcnt vmcnt(26)
s_barrier
s_mov_b32 m0, 104448
s_add_u32 s41, s57, 133632
buffer_load_dwordx4 v9, s[20:23], s41 offen lds
s_mov_b32 m0, 105472
s_add_u32 s41, s57, 138752
buffer_load_dwordx4 v9, s[20:23], s41 offen lds
s_mov_b32 m0, 112640
s_add_u32 s41, s57, 154112
buffer_load_dwordx4 v9, s[20:23], s41 offen lds
s_mov_b32 m0, 113664
s_add_u32 s41, s57, 159232
buffer_load_dwordx4 v9, s[20:23], s41 offen lds
s_mov_b32 m0, 120832
s_add_u32 s41, s57, 92928
buffer_load_dwordx4 v9, s[20:23], s41 offen lds
s_mov_b32 m0, 121856
s_add_u32 s41, s57, 98048
buffer_load_dwordx4 v9, s[20:23], s41 offen lds
s_mov_b32 m0, 129024
s_add_u32 s41, s57, 113408
buffer_load_dwordx4 v9, s[20:23], s41 offen lds
s_mov_b32 m0, 130048
s_add_u32 s41, s57, 118528
buffer_load_dwordx4 v9, s[20:23], s41 offen lds
ds_read_b64_tr_b16 a[240:241], v3 offset:0
ds_read_b64_tr_b16 a[242:243], v3 offset:1024
ds_read_b64_tr_b16 a[244:245], v3 offset:4096
ds_read_b64_tr_b16 a[246:247], v3 offset:5120
ds_read_b64_tr_b16 a[248:249], v3 offset:8192
ds_read_b64_tr_b16 a[250:251], v3 offset:9216
ds_read_b64_tr_b16 a[252:253], v3 offset:12288
ds_read_b64_tr_b16 a[254:255], v3 offset:13312
ds_read_b64_tr_b16 v[80:81], v3 offset:16384
ds_read_b64_tr_b16 v[82:83], v3 offset:17408
ds_read_b64_tr_b16 v[84:85], v3 offset:20480
ds_read_b64_tr_b16 v[86:87], v3 offset:21504
ds_read_b64_tr_b16 v[88:89], v3 offset:24576
ds_read_b64_tr_b16 v[90:91], v3 offset:25600
ds_read_b64_tr_b16 v[92:93], v3 offset:28672
ds_read_b64_tr_b16 v[94:95], v3 offset:29696
s_waitcnt lgkmcnt(0)
s_waitcnt vmcnt(26)
s_barrier
s_mov_b32 m0, 137216
s_add_u32 s41, s57, 133888
buffer_load_dwordx4 v9, s[20:23], s41 offen lds
s_mov_b32 m0, 138240
s_add_u32 s41, s57, 139008
buffer_load_dwordx4 v9, s[20:23], s41 offen lds
s_mov_b32 m0, 145408
s_add_u32 s41, s57, 154368
buffer_load_dwordx4 v9, s[20:23], s41 offen lds
s_mov_b32 m0, 146432
s_add_u32 s41, s57, 159488
buffer_load_dwordx4 v9, s[20:23], s41 offen lds
s_mov_b32 m0, 153600
s_add_u32 s41, s57, 93184
buffer_load_dwordx4 v9, s[20:23], s41 offen lds
s_mov_b32 m0, 154624
s_add_u32 s41, s57, 98304
buffer_load_dwordx4 v9, s[20:23], s41 offen lds
s_mov_b32 m0, 161792
s_add_u32 s41, s57, 113664
buffer_load_dwordx4 v9, s[20:23], s41 offen lds
s_mov_b32 m0, 162816
s_add_u32 s41, s57, 118784
buffer_load_dwordx4 v9, s[20:23], s41 offen lds
ds_read_b64_tr_b16 v[96:97], v1 offset:0
ds_read_b64_tr_b16 v[98:99], v1 offset:1024
ds_read_b64_tr_b16 v[100:101], v1 offset:4096
ds_read_b64_tr_b16 v[102:103], v1 offset:5120
ds_read_b64_tr_b16 v[112:113], v1 offset:8192
ds_read_b64_tr_b16 v[114:115], v1 offset:9216
ds_read_b64_tr_b16 v[116:117], v1 offset:12288
ds_read_b64_tr_b16 v[118:119], v1 offset:13312
ds_read_b64_tr_b16 v[144:145], v1 offset:16384
ds_read_b64_tr_b16 v[146:147], v1 offset:17408
ds_read_b64_tr_b16 v[148:149], v1 offset:20480
ds_read_b64_tr_b16 v[150:151], v1 offset:21504
ds_read_b64_tr_b16 v[120:121], v1 offset:24576
ds_read_b64_tr_b16 v[122:123], v1 offset:25600
ds_read_b64_tr_b16 v[124:125], v1 offset:28672
ds_read_b64_tr_b16 v[126:127], v1 offset:29696
s_waitcnt lgkmcnt(0)
s_waitcnt vmcnt(24)
s_barrier
s_mov_b32 m0, 6144
s_add_u32 s41, s57, 134144
buffer_load_dwordx4 v9, s[20:23], s41 offen lds
s_mov_b32 m0, 7168
s_add_u32 s41, s57, 139264
buffer_load_dwordx4 v9, s[20:23], s41 offen lds
s_mov_b32 m0, 14336
s_add_u32 s41, s57, 154624
buffer_load_dwordx4 v9, s[20:23], s41 offen lds
s_mov_b32 m0, 15360
s_add_u32 s41, s57, 159744
buffer_load_dwordx4 v9, s[20:23], s41 offen lds
s_mov_b32 m0, 22528
s_add_u32 s41, s56, 393344
buffer_load_dwordx4 v8, s[12:15], s41 offen lds
s_mov_b32 m0, 23552
s_add_u32 s41, s56, 458880
buffer_load_dwordx4 v8, s[12:15], s41 offen lds
s_mov_b32 m0, 30720
s_add_u32 s41, s56, 917632
buffer_load_dwordx4 v8, s[12:15], s41 offen lds
s_mov_b32 m0, 31744
s_add_u32 s41, s56, 983168
buffer_load_dwordx4 v8, s[12:15], s41 offen lds
ds_read_b64_tr_b16 v[136:137], v1 offset:32768
ds_read_b64_tr_b16 v[138:139], v1 offset:33792
ds_read_b64_tr_b16 v[140:141], v1 offset:36864
ds_read_b64_tr_b16 v[142:143], v1 offset:37888
ds_read_b64_tr_b16 a[192:193], v1 offset:40960
ds_read_b64_tr_b16 a[194:195], v1 offset:41984
ds_read_b64_tr_b16 a[196:197], v1 offset:45056
ds_read_b64_tr_b16 a[198:199], v1 offset:46080
ds_read_b64_tr_b16 a[200:201], v1 offset:49152
ds_read_b64_tr_b16 a[202:203], v1 offset:50176
ds_read_b64_tr_b16 a[204:205], v1 offset:53248
ds_read_b64_tr_b16 a[206:207], v1 offset:54272
ds_read_b64_tr_b16 v[168:169], v5 offset:57344
ds_read_b64_tr_b16 v[170:171], v5 offset:57856
ds_read_b64_tr_b16 v[172:173], v5 offset:59392
ds_read_b64_tr_b16 v[174:175], v5 offset:59904
s_waitcnt lgkmcnt(0)
s_waitcnt vmcnt(24)
s_barrier
s_mov_b32 m0, 38912
s_add_u32 s41, s56, 2490496
buffer_load_dwordx4 v8, s[12:15], s41 offen lds
s_mov_b32 m0, 39936
s_add_u32 s41, s56, 2556032
buffer_load_dwordx4 v8, s[12:15], s41 offen lds
s_mov_b32 m0, 47104
s_add_u32 s41, s56, 4063360
buffer_load_dwordx4 v8, s[12:15], s41 offen lds
s_mov_b32 m0, 48128
s_add_u32 s41, s56, 4128896
buffer_load_dwordx4 v8, s[12:15], s41 offen lds
s_mov_b32 m0, 55296
s_add_u32 s41, s56, 1966208
buffer_load_dwordx4 v8, s[12:15], s41 offen lds
s_mov_b32 m0, 56320
s_add_u32 s41, s56, 2031744
buffer_load_dwordx4 v8, s[12:15], s41 offen lds
s_mov_b32 m0, 63488
s_add_u32 s41, s56, 3014784
buffer_load_dwordx4 v8, s[12:15], s41 offen lds
s_mov_b32 m0, 64512
s_add_u32 s41, s56, 3080320
buffer_load_dwordx4 v8, s[12:15], s41 offen lds
ds_read_b64_tr_b16 v[160:161], v6 offset:0
ds_read_b64_tr_b16 v[162:163], v6 offset:512
ds_read_b64_tr_b16 v[164:165], v6 offset:2048
ds_read_b64_tr_b16 v[166:167], v6 offset:2560
ds_read_b64_tr_b16 v[152:153], v6 offset:8192
ds_read_b64_tr_b16 v[154:155], v6 offset:8704
ds_read_b64_tr_b16 v[156:157], v6 offset:10240
ds_read_b64_tr_b16 v[158:159], v6 offset:10752
ds_read_b64_tr_b16 v[184:185], v6 offset:16384
ds_read_b64_tr_b16 v[186:187], v6 offset:16896
ds_read_b64_tr_b16 v[188:189], v6 offset:18432
ds_read_b64_tr_b16 v[190:191], v6 offset:18944
ds_read_b64_tr_b16 v[192:193], v6 offset:24576
ds_read_b64_tr_b16 v[194:195], v6 offset:25088
ds_read_b64_tr_b16 v[196:197], v6 offset:26624
ds_read_b64_tr_b16 v[198:199], v6 offset:27136
s_waitcnt lgkmcnt(0)
s_waitcnt vmcnt(24)
s_barrier
s_mov_b32 m0, 71680
s_add_u32 s41, s56, 4587648
buffer_load_dwordx4 v8, s[12:15], s41 offen lds
s_mov_b32 m0, 72704
s_add_u32 s41, s56, 4653184
buffer_load_dwordx4 v8, s[12:15], s41 offen lds
s_mov_b32 m0, 79872
s_add_u32 s41, s56, 393344
buffer_load_dwordx4 v8, s[16:19], s41 offen lds
s_mov_b32 m0, 80896
s_add_u32 s41, s56, 458880
buffer_load_dwordx4 v8, s[16:19], s41 offen lds
s_mov_b32 m0, 88064
s_add_u32 s41, s56, 917632
buffer_load_dwordx4 v8, s[16:19], s41 offen lds
s_mov_b32 m0, 89088
s_add_u32 s41, s56, 983168
buffer_load_dwordx4 v8, s[16:19], s41 offen lds
s_mov_b32 m0, 96256
s_add_u32 s41, s56, 2490496
buffer_load_dwordx4 v8, s[16:19], s41 offen lds
s_mov_b32 m0, 97280
s_add_u32 s41, s56, 2556032
buffer_load_dwordx4 v8, s[16:19], s41 offen lds
ds_read_b64_tr_b16 v[16:17], v6 offset:32768
ds_read_b64_tr_b16 v[18:19], v6 offset:33280
ds_read_b64_tr_b16 v[20:21], v6 offset:34816
ds_read_b64_tr_b16 v[22:23], v6 offset:35328
ds_read_b64_tr_b16 v[176:177], v6 offset:40960
ds_read_b64_tr_b16 v[178:179], v6 offset:41472
ds_read_b64_tr_b16 v[180:181], v6 offset:43008
ds_read_b64_tr_b16 v[182:183], v6 offset:43520
ds_read_b64_tr_b16 v[208:209], v6 offset:49152
ds_read_b64_tr_b16 v[210:211], v6 offset:49664
ds_read_b64_tr_b16 v[212:213], v6 offset:51200
ds_read_b64_tr_b16 v[214:215], v6 offset:51712
ds_read_b64_tr_b16 v[216:217], v6 offset:57344
ds_read_b64_tr_b16 v[218:219], v6 offset:57856
ds_read_b64_tr_b16 v[220:221], v6 offset:59392
ds_read_b64_tr_b16 v[222:223], v6 offset:59904
s_waitcnt lgkmcnt(0)
buffer_store_dwordx4 v[16:19], v0, s[4:7], s63 offen offset:0
buffer_store_dwordx4 v[20:23], v0, s[4:7], s63 offen offset:1024
s_waitcnt vmcnt(26)
s_barrier
s_mov_b32 m0, 104448
s_add_u32 s41, s56, 3014784
buffer_load_dwordx4 v8, s[16:19], s41 offen lds
s_mov_b32 m0, 105472
s_add_u32 s41, s56, 3080320
buffer_load_dwordx4 v8, s[16:19], s41 offen lds
s_mov_b32 m0, 112640
s_add_u32 s41, s56, 4063360
buffer_load_dwordx4 v8, s[16:19], s41 offen lds
s_mov_b32 m0, 113664
s_add_u32 s41, s56, 4128896
buffer_load_dwordx4 v8, s[16:19], s41 offen lds
s_mov_b32 m0, 120832
s_add_u32 s41, s56, 4587648
buffer_load_dwordx4 v8, s[16:19], s41 offen lds
s_mov_b32 m0, 121856
s_add_u32 s41, s56, 4653184
buffer_load_dwordx4 v8, s[16:19], s41 offen lds
s_mov_b32 m0, 129024
s_add_u32 s41, s57, 92160
buffer_load_dwordx4 v9, s[20:23], s41 offen lds
s_mov_b32 m0, 130048
s_add_u32 s41, s57, 97280
buffer_load_dwordx4 v9, s[20:23], s41 offen lds
ds_read_b64_tr_b16 v[224:225], v7 offset:0
ds_read_b64_tr_b16 v[226:227], v7 offset:512
ds_read_b64_tr_b16 v[228:229], v7 offset:2048
ds_read_b64_tr_b16 v[230:231], v7 offset:2560
ds_read_b64_tr_b16 v[200:201], v7 offset:8192
ds_read_b64_tr_b16 v[202:203], v7 offset:8704
ds_read_b64_tr_b16 v[204:205], v7 offset:10240
ds_read_b64_tr_b16 v[206:207], v7 offset:10752
ds_read_b64_tr_b16 v[240:241], v7 offset:16384
ds_read_b64_tr_b16 v[242:243], v7 offset:16896
ds_read_b64_tr_b16 v[244:245], v7 offset:18432
ds_read_b64_tr_b16 v[246:247], v7 offset:18944
ds_read_b64_tr_b16 v[248:249], v7 offset:24576
ds_read_b64_tr_b16 v[250:251], v7 offset:25088
ds_read_b64_tr_b16 v[252:253], v7 offset:26624
ds_read_b64_tr_b16 v[254:255], v7 offset:27136
s_waitcnt lgkmcnt(0)
s_waitcnt vmcnt(30)
s_barrier
s_mov_b32 m0, 137216
s_add_u32 s41, s57, 112640
buffer_load_dwordx4 v9, s[20:23], s41 offen lds
s_mov_b32 m0, 138240
s_add_u32 s41, s57, 117760
buffer_load_dwordx4 v9, s[20:23], s41 offen lds
s_mov_b32 m0, 145408
s_add_u32 s41, s57, 133120
buffer_load_dwordx4 v9, s[20:23], s41 offen lds
s_mov_b32 m0, 146432
s_add_u32 s41, s57, 138240
buffer_load_dwordx4 v9, s[20:23], s41 offen lds
s_mov_b32 m0, 153600
s_add_u32 s41, s57, 153600
buffer_load_dwordx4 v9, s[20:23], s41 offen lds
s_mov_b32 m0, 154624
s_add_u32 s41, s57, 158720
buffer_load_dwordx4 v9, s[20:23], s41 offen lds
s_mov_b32 m0, 161792
s_add_u32 s41, s57, 92416
buffer_load_dwordx4 v9, s[20:23], s41 offen lds
s_mov_b32 m0, 162816
s_add_u32 s41, s57, 97536
buffer_load_dwordx4 v9, s[20:23], s41 offen lds
ds_read_b64_tr_b16 v[16:17], v5 offset:0
ds_read_b64_tr_b16 v[18:19], v5 offset:512
ds_read_b64_tr_b16 v[20:21], v5 offset:2048
ds_read_b64_tr_b16 v[22:23], v5 offset:2560
ds_read_b64_tr_b16 v[232:233], v5 offset:8192
ds_read_b64_tr_b16 v[234:235], v5 offset:8704
ds_read_b64_tr_b16 v[236:237], v5 offset:10240
ds_read_b64_tr_b16 v[238:239], v5 offset:10752
s_waitcnt lgkmcnt(0)
buffer_store_dwordx4 v[16:19], v0, s[4:7], s63 offen offset:2048
buffer_store_dwordx4 v[20:23], v0, s[4:7], s63 offen offset:3072
s_waitcnt vmcnt(22)
s_barrier
ds_read_b64_tr_b16 v[8:9], v1 offset:16384
ds_read_b64_tr_b16 v[10:11], v1 offset:17408
ds_read_b64_tr_b16 v[12:13], v1 offset:20480
ds_read_b64_tr_b16 v[14:15], v1 offset:21504
ds_read_b64_tr_b16 v[16:17], v1 offset:24576
ds_read_b64_tr_b16 v[18:19], v1 offset:25600
ds_read_b64_tr_b16 v[20:21], v1 offset:28672
ds_read_b64_tr_b16 v[22:23], v1 offset:29696
ds_read_b64_tr_b16 v[24:25], v1 offset:32768
ds_read_b64_tr_b16 v[26:27], v1 offset:33792
ds_read_b64_tr_b16 v[28:29], v1 offset:36864
ds_read_b64_tr_b16 v[30:31], v1 offset:37888
ds_read_b64_tr_b16 v[32:33], v1 offset:40960
ds_read_b64_tr_b16 v[34:35], v1 offset:41984
ds_read_b64_tr_b16 v[36:37], v1 offset:45056
ds_read_b64_tr_b16 v[38:39], v1 offset:46080
ds_read_b64_tr_b16 v[40:41], v1 offset:49152
ds_read_b64_tr_b16 v[42:43], v1 offset:50176
ds_read_b64_tr_b16 v[44:45], v1 offset:53248
ds_read_b64_tr_b16 v[46:47], v1 offset:54272
ds_read_b64_tr_b16 v[48:49], v1 offset:57344
ds_read_b64_tr_b16 v[50:51], v1 offset:58368
ds_read_b64_tr_b16 v[52:53], v1 offset:61440
ds_read_b64_tr_b16 v[54:55], v1 offset:62464
ds_read_b64_tr_b16 v[56:57], v2 offset:0
ds_read_b64_tr_b16 v[58:59], v2 offset:1024
ds_read_b64_tr_b16 v[60:61], v2 offset:4096
ds_read_b64_tr_b16 v[62:63], v2 offset:5120
ds_read_b64_tr_b16 v[64:65], v2 offset:8192
ds_read_b64_tr_b16 v[66:67], v2 offset:9216
ds_read_b64_tr_b16 v[68:69], v2 offset:12288
ds_read_b64_tr_b16 v[70:71], v2 offset:13312
ds_read_b64_tr_b16 v[72:73], v2 offset:16384
ds_read_b64_tr_b16 v[74:75], v2 offset:17408
ds_read_b64_tr_b16 v[76:77], v2 offset:20480
ds_read_b64_tr_b16 v[78:79], v2 offset:21504
s_waitcnt lgkmcnt(0)
s_barrier
ds_write_b128 v4, v[8:11] offset:6144
ds_write_b128 v4, v[12:15] offset:7168
ds_write_b128 v4, v[16:19] offset:8192
ds_write_b128 v4, v[20:23] offset:9216
ds_write_b128 v4, v[24:27] offset:10240
ds_write_b128 v4, v[28:31] offset:11264
ds_write_b128 v4, a[168:171] offset:12288
ds_write_b128 v4, a[172:175] offset:13312
ds_write_b128 v4, v[40:43] offset:14336
ds_write_b128 v4, v[44:47] offset:15360
ds_write_b128 v4, a[152:155] offset:16384
ds_write_b128 v4, a[156:159] offset:17408
ds_write_b128 v4, a[184:187] offset:18432
ds_write_b128 v4, a[188:191] offset:19456
ds_write_b128 v4, v[64:67] offset:20480
ds_write_b128 v4, v[68:71] offset:21504
ds_write_b128 v4, a[224:227] offset:22528
ds_write_b128 v4, a[228:231] offset:23552
s_waitcnt lgkmcnt(0)
v_accvgpr_write_b32 a168, v32
v_accvgpr_write_b32 a169, v33
v_accvgpr_write_b32 a170, v34
v_accvgpr_write_b32 a171, v35
v_accvgpr_write_b32 a172, v36
v_accvgpr_write_b32 a173, v37
v_accvgpr_write_b32 a174, v38
v_accvgpr_write_b32 a175, v39
v_accvgpr_write_b32 a152, v48
v_accvgpr_write_b32 a153, v49
v_accvgpr_write_b32 a154, v50
v_accvgpr_write_b32 a155, v51
v_accvgpr_write_b32 a156, v52
v_accvgpr_write_b32 a157, v53
v_accvgpr_write_b32 a158, v54
v_accvgpr_write_b32 a159, v55
v_accvgpr_write_b32 a184, v56
v_accvgpr_write_b32 a185, v57
v_accvgpr_write_b32 a186, v58
v_accvgpr_write_b32 a187, v59
v_accvgpr_write_b32 a188, v60
v_accvgpr_write_b32 a189, v61
v_accvgpr_write_b32 a190, v62
v_accvgpr_write_b32 a191, v63
v_accvgpr_write_b32 a224, v72
v_accvgpr_write_b32 a225, v73
v_accvgpr_write_b32 a226, v74
v_accvgpr_write_b32 a227, v75
v_accvgpr_write_b32 a228, v76
v_accvgpr_write_b32 a229, v77
v_accvgpr_write_b32 a230, v78
v_accvgpr_write_b32 a231, v79
s_waitcnt vmcnt(2)
s_barrier
ds_read_b64_tr_b16 v[8:9], v2 offset:24576
ds_read_b64_tr_b16 v[10:11], v2 offset:25600
ds_read_b64_tr_b16 v[12:13], v2 offset:28672
ds_read_b64_tr_b16 v[14:15], v2 offset:29696
ds_read_b64_tr_b16 v[16:17], v2 offset:32768
ds_read_b64_tr_b16 v[18:19], v2 offset:33792
ds_read_b64_tr_b16 v[20:21], v2 offset:36864
ds_read_b64_tr_b16 v[22:23], v2 offset:37888
ds_read_b64_tr_b16 v[24:25], v2 offset:40960
ds_read_b64_tr_b16 v[26:27], v2 offset:41984
ds_read_b64_tr_b16 v[28:29], v2 offset:45056
ds_read_b64_tr_b16 v[30:31], v2 offset:46080
ds_read_b64_tr_b16 v[32:33], v2 offset:49152
ds_read_b64_tr_b16 v[34:35], v2 offset:50176
ds_read_b64_tr_b16 v[36:37], v2 offset:53248
ds_read_b64_tr_b16 v[38:39], v2 offset:54272
ds_read_b64_tr_b16 v[40:41], v6 offset:57344
ds_read_b64_tr_b16 v[42:43], v6 offset:57856
ds_read_b64_tr_b16 v[44:45], v6 offset:59392
ds_read_b64_tr_b16 v[46:47], v6 offset:59904
ds_read_b64_tr_b16 v[48:49], v7 offset:0
ds_read_b64_tr_b16 v[50:51], v7 offset:512
ds_read_b64_tr_b16 v[52:53], v7 offset:2048
ds_read_b64_tr_b16 v[54:55], v7 offset:2560
ds_read_b64_tr_b16 v[56:57], v7 offset:8192
ds_read_b64_tr_b16 v[58:59], v7 offset:8704
ds_read_b64_tr_b16 v[60:61], v7 offset:10240
ds_read_b64_tr_b16 v[62:63], v7 offset:10752
ds_read_b64_tr_b16 v[64:65], v7 offset:16384
ds_read_b64_tr_b16 v[66:67], v7 offset:16896
ds_read_b64_tr_b16 v[68:69], v7 offset:18432
ds_read_b64_tr_b16 v[70:71], v7 offset:18944
ds_read_b64_tr_b16 v[72:73], v7 offset:24576
ds_read_b64_tr_b16 v[74:75], v7 offset:25088
ds_read_b64_tr_b16 v[76:77], v7 offset:26624
ds_read_b64_tr_b16 v[78:79], v7 offset:27136
s_waitcnt lgkmcnt(0)
s_barrier
ds_write_b128 v4, v[8:11] offset:43008
ds_write_b128 v4, v[12:15] offset:44032
ds_write_b128 v4, v[104:107] offset:45056
ds_write_b128 v4, v[108:111] offset:46080
ds_write_b128 v4, v[128:131] offset:47104
ds_write_b128 v4, v[132:135] offset:48128
ds_write_b128 v4, v[32:35] offset:49152
ds_write_b128 v4, v[36:39] offset:50176
ds_write_b128 v4, v[144:147] offset:51200
ds_write_b128 v4, v[148:151] offset:52224
ds_write_b128 v4, v[152:155] offset:53248
ds_write_b128 v4, v[156:159] offset:54272
ds_write_b128 v4, v[56:59] offset:55296
ds_write_b128 v4, v[60:63] offset:56320
ds_write_b128 v4, v[64:67] offset:57344
ds_write_b128 v4, v[68:71] offset:58368
ds_write_b128 v4, v[160:163] offset:59392
ds_write_b128 v4, v[164:167] offset:60416
s_waitcnt lgkmcnt(0)
v_mov_b32 v104, v16
v_mov_b32 v105, v17
v_mov_b32 v106, v18
v_mov_b32 v107, v19
v_mov_b32 v108, v20
v_mov_b32 v109, v21
v_mov_b32 v110, v22
v_mov_b32 v111, v23
v_mov_b32 v128, v24
v_mov_b32 v129, v25
v_mov_b32 v130, v26
v_mov_b32 v131, v27
v_mov_b32 v132, v28
v_mov_b32 v133, v29
v_mov_b32 v134, v30
v_mov_b32 v135, v31
v_mov_b32 v144, v40
v_mov_b32 v145, v41
v_mov_b32 v146, v42
v_mov_b32 v147, v43
v_mov_b32 v148, v44
v_mov_b32 v149, v45
v_mov_b32 v150, v46
v_mov_b32 v151, v47
v_mov_b32 v152, v48
v_mov_b32 v153, v49
v_mov_b32 v154, v50
v_mov_b32 v155, v51
v_mov_b32 v156, v52
v_mov_b32 v157, v53
v_mov_b32 v158, v54
v_mov_b32 v159, v55
v_mov_b32 v160, v72
v_mov_b32 v161, v73
v_mov_b32 v162, v74
v_mov_b32 v163, v75
v_mov_b32 v164, v76
v_mov_b32 v165, v77
v_mov_b32 v166, v78
v_mov_b32 v167, v79
v_lshrrev_b32 v8, 4, v0
v_and_b32 v9, 8, v8
v_cmp_ne_u32 s[42:43], 0, v9
v_and_b32 v9, 1, v8
v_cmp_ne_u32 s[44:45], 0, v9
v_bfe_u32 v9, v8, 1, 2
v_cmp_eq_u32 s[46:47], 0, v9
v_cmp_eq_u32 s[48:49], 1, v9
v_cmp_eq_u32 s[50:51], 2, v9
v_cmp_eq_u32 s[52:53], 3, v9
v_mov_b32 v1, 0x4444
v_mov_b32 v10, 0xeeee
v_cndmask_b32 v1, v1, v10, s[42:43]
v_mov_b32 v10, 0x3f80
v_cndmask_b32 v10, v10, 1.0, s[44:45]
v_bfe_u32 v11, v8, 4, 1
v_lshlrev_b32 v11, 1, v11
v_sub_u32 v9, v9, v11
v_cmp_eq_u32 vcc, 0, v9
s_nop 1
v_cndmask_b32 v2, 0, v10, vcc
v_cmp_eq_u32 vcc, 1, v9
s_nop 1
v_cndmask_b32 v3, 0, v10, vcc
v_lshrrev_b32 v9, 4, v8
v_and_b32 v10, 15, v8
v_lshlrev_b32 v10, 3, v10
v_lshl_add_u32 v5, v9, 12, v10
v_lshlrev_b32 v6, 2, v9
v_and_b32 v10, 3, v8
v_lshl_add_u32 v6, v10, 4, v6
v_bfe_u32 v10, v8, 2, 1
v_lshl_add_u32 v6, v10, 7, v6
v_and_b32 v7, 511, v0
s_mov_b32 s54, 0x3e0293ee
s_cmp_lg_u32 s3, 0
s_cbranch_scc1 k_wdd_193
v_mov_b32 v8, 192
k_wd_192:
global_load_dword v9, v8, s[28:29] sc1
s_waitcnt vmcnt(0)
v_readfirstlane_b32 s41, v9
s_cmp_ge_u32 s41, 32
s_cbranch_scc1 k_wdd_193
s_sleep 2
s_sub_u32 s32, s32, 1
s_cmp_gt_i32 s32, 0
s_cbranch_scc1 k_wd_192
k_wdd_193:
s_barrier
s_mov_b32 s68, 0
s_mov_b32 s31, 0
s_mov_b32 s33, 117449728
s_mov_b32 s34, 117440512
s_lshl_b32 s35, s30, 14
s_add_u32 s35, s35, 12288
s_lshl_b32 s40, s30, 13
s_add_u32 s40, s40, 83892224
s_lshl_b32 s36, s30, 7
s_add_u32 s36, s36, 119586816
s_mov_b32 s55, 327680
s_waitcnt vmcnt(0)
s_barrier
s_barrier
buffer_load_dwordx4 v[40:43], v0, s[4:7], s60 offen offset:0
buffer_load_dwordx4 v[44:47], v0, s[4:7], s60 offen offset:1024
buffer_load_dwordx4 v[48:51], v0, s[4:7], s60 offen offset:2048
buffer_load_dwordx4 v[52:55], v0, s[4:7], s60 offen offset:3072
buffer_load_dwordx4 v[64:67], v0, s[4:7], s61 offen offset:0
buffer_load_dwordx4 v[68:71], v0, s[4:7], s61 offen offset:1024
buffer_load_dwordx4 v[72:75], v0, s[4:7], s61 offen offset:2048
buffer_load_dwordx4 v[76:79], v0, s[4:7], s61 offen offset:3072
buffer_load_dwordx4 v[56:59], v0, s[4:7], s62 offen offset:0
buffer_load_dwordx4 v[60:63], v0, s[4:7], s62 offen offset:1024
v_mov_b64 v[24:25], 0
v_mov_b64 v[26:27], 0
v_mov_b64 v[28:29], 0
v_mov_b64 v[30:31], 0
v_mov_b64 v[32:33], 0
v_mov_b64 v[34:35], 0
v_mov_b64 v[36:37], 0
v_mov_b64 v[38:39], 0
k_top_195:
s_add_u32 s41, s31, 0
s_cmp_gt_u32 s68, s41
s_cbranch_scc1 k_cd_204
s_lshl_b32 s56, s30, 6
s_add_u32 s56, s56, 222330880
k_ck_203:
buffer_load_dwordx2 v[8:9], off, s[4:7], s56 sc1
s_waitcnt vmcnt(0)
v_min_u32 v8, v8, v9
s_nop 0
v_readfirstlane_b32 s68, v8
s_cmp_gt_u32 s68, s41
s_cbranch_scc1 k_cd_204
s_sub_u32 s32, s32, 1
s_cmp_gt_i32 s32, 0
s_cbranch_scc1 k_ck_203
k_cd_204:
k_poll2_196:
buffer_load_dwordx4 v[12:15], v0, s[4:7], s33 offen offset:0 sc1
buffer_load_dwordx4 v[16:19], v0, s[4:7], s34 offen offset:0 sc1
buffer_load_dwordx4 v[20:23], v0, s[4:7], s34 offen offset:1024 sc1
s_waitcnt vmcnt(2)
v_max3_u32 v8, v12, v13, v14
v_max_u32 v8, v8, v15
s_waitcnt vmcnt(1)
v_max3_u32 v8, v8, v16, v17
v_max3_u32 v8, v8, v18, v19
s_waitcnt vmcnt(0)
v_max3_u32 v8, v8, v20, v21
v_max3_u32 v8, v8, v22, v23
v_cmp_eq_u32 vcc, -1, v8
s_cbranch_vccnz k_retry2_197
k_poll2_196_ok:
ds_write_b128 v0, v[12:15] offset:9216
v_smfmac_f32_16x16x64_bf16 v[24:27], v[16:19], v[64:71], v1
ds_read_b128 v[64:67], v4 offset:6144
v_smfmac_f32_16x16x64_bf16 v[28:31], v[16:19], v[72:79], v1
ds_read_b128 v[68:71], v4 offset:7168
v_smfmac_f32_16x16x64_bf16 v[24:27], v[12:15], v[40:47], v1
ds_read_b128 v[72:75], v4 offset:8192
v_smfmac_f32_16x16x64_bf16 v[28:31], v[12:15], v[48:55], v1
ds_read_b128 v[76:79], v4 offset:9216
v_smfmac_f32_16x16x64_bf16 v[24:27], v[20:23], v[56:63], v1
v_smfmac_f32_16x16x64_bf16 v[28:31], v[20:23], a[0:7], v1
v_smfmac_f32_16x16x64_bf16 v[32:35], v[12:15], a[88:95], v1
buffer_load_dwordx4 v[40:43], v0, s[4:7], s62 offen offset:2048
v_smfmac_f32_16x16x64_bf16 v[36:39], v[12:15], a[96:103], v1
buffer_load_dwordx4 v[44:47], v0, s[4:7], s62 offen offset:3072
s_waitcnt lgkmcnt(4)
s_barrier
ds_read_b128 v[8:11], v0 offset:2048
v_smfmac_f32_16x16x64_bf16 v[32:35], v[16:19], a[104:111], v1
s_waitcnt lgkmcnt(3)
ds_read_b128 v[12:15], v0 offset:3072
v_smfmac_f32_16x16x64_bf16 v[36:39], v[16:19], v[64:71], v1
ds_read_b128 v[16:19], v0 offset:4096
buffer_load_dwordx4 v[48:51], v0, s[4:7], s35 offen offset:0 sc1
v_smfmac_f32_16x16x64_bf16 v[32:35], v[20:23], a[112:119], v1
s_waitcnt lgkmcnt(3)
buffer_load_dwordx4 v[52:55], v0, s[4:7], s35 offen offset:1024 sc1
ds_read_b128 v[64:67], v4 offset:12288
v_smfmac_f32_16x16x64_bf16 v[36:39], v[20:23], v[72:79], v1
s_waitcnt lgkmcnt(3)
ds_read_b128 v[68:71], v4 offset:13312
ds_read_b128 v[20:23], v0 offset:5120
v_smfmac_f32_16x16x64_bf16 v[24:27], v[8:11], a[8:15], v1
ds_read_b128 v[72:75], v4 offset:16384
v_smfmac_f32_16x16x64_bf16 v[28:31], v[8:11], a[16:23], v1
s_waitcnt lgkmcnt(5)
ds_read_b128 v[8:11], v0 offset:6144
v_smfmac_f32_16x16x64_bf16 v[24:27], v[12:15], a[24:31], v1
s_waitcnt lgkmcnt(3)
ds_read_b128 v[76:79], v4 offset:17408
v_smfmac_f32_16x16x64_bf16 v[28:31], v[12:15], v[64:71], v1
ds_read_b128 v[12:15], v0 offset:7168
v_smfmac_f32_16x16x64_bf16 v[24:27], v[16:19], a[32:39], v1
ds_read_b128 v[64:67], v4 offset:18432
v_smfmac_f32_16x16x64_bf16 v[28:31], v[16:19], a[40:47], v1
s_waitcnt lgkmcnt(2)
ds_read_b128 v[16:19], v0 offset:8192
v_smfmac_f32_16x16x64_bf16 v[24:27], v[20:23], v[72:79], v1
ds_read_b128 v[68:71], v4 offset:19456
v_smfmac_f32_16x16x64_bf16 v[28:31], v[20:23], a[48:55], v1
buffer_load_dwordx4 v[56:59], v0, s[4:7], s35 offen offset:2048 sc1
v_smfmac_f32_16x16x64_bf16 v[24:27], v[8:11], a[56:63], v1
s_waitcnt lgkmcnt(0)
buffer_load_dwordx4 v[60:63], v0, s[4:7], s35 offen offset:3072 sc1
v_smfmac_f32_16x16x64_bf16 v[28:31], v[8:11], v[64:71], v1
ds_read_b128 v[72:75], v4 offset:22528
v_smfmac_f32_16x16x64_bf16 v[24:27], v[12:15], a[64:71], v1
ds_read_b128 v[76:79], v4 offset:23552
v_smfmac_f32_16x16x64_bf16 v[28:31], v[12:15], a[72:79], v1
s_waitcnt lgkmcnt(0)
ds_read_b128 v[64:67], v4 offset:45056
v_smfmac_f32_16x16x64_bf16 v[24:27], v[16:19], v[72:79], v1
ds_read_b128 v[68:71], v4 offset:46080
v_smfmac_f32_16x16x64_bf16 v[28:31], v[16:19], a[80:87], v1
ds_read_b128 v[72:75], v4 offset:47104
v_smfmac_f32_16x16x64_bf16 v[32:35], v[16:19], a[176:183], v1
ds_read_b128 v[76:79], v4 offset:48128
v_smfmac_f32_16x16x64_bf16 v[36:39], v[16:19], a[184:191], v1
s_waitcnt lgkmcnt(2)
ds_read_b128 v[16:19], v0 offset:4096
v_cvt_pk_bf16_f32 v24, v24, v25
v_smfmac_f32_16x16x64_bf16 v[32:35], v[12:15], v[64:71], v1
ds_read_b128 v[64:67], v4 offset:10240
v_cvt_pk_bf16_f32 v25, v26, v27
v_smfmac_f32_16x16x64_bf16 v[36:39], v[12:15], a[168:175], v1
ds_read_b128 v[68:71], v4 offset:11264
v_cvt_pk_bf16_f32 v28, v28, v29
v_mfma_f32_16x16x16_bf16 v[24:27], v[24:25], v[2:3], 0
ds_read_b128 v[12:15], v0 offset:3072
v_cvt_pk_bf16_f32 v29, v30, v31
v_smfmac_f32_16x16x64_bf16 v[32:35], v[8:11], a[160:167], v1
v_mfma_f32_16x16x16_bf16 v[28:31], v[28:29], v[2:3], 0
s_waitcnt lgkmcnt(4)
v_smfmac_f32_16x16x64_bf16 v[36:39], v[8:11], v[72:79], v1
s_waitcnt vmcnt(4)
ds_read_b128 v[72:75], v4 offset:14336
v_cvt_pk_bf16_f32 v24, v24, v25
v_smfmac_f32_16x16x64_bf16 v[32:35], v[20:23], v[40:47], v1
ds_read_b128 v[76:79], v4 offset:15360
v_cvt_pk_bf16_f32 v25, v26, v27
v_smfmac_f32_16x16x64_bf16 v[36:39], v[20:23], a[152:159], v1
ds_read_b128 v[20:23], v0 offset:2048
v_cvt_pk_bf16_f32 v26, v28, v29
v_cvt_pk_bf16_f32 v27, v30, v31
s_waitcnt lgkmcnt(6)
v_smfmac_f32_16x16x64_bf16 v[32:35], v[16:19], a[144:151], v1
s_waitcnt vmcnt(3)
v_mfma_f32_16x16x32_bf16 v[28:31], v[48:51], v[24:27], 0
s_waitcnt vmcnt(2)
v_mfma_f32_16x16x32_bf16 v[8:11], v[52:55], v[24:27], 0
s_waitcnt lgkmcnt(4)
v_smfmac_f32_16x16x64_bf16 v[36:39], v[16:19], v[64:71], v1
s_waitcnt lgkmcnt(3)
ds_read_b128 v[64:67], v4 offset:43008
v_mov_b64 v[44:45], 0
v_smfmac_f32_16x16x64_bf16 v[32:35], v[12:15], a[136:143], v1
s_waitcnt lgkmcnt(2)
ds_read_b128 v[68:71], v4 offset:44032
v_mov_b64 v[46:47], 0
v_smfmac_f32_16x16x64_bf16 v[36:39], v[12:15], v[72:79], v1
ds_read_b128 v[72:75], v4 offset:51200
v_cndmask_b32 v28, v28, v8, s[42:43]
v_cndmask_b32 v29, v29, v9, s[42:43]
s_waitcnt lgkmcnt(3)
v_smfmac_f32_16x16x64_bf16 v[32:35], v[20:23], a[120:127], v1
ds_read_b128 v[76:79], v4 offset:52224
v_cndmask_b32 v30, v30, v10, s[42:43]
v_cndmask_b32 v31, v31, v11, s[42:43]
v_smfmac_f32_16x16x64_bf16 v[36:39], v[20:23], a[128:135], v1
ds_write_b128 v0, v[28:31] offset:13312
v_mov_b64 v[40:41], 0
v_mov_b64 v[42:43], 0
v_smfmac_f32_16x16x64_bf16 v[44:47], v[20:23], a[240:247], v1
v_cvt_pk_bf16_f32 v32, v32, v33
v_cvt_pk_bf16_f32 v33, v34, v35
v_smfmac_f32_16x16x64_bf16 v[40:43], v[20:23], a[232:239], v1
ds_read_b128 v[20:23], v0 offset:5120
v_mfma_f32_16x16x16_bf16 v[32:35], v[32:33], v[2:3], 0
v_cvt_pk_bf16_f32 v36, v36, v37
v_cvt_pk_bf16_f32 v37, v38, v39
s_waitcnt lgkmcnt(0)
s_barrier
v_mfma_f32_16x16x16_bf16 v[36:39], v[36:37], v[2:3], 0
ds_read_b128 v[48:51], v0 offset:10240
v_smfmac_f32_16x16x64_bf16 v[40:43], v[12:15], a[248:255], v1
ds_read_b128 v[52:55], v0 offset:11264
v_cvt_pk_bf16_f32 v32, v32, v33
v_cvt_pk_bf16_f32 v33, v34, v35
v_smfmac_f32_16x16x64_bf16 v[44:47], v[12:15], v[80:87], v1
ds_read_b128 v[12:15], v0 offset:6144
v_cvt_pk_bf16_f32 v34, v36, v37
v_cvt_pk_bf16_f32 v35, v38, v39
s_nop 1
v_mfma_f32_16x16x32_bf16 v[36:39], v[32:35], v[24:27], 0
ds_read_b128 v[8:11], v0 offset:12288
v_smfmac_f32_16x16x64_bf16 v[40:43], v[16:19], v[88:95], v1
buffer_store_dwordx4 v[32:35], v0, s[4:7], s40 offen sc1
s_waitcnt lgkmcnt(3)
v_add_f32 v28, v28, v48
v_add_f32 v29, v29, v49
v_smfmac_f32_16x16x64_bf16 v[44:47], v[16:19], v[64:71], v1
ds_write_b128 v7, v[36:39] offset:15872
v_smfmac_f32_16x16x64_bf16 v[40:43], v[20:23], v[96:103], v1
ds_read_b128 v[16:19], v0 offset:7168
v_add_f32 v30, v30, v50
v_add_f32 v31, v31, v51
v_smfmac_f32_16x16x64_bf16 v[44:47], v[20:23], v[104:111], v1
ds_read_b128 v[20:23], v0 offset:8192
s_waitcnt lgkmcnt(5)
v_add_f32 v28, v28, v52
v_add_f32 v29, v29, v53
s_waitcnt lgkmcnt(4)
v_smfmac_f32_16x16x64_bf16 v[40:43], v[12:15], v[112:119], v1
ds_read_b128 v[64:67], v4 offset:49152
v_add_f32 v30, v30, v54
v_add_f32 v31, v31, v55
v_smfmac_f32_16x16x64_bf16 v[44:47], v[12:15], v[72:79], v1
ds_read_b128 v[12:15], v0 offset:9216
s_waitcnt lgkmcnt(5)
v_add_f32 v28, v28, v8
v_add_f32 v29, v29, v9
s_waitcnt lgkmcnt(3)
v_smfmac_f32_16x16x64_bf16 v[40:43], v[16:19], v[120:127], v1
ds_read_b128 v[68:71], v4 offset:50176
v_add_f32 v30, v30, v10
v_add_f32 v31, v31, v11
s_waitcnt lgkmcnt(0)
s_barrier
ds_read_b128 v[48:51], v7 offset:14336
ds_read_b128 v[52:55], v7 offset:14848
ds_read_b128 v[8:11], v7 offset:15360
v_smfmac_f32_16x16x64_bf16 v[44:47], v[16:19], v[128:135], v1
ds_read_b128 v[16:19], v0 offset:0
v_max3_f32 v24, v28, v29, v30
v_smfmac_f32_16x16x64_bf16 v[40:43], v[20:23], v[136:143], v1
ds_read_b128 v[72:75], v4 offset:20480
v_max_f32 v24, v24, v31
v_smfmac_f32_16x16x64_bf16 v[44:47], v[20:23], v[64:71], v1
ds_read_b128 v[20:23], v0 offset:1024
v_max_f32_dpp v24, v24, v24 row_ror:8 row_mask:0xf bank_mask:0xf
v_smfmac_f32_16x16x64_bf16 v[40:43], v[12:15], a[192:199], v1
ds_read_b128 v[76:79], v4 offset:21504
v_mov_b32 v25, v24
v_smfmac_f32_16x16x64_bf16 v[44:47], v[12:15], a[200:207], v1
s_waitcnt lgkmcnt(3)
ds_read_b128 v[64:67], v4 offset:57344
v_permlane32_swap_b32 v24, v25
v_smfmac_f32_16x16x64_bf16 v[40:43], v[16:19], a[208:215], v1
s_waitcnt lgkmcnt(1)
ds_read_b128 v[68:71], v4 offset:58368
v_max_f32 v24, v24, v25
v_smfmac_f32_16x16x64_bf16 v[44:47], v[16:19], v[72:79], v1
ds_read_b128 v[72:75], v4 offset:53248
v_smfmac_f32_16x16x64_bf16 v[40:43], v[20:23], a[216:223], v1
ds_read_b128 v[76:79], v4 offset:54272
v_smfmac_f32_16x16x64_bf16 v[44:47], v[20:23], a[224:231], v1
v_add_f32 v36, v36, v48
v_add_f32 v37, v37, v49
v_add_f32 v38, v38, v50
v_add_f32 v39, v39, v51
v_add_f32 v36, v36, v52
v_add_f32 v37, v37, v53
v_add_f32 v38, v38, v54
v_add_f32 v39, v39, v55
v_add_f32 v36, v36, v8
v_add_f32 v37, v37, v9
v_add_f32 v38, v38, v10
v_add_f32 v39, v39, v11
buffer_load_dwordx4 v[48:51], v0, s[4:7], s63 offen offset:0
buffer_load_dwordx4 v[52:55], v0, s[4:7], s63 offen offset:1024
v_max3_f32 v24, v24, v36, v37
v_max3_f32 v24, v24, v38, v39
v_mov_b32 v25, v24
v_cvt_pk_bf16_f32 v40, v40, v41
v_cvt_pk_bf16_f32 v41, v42, v43
v_permlane16_swap_b32 v24, v25
v_max_f32 v24, v24, v25
v_mul_f32 v24, s54, v24
v_fma_f32 v28, v28, s54, -v24
v_exp_f32 v28, v28
v_fma_f32 v29, v29, s54, -v24
v_exp_f32 v29, v29
v_fma_f32 v30, v30, s54, -v24
v_exp_f32 v30, v30
v_fma_f32 v31, v31, s54, -v24
v_exp_f32 v31, v31
v_fma_f32 v36, v36, s54, -v24
v_exp_f32 v36, v36
v_fma_f32 v37, v37, s54, -v24
v_exp_f32 v37, v37
v_fma_f32 v38, v38, s54, -v24
v_exp_f32 v38, v38
v_fma_f32 v39, v39, s54, -v24
v_exp_f32 v39, v39
v_cvt_pk_bf16_f32 v24, v28, v29
v_cvt_pk_bf16_f32 v25, v30, v31
v_cvt_pk_bf16_f32 v26, v28, v29
v_cvt_pk_bf16_f32 v27, v30, v31
v_cvt_pk_bf16_f32 v32, v36, v37
v_cvt_pk_bf16_f32 v33, v38, v39
v_mov_b32_dpp v24, v26 row_ror:8 row_mask:0xf bank_mask:0xc
v_mov_b32_dpp v25, v27 row_ror:8 row_mask:0xf bank_mask:0xc
v_mov_b32_dpp v26, v26 row_ror:8 row_mask:0xf bank_mask:0x3
v_mov_b32_dpp v27, v27 row_ror:8 row_mask:0xf bank_mask:0x3
v_cvt_pk_bf16_f32 v42, v44, v45
v_cvt_pk_bf16_f32 v43, v46, v47
v_mov_b32 v8, 0x40004000
v_mov_b32 v9, 0x40004000
v_mov_b32 v10, 0x40004000
v_mov_b32 v11, 0x40004000
v_mov_b32 v34, 0x3f803f80
v_mov_b32 v35, 0x3f803f80
buffer_store_dwordx4 v[40:43], v0, s[4:7], s40 offen offset:1024 sc1
s_cmp_eq_u32 s31, 63
s_cbranch_scc1 k_done_198
v_mfma_f32_16x16x32_bf16 v[20:23], v[8:11], v[24:27], 0
s_waitcnt vmcnt(5)
v_mov_b64 v[28:29], 0
v_mov_b64 v[30:31], 0
v_mfma_f32_16x16x32_bf16 v[12:15], v[56:59], v[24:27], 0
v_mov_b64 v[36:37], 0
v_mov_b64 v[38:39], 0
v_mfma_f32_16x16x16_bf16 v[20:23], v[34:35], v[32:33], v[20:23]
s_waitcnt vmcnt(4)
v_mov_b64 v[44:45], 0
v_mov_b64 v[46:47], 0
v_mfma_f32_16x16x32_bf16 v[16:19], v[60:63], v[24:27], 0
buffer_load_dwordx4 v[56:59], v0, s[4:7], s63 offen offset:2048
v_mov_b64 v[24:25], 0
v_mfma_f32_16x16x16_bf16 v[12:15], v[40:41], v[32:33], v[12:15]
buffer_load_dwordx4 v[60:63], v0, s[4:7], s63 offen offset:3072
v_rcp_f32 v20, v20
v_mfma_f32_16x16x16_bf16 v[16:19], v[42:43], v[32:33], v[16:19]
v_mov_b64 v[26:27], 0
s_nop 1
v_mul_f32 v12, v12, v20
v_mul_f32 v13, v13, v20
v_mul_f32 v14, v14, v20
v_mul_f32 v15, v15, v20
v_cvt_pk_bf16_f32 v8, v12, v13
v_cvt_pk_bf16_f32 v9, v14, v15
v_mul_f32 v16, v16, v20
v_mul_f32 v17, v17, v20
v_mul_f32 v18, v18, v20
v_mul_f32 v19, v19, v20
v_cvt_pk_bf16_f32 v10, v16, v17
v_cvt_pk_bf16_f32 v11, v18, v19
ds_write_b128 v0, v[8:11] offset:13312
s_waitcnt lgkmcnt(3)
v_smfmac_f32_16x16x64_bf16 v[44:47], v[8:11], v[64:71], v1
s_waitcnt lgkmcnt(1)
v_mov_b64 v[32:33], 0
v_smfmac_f32_16x16x64_bf16 v[28:31], v[8:11], v[72:79], v1
v_mov_b64 v[34:35], 0
v_smfmac_f32_16x16x64_bf16 v[36:39], v[8:11], v[176:183], v1
s_waitcnt lgkmcnt(0)
s_barrier
ds_read_b128 v[12:15], v0 offset:10240
v_smfmac_f32_16x16x64_bf16 v[24:27], v[8:11], v[200:207], v1
ds_read_b128 v[16:19], v0 offset:11264
ds_read_b128 v[20:23], v0 offset:12288
v_smfmac_f32_16x16x64_bf16 v[32:35], v[8:11], v[232:239], v1
ds_read_b128 v[64:67], v4 offset:55296
ds_read_b128 v[68:71], v4 offset:56320
ds_read_b128 v[72:75], v4 offset:59392
ds_read_b128 v[76:79], v4 offset:60416
s_mov_b32 s41, s36
s_waitcnt lgkmcnt(6)
v_smfmac_f32_16x16x64_bf16 v[44:47], v[12:15], v[144:151], v1
s_waitcnt lgkmcnt(5)
v_smfmac_f32_16x16x64_bf16 v[44:47], v[16:19], v[152:159], v1
s_waitcnt lgkmcnt(2)
v_smfmac_f32_16x16x64_bf16 v[44:47], v[20:23], v[64:71], v1
v_smfmac_f32_16x16x64_bf16 v[28:31], v[12:15], v[160:167], v1
buffer_load_dwordx4 v[64:67], v0, s[4:7], s61 offen offset:0
v_smfmac_f32_16x16x64_bf16 v[28:31], v[16:19], v[168:175], v1
buffer_load_dwordx4 v[68:71], v0, s[4:7], s61 offen offset:1024
v_cvt_pk_bf16_f32 v44, v44, v45
v_cvt_pk_bf16_f32 v45, v46, v47
buffer_store_dwordx2 v[44:45], v5, s[4:7], s41 offen
s_add_u32 s41, s41, 65536
s_waitcnt lgkmcnt(0)
v_smfmac_f32_16x16x64_bf16 v[28:31], v[20:23], v[72:79], v1
buffer_load_dwordx4 v[40:43], v0, s[4:7], s60 offen offset:0
v_smfmac_f32_16x16x64_bf16 v[36:39], v[12:15], v[184:191], v1
buffer_load_dwordx4 v[44:47], v0, s[4:7], s60 offen offset:1024
v_smfmac_f32_16x16x64_bf16 v[36:39], v[16:19], v[192:199], v1
buffer_load_dwordx4 v[72:75], v0, s[4:7], s61 offen offset:2048
v_cvt_pk_bf16_f32 v28, v28, v29
v_cvt_pk_bf16_f32 v29, v30, v31
buffer_store_dwordx2 v[28:29], v5, s[4:7], s41 offen
s_add_u32 s41, s41, 65536
s_waitcnt vmcnt(10)
v_smfmac_f32_16x16x64_bf16 v[36:39], v[20:23], v[48:55], v1
buffer_load_dwordx4 v[76:79], v0, s[4:7], s61 offen offset:3072
v_smfmac_f32_16x16x64_bf16 v[24:27], v[12:15], v[208:215], v1
buffer_load_dwordx4 v[48:51], v0, s[4:7], s60 offen offset:2048
v_smfmac_f32_16x16x64_bf16 v[24:27], v[16:19], v[216:223], v1
buffer_load_dwordx4 v[52:55], v0, s[4:7], s60 offen offset:3072
v_cvt_pk_bf16_f32 v36, v36, v37
v_cvt_pk_bf16_f32 v37, v38, v39
buffer_store_dwordx2 v[36:37], v5, s[4:7], s41 offen
s_add_u32 s41, s41, 65536
v_smfmac_f32_16x16x64_bf16 v[24:27], v[20:23], v[224:231], v1
v_smfmac_f32_16x16x64_bf16 v[32:35], v[12:15], v[240:247], v1
v_smfmac_f32_16x16x64_bf16 v[32:35], v[16:19], v[248:255], v1
v_cvt_pk_bf16_f32 v24, v24, v25
v_cvt_pk_bf16_f32 v25, v26, v27
buffer_store_dwordx2 v[24:25], v5, s[4:7], s41 offen
s_add_u32 s41, s41, 65536
s_waitcnt vmcnt(12)
v_smfmac_f32_16x16x64_bf16 v[32:35], v[20:23], v[56:63], v1
s_nop 6
v_cvt_pk_bf16_f32 v32, v32, v33
v_cvt_pk_bf16_f32 v33, v34, v35
buffer_store_dwordx2 v[32:33], v5, s[4:7], s41 offen
s_add_u32 s41, s41, 65536
buffer_load_dwordx4 v[56:59], v0, s[4:7], s62 offen offset:0
buffer_load_dwordx4 v[60:63], v0, s[4:7], s62 offen offset:1024
s_add_u32 s31, s31, 1
s_add_u32 s33, s33, 10240
s_add_u32 s34, s34, 10240
s_add_u32 s35, s35, 524288
s_add_u32 s40, s40, 262144
s_add_u32 s36, s36, s55
s_sub_u32 s55, 0, s55
v_mov_b64 v[24:25], 0
v_mov_b64 v[26:27], 0
v_mov_b64 v[28:29], 0
v_mov_b64 v[30:31], 0
v_mov_b64 v[32:33], 0
v_mov_b64 v[34:35], 0
v_mov_b64 v[36:37], 0
v_mov_b64 v[38:39], 0
s_branch k_top_195
k_retry2_197:
s_add_u32 s75, s75, 1
s_sub_u32 s32, s32, 1
s_cmp_gt_i32 s32, 0
s_cbranch_scc1 k_poll2_196
s_branch k_poll2_196_ok
k_done_198:
s_mov_b32 s31, 0
s_mov_b32 s33, 118498304
s_mov_b32 s34, 118489088
s_lshl_b32 s35, s30, 14
s_add_u32 s35, s35, 41955328
s_lshl_b32 s40, s30, 13
s_add_u32 s40, s40, 100669440
s_lshl_b32 s36, s30, 7
s_add_u32 s36, s36, 119586816
s_mov_b32 s55, 327680
s_waitcnt vmcnt(0)
s_barrier
s_barrier
buffer_load_dwordx4 v[40:43], v0, s[4:7], s60 offen offset:0
buffer_load_dwordx4 v[44:47], v0, s[4:7], s60 offen offset:1024
buffer_load_dwordx4 v[48:51], v0, s[4:7], s60 offen offset:2048
buffer_load_dwordx4 v[52:55], v0, s[4:7], s60 offen offset:3072
s_waitcnt lgkmcnt(3)
buffer_load_dwordx4 v[64:67], v0, s[4:7], s61 offen offset:0
s_waitcnt lgkmcnt(2)
buffer_load_dwordx4 v[68:71], v0, s[4:7], s61 offen offset:1024
s_waitcnt lgkmcnt(1)
buffer_load_dwordx4 v[72:75], v0, s[4:7], s61 offen offset:2048
s_waitcnt lgkmcnt(0)
buffer_load_dwordx4 v[76:79], v0, s[4:7], s61 offen offset:3072
buffer_load_dwordx4 v[56:59], v0, s[4:7], s62 offen offset:0
buffer_load_dwordx4 v[60:63], v0, s[4:7], s62 offen offset:1024
v_mov_b64 v[24:25], 0
v_mov_b64 v[26:27], 0
v_mov_b64 v[28:29], 0
v_mov_b64 v[30:31], 0
v_mov_b64 v[32:33], 0
v_mov_b64 v[34:35], 0
v_mov_b64 v[36:37], 0
v_mov_b64 v[38:39], 0
k_top_206:
s_add_u32 s41, s31, 64
s_cmp_gt_u32 s68, s41
s_cbranch_scc1 k_cd_215
s_lshl_b32 s56, s30, 6
s_add_u32 s56, s56, 222330880
k_ck_214:
buffer_load_dwordx2 v[8:9], off, s[4:7], s56 sc1
s_waitcnt vmcnt(0)
v_min_u32 v8, v8, v9
s_nop 0
v_readfirstlane_b32 s68, v8
s_cmp_gt_u32 s68, s41
s_cbranch_scc1 k_cd_215
s_sub_u32 s32, s32, 1
s_cmp_gt_i32 s32, 0
s_cbranch_scc1 k_ck_214
k_cd_215:
k_poll2_207:
buffer_load_dwordx4 v[12:15], v0, s[4:7], s33 offen offset:0 sc1
buffer_load_dwordx4 v[16:19], v0, s[4:7], s34 offen offset:0 sc1
buffer_load_dwordx4 v[20:23], v0, s[4:7], s34 offen offset:1024 sc1
s_waitcnt vmcnt(2)
v_max3_u32 v8, v12, v13, v14
v_max_u32 v8, v8, v15
s_waitcnt vmcnt(1)
v_max3_u32 v8, v8, v16, v17
v_max3_u32 v8, v8, v18, v19
s_waitcnt vmcnt(0)
v_max3_u32 v8, v8, v20, v21
v_max3_u32 v8, v8, v22, v23
v_cmp_eq_u32 vcc, -1, v8
s_cbranch_vccnz k_retry2_208
k_poll2_207_ok:
ds_write_b128 v0, v[12:15] offset:9216
v_smfmac_f32_16x16x64_bf16 v[24:27], v[16:19], v[64:71], v1
ds_read_b128 v[64:67], v4 offset:6144
v_smfmac_f32_16x16x64_bf16 v[28:31], v[16:19], v[72:79], v1
ds_read_b128 v[68:71], v4 offset:7168
v_smfmac_f32_16x16x64_bf16 v[24:27], v[12:15], v[40:47], v1
ds_read_b128 v[72:75], v4 offset:8192
v_smfmac_f32_16x16x64_bf16 v[28:31], v[12:15], v[48:55], v1
ds_read_b128 v[76:79], v4 offset:9216
v_smfmac_f32_16x16x64_bf16 v[24:27], v[20:23], v[56:63], v1
v_smfmac_f32_16x16x64_bf16 v[28:31], v[20:23], a[0:7], v1
v_smfmac_f32_16x16x64_bf16 v[32:35], v[12:15], a[88:95], v1
buffer_load_dwordx4 v[40:43], v0, s[4:7], s62 offen offset:2048
v_smfmac_f32_16x16x64_bf16 v[36:39], v[12:15], a[96:103], v1
buffer_load_dwordx4 v[44:47], v0, s[4:7], s62 offen offset:3072
s_waitcnt lgkmcnt(4)
s_barrier
ds_read_b128 v[8:11], v0 offset:2048
v_smfmac_f32_16x16x64_bf16 v[32:35], v[16:19], a[104:111], v1
s_waitcnt lgkmcnt(3)
ds_read_b128 v[12:15], v0 offset:3072
v_smfmac_f32_16x16x64_bf16 v[36:39], v[16:19], v[64:71], v1
ds_read_b128 v[16:19], v0 offset:4096
buffer_load_dwordx4 v[48:51], v0, s[4:7], s35 offen offset:0 sc1
v_smfmac_f32_16x16x64_bf16 v[32:35], v[20:23], a[112:119], v1
s_waitcnt lgkmcnt(3)
buffer_load_dwordx4 v[52:55], v0, s[4:7], s35 offen offset:1024 sc1
ds_read_b128 v[64:67], v4 offset:12288
v_smfmac_f32_16x16x64_bf16 v[36:39], v[20:23], v[72:79], v1
s_waitcnt lgkmcnt(3)
ds_read_b128 v[68:71], v4 offset:13312
ds_read_b128 v[20:23], v0 offset:5120
v_smfmac_f32_16x16x64_bf16 v[24:27], v[8:11], a[8:15], v1
ds_read_b128 v[72:75], v4 offset:16384
v_smfmac_f32_16x16x64_bf16 v[28:31], v[8:11], a[16:23], v1
s_waitcnt lgkmcnt(5)
ds_read_b128 v[8:11], v0 offset:6144
v_smfmac_f32_16x16x64_bf16 v[24:27], v[12:15], a[24:31], v1
s_waitcnt lgkmcnt(3)
ds_read_b128 v[76:79], v4 offset:17408
v_smfmac_f32_16x16x64_bf16 v[28:31], v[12:15], v[64:71], v1
ds_read_b128 v[12:15], v0 offset:7168
v_smfmac_f32_16x16x64_bf16 v[24:27], v[16:19], a[32:39], v1
ds_read_b128 v[64:67], v4 offset:18432
v_smfmac_f32_16x16x64_bf16 v[28:31], v[16:19], a[40:47], v1
s_waitcnt lgkmcnt(2)
ds_read_b128 v[16:19], v0 offset:8192
v_smfmac_f32_16x16x64_bf16 v[24:27], v[20:23], v[72:79], v1
ds_read_b128 v[68:71], v4 offset:19456
v_smfmac_f32_16x16x64_bf16 v[28:31], v[20:23], a[48:55], v1
buffer_load_dwordx4 v[56:59], v0, s[4:7], s35 offen offset:2048 sc1
v_smfmac_f32_16x16x64_bf16 v[24:27], v[8:11], a[56:63], v1
s_waitcnt lgkmcnt(0)
buffer_load_dwordx4 v[60:63], v0, s[4:7], s35 offen offset:3072 sc1
v_smfmac_f32_16x16x64_bf16 v[28:31], v[8:11], v[64:71], v1
ds_read_b128 v[72:75], v4 offset:22528
v_smfmac_f32_16x16x64_bf16 v[24:27], v[12:15], a[64:71], v1
ds_read_b128 v[76:79], v4 offset:23552
v_smfmac_f32_16x16x64_bf16 v[28:31], v[12:15], a[72:79], v1
s_waitcnt lgkmcnt(0)
ds_read_b128 v[64:67], v4 offset:45056
v_smfmac_f32_16x16x64_bf16 v[24:27], v[16:19], v[72:79], v1
ds_read_b128 v[68:71], v4 offset:46080
v_smfmac_f32_16x16x64_bf16 v[28:31], v[16:19], a[80:87], v1
ds_read_b128 v[72:75], v4 offset:47104
v_smfmac_f32_16x16x64_bf16 v[32:35], v[16:19], a[176:183], v1
ds_read_b128 v[76:79], v4 offset:48128
v_smfmac_f32_16x16x64_bf16 v[36:39], v[16:19], a[184:191], v1
s_waitcnt lgkmcnt(2)
ds_read_b128 v[16:19], v0 offset:4096
v_cvt_pk_bf16_f32 v24, v24, v25
v_smfmac_f32_16x16x64_bf16 v[32:35], v[12:15], v[64:71], v1
ds_read_b128 v[64:67], v4 offset:10240
v_cvt_pk_bf16_f32 v25, v26, v27
v_smfmac_f32_16x16x64_bf16 v[36:39], v[12:15], a[168:175], v1
ds_read_b128 v[68:71], v4 offset:11264
v_cvt_pk_bf16_f32 v28, v28, v29
v_mfma_f32_16x16x16_bf16 v[24:27], v[24:25], v[2:3], 0
ds_read_b128 v[12:15], v0 offset:3072
v_cvt_pk_bf16_f32 v29, v30, v31
v_smfmac_f32_16x16x64_bf16 v[32:35], v[8:11], a[160:167], v1
v_mfma_f32_16x16x16_bf16 v[28:31], v[28:29], v[2:3], 0
s_waitcnt lgkmcnt(4)
v_smfmac_f32_16x16x64_bf16 v[36:39], v[8:11], v[72:79], v1
s_waitcnt vmcnt(4)
ds_read_b128 v[72:75], v4 offset:14336
v_cvt_pk_bf16_f32 v24, v24, v25
v_smfmac_f32_16x16x64_bf16 v[32:35], v[20:23], v[40:47], v1
ds_read_b128 v[76:79], v4 offset:15360
v_cvt_pk_bf16_f32 v25, v26, v27
v_smfmac_f32_16x16x64_bf16 v[36:39], v[20:23], a[152:159], v1
ds_read_b128 v[20:23], v0 offset:2048
v_cvt_pk_bf16_f32 v26, v28, v29
v_cvt_pk_bf16_f32 v27, v30, v31
s_waitcnt lgkmcnt(6)
v_smfmac_f32_16x16x64_bf16 v[32:35], v[16:19], a[144:151], v1
s_waitcnt vmcnt(3)
v_mfma_f32_16x16x32_bf16 v[28:31], v[48:51], v[24:27], 0
s_waitcnt vmcnt(2)
v_mfma_f32_16x16x32_bf16 v[8:11], v[52:55], v[24:27], 0
s_waitcnt lgkmcnt(4)
v_smfmac_f32_16x16x64_bf16 v[36:39], v[16:19], v[64:71], v1
s_waitcnt lgkmcnt(3)
ds_read_b128 v[64:67], v4 offset:43008
v_mov_b64 v[44:45], 0
v_smfmac_f32_16x16x64_bf16 v[32:35], v[12:15], a[136:143], v1
s_waitcnt lgkmcnt(2)
ds_read_b128 v[68:71], v4 offset:44032
v_mov_b64 v[46:47], 0
v_smfmac_f32_16x16x64_bf16 v[36:39], v[12:15], v[72:79], v1
ds_read_b128 v[72:75], v4 offset:51200
v_cndmask_b32 v28, v28, v8, s[42:43]
v_cndmask_b32 v29, v29, v9, s[42:43]
s_waitcnt lgkmcnt(3)
v_smfmac_f32_16x16x64_bf16 v[32:35], v[20:23], a[120:127], v1
ds_read_b128 v[76:79], v4 offset:52224
v_cndmask_b32 v30, v30, v10, s[42:43]
v_cndmask_b32 v31, v31, v11, s[42:43]
v_smfmac_f32_16x16x64_bf16 v[36:39], v[20:23], a[128:135], v1
ds_write_b128 v0, v[28:31] offset:13312
v_mov_b64 v[40:41], 0
v_mov_b64 v[42:43], 0
v_smfmac_f32_16x16x64_bf16 v[44:47], v[20:23], a[240:247], v1
v_cvt_pk_bf16_f32 v32, v32, v33
v_cvt_pk_bf16_f32 v33, v34, v35
v_smfmac_f32_16x16x64_bf16 v[40:43], v[20:23], a[232:239], v1
ds_read_b128 v[20:23], v0 offset:5120
v_mfma_f32_16x16x16_bf16 v[32:35], v[32:33], v[2:3], 0
v_cvt_pk_bf16_f32 v36, v36, v37
v_cvt_pk_bf16_f32 v37, v38, v39
s_waitcnt lgkmcnt(0)
s_barrier
v_mfma_f32_16x16x16_bf16 v[36:39], v[36:37], v[2:3], 0
ds_read_b128 v[48:51], v0 offset:10240
v_smfmac_f32_16x16x64_bf16 v[40:43], v[12:15], a[248:255], v1
ds_read_b128 v[52:55], v0 offset:11264
v_cvt_pk_bf16_f32 v32, v32, v33
v_cvt_pk_bf16_f32 v33, v34, v35
v_smfmac_f32_16x16x64_bf16 v[44:47], v[12:15], v[80:87], v1
ds_read_b128 v[12:15], v0 offset:6144
v_cvt_pk_bf16_f32 v34, v36, v37
v_cvt_pk_bf16_f32 v35, v38, v39
s_nop 1
v_mfma_f32_16x16x32_bf16 v[36:39], v[32:35], v[24:27], 0
ds_read_b128 v[8:11], v0 offset:12288
v_smfmac_f32_16x16x64_bf16 v[40:43], v[16:19], v[88:95], v1
buffer_store_dwordx4 v[32:35], v0, s[4:7], s40 offen sc1
s_waitcnt lgkmcnt(3)
v_add_f32 v28, v28, v48
v_add_f32 v29, v29, v49
v_smfmac_f32_16x16x64_bf16 v[44:47], v[16:19], v[64:71], v1
ds_write_b128 v7, v[36:39] offset:15872
v_smfmac_f32_16x16x64_bf16 v[40:43], v[20:23], v[96:103], v1
ds_read_b128 v[16:19], v0 offset:7168
v_add_f32 v30, v30, v50
v_add_f32 v31, v31, v51
v_smfmac_f32_16x16x64_bf16 v[44:47], v[20:23], v[104:111], v1
ds_read_b128 v[20:23], v0 offset:8192
s_waitcnt lgkmcnt(5)
v_add_f32 v28, v28, v52
v_add_f32 v29, v29, v53
s_waitcnt lgkmcnt(4)
v_smfmac_f32_16x16x64_bf16 v[40:43], v[12:15], v[112:119], v1
ds_read_b128 v[64:67], v4 offset:49152
v_add_f32 v30, v30, v54
v_add_f32 v31, v31, v55
v_smfmac_f32_16x16x64_bf16 v[44:47], v[12:15], v[72:79], v1
ds_read_b128 v[12:15], v0 offset:9216
s_waitcnt lgkmcnt(5)
v_add_f32 v28, v28, v8
v_add_f32 v29, v29, v9
s_waitcnt lgkmcnt(3)
v_smfmac_f32_16x16x64_bf16 v[40:43], v[16:19], v[120:127], v1
ds_read_b128 v[68:71], v4 offset:50176
v_add_f32 v30, v30, v10
v_add_f32 v31, v31, v11
s_waitcnt lgkmcnt(0)
s_barrier
ds_read_b128 v[48:51], v7 offset:14336
ds_read_b128 v[52:55], v7 offset:14848
ds_read_b128 v[8:11], v7 offset:15360
v_smfmac_f32_16x16x64_bf16 v[44:47], v[16:19], v[128:135], v1
ds_read_b128 v[16:19], v0 offset:0
v_max3_f32 v24, v28, v29, v30
v_smfmac_f32_16x16x64_bf16 v[40:43], v[20:23], v[136:143], v1
ds_read_b128 v[72:75], v4 offset:20480
v_max_f32 v24, v24, v31
v_smfmac_f32_16x16x64_bf16 v[44:47], v[20:23], v[64:71], v1
ds_read_b128 v[20:23], v0 offset:1024
v_max_f32_dpp v24, v24, v24 row_ror:8 row_mask:0xf bank_mask:0xf
v_smfmac_f32_16x16x64_bf16 v[40:43], v[12:15], a[192:199], v1
ds_read_b128 v[76:79], v4 offset:21504
v_mov_b32 v25, v24
v_smfmac_f32_16x16x64_bf16 v[44:47], v[12:15], a[200:207], v1
s_waitcnt lgkmcnt(3)
ds_read_b128 v[64:67], v4 offset:57344
v_permlane32_swap_b32 v24, v25
v_smfmac_f32_16x16x64_bf16 v[40:43], v[16:19], a[208:215], v1
s_waitcnt lgkmcnt(1)
ds_read_b128 v[68:71], v4 offset:58368
v_max_f32 v24, v24, v25
v_smfmac_f32_16x16x64_bf16 v[44:47], v[16:19], v[72:79], v1
ds_read_b128 v[72:75], v4 offset:53248
v_smfmac_f32_16x16x64_bf16 v[40:43], v[20:23], a[216:223], v1
ds_read_b128 v[76:79], v4 offset:54272
v_smfmac_f32_16x16x64_bf16 v[44:47], v[20:23], a[224:231], v1
v_add_f32 v36, v36, v48
v_add_f32 v37, v37, v49
v_add_f32 v38, v38, v50
v_add_f32 v39, v39, v51
v_add_f32 v36, v36, v52
v_add_f32 v37, v37, v53
v_add_f32 v38, v38, v54
v_add_f32 v39, v39, v55
v_add_f32 v36, v36, v8
v_add_f32 v37, v37, v9
v_add_f32 v38, v38, v10
v_add_f32 v39, v39, v11
buffer_load_dwordx4 v[48:51], v0, s[4:7], s63 offen offset:0
buffer_load_dwordx4 v[52:55], v0, s[4:7], s63 offen offset:1024
v_max3_f32 v24, v24, v36, v37
v_max3_f32 v24, v24, v38, v39
v_mov_b32 v25, v24
v_cvt_pk_bf16_f32 v40, v40, v41
v_cvt_pk_bf16_f32 v41, v42, v43
v_permlane16_swap_b32 v24, v25
v_max_f32 v24, v24, v25
v_mul_f32 v24, s54, v24
v_fma_f32 v28, v28, s54, -v24
v_exp_f32 v28, v28
v_fma_f32 v29, v29, s54, -v24
v_exp_f32 v29, v29
v_fma_f32 v30, v30, s54, -v24
v_exp_f32 v30, v30
v_fma_f32 v31, v31, s54, -v24
v_exp_f32 v31, v31
v_fma_f32 v36, v36, s54, -v24
v_exp_f32 v36, v36
v_fma_f32 v37, v37, s54, -v24
v_exp_f32 v37, v37
v_fma_f32 v38, v38, s54, -v24
v_exp_f32 v38, v38
v_fma_f32 v39, v39, s54, -v24
v_exp_f32 v39, v39
v_cvt_pk_bf16_f32 v24, v28, v29
v_cvt_pk_bf16_f32 v25, v30, v31
v_cvt_pk_bf16_f32 v26, v28, v29
v_cvt_pk_bf16_f32 v27, v30, v31
v_cvt_pk_bf16_f32 v32, v36, v37
v_cvt_pk_bf16_f32 v33, v38, v39
v_mov_b32_dpp v24, v26 row_ror:8 row_mask:0xf bank_mask:0xc
v_mov_b32_dpp v25, v27 row_ror:8 row_mask:0xf bank_mask:0xc
v_mov_b32_dpp v26, v26 row_ror:8 row_mask:0xf bank_mask:0x3
v_mov_b32_dpp v27, v27 row_ror:8 row_mask:0xf bank_mask:0x3
v_cvt_pk_bf16_f32 v42, v44, v45
v_cvt_pk_bf16_f32 v43, v46, v47
v_mov_b32 v8, 0x40004000
v_mov_b32 v9, 0x40004000
v_mov_b32 v10, 0x40004000
v_mov_b32 v11, 0x40004000
v_mov_b32 v34, 0x3f803f80
v_mov_b32 v35, 0x3f803f80
buffer_store_dwordx4 v[40:43], v0, s[4:7], s40 offen offset:1024 sc1
s_cmp_eq_u32 s31, 63
s_cbranch_scc1 k_done_209
v_mfma_f32_16x16x32_bf16 v[20:23], v[8:11], v[24:27], 0
s_waitcnt vmcnt(5)
v_mov_b64 v[28:29], 0
v_mov_b64 v[30:31], 0
v_mfma_f32_16x16x32_bf16 v[12:15], v[56:59], v[24:27], 0
v_mov_b64 v[36:37], 0
v_mov_b64 v[38:39], 0
v_mfma_f32_16x16x16_bf16 v[20:23], v[34:35], v[32:33], v[20:23]
s_waitcnt vmcnt(4)
v_mov_b64 v[44:45], 0
v_mov_b64 v[46:47], 0
v_mfma_f32_16x16x32_bf16 v[16:19], v[60:63], v[24:27], 0
buffer_load_dwordx4 v[56:59], v0, s[4:7], s63 offen offset:2048
v_mov_b64 v[24:25], 0
v_mfma_f32_16x16x16_bf16 v[12:15], v[40:41], v[32:33], v[12:15]
buffer_load_dwordx4 v[60:63], v0, s[4:7], s63 offen offset:3072
v_rcp_f32 v20, v20
v_mfma_f32_16x16x16_bf16 v[16:19], v[42:43], v[32:33], v[16:19]
v_mov_b64 v[26:27], 0
s_nop 1
v_mul_f32 v12, v12, v20
v_mul_f32 v13, v13, v20
v_mul_f32 v14, v14, v20
v_mul_f32 v15, v15, v20
v_cvt_pk_bf16_f32 v8, v12, v13
v_cvt_pk_bf16_f32 v9, v14, v15
v_mul_f32 v16, v16, v20
v_mul_f32 v17, v17, v20
v_mul_f32 v18, v18, v20
v_mul_f32 v19, v19, v20
v_cvt_pk_bf16_f32 v10, v16, v17
v_cvt_pk_bf16_f32 v11, v18, v19
ds_write_b128 v0, v[8:11] offset:13312
s_waitcnt lgkmcnt(3)
v_smfmac_f32_16x16x64_bf16 v[44:47], v[8:11], v[64:71], v1
s_waitcnt lgkmcnt(1)
v_mov_b64 v[32:33], 0
v_smfmac_f32_16x16x64_bf16 v[28:31], v[8:11], v[72:79], v1
v_mov_b64 v[34:35], 0
v_smfmac_f32_16x16x64_bf16 v[36:39], v[8:11], v[176:183], v1
s_waitcnt lgkmcnt(0)
s_barrier
ds_read_b128 v[12:15], v0 offset:10240
v_smfmac_f32_16x16x64_bf16 v[24:27], v[8:11], v[200:207], v1
ds_read_b128 v[16:19], v0 offset:11264
ds_read_b128 v[20:23], v0 offset:12288
v_smfmac_f32_16x16x64_bf16 v[32:35], v[8:11], v[232:239], v1
ds_read_b128 v[64:67], v4 offset:55296
ds_read_b128 v[68:71], v4 offset:56320
ds_read_b128 v[72:75], v4 offset:59392
ds_read_b128 v[76:79], v4 offset:60416
s_mov_b32 s41, s36
s_waitcnt lgkmcnt(6)
v_smfmac_f32_16x16x64_bf16 v[44:47], v[12:15], v[144:151], v1
s_waitcnt lgkmcnt(5)
v_smfmac_f32_16x16x64_bf16 v[44:47], v[16:19], v[152:159], v1
s_waitcnt lgkmcnt(2)
v_smfmac_f32_16x16x64_bf16 v[44:47], v[20:23], v[64:71], v1
v_smfmac_f32_16x16x64_bf16 v[28:31], v[12:15], v[160:167], v1
buffer_load_dwordx4 v[64:67], v0, s[4:7], s61 offen offset:0
v_smfmac_f32_16x16x64_bf16 v[28:31], v[16:19], v[168:175], v1
buffer_load_dwordx4 v[68:71], v0, s[4:7], s61 offen offset:1024
v_cvt_pk_bf16_f32 v44, v44, v45
v_cvt_pk_bf16_f32 v45, v46, v47
buffer_store_dwordx2 v[44:45], v5, s[4:7], s41 offen
s_add_u32 s41, s41, 65536
s_waitcnt lgkmcnt(0)
v_smfmac_f32_16x16x64_bf16 v[28:31], v[20:23], v[72:79], v1
buffer_load_dwordx4 v[40:43], v0, s[4:7], s60 offen offset:0
v_smfmac_f32_16x16x64_bf16 v[36:39], v[12:15], v[184:191], v1
buffer_load_dwordx4 v[44:47], v0, s[4:7], s60 offen offset:1024
v_smfmac_f32_16x16x64_bf16 v[36:39], v[16:19], v[192:199], v1
buffer_load_dwordx4 v[72:75], v0, s[4:7], s61 offen offset:2048
v_cvt_pk_bf16_f32 v28, v28, v29
v_cvt_pk_bf16_f32 v29, v30, v31
buffer_store_dwordx2 v[28:29], v5, s[4:7], s41 offen
s_add_u32 s41, s41, 65536
s_waitcnt vmcnt(10)
v_smfmac_f32_16x16x64_bf16 v[36:39], v[20:23], v[48:55], v1
buffer_load_dwordx4 v[76:79], v0, s[4:7], s61 offen offset:3072
v_smfmac_f32_16x16x64_bf16 v[24:27], v[12:15], v[208:215], v1
buffer_load_dwordx4 v[48:51], v0, s[4:7], s60 offen offset:2048
v_smfmac_f32_16x16x64_bf16 v[24:27], v[16:19], v[216:223], v1
buffer_load_dwordx4 v[52:55], v0, s[4:7], s60 offen offset:3072
v_cvt_pk_bf16_f32 v36, v36, v37
v_cvt_pk_bf16_f32 v37, v38, v39
buffer_store_dwordx2 v[36:37], v5, s[4:7], s41 offen
s_add_u32 s41, s41, 65536
v_smfmac_f32_16x16x64_bf16 v[24:27], v[20:23], v[224:231], v1
v_smfmac_f32_16x16x64_bf16 v[32:35], v[12:15], v[240:247], v1
v_smfmac_f32_16x16x64_bf16 v[32:35], v[16:19], v[248:255], v1
v_cvt_pk_bf16_f32 v24, v24, v25
v_cvt_pk_bf16_f32 v25, v26, v27
buffer_store_dwordx2 v[24:25], v5, s[4:7], s41 offen
s_add_u32 s41, s41, 65536
s_waitcnt vmcnt(12)
v_smfmac_f32_16x16x64_bf16 v[32:35], v[20:23], v[56:63], v1
s_nop 6
v_cvt_pk_bf16_f32 v32, v32, v33
v_cvt_pk_bf16_f32 v33, v34, v35
buffer_store_dwordx2 v[32:33], v5, s[4:7], s41 offen
s_add_u32 s41, s41, 65536
buffer_load_dwordx4 v[56:59], v0, s[4:7], s62 offen offset:0
buffer_load_dwordx4 v[60:63], v0, s[4:7], s62 offen offset:1024
s_add_u32 s31, s31, 1
s_add_u32 s33, s33, 10240
s_add_u32 s34, s34, 10240
s_add_u32 s35, s35, 524288
s_add_u32 s40, s40, 262144
s_add_u32 s36, s36, s55
s_sub_u32 s55, 0, s55
v_mov_b64 v[24:25], 0
v_mov_b64 v[26:27], 0
v_mov_b64 v[28:29], 0
v_mov_b64 v[30:31], 0
v_mov_b64 v[32:33], 0
v_mov_b64 v[34:35], 0
v_mov_b64 v[36:37], 0
v_mov_b64 v[38:39], 0
s_branch k_top_206
k_retry2_208:
s_add_u32 s75, s75, 1
s_sub_u32 s32, s32, 1
s_cmp_gt_i32 s32, 0
s_cbranch_scc1 k_poll2_207
s_branch k_poll2_207_ok
k_done_209:
s_add_u32 s30, s30, 112
s_waitcnt vmcnt(0) lgkmcnt(0)
s_barrier
s_branch k_fin_7
.section .rodata,"a"
.p2align 6
.amdhsa_kernel interleave_layers__memory_aug_recurrent_mem_tr__spectral_gfnet__prompt_kernel
  .amdhsa_next_free_vgpr 512
  .amdhsa_next_free_sgpr 102
  .amdhsa_accum_offset 256
  .amdhsa_group_segment_fixed_size 0
  .amdhsa_kernarg_size 104
  .amdhsa_user_sgpr_count 2
  .amdhsa_user_sgpr_kernarg_segment_ptr 1
  .amdhsa_system_sgpr_workgroup_id_x 1
  .amdhsa_float_denorm_mode_32 3
.end_amdhsa_kernel
```

```asm
; @launch grid=(256,1,1) block=(256,1,1) lds=163840
.amdgcn_target "amdgcn-amd-amdhsa--gfx950"
.text
.globl interleave_layers__memory_aug_recurrent_mem_tr__spectral_gfnet__prompt_kernel
.p2align 8
.type interleave_layers__memory_aug_recurrent_mem_tr__spectral_gfnet__prompt_kernel,@function
interleave_layers__memory_aug_recurrent_mem_tr__spectral_gfnet__prompt_kernel:
s_load_dwordx2 s[72:73], s[0:1], 8
s_load_dwordx4 s[76:79], s[0:1], 16
s_load_dwordx4 s[80:83], s[0:1], 32
s_load_dwordx2 s[28:29], s[0:1], 88
s_load_dwordx2 s[74:75], s[0:1], 96
v_lshrrev_b32 v1, 6, v0
v_and_b32 v0, 63, v0
v_readfirstlane_b32 s3, v1
s_waitcnt lgkmcnt(0)
s_mov_b32 s4, s74
s_mov_b32 s5, s75
s_mov_b32 s6, 268435456
s_mov_b32 s7, 0x20000
s_mov_b32 s8, s76
s_mov_b32 s9, s77
s_mov_b32 s10, 5242880
s_mov_b32 s11, 0x20000
s_mov_b32 s12, s78
s_mov_b32 s13, s79
s_mov_b32 s14, 5242880
s_mov_b32 s15, 0x20000
s_mov_b32 s16, s80
s_mov_b32 s17, s81
s_mov_b32 s18, 5242880
s_mov_b32 s19, 0x20000
s_mov_b32 s20, s82
s_mov_b32 s21, s83
s_mov_b32 s22, 5242880
s_mov_b32 s23, 0x20000
s_mov_b32 s24, s72
s_mov_b32 s25, s73
s_mov_b32 s26, 10240
s_mov_b32 s27, 0x20000
s_mov_b32 s32, 400000
s_getreg_b32 s52, hwreg(HW_REG_XCC_ID, 0, 4)
s_cmp_lg_u32 s3, 0
s_cbranch_scc1 k_skip_1
s_mov_b64 exec, 1
s_lshl_b32 s53, s52, 2
v_mov_b32 v1, s53
v_mov_b32 v2, 1
global_atomic_add v3, v1, v2, s[28:29] sc0 sc1
v_mov_b32 v1, 0
s_waitcnt vmcnt(0)
ds_write_b32 v1, v3
s_mov_b64 exec, -1
s_waitcnt lgkmcnt(0)
k_skip_1:
s_barrier
v_mov_b32 v1, 0
ds_read_b32 v2, v1
s_waitcnt lgkmcnt(0)
v_readfirstlane_b32 s30, v2
s_barrier
s_cmp_gt_u32 s30, 31
s_cbranch_scc1 k_end_2
s_cmp_eq_u32 s52, 0
s_cbranch_scc1 k_team_3
v_lshlrev_b32 v0, 4, v0
s_cmp_gt_u32 s52, 7
s_cbranch_scc1 k_end_2
s_cmp_gt_u32 s30, 29
s_cbranch_scc1 k_end_2
s_cmp_gt_u32 s52, 4
s_cbranch_scc1 k_nb_8
s_mul_i32 s53, s52, 20
s_add_u32 s53, s53, s30
s_sub_u32 s53, s53, 20
s_cmp_lt_u32 s30, 20
s_cmov_b32 s30, s53
s_cbranch_scc1 k_o_4
s_mul_i32 s53, s52, 10
s_add_u32 s30, s30, s53
s_sub_u32 s30, s30, 30
s_cmp_lt_u32 s30, 32
s_cbranch_scc1 k_at_5
s_sub_u32 s30, s30, 32
s_branch k_p_6
k_nb_8:
s_mul_i32 s53, s52, 30
s_add_u32 s30, s30, s53
s_sub_u32 s30, s30, 142
s_cmp_lt_u32 s30, 96
s_cbranch_scc1 k_p_6
k_end_2:
s_endpgm
k_at_5:
s_lshl_b32 s52, s30, 2
s_add_u32 s52, s52, s3
s_lshl_b32 s52, s52, 9
s_add_u32 s52, s52, 222298112
v_mov_b64 v[2:3], 0
v_lshrrev_b32 v1, 1, v0
buffer_store_dwordx2 v[2:3], v1, s[4:7], s52 offen sc1
s_lshl_b32 s47, s30, 2
s_add_u32 s47, s47, s3
v_bfe_u32 v6, v0, 4, 5
v_lshrrev_b32 v2, 9, v0
v_bfe_u32 v8, v6, 2, 1
s_mov_b32 s56, 0x3acccccd
v_bfe_u32 v9, v6, 3, 1
v_and_b32 v1, 0x13, v6
v_lshl_add_u32 v1, v8, 3, v1
v_lshl_add_u32 v1, v9, 2, v1
k_gt_9:
s_mul_i32 s52, s47, 1639
s_lshr_b32 s52, s52, 16
s_mul_i32 s53, s52, 40
s_sub_u32 s53, s47, s53
s_lshl_b32 s52, s52, 5
s_lshl_b32 s53, s53, 1
v_add_u32 v3, s52, v1
v_add_u32 v6, s53, v2
v_and_b32 v4, 1, v3
v_cvt_f32_u32 v4, v4
v_mul_f32 v4, 0.5, v4
v_mul_f32 v4, 0.5, v4
v_cmp_gt_u32 vcc, 2, v3
s_nop 1
v_cndmask_b32 v4, v4, 0, vcc
v_mov_b32 v5, 0x3d64f92e
v_mov_b32 v8, 0x3d21e89b
v_cndmask_b32 v5, v5, v8, vcc
v_cmp_eq_u32 vcc, 0, v3
v_lshrrev_b32 v3, 1, v3
v_mov_b32 v8, 320
v_cndmask_b32 v3, v3, v8, vcc
v_lshlrev_b32 v6, 3, v6
v_mul_u32_u24 v6, v6, v3
v_cvt_f32_u32 v6, v6
v_cvt_f32_u32 v3, v3
v_fma_f32 v8, v6, s56, v4
v_add_f32 v6, v6, v3
v_fract_f32 v8, v8
v_cos_f32 v8, v8
v_fma_f32 v9, v6, s56, v4
v_add_f32 v6, v6, v3
v_fract_f32 v9, v9
v_cos_f32 v9, v9
v_fma_f32 v10, v6, s56, v4
v_add_f32 v6, v6, v3
v_fract_f32 v10, v10
v_cos_f32 v10, v10
v_fma_f32 v11, v6, s56, v4
v_add_f32 v6, v6, v3
v_fract_f32 v11, v11
v_cos_f32 v11, v11
v_fma_f32 v12, v6, s56, v4
v_add_f32 v6, v6, v3
v_fract_f32 v12, v12
v_cos_f32 v12, v12
v_fma_f32 v13, v6, s56, v4
v_add_f32 v6, v6, v3
v_fract_f32 v13, v13
v_cos_f32 v13, v13
v_fma_f32 v14, v6, s56, v4
v_add_f32 v6, v6, v3
v_fract_f32 v14, v14
v_cos_f32 v14, v14
v_fma_f32 v15, v6, s56, v4
v_add_f32 v6, v6, v3
v_fract_f32 v15, v15
v_cos_f32 v15, v15
v_mul_f32 v8, v5, v8
v_mul_f32 v9, v5, v9
v_mul_f32 v10, v5, v10
v_mul_f32 v11, v5, v11
v_mul_f32 v12, v5, v12
v_mul_f32 v13, v5, v13
v_mul_f32 v14, v5, v14
v_mul_f32 v15, v5, v15
v_cvt_pk_bf16_f32 v16, v8, v9
v_cvt_pk_bf16_f32 v17, v10, v11
v_cvt_pk_bf16_f32 v18, v12, v13
v_cvt_pk_bf16_f32 v19, v14, v15
s_lshl_b32 s52, s47, 10
s_add_u32 s52, s52, 213909504
buffer_store_dwordx4 v[16:19], v0, s[4:7], s52 offen sc1
s_add_u32 s47, s47, 128
s_cmp_lt_u32 s47, 800
s_cbranch_scc1 k_gt_9
s_waitcnt vmcnt(0)
s_barrier
s_cmp_lg_u32 s3, 0
s_cbranch_scc1 k_sd_11
s_mov_b64 exec, 1
v_mov_b32 v2, 128
v_mov_b32 v3, 1
global_atomic_add v2, v3, s[28:29] sc1
s_mov_b64 exec, -1
k_sd_11:
s_lshl_b32 s47, s30, 2
s_add_u32 s47, s47, s3
v_bfe_u32 v6, v0, 4, 5
v_lshrrev_b32 v2, 9, v0
v_bfe_u32 v8, v6, 2, 1
s_mov_b32 s56, 0x3acccccd
v_lshrrev_b32 v9, 3, v6
v_and_b32 v1, 3, v6
v_lshl_add_u32 v1, v8, 4, v1
v_lshl_add_u32 v1, v9, 2, v1
k_gt_12:
s_mul_i32 s52, s47, 1639
s_lshr_b32 s52, s52, 16
s_mul_i32 s53, s52, 40
s_sub_u32 s53, s47, s53
s_lshl_b32 s52, s52, 5
s_lshl_b32 s53, s53, 1
v_add_u32 v3, s52, v1
v_add_u32 v6, s53, v2
v_cmp_eq_u32 vcc, 0, v6
v_lshlrev_b32 v6, 2, v6
v_mul_u32_u24 v6, v6, v3
v_cvt_f32_u32 v6, v6
v_lshlrev_b32 v4, 31, v3
v_cvt_f32_u32 v3, v3
v_mul_f32 v8, s56, v6
v_add_f32 v6, v6, v3
v_fract_f32 v8, v8
v_sin_f32 v9, v8
v_cos_f32 v8, v8
v_mul_f32 v10, s56, v6
v_add_f32 v6, v6, v3
v_fract_f32 v10, v10
v_sin_f32 v11, v10
v_cos_f32 v10, v10
v_mul_f32 v12, s56, v6
v_add_f32 v6, v6, v3
v_fract_f32 v12, v12
v_sin_f32 v13, v12
v_cos_f32 v12, v12
v_mul_f32 v14, s56, v6
v_add_f32 v6, v6, v3
v_fract_f32 v14, v14
v_sin_f32 v15, v14
v_cos_f32 v14, v14
v_mul_f32 v8, 0x3d64f92e, v8
v_mul_f32 v9, 0xbd64f92e, v9
v_mul_f32 v10, 0x3d64f92e, v10
v_mul_f32 v11, 0xbd64f92e, v11
v_mul_f32 v12, 0x3d64f92e, v12
v_mul_f32 v13, 0xbd64f92e, v13
v_mul_f32 v14, 0x3d64f92e, v14
v_mul_f32 v15, 0xbd64f92e, v15
v_mov_b32 v5, 0x3d21e89b
v_xor_b32 v4, v4, v5
v_cndmask_b32 v8, v8, v4, vcc
v_cndmask_b32 v9, v9, v5, vcc
v_cvt_pk_bf16_f32 v16, v8, v9
v_cvt_pk_bf16_f32 v17, v10, v11
v_cvt_pk_bf16_f32 v18, v12, v13
v_cvt_pk_bf16_f32 v19, v14, v15
s_lshl_b32 s52, s47, 10
s_add_u32 s52, s52, 214958080
buffer_store_dwordx4 v[16:19], v0, s[4:7], s52 offen sc1
s_add_u32 s47, s47, 128
s_cmp_lt_u32 s47, 800
s_cbranch_scc1 k_gt_12
s_lshl_b32 s52, s30, 2
s_add_u32 s52, s52, s3
s_lshr_b32 s53, s52, 6
s_mul_i32 s53, s53, 393216
s_mul_i32 s52, s52, 10240
s_add_u32 s52, s52, s53
s_add_u32 s52, s52, 117440512
v_mov_b64 v[4:5], -1
v_mov_b64 v[6:7], -1
buffer_store_dwordx4 v[4:7], v0, s[4:7], s52 offen offset:0 sc1
buffer_store_dwordx4 v[4:7], v0, s[4:7], s52 offen offset:1024 sc1
buffer_store_dwordx4 v[4:7], v0, s[4:7], s52 offen offset:2048 sc1
buffer_store_dwordx4 v[4:7], v0, s[4:7], s52 offen offset:3072 sc1
s_add_u32 s52, s52, 4096
buffer_store_dwordx4 v[4:7], v0, s[4:7], s52 offen offset:0 sc1
buffer_store_dwordx4 v[4:7], v0, s[4:7], s52 offen offset:1024 sc1
buffer_store_dwordx4 v[4:7], v0, s[4:7], s52 offen offset:2048 sc1
buffer_store_dwordx4 v[4:7], v0, s[4:7], s52 offen offset:3072 sc1
s_add_u32 s52, s52, 4096
buffer_store_dwordx4 v[4:7], v0, s[4:7], s52 offen offset:0 sc1
buffer_store_dwordx4 v[4:7], v0, s[4:7], s52 offen offset:1024 sc1
s_waitcnt vmcnt(0)
s_barrier
s_cmp_lg_u32 s3, 0
s_cbranch_scc1 k_sd_14
s_mov_b64 exec, 1
v_mov_b32 v2, 192
v_mov_b32 v3, 1
global_atomic_add v2, v3, s[28:29] sc1
s_mov_b64 exec, -1
k_sd_14:
v_lshrrev_b32 v1, 8, v0
v_and_b32 v2, 0xf0, v0
v_lshl_add_u32 v8, v1, 13, v2
v_bfe_u32 v2, v0, 6, 4
v_and_b32 v3, 7, v2
v_xor_b32 v3, s3, v3
v_lshlrev_b32 v3, 5, v3
v_lshl_add_u32 v16, v2, 10, v3
v_bfe_u32 v2, v0, 4, 2
v_lshl_add_u32 v16, v2, 3, v16
v_xor_b32 v19, 0x80, v16
v_xor_b32 v9, 32, v8
v_xor_b32 v10, 64, v8
v_xor_b32 v11, 96, v8
v_xor_b32 v12, 128, v8
v_xor_b32 v13, 160, v8
v_xor_b32 v14, 192, v8
v_xor_b32 v15, 224, v8
v_add_u32 v17, 65536, v16
v_add_u32 v18, 131072, v16
v_add_u32 v20, 65536, v19
v_add_u32 v21, 131072, v19
s_mul_i32 s52, s3, 1310720
s_lshl_b32 s53, s30, 8
s_add_u32 s52, s52, s53
s_mul_i32 s53, s3, 40960
s_add_u32 m0, s53, 0
s_add_u32 s54, s52, 0
buffer_load_dwordx4 v8, s[12:15], s54 offen lds
s_add_u32 m0, s53, 1024
s_add_u32 s54, s52, 32768
buffer_load_dwordx4 v9, s[12:15], s54 offen lds
s_add_u32 m0, s53, 2048
s_add_u32 s54, s52, 65536
buffer_load_dwordx4 v10, s[12:15], s54 offen lds
s_add_u32 m0, s53, 3072
s_add_u32 s54, s52, 98304
buffer_load_dwordx4 v11, s[12:15], s54 offen lds
s_add_u32 m0, s53, 4096
s_add_u32 s54, s52, 131072
buffer_load_dwordx4 v12, s[12:15], s54 offen lds
s_add_u32 m0, s53, 5120
s_add_u32 s54, s52, 163840
buffer_load_dwordx4 v13, s[12:15], s54 offen lds
s_add_u32 m0, s53, 6144
s_add_u32 s54, s52, 196608
buffer_load_dwordx4 v14, s[12:15], s54 offen lds
s_add_u32 m0, s53, 7168
s_add_u32 s54, s52, 229376
buffer_load_dwordx4 v15, s[12:15], s54 offen lds
s_add_u32 m0, s53, 8192
s_add_u32 s54, s52, 262144
buffer_load_dwordx4 v8, s[12:15], s54 offen lds
s_add_u32 m0, s53, 9216
s_add_u32 s54, s52, 294912
buffer_load_dwordx4 v9, s[12:15], s54 offen lds
s_add_u32 m0, s53, 10240
s_add_u32 s54, s52, 327680
buffer_load_dwordx4 v10, s[12:15], s54 offen lds
s_add_u32 m0, s53, 11264
s_add_u32 s54, s52, 360448
buffer_load_dwordx4 v11, s[12:15], s54 offen lds
s_add_u32 m0, s53, 12288
s_add_u32 s54, s52, 393216
buffer_load_dwordx4 v12, s[12:15], s54 offen lds
s_add_u32 m0, s53, 13312
s_add_u32 s54, s52, 425984
buffer_load_dwordx4 v13, s[12:15], s54 offen lds
s_add_u32 m0, s53, 14336
s_add_u32 s54, s52, 458752
buffer_load_dwordx4 v14, s[12:15], s54 offen lds
s_add_u32 m0, s53, 15360
s_add_u32 s54, s52, 491520
buffer_load_dwordx4 v15, s[12:15], s54 offen lds
s_add_u32 m0, s53, 16384
s_add_u32 s54, s52, 524288
buffer_load_dwordx4 v8, s[12:15], s54 offen lds
s_add_u32 m0, s53, 17408
s_add_u32 s54, s52, 557056
buffer_load_dwordx4 v9, s[12:15], s54 offen lds
s_add_u32 m0, s53, 18432
s_add_u32 s54, s52, 589824
buffer_load_dwordx4 v10, s[12:15], s54 offen lds
s_add_u32 m0, s53, 19456
s_add_u32 s54, s52, 622592
buffer_load_dwordx4 v11, s[12:15], s54 offen lds
s_add_u32 m0, s53, 20480
s_add_u32 s54, s52, 655360
buffer_load_dwordx4 v12, s[12:15], s54 offen lds
s_add_u32 m0, s53, 21504
s_add_u32 s54, s52, 688128
buffer_load_dwordx4 v13, s[12:15], s54 offen lds
s_add_u32 m0, s53, 22528
s_add_u32 s54, s52, 720896
buffer_load_dwordx4 v14, s[12:15], s54 offen lds
s_add_u32 m0, s53, 23552
s_add_u32 s54, s52, 753664
buffer_load_dwordx4 v15, s[12:15], s54 offen lds
s_add_u32 m0, s53, 24576
s_add_u32 s54, s52, 786432
buffer_load_dwordx4 v8, s[12:15], s54 offen lds
s_add_u32 m0, s53, 25600
s_add_u32 s54, s52, 819200
buffer_load_dwordx4 v9, s[12:15], s54 offen lds
s_add_u32 m0, s53, 26624
s_add_u32 s54, s52, 851968
buffer_load_dwordx4 v10, s[12:15], s54 offen lds
s_add_u32 m0, s53, 27648
s_add_u32 s54, s52, 884736
buffer_load_dwordx4 v11, s[12:15], s54 offen lds
s_add_u32 m0, s53, 28672
s_add_u32 s54, s52, 917504
buffer_load_dwordx4 v12, s[12:15], s54 offen lds
s_add_u32 m0, s53, 29696
s_add_u32 s54, s52, 950272
buffer_load_dwordx4 v13, s[12:15], s54 offen lds
s_add_u32 m0, s53, 30720
s_add_u32 s54, s52, 983040
buffer_load_dwordx4 v14, s[12:15], s54 offen lds
s_add_u32 m0, s53, 31744
s_add_u32 s54, s52, 1015808
buffer_load_dwordx4 v15, s[12:15], s54 offen lds
s_add_u32 m0, s53, 32768
s_add_u32 s54, s52, 1048576
buffer_load_dwordx4 v8, s[12:15], s54 offen lds
s_add_u32 m0, s53, 33792
s_add_u32 s54, s52, 1081344
buffer_load_dwordx4 v9, s[12:15], s54 offen lds
s_add_u32 m0, s53, 34816
s_add_u32 s54, s52, 1114112
buffer_load_dwordx4 v10, s[12:15], s54 offen lds
s_add_u32 m0, s53, 35840
s_add_u32 s54, s52, 1146880
buffer_load_dwordx4 v11, s[12:15], s54 offen lds
s_add_u32 m0, s53, 36864
s_add_u32 s54, s52, 1179648
buffer_load_dwordx4 v12, s[12:15], s54 offen lds
s_add_u32 m0, s53, 37888
s_add_u32 s54, s52, 1212416
buffer_load_dwordx4 v13, s[12:15], s54 offen lds
s_add_u32 m0, s53, 38912
s_add_u32 s54, s52, 1245184
buffer_load_dwordx4 v14, s[12:15], s54 offen lds
s_add_u32 m0, s53, 39936
s_add_u32 s54, s52, 1277952
buffer_load_dwordx4 v15, s[12:15], s54 offen lds
s_waitcnt vmcnt(0)
s_barrier
ds_read_b64_tr_b16 a[0:1], v16 offset:0
ds_read_b64_tr_b16 a[2:3], v16 offset:512
ds_read_b64_tr_b16 a[4:5], v19 offset:0
ds_read_b64_tr_b16 a[6:7], v19 offset:512
ds_read_b64_tr_b16 a[16:17], v16 offset:256
ds_read_b64_tr_b16 a[18:19], v16 offset:768
ds_read_b64_tr_b16 a[20:21], v19 offset:256
ds_read_b64_tr_b16 a[22:23], v19 offset:768
ds_read_b64_tr_b16 a[32:33], v16 offset:16384
ds_read_b64_tr_b16 a[34:35], v16 offset:16896
ds_read_b64_tr_b16 a[36:37], v19 offset:16384
ds_read_b64_tr_b16 a[38:39], v19 offset:16896
ds_read_b64_tr_b16 a[48:49], v16 offset:16640
ds_read_b64_tr_b16 a[50:51], v16 offset:17152
ds_read_b64_tr_b16 a[52:53], v19 offset:16640
ds_read_b64_tr_b16 a[54:55], v19 offset:17152
ds_read_b64_tr_b16 a[64:65], v16 offset:32768
ds_read_b64_tr_b16 a[66:67], v16 offset:33280
ds_read_b64_tr_b16 a[68:69], v19 offset:32768
ds_read_b64_tr_b16 a[70:71], v19 offset:33280
ds_read_b64_tr_b16 a[80:81], v16 offset:33024
ds_read_b64_tr_b16 a[82:83], v16 offset:33536
ds_read_b64_tr_b16 a[84:85], v19 offset:33024
ds_read_b64_tr_b16 a[86:87], v19 offset:33536
ds_read_b64_tr_b16 a[96:97], v16 offset:49152
ds_read_b64_tr_b16 a[98:99], v16 offset:49664
ds_read_b64_tr_b16 a[100:101], v19 offset:49152
ds_read_b64_tr_b16 a[102:103], v19 offset:49664
ds_read_b64_tr_b16 a[112:113], v16 offset:49408
ds_read_b64_tr_b16 a[114:115], v16 offset:49920
ds_read_b64_tr_b16 a[116:117], v19 offset:49408
ds_read_b64_tr_b16 a[118:119], v19 offset:49920
ds_read_b64_tr_b16 a[128:129], v17 offset:0
ds_read_b64_tr_b16 a[130:131], v17 offset:512
ds_read_b64_tr_b16 a[132:133], v20 offset:0
ds_read_b64_tr_b16 a[134:135], v20 offset:512
ds_read_b64_tr_b16 a[144:145], v17 offset:256
ds_read_b64_tr_b16 a[146:147], v17 offset:768
ds_read_b64_tr_b16 a[148:149], v20 offset:256
ds_read_b64_tr_b16 a[150:151], v20 offset:768
ds_read_b64_tr_b16 a[160:161], v17 offset:16384
ds_read_b64_tr_b16 a[162:163], v17 offset:16896
ds_read_b64_tr_b16 a[164:165], v20 offset:16384
ds_read_b64_tr_b16 a[166:167], v20 offset:16896
ds_read_b64_tr_b16 a[176:177], v17 offset:16640
ds_read_b64_tr_b16 a[178:179], v17 offset:17152
ds_read_b64_tr_b16 a[180:181], v20 offset:16640
ds_read_b64_tr_b16 a[182:183], v20 offset:17152
ds_read_b64_tr_b16 a[192:193], v17 offset:32768
ds_read_b64_tr_b16 a[194:195], v17 offset:33280
ds_read_b64_tr_b16 a[196:197], v20 offset:32768
ds_read_b64_tr_b16 a[198:199], v20 offset:33280
ds_read_b64_tr_b16 a[208:209], v17 offset:33024
ds_read_b64_tr_b16 a[210:211], v17 offset:33536
ds_read_b64_tr_b16 a[212:213], v20 offset:33024
ds_read_b64_tr_b16 a[214:215], v20 offset:33536
ds_read_b64_tr_b16 a[224:225], v17 offset:49152
ds_read_b64_tr_b16 a[226:227], v17 offset:49664
ds_read_b64_tr_b16 a[228:229], v20 offset:49152
ds_read_b64_tr_b16 a[230:231], v20 offset:49664
ds_read_b64_tr_b16 a[240:241], v17 offset:49408
ds_read_b64_tr_b16 a[242:243], v17 offset:49920
ds_read_b64_tr_b16 a[244:245], v20 offset:49408
ds_read_b64_tr_b16 a[246:247], v20 offset:49920
ds_read_b64_tr_b16 v[192:193], v18 offset:0
ds_read_b64_tr_b16 v[194:195], v18 offset:512
ds_read_b64_tr_b16 v[196:197], v21 offset:0
ds_read_b64_tr_b16 v[198:199], v21 offset:512
ds_read_b64_tr_b16 v[208:209], v18 offset:256
ds_read_b64_tr_b16 v[210:211], v18 offset:768
ds_read_b64_tr_b16 v[212:213], v21 offset:256
ds_read_b64_tr_b16 v[214:215], v21 offset:768
ds_read_b64_tr_b16 v[224:225], v18 offset:16384
ds_read_b64_tr_b16 v[226:227], v18 offset:16896
ds_read_b64_tr_b16 v[228:229], v21 offset:16384
ds_read_b64_tr_b16 v[230:231], v21 offset:16896
ds_read_b64_tr_b16 v[240:241], v18 offset:16640
ds_read_b64_tr_b16 v[242:243], v18 offset:17152
ds_read_b64_tr_b16 v[244:245], v21 offset:16640
ds_read_b64_tr_b16 v[246:247], v21 offset:17152
s_waitcnt lgkmcnt(0)
s_barrier
s_mul_i32 s52, s3, 1310720
s_lshl_b32 s53, s30, 8
s_add_u32 s52, s52, s53
s_mul_i32 s53, s3, 40960
s_add_u32 m0, s53, 0
s_add_u32 s54, s52, 0
buffer_load_dwordx4 v8, s[16:19], s54 offen lds
s_add_u32 m0, s53, 1024
s_add_u32 s54, s52, 32768
buffer_load_dwordx4 v9, s[16:19], s54 offen lds
s_add_u32 m0, s53, 2048
s_add_u32 s54, s52, 65536
buffer_load_dwordx4 v10, s[16:19], s54 offen lds
s_add_u32 m0, s53, 3072
s_add_u32 s54, s52, 98304
buffer_load_dwordx4 v11, s[16:19], s54 offen lds
s_add_u32 m0, s53, 4096
s_add_u32 s54, s52, 131072
buffer_load_dwordx4 v12, s[16:19], s54 offen lds
s_add_u32 m0, s53, 5120
s_add_u32 s54, s52, 163840
buffer_load_dwordx4 v13, s[16:19], s54 offen lds
s_add_u32 m0, s53, 6144
s_add_u32 s54, s52, 196608
buffer_load_dwordx4 v14, s[16:19], s54 offen lds
s_add_u32 m0, s53, 7168
s_add_u32 s54, s52, 229376
buffer_load_dwordx4 v15, s[16:19], s54 offen lds
s_add_u32 m0, s53, 8192
s_add_u32 s54, s52, 262144
buffer_load_dwordx4 v8, s[16:19], s54 offen lds
s_add_u32 m0, s53, 9216
s_add_u32 s54, s52, 294912
buffer_load_dwordx4 v9, s[16:19], s54 offen lds
s_add_u32 m0, s53, 10240
s_add_u32 s54, s52, 327680
buffer_load_dwordx4 v10, s[16:19], s54 offen lds
s_add_u32 m0, s53, 11264
s_add_u32 s54, s52, 360448
buffer_load_dwordx4 v11, s[16:19], s54 offen lds
s_add_u32 m0, s53, 12288
s_add_u32 s54, s52, 393216
buffer_load_dwordx4 v12, s[16:19], s54 offen lds
s_add_u32 m0, s53, 13312
s_add_u32 s54, s52, 425984
buffer_load_dwordx4 v13, s[16:19], s54 offen lds
s_add_u32 m0, s53, 14336
s_add_u32 s54, s52, 458752
buffer_load_dwordx4 v14, s[16:19], s54 offen lds
s_add_u32 m0, s53, 15360
s_add_u32 s54, s52, 491520
buffer_load_dwordx4 v15, s[16:19], s54 offen lds
s_add_u32 m0, s53, 16384
s_add_u32 s54, s52, 524288
buffer_load_dwordx4 v8, s[16:19], s54 offen lds
s_add_u32 m0, s53, 17408
s_add_u32 s54, s52, 557056
buffer_load_dwordx4 v9, s[16:19], s54 offen lds
s_add_u32 m0, s53, 18432
s_add_u32 s54, s52, 589824
buffer_load_dwordx4 v10, s[16:19], s54 offen lds
s_add_u32 m0, s53, 19456
s_add_u32 s54, s52, 622592
buffer_load_dwordx4 v11, s[16:19], s54 offen lds
s_add_u32 m0, s53, 20480
s_add_u32 s54, s52, 655360
buffer_load_dwordx4 v12, s[16:19], s54 offen lds
s_add_u32 m0, s53, 21504
s_add_u32 s54, s52, 688128
buffer_load_dwordx4 v13, s[16:19], s54 offen lds
s_add_u32 m0, s53, 22528
s_add_u32 s54, s52, 720896
buffer_load_dwordx4 v14, s[16:19], s54 offen lds
s_add_u32 m0, s53, 23552
s_add_u32 s54, s52, 753664
buffer_load_dwordx4 v15, s[16:19], s54 offen lds
s_add_u32 m0, s53, 24576
s_add_u32 s54, s52, 786432
buffer_load_dwordx4 v8, s[16:19], s54 offen lds
s_add_u32 m0, s53, 25600
s_add_u32 s54, s52, 819200
buffer_load_dwordx4 v9, s[16:19], s54 offen lds
s_add_u32 m0, s53, 26624
s_add_u32 s54, s52, 851968
buffer_load_dwordx4 v10, s[16:19], s54 offen lds
s_add_u32 m0, s53, 27648
s_add_u32 s54, s52, 884736
buffer_load_dwordx4 v11, s[16:19], s54 offen lds
s_add_u32 m0, s53, 28672
s_add_u32 s54, s52, 917504
buffer_load_dwordx4 v12, s[16:19], s54 offen lds
s_add_u32 m0, s53, 29696
s_add_u32 s54, s52, 950272
buffer_load_dwordx4 v13, s[16:19], s54 offen lds
s_add_u32 m0, s53, 30720
s_add_u32 s54, s52, 983040
buffer_load_dwordx4 v14, s[16:19], s54 offen lds
s_add_u32 m0, s53, 31744
s_add_u32 s54, s52, 1015808
buffer_load_dwordx4 v15, s[16:19], s54 offen lds
s_add_u32 m0, s53, 32768
s_add_u32 s54, s52, 1048576
buffer_load_dwordx4 v8, s[16:19], s54 offen lds
s_add_u32 m0, s53, 33792
s_add_u32 s54, s52, 1081344
buffer_load_dwordx4 v9, s[16:19], s54 offen lds
s_add_u32 m0, s53, 34816
s_add_u32 s54, s52, 1114112
buffer_load_dwordx4 v10, s[16:19], s54 offen lds
s_add_u32 m0, s53, 35840
s_add_u32 s54, s52, 1146880
buffer_load_dwordx4 v11, s[16:19], s54 offen lds
s_add_u32 m0, s53, 36864
s_add_u32 s54, s52, 1179648
buffer_load_dwordx4 v12, s[16:19], s54 offen lds
s_add_u32 m0, s53, 37888
s_add_u32 s54, s52, 1212416
buffer_load_dwordx4 v13, s[16:19], s54 offen lds
s_add_u32 m0, s53, 38912
s_add_u32 s54, s52, 1245184
buffer_load_dwordx4 v14, s[16:19], s54 offen lds
s_add_u32 m0, s53, 39936
s_add_u32 s54, s52, 1277952
buffer_load_dwordx4 v15, s[16:19], s54 offen lds
s_waitcnt vmcnt(0)
s_barrier
ds_read_b64_tr_b16 a[8:9], v16 offset:0
ds_read_b64_tr_b16 a[10:11], v16 offset:512
ds_read_b64_tr_b16 a[12:13], v19 offset:0
ds_read_b64_tr_b16 a[14:15], v19 offset:512
ds_read_b64_tr_b16 a[24:25], v16 offset:256
ds_read_b64_tr_b16 a[26:27], v16 offset:768
ds_read_b64_tr_b16 a[28:29], v19 offset:256
ds_read_b64_tr_b16 a[30:31], v19 offset:768
ds_read_b64_tr_b16 a[40:41], v16 offset:16384
ds_read_b64_tr_b16 a[42:43], v16 offset:16896
ds_read_b64_tr_b16 a[44:45], v19 offset:16384
ds_read_b64_tr_b16 a[46:47], v19 offset:16896
ds_read_b64_tr_b16 a[56:57], v16 offset:16640
ds_read_b64_tr_b16 a[58:59], v16 offset:17152
ds_read_b64_tr_b16 a[60:61], v19 offset:16640
ds_read_b64_tr_b16 a[62:63], v19 offset:17152
ds_read_b64_tr_b16 a[72:73], v16 offset:32768
ds_read_b64_tr_b16 a[74:75], v16 offset:33280
ds_read_b64_tr_b16 a[76:77], v19 offset:32768
ds_read_b64_tr_b16 a[78:79], v19 offset:33280
ds_read_b64_tr_b16 a[88:89], v16 offset:33024
ds_read_b64_tr_b16 a[90:91], v16 offset:33536
ds_read_b64_tr_b16 a[92:93], v19 offset:33024
ds_read_b64_tr_b16 a[94:95], v19 offset:33536
ds_read_b64_tr_b16 a[104:105], v16 offset:49152
ds_read_b64_tr_b16 a[106:107], v16 offset:49664
ds_read_b64_tr_b16 a[108:109], v19 offset:49152
ds_read_b64_tr_b16 a[110:111], v19 offset:49664
ds_read_b64_tr_b16 a[120:121], v16 offset:49408
ds_read_b64_tr_b16 a[122:123], v16 offset:49920
ds_read_b64_tr_b16 a[124:125], v19 offset:49408
ds_read_b64_tr_b16 a[126:127], v19 offset:49920
ds_read_b64_tr_b16 a[136:137], v17 offset:0
ds_read_b64_tr_b16 a[138:139], v17 offset:512
ds_read_b64_tr_b16 a[140:141], v20 offset:0
ds_read_b64_tr_b16 a[142:143], v20 offset:512
ds_read_b64_tr_b16 a[152:153], v17 offset:256
ds_read_b64_tr_b16 a[154:155], v17 offset:768
ds_read_b64_tr_b16 a[156:157], v20 offset:256
ds_read_b64_tr_b16 a[158:159], v20 offset:768
ds_read_b64_tr_b16 a[168:169], v17 offset:16384
ds_read_b64_tr_b16 a[170:171], v17 offset:16896
ds_read_b64_tr_b16 a[172:173], v20 offset:16384
ds_read_b64_tr_b16 a[174:175], v20 offset:16896
ds_read_b64_tr_b16 a[184:185], v17 offset:16640
ds_read_b64_tr_b16 a[186:187], v17 offset:17152
ds_read_b64_tr_b16 a[188:189], v20 offset:16640
ds_read_b64_tr_b16 a[190:191], v20 offset:17152
ds_read_b64_tr_b16 a[200:201], v17 offset:32768
ds_read_b64_tr_b16 a[202:203], v17 offset:33280
ds_read_b64_tr_b16 a[204:205], v20 offset:32768
ds_read_b64_tr_b16 a[206:207], v20 offset:33280
ds_read_b64_tr_b16 a[216:217], v17 offset:33024
ds_read_b64_tr_b16 a[218:219], v17 offset:33536
ds_read_b64_tr_b16 a[220:221], v20 offset:33024
ds_read_b64_tr_b16 a[222:223], v20 offset:33536
ds_read_b64_tr_b16 a[232:233], v17 offset:49152
ds_read_b64_tr_b16 a[234:235], v17 offset:49664
ds_read_b64_tr_b16 a[236:237], v20 offset:49152
ds_read_b64_tr_b16 a[238:239], v20 offset:49664
ds_read_b64_tr_b16 a[248:249], v17 offset:49408
ds_read_b64_tr_b16 a[250:251], v17 offset:49920
ds_read_b64_tr_b16 a[252:253], v20 offset:49408
ds_read_b64_tr_b16 a[254:255], v20 offset:49920
ds_read_b64_tr_b16 v[200:201], v18 offset:0
ds_read_b64_tr_b16 v[202:203], v18 offset:512
ds_read_b64_tr_b16 v[204:205], v21 offset:0
ds_read_b64_tr_b16 v[206:207], v21 offset:512
ds_read_b64_tr_b16 v[216:217], v18 offset:256
ds_read_b64_tr_b16 v[218:219], v18 offset:768
ds_read_b64_tr_b16 v[220:221], v21 offset:256
ds_read_b64_tr_b16 v[222:223], v21 offset:768
ds_read_b64_tr_b16 v[232:233], v18 offset:16384
ds_read_b64_tr_b16 v[234:235], v18 offset:16896
ds_read_b64_tr_b16 v[236:237], v21 offset:16384
ds_read_b64_tr_b16 v[238:239], v21 offset:16896
ds_read_b64_tr_b16 v[248:249], v18 offset:16640
ds_read_b64_tr_b16 v[250:251], v18 offset:17152
ds_read_b64_tr_b16 v[252:253], v21 offset:16640
ds_read_b64_tr_b16 v[254:255], v21 offset:17152
s_waitcnt lgkmcnt(0)
s_barrier
s_and_b32 s47, s3, 1
s_lshr_b32 s52, s3, 1
s_add_u32 s50, s52, 1
v_lshrrev_b32 v20, 9, v0
v_mov_b32 v21, 0xff800000
v_cmp_eq_u32 vcc, s52, v20
s_lshl_b32 s46, s52, 10
s_lshl_b32 s53, s47, 7
s_add_u32 s46, s46, s53
s_add_u32 s46, s46, 117440512
s_lshl_b32 s53, s52, 5
s_add_u32 s53, s53, s30
s_lshl_b32 s44, s53, 14
s_add_u32 s44, s44, 0
s_lshl_b32 s53, s53, 13
s_lshl_b32 s45, s47, 10
s_add_u32 s45, s45, s53
s_add_u32 s45, s45, 125829120
s_lshl_b32 s48, s3, 17
s_lshl_b32 s53, s30, 11
s_add_u32 s48, s48, s53
s_add_u32 s48, s48, 159383552
s_lshl_b32 s56, s30, 6
s_add_u32 s56, s56, 222330880
s_lshl_b32 s57, s3, 8
s_lshl_b32 s53, s30, 2
s_add_u32 s57, s57, s53
s_add_u32 s57, s57, 222339072
s_mov_b32 s58, 0x3e0293ee
v_cndmask_b32 v156, v21, 0, vcc
v_cndmask_b32 v157, v21, 0, vcc
v_cndmask_b32 v158, v21, 0, vcc
v_cndmask_b32 v159, v21, 0, vcc
v_bfe_u32 v20, v0, 7, 1
v_and_b32 v1, 0x370, v0
v_mul_u32_u24 v23, 10240, v20
v_add_u32 v23, v23, v1
v_lshl_add_u32 v1, v20, 16, v1
v_and_b32 v16, 0x350, v0
v_lshl_add_u32 v16, v20, 5, v16
v_bfe_u32 v20, v0, 5, 1
v_lshl_add_u32 v16, v20, 12, v16
v_add_u32 v17, 8192, v16
s_lshl_b32 s52, s3, 10
v_add_u32 v155, s52, v0
v_mov_b32 v2, 2146435072
v_cmp_eq_u32 vcc, 0, v0
s_nop 1
v_cndmask_b32 v2, v2, 0, vcc
v_bfe_u32 v20, v0, 4, 4
s_lshl_b32 s52, s47, 4
v_add_u32 v20, s52, v20
v_lshrrev_b32 v22, 8, v0
v_lshlrev_b32 v22, 2, v22
v_sub_u32 v20, v20, v22
v_add_u32 v3, 4096, v0
v_add_u32 v18, 8192, v0
v_add_u32 v19, 12288, v0
v_cmp_le_i32 vcc, 0, v20
s_nop 1
v_cndmask_b32 v4, v21, 0, vcc
v_cmp_le_i32 vcc, 1, v20
s_nop 1
v_cndmask_b32 v5, v21, 0, vcc
v_cmp_le_i32 vcc, 2, v20
s_nop 1
v_cndmask_b32 v6, v21, 0, vcc
v_cmp_le_i32 vcc, 3, v20
s_nop 1
v_cndmask_b32 v7, v21, 0, vcc
v_cmp_le_i32 vcc, 16, v20
s_nop 1
v_cndmask_b32 v8, v21, 0, vcc
v_cmp_le_i32 vcc, 17, v20
s_nop 1
v_cndmask_b32 v9, v21, 0, vcc
v_cmp_le_i32 vcc, 18, v20
s_nop 1
v_cndmask_b32 v10, v21, 0, vcc
v_cmp_le_i32 vcc, 19, v20
s_nop 1
v_cndmask_b32 v11, v21, 0, vcc
v_mov_b32 v12, 0x3f803f80
v_mov_b32 v13, 0x3f803f80
v_mov_b32 v14, 0x3f803f80
v_mov_b32 v15, 0x3f803f80
s_cmp_lg_u32 s3, 0
s_cbranch_scc1 k_wdd_16
v_mov_b32 v20, 192
k_wd_15:
global_load_dword v21, v20, s[28:29] sc1
s_waitcnt vmcnt(0)
v_readfirstlane_b32 s52, v21
s_cmp_ge_u32 s52, 32
s_cbranch_scc1 k_wdd_16
s_sleep 2
s_sub_u32 s32, s32, 1
s_cmp_gt_i32 s32, 0
s_cbranch_scc1 k_wd_15
k_wdd_16:
s_barrier
v_mov_b32 v154, 0
k_top_17:
s_waitcnt vmcnt(0)
buffer_store_dword v154, v2, s[4:7], s57 offen sc1
s_cmp_gt_u32 s50, 128
s_cbranch_scc1 k_out_24
k_ck_18:
buffer_load_dwordx3 v[20:22], off, s[4:7], s56 sc1
s_waitcnt vmcnt(0)
v_min3_u32 v20, v20, v21, v22
v_cmp_le_u32 vcc, s50, v20
s_cbranch_vccnz k_cd_19
s_sleep 4
s_sub_u32 s32, s32, 1
s_cmp_gt_i32 s32, 0
s_cbranch_scc1 k_ck_18
k_cd_19:
s_add_u32 s52, s46, 10240
buffer_load_dword v20, off, s[4:7], s52 sc1
buffer_load_dwordx4 v[24:27], v0, s[4:7], s45 offen offset:0 sc1
buffer_load_dwordx4 v[40:43], v16, s[4:7], s44 offen offset:0 sc1
buffer_load_dwordx4 v[44:47], v17, s[4:7], s44 offen offset:0 sc1
buffer_load_dwordx4 v[28:31], v0, s[4:7], s45 offen offset:2048 sc1
buffer_load_dwordx4 v[48:51], v16, s[4:7], s44 offen offset:128 sc1
buffer_load_dwordx4 v[52:55], v17, s[4:7], s44 offen offset:128 sc1
buffer_load_dwordx4 v[32:35], v3, s[4:7], s45 offen offset:0 sc1
buffer_load_dwordx4 v[56:59], v16, s[4:7], s44 offen offset:1024 sc1
buffer_load_dwordx4 v[60:63], v17, s[4:7], s44 offen offset:1024 sc1
buffer_load_dwordx4 v[36:39], v3, s[4:7], s45 offen offset:2048 sc1
buffer_load_dwordx4 v[64:67], v16, s[4:7], s44 offen offset:1152 sc1
buffer_load_dwordx4 v[68:71], v17, s[4:7], s44 offen offset:1152 sc1
buffer_load_dwordx4 v[72:75], v0, s[4:7], s44 offen offset:2048 sc1
buffer_load_dwordx4 v[76:79], v0, s[4:7], s44 offen offset:3072 sc1
buffer_load_dwordx4 v[80:83], v3, s[4:7], s44 offen offset:2048 sc1
buffer_load_dwordx4 v[84:87], v3, s[4:7], s44 offen offset:3072 sc1
buffer_load_dwordx4 v[88:91], v18, s[4:7], s44 offen offset:2048 sc1
buffer_load_dwordx4 v[92:95], v18, s[4:7], s44 offen offset:3072 sc1
buffer_load_dwordx4 v[96:99], v19, s[4:7], s44 offen offset:2048 sc1
buffer_load_dwordx4 v[100:103], v19, s[4:7], s44 offen offset:3072 sc1
s_waitcnt vmcnt(20)
v_cmp_eq_u32 vcc, -1, v20
buffer_store_dword v154, v2, s[4:7], s57 offen sc1
s_cbranch_vccz k_pm_21
k_pr_20:
buffer_load_dword v20, off, s[4:7], s52 sc1
s_waitcnt vmcnt(0)
v_cmp_eq_u32 vcc, -1, v20
s_cbranch_vccz k_pm_21
s_sleep 2
s_sub_u32 s32, s32, 1
s_cmp_gt_i32 s32, 0
s_cbranch_scc1 k_pr_20
k_pm_21:
s_add_u32 s52, s46, 4096
s_add_u32 s53, s46, 8192
buffer_load_dwordx4 v[160:163], v23, s[4:7], s46 offen offset:0 sc1
buffer_load_dwordx4 v[164:167], v23, s[4:7], s46 offen offset:2048 sc1
buffer_load_dwordx4 v[168:171], v23, s[4:7], s52 offen offset:0 sc1
buffer_load_dwordx4 v[172:175], v23, s[4:7], s52 offen offset:2048 sc1
buffer_load_dwordx4 v[176:179], v23, s[4:7], s53 offen offset:0 sc1
s_waitcnt vmcnt(2)
v_max3_u32 v20, v160, v164, v168
s_waitcnt vmcnt(0)
v_max3_u32 v20, v20, v172, v176
v_cmp_eq_u32 vcc, -1, v20
s_cbranch_vccz k_pmd_22
s_sleep 2
s_sub_u32 s32, s32, 1
s_cmp_gt_i32 s32, 0
s_cbranch_scc1 k_pm_21
k_pmd_22:
ds_write_b128 v155, v[160:163] offset:0
ds_write_b128 v155, v[164:167] offset:4096
ds_write_b128 v155, v[168:171] offset:8192
ds_write_b128 v155, v[172:175] offset:12288
ds_write_b128 v155, v[176:179] offset:16384
s_waitcnt lgkmcnt(0)
s_barrier
ds_read_b128 v[160:163], v0 offset:0
ds_read_b128 v[164:167], v0 offset:1024
ds_read_b128 v[168:171], v0 offset:2048
ds_read_b128 v[172:175], v0 offset:3072
buffer_load_dwordx3 v[20:22], off, s[4:7], s56 sc1
s_waitcnt lgkmcnt(3)
v_mfma_f32_16x16x32_bf16 v[104:107], a[0:3], v[160:163], 0
ds_read_b128 v[176:179], v0 offset:4096
v_mfma_f32_16x16x32_bf16 v[108:111], a[4:7], v[160:163], 0
v_mfma_f32_16x16x32_bf16 v[112:115], v[160:163], a[8:11], 0
v_mfma_f32_16x16x32_bf16 v[116:119], v[160:163], a[12:15], 0
s_waitcnt lgkmcnt(3)
v_mfma_f32_16x16x32_bf16 v[104:107], a[16:19], v[164:167], v[104:107]
ds_read_b128 v[180:183], v0 offset:5120
v_mfma_f32_16x16x32_bf16 v[108:111], a[20:23], v[164:167], v[108:111]
v_mfma_f32_16x16x32_bf16 v[112:115], v[164:167], a[24:27], v[112:115]
v_mfma_f32_16x16x32_bf16 v[116:119], v[164:167], a[28:31], v[116:119]
s_waitcnt lgkmcnt(3)
v_mfma_f32_16x16x32_bf16 v[104:107], a[32:35], v[168:171], v[104:107]
ds_read_b128 v[184:187], v0 offset:6144
v_mfma_f32_16x16x32_bf16 v[108:111], a[36:39], v[168:171], v[108:111]
v_mfma_f32_16x16x32_bf16 v[112:115], v[168:171], a[40:43], v[112:115]
v_mfma_f32_16x16x32_bf16 v[116:119], v[168:171], a[44:47], v[116:119]
s_waitcnt lgkmcnt(3)
v_mfma_f32_16x16x32_bf16 v[104:107], a[48:51], v[172:175], v[104:107]
ds_read_b128 v[188:191], v0 offset:7168
v_mfma_f32_16x16x32_bf16 v[108:111], a[52:55], v[172:175], v[108:111]
v_mfma_f32_16x16x32_bf16 v[112:115], v[172:175], a[56:59], v[112:115]
v_mfma_f32_16x16x32_bf16 v[116:119], v[172:175], a[60:63], v[116:119]
s_waitcnt lgkmcnt(3)
v_mfma_f32_16x16x32_bf16 v[104:107], a[64:67], v[176:179], v[104:107]
ds_read_b128 v[160:163], v0 offset:8192
v_mfma_f32_16x16x32_bf16 v[108:111], a[68:71], v[176:179], v[108:111]
v_mfma_f32_16x16x32_bf16 v[112:115], v[176:179], a[72:75], v[112:115]
v_mfma_f32_16x16x32_bf16 v[116:119], v[176:179], a[76:79], v[116:119]
s_waitcnt lgkmcnt(3)
v_mfma_f32_16x16x32_bf16 v[104:107], a[80:83], v[180:183], v[104:107]
ds_read_b128 v[164:167], v0 offset:9216
v_mfma_f32_16x16x32_bf16 v[108:111], a[84:87], v[180:183], v[108:111]
v_mfma_f32_16x16x32_bf16 v[112:115], v[180:183], a[88:91], v[112:115]
v_mfma_f32_16x16x32_bf16 v[116:119], v[180:183], a[92:95], v[116:119]
s_waitcnt lgkmcnt(3)
v_mfma_f32_16x16x32_bf16 v[104:107], a[96:99], v[184:187], v[104:107]
ds_read_b128 v[168:171], v0 offset:10240
v_mfma_f32_16x16x32_bf16 v[108:111], a[100:103], v[184:187], v[108:111]
v_mfma_f32_16x16x32_bf16 v[112:115], v[184:187], a[104:107], v[112:115]
v_mfma_f32_16x16x32_bf16 v[116:119], v[184:187], a[108:111], v[116:119]
s_waitcnt lgkmcnt(3)
v_mfma_f32_16x16x32_bf16 v[104:107], a[112:115], v[188:191], v[104:107]
ds_read_b128 v[172:175], v0 offset:11264
v_mfma_f32_16x16x32_bf16 v[108:111], a[116:119], v[188:191], v[108:111]
v_mfma_f32_16x16x32_bf16 v[112:115], v[188:191], a[120:123], v[112:115]
v_mfma_f32_16x16x32_bf16 v[116:119], v[188:191], a[124:127], v[116:119]
s_waitcnt lgkmcnt(3)
v_mfma_f32_16x16x32_bf16 v[104:107], a[128:131], v[160:163], v[104:107]
ds_read_b128 v[176:179], v0 offset:12288
v_mfma_f32_16x16x32_bf16 v[108:111], a[132:135], v[160:163], v[108:111]
v_mfma_f32_16x16x32_bf16 v[112:115], v[160:163], a[136:139], v[112:115]
v_mfma_f32_16x16x32_bf16 v[116:119], v[160:163], a[140:143], v[116:119]
s_waitcnt lgkmcnt(3)
v_mfma_f32_16x16x32_bf16 v[104:107], a[144:147], v[164:167], v[104:107]
ds_read_b128 v[180:183], v0 offset:13312
v_mfma_f32_16x16x32_bf16 v[108:111], a[148:151], v[164:167], v[108:111]
v_mfma_f32_16x16x32_bf16 v[112:115], v[164:167], a[152:155], v[112:115]
v_mfma_f32_16x16x32_bf16 v[116:119], v[164:167], a[156:159], v[116:119]
s_waitcnt lgkmcnt(3)
v_mfma_f32_16x16x32_bf16 v[104:107], a[160:163], v[168:171], v[104:107]
ds_read_b128 v[184:187], v0 offset:14336
v_mfma_f32_16x16x32_bf16 v[108:111], a[164:167], v[168:171], v[108:111]
v_mfma_f32_16x16x32_bf16 v[112:115], v[168:171], a[168:171], v[112:115]
v_mfma_f32_16x16x32_bf16 v[116:119], v[168:171], a[172:175], v[116:119]
s_waitcnt lgkmcnt(3)
v_mfma_f32_16x16x32_bf16 v[104:107], a[176:179], v[172:175], v[104:107]
ds_read_b128 v[188:191], v0 offset:15360
v_mfma_f32_16x16x32_bf16 v[108:111], a[180:183], v[172:175], v[108:111]
v_mfma_f32_16x16x32_bf16 v[112:115], v[172:175], a[184:187], v[112:115]
v_mfma_f32_16x16x32_bf16 v[116:119], v[172:175], a[188:191], v[116:119]
s_waitcnt lgkmcnt(3)
v_mfma_f32_16x16x32_bf16 v[104:107], a[192:195], v[176:179], v[104:107]
ds_read_b128 v[160:163], v0 offset:16384
v_mfma_f32_16x16x32_bf16 v[108:111], a[196:199], v[176:179], v[108:111]
v_mfma_f32_16x16x32_bf16 v[112:115], v[176:179], a[200:203], v[112:115]
v_mfma_f32_16x16x32_bf16 v[116:119], v[176:179], a[204:207], v[116:119]
s_waitcnt lgkmcnt(3)
v_mfma_f32_16x16x32_bf16 v[104:107], a[208:211], v[180:183], v[104:107]
ds_read_b128 v[164:167], v0 offset:17408
v_mfma_f32_16x16x32_bf16 v[108:111], a[212:215], v[180:183], v[108:111]
v_mfma_f32_16x16x32_bf16 v[112:115], v[180:183], a[216:219], v[112:115]
v_mfma_f32_16x16x32_bf16 v[116:119], v[180:183], a[220:223], v[116:119]
s_waitcnt lgkmcnt(3)
v_mfma_f32_16x16x32_bf16 v[104:107], a[224:227], v[184:187], v[104:107]
ds_read_b128 v[168:171], v0 offset:18432
v_mfma_f32_16x16x32_bf16 v[108:111], a[228:231], v[184:187], v[108:111]
v_mfma_f32_16x16x32_bf16 v[112:115], v[184:187], a[232:235], v[112:115]
v_mfma_f32_16x16x32_bf16 v[116:119], v[184:187], a[236:239], v[116:119]
s_waitcnt lgkmcnt(3)
v_mfma_f32_16x16x32_bf16 v[104:107], a[240:243], v[188:191], v[104:107]
ds_read_b128 v[172:175], v0 offset:19456
v_mfma_f32_16x16x32_bf16 v[108:111], a[244:247], v[188:191], v[108:111]
v_mfma_f32_16x16x32_bf16 v[112:115], v[188:191], a[248:251], v[112:115]
v_mfma_f32_16x16x32_bf16 v[116:119], v[188:191], a[252:255], v[116:119]
s_waitcnt lgkmcnt(3)
v_mfma_f32_16x16x32_bf16 v[104:107], v[192:195], v[160:163], v[104:107]
v_mfma_f32_16x16x32_bf16 v[108:111], v[196:199], v[160:163], v[108:111]
v_mfma_f32_16x16x32_bf16 v[112:115], v[160:163], v[200:203], v[112:115]
v_mfma_f32_16x16x32_bf16 v[116:119], v[160:163], v[204:207], v[116:119]
s_waitcnt lgkmcnt(2)
v_mfma_f32_16x16x32_bf16 v[104:107], v[208:211], v[164:167], v[104:107]
v_mfma_f32_16x16x32_bf16 v[108:111], v[212:215], v[164:167], v[108:111]
v_mfma_f32_16x16x32_bf16 v[112:115], v[164:167], v[216:219], v[112:115]
v_mfma_f32_16x16x32_bf16 v[116:119], v[164:167], v[220:223], v[116:119]
s_waitcnt lgkmcnt(1)
v_mfma_f32_16x16x32_bf16 v[104:107], v[224:227], v[168:171], v[104:107]
v_mfma_f32_16x16x32_bf16 v[108:111], v[228:231], v[168:171], v[108:111]
v_mfma_f32_16x16x32_bf16 v[112:115], v[168:171], v[232:235], v[112:115]
v_mfma_f32_16x16x32_bf16 v[116:119], v[168:171], v[236:239], v[116:119]
s_waitcnt lgkmcnt(0)
v_mfma_f32_16x16x32_bf16 v[104:107], v[240:243], v[172:175], v[104:107]
v_mfma_f32_16x16x32_bf16 v[108:111], v[244:247], v[172:175], v[108:111]
v_mfma_f32_16x16x32_bf16 v[112:115], v[172:175], v[248:251], v[112:115]
v_mfma_f32_16x16x32_bf16 v[116:119], v[172:175], v[252:255], v[116:119]
v_cvt_pk_bf16_f32 v104, v104, v105
v_cvt_pk_bf16_f32 v105, v106, v107
v_cvt_pk_bf16_f32 v106, v108, v109
v_cvt_pk_bf16_f32 v107, v110, v111
ds_write_b128 v155, v[104:107] offset:20480
v_cvt_pk_bf16_f32 v112, v112, v113
v_cvt_pk_bf16_f32 v113, v114, v115
v_cvt_pk_bf16_f32 v114, v116, v117
v_cvt_pk_bf16_f32 v115, v118, v119
ds_write_b128 v155, v[112:115] offset:24576
v_mfma_f32_16x16x32_bf16 v[136:139], v[40:43], v[24:27], v[4:7]
v_mfma_f32_16x16x32_bf16 v[140:143], v[44:47], v[24:27], v[8:11]
v_mfma_f32_16x16x32_bf16 v[136:139], v[48:51], v[28:31], v[136:139]
v_mfma_f32_16x16x32_bf16 v[140:143], v[52:55], v[28:31], v[140:143]
s_waitcnt lgkmcnt(0)
s_barrier
ds_read_b128 v[104:107], v0 offset:20480
ds_read_b128 v[108:111], v0 offset:21504
ds_read_b128 v[112:115], v0 offset:22528
ds_read_b128 v[116:119], v0 offset:23552
ds_read_b128 v[120:123], v0 offset:24576
ds_read_b128 v[124:127], v0 offset:25600
ds_read_b128 v[128:131], v0 offset:26624
ds_read_b128 v[132:135], v0 offset:27648
v_mfma_f32_16x16x32_bf16 v[136:139], v[56:59], v[32:35], v[136:139]
v_mfma_f32_16x16x32_bf16 v[140:143], v[60:63], v[32:35], v[140:143]
v_mfma_f32_16x16x32_bf16 v[136:139], v[64:67], v[36:39], v[136:139]
v_mfma_f32_16x16x32_bf16 v[140:143], v[68:71], v[36:39], v[140:143]
s_waitcnt lgkmcnt(7)
v_mfma_f32_16x16x32_bf16 v[144:147], v[104:107], v[24:27], v[156:159]
s_waitcnt lgkmcnt(6)
v_mfma_f32_16x16x32_bf16 v[144:147], v[108:111], v[28:31], v[144:147]
s_waitcnt lgkmcnt(5)
v_mfma_f32_16x16x32_bf16 v[144:147], v[112:115], v[32:35], v[144:147]
s_waitcnt lgkmcnt(4)
v_mfma_f32_16x16x32_bf16 v[144:147], v[116:119], v[36:39], v[144:147]
v_max3_f32 v44, v136, v137, v138
v_max3_f32 v44, v44, v139, v140
v_max3_f32 v44, v44, v141, v142
s_nop 2
v_max3_f32 v44, v44, v143, v144
v_max3_f32 v44, v44, v145, v146
v_max_f32 v44, v44, v147
v_mov_b32 v45, v44
s_nop 1
v_permlane32_swap_b32 v44, v45
v_max_f32 v44, v44, v45
v_mov_b32 v45, v44
s_nop 1
v_permlane16_swap_b32 v44, v45
v_max_f32 v44, v44, v45
v_mul_f32 v44, s58, v44
v_fma_f32 v136, v136, s58, -v44
v_exp_f32 v136, v136
v_fma_f32 v137, v137, s58, -v44
v_exp_f32 v137, v137
v_fma_f32 v138, v138, s58, -v44
v_exp_f32 v138, v138
v_fma_f32 v139, v139, s58, -v44
v_exp_f32 v139, v139
v_fma_f32 v140, v140, s58, -v44
v_exp_f32 v140, v140
v_fma_f32 v141, v141, s58, -v44
v_exp_f32 v141, v141
v_fma_f32 v142, v142, s58, -v44
v_exp_f32 v142, v142
v_fma_f32 v143, v143, s58, -v44
v_exp_f32 v143, v143
v_fma_f32 v144, v144, s58, -v44
v_exp_f32 v144, v144
v_fma_f32 v145, v145, s58, -v44
v_exp_f32 v145, v145
v_fma_f32 v146, v146, s58, -v44
v_exp_f32 v146, v146
v_fma_f32 v147, v147, s58, -v44
v_exp_f32 v147, v147
v_cvt_pk_bf16_f32 v148, v136, v137
v_cvt_pk_bf16_f32 v149, v138, v139
v_cvt_pk_bf16_f32 v150, v140, v141
v_cvt_pk_bf16_f32 v151, v142, v143
v_cvt_pk_bf16_f32 v152, v144, v145
v_cvt_pk_bf16_f32 v153, v146, v147
v_mfma_f32_16x16x32_bf16 v[40:43], v[12:15], v[148:151], 0
v_mfma_f32_16x16x32_bf16 v[160:163], v[72:75], v[148:151], 0
v_mfma_f32_16x16x32_bf16 v[164:167], v[76:79], v[148:151], 0
v_mfma_f32_16x16x16_bf16 v[40:43], v[12:13], v[152:153], v[40:43]
v_mfma_f32_16x16x32_bf16 v[168:171], v[80:83], v[148:151], 0
v_mfma_f32_16x16x32_bf16 v[172:175], v[84:87], v[148:151], 0
v_mfma_f32_16x16x32_bf16 v[176:179], v[88:91], v[148:151], 0
v_mfma_f32_16x16x32_bf16 v[180:183], v[92:95], v[148:151], 0
v_mfma_f32_16x16x32_bf16 v[184:187], v[96:99], v[148:151], 0
v_mfma_f32_16x16x32_bf16 v[188:191], v[100:103], v[148:151], 0
v_rcp_f32 v40, v40
s_waitcnt lgkmcnt(3)
v_mfma_f32_16x16x16_bf16 v[160:163], v[120:121], v[152:153], v[160:163]
v_mfma_f32_16x16x16_bf16 v[164:167], v[122:123], v[152:153], v[164:167]
s_waitcnt lgkmcnt(2)
v_mfma_f32_16x16x16_bf16 v[168:171], v[124:125], v[152:153], v[168:171]
v_mfma_f32_16x16x16_bf16 v[172:175], v[126:127], v[152:153], v[172:175]
s_waitcnt lgkmcnt(1)
v_mfma_f32_16x16x16_bf16 v[176:179], v[128:129], v[152:153], v[176:179]
v_mfma_f32_16x16x16_bf16 v[180:183], v[130:131], v[152:153], v[180:183]
s_waitcnt lgkmcnt(0)
v_mfma_f32_16x16x16_bf16 v[184:187], v[132:133], v[152:153], v[184:187]
v_mfma_f32_16x16x16_bf16 v[188:191], v[134:135], v[152:153], v[188:191]
v_mul_f32 v160, v40, v160
v_mul_f32 v161, v40, v161
v_mul_f32 v162, v40, v162
v_mul_f32 v163, v40, v163
v_mul_f32 v164, v40, v164
v_mul_f32 v165, v40, v165
v_mul_f32 v166, v40, v166
v_mul_f32 v167, v40, v167
v_cvt_pk_bf16_f32 v104, v160, v161
v_cvt_pk_bf16_f32 v105, v162, v163
v_cvt_pk_bf16_f32 v106, v164, v165
v_cvt_pk_bf16_f32 v107, v166, v167
buffer_store_dwordx4 v[104:107], v1, s[4:7], s48 offen offset:0 sc1
v_mul_f32 v168, v40, v168
v_mul_f32 v169, v40, v169
v_mul_f32 v170, v40, v170
v_mul_f32 v171, v40, v171
v_mul_f32 v172, v40, v172
v_mul_f32 v173, v40, v173
v_mul_f32 v174, v40, v174
v_mul_f32 v175, v40, v175
v_cvt_pk_bf16_f32 v108, v168, v169
v_cvt_pk_bf16_f32 v109, v170, v171
v_cvt_pk_bf16_f32 v110, v172, v173
v_cvt_pk_bf16_f32 v111, v174, v175
buffer_store_dwordx4 v[108:111], v1, s[4:7], s48 offen offset:128 sc1
v_mul_f32 v176, v40, v176
v_mul_f32 v177, v40, v177
v_mul_f32 v178, v40, v178
v_mul_f32 v179, v40, v179
v_mul_f32 v180, v40, v180
v_mul_f32 v181, v40, v181
v_mul_f32 v182, v40, v182
v_mul_f32 v183, v40, v183
v_cvt_pk_bf16_f32 v112, v176, v177
v_cvt_pk_bf16_f32 v113, v178, v179
v_cvt_pk_bf16_f32 v114, v180, v181
v_cvt_pk_bf16_f32 v115, v182, v183
buffer_store_dwordx4 v[112:115], v1, s[4:7], s48 offen offset:1024 sc1
v_mul_f32 v184, v40, v184
v_mul_f32 v185, v40, v185
v_mul_f32 v186, v40, v186
v_mul_f32 v187, v40, v187
v_mul_f32 v188, v40, v188
v_mul_f32 v189, v40, v189
v_mul_f32 v190, v40, v190
v_mul_f32 v191, v40, v191
v_cvt_pk_bf16_f32 v116, v184, v185
v_cvt_pk_bf16_f32 v117, v186, v187
v_cvt_pk_bf16_f32 v118, v188, v189
v_cvt_pk_bf16_f32 v119, v190, v191
buffer_store_dwordx4 v[116:119], v1, s[4:7], s48 offen offset:1152 sc1
v_mov_b32 v154, s50
s_add_u32 s44, s44, 1048576
s_add_u32 s45, s45, 524288
s_add_u32 s46, s46, 20480
s_add_u32 s48, s48, 524288
s_add_u32 s50, s50, 2
s_sub_u32 s52, s50, 65
s_cmp_lt_u32 s52, 2
s_cbranch_scc0 k_nosw_23
s_add_u32 s44, s44, 8388608
s_add_u32 s48, s48, 1048576
s_add_u32 s46, s46, 393216
k_nosw_23:
s_waitcnt vmcnt(4)
v_min3_u32 v20, v20, v21, v22
v_cmp_le_u32 vcc, s50, v20
s_cbranch_vccnz k_cd_19
s_branch k_top_17
k_out_24:
s_waitcnt vmcnt(0) lgkmcnt(0)
s_barrier
s_add_u32 s30, s30, 80
s_branch k_fin_7
k_p_6:
s_mul_i32 s57, s30, 21846
s_lshr_b32 s57, s57, 16
s_mul_i32 s52, s57, 3
s_sub_u32 s58, s30, s52
s_cmp_eq_u32 s58, 1
s_cselect_b32 s12, s16, s12
s_cselect_b32 s13, s17, s13
s_cmp_eq_u32 s58, 2
s_cselect_b32 s12, s8, s12
s_cselect_b32 s13, s9, s13
v_lshrrev_b32 v1, 8, v0
v_and_b32 v2, 0xf0, v0
v_lshlrev_b32 v3, 5, v1
v_xor_b32 v2, v2, v3
v_lshl_add_u32 v1, v1, 13, v2
s_mul_i32 s52, s3, 1310720
s_lshl_b32 s53, s57, 8
s_add_u32 s52, s52, s53
s_mul_i32 s53, s3, 40960
s_add_u32 m0, s53, 0
s_add_u32 s54, s52, 0
buffer_load_dwordx4 v1, s[12:15], s54 offen lds
s_add_u32 m0, s53, 1024
s_add_u32 s54, s52, 32768
buffer_load_dwordx4 v1, s[12:15], s54 offen lds
s_add_u32 m0, s53, 2048
s_add_u32 s54, s52, 65536
buffer_load_dwordx4 v1, s[12:15], s54 offen lds
s_add_u32 m0, s53, 3072
s_add_u32 s54, s52, 98304
buffer_load_dwordx4 v1, s[12:15], s54 offen lds
s_add_u32 m0, s53, 4096
s_add_u32 s54, s52, 131072
buffer_load_dwordx4 v1, s[12:15], s54 offen lds
s_add_u32 m0, s53, 5120
s_add_u32 s54, s52, 163840
buffer_load_dwordx4 v1, s[12:15], s54 offen lds
s_add_u32 m0, s53, 6144
s_add_u32 s54, s52, 196608
buffer_load_dwordx4 v1, s[12:15], s54 offen lds
s_add_u32 m0, s53, 7168
s_add_u32 s54, s52, 229376
buffer_load_dwordx4 v1, s[12:15], s54 offen lds
s_add_u32 m0, s53, 8192
s_add_u32 s54, s52, 262144
buffer_load_dwordx4 v1, s[12:15], s54 offen lds
s_add_u32 m0, s53, 9216
s_add_u32 s54, s52, 294912
buffer_load_dwordx4 v1, s[12:15], s54 offen lds
s_add_u32 m0, s53, 10240
s_add_u32 s54, s52, 327680
buffer_load_dwordx4 v1, s[12:15], s54 offen lds
s_add_u32 m0, s53, 11264
s_add_u32 s54, s52, 360448
buffer_load_dwordx4 v1, s[12:15], s54 offen lds
s_add_u32 m0, s53, 12288
s_add_u32 s54, s52, 393216
buffer_load_dwordx4 v1, s[12:15], s54 offen lds
s_add_u32 m0, s53, 13312
s_add_u32 s54, s52, 425984
buffer_load_dwordx4 v1, s[12:15], s54 offen lds
s_add_u32 m0, s53, 14336
s_add_u32 s54, s52, 458752
buffer_load_dwordx4 v1, s[12:15], s54 offen lds
s_add_u32 m0, s53, 15360
s_add_u32 s54, s52, 491520
buffer_load_dwordx4 v1, s[12:15], s54 offen lds
s_add_u32 m0, s53, 16384
s_add_u32 s54, s52, 524288
buffer_load_dwordx4 v1, s[12:15], s54 offen lds
s_add_u32 m0, s53, 17408
s_add_u32 s54, s52, 557056
buffer_load_dwordx4 v1, s[12:15], s54 offen lds
s_add_u32 m0, s53, 18432
s_add_u32 s54, s52, 589824
buffer_load_dwordx4 v1, s[12:15], s54 offen lds
s_add_u32 m0, s53, 19456
s_add_u32 s54, s52, 622592
buffer_load_dwordx4 v1, s[12:15], s54 offen lds
s_add_u32 m0, s53, 20480
s_add_u32 s54, s52, 655360
buffer_load_dwordx4 v1, s[12:15], s54 offen lds
s_add_u32 m0, s53, 21504
s_add_u32 s54, s52, 688128
buffer_load_dwordx4 v1, s[12:15], s54 offen lds
s_add_u32 m0, s53, 22528
s_add_u32 s54, s52, 720896
buffer_load_dwordx4 v1, s[12:15], s54 offen lds
s_add_u32 m0, s53, 23552
s_add_u32 s54, s52, 753664
buffer_load_dwordx4 v1, s[12:15], s54 offen lds
s_add_u32 m0, s53, 24576
s_add_u32 s54, s52, 786432
buffer_load_dwordx4 v1, s[12:15], s54 offen lds
s_add_u32 m0, s53, 25600
s_add_u32 s54, s52, 819200
buffer_load_dwordx4 v1, s[12:15], s54 offen lds
s_add_u32 m0, s53, 26624
s_add_u32 s54, s52, 851968
buffer_load_dwordx4 v1, s[12:15], s54 offen lds
s_add_u32 m0, s53, 27648
s_add_u32 s54, s52, 884736
buffer_load_dwordx4 v1, s[12:15], s54 offen lds
s_add_u32 m0, s53, 28672
s_add_u32 s54, s52, 917504
buffer_load_dwordx4 v1, s[12:15], s54 offen lds
s_add_u32 m0, s53, 29696
s_add_u32 s54, s52, 950272
buffer_load_dwordx4 v1, s[12:15], s54 offen lds
s_add_u32 m0, s53, 30720
s_add_u32 s54, s52, 983040
buffer_load_dwordx4 v1, s[12:15], s54 offen lds
s_add_u32 m0, s53, 31744
s_add_u32 s54, s52, 1015808
buffer_load_dwordx4 v1, s[12:15], s54 offen lds
s_add_u32 m0, s53, 32768
s_add_u32 s54, s52, 1048576
buffer_load_dwordx4 v1, s[12:15], s54 offen lds
s_add_u32 m0, s53, 33792
s_add_u32 s54, s52, 1081344
buffer_load_dwordx4 v1, s[12:15], s54 offen lds
s_add_u32 m0, s53, 34816
s_add_u32 s54, s52, 1114112
buffer_load_dwordx4 v1, s[12:15], s54 offen lds
s_add_u32 m0, s53, 35840
s_add_u32 s54, s52, 1146880
buffer_load_dwordx4 v1, s[12:15], s54 offen lds
s_add_u32 m0, s53, 36864
s_add_u32 s54, s52, 1179648
buffer_load_dwordx4 v1, s[12:15], s54 offen lds
s_add_u32 m0, s53, 37888
s_add_u32 s54, s52, 1212416
buffer_load_dwordx4 v1, s[12:15], s54 offen lds
s_add_u32 m0, s53, 38912
s_add_u32 s54, s52, 1245184
buffer_load_dwordx4 v1, s[12:15], s54 offen lds
s_add_u32 m0, s53, 39936
s_add_u32 s54, s52, 1277952
buffer_load_dwordx4 v1, s[12:15], s54 offen lds
v_bfe_u32 v2, v0, 8, 1
v_bfe_u32 v3, v0, 5, 1
s_cmp_eq_u32 s58, 1
s_cselect_b32 s52, 7, 4
s_cselect_b32 s53, 4, 7
v_lshlrev_b32 v2, s52, v2
v_lshlrev_b32 v3, s53, v3
v_add_u32 v2, v2, v3
v_bfe_u32 v3, v0, 4, 1
v_lshl_add_u32 v2, v3, 3, v2
v_bfe_u32 v3, v0, 6, 2
v_xor_b32 v4, s3, v3
v_lshl_add_u32 v2, v4, 5, v2
v_lshl_add_u32 v2, v3, 8, v2
v_lshrrev_b32 v3, 9, v0
v_lshl_add_u32 v2, v3, 11, v2
v_add_u32 v3, 0x10000, v2
v_add_u32 v4, 0x20000, v2
s_waitcnt vmcnt(0)
s_barrier
ds_read_b64_tr_b16 v[96:97], v2 offset:0
ds_read_b64_tr_b16 v[98:99], v2 offset:1024
ds_read_b64_tr_b16 v[100:101], v2 offset:4096
ds_read_b64_tr_b16 v[102:103], v2 offset:5120
ds_read_b64_tr_b16 v[104:105], v2 offset:8192
ds_read_b64_tr_b16 v[106:107], v2 offset:9216
ds_read_b64_tr_b16 v[108:109], v2 offset:12288
ds_read_b64_tr_b16 v[110:111], v2 offset:13312
ds_read_b64_tr_b16 v[112:113], v2 offset:16384
ds_read_b64_tr_b16 v[114:115], v2 offset:17408
ds_read_b64_tr_b16 v[116:117], v2 offset:20480
ds_read_b64_tr_b16 v[118:119], v2 offset:21504
ds_read_b64_tr_b16 v[120:121], v2 offset:24576
ds_read_b64_tr_b16 v[122:123], v2 offset:25600
ds_read_b64_tr_b16 v[124:125], v2 offset:28672
ds_read_b64_tr_b16 v[126:127], v2 offset:29696
ds_read_b64_tr_b16 v[128:129], v2 offset:32768
ds_read_b64_tr_b16 v[130:131], v2 offset:33792
ds_read_b64_tr_b16 v[132:133], v2 offset:36864
ds_read_b64_tr_b16 v[134:135], v2 offset:37888
ds_read_b64_tr_b16 v[136:137], v2 offset:40960
ds_read_b64_tr_b16 v[138:139], v2 offset:41984
ds_read_b64_tr_b16 v[140:141], v2 offset:45056
ds_read_b64_tr_b16 v[142:143], v2 offset:46080
ds_read_b64_tr_b16 v[144:145], v2 offset:49152
ds_read_b64_tr_b16 v[146:147], v2 offset:50176
ds_read_b64_tr_b16 v[148:149], v2 offset:53248
ds_read_b64_tr_b16 v[150:151], v2 offset:54272
ds_read_b64_tr_b16 v[152:153], v2 offset:57344
ds_read_b64_tr_b16 v[154:155], v2 offset:58368
ds_read_b64_tr_b16 v[156:157], v2 offset:61440
ds_read_b64_tr_b16 v[158:159], v2 offset:62464
ds_read_b64_tr_b16 v[160:161], v3 offset:0
ds_read_b64_tr_b16 v[162:163], v3 offset:1024
ds_read_b64_tr_b16 v[164:165], v3 offset:4096
ds_read_b64_tr_b16 v[166:167], v3 offset:5120
ds_read_b64_tr_b16 v[168:169], v3 offset:8192
ds_read_b64_tr_b16 v[170:171], v3 offset:9216
ds_read_b64_tr_b16 v[172:173], v3 offset:12288
ds_read_b64_tr_b16 v[174:175], v3 offset:13312
ds_read_b64_tr_b16 v[176:177], v3 offset:16384
ds_read_b64_tr_b16 v[178:179], v3 offset:17408
ds_read_b64_tr_b16 v[180:181], v3 offset:20480
ds_read_b64_tr_b16 v[182:183], v3 offset:21504
ds_read_b64_tr_b16 v[184:185], v3 offset:24576
ds_read_b64_tr_b16 v[186:187], v3 offset:25600
ds_read_b64_tr_b16 v[188:189], v3 offset:28672
ds_read_b64_tr_b16 v[190:191], v3 offset:29696
ds_read_b64_tr_b16 v[192:193], v3 offset:32768
ds_read_b64_tr_b16 v[194:195], v3 offset:33792
ds_read_b64_tr_b16 v[196:197], v3 offset:36864
ds_read_b64_tr_b16 v[198:199], v3 offset:37888
ds_read_b64_tr_b16 v[200:201], v3 offset:40960
ds_read_b64_tr_b16 v[202:203], v3 offset:41984
ds_read_b64_tr_b16 v[204:205], v3 offset:45056
ds_read_b64_tr_b16 v[206:207], v3 offset:46080
ds_read_b64_tr_b16 v[208:209], v3 offset:49152
ds_read_b64_tr_b16 v[210:211], v3 offset:50176
ds_read_b64_tr_b16 v[212:213], v3 offset:53248
ds_read_b64_tr_b16 v[214:215], v3 offset:54272
ds_read_b64_tr_b16 v[216:217], v3 offset:57344
ds_read_b64_tr_b16 v[218:219], v3 offset:58368
ds_read_b64_tr_b16 v[220:221], v3 offset:61440
ds_read_b64_tr_b16 v[222:223], v3 offset:62464
ds_read_b64_tr_b16 v[224:225], v4 offset:0
ds_read_b64_tr_b16 v[226:227], v4 offset:1024
ds_read_b64_tr_b16 v[228:229], v4 offset:4096
ds_read_b64_tr_b16 v[230:231], v4 offset:5120
ds_read_b64_tr_b16 v[232:233], v4 offset:8192
ds_read_b64_tr_b16 v[234:235], v4 offset:9216
ds_read_b64_tr_b16 v[236:237], v4 offset:12288
ds_read_b64_tr_b16 v[238:239], v4 offset:13312
ds_read_b64_tr_b16 v[240:241], v4 offset:16384
ds_read_b64_tr_b16 v[242:243], v4 offset:17408
ds_read_b64_tr_b16 v[244:245], v4 offset:20480
ds_read_b64_tr_b16 v[246:247], v4 offset:21504
ds_read_b64_tr_b16 v[248:249], v4 offset:24576
ds_read_b64_tr_b16 v[250:251], v4 offset:25600
ds_read_b64_tr_b16 v[252:253], v4 offset:28672
ds_read_b64_tr_b16 v[254:255], v4 offset:29696
s_waitcnt lgkmcnt(0)
s_cmp_lg_u32 s3, 0
s_cbranch_scc1 k_wdd_26
v_mov_b32 v2, 128
k_wd_25:
global_load_dword v3, v2, s[28:29] sc1
s_waitcnt vmcnt(0)
v_readfirstlane_b32 s52, v3
s_cmp_ge_u32 s52, 32
s_cbranch_scc1 k_wdd_26
s_sleep 2
s_sub_u32 s32, s32, 1
s_cmp_gt_i32 s32, 0
s_cbranch_scc1 k_wd_25
k_wdd_26:
s_barrier
s_mul_i32 s46, s3, 10240
s_add_u32 s46, s46, 213909504
s_mul_i32 s45, s3, 10240
s_mov_b32 s44, 0
v_mov_b32 v64, v0
s_add_u32 m0, s45, 0
s_add_u32 s55, s46, 0
buffer_load_dwordx4 v0, s[4:7], s55 offen offset:0 sc1 lds
buffer_load_dwordx4 v0, s[4:7], s55 offen offset:1024 sc1 lds
buffer_load_dwordx4 v0, s[4:7], s55 offen offset:2048 sc1 lds
buffer_load_dwordx4 v0, s[4:7], s55 offen offset:3072 sc1 lds
s_add_u32 m0, s45, 4096
s_add_u32 s55, s46, 4096
buffer_load_dwordx4 v0, s[4:7], s55 offen offset:0 sc1 lds
buffer_load_dwordx4 v0, s[4:7], s55 offen offset:1024 sc1 lds
buffer_load_dwordx4 v0, s[4:7], s55 offen offset:2048 sc1 lds
buffer_load_dwordx4 v0, s[4:7], s55 offen offset:3072 sc1 lds
s_add_u32 m0, s45, 8192
s_add_u32 s55, s46, 8192
buffer_load_dwordx4 v0, s[4:7], s55 offen offset:0 sc1 lds
buffer_load_dwordx4 v0, s[4:7], s55 offen offset:1024 sc1 lds
s_add_u32 s45, s45, 40960
s_cmp_ge_u32 s45, 122880
s_cselect_b32 s55, 122880, 0
s_sub_u32 s45, s45, s55
s_add_u32 s46, s46, 40960
s_add_u32 m0, s45, 0
s_add_u32 s55, s46, 0
buffer_load_dwordx4 v0, s[4:7], s55 offen offset:0 sc1 lds
buffer_load_dwordx4 v0, s[4:7], s55 offen offset:1024 sc1 lds
buffer_load_dwordx4 v0, s[4:7], s55 offen offset:2048 sc1 lds
buffer_load_dwordx4 v0, s[4:7], s55 offen offset:3072 sc1 lds
s_add_u32 m0, s45, 4096
s_add_u32 s55, s46, 4096
buffer_load_dwordx4 v0, s[4:7], s55 offen offset:0 sc1 lds
buffer_load_dwordx4 v0, s[4:7], s55 offen offset:1024 sc1 lds
buffer_load_dwordx4 v0, s[4:7], s55 offen offset:2048 sc1 lds
buffer_load_dwordx4 v0, s[4:7], s55 offen offset:3072 sc1 lds
s_add_u32 m0, s45, 8192
s_add_u32 s55, s46, 8192
buffer_load_dwordx4 v0, s[4:7], s55 offen offset:0 sc1 lds
buffer_load_dwordx4 v0, s[4:7], s55 offen offset:1024 sc1 lds
s_add_u32 s45, s45, 40960
s_cmp_ge_u32 s45, 122880
s_cselect_b32 s55, 122880, 0
s_sub_u32 s45, s45, s55
s_add_u32 s46, s46, 40960
s_waitcnt vmcnt(10)
s_barrier
ds_read_b128 v[8:11], v64 offset:0
ds_read_b128 v[12:15], v64 offset:1024
ds_read_b128 v[16:19], v64 offset:2048
ds_read_b128 v[20:23], v64 offset:3072
v_mov_b32 v1, 0xffff
v_cmp_gt_u32 vcc, 512, v0
s_nop 1
v_cndmask_b32 v1, -1, v1, vcc
s_waitcnt lgkmcnt(3)
v_mfma_f32_32x32x16_bf16 v[32:47], v[8:11], v[96:99], 0
s_waitcnt lgkmcnt(2)
ds_read_b128 v[24:27], v64 offset:4096
v_mfma_f32_32x32x16_bf16 v[32:47], v[12:15], v[100:103], v[32:47]
s_waitcnt lgkmcnt(2)
ds_read_b128 v[8:11], v64 offset:5120
s_add_u32 m0, s45, 0
s_add_u32 s55, s46, 0
buffer_load_dwordx4 v0, s[4:7], s55 offen offset:0 sc1 lds
buffer_load_dwordx4 v0, s[4:7], s55 offen offset:1024 sc1 lds
v_mfma_f32_32x32x16_bf16 v[32:47], v[16:19], v[104:107], v[32:47]
s_waitcnt lgkmcnt(2)
ds_read_b128 v[12:15], v64 offset:6144
buffer_load_dwordx4 v0, s[4:7], s55 offen offset:2048 sc1 lds
buffer_load_dwordx4 v0, s[4:7], s55 offen offset:3072 sc1 lds
v_mfma_f32_32x32x16_bf16 v[32:47], v[20:23], v[108:111], v[32:47]
s_waitcnt lgkmcnt(2)
ds_read_b128 v[16:19], v64 offset:7168
s_add_u32 m0, s45, 4096
s_add_u32 s55, s46, 4096
buffer_load_dwordx4 v0, s[4:7], s55 offen offset:0 sc1 lds
buffer_load_dwordx4 v0, s[4:7], s55 offen offset:1024 sc1 lds
v_mfma_f32_32x32x16_bf16 v[32:47], v[24:27], v[112:115], v[32:47]
s_waitcnt lgkmcnt(2)
ds_read_b128 v[20:23], v64 offset:8192
buffer_load_dwordx4 v0, s[4:7], s55 offen offset:2048 sc1 lds
buffer_load_dwordx4 v0, s[4:7], s55 offen offset:3072 sc1 lds
v_mfma_f32_32x32x16_bf16 v[32:47], v[8:11], v[116:119], v[32:47]
s_waitcnt lgkmcnt(2)
ds_read_b128 v[24:27], v64 offset:9216
s_add_u32 m0, s45, 8192
s_add_u32 s55, s46, 8192
buffer_load_dwordx4 v0, s[4:7], s55 offen offset:0 sc1 lds
buffer_load_dwordx4 v0, s[4:7], s55 offen offset:1024 sc1 lds
v_mfma_f32_32x32x16_bf16 v[32:47], v[12:15], v[120:123], v[32:47]
s_waitcnt lgkmcnt(2)
ds_read_b128 v[8:11], v64 offset:10240
s_add_u32 s45, s45, 40960
s_cmp_ge_u32 s45, 122880
s_cselect_b32 s55, 122880, 0
s_sub_u32 s45, s45, s55
s_add_u32 s46, s46, 40960
v_mfma_f32_32x32x16_bf16 v[32:47], v[16:19], v[124:127], v[32:47]
s_waitcnt lgkmcnt(2)
ds_read_b128 v[12:15], v64 offset:11264
v_mfma_f32_32x32x16_bf16 v[32:47], v[20:23], v[128:131], v[32:47]
s_waitcnt lgkmcnt(2)
ds_read_b128 v[16:19], v64 offset:12288
v_mfma_f32_32x32x16_bf16 v[32:47], v[24:27], v[132:135], v[32:47]
s_waitcnt lgkmcnt(2)
ds_read_b128 v[20:23], v64 offset:13312
v_mfma_f32_32x32x16_bf16 v[32:47], v[8:11], v[136:139], v[32:47]
s_waitcnt lgkmcnt(2)
ds_read_b128 v[24:27], v64 offset:14336
v_mfma_f32_32x32x16_bf16 v[32:47], v[12:15], v[140:143], v[32:47]
s_waitcnt lgkmcnt(2)
ds_read_b128 v[8:11], v64 offset:15360
v_mfma_f32_32x32x16_bf16 v[32:47], v[16:19], v[144:147], v[32:47]
s_waitcnt lgkmcnt(2)
ds_read_b128 v[12:15], v64 offset:16384
v_mfma_f32_32x32x16_bf16 v[32:47], v[20:23], v[148:151], v[32:47]
s_waitcnt lgkmcnt(2)
ds_read_b128 v[16:19], v64 offset:17408
v_mfma_f32_32x32x16_bf16 v[32:47], v[24:27], v[152:155], v[32:47]
s_waitcnt lgkmcnt(2)
ds_read_b128 v[20:23], v64 offset:18432
v_mfma_f32_32x32x16_bf16 v[32:47], v[8:11], v[156:159], v[32:47]
s_waitcnt lgkmcnt(2)
ds_read_b128 v[24:27], v64 offset:19456
v_mfma_f32_32x32x16_bf16 v[32:47], v[12:15], v[160:163], v[32:47]
s_waitcnt lgkmcnt(2)
ds_read_b128 v[8:11], v64 offset:20480
v_mfma_f32_32x32x16_bf16 v[32:47], v[16:19], v[164:167], v[32:47]
s_waitcnt lgkmcnt(2)
ds_read_b128 v[12:15], v64 offset:21504
v_mfma_f32_32x32x16_bf16 v[32:47], v[20:23], v[168:171], v[32:47]
s_waitcnt lgkmcnt(2)
ds_read_b128 v[16:19], v64 offset:22528
v_mfma_f32_32x32x16_bf16 v[32:47], v[24:27], v[172:175], v[32:47]
s_waitcnt lgkmcnt(2)
ds_read_b128 v[20:23], v64 offset:23552
v_mfma_f32_32x32x16_bf16 v[32:47], v[8:11], v[176:179], v[32:47]
s_waitcnt lgkmcnt(2)
ds_read_b128 v[24:27], v64 offset:24576
v_mfma_f32_32x32x16_bf16 v[32:47], v[12:15], v[180:183], v[32:47]
s_waitcnt lgkmcnt(2)
ds_read_b128 v[8:11], v64 offset:25600
v_mfma_f32_32x32x16_bf16 v[32:47], v[16:19], v[184:187], v[32:47]
s_waitcnt lgkmcnt(2)
ds_read_b128 v[12:15], v64 offset:26624
v_mfma_f32_32x32x16_bf16 v[32:47], v[20:23], v[188:191], v[32:47]
s_waitcnt lgkmcnt(2)
ds_read_b128 v[16:19], v64 offset:27648
v_mfma_f32_32x32x16_bf16 v[32:47], v[24:27], v[192:195], v[32:47]
s_waitcnt lgkmcnt(2)
ds_read_b128 v[20:23], v64 offset:28672
v_mfma_f32_32x32x16_bf16 v[32:47], v[8:11], v[196:199], v[32:47]
s_waitcnt lgkmcnt(2)
ds_read_b128 v[24:27], v64 offset:29696
v_mfma_f32_32x32x16_bf16 v[32:47], v[12:15], v[200:203], v[32:47]
s_waitcnt lgkmcnt(2)
ds_read_b128 v[8:11], v64 offset:30720
v_mfma_f32_32x32x16_bf16 v[32:47], v[16:19], v[204:207], v[32:47]
s_waitcnt lgkmcnt(2)
ds_read_b128 v[12:15], v64 offset:31744
v_mfma_f32_32x32x16_bf16 v[32:47], v[20:23], v[208:211], v[32:47]
s_waitcnt lgkmcnt(2)
ds_read_b128 v[16:19], v64 offset:32768
v_mfma_f32_32x32x16_bf16 v[32:47], v[24:27], v[212:215], v[32:47]
s_waitcnt lgkmcnt(2)
ds_read_b128 v[20:23], v64 offset:33792
v_mfma_f32_32x32x16_bf16 v[32:47], v[8:11], v[216:219], v[32:47]
s_waitcnt lgkmcnt(2)
ds_read_b128 v[24:27], v64 offset:34816
v_mfma_f32_32x32x16_bf16 v[32:47], v[12:15], v[220:223], v[32:47]
s_waitcnt lgkmcnt(2)
ds_read_b128 v[8:11], v64 offset:35840
v_mfma_f32_32x32x16_bf16 v[32:47], v[16:19], v[224:227], v[32:47]
s_waitcnt lgkmcnt(2)
ds_read_b128 v[12:15], v64 offset:36864
v_mfma_f32_32x32x16_bf16 v[32:47], v[20:23], v[228:231], v[32:47]
s_waitcnt lgkmcnt(2)
ds_read_b128 v[16:19], v64 offset:37888
v_mfma_f32_32x32x16_bf16 v[32:47], v[24:27], v[232:235], v[32:47]
s_waitcnt lgkmcnt(2)
ds_read_b128 v[20:23], v64 offset:38912
v_mfma_f32_32x32x16_bf16 v[32:47], v[8:11], v[236:239], v[32:47]
s_waitcnt lgkmcnt(2)
ds_read_b128 v[24:27], v64 offset:39936
v_mfma_f32_32x32x16_bf16 v[32:47], v[12:15], v[240:243], v[32:47]
s_add_u32 s44, s44, 1
s_cmp_eq_u32 s44, 3
s_mov_b32 s56, 40960
s_cmov_b32 s56, -81920
s_cselect_b32 s44, 0, s44
v_add_u32 v64, s56, v64
s_waitcnt vmcnt(10) lgkmcnt(2)
s_barrier
ds_read_b128 v[8:11], v64 offset:0
v_mfma_f32_32x32x16_bf16 v[32:47], v[16:19], v[244:247], v[32:47]
s_waitcnt lgkmcnt(2)
ds_read_b128 v[12:15], v64 offset:1024
v_mfma_f32_32x32x16_bf16 v[32:47], v[20:23], v[248:251], v[32:47]
s_waitcnt lgkmcnt(2)
ds_read_b128 v[16:19], v64 offset:2048
v_mfma_f32_32x32x16_bf16 v[32:47], v[24:27], v[252:255], v[32:47]
s_waitcnt lgkmcnt(2)
ds_read_b128 v[20:23], v64 offset:3072
v_mfma_f32_32x32x16_bf16 v[48:63], v[8:11], v[96:99], 0
s_waitcnt lgkmcnt(2)
ds_read_b128 v[24:27], v64 offset:4096
v_mfma_f32_32x32x16_bf16 v[48:63], v[12:15], v[100:103], v[48:63]
s_waitcnt lgkmcnt(2)
ds_read_b128 v[8:11], v64 offset:5120
v_cvt_pk_bf16_f32 v32, v32, v33
v_cvt_pk_bf16_f32 v33, v34, v35
v_mfma_f32_32x32x16_bf16 v[48:63], v[16:19], v[104:107], v[48:63]
s_waitcnt lgkmcnt(2)
ds_read_b128 v[12:15], v64 offset:6144
v_cvt_pk_bf16_f32 v34, v36, v37
v_cvt_pk_bf16_f32 v35, v38, v39
v_mfma_f32_32x32x16_bf16 v[48:63], v[20:23], v[108:111], v[48:63]
s_waitcnt lgkmcnt(2)
ds_read_b128 v[16:19], v64 offset:7168
v_cvt_pk_bf16_f32 v36, v40, v41
v_cvt_pk_bf16_f32 v37, v42, v43
v_mfma_f32_32x32x16_bf16 v[48:63], v[24:27], v[112:115], v[48:63]
s_waitcnt lgkmcnt(2)
ds_read_b128 v[20:23], v64 offset:8192
v_cvt_pk_bf16_f32 v38, v44, v45
v_cvt_pk_bf16_f32 v39, v46, v47
v_mfma_f32_32x32x16_bf16 v[48:63], v[8:11], v[116:119], v[48:63]
s_waitcnt lgkmcnt(2)
ds_read_b128 v[24:27], v64 offset:9216
v_and_b32 v32, v1, v32
v_accvgpr_write_b32 a0, v32
v_mfma_f32_32x32x16_bf16 v[48:63], v[12:15], v[120:123], v[48:63]
s_waitcnt lgkmcnt(2)
ds_read_b128 v[8:11], v64 offset:10240
v_accvgpr_write_b32 a1, v33
v_accvgpr_write_b32 a2, v34
v_mfma_f32_32x32x16_bf16 v[48:63], v[16:19], v[124:127], v[48:63]
s_waitcnt lgkmcnt(2)
ds_read_b128 v[12:15], v64 offset:11264
v_accvgpr_write_b32 a3, v35
v_accvgpr_write_b32 a4, v36
v_mfma_f32_32x32x16_bf16 v[48:63], v[20:23], v[128:131], v[48:63]
s_waitcnt lgkmcnt(2)
ds_read_b128 v[16:19], v64 offset:12288
v_accvgpr_write_b32 a5, v37
v_accvgpr_write_b32 a6, v38
v_mfma_f32_32x32x16_bf16 v[48:63], v[24:27], v[132:135], v[48:63]
s_waitcnt lgkmcnt(2)
ds_read_b128 v[20:23], v64 offset:13312
v_accvgpr_write_b32 a7, v39
s_add_u32 m0, s45, 0
s_add_u32 s55, s46, 0
buffer_load_dwordx4 v0, s[4:7], s55 offen offset:0 sc1 lds
v_mfma_f32_32x32x16_bf16 v[48:63], v[8:11], v[136:139], v[48:63]
s_waitcnt lgkmcnt(2)
ds_read_b128 v[24:27], v64 offset:14336
buffer_load_dwordx4 v0, s[4:7], s55 offen offset:1024 sc1 lds
buffer_load_dwordx4 v0, s[4:7], s55 offen offset:2048 sc1 lds
v_mfma_f32_32x32x16_bf16 v[48:63], v[12:15], v[140:143], v[48:63]
s_waitcnt lgkmcnt(2)
ds_read_b128 v[8:11], v64 offset:15360
buffer_load_dwordx4 v0, s[4:7], s55 offen offset:3072 sc1 lds
s_add_u32 m0, s45, 4096
s_add_u32 s55, s46, 4096
buffer_load_dwordx4 v0, s[4:7], s55 offen offset:0 sc1 lds
v_mfma_f32_32x32x16_bf16 v[48:63], v[16:19], v[144:147], v[48:63]
s_waitcnt lgkmcnt(2)
ds_read_b128 v[12:15], v64 offset:16384
buffer_load_dwordx4 v0, s[4:7], s55 offen offset:1024 sc1 lds
buffer_load_dwordx4 v0, s[4:7], s55 offen offset:2048 sc1 lds
v_mfma_f32_32x32x16_bf16 v[48:63], v[20:23], v[148:151], v[48:63]
s_waitcnt lgkmcnt(2)
ds_read_b128 v[16:19], v64 offset:17408
buffer_load_dwordx4 v0, s[4:7], s55 offen offset:3072 sc1 lds
s_add_u32 m0, s45, 8192
s_add_u32 s55, s46, 8192
buffer_load_dwordx4 v0, s[4:7], s55 offen offset:0 sc1 lds
v_mfma_f32_32x32x16_bf16 v[48:63], v[24:27], v[152:155], v[48:63]
s_waitcnt lgkmcnt(2)
ds_read_b128 v[20:23], v64 offset:18432
buffer_load_dwordx4 v0, s[4:7], s55 offen offset:1024 sc1 lds
s_add_u32 s45, s45, 40960
s_cmp_ge_u32 s45, 122880
s_cselect_b32 s55, 122880, 0
s_sub_u32 s45, s45, s55
v_mfma_f32_32x32x16_bf16 v[48:63], v[8:11], v[156:159], v[48:63]
s_waitcnt lgkmcnt(2)
ds_read_b128 v[24:27], v64 offset:19456
s_add_u32 s46, s46, 40960
v_mfma_f32_32x32x16_bf16 v[48:63], v[12:15], v[160:163], v[48:63]
s_waitcnt lgkmcnt(2)
ds_read_b128 v[8:11], v64 offset:20480
v_mfma_f32_32x32x16_bf16 v[48:63], v[16:19], v[164:167], v[48:63]
s_waitcnt lgkmcnt(2)
ds_read_b128 v[12:15], v64 offset:21504
v_mfma_f32_32x32x16_bf16 v[48:63], v[20:23], v[168:171], v[48:63]
s_waitcnt lgkmcnt(2)
ds_read_b128 v[16:19], v64 offset:22528
v_mfma_f32_32x32x16_bf16 v[48:63], v[24:27], v[172:175], v[48:63]
s_waitcnt lgkmcnt(2)
ds_read_b128 v[20:23], v64 offset:23552
v_mfma_f32_32x32x16_bf16 v[48:63], v[8:11], v[176:179], v[48:63]
s_waitcnt lgkmcnt(2)
ds_read_b128 v[24:27], v64 offset:24576
v_mfma_f32_32x32x16_bf16 v[48:63], v[12:15], v[180:183], v[48:63]
s_waitcnt lgkmcnt(2)
ds_read_b128 v[8:11], v64 offset:25600
v_mfma_f32_32x32x16_bf16 v[48:63], v[16:19], v[184:187], v[48:63]
s_waitcnt lgkmcnt(2)
ds_read_b128 v[12:15], v64 offset:26624
v_mfma_f32_32x32x16_bf16 v[48:63], v[20:23], v[188:191], v[48:63]
s_waitcnt lgkmcnt(2)
ds_read_b128 v[16:19], v64 offset:27648
v_mfma_f32_32x32x16_bf16 v[48:63], v[24:27], v[192:195], v[48:63]
s_waitcnt lgkmcnt(2)
ds_read_b128 v[20:23], v64 offset:28672
v_mfma_f32_32x32x16_bf16 v[48:63], v[8:11], v[196:199], v[48:63]
s_waitcnt lgkmcnt(2)
ds_read_b128 v[24:27], v64 offset:29696
v_mfma_f32_32x32x16_bf16 v[48:63], v[12:15], v[200:203], v[48:63]
s_waitcnt lgkmcnt(2)
ds_read_b128 v[8:11], v64 offset:30720
v_mfma_f32_32x32x16_bf16 v[48:63], v[16:19], v[204:207], v[48:63]
s_waitcnt lgkmcnt(2)
ds_read_b128 v[12:15], v64 offset:31744
v_mfma_f32_32x32x16_bf16 v[48:63], v[20:23], v[208:211], v[48:63]
s_waitcnt lgkmcnt(2)
ds_read_b128 v[16:19], v64 offset:32768
v_mfma_f32_32x32x16_bf16 v[48:63], v[24:27], v[212:215], v[48:63]
s_waitcnt lgkmcnt(2)
ds_read_b128 v[20:23], v64 offset:33792
v_mfma_f32_32x32x16_bf16 v[48:63], v[8:11], v[216:219], v[48:63]
s_waitcnt lgkmcnt(2)
ds_read_b128 v[24:27], v64 offset:34816
v_mfma_f32_32x32x16_bf16 v[48:63], v[12:15], v[220:223], v[48:63]
s_waitcnt lgkmcnt(2)
ds_read_b128 v[8:11], v64 offset:35840
v_mfma_f32_32x32x16_bf16 v[48:63], v[16:19], v[224:227], v[48:63]
s_waitcnt lgkmcnt(2)
ds_read_b128 v[12:15], v64 offset:36864
v_mfma_f32_32x32x16_bf16 v[48:63], v[20:23], v[228:231], v[48:63]
s_waitcnt lgkmcnt(2)
ds_read_b128 v[16:19], v64 offset:37888
v_mfma_f32_32x32x16_bf16 v[48:63], v[24:27], v[232:235], v[48:63]
s_waitcnt lgkmcnt(2)
ds_read_b128 v[20:23], v64 offset:38912
v_mfma_f32_32x32x16_bf16 v[48:63], v[8:11], v[236:239], v[48:63]
s_waitcnt lgkmcnt(2)
ds_read_b128 v[24:27], v64 offset:39936
v_mfma_f32_32x32x16_bf16 v[48:63], v[12:15], v[240:243], v[48:63]
s_add_u32 s44, s44, 1
s_cmp_eq_u32 s44, 3
s_mov_b32 s56, 40960
s_cmov_b32 s56, -81920
s_cselect_b32 s44, 0, s44
v_add_u32 v64, s56, v64
s_waitcnt vmcnt(10) lgkmcnt(2)
s_barrier
ds_read_b128 v[8:11], v64 offset:0
v_mfma_f32_32x32x16_bf16 v[48:63], v[16:19], v[244:247], v[48:63]
s_waitcnt lgkmcnt(2)
ds_read_b128 v[12:15], v64 offset:1024
v_mfma_f32_32x32x16_bf16 v[48:63], v[20:23], v[248:251], v[48:63]
s_waitcnt lgkmcnt(2)
ds_read_b128 v[16:19], v64 offset:2048
v_mfma_f32_32x32x16_bf16 v[48:63], v[24:27], v[252:255], v[48:63]
s_waitcnt lgkmcnt(2)
ds_read_b128 v[20:23], v64 offset:3072
v_mfma_f32_32x32x16_bf16 v[32:47], v[8:11], v[96:99], 0
s_waitcnt lgkmcnt(2)
ds_read_b128 v[24:27], v64 offset:4096
v_mfma_f32_32x32x16_bf16 v[32:47], v[12:15], v[100:103], v[32:47]
s_waitcnt lgkmcnt(2)
ds_read_b128 v[8:11], v64 offset:5120
v_cvt_pk_bf16_f32 v48, v48, v49
v_cvt_pk_bf16_f32 v49, v50, v51
v_mfma_f32_32x32x16_bf16 v[32:47], v[16:19], v[104:107], v[32:47]
s_waitcnt lgkmcnt(2)
ds_read_b128 v[12:15], v64 offset:6144
v_cvt_pk_bf16_f32 v50, v52, v53
v_cvt_pk_bf16_f32 v51, v54, v55
v_mfma_f32_32x32x16_bf16 v[32:47], v[20:23], v[108:111], v[32:47]
s_waitcnt lgkmcnt(2)
ds_read_b128 v[16:19], v64 offset:7168
v_cvt_pk_bf16_f32 v52, v56, v57
v_cvt_pk_bf16_f32 v53, v58, v59
v_mfma_f32_32x32x16_bf16 v[32:47], v[24:27], v[112:115], v[32:47]
s_waitcnt lgkmcnt(2)
ds_read_b128 v[20:23], v64 offset:8192
v_cvt_pk_bf16_f32 v54, v60, v61
v_cvt_pk_bf16_f32 v55, v62, v63
v_mfma_f32_32x32x16_bf16 v[32:47], v[8:11], v[116:119], v[32:47]
s_waitcnt lgkmcnt(2)
ds_read_b128 v[24:27], v64 offset:9216
v_accvgpr_write_b32 a8, v48
v_accvgpr_write_b32 a9, v49
v_mfma_f32_32x32x16_bf16 v[32:47], v[12:15], v[120:123], v[32:47]
s_waitcnt lgkmcnt(2)
ds_read_b128 v[8:11], v64 offset:10240
v_accvgpr_write_b32 a10, v50
v_accvgpr_write_b32 a11, v51
v_mfma_f32_32x32x16_bf16 v[32:47], v[16:19], v[124:127], v[32:47]
s_waitcnt lgkmcnt(2)
ds_read_b128 v[12:15], v64 offset:11264
v_accvgpr_write_b32 a12, v52
v_accvgpr_write_b32 a13, v53
v_mfma_f32_32x32x16_bf16 v[32:47], v[20:23], v[128:131], v[32:47]
s_waitcnt lgkmcnt(2)
ds_read_b128 v[16:19], v64 offset:12288
v_accvgpr_write_b32 a14, v54
v_accvgpr_write_b32 a15, v55
v_mfma_f32_32x32x16_bf16 v[32:47], v[24:27], v[132:135], v[32:47]
s_waitcnt lgkmcnt(2)
ds_read_b128 v[20:23], v64 offset:13312
s_add_u32 m0, s45, 0
s_add_u32 s55, s46, 0
buffer_load_dwordx4 v0, s[4:7], s55 offen offset:0 sc1 lds
buffer_load_dwordx4 v0, s[4:7], s55 offen offset:1024 sc1 lds
v_mfma_f32_32x32x16_bf16 v[32:47], v[8:11], v[136:139], v[32:47]
s_waitcnt lgkmcnt(2)
ds_read_b128 v[24:27], v64 offset:14336
buffer_load_dwordx4 v0, s[4:7], s55 offen offset:2048 sc1 lds
buffer_load_dwordx4 v0, s[4:7], s55 offen offset:3072 sc1 lds
v_mfma_f32_32x32x16_bf16 v[32:47], v[12:15], v[140:143], v[32:47]
s_waitcnt lgkmcnt(2)
ds_read_b128 v[8:11], v64 offset:15360
s_add_u32 m0, s45, 4096
s_add_u32 s55, s46, 4096
buffer_load_dwordx4 v0, s[4:7], s55 offen offset:0 sc1 lds
buffer_load_dwordx4 v0, s[4:7], s55 offen offset:1024 sc1 lds
v_mfma_f32_32x32x16_bf16 v[32:47], v[16:19], v[144:147], v[32:47]
s_waitcnt lgkmcnt(2)
ds_read_b128 v[12:15], v64 offset:16384
buffer_load_dwordx4 v0, s[4:7], s55 offen offset:2048 sc1 lds
buffer_load_dwordx4 v0, s[4:7], s55 offen offset:3072 sc1 lds
v_mfma_f32_32x32x16_bf16 v[32:47], v[20:23], v[148:151], v[32:47]
s_waitcnt lgkmcnt(2)
ds_read_b128 v[16:19], v64 offset:17408
s_add_u32 m0, s45, 8192
s_add_u32 s55, s46, 8192
buffer_load_dwordx4 v0, s[4:7], s55 offen offset:0 sc1 lds
buffer_load_dwordx4 v0, s[4:7], s55 offen offset:1024 sc1 lds
v_mfma_f32_32x32x16_bf16 v[32:47], v[24:27], v[152:155], v[32:47]
s_waitcnt lgkmcnt(2)
ds_read_b128 v[20:23], v64 offset:18432
s_add_u32 s45, s45, 40960
s_cmp_ge_u32 s45, 122880
s_cselect_b32 s55, 122880, 0
s_sub_u32 s45, s45, s55
s_add_u32 s46, s46, 40960
v_mfma_f32_32x32x16_bf16 v[32:47], v[8:11], v[156:159], v[32:47]
s_waitcnt lgkmcnt(2)
ds_read_b128 v[24:27], v64 offset:19456
v_mfma_f32_32x32x16_bf16 v[32:47], v[12:15], v[160:163], v[32:47]
s_waitcnt lgkmcnt(2)
ds_read_b128 v[8:11], v64 offset:20480
v_mfma_f32_32x32x16_bf16 v[32:47], v[16:19], v[164:167], v[32:47]
s_waitcnt lgkmcnt(2)
ds_read_b128 v[12:15], v64 offset:21504
v_mfma_f32_32x32x16_bf16 v[32:47], v[20:23], v[168:171], v[32:47]
s_waitcnt lgkmcnt(2)
ds_read_b128 v[16:19], v64 offset:22528
v_mfma_f32_32x32x16_bf16 v[32:47], v[24:27], v[172:175], v[32:47]
s_waitcnt lgkmcnt(2)
ds_read_b128 v[20:23], v64 offset:23552
v_mfma_f32_32x32x16_bf16 v[32:47], v[8:11], v[176:179], v[32:47]
s_waitcnt lgkmcnt(2)
ds_read_b128 v[24:27], v64 offset:24576
v_mfma_f32_32x32x16_bf16 v[32:47], v[12:15], v[180:183], v[32:47]
s_waitcnt lgkmcnt(2)
ds_read_b128 v[8:11], v64 offset:25600
v_mfma_f32_32x32x16_bf16 v[32:47], v[16:19], v[184:187], v[32:47]
s_waitcnt lgkmcnt(2)
ds_read_b128 v[12:15], v64 offset:26624
v_mfma_f32_32x32x16_bf16 v[32:47], v[20:23], v[188:191], v[32:47]
s_waitcnt lgkmcnt(2)
ds_read_b128 v[16:19], v64 offset:27648
v_mfma_f32_32x32x16_bf16 v[32:47], v[24:27], v[192:195], v[32:47]
s_waitcnt lgkmcnt(2)
ds_read_b128 v[20:23], v64 offset:28672
v_mfma_f32_32x32x16_bf16 v[32:47], v[8:11], v[196:199], v[32:47]
s_waitcnt lgkmcnt(2)
ds_read_b128 v[24:27], v64 offset:29696
v_mfma_f32_32x32x16_bf16 v[32:47], v[12:15], v[200:203], v[32:47]
s_waitcnt lgkmcnt(2)
ds_read_b128 v[8:11], v64 offset:30720
v_mfma_f32_32x32x16_bf16 v[32:47], v[16:19], v[204:207], v[32:47]
s_waitcnt lgkmcnt(2)
ds_read_b128 v[12:15], v64 offset:31744
v_mfma_f32_32x32x16_bf16 v[32:47], v[20:23], v[208:211], v[32:47]
s_waitcnt lgkmcnt(2)
ds_read_b128 v[16:19], v64 offset:32768
v_mfma_f32_32x32x16_bf16 v[32:47], v[24:27], v[212:215], v[32:47]
s_waitcnt lgkmcnt(2)
ds_read_b128 v[20:23], v64 offset:33792
v_mfma_f32_32x32x16_bf16 v[32:47], v[8:11], v[216:219], v[32:47]
s_waitcnt lgkmcnt(2)
ds_read_b128 v[24:27], v64 offset:34816
v_mfma_f32_32x32x16_bf16 v[32:47], v[12:15], v[220:223], v[32:47]
s_waitcnt lgkmcnt(2)
ds_read_b128 v[8:11], v64 offset:35840
v_mfma_f32_32x32x16_bf16 v[32:47], v[16:19], v[224:227], v[32:47]
s_waitcnt lgkmcnt(2)
ds_read_b128 v[12:15], v64 offset:36864
v_mfma_f32_32x32x16_bf16 v[32:47], v[20:23], v[228:231], v[32:47]
s_waitcnt lgkmcnt(2)
ds_read_b128 v[16:19], v64 offset:37888
v_mfma_f32_32x32x16_bf16 v[32:47], v[24:27], v[232:235], v[32:47]
s_waitcnt lgkmcnt(2)
ds_read_b128 v[20:23], v64 offset:38912
v_mfma_f32_32x32x16_bf16 v[32:47], v[8:11], v[236:239], v[32:47]
s_waitcnt lgkmcnt(2)
ds_read_b128 v[24:27], v64 offset:39936
v_mfma_f32_32x32x16_bf16 v[32:47], v[12:15], v[240:243], v[32:47]
s_add_u32 s44, s44, 1
s_cmp_eq_u32 s44, 3
s_mov_b32 s56, 40960
s_cmov_b32 s56, -81920
s_cselect_b32 s44, 0, s44
v_add_u32 v64, s56, v64
s_waitcnt vmcnt(10) lgkmcnt(2)
s_barrier
ds_read_b128 v[8:11], v64 offset:0
v_mfma_f32_32x32x16_bf16 v[32:47], v[16:19], v[244:247], v[32:47]
s_waitcnt lgkmcnt(2)
ds_read_b128 v[12:15], v64 offset:1024
v_mfma_f32_32x32x16_bf16 v[32:47], v[20:23], v[248:251], v[32:47]
s_waitcnt lgkmcnt(2)
ds_read_b128 v[16:19], v64 offset:2048
v_mfma_f32_32x32x16_bf16 v[32:47], v[24:27], v[252:255], v[32:47]
s_waitcnt lgkmcnt(2)
ds_read_b128 v[20:23], v64 offset:3072
v_mfma_f32_32x32x16_bf16 v[48:63], v[8:11], v[96:99], 0
s_waitcnt lgkmcnt(2)
ds_read_b128 v[24:27], v64 offset:4096
v_mfma_f32_32x32x16_bf16 v[48:63], v[12:15], v[100:103], v[48:63]
s_waitcnt lgkmcnt(2)
ds_read_b128 v[8:11], v64 offset:5120
v_cvt_pk_bf16_f32 v32, v32, v33
v_cvt_pk_bf16_f32 v33, v34, v35
v_mfma_f32_32x32x16_bf16 v[48:63], v[16:19], v[104:107], v[48:63]
s_waitcnt lgkmcnt(2)
ds_read_b128 v[12:15], v64 offset:6144
v_cvt_pk_bf16_f32 v34, v36, v37
v_cvt_pk_bf16_f32 v35, v38, v39
v_mfma_f32_32x32x16_bf16 v[48:63], v[20:23], v[108:111], v[48:63]
s_waitcnt lgkmcnt(2)
ds_read_b128 v[16:19], v64 offset:7168
v_cvt_pk_bf16_f32 v36, v40, v41
v_cvt_pk_bf16_f32 v37, v42, v43
v_mfma_f32_32x32x16_bf16 v[48:63], v[24:27], v[112:115], v[48:63]
s_waitcnt lgkmcnt(2)
ds_read_b128 v[20:23], v64 offset:8192
v_cvt_pk_bf16_f32 v38, v44, v45
v_cvt_pk_bf16_f32 v39, v46, v47
v_mfma_f32_32x32x16_bf16 v[48:63], v[8:11], v[116:119], v[48:63]
s_waitcnt lgkmcnt(2)
ds_read_b128 v[24:27], v64 offset:9216
v_accvgpr_write_b32 a16, v32
v_accvgpr_write_b32 a17, v33
v_mfma_f32_32x32x16_bf16 v[48:63], v[12:15], v[120:123], v[48:63]
s_waitcnt lgkmcnt(2)
ds_read_b128 v[8:11], v64 offset:10240
v_accvgpr_write_b32 a18, v34
v_accvgpr_write_b32 a19, v35
v_mfma_f32_32x32x16_bf16 v[48:63], v[16:19], v[124:127], v[48:63]
s_waitcnt lgkmcnt(2)
ds_read_b128 v[12:15], v64 offset:11264
v_accvgpr_write_b32 a20, v36
v_accvgpr_write_b32 a21, v37
v_mfma_f32_32x32x16_bf16 v[48:63], v[20:23], v[128:131], v[48:63]
s_waitcnt lgkmcnt(2)
ds_read_b128 v[16:19], v64 offset:12288
v_accvgpr_write_b32 a22, v38
v_accvgpr_write_b32 a23, v39
v_mfma_f32_32x32x16_bf16 v[48:63], v[24:27], v[132:135], v[48:63]
s_waitcnt lgkmcnt(2)
ds_read_b128 v[20:23], v64 offset:13312
s_add_u32 m0, s45, 0
s_add_u32 s55, s46, 0
buffer_load_dwordx4 v0, s[4:7], s55 offen offset:0 sc1 lds
buffer_load_dwordx4 v0, s[4:7], s55 offen offset:1024 sc1 lds
v_mfma_f32_32x32x16_bf16 v[48:63], v[8:11], v[136:139], v[48:63]
s_waitcnt lgkmcnt(2)
ds_read_b128 v[24:27], v64 offset:14336
buffer_load_dwordx4 v0, s[4:7], s55 offen offset:2048 sc1 lds
buffer_load_dwordx4 v0, s[4:7], s55 offen offset:3072 sc1 lds
v_mfma_f32_32x32x16_bf16 v[48:63], v[12:15], v[140:143], v[48:63]
s_waitcnt lgkmcnt(2)
ds_read_b128 v[8:11], v64 offset:15360
s_add_u32 m0, s45, 4096
s_add_u32 s55, s46, 4096
buffer_load_dwordx4 v0, s[4:7], s55 offen offset:0 sc1 lds
buffer_load_dwordx4 v0, s[4:7], s55 offen offset:1024 sc1 lds
v_mfma_f32_32x32x16_bf16 v[48:63], v[16:19], v[144:147], v[48:63]
s_waitcnt lgkmcnt(2)
ds_read_b128 v[12:15], v64 offset:16384
buffer_load_dwordx4 v0, s[4:7], s55 offen offset:2048 sc1 lds
buffer_load_dwordx4 v0, s[4:7], s55 offen offset:3072 sc1 lds
v_mfma_f32_32x32x16_bf16 v[48:63], v[20:23], v[148:151], v[48:63]
s_waitcnt lgkmcnt(2)
ds_read_b128 v[16:19], v64 offset:17408
s_add_u32 m0, s45, 8192
s_add_u32 s55, s46, 8192
buffer_load_dwordx4 v0, s[4:7], s55 offen offset:0 sc1 lds
buffer_load_dwordx4 v0, s[4:7], s55 offen offset:1024 sc1 lds
v_mfma_f32_32x32x16_bf16 v[48:63], v[24:27], v[152:155], v[48:63]
s_waitcnt lgkmcnt(2)
ds_read_b128 v[20:23], v64 offset:18432
s_add_u32 s45, s45, 40960
s_cmp_ge_u32 s45, 122880
s_cselect_b32 s55, 122880, 0
s_sub_u32 s45, s45, s55
s_add_u32 s46, s46, 40960
v_mfma_f32_32x32x16_bf16 v[48:63], v[8:11], v[156:159], v[48:63]
s_waitcnt lgkmcnt(2)
ds_read_b128 v[24:27], v64 offset:19456
v_mfma_f32_32x32x16_bf16 v[48:63], v[12:15], v[160:163], v[48:63]
s_waitcnt lgkmcnt(2)
ds_read_b128 v[8:11], v64 offset:20480
v_mfma_f32_32x32x16_bf16 v[48:63], v[16:19], v[164:167], v[48:63]
s_waitcnt lgkmcnt(2)
ds_read_b128 v[12:15], v64 offset:21504
v_mfma_f32_32x32x16_bf16 v[48:63], v[20:23], v[168:171], v[48:63]
s_waitcnt lgkmcnt(2)
ds_read_b128 v[16:19], v64 offset:22528
v_mfma_f32_32x32x16_bf16 v[48:63], v[24:27], v[172:175], v[48:63]
s_waitcnt lgkmcnt(2)
ds_read_b128 v[20:23], v64 offset:23552
v_mfma_f32_32x32x16_bf16 v[48:63], v[8:11], v[176:179], v[48:63]
s_waitcnt lgkmcnt(2)
ds_read_b128 v[24:27], v64 offset:24576
v_mfma_f32_32x32x16_bf16 v[48:63], v[12:15], v[180:183], v[48:63]
s_waitcnt lgkmcnt(2)
ds_read_b128 v[8:11], v64 offset:25600
v_mfma_f32_32x32x16_bf16 v[48:63], v[16:19], v[184:187], v[48:63]
s_waitcnt lgkmcnt(2)
ds_read_b128 v[12:15], v64 offset:26624
v_mfma_f32_32x32x16_bf16 v[48:63], v[20:23], v[188:191], v[48:63]
s_waitcnt lgkmcnt(2)
ds_read_b128 v[16:19], v64 offset:27648
v_mfma_f32_32x32x16_bf16 v[48:63], v[24:27], v[192:195], v[48:63]
s_waitcnt lgkmcnt(2)
ds_read_b128 v[20:23], v64 offset:28672
v_mfma_f32_32x32x16_bf16 v[48:63], v[8:11], v[196:199], v[48:63]
s_waitcnt lgkmcnt(2)
ds_read_b128 v[24:27], v64 offset:29696
v_mfma_f32_32x32x16_bf16 v[48:63], v[12:15], v[200:203], v[48:63]
s_waitcnt lgkmcnt(2)
ds_read_b128 v[8:11], v64 offset:30720
v_mfma_f32_32x32x16_bf16 v[48:63], v[16:19], v[204:207], v[48:63]
s_waitcnt lgkmcnt(2)
ds_read_b128 v[12:15], v64 offset:31744
v_mfma_f32_32x32x16_bf16 v[48:63], v[20:23], v[208:211], v[48:63]
s_waitcnt lgkmcnt(2)
ds_read_b128 v[16:19], v64 offset:32768
v_mfma_f32_32x32x16_bf16 v[48:63], v[24:27], v[212:215], v[48:63]
s_waitcnt lgkmcnt(2)
ds_read_b128 v[20:23], v64 offset:33792
v_mfma_f32_32x32x16_bf16 v[48:63], v[8:11], v[216:219], v[48:63]
s_waitcnt lgkmcnt(2)
ds_read_b128 v[24:27], v64 offset:34816
v_mfma_f32_32x32x16_bf16 v[48:63], v[12:15], v[220:223], v[48:63]
s_waitcnt lgkmcnt(2)
ds_read_b128 v[8:11], v64 offset:35840
v_mfma_f32_32x32x16_bf16 v[48:63], v[16:19], v[224:227], v[48:63]
s_waitcnt lgkmcnt(2)
ds_read_b128 v[12:15], v64 offset:36864
v_mfma_f32_32x32x16_bf16 v[48:63], v[20:23], v[228:231], v[48:63]
s_waitcnt lgkmcnt(2)
ds_read_b128 v[16:19], v64 offset:37888
v_mfma_f32_32x32x16_bf16 v[48:63], v[24:27], v[232:235], v[48:63]
s_waitcnt lgkmcnt(2)
ds_read_b128 v[20:23], v64 offset:38912
v_mfma_f32_32x32x16_bf16 v[48:63], v[8:11], v[236:239], v[48:63]
s_waitcnt lgkmcnt(2)
ds_read_b128 v[24:27], v64 offset:39936
v_mfma_f32_32x32x16_bf16 v[48:63], v[12:15], v[240:243], v[48:63]
s_add_u32 s44, s44, 1
s_cmp_eq_u32 s44, 3
s_mov_b32 s56, 40960
s_cmov_b32 s56, -81920
s_cselect_b32 s44, 0, s44
v_add_u32 v64, s56, v64
s_waitcnt vmcnt(10) lgkmcnt(2)
s_barrier
ds_read_b128 v[8:11], v64 offset:0
v_mfma_f32_32x32x16_bf16 v[48:63], v[16:19], v[244:247], v[48:63]
s_waitcnt lgkmcnt(2)
ds_read_b128 v[12:15], v64 offset:1024
v_mfma_f32_32x32x16_bf16 v[48:63], v[20:23], v[248:251], v[48:63]
s_waitcnt lgkmcnt(2)
ds_read_b128 v[16:19], v64 offset:2048
v_mfma_f32_32x32x16_bf16 v[48:63], v[24:27], v[252:255], v[48:63]
s_waitcnt lgkmcnt(2)
ds_read_b128 v[20:23], v64 offset:3072
v_mfma_f32_32x32x16_bf16 v[32:47], v[8:11], v[96:99], 0
s_waitcnt lgkmcnt(2)
ds_read_b128 v[24:27], v64 offset:4096
v_mfma_f32_32x32x16_bf16 v[32:47], v[12:15], v[100:103], v[32:47]
s_waitcnt lgkmcnt(2)
ds_read_b128 v[8:11], v64 offset:5120
v_cvt_pk_bf16_f32 v48, v48, v49
v_cvt_pk_bf16_f32 v49, v50, v51
v_mfma_f32_32x32x16_bf16 v[32:47], v[16:19], v[104:107], v[32:47]
s_waitcnt lgkmcnt(2)
ds_read_b128 v[12:15], v64 offset:6144
v_cvt_pk_bf16_f32 v50, v52, v53
v_cvt_pk_bf16_f32 v51, v54, v55
v_mfma_f32_32x32x16_bf16 v[32:47], v[20:23], v[108:111], v[32:47]
s_waitcnt lgkmcnt(2)
ds_read_b128 v[16:19], v64 offset:7168
v_cvt_pk_bf16_f32 v52, v56, v57
v_cvt_pk_bf16_f32 v53, v58, v59
v_mfma_f32_32x32x16_bf16 v[32:47], v[24:27], v[112:115], v[32:47]
s_waitcnt lgkmcnt(2)
ds_read_b128 v[20:23], v64 offset:8192
v_cvt_pk_bf16_f32 v54, v60, v61
v_cvt_pk_bf16_f32 v55, v62, v63
v_mfma_f32_32x32x16_bf16 v[32:47], v[8:11], v[116:119], v[32:47]
s_waitcnt lgkmcnt(2)
ds_read_b128 v[24:27], v64 offset:9216
v_accvgpr_write_b32 a24, v48
v_accvgpr_write_b32 a25, v49
v_mfma_f32_32x32x16_bf16 v[32:47], v[12:15], v[120:123], v[32:47]
s_waitcnt lgkmcnt(2)
ds_read_b128 v[8:11], v64 offset:10240
v_accvgpr_write_b32 a26, v50
v_accvgpr_write_b32 a27, v51
v_mfma_f32_32x32x16_bf16 v[32:47], v[16:19], v[124:127], v[32:47]
s_waitcnt lgkmcnt(2)
ds_read_b128 v[12:15], v64 offset:11264
v_accvgpr_write_b32 a28, v52
v_accvgpr_write_b32 a29, v53
v_mfma_f32_32x32x16_bf16 v[32:47], v[20:23], v[128:131], v[32:47]
s_waitcnt lgkmcnt(2)
ds_read_b128 v[16:19], v64 offset:12288
v_accvgpr_write_b32 a30, v54
v_accvgpr_write_b32 a31, v55
v_mfma_f32_32x32x16_bf16 v[32:47], v[24:27], v[132:135], v[32:47]
s_waitcnt lgkmcnt(2)
ds_read_b128 v[20:23], v64 offset:13312
s_add_u32 m0, s45, 0
s_add_u32 s55, s46, 0
buffer_load_dwordx4 v0, s[4:7], s55 offen offset:0 sc1 lds
buffer_load_dwordx4 v0, s[4:7], s55 offen offset:1024 sc1 lds
v_mfma_f32_32x32x16_bf16 v[32:47], v[8:11], v[136:139], v[32:47]
s_waitcnt lgkmcnt(2)
ds_read_b128 v[24:27], v64 offset:14336
buffer_load_dwordx4 v0, s[4:7], s55 offen offset:2048 sc1 lds
buffer_load_dwordx4 v0, s[4:7], s55 offen offset:3072 sc1 lds
v_mfma_f32_32x32x16_bf16 v[32:47], v[12:15], v[140:143], v[32:47]
s_waitcnt lgkmcnt(2)
ds_read_b128 v[8:11], v64 offset:15360
s_add_u32 m0, s45, 4096
s_add_u32 s55, s46, 4096
buffer_load_dwordx4 v0, s[4:7], s55 offen offset:0 sc1 lds
buffer_load_dwordx4 v0, s[4:7], s55 offen offset:1024 sc1 lds
v_mfma_f32_32x32x16_bf16 v[32:47], v[16:19], v[144:147], v[32:47]
s_waitcnt lgkmcnt(2)
ds_read_b128 v[12:15], v64 offset:16384
buffer_load_dwordx4 v0, s[4:7], s55 offen offset:2048 sc1 lds
buffer_load_dwordx4 v0, s[4:7], s55 offen offset:3072 sc1 lds
v_mfma_f32_32x32x16_bf16 v[32:47], v[20:23], v[148:151], v[32:47]
s_waitcnt lgkmcnt(2)
ds_read_b128 v[16:19], v64 offset:17408
s_add_u32 m0, s45, 8192
s_add_u32 s55, s46, 8192
buffer_load_dwordx4 v0, s[4:7], s55 offen offset:0 sc1 lds
buffer_load_dwordx4 v0, s[4:7], s55 offen offset:1024 sc1 lds
v_mfma_f32_32x32x16_bf16 v[32:47], v[24:27], v[152:155], v[32:47]
s_waitcnt lgkmcnt(2)
ds_read_b128 v[20:23], v64 offset:18432
s_add_u32 s45, s45, 40960
s_cmp_ge_u32 s45, 122880
s_cselect_b32 s55, 122880, 0
s_sub_u32 s45, s45, s55
s_add_u32 s46, s46, 40960
v_mfma_f32_32x32x16_bf16 v[32:47], v[8:11], v[156:159], v[32:47]
s_waitcnt lgkmcnt(2)
ds_read_b128 v[24:27], v64 offset:19456
v_mfma_f32_32x32x16_bf16 v[32:47], v[12:15], v[160:163], v[32:47]
s_waitcnt lgkmcnt(2)
ds_read_b128 v[8:11], v64 offset:20480
v_mfma_f32_32x32x16_bf16 v[32:47], v[16:19], v[164:167], v[32:47]
s_waitcnt lgkmcnt(2)
ds_read_b128 v[12:15], v64 offset:21504
v_mfma_f32_32x32x16_bf16 v[32:47], v[20:23], v[168:171], v[32:47]
s_waitcnt lgkmcnt(2)
ds_read_b128 v[16:19], v64 offset:22528
v_mfma_f32_32x32x16_bf16 v[32:47], v[24:27], v[172:175], v[32:47]
s_waitcnt lgkmcnt(2)
ds_read_b128 v[20:23], v64 offset:23552
v_mfma_f32_32x32x16_bf16 v[32:47], v[8:11], v[176:179], v[32:47]
s_waitcnt lgkmcnt(2)
ds_read_b128 v[24:27], v64 offset:24576
v_mfma_f32_32x32x16_bf16 v[32:47], v[12:15], v[180:183], v[32:47]
s_waitcnt lgkmcnt(2)
ds_read_b128 v[8:11], v64 offset:25600
v_mfma_f32_32x32x16_bf16 v[32:47], v[16:19], v[184:187], v[32:47]
s_waitcnt lgkmcnt(2)
ds_read_b128 v[12:15], v64 offset:26624
v_mfma_f32_32x32x16_bf16 v[32:47], v[20:23], v[188:191], v[32:47]
s_waitcnt lgkmcnt(2)
ds_read_b128 v[16:19], v64 offset:27648
v_mfma_f32_32x32x16_bf16 v[32:47], v[24:27], v[192:195], v[32:47]
s_waitcnt lgkmcnt(2)
ds_read_b128 v[20:23], v64 offset:28672
v_mfma_f32_32x32x16_bf16 v[32:47], v[8:11], v[196:199], v[32:47]
s_waitcnt lgkmcnt(2)
ds_read_b128 v[24:27], v64 offset:29696
v_mfma_f32_32x32x16_bf16 v[32:47], v[12:15], v[200:203], v[32:47]
s_waitcnt lgkmcnt(2)
ds_read_b128 v[8:11], v64 offset:30720
v_mfma_f32_32x32x16_bf16 v[32:47], v[16:19], v[204:207], v[32:47]
s_waitcnt lgkmcnt(2)
ds_read_b128 v[12:15], v64 offset:31744
v_mfma_f32_32x32x16_bf16 v[32:47], v[20:23], v[208:211], v[32:47]
s_waitcnt lgkmcnt(2)
ds_read_b128 v[16:19], v64 offset:32768
v_mfma_f32_32x32x16_bf16 v[32:47], v[24:27], v[212:215], v[32:47]
s_waitcnt lgkmcnt(2)
ds_read_b128 v[20:23], v64 offset:33792
v_mfma_f32_32x32x16_bf16 v[32:47], v[8:11], v[216:219], v[32:47]
s_waitcnt lgkmcnt(2)
ds_read_b128 v[24:27], v64 offset:34816
v_mfma_f32_32x32x16_bf16 v[32:47], v[12:15], v[220:223], v[32:47]
s_waitcnt lgkmcnt(2)
ds_read_b128 v[8:11], v64 offset:35840
v_mfma_f32_32x32x16_bf16 v[32:47], v[16:19], v[224:227], v[32:47]
s_waitcnt lgkmcnt(2)
ds_read_b128 v[12:15], v64 offset:36864
v_mfma_f32_32x32x16_bf16 v[32:47], v[20:23], v[228:231], v[32:47]
s_waitcnt lgkmcnt(2)
ds_read_b128 v[16:19], v64 offset:37888
v_mfma_f32_32x32x16_bf16 v[32:47], v[24:27], v[232:235], v[32:47]
s_waitcnt lgkmcnt(2)
ds_read_b128 v[20:23], v64 offset:38912
v_mfma_f32_32x32x16_bf16 v[32:47], v[8:11], v[236:239], v[32:47]
s_waitcnt lgkmcnt(2)
ds_read_b128 v[24:27], v64 offset:39936
v_mfma_f32_32x32x16_bf16 v[32:47], v[12:15], v[240:243], v[32:47]
s_add_u32 s44, s44, 1
s_cmp_eq_u32 s44, 3
s_mov_b32 s56, 40960
s_cmov_b32 s56, -81920
s_cselect_b32 s44, 0, s44
v_add_u32 v64, s56, v64
s_waitcnt vmcnt(10) lgkmcnt(2)
s_barrier
ds_read_b128 v[8:11], v64 offset:0
v_mfma_f32_32x32x16_bf16 v[32:47], v[16:19], v[244:247], v[32:47]
s_waitcnt lgkmcnt(2)
ds_read_b128 v[12:15], v64 offset:1024
v_mfma_f32_32x32x16_bf16 v[32:47], v[20:23], v[248:251], v[32:47]
s_waitcnt lgkmcnt(2)
ds_read_b128 v[16:19], v64 offset:2048
v_mfma_f32_32x32x16_bf16 v[32:47], v[24:27], v[252:255], v[32:47]
s_waitcnt lgkmcnt(2)
ds_read_b128 v[20:23], v64 offset:3072
v_mfma_f32_32x32x16_bf16 v[48:63], v[8:11], v[96:99], 0
s_waitcnt lgkmcnt(2)
ds_read_b128 v[24:27], v64 offset:4096
v_mfma_f32_32x32x16_bf16 v[48:63], v[12:15], v[100:103], v[48:63]
s_waitcnt lgkmcnt(2)
ds_read_b128 v[8:11], v64 offset:5120
v_cvt_pk_bf16_f32 v32, v32, v33
v_cvt_pk_bf16_f32 v33, v34, v35
v_mfma_f32_32x32x16_bf16 v[48:63], v[16:19], v[104:107], v[48:63]
s_waitcnt lgkmcnt(2)
ds_read_b128 v[12:15], v64 offset:6144
v_cvt_pk_bf16_f32 v34, v36, v37
v_cvt_pk_bf16_f32 v35, v38, v39
v_mfma_f32_32x32x16_bf16 v[48:63], v[20:23], v[108:111], v[48:63]
s_waitcnt lgkmcnt(2)
ds_read_b128 v[16:19], v64 offset:7168
v_cvt_pk_bf16_f32 v36, v40, v41
v_cvt_pk_bf16_f32 v37, v42, v43
v_mfma_f32_32x32x16_bf16 v[48:63], v[24:27], v[112:115], v[48:63]
s_waitcnt lgkmcnt(2)
ds_read_b128 v[20:23], v64 offset:8192
v_cvt_pk_bf16_f32 v38, v44, v45
v_cvt_pk_bf16_f32 v39, v46, v47
v_mfma_f32_32x32x16_bf16 v[48:63], v[8:11], v[116:119], v[48:63]
s_waitcnt lgkmcnt(2)
ds_read_b128 v[24:27], v64 offset:9216
v_accvgpr_write_b32 a32, v32
v_accvgpr_write_b32 a33, v33
v_mfma_f32_32x32x16_bf16 v[48:63], v[12:15], v[120:123], v[48:63]
s_waitcnt lgkmcnt(2)
ds_read_b128 v[8:11], v64 offset:10240
v_accvgpr_write_b32 a34, v34
v_accvgpr_write_b32 a35, v35
v_mfma_f32_32x32x16_bf16 v[48:63], v[16:19], v[124:127], v[48:63]
s_waitcnt lgkmcnt(2)
ds_read_b128 v[12:15], v64 offset:11264
v_accvgpr_write_b32 a36, v36
v_accvgpr_write_b32 a37, v37
v_mfma_f32_32x32x16_bf16 v[48:63], v[20:23], v[128:131], v[48:63]
s_waitcnt lgkmcnt(2)
ds_read_b128 v[16:19], v64 offset:12288
v_accvgpr_write_b32 a38, v38
v_accvgpr_write_b32 a39, v39
v_mfma_f32_32x32x16_bf16 v[48:63], v[24:27], v[132:135], v[48:63]
s_waitcnt lgkmcnt(2)
ds_read_b128 v[20:23], v64 offset:13312
s_add_u32 m0, s45, 0
s_add_u32 s55, s46, 0
buffer_load_dwordx4 v0, s[4:7], s55 offen offset:0 sc1 lds
buffer_load_dwordx4 v0, s[4:7], s55 offen offset:1024 sc1 lds
v_mfma_f32_32x32x16_bf16 v[48:63], v[8:11], v[136:139], v[48:63]
s_waitcnt lgkmcnt(2)
ds_read_b128 v[24:27], v64 offset:14336
buffer_load_dwordx4 v0, s[4:7], s55 offen offset:2048 sc1 lds
buffer_load_dwordx4 v0, s[4:7], s55 offen offset:3072 sc1 lds
v_mfma_f32_32x32x16_bf16 v[48:63], v[12:15], v[140:143], v[48:63]
s_waitcnt lgkmcnt(2)
ds_read_b128 v[8:11], v64 offset:15360
s_add_u32 m0, s45, 4096
s_add_u32 s55, s46, 4096
buffer_load_dwordx4 v0, s[4:7], s55 offen offset:0 sc1 lds
buffer_load_dwordx4 v0, s[4:7], s55 offen offset:1024 sc1 lds
v_mfma_f32_32x32x16_bf16 v[48:63], v[16:19], v[144:147], v[48:63]
s_waitcnt lgkmcnt(2)
ds_read_b128 v[12:15], v64 offset:16384
buffer_load_dwordx4 v0, s[4:7], s55 offen offset:2048 sc1 lds
buffer_load_dwordx4 v0, s[4:7], s55 offen offset:3072 sc1 lds
v_mfma_f32_32x32x16_bf16 v[48:63], v[20:23], v[148:151], v[48:63]
s_waitcnt lgkmcnt(2)
ds_read_b128 v[16:19], v64 offset:17408
s_add_u32 m0, s45, 8192
s_add_u32 s55, s46, 8192
buffer_load_dwordx4 v0, s[4:7], s55 offen offset:0 sc1 lds
buffer_load_dwordx4 v0, s[4:7], s55 offen offset:1024 sc1 lds
v_mfma_f32_32x32x16_bf16 v[48:63], v[24:27], v[152:155], v[48:63]
s_waitcnt lgkmcnt(2)
ds_read_b128 v[20:23], v64 offset:18432
s_add_u32 s45, s45, 40960
s_cmp_ge_u32 s45, 122880
s_cselect_b32 s55, 122880, 0
s_sub_u32 s45, s45, s55
s_add_u32 s46, s46, 40960
v_mfma_f32_32x32x16_bf16 v[48:63], v[8:11], v[156:159], v[48:63]
s_waitcnt lgkmcnt(2)
ds_read_b128 v[24:27], v64 offset:19456
v_mfma_f32_32x32x16_bf16 v[48:63], v[12:15], v[160:163], v[48:63]
s_waitcnt lgkmcnt(2)
ds_read_b128 v[8:11], v64 offset:20480
v_mfma_f32_32x32x16_bf16 v[48:63], v[16:19], v[164:167], v[48:63]
s_waitcnt lgkmcnt(2)
ds_read_b128 v[12:15], v64 offset:21504
v_mfma_f32_32x32x16_bf16 v[48:63], v[20:23], v[168:171], v[48:63]
s_waitcnt lgkmcnt(2)
ds_read_b128 v[16:19], v64 offset:22528
v_mfma_f32_32x32x16_bf16 v[48:63], v[24:27], v[172:175], v[48:63]
s_waitcnt lgkmcnt(2)
ds_read_b128 v[20:23], v64 offset:23552
v_mfma_f32_32x32x16_bf16 v[48:63], v[8:11], v[176:179], v[48:63]
s_waitcnt lgkmcnt(2)
ds_read_b128 v[24:27], v64 offset:24576
v_mfma_f32_32x32x16_bf16 v[48:63], v[12:15], v[180:183], v[48:63]
s_waitcnt lgkmcnt(2)
ds_read_b128 v[8:11], v64 offset:25600
v_mfma_f32_32x32x16_bf16 v[48:63], v[16:19], v[184:187], v[48:63]
s_waitcnt lgkmcnt(2)
ds_read_b128 v[12:15], v64 offset:26624
v_mfma_f32_32x32x16_bf16 v[48:63], v[20:23], v[188:191], v[48:63]
s_waitcnt lgkmcnt(2)
ds_read_b128 v[16:19], v64 offset:27648
v_mfma_f32_32x32x16_bf16 v[48:63], v[24:27], v[192:195], v[48:63]
s_waitcnt lgkmcnt(2)
ds_read_b128 v[20:23], v64 offset:28672
v_mfma_f32_32x32x16_bf16 v[48:63], v[8:11], v[196:199], v[48:63]
s_waitcnt lgkmcnt(2)
ds_read_b128 v[24:27], v64 offset:29696
v_mfma_f32_32x32x16_bf16 v[48:63], v[12:15], v[200:203], v[48:63]
s_waitcnt lgkmcnt(2)
ds_read_b128 v[8:11], v64 offset:30720
v_mfma_f32_32x32x16_bf16 v[48:63], v[16:19], v[204:207], v[48:63]
s_waitcnt lgkmcnt(2)
ds_read_b128 v[12:15], v64 offset:31744
v_mfma_f32_32x32x16_bf16 v[48:63], v[20:23], v[208:211], v[48:63]
s_waitcnt lgkmcnt(2)
ds_read_b128 v[16:19], v64 offset:32768
v_mfma_f32_32x32x16_bf16 v[48:63], v[24:27], v[212:215], v[48:63]
s_waitcnt lgkmcnt(2)
ds_read_b128 v[20:23], v64 offset:33792
v_mfma_f32_32x32x16_bf16 v[48:63], v[8:11], v[216:219], v[48:63]
s_waitcnt lgkmcnt(2)
ds_read_b128 v[24:27], v64 offset:34816
v_mfma_f32_32x32x16_bf16 v[48:63], v[12:15], v[220:223], v[48:63]
s_waitcnt lgkmcnt(2)
ds_read_b128 v[8:11], v64 offset:35840
v_mfma_f32_32x32x16_bf16 v[48:63], v[16:19], v[224:227], v[48:63]
s_waitcnt lgkmcnt(2)
ds_read_b128 v[12:15], v64 offset:36864
v_mfma_f32_32x32x16_bf16 v[48:63], v[20:23], v[228:231], v[48:63]
s_waitcnt lgkmcnt(2)
ds_read_b128 v[16:19], v64 offset:37888
v_mfma_f32_32x32x16_bf16 v[48:63], v[24:27], v[232:235], v[48:63]
s_waitcnt lgkmcnt(2)
ds_read_b128 v[20:23], v64 offset:38912
v_mfma_f32_32x32x16_bf16 v[48:63], v[8:11], v[236:239], v[48:63]
s_waitcnt lgkmcnt(2)
ds_read_b128 v[24:27], v64 offset:39936
v_mfma_f32_32x32x16_bf16 v[48:63], v[12:15], v[240:243], v[48:63]
s_add_u32 s44, s44, 1
s_cmp_eq_u32 s44, 3
s_mov_b32 s56, 40960
s_cmov_b32 s56, -81920
s_cselect_b32 s44, 0, s44
v_add_u32 v64, s56, v64
s_waitcnt vmcnt(10) lgkmcnt(2)
s_barrier
ds_read_b128 v[8:11], v64 offset:0
v_mfma_f32_32x32x16_bf16 v[48:63], v[16:19], v[244:247], v[48:63]
s_waitcnt lgkmcnt(2)
ds_read_b128 v[12:15], v64 offset:1024
v_mfma_f32_32x32x16_bf16 v[48:63], v[20:23], v[248:251], v[48:63]
s_waitcnt lgkmcnt(2)
ds_read_b128 v[16:19], v64 offset:2048
v_mfma_f32_32x32x16_bf16 v[48:63], v[24:27], v[252:255], v[48:63]
s_waitcnt lgkmcnt(2)
ds_read_b128 v[20:23], v64 offset:3072
v_mfma_f32_32x32x16_bf16 v[32:47], v[8:11], v[96:99], 0
s_waitcnt lgkmcnt(2)
ds_read_b128 v[24:27], v64 offset:4096
v_mfma_f32_32x32x16_bf16 v[32:47], v[12:15], v[100:103], v[32:47]
s_waitcnt lgkmcnt(2)
ds_read_b128 v[8:11], v64 offset:5120
v_cvt_pk_bf16_f32 v48, v48, v49
v_cvt_pk_bf16_f32 v49, v50, v51
v_mfma_f32_32x32x16_bf16 v[32:47], v[16:19], v[104:107], v[32:47]
s_waitcnt lgkmcnt(2)
ds_read_b128 v[12:15], v64 offset:6144
v_cvt_pk_bf16_f32 v50, v52, v53
v_cvt_pk_bf16_f32 v51, v54, v55
v_mfma_f32_32x32x16_bf16 v[32:47], v[20:23], v[108:111], v[32:47]
s_waitcnt lgkmcnt(2)
ds_read_b128 v[16:19], v64 offset:7168
v_cvt_pk_bf16_f32 v52, v56, v57
v_cvt_pk_bf16_f32 v53, v58, v59
v_mfma_f32_32x32x16_bf16 v[32:47], v[24:27], v[112:115], v[32:47]
s_waitcnt lgkmcnt(2)
ds_read_b128 v[20:23], v64 offset:8192
v_cvt_pk_bf16_f32 v54, v60, v61
v_cvt_pk_bf16_f32 v55, v62, v63
v_mfma_f32_32x32x16_bf16 v[32:47], v[8:11], v[116:119], v[32:47]
s_waitcnt lgkmcnt(2)
ds_read_b128 v[24:27], v64 offset:9216
v_accvgpr_write_b32 a40, v48
v_accvgpr_write_b32 a41, v49
v_mfma_f32_32x32x16_bf16 v[32:47], v[12:15], v[120:123], v[32:47]
s_waitcnt lgkmcnt(2)
ds_read_b128 v[8:11], v64 offset:10240
v_accvgpr_write_b32 a42, v50
v_accvgpr_write_b32 a43, v51
v_mfma_f32_32x32x16_bf16 v[32:47], v[16:19], v[124:127], v[32:47]
s_waitcnt lgkmcnt(2)
ds_read_b128 v[12:15], v64 offset:11264
v_accvgpr_write_b32 a44, v52
v_accvgpr_write_b32 a45, v53
v_mfma_f32_32x32x16_bf16 v[32:47], v[20:23], v[128:131], v[32:47]
s_waitcnt lgkmcnt(2)
ds_read_b128 v[16:19], v64 offset:12288
v_accvgpr_write_b32 a46, v54
v_accvgpr_write_b32 a47, v55
v_mfma_f32_32x32x16_bf16 v[32:47], v[24:27], v[132:135], v[32:47]
s_waitcnt lgkmcnt(2)
ds_read_b128 v[20:23], v64 offset:13312
s_add_u32 m0, s45, 0
s_add_u32 s55, s46, 0
buffer_load_dwordx4 v0, s[4:7], s55 offen offset:0 sc1 lds
buffer_load_dwordx4 v0, s[4:7], s55 offen offset:1024 sc1 lds
v_mfma_f32_32x32x16_bf16 v[32:47], v[8:11], v[136:139], v[32:47]
s_waitcnt lgkmcnt(2)
ds_read_b128 v[24:27], v64 offset:14336
buffer_load_dwordx4 v0, s[4:7], s55 offen offset:2048 sc1 lds
buffer_load_dwordx4 v0, s[4:7], s55 offen offset:3072 sc1 lds
v_mfma_f32_32x32x16_bf16 v[32:47], v[12:15], v[140:143], v[32:47]
s_waitcnt lgkmcnt(2)
ds_read_b128 v[8:11], v64 offset:15360
s_add_u32 m0, s45, 4096
s_add_u32 s55, s46, 4096
buffer_load_dwordx4 v0, s[4:7], s55 offen offset:0 sc1 lds
buffer_load_dwordx4 v0, s[4:7], s55 offen offset:1024 sc1 lds
v_mfma_f32_32x32x16_bf16 v[32:47], v[16:19], v[144:147], v[32:47]
s_waitcnt lgkmcnt(2)
ds_read_b128 v[12:15], v64 offset:16384
buffer_load_dwordx4 v0, s[4:7], s55 offen offset:2048 sc1 lds
buffer_load_dwordx4 v0, s[4:7], s55 offen offset:3072 sc1 lds
v_mfma_f32_32x32x16_bf16 v[32:47], v[20:23], v[148:151], v[32:47]
s_waitcnt lgkmcnt(2)
ds_read_b128 v[16:19], v64 offset:17408
s_add_u32 m0, s45, 8192
s_add_u32 s55, s46, 8192
buffer_load_dwordx4 v0, s[4:7], s55 offen offset:0 sc1 lds
buffer_load_dwordx4 v0, s[4:7], s55 offen offset:1024 sc1 lds
v_mfma_f32_32x32x16_bf16 v[32:47], v[24:27], v[152:155], v[32:47]
s_waitcnt lgkmcnt(2)
ds_read_b128 v[20:23], v64 offset:18432
s_add_u32 s45, s45, 40960
s_cmp_ge_u32 s45, 122880
s_cselect_b32 s55, 122880, 0
s_sub_u32 s45, s45, s55
s_add_u32 s46, s46, 40960
v_mfma_f32_32x32x16_bf16 v[32:47], v[8:11], v[156:159], v[32:47]
s_waitcnt lgkmcnt(2)
ds_read_b128 v[24:27], v64 offset:19456
v_mfma_f32_32x32x16_bf16 v[32:47], v[12:15], v[160:163], v[32:47]
s_waitcnt lgkmcnt(2)
ds_read_b128 v[8:11], v64 offset:20480
v_mfma_f32_32x32x16_bf16 v[32:47], v[16:19], v[164:167], v[32:47]
s_waitcnt lgkmcnt(2)
ds_read_b128 v[12:15], v64 offset:21504
v_mfma_f32_32x32x16_bf16 v[32:47], v[20:23], v[168:171], v[32:47]
s_waitcnt lgkmcnt(2)
ds_read_b128 v[16:19], v64 offset:22528
v_mfma_f32_32x32x16_bf16 v[32:47], v[24:27], v[172:175], v[32:47]
s_waitcnt lgkmcnt(2)
ds_read_b128 v[20:23], v64 offset:23552
v_mfma_f32_32x32x16_bf16 v[32:47], v[8:11], v[176:179], v[32:47]
s_waitcnt lgkmcnt(2)
ds_read_b128 v[24:27], v64 offset:24576
v_mfma_f32_32x32x16_bf16 v[32:47], v[12:15], v[180:183], v[32:47]
s_waitcnt lgkmcnt(2)
ds_read_b128 v[8:11], v64 offset:25600
v_mfma_f32_32x32x16_bf16 v[32:47], v[16:19], v[184:187], v[32:47]
s_waitcnt lgkmcnt(2)
ds_read_b128 v[12:15], v64 offset:26624
v_mfma_f32_32x32x16_bf16 v[32:47], v[20:23], v[188:191], v[32:47]
s_waitcnt lgkmcnt(2)
ds_read_b128 v[16:19], v64 offset:27648
v_mfma_f32_32x32x16_bf16 v[32:47], v[24:27], v[192:195], v[32:47]
s_waitcnt lgkmcnt(2)
ds_read_b128 v[20:23], v64 offset:28672
v_mfma_f32_32x32x16_bf16 v[32:47], v[8:11], v[196:199], v[32:47]
s_waitcnt lgkmcnt(2)
ds_read_b128 v[24:27], v64 offset:29696
v_mfma_f32_32x32x16_bf16 v[32:47], v[12:15], v[200:203], v[32:47]
s_waitcnt lgkmcnt(2)
ds_read_b128 v[8:11], v64 offset:30720
v_mfma_f32_32x32x16_bf16 v[32:47], v[16:19], v[204:207], v[32:47]
s_waitcnt lgkmcnt(2)
ds_read_b128 v[12:15], v64 offset:31744
v_mfma_f32_32x32x16_bf16 v[32:47], v[20:23], v[208:211], v[32:47]
s_waitcnt lgkmcnt(2)
ds_read_b128 v[16:19], v64 offset:32768
v_mfma_f32_32x32x16_bf16 v[32:47], v[24:27], v[212:215], v[32:47]
s_waitcnt lgkmcnt(2)
ds_read_b128 v[20:23], v64 offset:33792
v_mfma_f32_32x32x16_bf16 v[32:47], v[8:11], v[216:219], v[32:47]
s_waitcnt lgkmcnt(2)
ds_read_b128 v[24:27], v64 offset:34816
v_mfma_f32_32x32x16_bf16 v[32:47], v[12:15], v[220:223], v[32:47]
s_waitcnt lgkmcnt(2)
ds_read_b128 v[8:11], v64 offset:35840
v_mfma_f32_32x32x16_bf16 v[32:47], v[16:19], v[224:227], v[32:47]
s_waitcnt lgkmcnt(2)
ds_read_b128 v[12:15], v64 offset:36864
v_mfma_f32_32x32x16_bf16 v[32:47], v[20:23], v[228:231], v[32:47]
s_waitcnt lgkmcnt(2)
ds_read_b128 v[16:19], v64 offset:37888
v_mfma_f32_32x32x16_bf16 v[32:47], v[24:27], v[232:235], v[32:47]
s_waitcnt lgkmcnt(2)
ds_read_b128 v[20:23], v64 offset:38912
v_mfma_f32_32x32x16_bf16 v[32:47], v[8:11], v[236:239], v[32:47]
s_waitcnt lgkmcnt(2)
ds_read_b128 v[24:27], v64 offset:39936
v_mfma_f32_32x32x16_bf16 v[32:47], v[12:15], v[240:243], v[32:47]
s_add_u32 s44, s44, 1
s_cmp_eq_u32 s44, 3
s_mov_b32 s56, 40960
s_cmov_b32 s56, -81920
s_cselect_b32 s44, 0, s44
v_add_u32 v64, s56, v64
s_waitcnt vmcnt(10) lgkmcnt(2)
s_barrier
ds_read_b128 v[8:11], v64 offset:0
v_mfma_f32_32x32x16_bf16 v[32:47], v[16:19], v[244:247], v[32:47]
s_waitcnt lgkmcnt(2)
ds_read_b128 v[12:15], v64 offset:1024
v_mfma_f32_32x32x16_bf16 v[32:47], v[20:23], v[248:251], v[32:47]
s_waitcnt lgkmcnt(2)
ds_read_b128 v[16:19], v64 offset:2048
v_mfma_f32_32x32x16_bf16 v[32:47], v[24:27], v[252:255], v[32:47]
s_waitcnt lgkmcnt(2)
ds_read_b128 v[20:23], v64 offset:3072
v_mfma_f32_32x32x16_bf16 v[48:63], v[8:11], v[96:99], 0
s_waitcnt lgkmcnt(2)
ds_read_b128 v[24:27], v64 offset:4096
v_mfma_f32_32x32x16_bf16 v[48:63], v[12:15], v[100:103], v[48:63]
s_waitcnt lgkmcnt(2)
ds_read_b128 v[8:11], v64 offset:5120
v_cvt_pk_bf16_f32 v32, v32, v33
v_cvt_pk_bf16_f32 v33, v34, v35
v_mfma_f32_32x32x16_bf16 v[48:63], v[16:19], v[104:107], v[48:63]
s_waitcnt lgkmcnt(2)
ds_read_b128 v[12:15], v64 offset:6144
v_cvt_pk_bf16_f32 v34, v36, v37
v_cvt_pk_bf16_f32 v35, v38, v39
v_mfma_f32_32x32x16_bf16 v[48:63], v[20:23], v[108:111], v[48:63]
s_waitcnt lgkmcnt(2)
ds_read_b128 v[16:19], v64 offset:7168
v_cvt_pk_bf16_f32 v36, v40, v41
v_cvt_pk_bf16_f32 v37, v42, v43
v_mfma_f32_32x32x16_bf16 v[48:63], v[24:27], v[112:115], v[48:63]
s_waitcnt lgkmcnt(2)
ds_read_b128 v[20:23], v64 offset:8192
v_cvt_pk_bf16_f32 v38, v44, v45
v_cvt_pk_bf16_f32 v39, v46, v47
v_mfma_f32_32x32x16_bf16 v[48:63], v[8:11], v[116:119], v[48:63]
s_waitcnt lgkmcnt(2)
ds_read_b128 v[24:27], v64 offset:9216
v_accvgpr_write_b32 a48, v32
v_accvgpr_write_b32 a49, v33
v_mfma_f32_32x32x16_bf16 v[48:63], v[12:15], v[120:123], v[48:63]
s_waitcnt lgkmcnt(2)
ds_read_b128 v[8:11], v64 offset:10240
v_accvgpr_write_b32 a50, v34
v_accvgpr_write_b32 a51, v35
v_mfma_f32_32x32x16_bf16 v[48:63], v[16:19], v[124:127], v[48:63]
s_waitcnt lgkmcnt(2)
ds_read_b128 v[12:15], v64 offset:11264
v_accvgpr_write_b32 a52, v36
v_accvgpr_write_b32 a53, v37
v_mfma_f32_32x32x16_bf16 v[48:63], v[20:23], v[128:131], v[48:63]
s_waitcnt lgkmcnt(2)
ds_read_b128 v[16:19], v64 offset:12288
v_accvgpr_write_b32 a54, v38
v_accvgpr_write_b32 a55, v39
v_mfma_f32_32x32x16_bf16 v[48:63], v[24:27], v[132:135], v[48:63]
s_waitcnt lgkmcnt(2)
ds_read_b128 v[20:23], v64 offset:13312
s_add_u32 m0, s45, 0
s_add_u32 s55, s46, 0
buffer_load_dwordx4 v0, s[4:7], s55 offen offset:0 sc1 lds
buffer_load_dwordx4 v0, s[4:7], s55 offen offset:1024 sc1 lds
v_mfma_f32_32x32x16_bf16 v[48:63], v[8:11], v[136:139], v[48:63]
s_waitcnt lgkmcnt(2)
ds_read_b128 v[24:27], v64 offset:14336
buffer_load_dwordx4 v0, s[4:7], s55 offen offset:2048 sc1 lds
buffer_load_dwordx4 v0, s[4:7], s55 offen offset:3072 sc1 lds
v_mfma_f32_32x32x16_bf16 v[48:63], v[12:15], v[140:143], v[48:63]
s_waitcnt lgkmcnt(2)
ds_read_b128 v[8:11], v64 offset:15360
s_add_u32 m0, s45, 4096
s_add_u32 s55, s46, 4096
buffer_load_dwordx4 v0, s[4:7], s55 offen offset:0 sc1 lds
buffer_load_dwordx4 v0, s[4:7], s55 offen offset:1024 sc1 lds
v_mfma_f32_32x32x16_bf16 v[48:63], v[16:19], v[144:147], v[48:63]
s_waitcnt lgkmcnt(2)
ds_read_b128 v[12:15], v64 offset:16384
buffer_load_dwordx4 v0, s[4:7], s55 offen offset:2048 sc1 lds
buffer_load_dwordx4 v0, s[4:7], s55 offen offset:3072 sc1 lds
v_mfma_f32_32x32x16_bf16 v[48:63], v[20:23], v[148:151], v[48:63]
s_waitcnt lgkmcnt(2)
ds_read_b128 v[16:19], v64 offset:17408
s_add_u32 m0, s45, 8192
s_add_u32 s55, s46, 8192
buffer_load_dwordx4 v0, s[4:7], s55 offen offset:0 sc1 lds
buffer_load_dwordx4 v0, s[4:7], s55 offen offset:1024 sc1 lds
v_mfma_f32_32x32x16_bf16 v[48:63], v[24:27], v[152:155], v[48:63]
s_waitcnt lgkmcnt(2)
ds_read_b128 v[20:23], v64 offset:18432
s_add_u32 s45, s45, 40960
s_cmp_ge_u32 s45, 122880
s_cselect_b32 s55, 122880, 0
s_sub_u32 s45, s45, s55
s_add_u32 s46, s46, 40960
v_mfma_f32_32x32x16_bf16 v[48:63], v[8:11], v[156:159], v[48:63]
s_waitcnt lgkmcnt(2)
ds_read_b128 v[24:27], v64 offset:19456
v_mfma_f32_32x32x16_bf16 v[48:63], v[12:15], v[160:163], v[48:63]
s_waitcnt lgkmcnt(2)
ds_read_b128 v[8:11], v64 offset:20480
v_mfma_f32_32x32x16_bf16 v[48:63], v[16:19], v[164:167], v[48:63]
s_waitcnt lgkmcnt(2)
ds_read_b128 v[12:15], v64 offset:21504
v_mfma_f32_32x32x16_bf16 v[48:63], v[20:23], v[168:171], v[48:63]
s_waitcnt lgkmcnt(2)
ds_read_b128 v[16:19], v64 offset:22528
v_mfma_f32_32x32x16_bf16 v[48:63], v[24:27], v[172:175], v[48:63]
s_waitcnt lgkmcnt(2)
ds_read_b128 v[20:23], v64 offset:23552
v_mfma_f32_32x32x16_bf16 v[48:63], v[8:11], v[176:179], v[48:63]
s_waitcnt lgkmcnt(2)
ds_read_b128 v[24:27], v64 offset:24576
v_mfma_f32_32x32x16_bf16 v[48:63], v[12:15], v[180:183], v[48:63]
s_waitcnt lgkmcnt(2)
ds_read_b128 v[8:11], v64 offset:25600
v_mfma_f32_32x32x16_bf16 v[48:63], v[16:19], v[184:187], v[48:63]
s_waitcnt lgkmcnt(2)
ds_read_b128 v[12:15], v64 offset:26624
v_mfma_f32_32x32x16_bf16 v[48:63], v[20:23], v[188:191], v[48:63]
s_waitcnt lgkmcnt(2)
ds_read_b128 v[16:19], v64 offset:27648
v_mfma_f32_32x32x16_bf16 v[48:63], v[24:27], v[192:195], v[48:63]
s_waitcnt lgkmcnt(2)
ds_read_b128 v[20:23], v64 offset:28672
v_mfma_f32_32x32x16_bf16 v[48:63], v[8:11], v[196:199], v[48:63]
s_waitcnt lgkmcnt(2)
ds_read_b128 v[24:27], v64 offset:29696
v_mfma_f32_32x32x16_bf16 v[48:63], v[12:15], v[200:203], v[48:63]
s_waitcnt lgkmcnt(2)
ds_read_b128 v[8:11], v64 offset:30720
v_mfma_f32_32x32x16_bf16 v[48:63], v[16:19], v[204:207], v[48:63]
s_waitcnt lgkmcnt(2)
ds_read_b128 v[12:15], v64 offset:31744
v_mfma_f32_32x32x16_bf16 v[48:63], v[20:23], v[208:211], v[48:63]
s_waitcnt lgkmcnt(2)
ds_read_b128 v[16:19], v64 offset:32768
v_mfma_f32_32x32x16_bf16 v[48:63], v[24:27], v[212:215], v[48:63]
s_waitcnt lgkmcnt(2)
ds_read_b128 v[20:23], v64 offset:33792
v_mfma_f32_32x32x16_bf16 v[48:63], v[8:11], v[216:219], v[48:63]
s_waitcnt lgkmcnt(2)
ds_read_b128 v[24:27], v64 offset:34816
v_mfma_f32_32x32x16_bf16 v[48:63], v[12:15], v[220:223], v[48:63]
s_waitcnt lgkmcnt(2)
ds_read_b128 v[8:11], v64 offset:35840
v_mfma_f32_32x32x16_bf16 v[48:63], v[16:19], v[224:227], v[48:63]
s_waitcnt lgkmcnt(2)
ds_read_b128 v[12:15], v64 offset:36864
v_mfma_f32_32x32x16_bf16 v[48:63], v[20:23], v[228:231], v[48:63]
s_waitcnt lgkmcnt(2)
ds_read_b128 v[16:19], v64 offset:37888
v_mfma_f32_32x32x16_bf16 v[48:63], v[24:27], v[232:235], v[48:63]
s_waitcnt lgkmcnt(2)
ds_read_b128 v[20:23], v64 offset:38912
v_mfma_f32_32x32x16_bf16 v[48:63], v[8:11], v[236:239], v[48:63]
s_waitcnt lgkmcnt(2)
ds_read_b128 v[24:27], v64 offset:39936
v_mfma_f32_32x32x16_bf16 v[48:63], v[12:15], v[240:243], v[48:63]
s_add_u32 s44, s44, 1
s_cmp_eq_u32 s44, 3
s_mov_b32 s56, 40960
s_cmov_b32 s56, -81920
s_cselect_b32 s44, 0, s44
v_add_u32 v64, s56, v64
s_waitcnt vmcnt(10) lgkmcnt(2)
s_barrier
ds_read_b128 v[8:11], v64 offset:0
v_mfma_f32_32x32x16_bf16 v[48:63], v[16:19], v[244:247], v[48:63]
s_waitcnt lgkmcnt(2)
ds_read_b128 v[12:15], v64 offset:1024
v_mfma_f32_32x32x16_bf16 v[48:63], v[20:23], v[248:251], v[48:63]
s_waitcnt lgkmcnt(2)
ds_read_b128 v[16:19], v64 offset:2048
v_mfma_f32_32x32x16_bf16 v[48:63], v[24:27], v[252:255], v[48:63]
s_waitcnt lgkmcnt(2)
ds_read_b128 v[20:23], v64 offset:3072
v_mfma_f32_32x32x16_bf16 v[32:47], v[8:11], v[96:99], 0
s_waitcnt lgkmcnt(2)
ds_read_b128 v[24:27], v64 offset:4096
v_mfma_f32_32x32x16_bf16 v[32:47], v[12:15], v[100:103], v[32:47]
s_waitcnt lgkmcnt(2)
ds_read_b128 v[8:11], v64 offset:5120
v_cvt_pk_bf16_f32 v48, v48, v49
v_cvt_pk_bf16_f32 v49, v50, v51
v_mfma_f32_32x32x16_bf16 v[32:47], v[16:19], v[104:107], v[32:47]
s_waitcnt lgkmcnt(2)
ds_read_b128 v[12:15], v64 offset:6144
v_cvt_pk_bf16_f32 v50, v52, v53
v_cvt_pk_bf16_f32 v51, v54, v55
v_mfma_f32_32x32x16_bf16 v[32:47], v[20:23], v[108:111], v[32:47]
s_waitcnt lgkmcnt(2)
ds_read_b128 v[16:19], v64 offset:7168
v_cvt_pk_bf16_f32 v52, v56, v57
v_cvt_pk_bf16_f32 v53, v58, v59
v_mfma_f32_32x32x16_bf16 v[32:47], v[24:27], v[112:115], v[32:47]
s_waitcnt lgkmcnt(2)
ds_read_b128 v[20:23], v64 offset:8192
v_cvt_pk_bf16_f32 v54, v60, v61
v_cvt_pk_bf16_f32 v55, v62, v63
v_mfma_f32_32x32x16_bf16 v[32:47], v[8:11], v[116:119], v[32:47]
s_waitcnt lgkmcnt(2)
ds_read_b128 v[24:27], v64 offset:9216
v_accvgpr_write_b32 a56, v48
v_accvgpr_write_b32 a57, v49
v_mfma_f32_32x32x16_bf16 v[32:47], v[12:15], v[120:123], v[32:47]
s_waitcnt lgkmcnt(2)
ds_read_b128 v[8:11], v64 offset:10240
v_accvgpr_write_b32 a58, v50
v_accvgpr_write_b32 a59, v51
v_mfma_f32_32x32x16_bf16 v[32:47], v[16:19], v[124:127], v[32:47]
s_waitcnt lgkmcnt(2)
ds_read_b128 v[12:15], v64 offset:11264
v_accvgpr_write_b32 a60, v52
v_accvgpr_write_b32 a61, v53
v_mfma_f32_32x32x16_bf16 v[32:47], v[20:23], v[128:131], v[32:47]
s_waitcnt lgkmcnt(2)
ds_read_b128 v[16:19], v64 offset:12288
v_accvgpr_write_b32 a62, v54
v_accvgpr_write_b32 a63, v55
v_mfma_f32_32x32x16_bf16 v[32:47], v[24:27], v[132:135], v[32:47]
s_waitcnt lgkmcnt(2)
ds_read_b128 v[20:23], v64 offset:13312
s_add_u32 m0, s45, 0
s_add_u32 s55, s46, 0
buffer_load_dwordx4 v0, s[4:7], s55 offen offset:0 sc1 lds
buffer_load_dwordx4 v0, s[4:7], s55 offen offset:1024 sc1 lds
v_mfma_f32_32x32x16_bf16 v[32:47], v[8:11], v[136:139], v[32:47]
s_waitcnt lgkmcnt(2)
ds_read_b128 v[24:27], v64 offset:14336
buffer_load_dwordx4 v0, s[4:7], s55 offen offset:2048 sc1 lds
buffer_load_dwordx4 v0, s[4:7], s55 offen offset:3072 sc1 lds
v_mfma_f32_32x32x16_bf16 v[32:47], v[12:15], v[140:143], v[32:47]
s_waitcnt lgkmcnt(2)
ds_read_b128 v[8:11], v64 offset:15360
s_add_u32 m0, s45, 4096
s_add_u32 s55, s46, 4096
buffer_load_dwordx4 v0, s[4:7], s55 offen offset:0 sc1 lds
buffer_load_dwordx4 v0, s[4:7], s55 offen offset:1024 sc1 lds
v_mfma_f32_32x32x16_bf16 v[32:47], v[16:19], v[144:147], v[32:47]
s_waitcnt lgkmcnt(2)
ds_read_b128 v[12:15], v64 offset:16384
buffer_load_dwordx4 v0, s[4:7], s55 offen offset:2048 sc1 lds
buffer_load_dwordx4 v0, s[4:7], s55 offen offset:3072 sc1 lds
v_mfma_f32_32x32x16_bf16 v[32:47], v[20:23], v[148:151], v[32:47]
s_waitcnt lgkmcnt(2)
ds_read_b128 v[16:19], v64 offset:17408
s_add_u32 m0, s45, 8192
s_add_u32 s55, s46, 8192
buffer_load_dwordx4 v0, s[4:7], s55 offen offset:0 sc1 lds
buffer_load_dwordx4 v0, s[4:7], s55 offen offset:1024 sc1 lds
v_mfma_f32_32x32x16_bf16 v[32:47], v[24:27], v[152:155], v[32:47]
s_waitcnt lgkmcnt(2)
ds_read_b128 v[20:23], v64 offset:18432
s_add_u32 s45, s45, 40960
s_cmp_ge_u32 s45, 122880
s_cselect_b32 s55, 122880, 0
s_sub_u32 s45, s45, s55
s_add_u32 s46, s46, 40960
v_mfma_f32_32x32x16_bf16 v[32:47], v[8:11], v[156:159], v[32:47]
s_waitcnt lgkmcnt(2)
ds_read_b128 v[24:27], v64 offset:19456
v_mfma_f32_32x32x16_bf16 v[32:47], v[12:15], v[160:163], v[32:47]
s_waitcnt lgkmcnt(2)
ds_read_b128 v[8:11], v64 offset:20480
v_mfma_f32_32x32x16_bf16 v[32:47], v[16:19], v[164:167], v[32:47]
s_waitcnt lgkmcnt(2)
ds_read_b128 v[12:15], v64 offset:21504
v_mfma_f32_32x32x16_bf16 v[32:47], v[20:23], v[168:171], v[32:47]
s_waitcnt lgkmcnt(2)
ds_read_b128 v[16:19], v64 offset:22528
v_mfma_f32_32x32x16_bf16 v[32:47], v[24:27], v[172:175], v[32:47]
s_waitcnt lgkmcnt(2)
ds_read_b128 v[20:23], v64 offset:23552
v_mfma_f32_32x32x16_bf16 v[32:47], v[8:11], v[176:179], v[32:47]
s_waitcnt lgkmcnt(2)
ds_read_b128 v[24:27], v64 offset:24576
v_mfma_f32_32x32x16_bf16 v[32:47], v[12:15], v[180:183], v[32:47]
s_waitcnt lgkmcnt(2)
ds_read_b128 v[8:11], v64 offset:25600
v_mfma_f32_32x32x16_bf16 v[32:47], v[16:19], v[184:187], v[32:47]
s_waitcnt lgkmcnt(2)
ds_read_b128 v[12:15], v64 offset:26624
v_mfma_f32_32x32x16_bf16 v[32:47], v[20:23], v[188:191], v[32:47]
s_waitcnt lgkmcnt(2)
ds_read_b128 v[16:19], v64 offset:27648
v_mfma_f32_32x32x16_bf16 v[32:47], v[24:27], v[192:195], v[32:47]
s_waitcnt lgkmcnt(2)
ds_read_b128 v[20:23], v64 offset:28672
v_mfma_f32_32x32x16_bf16 v[32:47], v[8:11], v[196:199], v[32:47]
s_waitcnt lgkmcnt(2)
ds_read_b128 v[24:27], v64 offset:29696
v_mfma_f32_32x32x16_bf16 v[32:47], v[12:15], v[200:203], v[32:47]
s_waitcnt lgkmcnt(2)
ds_read_b128 v[8:11], v64 offset:30720
v_mfma_f32_32x32x16_bf16 v[32:47], v[16:19], v[204:207], v[32:47]
s_waitcnt lgkmcnt(2)
ds_read_b128 v[12:15], v64 offset:31744
v_mfma_f32_32x32x16_bf16 v[32:47], v[20:23], v[208:211], v[32:47]
s_waitcnt lgkmcnt(2)
ds_read_b128 v[16:19], v64 offset:32768
v_mfma_f32_32x32x16_bf16 v[32:47], v[24:27], v[212:215], v[32:47]
s_waitcnt lgkmcnt(2)
ds_read_b128 v[20:23], v64 offset:33792
v_mfma_f32_32x32x16_bf16 v[32:47], v[8:11], v[216:219], v[32:47]
s_waitcnt lgkmcnt(2)
ds_read_b128 v[24:27], v64 offset:34816
v_mfma_f32_32x32x16_bf16 v[32:47], v[12:15], v[220:223], v[32:47]
s_waitcnt lgkmcnt(2)
ds_read_b128 v[8:11], v64 offset:35840
v_mfma_f32_32x32x16_bf16 v[32:47], v[16:19], v[224:227], v[32:47]
s_waitcnt lgkmcnt(2)
ds_read_b128 v[12:15], v64 offset:36864
v_mfma_f32_32x32x16_bf16 v[32:47], v[20:23], v[228:231], v[32:47]
s_waitcnt lgkmcnt(2)
ds_read_b128 v[16:19], v64 offset:37888
v_mfma_f32_32x32x16_bf16 v[32:47], v[24:27], v[232:235], v[32:47]
s_waitcnt lgkmcnt(2)
ds_read_b128 v[20:23], v64 offset:38912
v_mfma_f32_32x32x16_bf16 v[32:47], v[8:11], v[236:239], v[32:47]
s_waitcnt lgkmcnt(2)
ds_read_b128 v[24:27], v64 offset:39936
v_mfma_f32_32x32x16_bf16 v[32:47], v[12:15], v[240:243], v[32:47]
s_add_u32 s44, s44, 1
s_cmp_eq_u32 s44, 3
s_mov_b32 s56, 40960
s_cmov_b32 s56, -81920
s_cselect_b32 s44, 0, s44
v_add_u32 v64, s56, v64
s_waitcnt vmcnt(10) lgkmcnt(2)
s_barrier
ds_read_b128 v[8:11], v64 offset:0
v_mfma_f32_32x32x16_bf16 v[32:47], v[16:19], v[244:247], v[32:47]
s_waitcnt lgkmcnt(2)
ds_read_b128 v[12:15], v64 offset:1024
v_mfma_f32_32x32x16_bf16 v[32:47], v[20:23], v[248:251], v[32:47]
s_waitcnt lgkmcnt(2)
ds_read_b128 v[16:19], v64 offset:2048
v_mfma_f32_32x32x16_bf16 v[32:47], v[24:27], v[252:255], v[32:47]
s_waitcnt lgkmcnt(2)
ds_read_b128 v[20:23], v64 offset:3072
v_mfma_f32_32x32x16_bf16 v[48:63], v[8:11], v[96:99], 0
s_waitcnt lgkmcnt(2)
ds_read_b128 v[24:27], v64 offset:4096
v_mfma_f32_32x32x16_bf16 v[48:63], v[12:15], v[100:103], v[48:63]
s_waitcnt lgkmcnt(2)
ds_read_b128 v[8:11], v64 offset:5120
v_cvt_pk_bf16_f32 v32, v32, v33
v_cvt_pk_bf16_f32 v33, v34, v35
v_mfma_f32_32x32x16_bf16 v[48:63], v[16:19], v[104:107], v[48:63]
s_waitcnt lgkmcnt(2)
ds_read_b128 v[12:15], v64 offset:6144
v_cvt_pk_bf16_f32 v34, v36, v37
v_cvt_pk_bf16_f32 v35, v38, v39
v_mfma_f32_32x32x16_bf16 v[48:63], v[20:23], v[108:111], v[48:63]
s_waitcnt lgkmcnt(2)
ds_read_b128 v[16:19], v64 offset:7168
v_cvt_pk_bf16_f32 v36, v40, v41
v_cvt_pk_bf16_f32 v37, v42, v43
v_mfma_f32_32x32x16_bf16 v[48:63], v[24:27], v[112:115], v[48:63]
s_waitcnt lgkmcnt(2)
ds_read_b128 v[20:23], v64 offset:8192
v_cvt_pk_bf16_f32 v38, v44, v45
v_cvt_pk_bf16_f32 v39, v46, v47
v_mfma_f32_32x32x16_bf16 v[48:63], v[8:11], v[116:119], v[48:63]
s_waitcnt lgkmcnt(2)
ds_read_b128 v[24:27], v64 offset:9216
v_accvgpr_write_b32 a64, v32
v_accvgpr_write_b32 a65, v33
v_mfma_f32_32x32x16_bf16 v[48:63], v[12:15], v[120:123], v[48:63]
s_waitcnt lgkmcnt(2)
ds_read_b128 v[8:11], v64 offset:10240
v_accvgpr_write_b32 a66, v34
v_accvgpr_write_b32 a67, v35
v_mfma_f32_32x32x16_bf16 v[48:63], v[16:19], v[124:127], v[48:63]
s_waitcnt lgkmcnt(2)
ds_read_b128 v[12:15], v64 offset:11264
v_accvgpr_write_b32 a68, v36
v_accvgpr_write_b32 a69, v37
v_mfma_f32_32x32x16_bf16 v[48:63], v[20:23], v[128:131], v[48:63]
s_waitcnt lgkmcnt(2)
ds_read_b128 v[16:19], v64 offset:12288
v_accvgpr_write_b32 a70, v38
v_accvgpr_write_b32 a71, v39
v_mfma_f32_32x32x16_bf16 v[48:63], v[24:27], v[132:135], v[48:63]
s_waitcnt lgkmcnt(2)
ds_read_b128 v[20:23], v64 offset:13312
s_add_u32 m0, s45, 0
s_add_u32 s55, s46, 0
buffer_load_dwordx4 v0, s[4:7], s55 offen offset:0 sc1 lds
buffer_load_dwordx4 v0, s[4:7], s55 offen offset:1024 sc1 lds
v_mfma_f32_32x32x16_bf16 v[48:63], v[8:11], v[136:139], v[48:63]
s_waitcnt lgkmcnt(2)
ds_read_b128 v[24:27], v64 offset:14336
buffer_load_dwordx4 v0, s[4:7], s55 offen offset:2048 sc1 lds
buffer_load_dwordx4 v0, s[4:7], s55 offen offset:3072 sc1 lds
v_mfma_f32_32x32x16_bf16 v[48:63], v[12:15], v[140:143], v[48:63]
s_waitcnt lgkmcnt(2)
ds_read_b128 v[8:11], v64 offset:15360
s_add_u32 m0, s45, 4096
s_add_u32 s55, s46, 4096
buffer_load_dwordx4 v0, s[4:7], s55 offen offset:0 sc1 lds
buffer_load_dwordx4 v0, s[4:7], s55 offen offset:1024 sc1 lds
v_mfma_f32_32x32x16_bf16 v[48:63], v[16:19], v[144:147], v[48:63]
s_waitcnt lgkmcnt(2)
ds_read_b128 v[12:15], v64 offset:16384
buffer_load_dwordx4 v0, s[4:7], s55 offen offset:2048 sc1 lds
buffer_load_dwordx4 v0, s[4:7], s55 offen offset:3072 sc1 lds
v_mfma_f32_32x32x16_bf16 v[48:63], v[20:23], v[148:151], v[48:63]
s_waitcnt lgkmcnt(2)
ds_read_b128 v[16:19], v64 offset:17408
s_add_u32 m0, s45, 8192
s_add_u32 s55, s46, 8192
buffer_load_dwordx4 v0, s[4:7], s55 offen offset:0 sc1 lds
buffer_load_dwordx4 v0, s[4:7], s55 offen offset:1024 sc1 lds
v_mfma_f32_32x32x16_bf16 v[48:63], v[24:27], v[152:155], v[48:63]
s_waitcnt lgkmcnt(2)
ds_read_b128 v[20:23], v64 offset:18432
s_add_u32 s45, s45, 40960
s_cmp_ge_u32 s45, 122880
s_cselect_b32 s55, 122880, 0
s_sub_u32 s45, s45, s55
s_add_u32 s46, s46, 40960
v_mfma_f32_32x32x16_bf16 v[48:63], v[8:11], v[156:159], v[48:63]
s_waitcnt lgkmcnt(2)
ds_read_b128 v[24:27], v64 offset:19456
v_mfma_f32_32x32x16_bf16 v[48:63], v[12:15], v[160:163], v[48:63]
s_waitcnt lgkmcnt(2)
ds_read_b128 v[8:11], v64 offset:20480
v_mfma_f32_32x32x16_bf16 v[48:63], v[16:19], v[164:167], v[48:63]
s_waitcnt lgkmcnt(2)
ds_read_b128 v[12:15], v64 offset:21504
v_mfma_f32_32x32x16_bf16 v[48:63], v[20:23], v[168:171], v[48:63]
s_waitcnt lgkmcnt(2)
ds_read_b128 v[16:19], v64 offset:22528
v_mfma_f32_32x32x16_bf16 v[48:63], v[24:27], v[172:175], v[48:63]
s_waitcnt lgkmcnt(2)
ds_read_b128 v[20:23], v64 offset:23552
v_mfma_f32_32x32x16_bf16 v[48:63], v[8:11], v[176:179], v[48:63]
s_waitcnt lgkmcnt(2)
ds_read_b128 v[24:27], v64 offset:24576
v_mfma_f32_32x32x16_bf16 v[48:63], v[12:15], v[180:183], v[48:63]
s_waitcnt lgkmcnt(2)
ds_read_b128 v[8:11], v64 offset:25600
v_mfma_f32_32x32x16_bf16 v[48:63], v[16:19], v[184:187], v[48:63]
s_waitcnt lgkmcnt(2)
ds_read_b128 v[12:15], v64 offset:26624
v_mfma_f32_32x32x16_bf16 v[48:63], v[20:23], v[188:191], v[48:63]
s_waitcnt lgkmcnt(2)
ds_read_b128 v[16:19], v64 offset:27648
v_mfma_f32_32x32x16_bf16 v[48:63], v[24:27], v[192:195], v[48:63]
s_waitcnt lgkmcnt(2)
ds_read_b128 v[20:23], v64 offset:28672
v_mfma_f32_32x32x16_bf16 v[48:63], v[8:11], v[196:199], v[48:63]
s_waitcnt lgkmcnt(2)
ds_read_b128 v[24:27], v64 offset:29696
v_mfma_f32_32x32x16_bf16 v[48:63], v[12:15], v[200:203], v[48:63]
s_waitcnt lgkmcnt(2)
ds_read_b128 v[8:11], v64 offset:30720
v_mfma_f32_32x32x16_bf16 v[48:63], v[16:19], v[204:207], v[48:63]
s_waitcnt lgkmcnt(2)
ds_read_b128 v[12:15], v64 offset:31744
v_mfma_f32_32x32x16_bf16 v[48:63], v[20:23], v[208:211], v[48:63]
s_waitcnt lgkmcnt(2)
ds_read_b128 v[16:19], v64 offset:32768
v_mfma_f32_32x32x16_bf16 v[48:63], v[24:27], v[212:215], v[48:63]
s_waitcnt lgkmcnt(2)
ds_read_b128 v[20:23], v64 offset:33792
v_mfma_f32_32x32x16_bf16 v[48:63], v[8:11], v[216:219], v[48:63]
s_waitcnt lgkmcnt(2)
ds_read_b128 v[24:27], v64 offset:34816
v_mfma_f32_32x32x16_bf16 v[48:63], v[12:15], v[220:223], v[48:63]
s_waitcnt lgkmcnt(2)
ds_read_b128 v[8:11], v64 offset:35840
v_mfma_f32_32x32x16_bf16 v[48:63], v[16:19], v[224:227], v[48:63]
s_waitcnt lgkmcnt(2)
ds_read_b128 v[12:15], v64 offset:36864
v_mfma_f32_32x32x16_bf16 v[48:63], v[20:23], v[228:231], v[48:63]
s_waitcnt lgkmcnt(2)
ds_read_b128 v[16:19], v64 offset:37888
v_mfma_f32_32x32x16_bf16 v[48:63], v[24:27], v[232:235], v[48:63]
s_waitcnt lgkmcnt(2)
ds_read_b128 v[20:23], v64 offset:38912
v_mfma_f32_32x32x16_bf16 v[48:63], v[8:11], v[236:239], v[48:63]
s_waitcnt lgkmcnt(2)
ds_read_b128 v[24:27], v64 offset:39936
v_mfma_f32_32x32x16_bf16 v[48:63], v[12:15], v[240:243], v[48:63]
s_add_u32 s44, s44, 1
s_cmp_eq_u32 s44, 3
s_mov_b32 s56, 40960
s_cmov_b32 s56, -81920
s_cselect_b32 s44, 0, s44
v_add_u32 v64, s56, v64
s_waitcnt vmcnt(10) lgkmcnt(2)
s_barrier
ds_read_b128 v[8:11], v64 offset:0
v_mfma_f32_32x32x16_bf16 v[48:63], v[16:19], v[244:247], v[48:63]
s_waitcnt lgkmcnt(2)
ds_read_b128 v[12:15], v64 offset:1024
v_mfma_f32_32x32x16_bf16 v[48:63], v[20:23], v[248:251], v[48:63]
s_waitcnt lgkmcnt(2)
ds_read_b128 v[16:19], v64 offset:2048
v_mfma_f32_32x32x16_bf16 v[48:63], v[24:27], v[252:255], v[48:63]
s_waitcnt lgkmcnt(2)
ds_read_b128 v[20:23], v64 offset:3072
v_mfma_f32_32x32x16_bf16 v[32:47], v[8:11], v[96:99], 0
s_waitcnt lgkmcnt(2)
ds_read_b128 v[24:27], v64 offset:4096
v_mfma_f32_32x32x16_bf16 v[32:47], v[12:15], v[100:103], v[32:47]
s_waitcnt lgkmcnt(2)
ds_read_b128 v[8:11], v64 offset:5120
v_cvt_pk_bf16_f32 v48, v48, v49
v_cvt_pk_bf16_f32 v49, v50, v51
v_mfma_f32_32x32x16_bf16 v[32:47], v[16:19], v[104:107], v[32:47]
s_waitcnt lgkmcnt(2)
ds_read_b128 v[12:15], v64 offset:6144
v_cvt_pk_bf16_f32 v50, v52, v53
v_cvt_pk_bf16_f32 v51, v54, v55
v_mfma_f32_32x32x16_bf16 v[32:47], v[20:23], v[108:111], v[32:47]
s_waitcnt lgkmcnt(2)
ds_read_b128 v[16:19], v64 offset:7168
v_cvt_pk_bf16_f32 v52, v56, v57
v_cvt_pk_bf16_f32 v53, v58, v59
v_mfma_f32_32x32x16_bf16 v[32:47], v[24:27], v[112:115], v[32:47]
s_waitcnt lgkmcnt(2)
ds_read_b128 v[20:23], v64 offset:8192
v_cvt_pk_bf16_f32 v54, v60, v61
v_cvt_pk_bf16_f32 v55, v62, v63
v_mfma_f32_32x32x16_bf16 v[32:47], v[8:11], v[116:119], v[32:47]
s_waitcnt lgkmcnt(2)
ds_read_b128 v[24:27], v64 offset:9216
v_accvgpr_write_b32 a72, v48
v_accvgpr_write_b32 a73, v49
v_mfma_f32_32x32x16_bf16 v[32:47], v[12:15], v[120:123], v[32:47]
s_waitcnt lgkmcnt(2)
ds_read_b128 v[8:11], v64 offset:10240
v_accvgpr_write_b32 a74, v50
v_accvgpr_write_b32 a75, v51
v_mfma_f32_32x32x16_bf16 v[32:47], v[16:19], v[124:127], v[32:47]
s_waitcnt lgkmcnt(2)
ds_read_b128 v[12:15], v64 offset:11264
v_accvgpr_write_b32 a76, v52
v_accvgpr_write_b32 a77, v53
v_mfma_f32_32x32x16_bf16 v[32:47], v[20:23], v[128:131], v[32:47]
s_waitcnt lgkmcnt(2)
ds_read_b128 v[16:19], v64 offset:12288
v_accvgpr_write_b32 a78, v54
v_accvgpr_write_b32 a79, v55
v_mfma_f32_32x32x16_bf16 v[32:47], v[24:27], v[132:135], v[32:47]
s_waitcnt lgkmcnt(2)
ds_read_b128 v[20:23], v64 offset:13312
s_add_u32 m0, s45, 0
s_add_u32 s55, s46, 0
buffer_load_dwordx4 v0, s[4:7], s55 offen offset:0 sc1 lds
buffer_load_dwordx4 v0, s[4:7], s55 offen offset:1024 sc1 lds
v_mfma_f32_32x32x16_bf16 v[32:47], v[8:11], v[136:139], v[32:47]
s_waitcnt lgkmcnt(2)
ds_read_b128 v[24:27], v64 offset:14336
buffer_load_dwordx4 v0, s[4:7], s55 offen offset:2048 sc1 lds
buffer_load_dwordx4 v0, s[4:7], s55 offen offset:3072 sc1 lds
v_mfma_f32_32x32x16_bf16 v[32:47], v[12:15], v[140:143], v[32:47]
s_waitcnt lgkmcnt(2)
ds_read_b128 v[8:11], v64 offset:15360
s_add_u32 m0, s45, 4096
s_add_u32 s55, s46, 4096
buffer_load_dwordx4 v0, s[4:7], s55 offen offset:0 sc1 lds
buffer_load_dwordx4 v0, s[4:7], s55 offen offset:1024 sc1 lds
v_mfma_f32_32x32x16_bf16 v[32:47], v[16:19], v[144:147], v[32:47]
s_waitcnt lgkmcnt(2)
ds_read_b128 v[12:15], v64 offset:16384
buffer_load_dwordx4 v0, s[4:7], s55 offen offset:2048 sc1 lds
buffer_load_dwordx4 v0, s[4:7], s55 offen offset:3072 sc1 lds
v_mfma_f32_32x32x16_bf16 v[32:47], v[20:23], v[148:151], v[32:47]
s_waitcnt lgkmcnt(2)
ds_read_b128 v[16:19], v64 offset:17408
s_add_u32 m0, s45, 8192
s_add_u32 s55, s46, 8192
buffer_load_dwordx4 v0, s[4:7], s55 offen offset:0 sc1 lds
buffer_load_dwordx4 v0, s[4:7], s55 offen offset:1024 sc1 lds
v_mfma_f32_32x32x16_bf16 v[32:47], v[24:27], v[152:155], v[32:47]
s_waitcnt lgkmcnt(2)
ds_read_b128 v[20:23], v64 offset:18432
s_add_u32 s45, s45, 40960
s_cmp_ge_u32 s45, 122880
s_cselect_b32 s55, 122880, 0
s_sub_u32 s45, s45, s55
s_add_u32 s46, s46, 40960
v_mfma_f32_32x32x16_bf16 v[32:47], v[8:11], v[156:159], v[32:47]
s_waitcnt lgkmcnt(2)
ds_read_b128 v[24:27], v64 offset:19456
v_mfma_f32_32x32x16_bf16 v[32:47], v[12:15], v[160:163], v[32:47]
s_waitcnt lgkmcnt(2)
ds_read_b128 v[8:11], v64 offset:20480
v_mfma_f32_32x32x16_bf16 v[32:47], v[16:19], v[164:167], v[32:47]
s_waitcnt lgkmcnt(2)
ds_read_b128 v[12:15], v64 offset:21504
v_mfma_f32_32x32x16_bf16 v[32:47], v[20:23], v[168:171], v[32:47]
s_waitcnt lgkmcnt(2)
ds_read_b128 v[16:19], v64 offset:22528
v_mfma_f32_32x32x16_bf16 v[32:47], v[24:27], v[172:175], v[32:47]
s_waitcnt lgkmcnt(2)
ds_read_b128 v[20:23], v64 offset:23552
v_mfma_f32_32x32x16_bf16 v[32:47], v[8:11], v[176:179], v[32:47]
s_waitcnt lgkmcnt(2)
ds_read_b128 v[24:27], v64 offset:24576
v_mfma_f32_32x32x16_bf16 v[32:47], v[12:15], v[180:183], v[32:47]
s_waitcnt lgkmcnt(2)
ds_read_b128 v[8:11], v64 offset:25600
v_mfma_f32_32x32x16_bf16 v[32:47], v[16:19], v[184:187], v[32:47]
s_waitcnt lgkmcnt(2)
ds_read_b128 v[12:15], v64 offset:26624
v_mfma_f32_32x32x16_bf16 v[32:47], v[20:23], v[188:191], v[32:47]
s_waitcnt lgkmcnt(2)
ds_read_b128 v[16:19], v64 offset:27648
v_mfma_f32_32x32x16_bf16 v[32:47], v[24:27], v[192:195], v[32:47]
s_waitcnt lgkmcnt(2)
ds_read_b128 v[20:23], v64 offset:28672
v_mfma_f32_32x32x16_bf16 v[32:47], v[8:11], v[196:199], v[32:47]
s_waitcnt lgkmcnt(2)
ds_read_b128 v[24:27], v64 offset:29696
v_mfma_f32_32x32x16_bf16 v[32:47], v[12:15], v[200:203], v[32:47]
s_waitcnt lgkmcnt(2)
ds_read_b128 v[8:11], v64 offset:30720
v_mfma_f32_32x32x16_bf16 v[32:47], v[16:19], v[204:207], v[32:47]
s_waitcnt lgkmcnt(2)
ds_read_b128 v[12:15], v64 offset:31744
v_mfma_f32_32x32x16_bf16 v[32:47], v[20:23], v[208:211], v[32:47]
s_waitcnt lgkmcnt(2)
ds_read_b128 v[16:19], v64 offset:32768
v_mfma_f32_32x32x16_bf16 v[32:47], v[24:27], v[212:215], v[32:47]
s_waitcnt lgkmcnt(2)
ds_read_b128 v[20:23], v64 offset:33792
v_mfma_f32_32x32x16_bf16 v[32:47], v[8:11], v[216:219], v[32:47]
s_waitcnt lgkmcnt(2)
ds_read_b128 v[24:27], v64 offset:34816
v_mfma_f32_32x32x16_bf16 v[32:47], v[12:15], v[220:223], v[32:47]
s_waitcnt lgkmcnt(2)
ds_read_b128 v[8:11], v64 offset:35840
v_mfma_f32_32x32x16_bf16 v[32:47], v[16:19], v[224:227], v[32:47]
s_waitcnt lgkmcnt(2)
ds_read_b128 v[12:15], v64 offset:36864
v_mfma_f32_32x32x16_bf16 v[32:47], v[20:23], v[228:231], v[32:47]
s_waitcnt lgkmcnt(2)
ds_read_b128 v[16:19], v64 offset:37888
v_mfma_f32_32x32x16_bf16 v[32:47], v[24:27], v[232:235], v[32:47]
s_waitcnt lgkmcnt(2)
ds_read_b128 v[20:23], v64 offset:38912
v_mfma_f32_32x32x16_bf16 v[32:47], v[8:11], v[236:239], v[32:47]
s_waitcnt lgkmcnt(2)
ds_read_b128 v[24:27], v64 offset:39936
v_mfma_f32_32x32x16_bf16 v[32:47], v[12:15], v[240:243], v[32:47]
s_add_u32 s44, s44, 1
s_cmp_eq_u32 s44, 3
s_mov_b32 s56, 40960
s_cmov_b32 s56, -81920
s_cselect_b32 s44, 0, s44
v_add_u32 v64, s56, v64
s_waitcnt vmcnt(10) lgkmcnt(2)
s_barrier
ds_read_b128 v[8:11], v64 offset:0
v_mfma_f32_32x32x16_bf16 v[32:47], v[16:19], v[244:247], v[32:47]
s_waitcnt lgkmcnt(2)
ds_read_b128 v[12:15], v64 offset:1024
v_mfma_f32_32x32x16_bf16 v[32:47], v[20:23], v[248:251], v[32:47]
s_waitcnt lgkmcnt(2)
ds_read_b128 v[16:19], v64 offset:2048
v_mfma_f32_32x32x16_bf16 v[32:47], v[24:27], v[252:255], v[32:47]
s_waitcnt lgkmcnt(2)
ds_read_b128 v[20:23], v64 offset:3072
v_mfma_f32_32x32x16_bf16 v[48:63], v[8:11], v[96:99], 0
s_waitcnt lgkmcnt(2)
ds_read_b128 v[24:27], v64 offset:4096
v_mfma_f32_32x32x16_bf16 v[48:63], v[12:15], v[100:103], v[48:63]
s_waitcnt lgkmcnt(2)
ds_read_b128 v[8:11], v64 offset:5120
v_cvt_pk_bf16_f32 v32, v32, v33
v_cvt_pk_bf16_f32 v33, v34, v35
v_mfma_f32_32x32x16_bf16 v[48:63], v[16:19], v[104:107], v[48:63]
s_waitcnt lgkmcnt(2)
ds_read_b128 v[12:15], v64 offset:6144
v_cvt_pk_bf16_f32 v34, v36, v37
v_cvt_pk_bf16_f32 v35, v38, v39
v_mfma_f32_32x32x16_bf16 v[48:63], v[20:23], v[108:111], v[48:63]
s_waitcnt lgkmcnt(2)
ds_read_b128 v[16:19], v64 offset:7168
v_cvt_pk_bf16_f32 v36, v40, v41
v_cvt_pk_bf16_f32 v37, v42, v43
v_mfma_f32_32x32x16_bf16 v[48:63], v[24:27], v[112:115], v[48:63]
s_waitcnt lgkmcnt(2)
ds_read_b128 v[20:23], v64 offset:8192
v_cvt_pk_bf16_f32 v38, v44, v45
v_cvt_pk_bf16_f32 v39, v46, v47
v_mfma_f32_32x32x16_bf16 v[48:63], v[8:11], v[116:119], v[48:63]
s_waitcnt lgkmcnt(2)
ds_read_b128 v[24:27], v64 offset:9216
v_accvgpr_write_b32 a80, v32
v_accvgpr_write_b32 a81, v33
v_mfma_f32_32x32x16_bf16 v[48:63], v[12:15], v[120:123], v[48:63]
s_waitcnt lgkmcnt(2)
ds_read_b128 v[8:11], v64 offset:10240
v_accvgpr_write_b32 a82, v34
v_accvgpr_write_b32 a83, v35
v_mfma_f32_32x32x16_bf16 v[48:63], v[16:19], v[124:127], v[48:63]
s_waitcnt lgkmcnt(2)
ds_read_b128 v[12:15], v64 offset:11264
v_accvgpr_write_b32 a84, v36
v_accvgpr_write_b32 a85, v37
v_mfma_f32_32x32x16_bf16 v[48:63], v[20:23], v[128:131], v[48:63]
s_waitcnt lgkmcnt(2)
ds_read_b128 v[16:19], v64 offset:12288
v_accvgpr_write_b32 a86, v38
v_accvgpr_write_b32 a87, v39
v_mfma_f32_32x32x16_bf16 v[48:63], v[24:27], v[132:135], v[48:63]
s_waitcnt lgkmcnt(2)
ds_read_b128 v[20:23], v64 offset:13312
s_add_u32 m0, s45, 0
s_add_u32 s55, s46, 0
buffer_load_dwordx4 v0, s[4:7], s55 offen offset:0 sc1 lds
buffer_load_dwordx4 v0, s[4:7], s55 offen offset:1024 sc1 lds
v_mfma_f32_32x32x16_bf16 v[48:63], v[8:11], v[136:139], v[48:63]
s_waitcnt lgkmcnt(2)
ds_read_b128 v[24:27], v64 offset:14336
buffer_load_dwordx4 v0, s[4:7], s55 offen offset:2048 sc1 lds
buffer_load_dwordx4 v0, s[4:7], s55 offen offset:3072 sc1 lds
v_mfma_f32_32x32x16_bf16 v[48:63], v[12:15], v[140:143], v[48:63]
s_waitcnt lgkmcnt(2)
ds_read_b128 v[8:11], v64 offset:15360
s_add_u32 m0, s45, 4096
s_add_u32 s55, s46, 4096
buffer_load_dwordx4 v0, s[4:7], s55 offen offset:0 sc1 lds
buffer_load_dwordx4 v0, s[4:7], s55 offen offset:1024 sc1 lds
v_mfma_f32_32x32x16_bf16 v[48:63], v[16:19], v[144:147], v[48:63]
s_waitcnt lgkmcnt(2)
ds_read_b128 v[12:15], v64 offset:16384
buffer_load_dwordx4 v0, s[4:7], s55 offen offset:2048 sc1 lds
buffer_load_dwordx4 v0, s[4:7], s55 offen offset:3072 sc1 lds
v_mfma_f32_32x32x16_bf16 v[48:63], v[20:23], v[148:151], v[48:63]
s_waitcnt lgkmcnt(2)
ds_read_b128 v[16:19], v64 offset:17408
s_add_u32 m0, s45, 8192
s_add_u32 s55, s46, 8192
buffer_load_dwordx4 v0, s[4:7], s55 offen offset:0 sc1 lds
buffer_load_dwordx4 v0, s[4:7], s55 offen offset:1024 sc1 lds
v_mfma_f32_32x32x16_bf16 v[48:63], v[24:27], v[152:155], v[48:63]
s_waitcnt lgkmcnt(2)
ds_read_b128 v[20:23], v64 offset:18432
s_add_u32 s45, s45, 40960
s_cmp_ge_u32 s45, 122880
s_cselect_b32 s55, 122880, 0
s_sub_u32 s45, s45, s55
s_add_u32 s46, s46, 40960
v_mfma_f32_32x32x16_bf16 v[48:63], v[8:11], v[156:159], v[48:63]
s_waitcnt lgkmcnt(2)
ds_read_b128 v[24:27], v64 offset:19456
v_mfma_f32_32x32x16_bf16 v[48:63], v[12:15], v[160:163], v[48:63]
s_waitcnt lgkmcnt(2)
ds_read_b128 v[8:11], v64 offset:20480
v_mfma_f32_32x32x16_bf16 v[48:63], v[16:19], v[164:167], v[48:63]
s_waitcnt lgkmcnt(2)
ds_read_b128 v[12:15], v64 offset:21504
v_mfma_f32_32x32x16_bf16 v[48:63], v[20:23], v[168:171], v[48:63]
s_waitcnt lgkmcnt(2)
ds_read_b128 v[16:19], v64 offset:22528
v_mfma_f32_32x32x16_bf16 v[48:63], v[24:27], v[172:175], v[48:63]
s_waitcnt lgkmcnt(2)
ds_read_b128 v[20:23], v64 offset:23552
v_mfma_f32_32x32x16_bf16 v[48:63], v[8:11], v[176:179], v[48:63]
s_waitcnt lgkmcnt(2)
ds_read_b128 v[24:27], v64 offset:24576
v_mfma_f32_32x32x16_bf16 v[48:63], v[12:15], v[180:183], v[48:63]
s_waitcnt lgkmcnt(2)
ds_read_b128 v[8:11], v64 offset:25600
v_mfma_f32_32x32x16_bf16 v[48:63], v[16:19], v[184:187], v[48:63]
s_waitcnt lgkmcnt(2)
ds_read_b128 v[12:15], v64 offset:26624
v_mfma_f32_32x32x16_bf16 v[48:63], v[20:23], v[188:191], v[48:63]
s_waitcnt lgkmcnt(2)
ds_read_b128 v[16:19], v64 offset:27648
v_mfma_f32_32x32x16_bf16 v[48:63], v[24:27], v[192:195], v[48:63]
s_waitcnt lgkmcnt(2)
ds_read_b128 v[20:23], v64 offset:28672
v_mfma_f32_32x32x16_bf16 v[48:63], v[8:11], v[196:199], v[48:63]
s_waitcnt lgkmcnt(2)
ds_read_b128 v[24:27], v64 offset:29696
v_mfma_f32_32x32x16_bf16 v[48:63], v[12:15], v[200:203], v[48:63]
s_waitcnt lgkmcnt(2)
ds_read_b128 v[8:11], v64 offset:30720
v_mfma_f32_32x32x16_bf16 v[48:63], v[16:19], v[204:207], v[48:63]
s_waitcnt lgkmcnt(2)
ds_read_b128 v[12:15], v64 offset:31744
v_mfma_f32_32x32x16_bf16 v[48:63], v[20:23], v[208:211], v[48:63]
s_waitcnt lgkmcnt(2)
ds_read_b128 v[16:19], v64 offset:32768
v_mfma_f32_32x32x16_bf16 v[48:63], v[24:27], v[212:215], v[48:63]
s_waitcnt lgkmcnt(2)
ds_read_b128 v[20:23], v64 offset:33792
v_mfma_f32_32x32x16_bf16 v[48:63], v[8:11], v[216:219], v[48:63]
s_waitcnt lgkmcnt(2)
ds_read_b128 v[24:27], v64 offset:34816
v_mfma_f32_32x32x16_bf16 v[48:63], v[12:15], v[220:223], v[48:63]
s_waitcnt lgkmcnt(2)
ds_read_b128 v[8:11], v64 offset:35840
v_mfma_f32_32x32x16_bf16 v[48:63], v[16:19], v[224:227], v[48:63]
s_waitcnt lgkmcnt(2)
ds_read_b128 v[12:15], v64 offset:36864
v_mfma_f32_32x32x16_bf16 v[48:63], v[20:23], v[228:231], v[48:63]
s_waitcnt lgkmcnt(2)
ds_read_b128 v[16:19], v64 offset:37888
v_mfma_f32_32x32x16_bf16 v[48:63], v[24:27], v[232:235], v[48:63]
s_waitcnt lgkmcnt(2)
ds_read_b128 v[20:23], v64 offset:38912
v_mfma_f32_32x32x16_bf16 v[48:63], v[8:11], v[236:239], v[48:63]
s_waitcnt lgkmcnt(2)
ds_read_b128 v[24:27], v64 offset:39936
v_mfma_f32_32x32x16_bf16 v[48:63], v[12:15], v[240:243], v[48:63]
s_add_u32 s44, s44, 1
s_cmp_eq_u32 s44, 3
s_mov_b32 s56, 40960
s_cmov_b32 s56, -81920
s_cselect_b32 s44, 0, s44
v_add_u32 v64, s56, v64
s_waitcnt vmcnt(10) lgkmcnt(2)
s_barrier
ds_read_b128 v[8:11], v64 offset:0
v_mfma_f32_32x32x16_bf16 v[48:63], v[16:19], v[244:247], v[48:63]
s_waitcnt lgkmcnt(2)
ds_read_b128 v[12:15], v64 offset:1024
v_mfma_f32_32x32x16_bf16 v[48:63], v[20:23], v[248:251], v[48:63]
s_waitcnt lgkmcnt(2)
ds_read_b128 v[16:19], v64 offset:2048
v_mfma_f32_32x32x16_bf16 v[48:63], v[24:27], v[252:255], v[48:63]
s_waitcnt lgkmcnt(2)
ds_read_b128 v[20:23], v64 offset:3072
v_mfma_f32_32x32x16_bf16 v[32:47], v[8:11], v[96:99], 0
s_waitcnt lgkmcnt(2)
ds_read_b128 v[24:27], v64 offset:4096
v_mfma_f32_32x32x16_bf16 v[32:47], v[12:15], v[100:103], v[32:47]
s_waitcnt lgkmcnt(2)
ds_read_b128 v[8:11], v64 offset:5120
v_cvt_pk_bf16_f32 v48, v48, v49
v_cvt_pk_bf16_f32 v49, v50, v51
v_mfma_f32_32x32x16_bf16 v[32:47], v[16:19], v[104:107], v[32:47]
s_waitcnt lgkmcnt(2)
ds_read_b128 v[12:15], v64 offset:6144
v_cvt_pk_bf16_f32 v50, v52, v53
v_cvt_pk_bf16_f32 v51, v54, v55
v_mfma_f32_32x32x16_bf16 v[32:47], v[20:23], v[108:111], v[32:47]
s_waitcnt lgkmcnt(2)
ds_read_b128 v[16:19], v64 offset:7168
v_cvt_pk_bf16_f32 v52, v56, v57
v_cvt_pk_bf16_f32 v53, v58, v59
v_mfma_f32_32x32x16_bf16 v[32:47], v[24:27], v[112:115], v[32:47]
s_waitcnt lgkmcnt(2)
ds_read_b128 v[20:23], v64 offset:8192
v_cvt_pk_bf16_f32 v54, v60, v61
v_cvt_pk_bf16_f32 v55, v62, v63
v_mfma_f32_32x32x16_bf16 v[32:47], v[8:11], v[116:119], v[32:47]
s_waitcnt lgkmcnt(2)
ds_read_b128 v[24:27], v64 offset:9216
v_accvgpr_write_b32 a88, v48
v_accvgpr_write_b32 a89, v49
v_mfma_f32_32x32x16_bf16 v[32:47], v[12:15], v[120:123], v[32:47]
s_waitcnt lgkmcnt(2)
ds_read_b128 v[8:11], v64 offset:10240
v_accvgpr_write_b32 a90, v50
v_accvgpr_write_b32 a91, v51
v_mfma_f32_32x32x16_bf16 v[32:47], v[16:19], v[124:127], v[32:47]
s_waitcnt lgkmcnt(2)
ds_read_b128 v[12:15], v64 offset:11264
v_accvgpr_write_b32 a92, v52
v_accvgpr_write_b32 a93, v53
v_mfma_f32_32x32x16_bf16 v[32:47], v[20:23], v[128:131], v[32:47]
s_waitcnt lgkmcnt(2)
ds_read_b128 v[16:19], v64 offset:12288
v_accvgpr_write_b32 a94, v54
v_accvgpr_write_b32 a95, v55
v_mfma_f32_32x32x16_bf16 v[32:47], v[24:27], v[132:135], v[32:47]
s_waitcnt lgkmcnt(2)
ds_read_b128 v[20:23], v64 offset:13312
s_add_u32 m0, s45, 0
s_add_u32 s55, s46, 0
buffer_load_dwordx4 v0, s[4:7], s55 offen offset:0 sc1 lds
buffer_load_dwordx4 v0, s[4:7], s55 offen offset:1024 sc1 lds
v_mfma_f32_32x32x16_bf16 v[32:47], v[8:11], v[136:139], v[32:47]
s_waitcnt lgkmcnt(2)
ds_read_b128 v[24:27], v64 offset:14336
buffer_load_dwordx4 v0, s[4:7], s55 offen offset:2048 sc1 lds
buffer_load_dwordx4 v0, s[4:7], s55 offen offset:3072 sc1 lds
v_mfma_f32_32x32x16_bf16 v[32:47], v[12:15], v[140:143], v[32:47]
s_waitcnt lgkmcnt(2)
ds_read_b128 v[8:11], v64 offset:15360
s_add_u32 m0, s45, 4096
s_add_u32 s55, s46, 4096
buffer_load_dwordx4 v0, s[4:7], s55 offen offset:0 sc1 lds
buffer_load_dwordx4 v0, s[4:7], s55 offen offset:1024 sc1 lds
v_mfma_f32_32x32x16_bf16 v[32:47], v[16:19], v[144:147], v[32:47]
s_waitcnt lgkmcnt(2)
ds_read_b128 v[12:15], v64 offset:16384
buffer_load_dwordx4 v0, s[4:7], s55 offen offset:2048 sc1 lds
buffer_load_dwordx4 v0, s[4:7], s55 offen offset:3072 sc1 lds
v_mfma_f32_32x32x16_bf16 v[32:47], v[20:23], v[148:151], v[32:47]
s_waitcnt lgkmcnt(2)
ds_read_b128 v[16:19], v64 offset:17408
s_add_u32 m0, s45, 8192
s_add_u32 s55, s46, 8192
buffer_load_dwordx4 v0, s[4:7], s55 offen offset:0 sc1 lds
buffer_load_dwordx4 v0, s[4:7], s55 offen offset:1024 sc1 lds
v_mfma_f32_32x32x16_bf16 v[32:47], v[24:27], v[152:155], v[32:47]
s_waitcnt lgkmcnt(2)
ds_read_b128 v[20:23], v64 offset:18432
s_add_u32 s45, s45, 40960
s_cmp_ge_u32 s45, 122880
s_cselect_b32 s55, 122880, 0
s_sub_u32 s45, s45, s55
s_add_u32 s46, s46, 40960
v_mfma_f32_32x32x16_bf16 v[32:47], v[8:11], v[156:159], v[32:47]
s_waitcnt lgkmcnt(2)
ds_read_b128 v[24:27], v64 offset:19456
v_mfma_f32_32x32x16_bf16 v[32:47], v[12:15], v[160:163], v[32:47]
s_waitcnt lgkmcnt(2)
ds_read_b128 v[8:11], v64 offset:20480
v_mfma_f32_32x32x16_bf16 v[32:47], v[16:19], v[164:167], v[32:47]
s_waitcnt lgkmcnt(2)
ds_read_b128 v[12:15], v64 offset:21504
v_mfma_f32_32x32x16_bf16 v[32:47], v[20:23], v[168:171], v[32:47]
s_waitcnt lgkmcnt(2)
ds_read_b128 v[16:19], v64 offset:22528
v_mfma_f32_32x32x16_bf16 v[32:47], v[24:27], v[172:175], v[32:47]
s_waitcnt lgkmcnt(2)
ds_read_b128 v[20:23], v64 offset:23552
v_mfma_f32_32x32x16_bf16 v[32:47], v[8:11], v[176:179], v[32:47]
s_waitcnt lgkmcnt(2)
ds_read_b128 v[24:27], v64 offset:24576
v_mfma_f32_32x32x16_bf16 v[32:47], v[12:15], v[180:183], v[32:47]
s_waitcnt lgkmcnt(2)
ds_read_b128 v[8:11], v64 offset:25600
v_mfma_f32_32x32x16_bf16 v[32:47], v[16:19], v[184:187], v[32:47]
s_waitcnt lgkmcnt(2)
ds_read_b128 v[12:15], v64 offset:26624
v_mfma_f32_32x32x16_bf16 v[32:47], v[20:23], v[188:191], v[32:47]
s_waitcnt lgkmcnt(2)
ds_read_b128 v[16:19], v64 offset:27648
v_mfma_f32_32x32x16_bf16 v[32:47], v[24:27], v[192:195], v[32:47]
s_waitcnt lgkmcnt(2)
ds_read_b128 v[20:23], v64 offset:28672
v_mfma_f32_32x32x16_bf16 v[32:47], v[8:11], v[196:199], v[32:47]
s_waitcnt lgkmcnt(2)
ds_read_b128 v[24:27], v64 offset:29696
v_mfma_f32_32x32x16_bf16 v[32:47], v[12:15], v[200:203], v[32:47]
s_waitcnt lgkmcnt(2)
ds_read_b128 v[8:11], v64 offset:30720
v_mfma_f32_32x32x16_bf16 v[32:47], v[16:19], v[204:207], v[32:47]
s_waitcnt lgkmcnt(2)
ds_read_b128 v[12:15], v64 offset:31744
v_mfma_f32_32x32x16_bf16 v[32:47], v[20:23], v[208:211], v[32:47]
s_waitcnt lgkmcnt(2)
ds_read_b128 v[16:19], v64 offset:32768
v_mfma_f32_32x32x16_bf16 v[32:47], v[24:27], v[212:215], v[32:47]
s_waitcnt lgkmcnt(2)
ds_read_b128 v[20:23], v64 offset:33792
v_mfma_f32_32x32x16_bf16 v[32:47], v[8:11], v[216:219], v[32:47]
s_waitcnt lgkmcnt(2)
ds_read_b128 v[24:27], v64 offset:34816
v_mfma_f32_32x32x16_bf16 v[32:47], v[12:15], v[220:223], v[32:47]
s_waitcnt lgkmcnt(2)
ds_read_b128 v[8:11], v64 offset:35840
v_mfma_f32_32x32x16_bf16 v[32:47], v[16:19], v[224:227], v[32:47]
s_waitcnt lgkmcnt(2)
ds_read_b128 v[12:15], v64 offset:36864
v_mfma_f32_32x32x16_bf16 v[32:47], v[20:23], v[228:231], v[32:47]
s_waitcnt lgkmcnt(2)
ds_read_b128 v[16:19], v64 offset:37888
v_mfma_f32_32x32x16_bf16 v[32:47], v[24:27], v[232:235], v[32:47]
s_waitcnt lgkmcnt(2)
ds_read_b128 v[20:23], v64 offset:38912
v_mfma_f32_32x32x16_bf16 v[32:47], v[8:11], v[236:239], v[32:47]
s_waitcnt lgkmcnt(2)
ds_read_b128 v[24:27], v64 offset:39936
v_mfma_f32_32x32x16_bf16 v[32:47], v[12:15], v[240:243], v[32:47]
s_add_u32 s44, s44, 1
s_cmp_eq_u32 s44, 3
s_mov_b32 s56, 40960
s_cmov_b32 s56, -81920
s_cselect_b32 s44, 0, s44
v_add_u32 v64, s56, v64
s_waitcnt vmcnt(10) lgkmcnt(2)
s_barrier
ds_read_b128 v[8:11], v64 offset:0
v_mfma_f32_32x32x16_bf16 v[32:47], v[16:19], v[244:247], v[32:47]
s_waitcnt lgkmcnt(2)
ds_read_b128 v[12:15], v64 offset:1024
v_mfma_f32_32x32x16_bf16 v[32:47], v[20:23], v[248:251], v[32:47]
s_waitcnt lgkmcnt(2)
ds_read_b128 v[16:19], v64 offset:2048
v_mfma_f32_32x32x16_bf16 v[32:47], v[24:27], v[252:255], v[32:47]
s_waitcnt lgkmcnt(2)
ds_read_b128 v[20:23], v64 offset:3072
v_mfma_f32_32x32x16_bf16 v[48:63], v[8:11], v[96:99], 0
s_waitcnt lgkmcnt(2)
ds_read_b128 v[24:27], v64 offset:4096
v_mfma_f32_32x32x16_bf16 v[48:63], v[12:15], v[100:103], v[48:63]
s_waitcnt lgkmcnt(2)
ds_read_b128 v[8:11], v64 offset:5120
v_cvt_pk_bf16_f32 v32, v32, v33
v_cvt_pk_bf16_f32 v33, v34, v35
v_mfma_f32_32x32x16_bf16 v[48:63], v[16:19], v[104:107], v[48:63]
s_waitcnt lgkmcnt(2)
ds_read_b128 v[12:15], v64 offset:6144
v_cvt_pk_bf16_f32 v34, v36, v37
v_cvt_pk_bf16_f32 v35, v38, v39
v_mfma_f32_32x32x16_bf16 v[48:63], v[20:23], v[108:111], v[48:63]
s_waitcnt lgkmcnt(2)
ds_read_b128 v[16:19], v64 offset:7168
v_cvt_pk_bf16_f32 v36, v40, v41
v_cvt_pk_bf16_f32 v37, v42, v43
v_mfma_f32_32x32x16_bf16 v[48:63], v[24:27], v[112:115], v[48:63]
s_waitcnt lgkmcnt(2)
ds_read_b128 v[20:23], v64 offset:8192
v_cvt_pk_bf16_f32 v38, v44, v45
v_cvt_pk_bf16_f32 v39, v46, v47
v_mfma_f32_32x32x16_bf16 v[48:63], v[8:11], v[116:119], v[48:63]
s_waitcnt lgkmcnt(2)
ds_read_b128 v[24:27], v64 offset:9216
v_accvgpr_write_b32 a96, v32
v_accvgpr_write_b32 a97, v33
v_mfma_f32_32x32x16_bf16 v[48:63], v[12:15], v[120:123], v[48:63]
s_waitcnt lgkmcnt(2)
ds_read_b128 v[8:11], v64 offset:10240
v_accvgpr_write_b32 a98, v34
v_accvgpr_write_b32 a99, v35
v_mfma_f32_32x32x16_bf16 v[48:63], v[16:19], v[124:127], v[48:63]
s_waitcnt lgkmcnt(2)
ds_read_b128 v[12:15], v64 offset:11264
v_accvgpr_write_b32 a100, v36
v_accvgpr_write_b32 a101, v37
v_mfma_f32_32x32x16_bf16 v[48:63], v[20:23], v[128:131], v[48:63]
s_waitcnt lgkmcnt(2)
ds_read_b128 v[16:19], v64 offset:12288
v_accvgpr_write_b32 a102, v38
v_accvgpr_write_b32 a103, v39
v_mfma_f32_32x32x16_bf16 v[48:63], v[24:27], v[132:135], v[48:63]
s_waitcnt lgkmcnt(2)
ds_read_b128 v[20:23], v64 offset:13312
s_add_u32 m0, s45, 0
s_add_u32 s55, s46, 0
buffer_load_dwordx4 v0, s[4:7], s55 offen offset:0 sc1 lds
buffer_load_dwordx4 v0, s[4:7], s55 offen offset:1024 sc1 lds
v_mfma_f32_32x32x16_bf16 v[48:63], v[8:11], v[136:139], v[48:63]
s_waitcnt lgkmcnt(2)
ds_read_b128 v[24:27], v64 offset:14336
buffer_load_dwordx4 v0, s[4:7], s55 offen offset:2048 sc1 lds
buffer_load_dwordx4 v0, s[4:7], s55 offen offset:3072 sc1 lds
v_mfma_f32_32x32x16_bf16 v[48:63], v[12:15], v[140:143], v[48:63]
s_waitcnt lgkmcnt(2)
ds_read_b128 v[8:11], v64 offset:15360
s_add_u32 m0, s45, 4096
s_add_u32 s55, s46, 4096
buffer_load_dwordx4 v0, s[4:7], s55 offen offset:0 sc1 lds
buffer_load_dwordx4 v0, s[4:7], s55 offen offset:1024 sc1 lds
v_mfma_f32_32x32x16_bf16 v[48:63], v[16:19], v[144:147], v[48:63]
s_waitcnt lgkmcnt(2)
ds_read_b128 v[12:15], v64 offset:16384
buffer_load_dwordx4 v0, s[4:7], s55 offen offset:2048 sc1 lds
buffer_load_dwordx4 v0, s[4:7], s55 offen offset:3072 sc1 lds
v_mfma_f32_32x32x16_bf16 v[48:63], v[20:23], v[148:151], v[48:63]
s_waitcnt lgkmcnt(2)
ds_read_b128 v[16:19], v64 offset:17408
s_add_u32 m0, s45, 8192
s_add_u32 s55, s46, 8192
buffer_load_dwordx4 v0, s[4:7], s55 offen offset:0 sc1 lds
buffer_load_dwordx4 v0, s[4:7], s55 offen offset:1024 sc1 lds
v_mfma_f32_32x32x16_bf16 v[48:63], v[24:27], v[152:155], v[48:63]
s_waitcnt lgkmcnt(2)
ds_read_b128 v[20:23], v64 offset:18432
s_add_u32 s45, s45, 40960
s_cmp_ge_u32 s45, 122880
s_cselect_b32 s55, 122880, 0
s_sub_u32 s45, s45, s55
s_add_u32 s46, s46, 40960
v_mfma_f32_32x32x16_bf16 v[48:63], v[8:11], v[156:159], v[48:63]
s_waitcnt lgkmcnt(2)
ds_read_b128 v[24:27], v64 offset:19456
v_mfma_f32_32x32x16_bf16 v[48:63], v[12:15], v[160:163], v[48:63]
s_waitcnt lgkmcnt(2)
ds_read_b128 v[8:11], v64 offset:20480
v_mfma_f32_32x32x16_bf16 v[48:63], v[16:19], v[164:167], v[48:63]
s_waitcnt lgkmcnt(2)
ds_read_b128 v[12:15], v64 offset:21504
v_mfma_f32_32x32x16_bf16 v[48:63], v[20:23], v[168:171], v[48:63]
s_waitcnt lgkmcnt(2)
ds_read_b128 v[16:19], v64 offset:22528
v_mfma_f32_32x32x16_bf16 v[48:63], v[24:27], v[172:175], v[48:63]
s_waitcnt lgkmcnt(2)
ds_read_b128 v[20:23], v64 offset:23552
v_mfma_f32_32x32x16_bf16 v[48:63], v[8:11], v[176:179], v[48:63]
s_waitcnt lgkmcnt(2)
ds_read_b128 v[24:27], v64 offset:24576
v_mfma_f32_32x32x16_bf16 v[48:63], v[12:15], v[180:183], v[48:63]
s_waitcnt lgkmcnt(2)
ds_read_b128 v[8:11], v64 offset:25600
v_mfma_f32_32x32x16_bf16 v[48:63], v[16:19], v[184:187], v[48:63]
s_waitcnt lgkmcnt(2)
ds_read_b128 v[12:15], v64 offset:26624
v_mfma_f32_32x32x16_bf16 v[48:63], v[20:23], v[188:191], v[48:63]
s_waitcnt lgkmcnt(2)
ds_read_b128 v[16:19], v64 offset:27648
v_mfma_f32_32x32x16_bf16 v[48:63], v[24:27], v[192:195], v[48:63]
s_waitcnt lgkmcnt(2)
ds_read_b128 v[20:23], v64 offset:28672
v_mfma_f32_32x32x16_bf16 v[48:63], v[8:11], v[196:199], v[48:63]
s_waitcnt lgkmcnt(2)
ds_read_b128 v[24:27], v64 offset:29696
v_mfma_f32_32x32x16_bf16 v[48:63], v[12:15], v[200:203], v[48:63]
s_waitcnt lgkmcnt(2)
ds_read_b128 v[8:11], v64 offset:30720
v_mfma_f32_32x32x16_bf16 v[48:63], v[16:19], v[204:207], v[48:63]
s_waitcnt lgkmcnt(2)
ds_read_b128 v[12:15], v64 offset:31744
v_mfma_f32_32x32x16_bf16 v[48:63], v[20:23], v[208:211], v[48:63]
s_waitcnt lgkmcnt(2)
ds_read_b128 v[16:19], v64 offset:32768
v_mfma_f32_32x32x16_bf16 v[48:63], v[24:27], v[212:215], v[48:63]
s_waitcnt lgkmcnt(2)
ds_read_b128 v[20:23], v64 offset:33792
v_mfma_f32_32x32x16_bf16 v[48:63], v[8:11], v[216:219], v[48:63]
s_waitcnt lgkmcnt(2)
ds_read_b128 v[24:27], v64 offset:34816
v_mfma_f32_32x32x16_bf16 v[48:63], v[12:15], v[220:223], v[48:63]
s_waitcnt lgkmcnt(2)
ds_read_b128 v[8:11], v64 offset:35840
v_mfma_f32_32x32x16_bf16 v[48:63], v[16:19], v[224:227], v[48:63]
s_waitcnt lgkmcnt(2)
ds_read_b128 v[12:15], v64 offset:36864
v_mfma_f32_32x32x16_bf16 v[48:63], v[20:23], v[228:231], v[48:63]
s_waitcnt lgkmcnt(2)
ds_read_b128 v[16:19], v64 offset:37888
v_mfma_f32_32x32x16_bf16 v[48:63], v[24:27], v[232:235], v[48:63]
s_waitcnt lgkmcnt(2)
ds_read_b128 v[20:23], v64 offset:38912
v_mfma_f32_32x32x16_bf16 v[48:63], v[8:11], v[236:239], v[48:63]
s_waitcnt lgkmcnt(2)
ds_read_b128 v[24:27], v64 offset:39936
v_mfma_f32_32x32x16_bf16 v[48:63], v[12:15], v[240:243], v[48:63]
s_add_u32 s44, s44, 1
s_cmp_eq_u32 s44, 3
s_mov_b32 s56, 40960
s_cmov_b32 s56, -81920
s_cselect_b32 s44, 0, s44
v_add_u32 v64, s56, v64
s_waitcnt vmcnt(10) lgkmcnt(2)
s_barrier
ds_read_b128 v[8:11], v64 offset:0
v_mfma_f32_32x32x16_bf16 v[48:63], v[16:19], v[244:247], v[48:63]
s_waitcnt lgkmcnt(2)
ds_read_b128 v[12:15], v64 offset:1024
v_mfma_f32_32x32x16_bf16 v[48:63], v[20:23], v[248:251], v[48:63]
s_waitcnt lgkmcnt(2)
ds_read_b128 v[16:19], v64 offset:2048
v_mfma_f32_32x32x16_bf16 v[48:63], v[24:27], v[252:255], v[48:63]
s_waitcnt lgkmcnt(2)
ds_read_b128 v[20:23], v64 offset:3072
v_mfma_f32_32x32x16_bf16 v[32:47], v[8:11], v[96:99], 0
s_waitcnt lgkmcnt(2)
ds_read_b128 v[24:27], v64 offset:4096
v_mfma_f32_32x32x16_bf16 v[32:47], v[12:15], v[100:103], v[32:47]
s_waitcnt lgkmcnt(2)
ds_read_b128 v[8:11], v64 offset:5120
v_cvt_pk_bf16_f32 v48, v48, v49
v_cvt_pk_bf16_f32 v49, v50, v51
v_mfma_f32_32x32x16_bf16 v[32:47], v[16:19], v[104:107], v[32:47]
s_waitcnt lgkmcnt(2)
ds_read_b128 v[12:15], v64 offset:6144
v_cvt_pk_bf16_f32 v50, v52, v53
v_cvt_pk_bf16_f32 v51, v54, v55
v_mfma_f32_32x32x16_bf16 v[32:47], v[20:23], v[108:111], v[32:47]
s_waitcnt lgkmcnt(2)
ds_read_b128 v[16:19], v64 offset:7168
v_cvt_pk_bf16_f32 v52, v56, v57
v_cvt_pk_bf16_f32 v53, v58, v59
v_mfma_f32_32x32x16_bf16 v[32:47], v[24:27], v[112:115], v[32:47]
s_waitcnt lgkmcnt(2)
ds_read_b128 v[20:23], v64 offset:8192
v_cvt_pk_bf16_f32 v54, v60, v61
v_cvt_pk_bf16_f32 v55, v62, v63
v_mfma_f32_32x32x16_bf16 v[32:47], v[8:11], v[116:119], v[32:47]
s_waitcnt lgkmcnt(2)
ds_read_b128 v[24:27], v64 offset:9216
v_accvgpr_write_b32 a104, v48
v_accvgpr_write_b32 a105, v49
v_mfma_f32_32x32x16_bf16 v[32:47], v[12:15], v[120:123], v[32:47]
s_waitcnt lgkmcnt(2)
ds_read_b128 v[8:11], v64 offset:10240
v_accvgpr_write_b32 a106, v50
v_accvgpr_write_b32 a107, v51
v_mfma_f32_32x32x16_bf16 v[32:47], v[16:19], v[124:127], v[32:47]
s_waitcnt lgkmcnt(2)
ds_read_b128 v[12:15], v64 offset:11264
v_accvgpr_write_b32 a108, v52
v_accvgpr_write_b32 a109, v53
v_mfma_f32_32x32x16_bf16 v[32:47], v[20:23], v[128:131], v[32:47]
s_waitcnt lgkmcnt(2)
ds_read_b128 v[16:19], v64 offset:12288
v_accvgpr_write_b32 a110, v54
v_accvgpr_write_b32 a111, v55
v_mfma_f32_32x32x16_bf16 v[32:47], v[24:27], v[132:135], v[32:47]
s_waitcnt lgkmcnt(2)
ds_read_b128 v[20:23], v64 offset:13312
s_add_u32 m0, s45, 0
s_add_u32 s55, s46, 0
buffer_load_dwordx4 v0, s[4:7], s55 offen offset:0 sc1 lds
buffer_load_dwordx4 v0, s[4:7], s55 offen offset:1024 sc1 lds
v_mfma_f32_32x32x16_bf16 v[32:47], v[8:11], v[136:139], v[32:47]
s_waitcnt lgkmcnt(2)
ds_read_b128 v[24:27], v64 offset:14336
buffer_load_dwordx4 v0, s[4:7], s55 offen offset:2048 sc1 lds
buffer_load_dwordx4 v0, s[4:7], s55 offen offset:3072 sc1 lds
v_mfma_f32_32x32x16_bf16 v[32:47], v[12:15], v[140:143], v[32:47]
s_waitcnt lgkmcnt(2)
ds_read_b128 v[8:11], v64 offset:15360
s_add_u32 m0, s45, 4096
s_add_u32 s55, s46, 4096
buffer_load_dwordx4 v0, s[4:7], s55 offen offset:0 sc1 lds
buffer_load_dwordx4 v0, s[4:7], s55 offen offset:1024 sc1 lds
v_mfma_f32_32x32x16_bf16 v[32:47], v[16:19], v[144:147], v[32:47]
s_waitcnt lgkmcnt(2)
ds_read_b128 v[12:15], v64 offset:16384
buffer_load_dwordx4 v0, s[4:7], s55 offen offset:2048 sc1 lds
buffer_load_dwordx4 v0, s[4:7], s55 offen offset:3072 sc1 lds
v_mfma_f32_32x32x16_bf16 v[32:47], v[20:23], v[148:151], v[32:47]
s_waitcnt lgkmcnt(2)
ds_read_b128 v[16:19], v64 offset:17408
s_add_u32 m0, s45, 8192
s_add_u32 s55, s46, 8192
buffer_load_dwordx4 v0, s[4:7], s55 offen offset:0 sc1 lds
buffer_load_dwordx4 v0, s[4:7], s55 offen offset:1024 sc1 lds
v_mfma_f32_32x32x16_bf16 v[32:47], v[24:27], v[152:155], v[32:47]
s_waitcnt lgkmcnt(2)
ds_read_b128 v[20:23], v64 offset:18432
s_add_u32 s45, s45, 40960
s_cmp_ge_u32 s45, 122880
s_cselect_b32 s55, 122880, 0
s_sub_u32 s45, s45, s55
s_add_u32 s46, s46, 40960
v_mfma_f32_32x32x16_bf16 v[32:47], v[8:11], v[156:159], v[32:47]
s_waitcnt lgkmcnt(2)
ds_read_b128 v[24:27], v64 offset:19456
v_mfma_f32_32x32x16_bf16 v[32:47], v[12:15], v[160:163], v[32:47]
s_waitcnt lgkmcnt(2)
ds_read_b128 v[8:11], v64 offset:20480
v_mfma_f32_32x32x16_bf16 v[32:47], v[16:19], v[164:167], v[32:47]
s_waitcnt lgkmcnt(2)
ds_read_b128 v[12:15], v64 offset:21504
v_mfma_f32_32x32x16_bf16 v[32:47], v[20:23], v[168:171], v[32:47]
s_waitcnt lgkmcnt(2)
ds_read_b128 v[16:19], v64 offset:22528
v_mfma_f32_32x32x16_bf16 v[32:47], v[24:27], v[172:175], v[32:47]
s_waitcnt lgkmcnt(2)
ds_read_b128 v[20:23], v64 offset:23552
v_mfma_f32_32x32x16_bf16 v[32:47], v[8:11], v[176:179], v[32:47]
s_waitcnt lgkmcnt(2)
ds_read_b128 v[24:27], v64 offset:24576
v_mfma_f32_32x32x16_bf16 v[32:47], v[12:15], v[180:183], v[32:47]
s_waitcnt lgkmcnt(2)
ds_read_b128 v[8:11], v64 offset:25600
v_mfma_f32_32x32x16_bf16 v[32:47], v[16:19], v[184:187], v[32:47]
s_waitcnt lgkmcnt(2)
ds_read_b128 v[12:15], v64 offset:26624
v_mfma_f32_32x32x16_bf16 v[32:47], v[20:23], v[188:191], v[32:47]
s_waitcnt lgkmcnt(2)
ds_read_b128 v[16:19], v64 offset:27648
v_mfma_f32_32x32x16_bf16 v[32:47], v[24:27], v[192:195], v[32:47]
s_waitcnt lgkmcnt(2)
ds_read_b128 v[20:23], v64 offset:28672
v_mfma_f32_32x32x16_bf16 v[32:47], v[8:11], v[196:199], v[32:47]
s_waitcnt lgkmcnt(2)
ds_read_b128 v[24:27], v64 offset:29696
v_mfma_f32_32x32x16_bf16 v[32:47], v[12:15], v[200:203], v[32:47]
s_waitcnt lgkmcnt(2)
ds_read_b128 v[8:11], v64 offset:30720
v_mfma_f32_32x32x16_bf16 v[32:47], v[16:19], v[204:207], v[32:47]
s_waitcnt lgkmcnt(2)
ds_read_b128 v[12:15], v64 offset:31744
v_mfma_f32_32x32x16_bf16 v[32:47], v[20:23], v[208:211], v[32:47]
s_waitcnt lgkmcnt(2)
ds_read_b128 v[16:19], v64 offset:32768
v_mfma_f32_32x32x16_bf16 v[32:47], v[24:27], v[212:215], v[32:47]
s_waitcnt lgkmcnt(2)
ds_read_b128 v[20:23], v64 offset:33792
v_mfma_f32_32x32x16_bf16 v[32:47], v[8:11], v[216:219], v[32:47]
s_waitcnt lgkmcnt(2)
ds_read_b128 v[24:27], v64 offset:34816
v_mfma_f32_32x32x16_bf16 v[32:47], v[12:15], v[220:223], v[32:47]
s_waitcnt lgkmcnt(2)
ds_read_b128 v[8:11], v64 offset:35840
v_mfma_f32_32x32x16_bf16 v[32:47], v[16:19], v[224:227], v[32:47]
s_waitcnt lgkmcnt(2)
ds_read_b128 v[12:15], v64 offset:36864
v_mfma_f32_32x32x16_bf16 v[32:47], v[20:23], v[228:231], v[32:47]
s_waitcnt lgkmcnt(2)
ds_read_b128 v[16:19], v64 offset:37888
v_mfma_f32_32x32x16_bf16 v[32:47], v[24:27], v[232:235], v[32:47]
s_waitcnt lgkmcnt(2)
ds_read_b128 v[20:23], v64 offset:38912
v_mfma_f32_32x32x16_bf16 v[32:47], v[8:11], v[236:239], v[32:47]
s_waitcnt lgkmcnt(2)
ds_read_b128 v[24:27], v64 offset:39936
v_mfma_f32_32x32x16_bf16 v[32:47], v[12:15], v[240:243], v[32:47]
s_add_u32 s44, s44, 1
s_cmp_eq_u32 s44, 3
s_mov_b32 s56, 40960
s_cmov_b32 s56, -81920
s_cselect_b32 s44, 0, s44
v_add_u32 v64, s56, v64
s_waitcnt vmcnt(10) lgkmcnt(2)
s_barrier
ds_read_b128 v[8:11], v64 offset:0
v_mfma_f32_32x32x16_bf16 v[32:47], v[16:19], v[244:247], v[32:47]
s_waitcnt lgkmcnt(2)
ds_read_b128 v[12:15], v64 offset:1024
v_mfma_f32_32x32x16_bf16 v[32:47], v[20:23], v[248:251], v[32:47]
s_waitcnt lgkmcnt(2)
ds_read_b128 v[16:19], v64 offset:2048
v_mfma_f32_32x32x16_bf16 v[32:47], v[24:27], v[252:255], v[32:47]
s_waitcnt lgkmcnt(2)
ds_read_b128 v[20:23], v64 offset:3072
v_mfma_f32_32x32x16_bf16 v[48:63], v[8:11], v[96:99], 0
s_waitcnt lgkmcnt(2)
ds_read_b128 v[24:27], v64 offset:4096
v_mfma_f32_32x32x16_bf16 v[48:63], v[12:15], v[100:103], v[48:63]
s_waitcnt lgkmcnt(2)
ds_read_b128 v[8:11], v64 offset:5120
v_cvt_pk_bf16_f32 v32, v32, v33
v_cvt_pk_bf16_f32 v33, v34, v35
v_mfma_f32_32x32x16_bf16 v[48:63], v[16:19], v[104:107], v[48:63]
s_waitcnt lgkmcnt(2)
ds_read_b128 v[12:15], v64 offset:6144
v_cvt_pk_bf16_f32 v34, v36, v37
v_cvt_pk_bf16_f32 v35, v38, v39
v_mfma_f32_32x32x16_bf16 v[48:63], v[20:23], v[108:111], v[48:63]
s_waitcnt lgkmcnt(2)
ds_read_b128 v[16:19], v64 offset:7168
v_cvt_pk_bf16_f32 v36, v40, v41
v_cvt_pk_bf16_f32 v37, v42, v43
v_mfma_f32_32x32x16_bf16 v[48:63], v[24:27], v[112:115], v[48:63]
s_waitcnt lgkmcnt(2)
ds_read_b128 v[20:23], v64 offset:8192
v_cvt_pk_bf16_f32 v38, v44, v45
v_cvt_pk_bf16_f32 v39, v46, v47
v_mfma_f32_32x32x16_bf16 v[48:63], v[8:11], v[116:119], v[48:63]
s_waitcnt lgkmcnt(2)
ds_read_b128 v[24:27], v64 offset:9216
v_accvgpr_write_b32 a112, v32
v_accvgpr_write_b32 a113, v33
v_mfma_f32_32x32x16_bf16 v[48:63], v[12:15], v[120:123], v[48:63]
s_waitcnt lgkmcnt(2)
ds_read_b128 v[8:11], v64 offset:10240
v_accvgpr_write_b32 a114, v34
v_accvgpr_write_b32 a115, v35
v_mfma_f32_32x32x16_bf16 v[48:63], v[16:19], v[124:127], v[48:63]
s_waitcnt lgkmcnt(2)
ds_read_b128 v[12:15], v64 offset:11264
v_accvgpr_write_b32 a116, v36
v_accvgpr_write_b32 a117, v37
v_mfma_f32_32x32x16_bf16 v[48:63], v[20:23], v[128:131], v[48:63]
s_waitcnt lgkmcnt(2)
ds_read_b128 v[16:19], v64 offset:12288
v_accvgpr_write_b32 a118, v38
v_accvgpr_write_b32 a119, v39
v_mfma_f32_32x32x16_bf16 v[48:63], v[24:27], v[132:135], v[48:63]
s_waitcnt lgkmcnt(2)
ds_read_b128 v[20:23], v64 offset:13312
s_add_u32 m0, s45, 0
s_add_u32 s55, s46, 0
buffer_load_dwordx4 v0, s[4:7], s55 offen offset:0 sc1 lds
buffer_load_dwordx4 v0, s[4:7], s55 offen offset:1024 sc1 lds
v_mfma_f32_32x32x16_bf16 v[48:63], v[8:11], v[136:139], v[48:63]
s_waitcnt lgkmcnt(2)
ds_read_b128 v[24:27], v64 offset:14336
buffer_load_dwordx4 v0, s[4:7], s55 offen offset:2048 sc1 lds
buffer_load_dwordx4 v0, s[4:7], s55 offen offset:3072 sc1 lds
v_mfma_f32_32x32x16_bf16 v[48:63], v[12:15], v[140:143], v[48:63]
s_waitcnt lgkmcnt(2)
ds_read_b128 v[8:11], v64 offset:15360
s_add_u32 m0, s45, 4096
s_add_u32 s55, s46, 4096
buffer_load_dwordx4 v0, s[4:7], s55 offen offset:0 sc1 lds
buffer_load_dwordx4 v0, s[4:7], s55 offen offset:1024 sc1 lds
v_mfma_f32_32x32x16_bf16 v[48:63], v[16:19], v[144:147], v[48:63]
s_waitcnt lgkmcnt(2)
ds_read_b128 v[12:15], v64 offset:16384
buffer_load_dwordx4 v0, s[4:7], s55 offen offset:2048 sc1 lds
buffer_load_dwordx4 v0, s[4:7], s55 offen offset:3072 sc1 lds
v_mfma_f32_32x32x16_bf16 v[48:63], v[20:23], v[148:151], v[48:63]
s_waitcnt lgkmcnt(2)
ds_read_b128 v[16:19], v64 offset:17408
s_add_u32 m0, s45, 8192
s_add_u32 s55, s46, 8192
buffer_load_dwordx4 v0, s[4:7], s55 offen offset:0 sc1 lds
buffer_load_dwordx4 v0, s[4:7], s55 offen offset:1024 sc1 lds
v_mfma_f32_32x32x16_bf16 v[48:63], v[24:27], v[152:155], v[48:63]
s_waitcnt lgkmcnt(2)
ds_read_b128 v[20:23], v64 offset:18432
s_add_u32 s45, s45, 40960
s_cmp_ge_u32 s45, 122880
s_cselect_b32 s55, 122880, 0
s_sub_u32 s45, s45, s55
s_add_u32 s46, s46, 40960
v_mfma_f32_32x32x16_bf16 v[48:63], v[8:11], v[156:159], v[48:63]
s_waitcnt lgkmcnt(2)
ds_read_b128 v[24:27], v64 offset:19456
v_mfma_f32_32x32x16_bf16 v[48:63], v[12:15], v[160:163], v[48:63]
s_waitcnt lgkmcnt(2)
ds_read_b128 v[8:11], v64 offset:20480
v_mfma_f32_32x32x16_bf16 v[48:63], v[16:19], v[164:167], v[48:63]
s_waitcnt lgkmcnt(2)
ds_read_b128 v[12:15], v64 offset:21504
v_mfma_f32_32x32x16_bf16 v[48:63], v[20:23], v[168:171], v[48:63]
s_waitcnt lgkmcnt(2)
ds_read_b128 v[16:19], v64 offset:22528
v_mfma_f32_32x32x16_bf16 v[48:63], v[24:27], v[172:175], v[48:63]
s_waitcnt lgkmcnt(2)
ds_read_b128 v[20:23], v64 offset:23552
v_mfma_f32_32x32x16_bf16 v[48:63], v[8:11], v[176:179], v[48:63]
s_waitcnt lgkmcnt(2)
ds_read_b128 v[24:27], v64 offset:24576
v_mfma_f32_32x32x16_bf16 v[48:63], v[12:15], v[180:183], v[48:63]
s_waitcnt lgkmcnt(2)
ds_read_b128 v[8:11], v64 offset:25600
v_mfma_f32_32x32x16_bf16 v[48:63], v[16:19], v[184:187], v[48:63]
s_waitcnt lgkmcnt(2)
ds_read_b128 v[12:15], v64 offset:26624
v_mfma_f32_32x32x16_bf16 v[48:63], v[20:23], v[188:191], v[48:63]
s_waitcnt lgkmcnt(2)
ds_read_b128 v[16:19], v64 offset:27648
v_mfma_f32_32x32x16_bf16 v[48:63], v[24:27], v[192:195], v[48:63]
s_waitcnt lgkmcnt(2)
ds_read_b128 v[20:23], v64 offset:28672
v_mfma_f32_32x32x16_bf16 v[48:63], v[8:11], v[196:199], v[48:63]
s_waitcnt lgkmcnt(2)
ds_read_b128 v[24:27], v64 offset:29696
v_mfma_f32_32x32x16_bf16 v[48:63], v[12:15], v[200:203], v[48:63]
s_waitcnt lgkmcnt(2)
ds_read_b128 v[8:11], v64 offset:30720
v_mfma_f32_32x32x16_bf16 v[48:63], v[16:19], v[204:207], v[48:63]
s_waitcnt lgkmcnt(2)
ds_read_b128 v[12:15], v64 offset:31744
v_mfma_f32_32x32x16_bf16 v[48:63], v[20:23], v[208:211], v[48:63]
s_waitcnt lgkmcnt(2)
ds_read_b128 v[16:19], v64 offset:32768
v_mfma_f32_32x32x16_bf16 v[48:63], v[24:27], v[212:215], v[48:63]
s_waitcnt lgkmcnt(2)
ds_read_b128 v[20:23], v64 offset:33792
v_mfma_f32_32x32x16_bf16 v[48:63], v[8:11], v[216:219], v[48:63]
s_waitcnt lgkmcnt(2)
ds_read_b128 v[24:27], v64 offset:34816
v_mfma_f32_32x32x16_bf16 v[48:63], v[12:15], v[220:223], v[48:63]
s_waitcnt lgkmcnt(2)
ds_read_b128 v[8:11], v64 offset:35840
v_mfma_f32_32x32x16_bf16 v[48:63], v[16:19], v[224:227], v[48:63]
s_waitcnt lgkmcnt(2)
ds_read_b128 v[12:15], v64 offset:36864
v_mfma_f32_32x32x16_bf16 v[48:63], v[20:23], v[228:231], v[48:63]
s_waitcnt lgkmcnt(2)
ds_read_b128 v[16:19], v64 offset:37888
v_mfma_f32_32x32x16_bf16 v[48:63], v[24:27], v[232:235], v[48:63]
s_waitcnt lgkmcnt(2)
ds_read_b128 v[20:23], v64 offset:38912
v_mfma_f32_32x32x16_bf16 v[48:63], v[8:11], v[236:239], v[48:63]
s_waitcnt lgkmcnt(2)
ds_read_b128 v[24:27], v64 offset:39936
v_mfma_f32_32x32x16_bf16 v[48:63], v[12:15], v[240:243], v[48:63]
s_add_u32 s44, s44, 1
s_cmp_eq_u32 s44, 3
s_mov_b32 s56, 40960
s_cmov_b32 s56, -81920
s_cselect_b32 s44, 0, s44
v_add_u32 v64, s56, v64
s_waitcnt vmcnt(10) lgkmcnt(2)
s_barrier
ds_read_b128 v[8:11], v64 offset:0
v_mfma_f32_32x32x16_bf16 v[48:63], v[16:19], v[244:247], v[48:63]
s_waitcnt lgkmcnt(2)
ds_read_b128 v[12:15], v64 offset:1024
v_mfma_f32_32x32x16_bf16 v[48:63], v[20:23], v[248:251], v[48:63]
s_waitcnt lgkmcnt(2)
ds_read_b128 v[16:19], v64 offset:2048
v_mfma_f32_32x32x16_bf16 v[48:63], v[24:27], v[252:255], v[48:63]
s_waitcnt lgkmcnt(2)
ds_read_b128 v[20:23], v64 offset:3072
v_mfma_f32_32x32x16_bf16 v[32:47], v[8:11], v[96:99], 0
s_waitcnt lgkmcnt(2)
ds_read_b128 v[24:27], v64 offset:4096
v_mfma_f32_32x32x16_bf16 v[32:47], v[12:15], v[100:103], v[32:47]
s_waitcnt lgkmcnt(2)
ds_read_b128 v[8:11], v64 offset:5120
v_cvt_pk_bf16_f32 v48, v48, v49
v_cvt_pk_bf16_f32 v49, v50, v51
v_mfma_f32_32x32x16_bf16 v[32:47], v[16:19], v[104:107], v[32:47]
s_waitcnt lgkmcnt(2)
ds_read_b128 v[12:15], v64 offset:6144
v_cvt_pk_bf16_f32 v50, v52, v53
v_cvt_pk_bf16_f32 v51, v54, v55
v_mfma_f32_32x32x16_bf16 v[32:47], v[20:23], v[108:111], v[32:47]
s_waitcnt lgkmcnt(2)
ds_read_b128 v[16:19], v64 offset:7168
v_cvt_pk_bf16_f32 v52, v56, v57
v_cvt_pk_bf16_f32 v53, v58, v59
v_mfma_f32_32x32x16_bf16 v[32:47], v[24:27], v[112:115], v[32:47]
s_waitcnt lgkmcnt(2)
ds_read_b128 v[20:23], v64 offset:8192
v_cvt_pk_bf16_f32 v54, v60, v61
v_cvt_pk_bf16_f32 v55, v62, v63
v_mfma_f32_32x32x16_bf16 v[32:47], v[8:11], v[116:119], v[32:47]
s_waitcnt lgkmcnt(2)
ds_read_b128 v[24:27], v64 offset:9216
v_accvgpr_write_b32 a120, v48
v_accvgpr_write_b32 a121, v49
v_mfma_f32_32x32x16_bf16 v[32:47], v[12:15], v[120:123], v[32:47]
s_waitcnt lgkmcnt(2)
ds_read_b128 v[8:11], v64 offset:10240
v_accvgpr_write_b32 a122, v50
v_accvgpr_write_b32 a123, v51
v_mfma_f32_32x32x16_bf16 v[32:47], v[16:19], v[124:127], v[32:47]
s_waitcnt lgkmcnt(2)
ds_read_b128 v[12:15], v64 offset:11264
v_accvgpr_write_b32 a124, v52
v_accvgpr_write_b32 a125, v53
v_mfma_f32_32x32x16_bf16 v[32:47], v[20:23], v[128:131], v[32:47]
s_waitcnt lgkmcnt(2)
ds_read_b128 v[16:19], v64 offset:12288
v_accvgpr_write_b32 a126, v54
v_accvgpr_write_b32 a127, v55
v_mfma_f32_32x32x16_bf16 v[32:47], v[24:27], v[132:135], v[32:47]
s_waitcnt lgkmcnt(2)
ds_read_b128 v[20:23], v64 offset:13312
s_add_u32 m0, s45, 0
s_add_u32 s55, s46, 0
buffer_load_dwordx4 v0, s[4:7], s55 offen offset:0 sc1 lds
buffer_load_dwordx4 v0, s[4:7], s55 offen offset:1024 sc1 lds
v_mfma_f32_32x32x16_bf16 v[32:47], v[8:11], v[136:139], v[32:47]
s_waitcnt lgkmcnt(2)
ds_read_b128 v[24:27], v64 offset:14336
buffer_load_dwordx4 v0, s[4:7], s55 offen offset:2048 sc1 lds
buffer_load_dwordx4 v0, s[4:7], s55 offen offset:3072 sc1 lds
v_mfma_f32_32x32x16_bf16 v[32:47], v[12:15], v[140:143], v[32:47]
s_waitcnt lgkmcnt(2)
ds_read_b128 v[8:11], v64 offset:15360
s_add_u32 m0, s45, 4096
s_add_u32 s55, s46, 4096
buffer_load_dwordx4 v0, s[4:7], s55 offen offset:0 sc1 lds
buffer_load_dwordx4 v0, s[4:7], s55 offen offset:1024 sc1 lds
v_mfma_f32_32x32x16_bf16 v[32:47], v[16:19], v[144:147], v[32:47]
s_waitcnt lgkmcnt(2)
ds_read_b128 v[12:15], v64 offset:16384
buffer_load_dwordx4 v0, s[4:7], s55 offen offset:2048 sc1 lds
buffer_load_dwordx4 v0, s[4:7], s55 offen offset:3072 sc1 lds
v_mfma_f32_32x32x16_bf16 v[32:47], v[20:23], v[148:151], v[32:47]
s_waitcnt lgkmcnt(2)
ds_read_b128 v[16:19], v64 offset:17408
s_add_u32 m0, s45, 8192
s_add_u32 s55, s46, 8192
buffer_load_dwordx4 v0, s[4:7], s55 offen offset:0 sc1 lds
buffer_load_dwordx4 v0, s[4:7], s55 offen offset:1024 sc1 lds
v_mfma_f32_32x32x16_bf16 v[32:47], v[24:27], v[152:155], v[32:47]
s_waitcnt lgkmcnt(2)
ds_read_b128 v[20:23], v64 offset:18432
s_add_u32 s45, s45, 40960
s_cmp_ge_u32 s45, 122880
s_cselect_b32 s55, 122880, 0
s_sub_u32 s45, s45, s55
s_add_u32 s46, s46, 40960
v_mfma_f32_32x32x16_bf16 v[32:47], v[8:11], v[156:159], v[32:47]
s_waitcnt lgkmcnt(2)
ds_read_b128 v[24:27], v64 offset:19456
v_mfma_f32_32x32x16_bf16 v[32:47], v[12:15], v[160:163], v[32:47]
s_waitcnt lgkmcnt(2)
ds_read_b128 v[8:11], v64 offset:20480
v_mfma_f32_32x32x16_bf16 v[32:47], v[16:19], v[164:167], v[32:47]
s_waitcnt lgkmcnt(2)
ds_read_b128 v[12:15], v64 offset:21504
v_mfma_f32_32x32x16_bf16 v[32:47], v[20:23], v[168:171], v[32:47]
s_waitcnt lgkmcnt(2)
ds_read_b128 v[16:19], v64 offset:22528
v_mfma_f32_32x32x16_bf16 v[32:47], v[24:27], v[172:175], v[32:47]
s_waitcnt lgkmcnt(2)
ds_read_b128 v[20:23], v64 offset:23552
v_mfma_f32_32x32x16_bf16 v[32:47], v[8:11], v[176:179], v[32:47]
s_waitcnt lgkmcnt(2)
ds_read_b128 v[24:27], v64 offset:24576
v_mfma_f32_32x32x16_bf16 v[32:47], v[12:15], v[180:183], v[32:47]
s_waitcnt lgkmcnt(2)
ds_read_b128 v[8:11], v64 offset:25600
v_mfma_f32_32x32x16_bf16 v[32:47], v[16:19], v[184:187], v[32:47]
s_waitcnt lgkmcnt(2)
ds_read_b128 v[12:15], v64 offset:26624
v_mfma_f32_32x32x16_bf16 v[32:47], v[20:23], v[188:191], v[32:47]
s_waitcnt lgkmcnt(2)
ds_read_b128 v[16:19], v64 offset:27648
v_mfma_f32_32x32x16_bf16 v[32:47], v[24:27], v[192:195], v[32:47]
s_waitcnt lgkmcnt(2)
ds_read_b128 v[20:23], v64 offset:28672
v_mfma_f32_32x32x16_bf16 v[32:47], v[8:11], v[196:199], v[32:47]
s_waitcnt lgkmcnt(2)
ds_read_b128 v[24:27], v64 offset:29696
v_mfma_f32_32x32x16_bf16 v[32:47], v[12:15], v[200:203], v[32:47]
s_waitcnt lgkmcnt(2)
ds_read_b128 v[8:11], v64 offset:30720
v_mfma_f32_32x32x16_bf16 v[32:47], v[16:19], v[204:207], v[32:47]
s_waitcnt lgkmcnt(2)
ds_read_b128 v[12:15], v64 offset:31744
v_mfma_f32_32x32x16_bf16 v[32:47], v[20:23], v[208:211], v[32:47]
s_waitcnt lgkmcnt(2)
ds_read_b128 v[16:19], v64 offset:32768
v_mfma_f32_32x32x16_bf16 v[32:47], v[24:27], v[212:215], v[32:47]
s_waitcnt lgkmcnt(2)
ds_read_b128 v[20:23], v64 offset:33792
v_mfma_f32_32x32x16_bf16 v[32:47], v[8:11], v[216:219], v[32:47]
s_waitcnt lgkmcnt(2)
ds_read_b128 v[24:27], v64 offset:34816
v_mfma_f32_32x32x16_bf16 v[32:47], v[12:15], v[220:223], v[32:47]
s_waitcnt lgkmcnt(2)
ds_read_b128 v[8:11], v64 offset:35840
v_mfma_f32_32x32x16_bf16 v[32:47], v[16:19], v[224:227], v[32:47]
s_waitcnt lgkmcnt(2)
ds_read_b128 v[12:15], v64 offset:36864
v_mfma_f32_32x32x16_bf16 v[32:47], v[20:23], v[228:231], v[32:47]
s_waitcnt lgkmcnt(2)
ds_read_b128 v[16:19], v64 offset:37888
v_mfma_f32_32x32x16_bf16 v[32:47], v[24:27], v[232:235], v[32:47]
s_waitcnt lgkmcnt(2)
ds_read_b128 v[20:23], v64 offset:38912
v_mfma_f32_32x32x16_bf16 v[32:47], v[8:11], v[236:239], v[32:47]
s_waitcnt lgkmcnt(2)
ds_read_b128 v[24:27], v64 offset:39936
v_mfma_f32_32x32x16_bf16 v[32:47], v[12:15], v[240:243], v[32:47]
s_add_u32 s44, s44, 1
s_cmp_eq_u32 s44, 3
s_mov_b32 s56, 40960
s_cmov_b32 s56, -81920
s_cselect_b32 s44, 0, s44
v_add_u32 v64, s56, v64
s_waitcnt vmcnt(10) lgkmcnt(2)
s_barrier
ds_read_b128 v[8:11], v64 offset:0
v_mfma_f32_32x32x16_bf16 v[32:47], v[16:19], v[244:247], v[32:47]
s_waitcnt lgkmcnt(2)
ds_read_b128 v[12:15], v64 offset:1024
v_mfma_f32_32x32x16_bf16 v[32:47], v[20:23], v[248:251], v[32:47]
s_waitcnt lgkmcnt(2)
ds_read_b128 v[16:19], v64 offset:2048
v_mfma_f32_32x32x16_bf16 v[32:47], v[24:27], v[252:255], v[32:47]
s_waitcnt lgkmcnt(2)
ds_read_b128 v[20:23], v64 offset:3072
v_mfma_f32_32x32x16_bf16 v[48:63], v[8:11], v[96:99], 0
s_waitcnt lgkmcnt(2)
ds_read_b128 v[24:27], v64 offset:4096
v_mfma_f32_32x32x16_bf16 v[48:63], v[12:15], v[100:103], v[48:63]
s_waitcnt lgkmcnt(2)
ds_read_b128 v[8:11], v64 offset:5120
v_cvt_pk_bf16_f32 v32, v32, v33
v_cvt_pk_bf16_f32 v33, v34, v35
v_mfma_f32_32x32x16_bf16 v[48:63], v[16:19], v[104:107], v[48:63]
s_waitcnt lgkmcnt(2)
ds_read_b128 v[12:15], v64 offset:6144
v_cvt_pk_bf16_f32 v34, v36, v37
v_cvt_pk_bf16_f32 v35, v38, v39
v_mfma_f32_32x32x16_bf16 v[48:63], v[20:23], v[108:111], v[48:63]
s_waitcnt lgkmcnt(2)
ds_read_b128 v[16:19], v64 offset:7168
v_cvt_pk_bf16_f32 v36, v40, v41
v_cvt_pk_bf16_f32 v37, v42, v43
v_mfma_f32_32x32x16_bf16 v[48:63], v[24:27], v[112:115], v[48:63]
s_waitcnt lgkmcnt(2)
ds_read_b128 v[20:23], v64 offset:8192
v_cvt_pk_bf16_f32 v38, v44, v45
v_cvt_pk_bf16_f32 v39, v46, v47
v_mfma_f32_32x32x16_bf16 v[48:63], v[8:11], v[116:119], v[48:63]
s_waitcnt lgkmcnt(2)
ds_read_b128 v[24:27], v64 offset:9216
v_accvgpr_write_b32 a128, v32
v_accvgpr_write_b32 a129, v33
v_mfma_f32_32x32x16_bf16 v[48:63], v[12:15], v[120:123], v[48:63]
s_waitcnt lgkmcnt(2)
ds_read_b128 v[8:11], v64 offset:10240
v_accvgpr_write_b32 a130, v34
v_accvgpr_write_b32 a131, v35
v_mfma_f32_32x32x16_bf16 v[48:63], v[16:19], v[124:127], v[48:63]
s_waitcnt lgkmcnt(2)
ds_read_b128 v[12:15], v64 offset:11264
v_accvgpr_write_b32 a132, v36
v_accvgpr_write_b32 a133, v37
v_mfma_f32_32x32x16_bf16 v[48:63], v[20:23], v[128:131], v[48:63]
s_waitcnt lgkmcnt(2)
ds_read_b128 v[16:19], v64 offset:12288
v_accvgpr_write_b32 a134, v38
v_accvgpr_write_b32 a135, v39
v_mfma_f32_32x32x16_bf16 v[48:63], v[24:27], v[132:135], v[48:63]
s_waitcnt lgkmcnt(2)
ds_read_b128 v[20:23], v64 offset:13312
s_add_u32 m0, s45, 0
s_add_u32 s55, s46, 0
buffer_load_dwordx4 v0, s[4:7], s55 offen offset:0 sc1 lds
buffer_load_dwordx4 v0, s[4:7], s55 offen offset:1024 sc1 lds
v_mfma_f32_32x32x16_bf16 v[48:63], v[8:11], v[136:139], v[48:63]
s_waitcnt lgkmcnt(2)
ds_read_b128 v[24:27], v64 offset:14336
buffer_load_dwordx4 v0, s[4:7], s55 offen offset:2048 sc1 lds
buffer_load_dwordx4 v0, s[4:7], s55 offen offset:3072 sc1 lds
v_mfma_f32_32x32x16_bf16 v[48:63], v[12:15], v[140:143], v[48:63]
s_waitcnt lgkmcnt(2)
ds_read_b128 v[8:11], v64 offset:15360
s_add_u32 m0, s45, 4096
s_add_u32 s55, s46, 4096
buffer_load_dwordx4 v0, s[4:7], s55 offen offset:0 sc1 lds
buffer_load_dwordx4 v0, s[4:7], s55 offen offset:1024 sc1 lds
v_mfma_f32_32x32x16_bf16 v[48:63], v[16:19], v[144:147], v[48:63]
s_waitcnt lgkmcnt(2)
ds_read_b128 v[12:15], v64 offset:16384
buffer_load_dwordx4 v0, s[4:7], s55 offen offset:2048 sc1 lds
buffer_load_dwordx4 v0, s[4:7], s55 offen offset:3072 sc1 lds
v_mfma_f32_32x32x16_bf16 v[48:63], v[20:23], v[148:151], v[48:63]
s_waitcnt lgkmcnt(2)
ds_read_b128 v[16:19], v64 offset:17408
s_add_u32 m0, s45, 8192
s_add_u32 s55, s46, 8192
buffer_load_dwordx4 v0, s[4:7], s55 offen offset:0 sc1 lds
buffer_load_dwordx4 v0, s[4:7], s55 offen offset:1024 sc1 lds
v_mfma_f32_32x32x16_bf16 v[48:63], v[24:27], v[152:155], v[48:63]
s_waitcnt lgkmcnt(2)
ds_read_b128 v[20:23], v64 offset:18432
s_add_u32 s45, s45, 40960
s_cmp_ge_u32 s45, 122880
s_cselect_b32 s55, 122880, 0
s_sub_u32 s45, s45, s55
s_add_u32 s46, s46, 40960
v_mfma_f32_32x32x16_bf16 v[48:63], v[8:11], v[156:159], v[48:63]
s_waitcnt lgkmcnt(2)
ds_read_b128 v[24:27], v64 offset:19456
v_mfma_f32_32x32x16_bf16 v[48:63], v[12:15], v[160:163], v[48:63]
s_waitcnt lgkmcnt(2)
ds_read_b128 v[8:11], v64 offset:20480
v_mfma_f32_32x32x16_bf16 v[48:63], v[16:19], v[164:167], v[48:63]
s_waitcnt lgkmcnt(2)
ds_read_b128 v[12:15], v64 offset:21504
v_mfma_f32_32x32x16_bf16 v[48:63], v[20:23], v[168:171], v[48:63]
s_waitcnt lgkmcnt(2)
ds_read_b128 v[16:19], v64 offset:22528
v_mfma_f32_32x32x16_bf16 v[48:63], v[24:27], v[172:175], v[48:63]
s_waitcnt lgkmcnt(2)
ds_read_b128 v[20:23], v64 offset:23552
v_mfma_f32_32x32x16_bf16 v[48:63], v[8:11], v[176:179], v[48:63]
s_waitcnt lgkmcnt(2)
ds_read_b128 v[24:27], v64 offset:24576
v_mfma_f32_32x32x16_bf16 v[48:63], v[12:15], v[180:183], v[48:63]
s_waitcnt lgkmcnt(2)
ds_read_b128 v[8:11], v64 offset:25600
v_mfma_f32_32x32x16_bf16 v[48:63], v[16:19], v[184:187], v[48:63]
s_waitcnt lgkmcnt(2)
ds_read_b128 v[12:15], v64 offset:26624
v_mfma_f32_32x32x16_bf16 v[48:63], v[20:23], v[188:191], v[48:63]
s_waitcnt lgkmcnt(2)
ds_read_b128 v[16:19], v64 offset:27648
v_mfma_f32_32x32x16_bf16 v[48:63], v[24:27], v[192:195], v[48:63]
s_waitcnt lgkmcnt(2)
ds_read_b128 v[20:23], v64 offset:28672
v_mfma_f32_32x32x16_bf16 v[48:63], v[8:11], v[196:199], v[48:63]
s_waitcnt lgkmcnt(2)
ds_read_b128 v[24:27], v64 offset:29696
v_mfma_f32_32x32x16_bf16 v[48:63], v[12:15], v[200:203], v[48:63]
s_waitcnt lgkmcnt(2)
ds_read_b128 v[8:11], v64 offset:30720
v_mfma_f32_32x32x16_bf16 v[48:63], v[16:19], v[204:207], v[48:63]
s_waitcnt lgkmcnt(2)
ds_read_b128 v[12:15], v64 offset:31744
v_mfma_f32_32x32x16_bf16 v[48:63], v[20:23], v[208:211], v[48:63]
s_waitcnt lgkmcnt(2)
ds_read_b128 v[16:19], v64 offset:32768
v_mfma_f32_32x32x16_bf16 v[48:63], v[24:27], v[212:215], v[48:63]
s_waitcnt lgkmcnt(2)
ds_read_b128 v[20:23], v64 offset:33792
v_mfma_f32_32x32x16_bf16 v[48:63], v[8:11], v[216:219], v[48:63]
s_waitcnt lgkmcnt(2)
ds_read_b128 v[24:27], v64 offset:34816
v_mfma_f32_32x32x16_bf16 v[48:63], v[12:15], v[220:223], v[48:63]
s_waitcnt lgkmcnt(2)
ds_read_b128 v[8:11], v64 offset:35840
v_mfma_f32_32x32x16_bf16 v[48:63], v[16:19], v[224:227], v[48:63]
s_waitcnt lgkmcnt(2)
ds_read_b128 v[12:15], v64 offset:36864
v_mfma_f32_32x32x16_bf16 v[48:63], v[20:23], v[228:231], v[48:63]
s_waitcnt lgkmcnt(2)
ds_read_b128 v[16:19], v64 offset:37888
v_mfma_f32_32x32x16_bf16 v[48:63], v[24:27], v[232:235], v[48:63]
s_waitcnt lgkmcnt(2)
ds_read_b128 v[20:23], v64 offset:38912
v_mfma_f32_32x32x16_bf16 v[48:63], v[8:11], v[236:239], v[48:63]
s_waitcnt lgkmcnt(2)
ds_read_b128 v[24:27], v64 offset:39936
v_mfma_f32_32x32x16_bf16 v[48:63], v[12:15], v[240:243], v[48:63]
s_add_u32 s44, s44, 1
s_cmp_eq_u32 s44, 3
s_mov_b32 s56, 40960
s_cmov_b32 s56, -81920
s_cselect_b32 s44, 0, s44
v_add_u32 v64, s56, v64
s_waitcnt vmcnt(10) lgkmcnt(2)
s_barrier
ds_read_b128 v[8:11], v64 offset:0
v_mfma_f32_32x32x16_bf16 v[48:63], v[16:19], v[244:247], v[48:63]
s_waitcnt lgkmcnt(2)
ds_read_b128 v[12:15], v64 offset:1024
v_mfma_f32_32x32x16_bf16 v[48:63], v[20:23], v[248:251], v[48:63]
s_waitcnt lgkmcnt(2)
ds_read_b128 v[16:19], v64 offset:2048
v_mfma_f32_32x32x16_bf16 v[48:63], v[24:27], v[252:255], v[48:63]
s_waitcnt lgkmcnt(2)
ds_read_b128 v[20:23], v64 offset:3072
v_mfma_f32_32x32x16_bf16 v[32:47], v[8:11], v[96:99], 0
s_waitcnt lgkmcnt(2)
ds_read_b128 v[24:27], v64 offset:4096
v_mfma_f32_32x32x16_bf16 v[32:47], v[12:15], v[100:103], v[32:47]
s_waitcnt lgkmcnt(2)
ds_read_b128 v[8:11], v64 offset:5120
v_cvt_pk_bf16_f32 v48, v48, v49
v_cvt_pk_bf16_f32 v49, v50, v51
v_mfma_f32_32x32x16_bf16 v[32:47], v[16:19], v[104:107], v[32:47]
s_waitcnt lgkmcnt(2)
ds_read_b128 v[12:15], v64 offset:6144
v_cvt_pk_bf16_f32 v50, v52, v53
v_cvt_pk_bf16_f32 v51, v54, v55
v_mfma_f32_32x32x16_bf16 v[32:47], v[20:23], v[108:111], v[32:47]
s_waitcnt lgkmcnt(2)
ds_read_b128 v[16:19], v64 offset:7168
v_cvt_pk_bf16_f32 v52, v56, v57
v_cvt_pk_bf16_f32 v53, v58, v59
v_mfma_f32_32x32x16_bf16 v[32:47], v[24:27], v[112:115], v[32:47]
s_waitcnt lgkmcnt(2)
ds_read_b128 v[20:23], v64 offset:8192
v_cvt_pk_bf16_f32 v54, v60, v61
v_cvt_pk_bf16_f32 v55, v62, v63
v_mfma_f32_32x32x16_bf16 v[32:47], v[8:11], v[116:119], v[32:47]
s_waitcnt lgkmcnt(2)
ds_read_b128 v[24:27], v64 offset:9216
v_accvgpr_write_b32 a136, v48
v_accvgpr_write_b32 a137, v49
v_mfma_f32_32x32x16_bf16 v[32:47], v[12:15], v[120:123], v[32:47]
s_waitcnt lgkmcnt(2)
ds_read_b128 v[8:11], v64 offset:10240
v_accvgpr_write_b32 a138, v50
v_accvgpr_write_b32 a139, v51
v_mfma_f32_32x32x16_bf16 v[32:47], v[16:19], v[124:127], v[32:47]
s_waitcnt lgkmcnt(2)
ds_read_b128 v[12:15], v64 offset:11264
v_accvgpr_write_b32 a140, v52
v_accvgpr_write_b32 a141, v53
v_mfma_f32_32x32x16_bf16 v[32:47], v[20:23], v[128:131], v[32:47]
s_waitcnt lgkmcnt(2)
ds_read_b128 v[16:19], v64 offset:12288
v_accvgpr_write_b32 a142, v54
v_accvgpr_write_b32 a143, v55
v_mfma_f32_32x32x16_bf16 v[32:47], v[24:27], v[132:135], v[32:47]
s_waitcnt lgkmcnt(2)
ds_read_b128 v[20:23], v64 offset:13312
s_add_u32 m0, s45, 0
s_add_u32 s55, s46, 0
buffer_load_dwordx4 v0, s[4:7], s55 offen offset:0 sc1 lds
buffer_load_dwordx4 v0, s[4:7], s55 offen offset:1024 sc1 lds
v_mfma_f32_32x32x16_bf16 v[32:47], v[8:11], v[136:139], v[32:47]
s_waitcnt lgkmcnt(2)
ds_read_b128 v[24:27], v64 offset:14336
buffer_load_dwordx4 v0, s[4:7], s55 offen offset:2048 sc1 lds
buffer_load_dwordx4 v0, s[4:7], s55 offen offset:3072 sc1 lds
v_mfma_f32_32x32x16_bf16 v[32:47], v[12:15], v[140:143], v[32:47]
s_waitcnt lgkmcnt(2)
ds_read_b128 v[8:11], v64 offset:15360
s_add_u32 m0, s45, 4096
s_add_u32 s55, s46, 4096
buffer_load_dwordx4 v0, s[4:7], s55 offen offset:0 sc1 lds
buffer_load_dwordx4 v0, s[4:7], s55 offen offset:1024 sc1 lds
v_mfma_f32_32x32x16_bf16 v[32:47], v[16:19], v[144:147], v[32:47]
s_waitcnt lgkmcnt(2)
ds_read_b128 v[12:15], v64 offset:16384
buffer_load_dwordx4 v0, s[4:7], s55 offen offset:2048 sc1 lds
buffer_load_dwordx4 v0, s[4:7], s55 offen offset:3072 sc1 lds
v_mfma_f32_32x32x16_bf16 v[32:47], v[20:23], v[148:151], v[32:47]
s_waitcnt lgkmcnt(2)
ds_read_b128 v[16:19], v64 offset:17408
s_add_u32 m0, s45, 8192
s_add_u32 s55, s46, 8192
buffer_load_dwordx4 v0, s[4:7], s55 offen offset:0 sc1 lds
buffer_load_dwordx4 v0, s[4:7], s55 offen offset:1024 sc1 lds
v_mfma_f32_32x32x16_bf16 v[32:47], v[24:27], v[152:155], v[32:47]
s_waitcnt lgkmcnt(2)
ds_read_b128 v[20:23], v64 offset:18432
s_add_u32 s45, s45, 40960
s_cmp_ge_u32 s45, 122880
s_cselect_b32 s55, 122880, 0
s_sub_u32 s45, s45, s55
s_add_u32 s46, s46, 40960
v_mfma_f32_32x32x16_bf16 v[32:47], v[8:11], v[156:159], v[32:47]
s_waitcnt lgkmcnt(2)
ds_read_b128 v[24:27], v64 offset:19456
v_mfma_f32_32x32x16_bf16 v[32:47], v[12:15], v[160:163], v[32:47]
s_waitcnt lgkmcnt(2)
ds_read_b128 v[8:11], v64 offset:20480
v_mfma_f32_32x32x16_bf16 v[32:47], v[16:19], v[164:167], v[32:47]
s_waitcnt lgkmcnt(2)
ds_read_b128 v[12:15], v64 offset:21504
v_mfma_f32_32x32x16_bf16 v[32:47], v[20:23], v[168:171], v[32:47]
s_waitcnt lgkmcnt(2)
ds_read_b128 v[16:19], v64 offset:22528
v_mfma_f32_32x32x16_bf16 v[32:47], v[24:27], v[172:175], v[32:47]
s_waitcnt lgkmcnt(2)
ds_read_b128 v[20:23], v64 offset:23552
v_mfma_f32_32x32x16_bf16 v[32:47], v[8:11], v[176:179], v[32:47]
s_waitcnt lgkmcnt(2)
ds_read_b128 v[24:27], v64 offset:24576
v_mfma_f32_32x32x16_bf16 v[32:47], v[12:15], v[180:183], v[32:47]
s_waitcnt lgkmcnt(2)
ds_read_b128 v[8:11], v64 offset:25600
v_mfma_f32_32x32x16_bf16 v[32:47], v[16:19], v[184:187], v[32:47]
s_waitcnt lgkmcnt(2)
ds_read_b128 v[12:15], v64 offset:26624
v_mfma_f32_32x32x16_bf16 v[32:47], v[20:23], v[188:191], v[32:47]
s_waitcnt lgkmcnt(2)
ds_read_b128 v[16:19], v64 offset:27648
v_mfma_f32_32x32x16_bf16 v[32:47], v[24:27], v[192:195], v[32:47]
s_waitcnt lgkmcnt(2)
ds_read_b128 v[20:23], v64 offset:28672
v_mfma_f32_32x32x16_bf16 v[32:47], v[8:11], v[196:199], v[32:47]
s_waitcnt lgkmcnt(2)
ds_read_b128 v[24:27], v64 offset:29696
v_mfma_f32_32x32x16_bf16 v[32:47], v[12:15], v[200:203], v[32:47]
s_waitcnt lgkmcnt(2)
ds_read_b128 v[8:11], v64 offset:30720
v_mfma_f32_32x32x16_bf16 v[32:47], v[16:19], v[204:207], v[32:47]
s_waitcnt lgkmcnt(2)
ds_read_b128 v[12:15], v64 offset:31744
v_mfma_f32_32x32x16_bf16 v[32:47], v[20:23], v[208:211], v[32:47]
s_waitcnt lgkmcnt(2)
ds_read_b128 v[16:19], v64 offset:32768
v_mfma_f32_32x32x16_bf16 v[32:47], v[24:27], v[212:215], v[32:47]
s_waitcnt lgkmcnt(2)
ds_read_b128 v[20:23], v64 offset:33792
v_mfma_f32_32x32x16_bf16 v[32:47], v[8:11], v[216:219], v[32:47]
s_waitcnt lgkmcnt(2)
ds_read_b128 v[24:27], v64 offset:34816
v_mfma_f32_32x32x16_bf16 v[32:47], v[12:15], v[220:223], v[32:47]
s_waitcnt lgkmcnt(2)
ds_read_b128 v[8:11], v64 offset:35840
v_mfma_f32_32x32x16_bf16 v[32:47], v[16:19], v[224:227], v[32:47]
s_waitcnt lgkmcnt(2)
ds_read_b128 v[12:15], v64 offset:36864
v_mfma_f32_32x32x16_bf16 v[32:47], v[20:23], v[228:231], v[32:47]
s_waitcnt lgkmcnt(2)
ds_read_b128 v[16:19], v64 offset:37888
v_mfma_f32_32x32x16_bf16 v[32:47], v[24:27], v[232:235], v[32:47]
s_waitcnt lgkmcnt(2)
ds_read_b128 v[20:23], v64 offset:38912
v_mfma_f32_32x32x16_bf16 v[32:47], v[8:11], v[236:239], v[32:47]
s_waitcnt lgkmcnt(2)
ds_read_b128 v[24:27], v64 offset:39936
v_mfma_f32_32x32x16_bf16 v[32:47], v[12:15], v[240:243], v[32:47]
s_add_u32 s44, s44, 1
s_cmp_eq_u32 s44, 3
s_mov_b32 s56, 40960
s_cmov_b32 s56, -81920
s_cselect_b32 s44, 0, s44
v_add_u32 v64, s56, v64
s_waitcnt vmcnt(10) lgkmcnt(2)
s_barrier
ds_read_b128 v[8:11], v64 offset:0
v_mfma_f32_32x32x16_bf16 v[32:47], v[16:19], v[244:247], v[32:47]
s_waitcnt lgkmcnt(2)
ds_read_b128 v[12:15], v64 offset:1024
v_mfma_f32_32x32x16_bf16 v[32:47], v[20:23], v[248:251], v[32:47]
s_waitcnt lgkmcnt(2)
ds_read_b128 v[16:19], v64 offset:2048
v_mfma_f32_32x32x16_bf16 v[32:47], v[24:27], v[252:255], v[32:47]
s_waitcnt lgkmcnt(2)
ds_read_b128 v[20:23], v64 offset:3072
v_mfma_f32_32x32x16_bf16 v[48:63], v[8:11], v[96:99], 0
s_waitcnt lgkmcnt(2)
ds_read_b128 v[24:27], v64 offset:4096
v_mfma_f32_32x32x16_bf16 v[48:63], v[12:15], v[100:103], v[48:63]
s_waitcnt lgkmcnt(2)
ds_read_b128 v[8:11], v64 offset:5120
v_cvt_pk_bf16_f32 v32, v32, v33
v_cvt_pk_bf16_f32 v33, v34, v35
v_mfma_f32_32x32x16_bf16 v[48:63], v[16:19], v[104:107], v[48:63]
s_waitcnt lgkmcnt(2)
ds_read_b128 v[12:15], v64 offset:6144
v_cvt_pk_bf16_f32 v34, v36, v37
v_cvt_pk_bf16_f32 v35, v38, v39
v_mfma_f32_32x32x16_bf16 v[48:63], v[20:23], v[108:111], v[48:63]
s_waitcnt lgkmcnt(2)
ds_read_b128 v[16:19], v64 offset:7168
v_cvt_pk_bf16_f32 v36, v40, v41
v_cvt_pk_bf16_f32 v37, v42, v43
v_mfma_f32_32x32x16_bf16 v[48:63], v[24:27], v[112:115], v[48:63]
s_waitcnt lgkmcnt(2)
ds_read_b128 v[20:23], v64 offset:8192
v_cvt_pk_bf16_f32 v38, v44, v45
v_cvt_pk_bf16_f32 v39, v46, v47
v_mfma_f32_32x32x16_bf16 v[48:63], v[8:11], v[116:119], v[48:63]
s_waitcnt lgkmcnt(2)
ds_read_b128 v[24:27], v64 offset:9216
v_accvgpr_write_b32 a144, v32
v_accvgpr_write_b32 a145, v33
v_mfma_f32_32x32x16_bf16 v[48:63], v[12:15], v[120:123], v[48:63]
s_waitcnt lgkmcnt(2)
ds_read_b128 v[8:11], v64 offset:10240
v_accvgpr_write_b32 a146, v34
v_accvgpr_write_b32 a147, v35
v_mfma_f32_32x32x16_bf16 v[48:63], v[16:19], v[124:127], v[48:63]
s_waitcnt lgkmcnt(2)
ds_read_b128 v[12:15], v64 offset:11264
v_accvgpr_write_b32 a148, v36
v_accvgpr_write_b32 a149, v37
v_mfma_f32_32x32x16_bf16 v[48:63], v[20:23], v[128:131], v[48:63]
s_waitcnt lgkmcnt(2)
ds_read_b128 v[16:19], v64 offset:12288
v_accvgpr_write_b32 a150, v38
v_accvgpr_write_b32 a151, v39
v_mfma_f32_32x32x16_bf16 v[48:63], v[24:27], v[132:135], v[48:63]
s_waitcnt lgkmcnt(2)
ds_read_b128 v[20:23], v64 offset:13312
s_add_u32 m0, s45, 0
s_add_u32 s55, s46, 0
buffer_load_dwordx4 v0, s[4:7], s55 offen offset:0 sc1 lds
buffer_load_dwordx4 v0, s[4:7], s55 offen offset:1024 sc1 lds
v_mfma_f32_32x32x16_bf16 v[48:63], v[8:11], v[136:139], v[48:63]
s_waitcnt lgkmcnt(2)
ds_read_b128 v[24:27], v64 offset:14336
buffer_load_dwordx4 v0, s[4:7], s55 offen offset:2048 sc1 lds
buffer_load_dwordx4 v0, s[4:7], s55 offen offset:3072 sc1 lds
v_mfma_f32_32x32x16_bf16 v[48:63], v[12:15], v[140:143], v[48:63]
s_waitcnt lgkmcnt(2)
ds_read_b128 v[8:11], v64 offset:15360
s_add_u32 m0, s45, 4096
s_add_u32 s55, s46, 4096
buffer_load_dwordx4 v0, s[4:7], s55 offen offset:0 sc1 lds
buffer_load_dwordx4 v0, s[4:7], s55 offen offset:1024 sc1 lds
v_mfma_f32_32x32x16_bf16 v[48:63], v[16:19], v[144:147], v[48:63]
s_waitcnt lgkmcnt(2)
ds_read_b128 v[12:15], v64 offset:16384
buffer_load_dwordx4 v0, s[4:7], s55 offen offset:2048 sc1 lds
buffer_load_dwordx4 v0, s[4:7], s55 offen offset:3072 sc1 lds
v_mfma_f32_32x32x16_bf16 v[48:63], v[20:23], v[148:151], v[48:63]
s_waitcnt lgkmcnt(2)
ds_read_b128 v[16:19], v64 offset:17408
s_add_u32 m0, s45, 8192
s_add_u32 s55, s46, 8192
buffer_load_dwordx4 v0, s[4:7], s55 offen offset:0 sc1 lds
buffer_load_dwordx4 v0, s[4:7], s55 offen offset:1024 sc1 lds
v_mfma_f32_32x32x16_bf16 v[48:63], v[24:27], v[152:155], v[48:63]
s_waitcnt lgkmcnt(2)
ds_read_b128 v[20:23], v64 offset:18432
s_add_u32 s45, s45, 40960
s_cmp_ge_u32 s45, 122880
s_cselect_b32 s55, 122880, 0
s_sub_u32 s45, s45, s55
s_add_u32 s46, s46, 40960
v_mfma_f32_32x32x16_bf16 v[48:63], v[8:11], v[156:159], v[48:63]
s_waitcnt lgkmcnt(2)
ds_read_b128 v[24:27], v64 offset:19456
v_mfma_f32_32x32x16_bf16 v[48:63], v[12:15], v[160:163], v[48:63]
s_waitcnt lgkmcnt(2)
ds_read_b128 v[8:11], v64 offset:20480
v_mfma_f32_32x32x16_bf16 v[48:63], v[16:19], v[164:167], v[48:63]
s_waitcnt lgkmcnt(2)
ds_read_b128 v[12:15], v64 offset:21504
v_mfma_f32_32x32x16_bf16 v[48:63], v[20:23], v[168:171], v[48:63]
s_waitcnt lgkmcnt(2)
ds_read_b128 v[16:19], v64 offset:22528
v_mfma_f32_32x32x16_bf16 v[48:63], v[24:27], v[172:175], v[48:63]
s_waitcnt lgkmcnt(2)
ds_read_b128 v[20:23], v64 offset:23552
v_mfma_f32_32x32x16_bf16 v[48:63], v[8:11], v[176:179], v[48:63]
s_waitcnt lgkmcnt(2)
ds_read_b128 v[24:27], v64 offset:24576
v_mfma_f32_32x32x16_bf16 v[48:63], v[12:15], v[180:183], v[48:63]
s_waitcnt lgkmcnt(2)
ds_read_b128 v[8:11], v64 offset:25600
v_mfma_f32_32x32x16_bf16 v[48:63], v[16:19], v[184:187], v[48:63]
s_waitcnt lgkmcnt(2)
ds_read_b128 v[12:15], v64 offset:26624
v_mfma_f32_32x32x16_bf16 v[48:63], v[20:23], v[188:191], v[48:63]
s_waitcnt lgkmcnt(2)
ds_read_b128 v[16:19], v64 offset:27648
v_mfma_f32_32x32x16_bf16 v[48:63], v[24:27], v[192:195], v[48:63]
s_waitcnt lgkmcnt(2)
ds_read_b128 v[20:23], v64 offset:28672
v_mfma_f32_32x32x16_bf16 v[48:63], v[8:11], v[196:199], v[48:63]
s_waitcnt lgkmcnt(2)
ds_read_b128 v[24:27], v64 offset:29696
v_mfma_f32_32x32x16_bf16 v[48:63], v[12:15], v[200:203], v[48:63]
s_waitcnt lgkmcnt(2)
ds_read_b128 v[8:11], v64 offset:30720
v_mfma_f32_32x32x16_bf16 v[48:63], v[16:19], v[204:207], v[48:63]
s_waitcnt lgkmcnt(2)
ds_read_b128 v[12:15], v64 offset:31744
v_mfma_f32_32x32x16_bf16 v[48:63], v[20:23], v[208:211], v[48:63]
s_waitcnt lgkmcnt(2)
ds_read_b128 v[16:19], v64 offset:32768
v_mfma_f32_32x32x16_bf16 v[48:63], v[24:27], v[212:215], v[48:63]
s_waitcnt lgkmcnt(2)
ds_read_b128 v[20:23], v64 offset:33792
v_mfma_f32_32x32x16_bf16 v[48:63], v[8:11], v[216:219], v[48:63]
s_waitcnt lgkmcnt(2)
ds_read_b128 v[24:27], v64 offset:34816
v_mfma_f32_32x32x16_bf16 v[48:63], v[12:15], v[220:223], v[48:63]
s_waitcnt lgkmcnt(2)
ds_read_b128 v[8:11], v64 offset:35840
v_mfma_f32_32x32x16_bf16 v[48:63], v[16:19], v[224:227], v[48:63]
s_waitcnt lgkmcnt(2)
ds_read_b128 v[12:15], v64 offset:36864
v_mfma_f32_32x32x16_bf16 v[48:63], v[20:23], v[228:231], v[48:63]
s_waitcnt lgkmcnt(2)
ds_read_b128 v[16:19], v64 offset:37888
v_mfma_f32_32x32x16_bf16 v[48:63], v[24:27], v[232:235], v[48:63]
s_waitcnt lgkmcnt(2)
ds_read_b128 v[20:23], v64 offset:38912
v_mfma_f32_32x32x16_bf16 v[48:63], v[8:11], v[236:239], v[48:63]
s_waitcnt lgkmcnt(2)
ds_read_b128 v[24:27], v64 offset:39936
v_mfma_f32_32x32x16_bf16 v[48:63], v[12:15], v[240:243], v[48:63]
s_add_u32 s44, s44, 1
s_cmp_eq_u32 s44, 3
s_mov_b32 s56, 40960
s_cmov_b32 s56, -81920
s_cselect_b32 s44, 0, s44
v_add_u32 v64, s56, v64
s_waitcnt vmcnt(10) lgkmcnt(2)
s_barrier
ds_read_b128 v[8:11], v64 offset:0
v_mfma_f32_32x32x16_bf16 v[48:63], v[16:19], v[244:247], v[48:63]
s_waitcnt lgkmcnt(2)
ds_read_b128 v[12:15], v64 offset:1024
v_mfma_f32_32x32x16_bf16 v[48:63], v[20:23], v[248:251], v[48:63]
s_waitcnt lgkmcnt(2)
ds_read_b128 v[16:19], v64 offset:2048
v_mfma_f32_32x32x16_bf16 v[48:63], v[24:27], v[252:255], v[48:63]
s_waitcnt lgkmcnt(2)
ds_read_b128 v[20:23], v64 offset:3072
s_nop 9
v_cvt_pk_bf16_f32 v48, v48, v49
v_cvt_pk_bf16_f32 v49, v50, v51
v_cvt_pk_bf16_f32 v50, v52, v53
v_cvt_pk_bf16_f32 v51, v54, v55
v_cvt_pk_bf16_f32 v52, v56, v57
v_cvt_pk_bf16_f32 v53, v58, v59
v_cvt_pk_bf16_f32 v54, v60, v61
v_cvt_pk_bf16_f32 v55, v62, v63
v_accvgpr_write_b32 a152, v48
v_accvgpr_write_b32 a153, v49
v_accvgpr_write_b32 a154, v50
v_accvgpr_write_b32 a155, v51
v_accvgpr_write_b32 a156, v52
v_accvgpr_write_b32 a157, v53
v_accvgpr_write_b32 a158, v54
v_accvgpr_write_b32 a159, v55
v_bfe_u32 v72, v0, 8, 1
v_and_b32 v1, 0xf0, v0
v_lshl_add_u32 v1, v72, 10, v1
v_and_b32 v2, 0x50, v0
v_lshl_add_u32 v2, v72, 13, v2
v_bfe_u32 v72, v0, 7, 1
v_lshl_add_u32 v2, v72, 5, v2
v_bfe_u32 v72, v0, 5, 1
v_lshl_add_u32 v2, v72, 12, v2
s_cmp_eq_u32 s58, 0
s_cselect_b64 vcc, -1, 0
v_cndmask_b32 v1, v1, v2, vcc
v_lshrrev_b32 v72, 9, v0
v_lshl_add_u32 v1, v72, 8, v1
s_lshl_b32 s52, s3, 10
v_add_u32 v73, s52, v0
v_mov_b32 v2, 2146435072
v_cmp_eq_u32 vcc, 0, v73
s_nop 1
v_cndmask_b32 v2, v2, 0, vcc
v_mov_b32 v3, 0xffff
v_cmp_gt_u32 vcc, 512, v73
s_nop 1
v_cndmask_b32 v3, -1, v3, vcc
v_and_b32 v7, 0x1f0, v0
v_lshrrev_b32 v28, 2, v7
v_lshlrev_b32 v7, 1, v7
v_add_u32 v7, 122880, v7
s_lshl_b32 s52, s3, 3
v_lshl_add_u32 v6, v72, 2, v7
v_add_u32 v6, s52, v6
s_lshl_b32 s52, s3, 7
s_add_u32 s52, s52, 124928
v_add_u32 v28, s52, v28
v_lshlrev_b32 v29, 4, v72
v_add_u32 v29, s52, v29
s_mov_b32 s51, 0
s_mov_b32 s50, 0
k_lay_27:
s_lshl_b32 s54, s51, 13
s_add_u32 s54, s54, 222298112
s_waitcnt vmcnt(0) lgkmcnt(0)
s_cmp_lg_u32 s3, 0
s_cbranch_scc1 k_w8d_31
v_lshlrev_b32 v8, 2, v0
k_w8_30:
buffer_load_dword v9, v8, s[4:7], s54 offen sc1
buffer_load_dword v10, v8, s[4:7], s54 offen offset:1024 sc1
s_waitcnt vmcnt(0)
v_and_b32 v9, v9, v10
v_cmp_eq_u32 vcc, 0, v9
s_cbranch_vccz k_w8d_31
s_sleep 1
s_sub_u32 s32, s32, 1
s_cmp_gt_i32 s32, 0
s_cbranch_scc1 k_w8_30
k_w8d_31:
s_barrier
s_mul_i32 s52, s3, 10240
v_add_u32 v5, s52, v0
s_mul_i32 s46, s51, 3145728
s_add_u32 s46, s46, s52
s_add_u32 s46, s46, 195035136
s_lshl_b32 s52, s57, 2
s_add_u32 s52, s52, s3
s_cmp_eq_u32 s58, 2
s_cselect_b32 s53, 11, 12
s_mov_b32 s49, 524288
s_cmov_b32 s49, 262144
s_lshl_b32 s48, s52, s53
s_lshr_b32 s52, s3, 1
s_mul_i32 s52, s52, 768
s_mul_i32 s53, s3, 3968
s_sub_u32 s52, s53, s52
s_cmp_eq_u32 s58, 0
s_cselect_b32 s52, s52, 0
s_sub_u32 s48, s48, s52
s_cmp_eq_u32 s58, 2
s_mov_b32 s52, 41943040
s_cmov_b32 s52, 16777216
s_cselect_b32 s53, 125829120, 0
s_mul_i32 s52, s52, s51
s_add_u32 s48, s48, s52
s_add_u32 s48, s48, s53
s_lshl_b32 s60, s57, 6
s_lshl_b32 s52, s58, 2
s_add_u32 s60, s60, s52
s_add_u32 s60, s60, 222330880
s_mov_b32 s61, 0x3acccccd
s_cmp_eq_u32 s58, 1
s_cbranch_scc1 k_isv_28
s_mul_i32 s45, s3, 10240
s_mov_b32 s44, 0
v_mov_b32 v64, v0
s_add_u32 m0, s45, 0
s_add_u32 s55, s46, 0
buffer_load_dwordx4 v0, s[4:7], s55 offen offset:0 sc1 lds
buffer_load_dwordx4 v0, s[4:7], s55 offen offset:1024 sc1 lds
buffer_load_dwordx4 v0, s[4:7], s55 offen offset:2048 sc1 lds
buffer_load_dwordx4 v0, s[4:7], s55 offen offset:3072 sc1 lds
s_add_u32 m0, s45, 4096
s_add_u32 s55, s46, 4096
buffer_load_dwordx4 v0, s[4:7], s55 offen offset:0 sc1 lds
buffer_load_dwordx4 v0, s[4:7], s55 offen offset:1024 sc1 lds
buffer_load_dwordx4 v0, s[4:7], s55 offen offset:2048 sc1 lds
buffer_load_dwordx4 v0, s[4:7], s55 offen offset:3072 sc1 lds
s_add_u32 m0, s45, 8192
s_add_u32 s55, s46, 8192
buffer_load_dwordx4 v0, s[4:7], s55 offen offset:0 sc1 lds
buffer_load_dwordx4 v0, s[4:7], s55 offen offset:1024 sc1 lds
s_add_u32 s45, s45, 40960
s_cmp_ge_u32 s45, 122880
s_cselect_b32 s55, 122880, 0
s_sub_u32 s45, s45, s55
s_add_u32 s46, s46, 40960
s_add_u32 m0, s45, 0
s_add_u32 s55, s46, 0
buffer_load_dwordx4 v0, s[4:7], s55 offen offset:0 sc1 lds
buffer_load_dwordx4 v0, s[4:7], s55 offen offset:1024 sc1 lds
buffer_load_dwordx4 v0, s[4:7], s55 offen offset:2048 sc1 lds
buffer_load_dwordx4 v0, s[4:7], s55 offen offset:3072 sc1 lds
s_add_u32 m0, s45, 4096
s_add_u32 s55, s46, 4096
buffer_load_dwordx4 v0, s[4:7], s55 offen offset:0 sc1 lds
buffer_load_dwordx4 v0, s[4:7], s55 offen offset:1024 sc1 lds
buffer_load_dwordx4 v0, s[4:7], s55 offen offset:2048 sc1 lds
buffer_load_dwordx4 v0, s[4:7], s55 offen offset:3072 sc1 lds
s_add_u32 m0, s45, 8192
s_add_u32 s55, s46, 8192
buffer_load_dwordx4 v0, s[4:7], s55 offen offset:0 sc1 lds
buffer_load_dwordx4 v0, s[4:7], s55 offen offset:1024 sc1 lds
s_add_u32 s45, s45, 40960
s_cmp_ge_u32 s45, 122880
s_cselect_b32 s55, 122880, 0
s_sub_u32 s45, s45, s55
s_add_u32 s46, s46, 40960
s_waitcnt vmcnt(10)
s_barrier
ds_read_b128 v[8:11], v64 offset:0
ds_read_b128 v[12:15], v64 offset:1024
ds_read_b128 v[16:19], v64 offset:2048
ds_read_b128 v[20:23], v64 offset:3072
s_mov_b32 s59, 32
s_waitcnt lgkmcnt(3)
v_mfma_f32_32x32x16_bf16 v[32:47], a[0:3], v[8:11], 0
s_waitcnt lgkmcnt(2)
ds_read_b128 v[24:27], v64 offset:4096
v_mfma_f32_32x32x16_bf16 v[32:47], a[4:7], v[12:15], v[32:47]
s_waitcnt lgkmcnt(2)
ds_read_b128 v[8:11], v64 offset:5120
ds_read_b128 v[72:75], v5
v_mov_b32 v4, 0
ds_read_b128 v[76:79], v5 offset:1024
v_mfma_f32_32x32x16_bf16 v[32:47], a[8:11], v[16:19], v[32:47]
s_waitcnt lgkmcnt(4)
ds_read_b128 v[12:15], v64 offset:6144
s_waitcnt lgkmcnt(2)
v_and_b32 v72, v3, v72
v_dot2c_f32_bf16 v4, v72, v72
v_dot2c_f32_bf16 v4, v73, v73
v_dot2c_f32_bf16 v4, v74, v74
v_dot2c_f32_bf16 v4, v75, v75
v_mfma_f32_32x32x16_bf16 v[32:47], a[12:15], v[20:23], v[32:47]
ds_read_b128 v[16:19], v64 offset:7168
ds_read_b128 v[72:75], v5 offset:2048
s_waitcnt lgkmcnt(3)
v_dot2c_f32_bf16 v4, v76, v76
v_dot2c_f32_bf16 v4, v77, v77
v_dot2c_f32_bf16 v4, v78, v78
v_dot2c_f32_bf16 v4, v79, v79
v_mfma_f32_32x32x16_bf16 v[32:47], a[16:19], v[24:27], v[32:47]
ds_read_b128 v[20:23], v64 offset:8192
ds_read_b128 v[76:79], v5 offset:3072
s_waitcnt lgkmcnt(2)
v_dot2c_f32_bf16 v4, v72, v72
v_dot2c_f32_bf16 v4, v73, v73
v_dot2c_f32_bf16 v4, v74, v74
v_dot2c_f32_bf16 v4, v75, v75
v_mfma_f32_32x32x16_bf16 v[32:47], a[20:23], v[8:11], v[32:47]
ds_read_b128 v[24:27], v64 offset:9216
ds_read_b128 v[72:75], v5 offset:4096
s_waitcnt lgkmcnt(2)
v_dot2c_f32_bf16 v4, v76, v76
v_dot2c_f32_bf16 v4, v77, v77
v_dot2c_f32_bf16 v4, v78, v78
v_dot2c_f32_bf16 v4, v79, v79
v_mfma_f32_32x32x16_bf16 v[32:47], a[24:27], v[12:15], v[32:47]
ds_read_b128 v[8:11], v64 offset:10240
ds_read_b128 v[76:79], v5 offset:5120
s_waitcnt lgkmcnt(2)
v_dot2c_f32_bf16 v4, v72, v72
v_dot2c_f32_bf16 v4, v73, v73
v_dot2c_f32_bf16 v4, v74, v74
v_dot2c_f32_bf16 v4, v75, v75
v_mfma_f32_32x32x16_bf16 v[32:47], a[28:31], v[16:19], v[32:47]
ds_read_b128 v[12:15], v64 offset:11264
ds_read_b128 v[72:75], v5 offset:6144
s_waitcnt lgkmcnt(2)
v_dot2c_f32_bf16 v4, v76, v76
v_dot2c_f32_bf16 v4, v77, v77
v_dot2c_f32_bf16 v4, v78, v78
v_dot2c_f32_bf16 v4, v79, v79
v_mfma_f32_32x32x16_bf16 v[32:47], a[32:35], v[20:23], v[32:47]
ds_read_b128 v[16:19], v64 offset:12288
ds_read_b128 v[76:79], v5 offset:7168
s_waitcnt lgkmcnt(2)
v_dot2c_f32_bf16 v4, v72, v72
v_dot2c_f32_bf16 v4, v73, v73
v_dot2c_f32_bf16 v4, v74, v74
v_dot2c_f32_bf16 v4, v75, v75
v_mfma_f32_32x32x16_bf16 v[32:47], a[36:39], v[24:27], v[32:47]
ds_read_b128 v[20:23], v64 offset:13312
ds_read_b128 v[72:75], v5 offset:8192
s_waitcnt lgkmcnt(2)
v_dot2c_f32_bf16 v4, v76, v76
v_dot2c_f32_bf16 v4, v77, v77
v_dot2c_f32_bf16 v4, v78, v78
v_dot2c_f32_bf16 v4, v79, v79
v_mfma_f32_32x32x16_bf16 v[32:47], a[40:43], v[8:11], v[32:47]
ds_read_b128 v[24:27], v64 offset:14336
ds_read_b128 v[76:79], v5 offset:9216
s_waitcnt lgkmcnt(2)
v_dot2c_f32_bf16 v4, v72, v72
v_dot2c_f32_bf16 v4, v73, v73
v_dot2c_f32_bf16 v4, v74, v74
v_dot2c_f32_bf16 v4, v75, v75
v_mfma_f32_32x32x16_bf16 v[32:47], a[44:47], v[12:15], v[32:47]
ds_read_b128 v[8:11], v64 offset:15360
s_waitcnt lgkmcnt(1)
v_dot2c_f32_bf16 v4, v76, v76
v_dot2c_f32_bf16 v4, v77, v77
v_dot2c_f32_bf16 v4, v78, v78
v_dot2c_f32_bf16 v4, v79, v79
s_nop 2
ds_write_b32 v6, v4 offset:0
v_mfma_f32_32x32x16_bf16 v[32:47], a[48:51], v[16:19], v[32:47]
ds_read_b128 v[12:15], v64 offset:16384
s_add_u32 m0, s45, 0
s_add_u32 s55, s46, 0
buffer_load_dwordx4 v0, s[4:7], s55 offen offset:0 sc1 lds
buffer_load_dwordx4 v0, s[4:7], s55 offen offset:1024 sc1 lds
v_mfma_f32_32x32x16_bf16 v[32:47], a[52:55], v[20:23], v[32:47]
ds_read_b128 v[16:19], v64 offset:17408
buffer_load_dwordx4 v0, s[4:7], s55 offen offset:2048 sc1 lds
buffer_load_dwordx4 v0, s[4:7], s55 offen offset:3072 sc1 lds
v_mfma_f32_32x32x16_bf16 v[32:47], a[56:59], v[24:27], v[32:47]
s_waitcnt lgkmcnt(3)
ds_read_b128 v[20:23], v64 offset:18432
s_add_u32 m0, s45, 4096
s_add_u32 s55, s46, 4096
buffer_load_dwordx4 v0, s[4:7], s55 offen offset:0 sc1 lds
buffer_load_dwordx4 v0, s[4:7], s55 offen offset:1024 sc1 lds
v_mfma_f32_32x32x16_bf16 v[32:47], a[60:63], v[8:11], v[32:47]
s_waitcnt lgkmcnt(2)
ds_read_b128 v[24:27], v64 offset:19456
buffer_load_dwordx4 v0, s[4:7], s55 offen offset:2048 sc1 lds
buffer_load_dwordx4 v0, s[4:7], s55 offen offset:3072 sc1 lds
v_mfma_f32_32x32x16_bf16 v[32:47], a[64:67], v[12:15], v[32:47]
s_waitcnt lgkmcnt(2)
ds_read_b128 v[8:11], v64 offset:20480
s_add_u32 m0, s45, 8192
s_add_u32 s55, s46, 8192
buffer_load_dwordx4 v0, s[4:7], s55 offen offset:0 sc1 lds
buffer_load_dwordx4 v0, s[4:7], s55 offen offset:1024 sc1 lds
v_mfma_f32_32x32x16_bf16 v[32:47], a[68:71], v[16:19], v[32:47]
s_waitcnt lgkmcnt(2)
ds_read_b128 v[12:15], v64 offset:21504
s_add_u32 s45, s45, 40960
s_cmp_ge_u32 s45, 122880
s_cselect_b32 s55, 122880, 0
s_sub_u32 s45, s45, s55
s_add_u32 s46, s46, 40960
v_mfma_f32_32x32x16_bf16 v[32:47], a[72:75], v[20:23], v[32:47]
s_waitcnt lgkmcnt(2)
ds_read_b128 v[16:19], v64 offset:22528
v_mfma_f32_32x32x16_bf16 v[32:47], a[76:79], v[24:27], v[32:47]
s_waitcnt lgkmcnt(2)
ds_read_b128 v[20:23], v64 offset:23552
v_mfma_f32_32x32x16_bf16 v[32:47], a[80:83], v[8:11], v[32:47]
s_waitcnt lgkmcnt(2)
ds_read_b128 v[24:27], v64 offset:24576
v_mfma_f32_32x32x16_bf16 v[32:47], a[84:87], v[12:15], v[32:47]
s_waitcnt lgkmcnt(2)
ds_read_b128 v[8:11], v64 offset:25600
v_mfma_f32_32x32x16_bf16 v[32:47], a[88:91], v[16:19], v[32:47]
s_waitcnt lgkmcnt(2)
ds_read_b128 v[12:15], v64 offset:26624
v_mfma_f32_32x32x16_bf16 v[32:47], a[92:95], v[20:23], v[32:47]
s_waitcnt lgkmcnt(2)
ds_read_b128 v[16:19], v64 offset:27648
v_mfma_f32_32x32x16_bf16 v[32:47], a[96:99], v[24:27], v[32:47]
s_waitcnt lgkmcnt(2)
ds_read_b128 v[20:23], v64 offset:28672
v_mfma_f32_32x32x16_bf16 v[32:47], a[100:103], v[8:11], v[32:47]
s_waitcnt lgkmcnt(2)
ds_read_b128 v[24:27], v64 offset:29696
v_mfma_f32_32x32x16_bf16 v[32:47], a[104:107], v[12:15], v[32:47]
s_waitcnt lgkmcnt(2)
ds_read_b128 v[8:11], v64 offset:30720
v_mfma_f32_32x32x16_bf16 v[32:47], a[108:111], v[16:19], v[32:47]
s_waitcnt lgkmcnt(2)
ds_read_b128 v[12:15], v64 offset:31744
v_mfma_f32_32x32x16_bf16 v[32:47], a[112:115], v[20:23], v[32:47]
s_waitcnt lgkmcnt(2)
ds_read_b128 v[16:19], v64 offset:32768
v_mfma_f32_32x32x16_bf16 v[32:47], a[116:119], v[24:27], v[32:47]
s_waitcnt lgkmcnt(2)
ds_read_b128 v[20:23], v64 offset:33792
v_mfma_f32_32x32x16_bf16 v[32:47], a[120:123], v[8:11], v[32:47]
s_waitcnt lgkmcnt(2)
ds_read_b128 v[24:27], v64 offset:34816
v_mfma_f32_32x32x16_bf16 v[32:47], a[124:127], v[12:15], v[32:47]
s_waitcnt lgkmcnt(2)
ds_read_b128 v[8:11], v64 offset:35840
v_mfma_f32_32x32x16_bf16 v[32:47], a[128:131], v[16:19], v[32:47]
s_waitcnt lgkmcnt(2)
ds_read_b128 v[12:15], v64 offset:36864
v_mfma_f32_32x32x16_bf16 v[32:47], a[132:135], v[20:23], v[32:47]
s_waitcnt lgkmcnt(2)
ds_read_b128 v[16:19], v64 offset:37888
v_mfma_f32_32x32x16_bf16 v[32:47], a[136:139], v[24:27], v[32:47]
s_waitcnt lgkmcnt(2)
ds_read_b128 v[20:23], v64 offset:38912
v_mfma_f32_32x32x16_bf16 v[32:47], a[140:143], v[8:11], v[32:47]
s_waitcnt lgkmcnt(2)
ds_read_b128 v[24:27], v64 offset:39936
v_mfma_f32_32x32x16_bf16 v[32:47], a[144:147], v[12:15], v[32:47]
s_add_u32 s44, s44, 1
s_cmp_eq_u32 s44, 3
s_mov_b32 s56, 40960
s_cmov_b32 s56, -81920
s_cselect_b32 s44, 0, s44
v_add_u32 v64, s56, v64
v_add_u32 v5, s56, v5
s_waitcnt vmcnt(10) lgkmcnt(2)
s_barrier
ds_read_b128 v[8:11], v64 offset:0
v_mfma_f32_32x32x16_bf16 v[32:47], a[148:151], v[16:19], v[32:47]
s_waitcnt lgkmcnt(2)
ds_read_b128 v[12:15], v64 offset:1024
v_mfma_f32_32x32x16_bf16 v[32:47], a[152:155], v[20:23], v[32:47]
s_waitcnt lgkmcnt(2)
ds_read_b128 v[16:19], v64 offset:2048
v_mfma_f32_32x32x16_bf16 v[32:47], a[156:159], v[24:27], v[32:47]
s_waitcnt lgkmcnt(2)
ds_read_b128 v[20:23], v64 offset:3072
k_st_32:
v_mfma_f32_32x32x16_bf16 v[48:63], a[0:3], v[8:11], 0
s_waitcnt lgkmcnt(2)
ds_read_b128 v[24:27], v64 offset:4096
v_mfma_f32_32x32x16_bf16 v[48:63], a[4:7], v[12:15], v[48:63]
s_waitcnt lgkmcnt(2)
ds_read_b128 v[8:11], v64 offset:5120
ds_read_b128 v[80:83], v7 offset:0
ds_read_b128 v[84:87], v7 offset:16
v_mov_b32 v88, 0x3727c5ac
v_mfma_f32_32x32x16_bf16 v[48:63], a[8:11], v[16:19], v[48:63]
s_waitcnt lgkmcnt(4)
ds_read_b128 v[12:15], v64 offset:6144
s_waitcnt lgkmcnt(1)
v_add_f32 v80, v80, v84
v_add_f32 v81, v81, v85
v_add_f32 v82, v82, v86
v_add_f32 v83, v83, v87
v_add_f32 v80, v80, v81
v_add_f32 v82, v82, v83
v_add_f32 v80, v80, v82
v_mfma_f32_32x32x16_bf16 v[48:63], a[12:15], v[20:23], v[48:63]
ds_read_b128 v[16:19], v64 offset:7168
v_fma_f32 v80, v80, s61, v88
v_rsq_f32 v80, v80
s_nop 0
v_mul_f32 v32, v80, v32
v_mul_f32 v33, v80, v33
v_cvt_pk_bf16_f32 v32, v32, v33
v_mfma_f32_32x32x16_bf16 v[48:63], a[16:19], v[24:27], v[48:63]
ds_read_b128 v[20:23], v64 offset:8192
v_mul_f32 v34, v80, v34
v_mul_f32 v35, v80, v35
v_cvt_pk_bf16_f32 v33, v34, v35
v_mul_f32 v36, v80, v36
v_mul_f32 v37, v80, v37
v_cvt_pk_bf16_f32 v34, v36, v37
v_mfma_f32_32x32x16_bf16 v[48:63], a[20:23], v[8:11], v[48:63]
s_waitcnt lgkmcnt(2)
ds_read_b128 v[24:27], v64 offset:9216
v_mul_f32 v38, v80, v38
v_mul_f32 v39, v80, v39
v_cvt_pk_bf16_f32 v35, v38, v39
v_mul_f32 v40, v80, v40
v_mul_f32 v41, v80, v41
v_cvt_pk_bf16_f32 v36, v40, v41
v_mfma_f32_32x32x16_bf16 v[48:63], a[24:27], v[12:15], v[48:63]
s_waitcnt lgkmcnt(2)
ds_read_b128 v[8:11], v64 offset:10240
v_mul_f32 v42, v80, v42
v_mul_f32 v43, v80, v43
v_cvt_pk_bf16_f32 v37, v42, v43
v_mul_f32 v44, v80, v44
v_mul_f32 v45, v80, v45
v_cvt_pk_bf16_f32 v38, v44, v45
v_mfma_f32_32x32x16_bf16 v[48:63], a[28:31], v[16:19], v[48:63]
s_waitcnt lgkmcnt(2)
ds_read_b128 v[12:15], v64 offset:11264
v_mul_f32 v46, v80, v46
v_mul_f32 v47, v80, v47
v_cvt_pk_bf16_f32 v39, v46, v47
buffer_store_dwordx4 v[32:35], v1, s[4:7], s48 offen offset:0 sc1
v_mfma_f32_32x32x16_bf16 v[48:63], a[32:35], v[20:23], v[48:63]
s_waitcnt lgkmcnt(2)
ds_read_b128 v[16:19], v64 offset:12288
buffer_store_dwordx4 v[36:39], v1, s[4:7], s48 offen offset:512 sc1
s_add_u32 s48, s48, s49
v_mfma_f32_32x32x16_bf16 v[48:63], a[36:39], v[24:27], v[48:63]
s_waitcnt lgkmcnt(2)
ds_read_b128 v[20:23], v64 offset:13312
ds_read_b128 v[72:75], v5
v_mov_b32 v4, 0
ds_read_b128 v[76:79], v5 offset:1024
v_mfma_f32_32x32x16_bf16 v[48:63], a[40:43], v[8:11], v[48:63]
s_waitcnt lgkmcnt(4)
ds_read_b128 v[24:27], v64 offset:14336
s_waitcnt lgkmcnt(2)
v_and_b32 v72, v3, v72
v_dot2c_f32_bf16 v4, v72, v72
v_dot2c_f32_bf16 v4, v73, v73
v_dot2c_f32_bf16 v4, v74, v74
v_dot2c_f32_bf16 v4, v75, v75
v_mfma_f32_32x32x16_bf16 v[48:63], a[44:47], v[12:15], v[48:63]
ds_read_b128 v[8:11], v64 offset:15360
ds_read_b128 v[72:75], v5 offset:2048
s_waitcnt lgkmcnt(3)
v_dot2c_f32_bf16 v4, v76, v76
v_dot2c_f32_bf16 v4, v77, v77
v_dot2c_f32_bf16 v4, v78, v78
v_dot2c_f32_bf16 v4, v79, v79
v_mfma_f32_32x32x16_bf16 v[48:63], a[48:51], v[16:19], v[48:63]
ds_read_b128 v[12:15], v64 offset:16384
ds_read_b128 v[76:79], v5 offset:3072
s_waitcnt lgkmcnt(2)
v_dot2c_f32_bf16 v4, v72, v72
v_dot2c_f32_bf16 v4, v73, v73
v_dot2c_f32_bf16 v4, v74, v74
v_dot2c_f32_bf16 v4, v75, v75
v_mfma_f32_32x32x16_bf16 v[48:63], a[52:55], v[20:23], v[48:63]
ds_read_b128 v[16:19], v64 offset:17408
ds_read_b128 v[72:75], v5 offset:4096
s_waitcnt lgkmcnt(2)
v_dot2c_f32_bf16 v4, v76, v76
v_dot2c_f32_bf16 v4, v77, v77
v_dot2c_f32_bf16 v4, v78, v78
v_dot2c_f32_bf16 v4, v79, v79
v_mfma_f32_32x32x16_bf16 v[48:63], a[56:59], v[24:27], v[48:63]
ds_read_b128 v[20:23], v64 offset:18432
ds_read_b128 v[76:79], v5 offset:5120
s_waitcnt lgkmcnt(2)
v_dot2c_f32_bf16 v4, v72, v72
v_dot2c_f32_bf16 v4, v73, v73
v_dot2c_f32_bf16 v4, v74, v74
v_dot2c_f32_bf16 v4, v75, v75
v_mfma_f32_32x32x16_bf16 v[48:63], a[60:63], v[8:11], v[48:63]
ds_read_b128 v[24:27], v64 offset:19456
ds_read_b128 v[72:75], v5 offset:6144
s_waitcnt lgkmcnt(2)
v_dot2c_f32_bf16 v4, v76, v76
v_dot2c_f32_bf16 v4, v77, v77
v_dot2c_f32_bf16 v4, v78, v78
v_dot2c_f32_bf16 v4, v79, v79
v_mfma_f32_32x32x16_bf16 v[48:63], a[64:67], v[12:15], v[48:63]
ds_read_b128 v[8:11], v64 offset:20480
ds_read_b128 v[76:79], v5 offset:7168
s_waitcnt lgkmcnt(2)
v_dot2c_f32_bf16 v4, v72, v72
v_dot2c_f32_bf16 v4, v73, v73
v_dot2c_f32_bf16 v4, v74, v74
v_dot2c_f32_bf16 v4, v75, v75
v_mfma_f32_32x32x16_bf16 v[48:63], a[68:71], v[16:19], v[48:63]
ds_read_b128 v[12:15], v64 offset:21504
ds_read_b128 v[72:75], v5 offset:8192
s_waitcnt lgkmcnt(2)
v_dot2c_f32_bf16 v4, v76, v76
v_dot2c_f32_bf16 v4, v77, v77
v_dot2c_f32_bf16 v4, v78, v78
v_dot2c_f32_bf16 v4, v79, v79
v_mfma_f32_32x32x16_bf16 v[48:63], a[72:75], v[20:23], v[48:63]
ds_read_b128 v[16:19], v64 offset:22528
ds_read_b128 v[76:79], v5 offset:9216
s_waitcnt lgkmcnt(2)
v_dot2c_f32_bf16 v4, v72, v72
v_dot2c_f32_bf16 v4, v73, v73
v_dot2c_f32_bf16 v4, v74, v74
v_dot2c_f32_bf16 v4, v75, v75
v_mfma_f32_32x32x16_bf16 v[48:63], a[76:79], v[24:27], v[48:63]
ds_read_b128 v[20:23], v64 offset:23552
s_waitcnt lgkmcnt(1)
v_dot2c_f32_bf16 v4, v76, v76
v_dot2c_f32_bf16 v4, v77, v77
v_dot2c_f32_bf16 v4, v78, v78
v_dot2c_f32_bf16 v4, v79, v79
s_nop 2
ds_write_b32 v6, v4 offset:1024
v_mfma_f32_32x32x16_bf16 v[48:63], a[80:83], v[8:11], v[48:63]
ds_read_b128 v[24:27], v64 offset:24576
s_add_u32 m0, s45, 0
s_add_u32 s55, s46, 0
buffer_load_dwordx4 v0, s[4:7], s55 offen offset:0 sc1 lds
buffer_load_dwordx4 v0, s[4:7], s55 offen offset:1024 sc1 lds
v_mfma_f32_32x32x16_bf16 v[48:63], a[84:87], v[12:15], v[48:63]
ds_read_b128 v[8:11], v64 offset:25600
buffer_load_dwordx4 v0, s[4:7], s55 offen offset:2048 sc1 lds
buffer_load_dwordx4 v0, s[4:7], s55 offen offset:3072 sc1 lds
v_mfma_f32_32x32x16_bf16 v[48:63], a[88:91], v[16:19], v[48:63]
s_waitcnt lgkmcnt(3)
ds_read_b128 v[12:15], v64 offset:26624
s_add_u32 m0, s45, 4096
s_add_u32 s55, s46, 4096
buffer_load_dwordx4 v0, s[4:7], s55 offen offset:0 sc1 lds
buffer_load_dwordx4 v0, s[4:7], s55 offen offset:1024 sc1 lds
v_mfma_f32_32x32x16_bf16 v[48:63], a[92:95], v[20:23], v[48:63]
s_waitcnt lgkmcnt(2)
ds_read_b128 v[16:19], v64 offset:27648
buffer_load_dwordx4 v0, s[4:7], s55 offen offset:2048 sc1 lds
buffer_load_dwordx4 v0, s[4:7], s55 offen offset:3072 sc1 lds
v_mfma_f32_32x32x16_bf16 v[48:63], a[96:99], v[24:27], v[48:63]
s_waitcnt lgkmcnt(2)
ds_read_b128 v[20:23], v64 offset:28672
s_add_u32 m0, s45, 8192
s_add_u32 s55, s46, 8192
buffer_load_dwordx4 v0, s[4:7], s55 offen offset:0 sc1 lds
buffer_load_dwordx4 v0, s[4:7], s55 offen offset:1024 sc1 lds
v_mfma_f32_32x32x16_bf16 v[48:63], a[100:103], v[8:11], v[48:63]
s_waitcnt lgkmcnt(2)
ds_read_b128 v[24:27], v64 offset:29696
s_add_u32 s45, s45, 40960
s_cmp_ge_u32 s45, 122880
s_cselect_b32 s55, 122880, 0
s_sub_u32 s45, s45, s55
s_add_u32 s46, s46, 40960
v_mfma_f32_32x32x16_bf16 v[48:63], a[104:107], v[12:15], v[48:63]
s_waitcnt lgkmcnt(2)
ds_read_b128 v[8:11], v64 offset:30720
v_mfma_f32_32x32x16_bf16 v[48:63], a[108:111], v[16:19], v[48:63]
s_waitcnt lgkmcnt(2)
ds_read_b128 v[12:15], v64 offset:31744
v_mfma_f32_32x32x16_bf16 v[48:63], a[112:115], v[20:23], v[48:63]
s_waitcnt lgkmcnt(2)
ds_read_b128 v[16:19], v64 offset:32768
v_mfma_f32_32x32x16_bf16 v[48:63], a[116:119], v[24:27], v[48:63]
s_waitcnt lgkmcnt(2)
ds_read_b128 v[20:23], v64 offset:33792
v_mfma_f32_32x32x16_bf16 v[48:63], a[120:123], v[8:11], v[48:63]
s_waitcnt lgkmcnt(2)
ds_read_b128 v[24:27], v64 offset:34816
v_mfma_f32_32x32x16_bf16 v[48:63], a[124:127], v[12:15], v[48:63]
s_waitcnt lgkmcnt(2)
ds_read_b128 v[8:11], v64 offset:35840
v_mfma_f32_32x32x16_bf16 v[48:63], a[128:131], v[16:19], v[48:63]
s_waitcnt lgkmcnt(2)
ds_read_b128 v[12:15], v64 offset:36864
v_mfma_f32_32x32x16_bf16 v[48:63], a[132:135], v[20:23], v[48:63]
s_waitcnt lgkmcnt(2)
ds_read_b128 v[16:19], v64 offset:37888
v_mfma_f32_32x32x16_bf16 v[48:63], a[136:139], v[24:27], v[48:63]
s_waitcnt lgkmcnt(2)
ds_read_b128 v[20:23], v64 offset:38912
v_mfma_f32_32x32x16_bf16 v[48:63], a[140:143], v[8:11], v[48:63]
s_waitcnt lgkmcnt(2)
ds_read_b128 v[24:27], v64 offset:39936
v_mfma_f32_32x32x16_bf16 v[48:63], a[144:147], v[12:15], v[48:63]
s_add_u32 s44, s44, 1
s_cmp_eq_u32 s44, 3
s_mov_b32 s56, 40960
s_cmov_b32 s56, -81920
s_cselect_b32 s44, 0, s44
v_add_u32 v64, s56, v64
v_add_u32 v5, s56, v5
s_waitcnt vmcnt(10) lgkmcnt(2)
s_barrier
s_add_u32 s50, s50, 1
v_mov_b32 v4, s50
buffer_store_dword v4, v2, s[4:7], s60 offen sc1
ds_read_b128 v[8:11], v64 offset:0
v_mfma_f32_32x32x16_bf16 v[48:63], a[148:151], v[16:19], v[48:63]
s_waitcnt lgkmcnt(2)
ds_read_b128 v[12:15], v64 offset:1024
v_mfma_f32_32x32x16_bf16 v[48:63], a[152:155], v[20:23], v[48:63]
s_waitcnt lgkmcnt(2)
ds_read_b128 v[16:19], v64 offset:2048
v_mfma_f32_32x32x16_bf16 v[48:63], a[156:159], v[24:27], v[48:63]
s_waitcnt lgkmcnt(2)
ds_read_b128 v[20:23], v64 offset:3072
s_sub_u32 s59, s59, 1
s_cmp_eq_u32 s59, 0
s_cbranch_scc1 k_so_33
v_mfma_f32_32x32x16_bf16 v[32:47], a[0:3], v[8:11], 0
s_waitcnt lgkmcnt(2)
ds_read_b128 v[24:27], v64 offset:4096
v_mfma_f32_32x32x16_bf16 v[32:47], a[4:7], v[12:15], v[32:47]
s_waitcnt lgkmcnt(2)
ds_read_b128 v[8:11], v64 offset:5120
ds_read_b128 v[80:83], v7 offset:1024
ds_read_b128 v[84:87], v7 offset:1040
v_mov_b32 v88, 0x3727c5ac
v_mfma_f32_32x32x16_bf16 v[32:47], a[8:11], v[16:19], v[32:47]
s_waitcnt lgkmcnt(4)
ds_read_b128 v[12:15], v64 offset:6144
s_waitcnt lgkmcnt(1)
v_add_f32 v80, v80, v84
v_add_f32 v81, v81, v85
v_add_f32 v82, v82, v86
v_add_f32 v83, v83, v87
v_add_f32 v80, v80, v81
v_add_f32 v82, v82, v83
v_add_f32 v80, v80, v82
v_mfma_f32_32x32x16_bf16 v[32:47], a[12:15], v[20:23], v[32:47]
ds_read_b128 v[16:19], v64 offset:7168
v_fma_f32 v80, v80, s61, v88
v_rsq_f32 v80, v80
s_nop 0
v_mul_f32 v48, v80, v48
v_mul_f32 v49, v80, v49
v_cvt_pk_bf16_f32 v48, v48, v49
v_mfma_f32_32x32x16_bf16 v[32:47], a[16:19], v[24:27], v[32:47]
ds_read_b128 v[20:23], v64 offset:8192
v_mul_f32 v50, v80, v50
v_mul_f32 v51, v80, v51
v_cvt_pk_bf16_f32 v49, v50, v51
v_mul_f32 v52, v80, v52
v_mul_f32 v53, v80, v53
v_cvt_pk_bf16_f32 v50, v52, v53
v_mfma_f32_32x32x16_bf16 v[32:47], a[20:23], v[8:11], v[32:47]
s_waitcnt lgkmcnt(2)
ds_read_b128 v[24:27], v64 offset:9216
v_mul_f32 v54, v80, v54
v_mul_f32 v55, v80, v55
v_cvt_pk_bf16_f32 v51, v54, v55
v_mul_f32 v56, v80, v56
v_mul_f32 v57, v80, v57
v_cvt_pk_bf16_f32 v52, v56, v57
v_mfma_f32_32x32x16_bf16 v[32:47], a[24:27], v[12:15], v[32:47]
s_waitcnt lgkmcnt(2)
ds_read_b128 v[8:11], v64 offset:10240
v_mul_f32 v58, v80, v58
v_mul_f32 v59, v80, v59
v_cvt_pk_bf16_f32 v53, v58, v59
v_mul_f32 v60, v80, v60
v_mul_f32 v61, v80, v61
v_cvt_pk_bf16_f32 v54, v60, v61
v_mfma_f32_32x32x16_bf16 v[32:47], a[28:31], v[16:19], v[32:47]
s_waitcnt lgkmcnt(2)
ds_read_b128 v[12:15], v64 offset:11264
v_mul_f32 v62, v80, v62
v_mul_f32 v63, v80, v63
v_cvt_pk_bf16_f32 v55, v62, v63
buffer_store_dwordx4 v[48:51], v1, s[4:7], s48 offen offset:0 sc1
v_mfma_f32_32x32x16_bf16 v[32:47], a[32:35], v[20:23], v[32:47]
s_waitcnt lgkmcnt(2)
ds_read_b128 v[16:19], v64 offset:12288
buffer_store_dwordx4 v[52:55], v1, s[4:7], s48 offen offset:512 sc1
s_add_u32 s48, s48, s49
v_mfma_f32_32x32x16_bf16 v[32:47], a[36:39], v[24:27], v[32:47]
s_waitcnt lgkmcnt(2)
ds_read_b128 v[20:23], v64 offset:13312
ds_read_b128 v[72:75], v5
v_mov_b32 v4, 0
ds_read_b128 v[76:79], v5 offset:1024
v_mfma_f32_32x32x16_bf16 v[32:47], a[40:43], v[8:11], v[32:47]
s_waitcnt lgkmcnt(4)
ds_read_b128 v[24:27], v64 offset:14336
s_waitcnt lgkmcnt(2)
v_and_b32 v72, v3, v72
v_dot2c_f32_bf16 v4, v72, v72
v_dot2c_f32_bf16 v4, v73, v73
v_dot2c_f32_bf16 v4, v74, v74
v_dot2c_f32_bf16 v4, v75, v75
v_mfma_f32_32x32x16_bf16 v[32:47], a[44:47], v[12:15], v[32:47]
ds_read_b128 v[8:11], v64 offset:15360
ds_read_b128 v[72:75], v5 offset:2048
s_waitcnt lgkmcnt(3)
v_dot2c_f32_bf16 v4, v76, v76
v_dot2c_f32_bf16 v4, v77, v77
v_dot2c_f32_bf16 v4, v78, v78
v_dot2c_f32_bf16 v4, v79, v79
v_mfma_f32_32x32x16_bf16 v[32:47], a[48:51], v[16:19], v[32:47]
ds_read_b128 v[12:15], v64 offset:16384
ds_read_b128 v[76:79], v5 offset:3072
s_waitcnt lgkmcnt(2)
v_dot2c_f32_bf16 v4, v72, v72
v_dot2c_f32_bf16 v4, v73, v73
v_dot2c_f32_bf16 v4, v74, v74
v_dot2c_f32_bf16 v4, v75, v75
v_mfma_f32_32x32x16_bf16 v[32:47], a[52:55], v[20:23], v[32:47]
ds_read_b128 v[16:19], v64 offset:17408
ds_read_b128 v[72:75], v5 offset:4096
s_waitcnt lgkmcnt(2)
v_dot2c_f32_bf16 v4, v76, v76
v_dot2c_f32_bf16 v4, v77, v77
v_dot2c_f32_bf16 v4, v78, v78
v_dot2c_f32_bf16 v4, v79, v79
v_mfma_f32_32x32x16_bf16 v[32:47], a[56:59], v[24:27], v[32:47]
ds_read_b128 v[20:23], v64 offset:18432
ds_read_b128 v[76:79], v5 offset:5120
s_waitcnt lgkmcnt(2)
v_dot2c_f32_bf16 v4, v72, v72
v_dot2c_f32_bf16 v4, v73, v73
v_dot2c_f32_bf16 v4, v74, v74
v_dot2c_f32_bf16 v4, v75, v75
v_mfma_f32_32x32x16_bf16 v[32:47], a[60:63], v[8:11], v[32:47]
ds_read_b128 v[24:27], v64 offset:19456
ds_read_b128 v[72:75], v5 offset:6144
s_waitcnt lgkmcnt(2)
v_dot2c_f32_bf16 v4, v76, v76
v_dot2c_f32_bf16 v4, v77, v77
v_dot2c_f32_bf16 v4, v78, v78
v_dot2c_f32_bf16 v4, v79, v79
v_mfma_f32_32x32x16_bf16 v[32:47], a[64:67], v[12:15], v[32:47]
ds_read_b128 v[8:11], v64 offset:20480
ds_read_b128 v[76:79], v5 offset:7168
s_waitcnt lgkmcnt(2)
v_dot2c_f32_bf16 v4, v72, v72
v_dot2c_f32_bf16 v4, v73, v73
v_dot2c_f32_bf16 v4, v74, v74
v_dot2c_f32_bf16 v4, v75, v75
v_mfma_f32_32x32x16_bf16 v[32:47], a[68:71], v[16:19], v[32:47]
ds_read_b128 v[12:15], v64 offset:21504
ds_read_b128 v[72:75], v5 offset:8192
s_waitcnt lgkmcnt(2)
v_dot2c_f32_bf16 v4, v76, v76
v_dot2c_f32_bf16 v4, v77, v77
v_dot2c_f32_bf16 v4, v78, v78
v_dot2c_f32_bf16 v4, v79, v79
v_mfma_f32_32x32x16_bf16 v[32:47], a[72:75], v[20:23], v[32:47]
ds_read_b128 v[16:19], v64 offset:22528
ds_read_b128 v[76:79], v5 offset:9216
s_waitcnt lgkmcnt(2)
v_dot2c_f32_bf16 v4, v72, v72
v_dot2c_f32_bf16 v4, v73, v73
v_dot2c_f32_bf16 v4, v74, v74
v_dot2c_f32_bf16 v4, v75, v75
v_mfma_f32_32x32x16_bf16 v[32:47], a[76:79], v[24:27], v[32:47]
ds_read_b128 v[20:23], v64 offset:23552
s_waitcnt lgkmcnt(1)
v_dot2c_f32_bf16 v4, v76, v76
v_dot2c_f32_bf16 v4, v77, v77
v_dot2c_f32_bf16 v4, v78, v78
v_dot2c_f32_bf16 v4, v79, v79
s_nop 2
ds_write_b32 v6, v4 offset:0
v_mfma_f32_32x32x16_bf16 v[32:47], a[80:83], v[8:11], v[32:47]
ds_read_b128 v[24:27], v64 offset:24576
s_add_u32 m0, s45, 0
s_add_u32 s55, s46, 0
buffer_load_dwordx4 v0, s[4:7], s55 offen offset:0 sc1 lds
buffer_load_dwordx4 v0, s[4:7], s55 offen offset:1024 sc1 lds
v_mfma_f32_32x32x16_bf16 v[32:47], a[84:87], v[12:15], v[32:47]
ds_read_b128 v[8:11], v64 offset:25600
buffer_load_dwordx4 v0, s[4:7], s55 offen offset:2048 sc1 lds
buffer_load_dwordx4 v0, s[4:7], s55 offen offset:3072 sc1 lds
v_mfma_f32_32x32x16_bf16 v[32:47], a[88:91], v[16:19], v[32:47]
s_waitcnt lgkmcnt(3)
ds_read_b128 v[12:15], v64 offset:26624
s_add_u32 m0, s45, 4096
s_add_u32 s55, s46, 4096
buffer_load_dwordx4 v0, s[4:7], s55 offen offset:0 sc1 lds
buffer_load_dwordx4 v0, s[4:7], s55 offen offset:1024 sc1 lds
v_mfma_f32_32x32x16_bf16 v[32:47], a[92:95], v[20:23], v[32:47]
s_waitcnt lgkmcnt(2)
ds_read_b128 v[16:19], v64 offset:27648
buffer_load_dwordx4 v0, s[4:7], s55 offen offset:2048 sc1 lds
buffer_load_dwordx4 v0, s[4:7], s55 offen offset:3072 sc1 lds
v_mfma_f32_32x32x16_bf16 v[32:47], a[96:99], v[24:27], v[32:47]
s_waitcnt lgkmcnt(2)
ds_read_b128 v[20:23], v64 offset:28672
s_add_u32 m0, s45, 8192
s_add_u32 s55, s46, 8192
buffer_load_dwordx4 v0, s[4:7], s55 offen offset:0 sc1 lds
buffer_load_dwordx4 v0, s[4:7], s55 offen offset:1024 sc1 lds
v_mfma_f32_32x32x16_bf16 v[32:47], a[100:103], v[8:11], v[32:47]
s_waitcnt lgkmcnt(2)
ds_read_b128 v[24:27], v64 offset:29696
s_add_u32 s45, s45, 40960
s_cmp_ge_u32 s45, 122880
s_cselect_b32 s55, 122880, 0
s_sub_u32 s45, s45, s55
s_add_u32 s46, s46, 40960
v_mfma_f32_32x32x16_bf16 v[32:47], a[104:107], v[12:15], v[32:47]
s_waitcnt lgkmcnt(2)
ds_read_b128 v[8:11], v64 offset:30720
v_mfma_f32_32x32x16_bf16 v[32:47], a[108:111], v[16:19], v[32:47]
s_waitcnt lgkmcnt(2)
ds_read_b128 v[12:15], v64 offset:31744
v_mfma_f32_32x32x16_bf16 v[32:47], a[112:115], v[20:23], v[32:47]
s_waitcnt lgkmcnt(2)
ds_read_b128 v[16:19], v64 offset:32768
v_mfma_f32_32x32x16_bf16 v[32:47], a[116:119], v[24:27], v[32:47]
s_waitcnt lgkmcnt(2)
ds_read_b128 v[20:23], v64 offset:33792
v_mfma_f32_32x32x16_bf16 v[32:47], a[120:123], v[8:11], v[32:47]
s_waitcnt lgkmcnt(2)
ds_read_b128 v[24:27], v64 offset:34816
v_mfma_f32_32x32x16_bf16 v[32:47], a[124:127], v[12:15], v[32:47]
s_waitcnt lgkmcnt(2)
ds_read_b128 v[8:11], v64 offset:35840
v_mfma_f32_32x32x16_bf16 v[32:47], a[128:131], v[16:19], v[32:47]
s_waitcnt lgkmcnt(2)
ds_read_b128 v[12:15], v64 offset:36864
v_mfma_f32_32x32x16_bf16 v[32:47], a[132:135], v[20:23], v[32:47]
s_waitcnt lgkmcnt(2)
ds_read_b128 v[16:19], v64 offset:37888
v_mfma_f32_32x32x16_bf16 v[32:47], a[136:139], v[24:27], v[32:47]
s_waitcnt lgkmcnt(2)
ds_read_b128 v[20:23], v64 offset:38912
v_mfma_f32_32x32x16_bf16 v[32:47], a[140:143], v[8:11], v[32:47]
s_waitcnt lgkmcnt(2)
ds_read_b128 v[24:27], v64 offset:39936
v_mfma_f32_32x32x16_bf16 v[32:47], a[144:147], v[12:15], v[32:47]
s_add_u32 s44, s44, 1
s_cmp_eq_u32 s44, 3
s_mov_b32 s56, 40960
s_cmov_b32 s56, -81920
s_cselect_b32 s44, 0, s44
v_add_u32 v64, s56, v64
v_add_u32 v5, s56, v5
s_waitcnt vmcnt(10) lgkmcnt(2)
s_barrier
s_add_u32 s50, s50, 1
v_mov_b32 v4, s50
buffer_store_dword v4, v2, s[4:7], s60 offen sc1
ds_read_b128 v[8:11], v64 offset:0
v_mfma_f32_32x32x16_bf16 v[32:47], a[148:151], v[16:19], v[32:47]
s_waitcnt lgkmcnt(2)
ds_read_b128 v[12:15], v64 offset:1024
v_mfma_f32_32x32x16_bf16 v[32:47], a[152:155], v[20:23], v[32:47]
s_waitcnt lgkmcnt(2)
ds_read_b128 v[16:19], v64 offset:2048
v_mfma_f32_32x32x16_bf16 v[32:47], a[156:159], v[24:27], v[32:47]
s_waitcnt lgkmcnt(2)
ds_read_b128 v[20:23], v64 offset:3072
s_branch k_st_32
k_so_33:
ds_read_b128 v[80:83], v7 offset:1024
ds_read_b128 v[84:87], v7 offset:1040
v_mov_b32 v88, 0x3727c5ac
s_waitcnt lgkmcnt(0)
v_add_f32 v80, v80, v84
v_add_f32 v81, v81, v85
v_add_f32 v82, v82, v86
v_add_f32 v83, v83, v87
v_add_f32 v80, v80, v81
v_add_f32 v82, v82, v83
v_add_f32 v80, v80, v82
v_fma_f32 v80, v80, s61, v88
v_rsq_f32 v80, v80
s_nop 0
v_mul_f32 v48, v80, v48
v_mul_f32 v49, v80, v49
v_cvt_pk_bf16_f32 v48, v48, v49
v_mul_f32 v50, v80, v50
v_mul_f32 v51, v80, v51
v_cvt_pk_bf16_f32 v49, v50, v51
v_mul_f32 v52, v80, v52
v_mul_f32 v53, v80, v53
v_cvt_pk_bf16_f32 v50, v52, v53
v_mul_f32 v54, v80, v54
v_mul_f32 v55, v80, v55
v_cvt_pk_bf16_f32 v51, v54, v55
v_mul_f32 v56, v80, v56
v_mul_f32 v57, v80, v57
v_cvt_pk_bf16_f32 v52, v56, v57
v_mul_f32 v58, v80, v58
v_mul_f32 v59, v80, v59
v_cvt_pk_bf16_f32 v53, v58, v59
v_mul_f32 v60, v80, v60
v_mul_f32 v61, v80, v61
v_cvt_pk_bf16_f32 v54, v60, v61
v_mul_f32 v62, v80, v62
v_mul_f32 v63, v80, v63
v_cvt_pk_bf16_f32 v55, v62, v63
buffer_store_dwordx4 v[48:51], v1, s[4:7], s48 offen offset:0 sc1
buffer_store_dwordx4 v[52:55], v1, s[4:7], s48 offen offset:512 sc1
s_add_u32 s48, s48, s49
s_branch k_join_29
k_isv_28:
s_mul_i32 s45, s3, 10240
s_mov_b32 s44, 0
v_mov_b32 v64, v0
s_add_u32 m0, s45, 0
s_add_u32 s55, s46, 0
buffer_load_dwordx4 v0, s[4:7], s55 offen offset:0 sc1 lds
buffer_load_dwordx4 v0, s[4:7], s55 offen offset:1024 sc1 lds
buffer_load_dwordx4 v0, s[4:7], s55 offen offset:2048 sc1 lds
buffer_load_dwordx4 v0, s[4:7], s55 offen offset:3072 sc1 lds
s_add_u32 m0, s45, 4096
s_add_u32 s55, s46, 4096
buffer_load_dwordx4 v0, s[4:7], s55 offen offset:0 sc1 lds
buffer_load_dwordx4 v0, s[4:7], s55 offen offset:1024 sc1 lds
buffer_load_dwordx4 v0, s[4:7], s55 offen offset:2048 sc1 lds
buffer_load_dwordx4 v0, s[4:7], s55 offen offset:3072 sc1 lds
s_add_u32 m0, s45, 8192
s_add_u32 s55, s46, 8192
buffer_load_dwordx4 v0, s[4:7], s55 offen offset:0 sc1 lds
buffer_load_dwordx4 v0, s[4:7], s55 offen offset:1024 sc1 lds
s_add_u32 s45, s45, 40960
s_cmp_ge_u32 s45, 122880
s_cselect_b32 s55, 122880, 0
s_sub_u32 s45, s45, s55
s_add_u32 s46, s46, 40960
s_add_u32 m0, s45, 0
s_add_u32 s55, s46, 0
buffer_load_dwordx4 v0, s[4:7], s55 offen offset:0 sc1 lds
buffer_load_dwordx4 v0, s[4:7], s55 offen offset:1024 sc1 lds
buffer_load_dwordx4 v0, s[4:7], s55 offen offset:2048 sc1 lds
buffer_load_dwordx4 v0, s[4:7], s55 offen offset:3072 sc1 lds
s_add_u32 m0, s45, 4096
s_add_u32 s55, s46, 4096
buffer_load_dwordx4 v0, s[4:7], s55 offen offset:0 sc1 lds
buffer_load_dwordx4 v0, s[4:7], s55 offen offset:1024 sc1 lds
buffer_load_dwordx4 v0, s[4:7], s55 offen offset:2048 sc1 lds
buffer_load_dwordx4 v0, s[4:7], s55 offen offset:3072 sc1 lds
s_add_u32 m0, s45, 8192
s_add_u32 s55, s46, 8192
buffer_load_dwordx4 v0, s[4:7], s55 offen offset:0 sc1 lds
buffer_load_dwordx4 v0, s[4:7], s55 offen offset:1024 sc1 lds
s_add_u32 s45, s45, 40960
s_cmp_ge_u32 s45, 122880
s_cselect_b32 s55, 122880, 0
s_sub_u32 s45, s45, s55
s_add_u32 s46, s46, 40960
s_waitcnt vmcnt(10)
s_barrier
ds_read_b128 v[8:11], v64 offset:0
ds_read_b128 v[12:15], v64 offset:1024
ds_read_b128 v[16:19], v64 offset:2048
ds_read_b128 v[20:23], v64 offset:3072
s_mov_b32 s59, 32
s_waitcnt lgkmcnt(3)
v_mfma_f32_32x32x16_bf16 v[32:47], v[8:11], a[0:3], 0
s_waitcnt lgkmcnt(2)
ds_read_b128 v[24:27], v64 offset:4096
v_mfma_f32_32x32x16_bf16 v[32:47], v[12:15], a[4:7], v[32:47]
s_waitcnt lgkmcnt(2)
ds_read_b128 v[8:11], v64 offset:5120
ds_read_b128 v[72:75], v5
v_mov_b32 v4, 0
ds_read_b128 v[76:79], v5 offset:1024
v_mfma_f32_32x32x16_bf16 v[32:47], v[16:19], a[8:11], v[32:47]
s_waitcnt lgkmcnt(4)
ds_read_b128 v[12:15], v64 offset:6144
s_waitcnt lgkmcnt(2)
v_and_b32 v72, v3, v72
v_dot2c_f32_bf16 v4, v72, v72
v_dot2c_f32_bf16 v4, v73, v73
v_dot2c_f32_bf16 v4, v74, v74
v_dot2c_f32_bf16 v4, v75, v75
v_mfma_f32_32x32x16_bf16 v[32:47], v[20:23], a[12:15], v[32:47]
ds_read_b128 v[16:19], v64 offset:7168
ds_read_b128 v[72:75], v5 offset:2048
s_waitcnt lgkmcnt(3)
v_dot2c_f32_bf16 v4, v76, v76
v_dot2c_f32_bf16 v4, v77, v77
v_dot2c_f32_bf16 v4, v78, v78
v_dot2c_f32_bf16 v4, v79, v79
v_mfma_f32_32x32x16_bf16 v[32:47], v[24:27], a[16:19], v[32:47]
ds_read_b128 v[20:23], v64 offset:8192
ds_read_b128 v[76:79], v5 offset:3072
s_waitcnt lgkmcnt(2)
v_dot2c_f32_bf16 v4, v72, v72
v_dot2c_f32_bf16 v4, v73, v73
v_dot2c_f32_bf16 v4, v74, v74
v_dot2c_f32_bf16 v4, v75, v75
v_mfma_f32_32x32x16_bf16 v[32:47], v[8:11], a[20:23], v[32:47]
ds_read_b128 v[24:27], v64 offset:9216
ds_read_b128 v[72:75], v5 offset:4096
s_waitcnt lgkmcnt(2)
v_dot2c_f32_bf16 v4, v76, v76
v_dot2c_f32_bf16 v4, v77, v77
v_dot2c_f32_bf16 v4, v78, v78
v_dot2c_f32_bf16 v4, v79, v79
v_mfma_f32_32x32x16_bf16 v[32:47], v[12:15], a[24:27], v[32:47]
ds_read_b128 v[8:11], v64 offset:10240
ds_read_b128 v[76:79], v5 offset:5120
s_waitcnt lgkmcnt(2)
v_dot2c_f32_bf16 v4, v72, v72
v_dot2c_f32_bf16 v4, v73, v73
v_dot2c_f32_bf16 v4, v74, v74
v_dot2c_f32_bf16 v4, v75, v75
v_mfma_f32_32x32x16_bf16 v[32:47], v[16:19], a[28:31], v[32:47]
ds_read_b128 v[12:15], v64 offset:11264
ds_read_b128 v[72:75], v5 offset:6144
s_waitcnt lgkmcnt(2)
v_dot2c_f32_bf16 v4, v76, v76
v_dot2c_f32_bf16 v4, v77, v77
v_dot2c_f32_bf16 v4, v78, v78
v_dot2c_f32_bf16 v4, v79, v79
v_mfma_f32_32x32x16_bf16 v[32:47], v[20:23], a[32:35], v[32:47]
ds_read_b128 v[16:19], v64 offset:12288
ds_read_b128 v[76:79], v5 offset:7168
s_waitcnt lgkmcnt(2)
v_dot2c_f32_bf16 v4, v72, v72
v_dot2c_f32_bf16 v4, v73, v73
v_dot2c_f32_bf16 v4, v74, v74
v_dot2c_f32_bf16 v4, v75, v75
v_mfma_f32_32x32x16_bf16 v[32:47], v[24:27], a[36:39], v[32:47]
ds_read_b128 v[20:23], v64 offset:13312
ds_read_b128 v[72:75], v5 offset:8192
s_waitcnt lgkmcnt(2)
v_dot2c_f32_bf16 v4, v76, v76
v_dot2c_f32_bf16 v4, v77, v77
v_dot2c_f32_bf16 v4, v78, v78
v_dot2c_f32_bf16 v4, v79, v79
v_mfma_f32_32x32x16_bf16 v[32:47], v[8:11], a[40:43], v[32:47]
ds_read_b128 v[24:27], v64 offset:14336
ds_read_b128 v[76:79], v5 offset:9216
s_waitcnt lgkmcnt(2)
v_dot2c_f32_bf16 v4, v72, v72
v_dot2c_f32_bf16 v4, v73, v73
v_dot2c_f32_bf16 v4, v74, v74
v_dot2c_f32_bf16 v4, v75, v75
v_mfma_f32_32x32x16_bf16 v[32:47], v[12:15], a[44:47], v[32:47]
ds_read_b128 v[8:11], v64 offset:15360
s_waitcnt lgkmcnt(1)
v_dot2c_f32_bf16 v4, v76, v76
v_dot2c_f32_bf16 v4, v77, v77
v_dot2c_f32_bf16 v4, v78, v78
v_dot2c_f32_bf16 v4, v79, v79
s_nop 2
ds_write_b32 v6, v4 offset:0
v_mfma_f32_32x32x16_bf16 v[32:47], v[16:19], a[48:51], v[32:47]
ds_read_b128 v[12:15], v64 offset:16384
s_add_u32 m0, s45, 0
s_add_u32 s55, s46, 0
buffer_load_dwordx4 v0, s[4:7], s55 offen offset:0 sc1 lds
buffer_load_dwordx4 v0, s[4:7], s55 offen offset:1024 sc1 lds
v_mfma_f32_32x32x16_bf16 v[32:47], v[20:23], a[52:55], v[32:47]
ds_read_b128 v[16:19], v64 offset:17408
buffer_load_dwordx4 v0, s[4:7], s55 offen offset:2048 sc1 lds
buffer_load_dwordx4 v0, s[4:7], s55 offen offset:3072 sc1 lds
v_mfma_f32_32x32x16_bf16 v[32:47], v[24:27], a[56:59], v[32:47]
s_waitcnt lgkmcnt(3)
ds_read_b128 v[20:23], v64 offset:18432
s_add_u32 m0, s45, 4096
s_add_u32 s55, s46, 4096
buffer_load_dwordx4 v0, s[4:7], s55 offen offset:0 sc1 lds
buffer_load_dwordx4 v0, s[4:7], s55 offen offset:1024 sc1 lds
v_mfma_f32_32x32x16_bf16 v[32:47], v[8:11], a[60:63], v[32:47]
s_waitcnt lgkmcnt(2)
ds_read_b128 v[24:27], v64 offset:19456
buffer_load_dwordx4 v0, s[4:7], s55 offen offset:2048 sc1 lds
buffer_load_dwordx4 v0, s[4:7], s55 offen offset:3072 sc1 lds
v_mfma_f32_32x32x16_bf16 v[32:47], v[12:15], a[64:67], v[32:47]
s_waitcnt lgkmcnt(2)
ds_read_b128 v[8:11], v64 offset:20480
s_add_u32 m0, s45, 8192
s_add_u32 s55, s46, 8192
buffer_load_dwordx4 v0, s[4:7], s55 offen offset:0 sc1 lds
buffer_load_dwordx4 v0, s[4:7], s55 offen offset:1024 sc1 lds
v_mfma_f32_32x32x16_bf16 v[32:47], v[16:19], a[68:71], v[32:47]
s_waitcnt lgkmcnt(2)
ds_read_b128 v[12:15], v64 offset:21504
s_add_u32 s45, s45, 40960
s_cmp_ge_u32 s45, 122880
s_cselect_b32 s55, 122880, 0
s_sub_u32 s45, s45, s55
s_add_u32 s46, s46, 40960
v_mfma_f32_32x32x16_bf16 v[32:47], v[20:23], a[72:75], v[32:47]
s_waitcnt lgkmcnt(2)
ds_read_b128 v[16:19], v64 offset:22528
v_mfma_f32_32x32x16_bf16 v[32:47], v[24:27], a[76:79], v[32:47]
s_waitcnt lgkmcnt(2)
ds_read_b128 v[20:23], v64 offset:23552
v_mfma_f32_32x32x16_bf16 v[32:47], v[8:11], a[80:83], v[32:47]
s_waitcnt lgkmcnt(2)
ds_read_b128 v[24:27], v64 offset:24576
v_mfma_f32_32x32x16_bf16 v[32:47], v[12:15], a[84:87], v[32:47]
s_waitcnt lgkmcnt(2)
ds_read_b128 v[8:11], v64 offset:25600
v_mfma_f32_32x32x16_bf16 v[32:47], v[16:19], a[88:91], v[32:47]
s_waitcnt lgkmcnt(2)
ds_read_b128 v[12:15], v64 offset:26624
v_mfma_f32_32x32x16_bf16 v[32:47], v[20:23], a[92:95], v[32:47]
s_waitcnt lgkmcnt(2)
ds_read_b128 v[16:19], v64 offset:27648
v_mfma_f32_32x32x16_bf16 v[32:47], v[24:27], a[96:99], v[32:47]
s_waitcnt lgkmcnt(2)
ds_read_b128 v[20:23], v64 offset:28672
v_mfma_f32_32x32x16_bf16 v[32:47], v[8:11], a[100:103], v[32:47]
s_waitcnt lgkmcnt(2)
ds_read_b128 v[24:27], v64 offset:29696
v_mfma_f32_32x32x16_bf16 v[32:47], v[12:15], a[104:107], v[32:47]
s_waitcnt lgkmcnt(2)
ds_read_b128 v[8:11], v64 offset:30720
v_mfma_f32_32x32x16_bf16 v[32:47], v[16:19], a[108:111], v[32:47]
s_waitcnt lgkmcnt(2)
ds_read_b128 v[12:15], v64 offset:31744
v_mfma_f32_32x32x16_bf16 v[32:47], v[20:23], a[112:115], v[32:47]
s_waitcnt lgkmcnt(2)
ds_read_b128 v[16:19], v64 offset:32768
v_mfma_f32_32x32x16_bf16 v[32:47], v[24:27], a[116:119], v[32:47]
s_waitcnt lgkmcnt(2)
ds_read_b128 v[20:23], v64 offset:33792
v_mfma_f32_32x32x16_bf16 v[32:47], v[8:11], a[120:123], v[32:47]
s_waitcnt lgkmcnt(2)
ds_read_b128 v[24:27], v64 offset:34816
v_mfma_f32_32x32x16_bf16 v[32:47], v[12:15], a[124:127], v[32:47]
s_waitcnt lgkmcnt(2)
ds_read_b128 v[8:11], v64 offset:35840
v_mfma_f32_32x32x16_bf16 v[32:47], v[16:19], a[128:131], v[32:47]
s_waitcnt lgkmcnt(2)
ds_read_b128 v[12:15], v64 offset:36864
v_mfma_f32_32x32x16_bf16 v[32:47], v[20:23], a[132:135], v[32:47]
s_waitcnt lgkmcnt(2)
ds_read_b128 v[16:19], v64 offset:37888
v_mfma_f32_32x32x16_bf16 v[32:47], v[24:27], a[136:139], v[32:47]
s_waitcnt lgkmcnt(2)
ds_read_b128 v[20:23], v64 offset:38912
v_mfma_f32_32x32x16_bf16 v[32:47], v[8:11], a[140:143], v[32:47]
s_waitcnt lgkmcnt(2)
ds_read_b128 v[24:27], v64 offset:39936
v_mfma_f32_32x32x16_bf16 v[32:47], v[12:15], a[144:147], v[32:47]
s_add_u32 s44, s44, 1
s_cmp_eq_u32 s44, 3
s_mov_b32 s56, 40960
s_cmov_b32 s56, -81920
s_cselect_b32 s44, 0, s44
v_add_u32 v64, s56, v64
v_add_u32 v5, s56, v5
s_waitcnt vmcnt(10) lgkmcnt(2)
s_barrier
ds_read_b128 v[8:11], v64 offset:0
v_mfma_f32_32x32x16_bf16 v[32:47], v[16:19], a[148:151], v[32:47]
s_waitcnt lgkmcnt(2)
ds_read_b128 v[12:15], v64 offset:1024
v_mfma_f32_32x32x16_bf16 v[32:47], v[20:23], a[152:155], v[32:47]
s_waitcnt lgkmcnt(2)
ds_read_b128 v[16:19], v64 offset:2048
v_mfma_f32_32x32x16_bf16 v[32:47], v[24:27], a[156:159], v[32:47]
s_waitcnt lgkmcnt(2)
ds_read_b128 v[20:23], v64 offset:3072
k_st_34:
v_mfma_f32_32x32x16_bf16 v[48:63], v[8:11], a[0:3], 0
s_waitcnt lgkmcnt(2)
ds_read_b128 v[24:27], v64 offset:4096
v_mfma_f32_32x32x16_bf16 v[48:63], v[12:15], a[4:7], v[48:63]
s_waitcnt lgkmcnt(2)
ds_read_b128 v[8:11], v64 offset:5120
ds_read_b128 v[80:83], v7 offset:0
ds_read_b128 v[84:87], v7 offset:16
v_mov_b32 v88, 0x3727c5ac
v_mfma_f32_32x32x16_bf16 v[48:63], v[16:19], a[8:11], v[48:63]
s_waitcnt lgkmcnt(4)
ds_read_b128 v[12:15], v64 offset:6144
s_waitcnt lgkmcnt(1)
v_add_f32 v80, v80, v84
v_add_f32 v81, v81, v85
v_add_f32 v82, v82, v86
v_add_f32 v83, v83, v87
v_add_f32 v80, v80, v81
v_add_f32 v82, v82, v83
v_add_f32 v80, v80, v82
v_mfma_f32_32x32x16_bf16 v[48:63], v[20:23], a[12:15], v[48:63]
ds_read_b128 v[16:19], v64 offset:7168
v_fma_f32 v80, v80, s61, v88
v_rsq_f32 v80, v80
ds_write_b32 v28, v80
v_mfma_f32_32x32x16_bf16 v[48:63], v[24:27], a[16:19], v[48:63]
ds_read_b128 v[20:23], v64 offset:8192
ds_read_b128 v[80:83], v29 offset:0
ds_read_b128 v[84:87], v29 offset:32
ds_read_b128 v[88:91], v29 offset:64
ds_read_b128 v[92:95], v29 offset:96
v_mfma_f32_32x32x16_bf16 v[48:63], v[8:11], a[20:23], v[48:63]
s_waitcnt lgkmcnt(7)
ds_read_b128 v[24:27], v64 offset:9216
s_waitcnt lgkmcnt(4)
v_mul_f32 v80, v80, v32
v_mul_f32 v81, v81, v33
v_mul_f32 v82, v82, v34
v_mul_f32 v83, v83, v35
v_mfma_f32_32x32x16_bf16 v[48:63], v[12:15], a[24:27], v[48:63]
ds_read_b128 v[8:11], v64 offset:10240
s_waitcnt lgkmcnt(4)
v_mul_f32 v84, v84, v36
v_mul_f32 v85, v85, v37
v_mul_f32 v86, v86, v38
v_mul_f32 v87, v87, v39
v_mfma_f32_32x32x16_bf16 v[48:63], v[16:19], a[28:31], v[48:63]
ds_read_b128 v[12:15], v64 offset:11264
s_waitcnt lgkmcnt(4)
v_mul_f32 v88, v88, v40
v_mul_f32 v89, v89, v41
v_mul_f32 v90, v90, v42
v_mul_f32 v91, v91, v43
v_mfma_f32_32x32x16_bf16 v[48:63], v[20:23], a[32:35], v[48:63]
s_waitcnt lgkmcnt(2)
ds_read_b128 v[16:19], v64 offset:12288
v_mul_f32 v92, v92, v44
v_mul_f32 v93, v93, v45
v_mul_f32 v94, v94, v46
v_mul_f32 v95, v95, v47
v_mfma_f32_32x32x16_bf16 v[48:63], v[24:27], a[36:39], v[48:63]
s_waitcnt lgkmcnt(2)
ds_read_b128 v[20:23], v64 offset:13312
v_cvt_pk_bf16_f32 v32, v80, v81
v_cvt_pk_bf16_f32 v33, v82, v83
v_mfma_f32_32x32x16_bf16 v[48:63], v[8:11], a[40:43], v[48:63]
s_waitcnt lgkmcnt(2)
ds_read_b128 v[24:27], v64 offset:14336
v_cvt_pk_bf16_f32 v36, v84, v85
v_cvt_pk_bf16_f32 v37, v86, v87
v_mfma_f32_32x32x16_bf16 v[48:63], v[12:15], a[44:47], v[48:63]
s_waitcnt lgkmcnt(2)
ds_read_b128 v[8:11], v64 offset:15360
v_cvt_pk_bf16_f32 v34, v88, v89
v_cvt_pk_bf16_f32 v35, v90, v91
v_mfma_f32_32x32x16_bf16 v[48:63], v[16:19], a[48:51], v[48:63]
s_waitcnt lgkmcnt(2)
ds_read_b128 v[12:15], v64 offset:16384
v_cvt_pk_bf16_f32 v38, v92, v93
v_cvt_pk_bf16_f32 v39, v94, v95
v_mfma_f32_32x32x16_bf16 v[48:63], v[20:23], a[52:55], v[48:63]
s_waitcnt lgkmcnt(2)
ds_read_b128 v[16:19], v64 offset:17408
buffer_store_dwordx4 v[32:35], v1, s[4:7], s48 offen offset:2048 sc1
buffer_store_dwordx4 v[36:39], v1, s[4:7], s48 offen offset:2560 sc1
v_mfma_f32_32x32x16_bf16 v[48:63], v[24:27], a[56:59], v[48:63]
s_waitcnt lgkmcnt(2)
ds_read_b128 v[20:23], v64 offset:18432
s_add_u32 s48, s48, s49
ds_read_b128 v[72:75], v5
v_mov_b32 v4, 0
v_mfma_f32_32x32x16_bf16 v[48:63], v[8:11], a[60:63], v[48:63]
s_waitcnt lgkmcnt(3)
ds_read_b128 v[24:27], v64 offset:19456
ds_read_b128 v[76:79], v5 offset:1024
s_waitcnt lgkmcnt(2)
v_and_b32 v72, v3, v72
v_mfma_f32_32x32x16_bf16 v[48:63], v[12:15], a[64:67], v[48:63]
ds_read_b128 v[8:11], v64 offset:20480
v_dot2c_f32_bf16 v4, v72, v72
v_dot2c_f32_bf16 v4, v73, v73
v_dot2c_f32_bf16 v4, v74, v74
v_dot2c_f32_bf16 v4, v75, v75
ds_read_b128 v[72:75], v5 offset:2048
v_mfma_f32_32x32x16_bf16 v[48:63], v[16:19], a[68:71], v[48:63]
ds_read_b128 v[12:15], v64 offset:21504
s_waitcnt lgkmcnt(3)
v_dot2c_f32_bf16 v4, v76, v76
v_dot2c_f32_bf16 v4, v77, v77
v_dot2c_f32_bf16 v4, v78, v78
v_dot2c_f32_bf16 v4, v79, v79
ds_read_b128 v[76:79], v5 offset:3072
v_mfma_f32_32x32x16_bf16 v[48:63], v[20:23], a[72:75], v[48:63]
ds_read_b128 v[16:19], v64 offset:22528
s_waitcnt lgkmcnt(3)
v_dot2c_f32_bf16 v4, v72, v72
v_dot2c_f32_bf16 v4, v73, v73
v_dot2c_f32_bf16 v4, v74, v74
v_dot2c_f32_bf16 v4, v75, v75
ds_read_b128 v[72:75], v5 offset:4096
v_mfma_f32_32x32x16_bf16 v[48:63], v[24:27], a[76:79], v[48:63]
ds_read_b128 v[20:23], v64 offset:23552
s_waitcnt lgkmcnt(3)
v_dot2c_f32_bf16 v4, v76, v76
v_dot2c_f32_bf16 v4, v77, v77
v_dot2c_f32_bf16 v4, v78, v78
v_dot2c_f32_bf16 v4, v79, v79
ds_read_b128 v[76:79], v5 offset:5120
v_mfma_f32_32x32x16_bf16 v[48:63], v[8:11], a[80:83], v[48:63]
ds_read_b128 v[24:27], v64 offset:24576
s_waitcnt lgkmcnt(3)
v_dot2c_f32_bf16 v4, v72, v72
v_dot2c_f32_bf16 v4, v73, v73
v_dot2c_f32_bf16 v4, v74, v74
v_dot2c_f32_bf16 v4, v75, v75
ds_read_b128 v[72:75], v5 offset:6144
v_mfma_f32_32x32x16_bf16 v[48:63], v[12:15], a[84:87], v[48:63]
ds_read_b128 v[8:11], v64 offset:25600
s_waitcnt lgkmcnt(3)
v_dot2c_f32_bf16 v4, v76, v76
v_dot2c_f32_bf16 v4, v77, v77
v_dot2c_f32_bf16 v4, v78, v78
v_dot2c_f32_bf16 v4, v79, v79
ds_read_b128 v[76:79], v5 offset:7168
v_mfma_f32_32x32x16_bf16 v[48:63], v[16:19], a[88:91], v[48:63]
ds_read_b128 v[12:15], v64 offset:26624
s_waitcnt lgkmcnt(3)
v_dot2c_f32_bf16 v4, v72, v72
v_dot2c_f32_bf16 v4, v73, v73
v_dot2c_f32_bf16 v4, v74, v74
v_dot2c_f32_bf16 v4, v75, v75
ds_read_b128 v[72:75], v5 offset:8192
v_mfma_f32_32x32x16_bf16 v[48:63], v[20:23], a[92:95], v[48:63]
ds_read_b128 v[16:19], v64 offset:27648
s_waitcnt lgkmcnt(3)
v_dot2c_f32_bf16 v4, v76, v76
v_dot2c_f32_bf16 v4, v77, v77
v_dot2c_f32_bf16 v4, v78, v78
v_dot2c_f32_bf16 v4, v79, v79
ds_read_b128 v[76:79], v5 offset:9216
v_mfma_f32_32x32x16_bf16 v[48:63], v[24:27], a[96:99], v[48:63]
ds_read_b128 v[20:23], v64 offset:28672
s_waitcnt lgkmcnt(3)
v_dot2c_f32_bf16 v4, v72, v72
v_dot2c_f32_bf16 v4, v73, v73
v_dot2c_f32_bf16 v4, v74, v74
v_dot2c_f32_bf16 v4, v75, v75
s_waitcnt lgkmcnt(1)
v_dot2c_f32_bf16 v4, v76, v76
v_dot2c_f32_bf16 v4, v77, v77
v_dot2c_f32_bf16 v4, v78, v78
v_dot2c_f32_bf16 v4, v79, v79
v_mfma_f32_32x32x16_bf16 v[48:63], v[8:11], a[100:103], v[48:63]
ds_read_b128 v[24:27], v64 offset:29696
ds_write_b32 v6, v4 offset:1024
s_add_u32 m0, s45, 0
s_add_u32 s55, s46, 0
buffer_load_dwordx4 v0, s[4:7], s55 offen offset:0 sc1 lds
v_mfma_f32_32x32x16_bf16 v[48:63], v[12:15], a[104:107], v[48:63]
ds_read_b128 v[8:11], v64 offset:30720
buffer_load_dwordx4 v0, s[4:7], s55 offen offset:1024 sc1 lds
buffer_load_dwordx4 v0, s[4:7], s55 offen offset:2048 sc1 lds
v_mfma_f32_32x32x16_bf16 v[48:63], v[16:19], a[108:111], v[48:63]
s_waitcnt lgkmcnt(3)
ds_read_b128 v[12:15], v64 offset:31744
buffer_load_dwordx4 v0, s[4:7], s55 offen offset:3072 sc1 lds
s_add_u32 m0, s45, 4096
s_add_u32 s55, s46, 4096
buffer_load_dwordx4 v0, s[4:7], s55 offen offset:0 sc1 lds
v_mfma_f32_32x32x16_bf16 v[48:63], v[20:23], a[112:115], v[48:63]
s_waitcnt lgkmcnt(3)
ds_read_b128 v[16:19], v64 offset:32768
buffer_load_dwordx4 v0, s[4:7], s55 offen offset:1024 sc1 lds
buffer_load_dwordx4 v0, s[4:7], s55 offen offset:2048 sc1 lds
v_mfma_f32_32x32x16_bf16 v[48:63], v[24:27], a[116:119], v[48:63]
s_waitcnt lgkmcnt(2)
ds_read_b128 v[20:23], v64 offset:33792
buffer_load_dwordx4 v0, s[4:7], s55 offen offset:3072 sc1 lds
s_add_u32 m0, s45, 8192
s_add_u32 s55, s46, 8192
buffer_load_dwordx4 v0, s[4:7], s55 offen offset:0 sc1 lds
v_mfma_f32_32x32x16_bf16 v[48:63], v[8:11], a[120:123], v[48:63]
s_waitcnt lgkmcnt(2)
ds_read_b128 v[24:27], v64 offset:34816
buffer_load_dwordx4 v0, s[4:7], s55 offen offset:1024 sc1 lds
s_add_u32 s45, s45, 40960
s_cmp_ge_u32 s45, 122880
s_cselect_b32 s55, 122880, 0
s_sub_u32 s45, s45, s55
v_mfma_f32_32x32x16_bf16 v[48:63], v[12:15], a[124:127], v[48:63]
s_waitcnt lgkmcnt(2)
ds_read_b128 v[8:11], v64 offset:35840
s_add_u32 s46, s46, 40960
v_mfma_f32_32x32x16_bf16 v[48:63], v[16:19], a[128:131], v[48:63]
s_waitcnt lgkmcnt(2)
ds_read_b128 v[12:15], v64 offset:36864
v_mfma_f32_32x32x16_bf16 v[48:63], v[20:23], a[132:135], v[48:63]
s_waitcnt lgkmcnt(2)
ds_read_b128 v[16:19], v64 offset:37888
v_mfma_f32_32x32x16_bf16 v[48:63], v[24:27], a[136:139], v[48:63]
s_waitcnt lgkmcnt(2)
ds_read_b128 v[20:23], v64 offset:38912
v_mfma_f32_32x32x16_bf16 v[48:63], v[8:11], a[140:143], v[48:63]
s_waitcnt lgkmcnt(2)
ds_read_b128 v[24:27], v64 offset:39936
v_mfma_f32_32x32x16_bf16 v[48:63], v[12:15], a[144:147], v[48:63]
s_add_u32 s44, s44, 1
s_cmp_eq_u32 s44, 3
s_mov_b32 s56, 40960
s_cmov_b32 s56, -81920
s_cselect_b32 s44, 0, s44
v_add_u32 v64, s56, v64
v_add_u32 v5, s56, v5
s_waitcnt vmcnt(10) lgkmcnt(2)
s_barrier
s_add_u32 s50, s50, 1
v_mov_b32 v4, s50
buffer_store_dword v4, v2, s[4:7], s60 offen sc1
ds_read_b128 v[8:11], v64 offset:0
v_mfma_f32_32x32x16_bf16 v[48:63], v[16:19], a[148:151], v[48:63]
s_waitcnt lgkmcnt(2)
ds_read_b128 v[12:15], v64 offset:1024
v_mfma_f32_32x32x16_bf16 v[48:63], v[20:23], a[152:155], v[48:63]
s_waitcnt lgkmcnt(2)
ds_read_b128 v[16:19], v64 offset:2048
v_mfma_f32_32x32x16_bf16 v[48:63], v[24:27], a[156:159], v[48:63]
s_waitcnt lgkmcnt(2)
ds_read_b128 v[20:23], v64 offset:3072
s_sub_u32 s59, s59, 1
s_cmp_eq_u32 s59, 0
s_cbranch_scc1 k_so_35
v_mfma_f32_32x32x16_bf16 v[32:47], v[8:11], a[0:3], 0
s_waitcnt lgkmcnt(2)
ds_read_b128 v[24:27], v64 offset:4096
v_mfma_f32_32x32x16_bf16 v[32:47], v[12:15], a[4:7], v[32:47]
s_waitcnt lgkmcnt(2)
ds_read_b128 v[8:11], v64 offset:5120
ds_read_b128 v[80:83], v7 offset:1024
ds_read_b128 v[84:87], v7 offset:1040
v_mov_b32 v88, 0x3727c5ac
v_mfma_f32_32x32x16_bf16 v[32:47], v[16:19], a[8:11], v[32:47]
s_waitcnt lgkmcnt(4)
ds_read_b128 v[12:15], v64 offset:6144
s_waitcnt lgkmcnt(1)
v_add_f32 v80, v80, v84
v_add_f32 v81, v81, v85
v_add_f32 v82, v82, v86
v_add_f32 v83, v83, v87
v_add_f32 v80, v80, v81
v_add_f32 v82, v82, v83
v_add_f32 v80, v80, v82
v_mfma_f32_32x32x16_bf16 v[32:47], v[20:23], a[12:15], v[32:47]
ds_read_b128 v[16:19], v64 offset:7168
v_fma_f32 v80, v80, s61, v88
v_rsq_f32 v80, v80
ds_write_b32 v28, v80
v_mfma_f32_32x32x16_bf16 v[32:47], v[24:27], a[16:19], v[32:47]
ds_read_b128 v[20:23], v64 offset:8192
ds_read_b128 v[80:83], v29 offset:0
ds_read_b128 v[84:87], v29 offset:32
ds_read_b128 v[88:91], v29 offset:64
ds_read_b128 v[92:95], v29 offset:96
v_mfma_f32_32x32x16_bf16 v[32:47], v[8:11], a[20:23], v[32:47]
s_waitcnt lgkmcnt(7)
ds_read_b128 v[24:27], v64 offset:9216
s_waitcnt lgkmcnt(4)
v_mul_f32 v80, v80, v48
v_mul_f32 v81, v81, v49
v_mul_f32 v82, v82, v50
v_mul_f32 v83, v83, v51
v_mfma_f32_32x32x16_bf16 v[32:47], v[12:15], a[24:27], v[32:47]
ds_read_b128 v[8:11], v64 offset:10240
s_waitcnt lgkmcnt(4)
v_mul_f32 v84, v84, v52
v_mul_f32 v85, v85, v53
v_mul_f32 v86, v86, v54
v_mul_f32 v87, v87, v55
v_mfma_f32_32x32x16_bf16 v[32:47], v[16:19], a[28:31], v[32:47]
ds_read_b128 v[12:15], v64 offset:11264
s_waitcnt lgkmcnt(4)
v_mul_f32 v88, v88, v56
v_mul_f32 v89, v89, v57
v_mul_f32 v90, v90, v58
v_mul_f32 v91, v91, v59
v_mfma_f32_32x32x16_bf16 v[32:47], v[20:23], a[32:35], v[32:47]
s_waitcnt lgkmcnt(2)
ds_read_b128 v[16:19], v64 offset:12288
v_mul_f32 v92, v92, v60
v_mul_f32 v93, v93, v61
v_mul_f32 v94, v94, v62
v_mul_f32 v95, v95, v63
v_mfma_f32_32x32x16_bf16 v[32:47], v[24:27], a[36:39], v[32:47]
s_waitcnt lgkmcnt(2)
ds_read_b128 v[20:23], v64 offset:13312
v_cvt_pk_bf16_f32 v48, v80, v81
v_cvt_pk_bf16_f32 v49, v82, v83
v_mfma_f32_32x32x16_bf16 v[32:47], v[8:11], a[40:43], v[32:47]
s_waitcnt lgkmcnt(2)
ds_read_b128 v[24:27], v64 offset:14336
v_cvt_pk_bf16_f32 v52, v84, v85
v_cvt_pk_bf16_f32 v53, v86, v87
v_mfma_f32_32x32x16_bf16 v[32:47], v[12:15], a[44:47], v[32:47]
s_waitcnt lgkmcnt(2)
ds_read_b128 v[8:11], v64 offset:15360
v_cvt_pk_bf16_f32 v50, v88, v89
v_cvt_pk_bf16_f32 v51, v90, v91
v_mfma_f32_32x32x16_bf16 v[32:47], v[16:19], a[48:51], v[32:47]
s_waitcnt lgkmcnt(2)
ds_read_b128 v[12:15], v64 offset:16384
v_cvt_pk_bf16_f32 v54, v92, v93
v_cvt_pk_bf16_f32 v55, v94, v95
v_mfma_f32_32x32x16_bf16 v[32:47], v[20:23], a[52:55], v[32:47]
s_waitcnt lgkmcnt(2)
ds_read_b128 v[16:19], v64 offset:17408
buffer_store_dwordx4 v[48:51], v1, s[4:7], s48 offen offset:2048 sc1
buffer_store_dwordx4 v[52:55], v1, s[4:7], s48 offen offset:2560 sc1
v_mfma_f32_32x32x16_bf16 v[32:47], v[24:27], a[56:59], v[32:47]
s_waitcnt lgkmcnt(2)
ds_read_b128 v[20:23], v64 offset:18432
s_add_u32 s48, s48, s49
ds_read_b128 v[72:75], v5
v_mov_b32 v4, 0
v_mfma_f32_32x32x16_bf16 v[32:47], v[8:11], a[60:63], v[32:47]
s_waitcnt lgkmcnt(3)
ds_read_b128 v[24:27], v64 offset:19456
ds_read_b128 v[76:79], v5 offset:1024
s_waitcnt lgkmcnt(2)
v_and_b32 v72, v3, v72
v_mfma_f32_32x32x16_bf16 v[32:47], v[12:15], a[64:67], v[32:47]
ds_read_b128 v[8:11], v64 offset:20480
v_dot2c_f32_bf16 v4, v72, v72
v_dot2c_f32_bf16 v4, v73, v73
v_dot2c_f32_bf16 v4, v74, v74
v_dot2c_f32_bf16 v4, v75, v75
ds_read_b128 v[72:75], v5 offset:2048
v_mfma_f32_32x32x16_bf16 v[32:47], v[16:19], a[68:71], v[32:47]
ds_read_b128 v[12:15], v64 offset:21504
s_waitcnt lgkmcnt(3)
v_dot2c_f32_bf16 v4, v76, v76
v_dot2c_f32_bf16 v4, v77, v77
v_dot2c_f32_bf16 v4, v78, v78
v_dot2c_f32_bf16 v4, v79, v79
ds_read_b128 v[76:79], v5 offset:3072
v_mfma_f32_32x32x16_bf16 v[32:47], v[20:23], a[72:75], v[32:47]
ds_read_b128 v[16:19], v64 offset:22528
s_waitcnt lgkmcnt(3)
v_dot2c_f32_bf16 v4, v72, v72
v_dot2c_f32_bf16 v4, v73, v73
v_dot2c_f32_bf16 v4, v74, v74
v_dot2c_f32_bf16 v4, v75, v75
ds_read_b128 v[72:75], v5 offset:4096
v_mfma_f32_32x32x16_bf16 v[32:47], v[24:27], a[76:79], v[32:47]
ds_read_b128 v[20:23], v64 offset:23552
s_waitcnt lgkmcnt(3)
v_dot2c_f32_bf16 v4, v76, v76
v_dot2c_f32_bf16 v4, v77, v77
v_dot2c_f32_bf16 v4, v78, v78
v_dot2c_f32_bf16 v4, v79, v79
ds_read_b128 v[76:79], v5 offset:5120
v_mfma_f32_32x32x16_bf16 v[32:47], v[8:11], a[80:83], v[32:47]
ds_read_b128 v[24:27], v64 offset:24576
s_waitcnt lgkmcnt(3)
v_dot2c_f32_bf16 v4, v72, v72
v_dot2c_f32_bf16 v4, v73, v73
v_dot2c_f32_bf16 v4, v74, v74
v_dot2c_f32_bf16 v4, v75, v75
ds_read_b128 v[72:75], v5 offset:6144
v_mfma_f32_32x32x16_bf16 v[32:47], v[12:15], a[84:87], v[32:47]
ds_read_b128 v[8:11], v64 offset:25600
s_waitcnt lgkmcnt(3)
v_dot2c_f32_bf16 v4, v76, v76
v_dot2c_f32_bf16 v4, v77, v77
v_dot2c_f32_bf16 v4, v78, v78
v_dot2c_f32_bf16 v4, v79, v79
ds_read_b128 v[76:79], v5 offset:7168
v_mfma_f32_32x32x16_bf16 v[32:47], v[16:19], a[88:91], v[32:47]
ds_read_b128 v[12:15], v64 offset:26624
s_waitcnt lgkmcnt(3)
v_dot2c_f32_bf16 v4, v72, v72
v_dot2c_f32_bf16 v4, v73, v73
v_dot2c_f32_bf16 v4, v74, v74
v_dot2c_f32_bf16 v4, v75, v75
ds_read_b128 v[72:75], v5 offset:8192
v_mfma_f32_32x32x16_bf16 v[32:47], v[20:23], a[92:95], v[32:47]
ds_read_b128 v[16:19], v64 offset:27648
s_waitcnt lgkmcnt(3)
v_dot2c_f32_bf16 v4, v76, v76
v_dot2c_f32_bf16 v4, v77, v77
v_dot2c_f32_bf16 v4, v78, v78
v_dot2c_f32_bf16 v4, v79, v79
ds_read_b128 v[76:79], v5 offset:9216
v_mfma_f32_32x32x16_bf16 v[32:47], v[24:27], a[96:99], v[32:47]
ds_read_b128 v[20:23], v64 offset:28672
s_waitcnt lgkmcnt(3)
v_dot2c_f32_bf16 v4, v72, v72
v_dot2c_f32_bf16 v4, v73, v73
v_dot2c_f32_bf16 v4, v74, v74
v_dot2c_f32_bf16 v4, v75, v75
s_waitcnt lgkmcnt(1)
v_dot2c_f32_bf16 v4, v76, v76
v_dot2c_f32_bf16 v4, v77, v77
v_dot2c_f32_bf16 v4, v78, v78
v_dot2c_f32_bf16 v4, v79, v79
v_mfma_f32_32x32x16_bf16 v[32:47], v[8:11], a[100:103], v[32:47]
ds_read_b128 v[24:27], v64 offset:29696
ds_write_b32 v6, v4 offset:0
s_add_u32 m0, s45, 0
s_add_u32 s55, s46, 0
buffer_load_dwordx4 v0, s[4:7], s55 offen offset:0 sc1 lds
v_mfma_f32_32x32x16_bf16 v[32:47], v[12:15], a[104:107], v[32:47]
ds_read_b128 v[8:11], v64 offset:30720
buffer_load_dwordx4 v0, s[4:7], s55 offen offset:1024 sc1 lds
buffer_load_dwordx4 v0, s[4:7], s55 offen offset:2048 sc1 lds
v_mfma_f32_32x32x16_bf16 v[32:47], v[16:19], a[108:111], v[32:47]
s_waitcnt lgkmcnt(3)
ds_read_b128 v[12:15], v64 offset:31744
buffer_load_dwordx4 v0, s[4:7], s55 offen offset:3072 sc1 lds
s_add_u32 m0, s45, 4096
s_add_u32 s55, s46, 4096
buffer_load_dwordx4 v0, s[4:7], s55 offen offset:0 sc1 lds
v_mfma_f32_32x32x16_bf16 v[32:47], v[20:23], a[112:115], v[32:47]
s_waitcnt lgkmcnt(3)
ds_read_b128 v[16:19], v64 offset:32768
buffer_load_dwordx4 v0, s[4:7], s55 offen offset:1024 sc1 lds
buffer_load_dwordx4 v0, s[4:7], s55 offen offset:2048 sc1 lds
v_mfma_f32_32x32x16_bf16 v[32:47], v[24:27], a[116:119], v[32:47]
s_waitcnt lgkmcnt(2)
ds_read_b128 v[20:23], v64 offset:33792
buffer_load_dwordx4 v0, s[4:7], s55 offen offset:3072 sc1 lds
s_add_u32 m0, s45, 8192
s_add_u32 s55, s46, 8192
buffer_load_dwordx4 v0, s[4:7], s55 offen offset:0 sc1 lds
v_mfma_f32_32x32x16_bf16 v[32:47], v[8:11], a[120:123], v[32:47]
s_waitcnt lgkmcnt(2)
ds_read_b128 v[24:27], v64 offset:34816
buffer_load_dwordx4 v0, s[4:7], s55 offen offset:1024 sc1 lds
s_add_u32 s45, s45, 40960
s_cmp_ge_u32 s45, 122880
s_cselect_b32 s55, 122880, 0
s_sub_u32 s45, s45, s55
v_mfma_f32_32x32x16_bf16 v[32:47], v[12:15], a[124:127], v[32:47]
s_waitcnt lgkmcnt(2)
ds_read_b128 v[8:11], v64 offset:35840
s_add_u32 s46, s46, 40960
v_mfma_f32_32x32x16_bf16 v[32:47], v[16:19], a[128:131], v[32:47]
s_waitcnt lgkmcnt(2)
ds_read_b128 v[12:15], v64 offset:36864
v_mfma_f32_32x32x16_bf16 v[32:47], v[20:23], a[132:135], v[32:47]
s_waitcnt lgkmcnt(2)
ds_read_b128 v[16:19], v64 offset:37888
v_mfma_f32_32x32x16_bf16 v[32:47], v[24:27], a[136:139], v[32:47]
s_waitcnt lgkmcnt(2)
ds_read_b128 v[20:23], v64 offset:38912
v_mfma_f32_32x32x16_bf16 v[32:47], v[8:11], a[140:143], v[32:47]
s_waitcnt lgkmcnt(2)
ds_read_b128 v[24:27], v64 offset:39936
v_mfma_f32_32x32x16_bf16 v[32:47], v[12:15], a[144:147], v[32:47]
s_add_u32 s44, s44, 1
s_cmp_eq_u32 s44, 3
s_mov_b32 s56, 40960
s_cmov_b32 s56, -81920
s_cselect_b32 s44, 0, s44
v_add_u32 v64, s56, v64
v_add_u32 v5, s56, v5
s_waitcnt vmcnt(10) lgkmcnt(2)
s_barrier
s_add_u32 s50, s50, 1
v_mov_b32 v4, s50
buffer_store_dword v4, v2, s[4:7], s60 offen sc1
ds_read_b128 v[8:11], v64 offset:0
v_mfma_f32_32x32x16_bf16 v[32:47], v[16:19], a[148:151], v[32:47]
s_waitcnt lgkmcnt(2)
ds_read_b128 v[12:15], v64 offset:1024
v_mfma_f32_32x32x16_bf16 v[32:47], v[20:23], a[152:155], v[32:47]
s_waitcnt lgkmcnt(2)
ds_read_b128 v[16:19], v64 offset:2048
v_mfma_f32_32x32x16_bf16 v[32:47], v[24:27], a[156:159], v[32:47]
s_waitcnt lgkmcnt(2)
ds_read_b128 v[20:23], v64 offset:3072
s_branch k_st_34
k_so_35:
ds_read_b128 v[80:83], v7 offset:1024
ds_read_b128 v[84:87], v7 offset:1040
v_mov_b32 v88, 0x3727c5ac
s_waitcnt lgkmcnt(0)
v_add_f32 v80, v80, v84
v_add_f32 v81, v81, v85
v_add_f32 v82, v82, v86
v_add_f32 v83, v83, v87
v_add_f32 v80, v80, v81
v_add_f32 v82, v82, v83
v_add_f32 v80, v80, v82
v_fma_f32 v80, v80, s61, v88
v_rsq_f32 v80, v80
ds_write_b32 v28, v80
ds_read_b128 v[80:83], v29 offset:0
ds_read_b128 v[84:87], v29 offset:32
ds_read_b128 v[88:91], v29 offset:64
ds_read_b128 v[92:95], v29 offset:96
s_waitcnt lgkmcnt(3)
v_mul_f32 v80, v80, v48
v_mul_f32 v81, v81, v49
v_mul_f32 v82, v82, v50
v_mul_f32 v83, v83, v51
s_waitcnt lgkmcnt(2)
v_mul_f32 v84, v84, v52
v_mul_f32 v85, v85, v53
v_mul_f32 v86, v86, v54
v_mul_f32 v87, v87, v55
s_waitcnt lgkmcnt(1)
v_mul_f32 v88, v88, v56
v_mul_f32 v89, v89, v57
v_mul_f32 v90, v90, v58
v_mul_f32 v91, v91, v59
s_waitcnt lgkmcnt(0)
v_mul_f32 v92, v92, v60
v_mul_f32 v93, v93, v61
v_mul_f32 v94, v94, v62
v_mul_f32 v95, v95, v63
v_cvt_pk_bf16_f32 v48, v80, v81
v_cvt_pk_bf16_f32 v49, v82, v83
v_cvt_pk_bf16_f32 v52, v84, v85
v_cvt_pk_bf16_f32 v53, v86, v87
v_cvt_pk_bf16_f32 v50, v88, v89
v_cvt_pk_bf16_f32 v51, v90, v91
v_cvt_pk_bf16_f32 v54, v92, v93
v_cvt_pk_bf16_f32 v55, v94, v95
buffer_store_dwordx4 v[48:51], v1, s[4:7], s48 offen offset:2048 sc1
buffer_store_dwordx4 v[52:55], v1, s[4:7], s48 offen offset:2560 sc1
s_add_u32 s48, s48, s49
k_join_29:
s_waitcnt vmcnt(0) lgkmcnt(0)
s_barrier
s_add_u32 s50, s50, 1
v_mov_b32 v4, s50
buffer_store_dword v4, v2, s[4:7], s60 offen sc1
s_cmp_ge_u32 s30, 80
s_cbranch_scc1 k_fend_36
v_bfe_u32 v8, v0, 4, 5
v_lshrrev_b32 v9, 9, v0
s_lshl_b32 s52, s30, 2
s_add_u32 s52, s52, s3
s_cmp_eq_u32 s52, 0
s_cselect_b32 s47, 0xffff, -1
s_cselect_b32 s53, 0x30000, 0
s_cmov_b32 s52, 320
v_add_u32 v26, s53, v0
s_cmp_lg_u32 s51, 0
s_cbranch_scc1 k_fnog_37
s_load_dwordx2 s[36:37], s[0:1], 64
s_mov_b32 s38, 1314816
s_mov_b32 s39, 0x20000
s_load_dwordx2 s[40:41], s[0:1], 72
s_mov_b32 s42, 1314816
s_mov_b32 s43, 0x20000
v_lshl_add_u32 v20, v9, 8, v8
v_mul_u32_u24 v20, 642, v20
s_lshl_b32 s52, s52, 1
v_add_u32 v22, s52, v20
s_waitcnt lgkmcnt(0)
s_mov_b32 s53, 0
buffer_load_ushort v192, v22, s[36:39], s53 offen
buffer_load_ushort v208, v22, s[40:43], s53 offen
s_mov_b32 s53, 41088
buffer_load_ushort v193, v22, s[36:39], s53 offen
buffer_load_ushort v209, v22, s[40:43], s53 offen
s_mov_b32 s53, 82176
buffer_load_ushort v194, v22, s[36:39], s53 offen
buffer_load_ushort v210, v22, s[40:43], s53 offen
s_mov_b32 s53, 123264
buffer_load_ushort v195, v22, s[36:39], s53 offen
buffer_load_ushort v211, v22, s[40:43], s53 offen
s_mov_b32 s53, 328704
buffer_load_ushort v196, v22, s[36:39], s53 offen
buffer_load_ushort v212, v22, s[40:43], s53 offen
s_mov_b32 s53, 369792
buffer_load_ushort v197, v22, s[36:39], s53 offen
buffer_load_ushort v213, v22, s[40:43], s53 offen
s_mov_b32 s53, 410880
buffer_load_ushort v198, v22, s[36:39], s53 offen
buffer_load_ushort v214, v22, s[40:43], s53 offen
s_mov_b32 s53, 451968
buffer_load_ushort v199, v22, s[36:39], s53 offen
buffer_load_ushort v215, v22, s[40:43], s53 offen
s_mov_b32 s53, 657408
buffer_load_ushort v200, v22, s[36:39], s53 offen
buffer_load_ushort v216, v22, s[40:43], s53 offen
s_mov_b32 s53, 698496
buffer_load_ushort v201, v22, s[36:39], s53 offen
buffer_load_ushort v217, v22, s[40:43], s53 offen
s_mov_b32 s53, 739584
buffer_load_ushort v202, v22, s[36:39], s53 offen
buffer_load_ushort v218, v22, s[40:43], s53 offen
s_mov_b32 s53, 780672
buffer_load_ushort v203, v22, s[36:39], s53 offen
buffer_load_ushort v219, v22, s[40:43], s53 offen
s_mov_b32 s53, 986112
buffer_load_ushort v204, v22, s[36:39], s53 offen
buffer_load_ushort v220, v22, s[40:43], s53 offen
s_mov_b32 s53, 1027200
buffer_load_ushort v205, v22, s[36:39], s53 offen
buffer_load_ushort v221, v22, s[40:43], s53 offen
s_mov_b32 s53, 1068288
buffer_load_ushort v206, v22, s[36:39], s53 offen
buffer_load_ushort v222, v22, s[40:43], s53 offen
s_mov_b32 s53, 1109376
buffer_load_ushort v207, v22, s[36:39], s53 offen
buffer_load_ushort v223, v22, s[40:43], s53 offen
s_mov_b32 s53, 20544
buffer_load_ushort v224, v22, s[36:39], s53 offen
buffer_load_ushort v240, v22, s[40:43], s53 offen
s_mov_b32 s53, 61632
buffer_load_ushort v225, v22, s[36:39], s53 offen
buffer_load_ushort v241, v22, s[40:43], s53 offen
s_mov_b32 s53, 102720
buffer_load_ushort v226, v22, s[36:39], s53 offen
buffer_load_ushort v242, v22, s[40:43], s53 offen
s_mov_b32 s53, 143808
buffer_load_ushort v227, v22, s[36:39], s53 offen
buffer_load_ushort v243, v22, s[40:43], s53 offen
s_mov_b32 s53, 349248
buffer_load_ushort v228, v22, s[36:39], s53 offen
buffer_load_ushort v244, v22, s[40:43], s53 offen
s_mov_b32 s53, 390336
buffer_load_ushort v229, v22, s[36:39], s53 offen
buffer_load_ushort v245, v22, s[40:43], s53 offen
s_mov_b32 s53, 431424
buffer_load_ushort v230, v22, s[36:39], s53 offen
buffer_load_ushort v246, v22, s[40:43], s53 offen
s_mov_b32 s53, 472512
buffer_load_ushort v231, v22, s[36:39], s53 offen
buffer_load_ushort v247, v22, s[40:43], s53 offen
s_mov_b32 s53, 677952
buffer_load_ushort v232, v22, s[36:39], s53 offen
buffer_load_ushort v248, v22, s[40:43], s53 offen
s_mov_b32 s53, 719040
buffer_load_ushort v233, v22, s[36:39], s53 offen
buffer_load_ushort v249, v22, s[40:43], s53 offen
s_mov_b32 s53, 760128
buffer_load_ushort v234, v22, s[36:39], s53 offen
buffer_load_ushort v250, v22, s[40:43], s53 offen
s_mov_b32 s53, 801216
buffer_load_ushort v235, v22, s[36:39], s53 offen
buffer_load_ushort v251, v22, s[40:43], s53 offen
s_mov_b32 s53, 1006656
buffer_load_ushort v236, v22, s[36:39], s53 offen
buffer_load_ushort v252, v22, s[40:43], s53 offen
s_mov_b32 s53, 1047744
buffer_load_ushort v237, v22, s[36:39], s53 offen
buffer_load_ushort v253, v22, s[40:43], s53 offen
s_mov_b32 s53, 1088832
buffer_load_ushort v238, v22, s[36:39], s53 offen
buffer_load_ushort v254, v22, s[40:43], s53 offen
s_mov_b32 s53, 1129920
buffer_load_ushort v239, v22, s[36:39], s53 offen
buffer_load_ushort v255, v22, s[40:43], s53 offen
v_lshl_add_u32 v10, v9, 2, 0
v_mul_u32_u24 v10, v10, v8
v_and_b32 v20, 31, v10
v_cvt_f32_u32 v20, v20
v_mul_f32 v20, 0x3d000000, v20
v_sin_f32 v21, v20
v_cos_f32 v20, v20
v_add_u32 v10, v8, v10
v_cvt_pk_bf16_f32 v32, v20, v21
v_cvt_pk_bf16_f32 v36, -v21, v20
v_and_b32 v20, 31, v10
v_cvt_f32_u32 v20, v20
v_mul_f32 v20, 0x3d000000, v20
v_sin_f32 v21, v20
v_cos_f32 v20, v20
v_add_u32 v10, v8, v10
v_cvt_pk_bf16_f32 v33, v20, v21
v_cvt_pk_bf16_f32 v37, -v21, v20
v_and_b32 v20, 31, v10
v_cvt_f32_u32 v20, v20
v_mul_f32 v20, 0x3d000000, v20
v_sin_f32 v21, v20
v_cos_f32 v20, v20
v_add_u32 v10, v8, v10
v_cvt_pk_bf16_f32 v34, v20, v21
v_cvt_pk_bf16_f32 v38, -v21, v20
v_and_b32 v20, 31, v10
v_cvt_f32_u32 v20, v20
v_mul_f32 v20, 0x3d000000, v20
v_sin_f32 v21, v20
v_cos_f32 v20, v20
v_add_u32 v10, v8, v10
v_cvt_pk_bf16_f32 v35, v20, v21
v_cvt_pk_bf16_f32 v39, -v21, v20
v_accvgpr_write_b32 a160, v32
v_accvgpr_write_b32 a161, v33
v_accvgpr_write_b32 a162, v34
v_accvgpr_write_b32 a163, v35
v_accvgpr_write_b32 a164, v36
v_accvgpr_write_b32 a165, v37
v_accvgpr_write_b32 a166, v38
v_accvgpr_write_b32 a167, v39
v_lshl_add_u32 v10, v9, 2, 8
v_mul_u32_u24 v10, v10, v8
v_and_b32 v20, 31, v10
v_cvt_f32_u32 v20, v20
v_mul_f32 v20, 0x3d000000, v20
v_sin_f32 v21, v20
v_cos_f32 v20, v20
v_add_u32 v10, v8, v10
v_cvt_pk_bf16_f32 v32, v20, v21
v_cvt_pk_bf16_f32 v36, -v21, v20
v_and_b32 v20, 31, v10
v_cvt_f32_u32 v20, v20
v_mul_f32 v20, 0x3d000000, v20
v_sin_f32 v21, v20
v_cos_f32 v20, v20
v_add_u32 v10, v8, v10
v_cvt_pk_bf16_f32 v33, v20, v21
v_cvt_pk_bf16_f32 v37, -v21, v20
v_and_b32 v20, 31, v10
v_cvt_f32_u32 v20, v20
v_mul_f32 v20, 0x3d000000, v20
v_sin_f32 v21, v20
v_cos_f32 v20, v20
v_add_u32 v10, v8, v10
v_cvt_pk_bf16_f32 v34, v20, v21
v_cvt_pk_bf16_f32 v38, -v21, v20
v_and_b32 v20, 31, v10
v_cvt_f32_u32 v20, v20
v_mul_f32 v20, 0x3d000000, v20
v_sin_f32 v21, v20
v_cos_f32 v20, v20
v_add_u32 v10, v8, v10
v_cvt_pk_bf16_f32 v35, v20, v21
v_cvt_pk_bf16_f32 v39, -v21, v20
v_accvgpr_write_b32 a168, v32
v_accvgpr_write_b32 a169, v33
v_accvgpr_write_b32 a170, v34
v_accvgpr_write_b32 a171, v35
v_accvgpr_write_b32 a172, v36
v_accvgpr_write_b32 a173, v37
v_accvgpr_write_b32 a174, v38
v_accvgpr_write_b32 a175, v39
v_lshl_add_u32 v10, v9, 2, 16
v_mul_u32_u24 v10, v10, v8
v_and_b32 v20, 31, v10
v_cvt_f32_u32 v20, v20
v_mul_f32 v20, 0x3d000000, v20
v_sin_f32 v21, v20
v_cos_f32 v20, v20
v_add_u32 v10, v8, v10
v_cvt_pk_bf16_f32 v32, v20, v21
v_cvt_pk_bf16_f32 v36, -v21, v20
v_and_b32 v20, 31, v10
v_cvt_f32_u32 v20, v20
v_mul_f32 v20, 0x3d000000, v20
v_sin_f32 v21, v20
v_cos_f32 v20, v20
v_add_u32 v10, v8, v10
v_cvt_pk_bf16_f32 v33, v20, v21
v_cvt_pk_bf16_f32 v37, -v21, v20
v_and_b32 v20, 31, v10
v_cvt_f32_u32 v20, v20
v_mul_f32 v20, 0x3d000000, v20
v_sin_f32 v21, v20
v_cos_f32 v20, v20
v_add_u32 v10, v8, v10
v_cvt_pk_bf16_f32 v34, v20, v21
v_cvt_pk_bf16_f32 v38, -v21, v20
v_and_b32 v20, 31, v10
v_cvt_f32_u32 v20, v20
v_mul_f32 v20, 0x3d000000, v20
v_sin_f32 v21, v20
v_cos_f32 v20, v20
v_add_u32 v10, v8, v10
v_cvt_pk_bf16_f32 v35, v20, v21
v_cvt_pk_bf16_f32 v39, -v21, v20
v_accvgpr_write_b32 a176, v32
v_accvgpr_write_b32 a177, v33
v_accvgpr_write_b32 a178, v34
v_accvgpr_write_b32 a179, v35
v_accvgpr_write_b32 a180, v36
v_accvgpr_write_b32 a181, v37
v_accvgpr_write_b32 a182, v38
v_accvgpr_write_b32 a183, v39
v_lshl_add_u32 v10, v9, 2, 24
v_mul_u32_u24 v10, v10, v8
v_and_b32 v20, 31, v10
v_cvt_f32_u32 v20, v20
v_mul_f32 v20, 0x3d000000, v20
v_sin_f32 v21, v20
v_cos_f32 v20, v20
v_add_u32 v10, v8, v10
v_cvt_pk_bf16_f32 v32, v20, v21
v_cvt_pk_bf16_f32 v36, -v21, v20
v_and_b32 v20, 31, v10
v_cvt_f32_u32 v20, v20
v_mul_f32 v20, 0x3d000000, v20
v_sin_f32 v21, v20
v_cos_f32 v20, v20
v_add_u32 v10, v8, v10
v_cvt_pk_bf16_f32 v33, v20, v21
v_cvt_pk_bf16_f32 v37, -v21, v20
v_and_b32 v20, 31, v10
v_cvt_f32_u32 v20, v20
v_mul_f32 v20, 0x3d000000, v20
v_sin_f32 v21, v20
v_cos_f32 v20, v20
v_add_u32 v10, v8, v10
v_cvt_pk_bf16_f32 v34, v20, v21
v_cvt_pk_bf16_f32 v38, -v21, v20
v_and_b32 v20, 31, v10
v_cvt_f32_u32 v20, v20
v_mul_f32 v20, 0x3d000000, v20
v_sin_f32 v21, v20
v_cos_f32 v20, v20
v_add_u32 v10, v8, v10
v_cvt_pk_bf16_f32 v35, v20, v21
v_cvt_pk_bf16_f32 v39, -v21, v20
v_accvgpr_write_b32 a184, v32
v_accvgpr_write_b32 a185, v33
v_accvgpr_write_b32 a186, v34
v_accvgpr_write_b32 a187, v35
v_accvgpr_write_b32 a188, v36
v_accvgpr_write_b32 a189, v37
v_accvgpr_write_b32 a190, v38
v_accvgpr_write_b32 a191, v39
s_waitcnt vmcnt(63)
v_lshlrev_b32 v192, 16, v192
v_mul_f32 v192, 0x3a000000, v192
s_waitcnt vmcnt(61)
v_lshlrev_b32 v193, 16, v193
v_mul_f32 v193, 0x3a000000, v193
s_waitcnt vmcnt(59)
v_lshlrev_b32 v194, 16, v194
v_mul_f32 v194, 0x3a000000, v194
s_waitcnt vmcnt(57)
v_lshlrev_b32 v195, 16, v195
v_mul_f32 v195, 0x3a000000, v195
s_waitcnt vmcnt(55)
v_lshlrev_b32 v196, 16, v196
v_mul_f32 v196, 0x3a000000, v196
s_waitcnt vmcnt(53)
v_lshlrev_b32 v197, 16, v197
v_mul_f32 v197, 0x3a000000, v197
s_waitcnt vmcnt(51)
v_lshlrev_b32 v198, 16, v198
v_mul_f32 v198, 0x3a000000, v198
s_waitcnt vmcnt(49)
v_lshlrev_b32 v199, 16, v199
v_mul_f32 v199, 0x3a000000, v199
s_waitcnt vmcnt(47)
v_lshlrev_b32 v200, 16, v200
v_mul_f32 v200, 0x3a000000, v200
s_waitcnt vmcnt(45)
v_lshlrev_b32 v201, 16, v201
v_mul_f32 v201, 0x3a000000, v201
s_waitcnt vmcnt(43)
v_lshlrev_b32 v202, 16, v202
v_mul_f32 v202, 0x3a000000, v202
s_waitcnt vmcnt(41)
v_lshlrev_b32 v203, 16, v203
v_mul_f32 v203, 0x3a000000, v203
s_waitcnt vmcnt(39)
v_lshlrev_b32 v204, 16, v204
v_mul_f32 v204, 0x3a000000, v204
s_waitcnt vmcnt(37)
v_lshlrev_b32 v205, 16, v205
v_mul_f32 v205, 0x3a000000, v205
s_waitcnt vmcnt(35)
v_lshlrev_b32 v206, 16, v206
v_mul_f32 v206, 0x3a000000, v206
s_waitcnt vmcnt(33)
v_lshlrev_b32 v207, 16, v207
v_mul_f32 v207, 0x3a000000, v207
v_lshlrev_b32 v208, 16, v208
v_mul_f32 v208, 0x3a000000, v208
v_lshlrev_b32 v209, 16, v209
v_mul_f32 v209, 0x3a000000, v209
v_lshlrev_b32 v210, 16, v210
v_mul_f32 v210, 0x3a000000, v210
v_lshlrev_b32 v211, 16, v211
v_mul_f32 v211, 0x3a000000, v211
v_lshlrev_b32 v212, 16, v212
v_mul_f32 v212, 0x3a000000, v212
v_lshlrev_b32 v213, 16, v213
v_mul_f32 v213, 0x3a000000, v213
v_lshlrev_b32 v214, 16, v214
v_mul_f32 v214, 0x3a000000, v214
v_lshlrev_b32 v215, 16, v215
v_mul_f32 v215, 0x3a000000, v215
v_lshlrev_b32 v216, 16, v216
v_mul_f32 v216, 0x3a000000, v216
v_lshlrev_b32 v217, 16, v217
v_mul_f32 v217, 0x3a000000, v217
v_lshlrev_b32 v218, 16, v218
v_mul_f32 v218, 0x3a000000, v218
v_lshlrev_b32 v219, 16, v219
v_mul_f32 v219, 0x3a000000, v219
v_lshlrev_b32 v220, 16, v220
v_mul_f32 v220, 0x3a000000, v220
v_lshlrev_b32 v221, 16, v221
v_mul_f32 v221, 0x3a000000, v221
v_lshlrev_b32 v222, 16, v222
v_mul_f32 v222, 0x3a000000, v222
s_waitcnt vmcnt(32)
v_lshlrev_b32 v223, 16, v223
v_mul_f32 v223, 0x3a000000, v223
s_waitcnt vmcnt(31)
v_lshlrev_b32 v224, 16, v224
v_mul_f32 v224, 0x3a000000, v224
s_waitcnt vmcnt(29)
v_lshlrev_b32 v225, 16, v225
v_mul_f32 v225, 0x3a000000, v225
s_waitcnt vmcnt(27)
v_lshlrev_b32 v226, 16, v226
v_mul_f32 v226, 0x3a000000, v226
s_waitcnt vmcnt(25)
v_lshlrev_b32 v227, 16, v227
v_mul_f32 v227, 0x3a000000, v227
s_waitcnt vmcnt(23)
v_lshlrev_b32 v228, 16, v228
v_mul_f32 v228, 0x3a000000, v228
s_waitcnt vmcnt(21)
v_lshlrev_b32 v229, 16, v229
v_mul_f32 v229, 0x3a000000, v229
s_waitcnt vmcnt(19)
v_lshlrev_b32 v230, 16, v230
v_mul_f32 v230, 0x3a000000, v230
s_waitcnt vmcnt(17)
v_lshlrev_b32 v231, 16, v231
v_mul_f32 v231, 0x3a000000, v231
s_waitcnt vmcnt(15)
v_lshlrev_b32 v232, 16, v232
v_mul_f32 v232, 0x3a000000, v232
s_waitcnt vmcnt(13)
v_lshlrev_b32 v233, 16, v233
v_mul_f32 v233, 0x3a000000, v233
s_waitcnt vmcnt(11)
v_lshlrev_b32 v234, 16, v234
v_mul_f32 v234, 0x3a000000, v234
s_waitcnt vmcnt(9)
v_lshlrev_b32 v235, 16, v235
v_mul_f32 v235, 0x3a000000, v235
s_waitcnt vmcnt(7)
v_lshlrev_b32 v236, 16, v236
v_mul_f32 v236, 0x3a000000, v236
s_waitcnt vmcnt(5)
v_lshlrev_b32 v237, 16, v237
v_mul_f32 v237, 0x3a000000, v237
s_waitcnt vmcnt(3)
v_lshlrev_b32 v238, 16, v238
v_mul_f32 v238, 0x3a000000, v238
s_waitcnt vmcnt(1)
v_lshlrev_b32 v239, 16, v239
v_mul_f32 v239, 0x3a000000, v239
v_lshlrev_b32 v240, 16, v240
v_mul_f32 v240, 0x3a000000, v240
v_lshlrev_b32 v241, 16, v241
v_mul_f32 v241, 0x3a000000, v241
v_lshlrev_b32 v242, 16, v242
v_mul_f32 v242, 0x3a000000, v242
v_lshlrev_b32 v243, 16, v243
v_mul_f32 v243, 0x3a000000, v243
v_lshlrev_b32 v244, 16, v244
v_mul_f32 v244, 0x3a000000, v244
v_lshlrev_b32 v245, 16, v245
v_mul_f32 v245, 0x3a000000, v245
v_lshlrev_b32 v246, 16, v246
v_mul_f32 v246, 0x3a000000, v246
v_lshlrev_b32 v247, 16, v247
v_mul_f32 v247, 0x3a000000, v247
v_lshlrev_b32 v248, 16, v248
v_mul_f32 v248, 0x3a000000, v248
v_lshlrev_b32 v249, 16, v249
v_mul_f32 v249, 0x3a000000, v249
v_lshlrev_b32 v250, 16, v250
v_mul_f32 v250, 0x3a000000, v250
v_lshlrev_b32 v251, 16, v251
v_mul_f32 v251, 0x3a000000, v251
v_lshlrev_b32 v252, 16, v252
v_mul_f32 v252, 0x3a000000, v252
v_lshlrev_b32 v253, 16, v253
v_mul_f32 v253, 0x3a000000, v253
v_lshlrev_b32 v254, 16, v254
v_mul_f32 v254, 0x3a000000, v254
s_waitcnt vmcnt(0)
v_lshlrev_b32 v255, 16, v255
v_mul_f32 v255, 0x3a000000, v255
k_fnog_37:
s_lshl_b32 s52, s3, 13
v_add_u32 v12, s52, v0
s_lshl_b32 s52, s3, 4
v_lshl_add_u32 v10, v9, 2, s52
v_add_u32 v10, 0, v10
v_add_u32 v11, 0, v8
v_mul_u32_u24 v10, v10, v11
v_and_b32 v20, 63, v10
v_cvt_f32_u32 v20, v20
v_mul_f32 v20, 0x3c800000, v20
v_sin_f32 v21, v20
v_cos_f32 v20, v20
v_add_u32 v10, v11, v10
v_cvt_pk_bf16_f32 v32, v20, v21
v_cvt_pk_bf16_f32 v36, -v21, v20
v_and_b32 v20, 63, v10
v_cvt_f32_u32 v20, v20
v_mul_f32 v20, 0x3c800000, v20
v_sin_f32 v21, v20
v_cos_f32 v20, v20
v_add_u32 v10, v11, v10
v_cvt_pk_bf16_f32 v33, v20, v21
v_cvt_pk_bf16_f32 v37, -v21, v20
v_and_b32 v20, 63, v10
v_cvt_f32_u32 v20, v20
v_mul_f32 v20, 0x3c800000, v20
v_sin_f32 v21, v20
v_cos_f32 v20, v20
v_add_u32 v10, v11, v10
v_cvt_pk_bf16_f32 v34, v20, v21
v_cvt_pk_bf16_f32 v38, -v21, v20
v_and_b32 v20, 63, v10
v_cvt_f32_u32 v20, v20
v_mul_f32 v20, 0x3c800000, v20
v_sin_f32 v21, v20
v_cos_f32 v20, v20
v_add_u32 v10, v11, v10
v_cvt_pk_bf16_f32 v35, v20, v21
v_cvt_pk_bf16_f32 v39, -v21, v20
ds_write_b128 v12, v[32:35] offset:0
ds_write_b128 v12, v[36:39] offset:1024
v_lshl_add_u32 v10, v9, 2, s52
v_add_u32 v10, 0, v10
v_add_u32 v11, 32, v8
v_mul_u32_u24 v10, v10, v11
v_and_b32 v20, 63, v10
v_cvt_f32_u32 v20, v20
v_mul_f32 v20, 0x3c800000, v20
v_sin_f32 v21, v20
v_cos_f32 v20, v20
v_add_u32 v10, v11, v10
v_cvt_pk_bf16_f32 v40, v20, v21
v_cvt_pk_bf16_f32 v44, -v21, v20
v_and_b32 v20, 63, v10
v_cvt_f32_u32 v20, v20
v_mul_f32 v20, 0x3c800000, v20
v_sin_f32 v21, v20
v_cos_f32 v20, v20
v_add_u32 v10, v11, v10
v_cvt_pk_bf16_f32 v41, v20, v21
v_cvt_pk_bf16_f32 v45, -v21, v20
v_and_b32 v20, 63, v10
v_cvt_f32_u32 v20, v20
v_mul_f32 v20, 0x3c800000, v20
v_sin_f32 v21, v20
v_cos_f32 v20, v20
v_add_u32 v10, v11, v10
v_cvt_pk_bf16_f32 v42, v20, v21
v_cvt_pk_bf16_f32 v46, -v21, v20
v_and_b32 v20, 63, v10
v_cvt_f32_u32 v20, v20
v_mul_f32 v20, 0x3c800000, v20
v_sin_f32 v21, v20
v_cos_f32 v20, v20
v_add_u32 v10, v11, v10
v_cvt_pk_bf16_f32 v43, v20, v21
v_cvt_pk_bf16_f32 v47, -v21, v20
ds_write_b128 v12, v[40:43] offset:2048
ds_write_b128 v12, v[44:47] offset:3072
v_lshl_add_u32 v10, v9, 2, s52
v_add_u32 v10, 8, v10
v_add_u32 v11, 0, v8
v_mul_u32_u24 v10, v10, v11
v_and_b32 v20, 63, v10
v_cvt_f32_u32 v20, v20
v_mul_f32 v20, 0x3c800000, v20
v_sin_f32 v21, v20
v_cos_f32 v20, v20
v_add_u32 v10, v11, v10
v_cvt_pk_bf16_f32 v48, v20, v21
v_cvt_pk_bf16_f32 v52, -v21, v20
v_and_b32 v20, 63, v10
v_cvt_f32_u32 v20, v20
v_mul_f32 v20, 0x3c800000, v20
v_sin_f32 v21, v20
v_cos_f32 v20, v20
v_add_u32 v10, v11, v10
v_cvt_pk_bf16_f32 v49, v20, v21
v_cvt_pk_bf16_f32 v53, -v21, v20
v_and_b32 v20, 63, v10
v_cvt_f32_u32 v20, v20
v_mul_f32 v20, 0x3c800000, v20
v_sin_f32 v21, v20
v_cos_f32 v20, v20
v_add_u32 v10, v11, v10
v_cvt_pk_bf16_f32 v50, v20, v21
v_cvt_pk_bf16_f32 v54, -v21, v20
v_and_b32 v20, 63, v10
v_cvt_f32_u32 v20, v20
v_mul_f32 v20, 0x3c800000, v20
v_sin_f32 v21, v20
v_cos_f32 v20, v20
v_add_u32 v10, v11, v10
v_cvt_pk_bf16_f32 v51, v20, v21
v_cvt_pk_bf16_f32 v55, -v21, v20
ds_write_b128 v12, v[48:51] offset:4096
ds_write_b128 v12, v[52:55] offset:5120
v_lshl_add_u32 v10, v9, 2, s52
v_add_u32 v10, 8, v10
v_add_u32 v11, 32, v8
v_mul_u32_u24 v10, v10, v11
v_and_b32 v20, 63, v10
v_cvt_f32_u32 v20, v20
v_mul_f32 v20, 0x3c800000, v20
v_sin_f32 v21, v20
v_cos_f32 v20, v20
v_add_u32 v10, v11, v10
v_cvt_pk_bf16_f32 v56, v20, v21
v_cvt_pk_bf16_f32 v60, -v21, v20
v_and_b32 v20, 63, v10
v_cvt_f32_u32 v20, v20
v_mul_f32 v20, 0x3c800000, v20
v_sin_f32 v21, v20
v_cos_f32 v20, v20
v_add_u32 v10, v11, v10
v_cvt_pk_bf16_f32 v57, v20, v21
v_cvt_pk_bf16_f32 v61, -v21, v20
v_and_b32 v20, 63, v10
v_cvt_f32_u32 v20, v20
v_mul_f32 v20, 0x3c800000, v20
v_sin_f32 v21, v20
v_cos_f32 v20, v20
v_add_u32 v10, v11, v10
v_cvt_pk_bf16_f32 v58, v20, v21
v_cvt_pk_bf16_f32 v62, -v21, v20
v_and_b32 v20, 63, v10
v_cvt_f32_u32 v20, v20
v_mul_f32 v20, 0x3c800000, v20
v_sin_f32 v21, v20
v_cos_f32 v20, v20
v_add_u32 v10, v11, v10
v_cvt_pk_bf16_f32 v59, v20, v21
v_cvt_pk_bf16_f32 v63, -v21, v20
ds_write_b128 v12, v[56:59] offset:6144
ds_write_b128 v12, v[60:63] offset:7168
s_lshl_b32 s52, s3, 11
v_add_u32 v12, s52, v0
s_lshl_b32 s52, s3, 3
v_lshl_add_u32 v10, v9, 2, s52
v_add_u32 v10, 0, v10
v_add_u32 v11, 0, v8
v_mul_u32_u24 v10, v10, v11
v_cvt_f32_u32 v20, v10
v_mul_f32 v20, 0x3a000000, v20
v_add_u32 v10, v11, v10
v_cos_f32 v64, v20
v_sin_f32 v68, v20
v_cvt_f32_u32 v20, v10
v_mul_f32 v20, 0x3a000000, v20
v_add_u32 v10, v11, v10
v_cos_f32 v65, v20
v_sin_f32 v69, v20
v_cvt_f32_u32 v20, v10
v_mul_f32 v20, 0x3a000000, v20
v_add_u32 v10, v11, v10
v_cos_f32 v66, v20
v_sin_f32 v70, v20
v_cvt_f32_u32 v20, v10
v_mul_f32 v20, 0x3a000000, v20
v_add_u32 v10, v11, v10
v_cos_f32 v67, v20
v_sin_f32 v71, v20
ds_write_b128 v12, v[64:67] offset:32768
ds_write_b128 v12, v[68:71] offset:33792
v_lshl_add_u32 v10, v9, 2, s52
v_add_u32 v10, 0, v10
v_add_u32 v11, 32, v8
v_mul_u32_u24 v10, v10, v11
v_cvt_f32_u32 v20, v10
v_mul_f32 v20, 0x3a000000, v20
v_add_u32 v10, v11, v10
v_cos_f32 v72, v20
v_sin_f32 v76, v20
v_cvt_f32_u32 v20, v10
v_mul_f32 v20, 0x3a000000, v20
v_add_u32 v10, v11, v10
v_cos_f32 v73, v20
v_sin_f32 v77, v20
v_cvt_f32_u32 v20, v10
v_mul_f32 v20, 0x3a000000, v20
v_add_u32 v10, v11, v10
v_cos_f32 v74, v20
v_sin_f32 v78, v20
v_cvt_f32_u32 v20, v10
v_mul_f32 v20, 0x3a000000, v20
v_add_u32 v10, v11, v10
v_cos_f32 v75, v20
v_sin_f32 v79, v20
ds_write_b128 v12, v[72:75] offset:40960
ds_write_b128 v12, v[76:79] offset:41984
v_lshl_add_u32 v10, v9, 2, s52
v_add_u32 v10, 32, v10
v_add_u32 v11, 0, v8
v_mul_u32_u24 v10, v10, v11
v_cvt_f32_u32 v20, v10
v_mul_f32 v20, 0x3a000000, v20
v_add_u32 v10, v11, v10
v_cos_f32 v80, v20
v_sin_f32 v84, v20
v_cvt_f32_u32 v20, v10
v_mul_f32 v20, 0x3a000000, v20
v_add_u32 v10, v11, v10
v_cos_f32 v81, v20
v_sin_f32 v85, v20
v_cvt_f32_u32 v20, v10
v_mul_f32 v20, 0x3a000000, v20
v_add_u32 v10, v11, v10
v_cos_f32 v82, v20
v_sin_f32 v86, v20
v_cvt_f32_u32 v20, v10
v_mul_f32 v20, 0x3a000000, v20
v_add_u32 v10, v11, v10
v_cos_f32 v83, v20
v_sin_f32 v87, v20
ds_write_b128 v12, v[80:83] offset:49152
ds_write_b128 v12, v[84:87] offset:50176
s_lshl_b32 s52, s3, 2
v_lshl_add_u32 v30, v8, 4, s52
v_lshl_add_u32 v30, v9, 11, v30
v_mul_u32_u24 v31, 2560, v9
v_lshl_add_u32 v31, v8, 2, v31
s_lshr_b32 s52, s3, 1
s_lshl_b32 s52, s52, 9
s_and_b32 s53, s3, 1
s_lshl_b32 s53, s53, 3
s_add_u32 s52, s52, s53
v_lshl_add_u32 v24, v8, 4, s52
v_lshl_add_u32 v24, v9, 2, v24
s_mov_b32 s52, 163840
v_mul_lo_u32 v25, v9, s52
v_lshl_add_u32 v25, v8, 4, v25
s_mul_i32 s44, s51, 3145728
s_lshl_b32 s52, s30, 15
s_add_u32 s44, s44, s52
s_add_u32 s44, s44, 205520896
s_mul_i32 s45, s51, 1048576
s_mul_i32 s52, s3, 5120
s_add_u32 s45, s45, s52
s_add_u32 s45, s45, 211812352
s_mul_i32 s48, s51, 3145728
s_lshl_b32 s52, s30, 9
s_add_u32 s48, s48, s52
s_mul_i32 s52, s3, 327680
s_add_u32 s48, s48, s52
s_add_u32 s48, s48, 198180864
s_mov_b32 s49, 0x3acccccd
v_mov_b32 v27, 0x3727c5ac
s_waitcnt vmcnt(0) lgkmcnt(0)
s_barrier
ds_read_b128 v[112:115], v0 offset:0
ds_read_b128 v[116:119], v0 offset:1024
ds_read_b128 v[120:123], v0 offset:2048
ds_read_b128 v[124:127], v0 offset:3072
k_pr_38:
buffer_load_dword v18, v30, s[4:7], s44 offen offset:1024 sc1
s_waitcnt vmcnt(0)
v_cmp_eq_u32 vcc, -1, v18
s_cbranch_vccz k_prd_39
s_sleep 8
s_sub_u32 s32, s32, 1
s_cmp_gt_i32 s32, 0
s_cbranch_scc1 k_pr_38
k_prd_39:
k_ps_40:
buffer_load_dword v96, v31, s[4:7], s45 offen offset:0 sc1
buffer_load_dword v97, v31, s[4:7], s45 offen offset:128 sc1
buffer_load_dword v98, v31, s[4:7], s45 offen offset:256 sc1
buffer_load_dword v99, v31, s[4:7], s45 offen offset:384 sc1
buffer_load_dword v100, v31, s[4:7], s45 offen offset:512 sc1
buffer_load_dword v101, v31, s[4:7], s45 offen offset:640 sc1
buffer_load_dword v102, v31, s[4:7], s45 offen offset:768 sc1
buffer_load_dword v103, v31, s[4:7], s45 offen offset:896 sc1
buffer_load_dword v104, v31, s[4:7], s45 offen offset:1024 sc1
buffer_load_dword v105, v31, s[4:7], s45 offen offset:1152 sc1
buffer_load_dword v106, v31, s[4:7], s45 offen offset:1280 sc1
buffer_load_dword v107, v31, s[4:7], s45 offen offset:1408 sc1
buffer_load_dword v108, v31, s[4:7], s45 offen offset:1536 sc1
buffer_load_dword v109, v31, s[4:7], s45 offen offset:1664 sc1
buffer_load_dword v110, v31, s[4:7], s45 offen offset:1792 sc1
buffer_load_dword v111, v31, s[4:7], s45 offen offset:1920 sc1
buffer_load_dword v20, v31, s[4:7], s45 offen offset:2048 sc1
buffer_load_dword v21, v31, s[4:7], s45 offen offset:2176 sc1
buffer_load_dword v22, v31, s[4:7], s45 offen offset:2304 sc1
buffer_load_dword v23, v31, s[4:7], s45 offen offset:2432 sc1
buffer_load_dword v16, v30, s[4:7], s44 offen offset:0 sc1
buffer_load_dword v17, v30, s[4:7], s44 offen offset:512 sc1
buffer_load_dword v19, v30, s[4:7], s44 offen offset:1536 sc1
s_waitcnt vmcnt(21)
v_add_f32 v96, v96, v97
s_waitcnt vmcnt(20)
v_add_f32 v96, v96, v98
s_waitcnt vmcnt(19)
v_add_f32 v96, v96, v99
s_waitcnt vmcnt(18)
v_add_f32 v96, v96, v100
s_waitcnt vmcnt(17)
v_add_f32 v96, v96, v101
s_waitcnt vmcnt(16)
v_add_f32 v96, v96, v102
s_waitcnt vmcnt(15)
v_add_f32 v96, v96, v103
s_waitcnt vmcnt(14)
v_add_f32 v96, v96, v104
s_waitcnt vmcnt(13)
v_add_f32 v96, v96, v105
s_waitcnt vmcnt(12)
v_add_f32 v96, v96, v106
s_waitcnt vmcnt(11)
v_add_f32 v96, v96, v107
s_waitcnt vmcnt(10)
v_add_f32 v96, v96, v108
s_waitcnt vmcnt(9)
v_add_f32 v96, v96, v109
s_waitcnt vmcnt(8)
v_add_f32 v96, v96, v110
s_waitcnt vmcnt(7)
v_add_f32 v96, v96, v111
s_waitcnt vmcnt(6)
v_add_f32 v96, v96, v20
s_waitcnt vmcnt(5)
v_add_f32 v96, v96, v21
s_waitcnt vmcnt(4)
v_add_f32 v96, v96, v22
s_waitcnt vmcnt(3)
v_add_f32 v96, v96, v23
v_cmp_u_f32 vcc, v96, v96
v_fma_f32 v96, v96, s49, v27
s_cbranch_vccz k_psd_41
s_sub_u32 s32, s32, 1
s_cmp_gt_i32 s32, 0
s_cbranch_scc1 k_ps_40
k_psd_41:
v_rsq_f32 v96, v96
s_add_u32 s45, s45, 20480
ds_write_b32 v24, v96 offset:57344
s_branch k_pyd_43
k_py_42:
buffer_load_dword v16, v30, s[4:7], s44 offen offset:0 sc1
buffer_load_dword v17, v30, s[4:7], s44 offen offset:512 sc1
buffer_load_dword v19, v30, s[4:7], s44 offen offset:1536 sc1
s_sub_u32 s32, s32, 1
k_pyd_43:
s_waitcnt vmcnt(0)
v_max3_u32 v20, v16, v17, v19
v_cmp_eq_u32 vcc, -1, v20
s_cmp_gt_i32 s32, 0
s_cselect_b64 vcc, vcc, 0
s_cbranch_vccnz k_py_42
s_add_u32 s44, s44, 4096
s_waitcnt lgkmcnt(0)
s_barrier
ds_read_b128 v[12:15], v0 offset:57344
v_lshlrev_b32 v144, 16, v16
v_and_b32 v128, 0xffff0000, v16
v_lshlrev_b32 v145, 16, v17
v_and_b32 v129, 0xffff0000, v17
v_lshlrev_b32 v146, 16, v18
v_and_b32 v130, 0xffff0000, v18
v_lshlrev_b32 v147, 16, v19
v_and_b32 v131, 0xffff0000, v19
s_waitcnt lgkmcnt(0)
v_mul_f32 v8, v12, v144
v_mul_f32 v12, v12, v128
v_cvt_pk_bf16_f32 v8, v8, v12
v_and_b32 v8, s47, v8
v_mul_f32 v9, v13, v145
v_mul_f32 v13, v13, v129
v_cvt_pk_bf16_f32 v9, v9, v13
v_and_b32 v9, s47, v9
v_mul_f32 v10, v14, v146
v_mul_f32 v14, v14, v130
v_cvt_pk_bf16_f32 v10, v10, v14
v_and_b32 v10, s47, v10
v_mul_f32 v11, v15, v147
v_mul_f32 v15, v15, v131
v_cvt_pk_bf16_f32 v11, v11, v15
v_and_b32 v11, s47, v11
s_nop 1
v_mfma_f32_32x32x16_bf16 v[32:47], v[8:11], v[112:115], 0
v_mfma_f32_32x32x16_bf16 v[48:63], v[8:11], v[116:119], 0
v_mfma_f32_32x32x16_bf16 v[64:79], v[8:11], v[120:123], 0
v_mfma_f32_32x32x16_bf16 v[80:95], v[8:11], v[124:127], 0
ds_read_b128 v[112:115], v0 offset:4096
ds_read_b128 v[116:119], v0 offset:5120
ds_read_b128 v[120:123], v0 offset:6144
ds_read_b128 v[124:127], v0 offset:7168
k_pr_44:
buffer_load_dword v18, v30, s[4:7], s44 offen offset:1024 sc1
s_waitcnt vmcnt(0)
v_cmp_eq_u32 vcc, -1, v18
s_cbranch_vccz k_prd_45
s_sleep 8
s_sub_u32 s32, s32, 1
s_cmp_gt_i32 s32, 0
s_cbranch_scc1 k_pr_44
k_prd_45:
k_ps_46:
buffer_load_dword v96, v31, s[4:7], s45 offen offset:0 sc1
buffer_load_dword v97, v31, s[4:7], s45 offen offset:128 sc1
buffer_load_dword v98, v31, s[4:7], s45 offen offset:256 sc1
buffer_load_dword v99, v31, s[4:7], s45 offen offset:384 sc1
buffer_load_dword v100, v31, s[4:7], s45 offen offset:512 sc1
buffer_load_dword v101, v31, s[4:7], s45 offen offset:640 sc1
buffer_load_dword v102, v31, s[4:7], s45 offen offset:768 sc1
buffer_load_dword v103, v31, s[4:7], s45 offen offset:896 sc1
buffer_load_dword v104, v31, s[4:7], s45 offen offset:1024 sc1
buffer_load_dword v105, v31, s[4:7], s45 offen offset:1152 sc1
buffer_load_dword v106, v31, s[4:7], s45 offen offset:1280 sc1
buffer_load_dword v107, v31, s[4:7], s45 offen offset:1408 sc1
buffer_load_dword v108, v31, s[4:7], s45 offen offset:1536 sc1
buffer_load_dword v109, v31, s[4:7], s45 offen offset:1664 sc1
buffer_load_dword v110, v31, s[4:7], s45 offen offset:1792 sc1
buffer_load_dword v111, v31, s[4:7], s45 offen offset:1920 sc1
buffer_load_dword v20, v31, s[4:7], s45 offen offset:2048 sc1
buffer_load_dword v21, v31, s[4:7], s45 offen offset:2176 sc1
buffer_load_dword v22, v31, s[4:7], s45 offen offset:2304 sc1
buffer_load_dword v23, v31, s[4:7], s45 offen offset:2432 sc1
buffer_load_dword v16, v30, s[4:7], s44 offen offset:0 sc1
buffer_load_dword v17, v30, s[4:7], s44 offen offset:512 sc1
buffer_load_dword v19, v30, s[4:7], s44 offen offset:1536 sc1
s_waitcnt vmcnt(21)
v_add_f32 v96, v96, v97
s_waitcnt vmcnt(20)
v_add_f32 v96, v96, v98
s_waitcnt vmcnt(19)
v_add_f32 v96, v96, v99
s_waitcnt vmcnt(18)
v_add_f32 v96, v96, v100
s_waitcnt vmcnt(17)
v_add_f32 v96, v96, v101
s_waitcnt vmcnt(16)
v_add_f32 v96, v96, v102
s_waitcnt vmcnt(15)
v_add_f32 v96, v96, v103
s_waitcnt vmcnt(14)
v_add_f32 v96, v96, v104
s_waitcnt vmcnt(13)
v_add_f32 v96, v96, v105
s_waitcnt vmcnt(12)
v_add_f32 v96, v96, v106
s_waitcnt vmcnt(11)
v_add_f32 v96, v96, v107
s_waitcnt vmcnt(10)
v_add_f32 v96, v96, v108
s_waitcnt vmcnt(9)
v_add_f32 v96, v96, v109
s_waitcnt vmcnt(8)
v_add_f32 v96, v96, v110
s_waitcnt vmcnt(7)
v_add_f32 v96, v96, v111
s_waitcnt vmcnt(6)
v_add_f32 v96, v96, v20
s_waitcnt vmcnt(5)
v_add_f32 v96, v96, v21
s_waitcnt vmcnt(4)
v_add_f32 v96, v96, v22
s_waitcnt vmcnt(3)
v_add_f32 v96, v96, v23
v_cmp_u_f32 vcc, v96, v96
v_fma_f32 v96, v96, s49, v27
s_cbranch_vccz k_psd_47
s_sub_u32 s32, s32, 1
s_cmp_gt_i32 s32, 0
s_cbranch_scc1 k_ps_46
k_psd_47:
v_rsq_f32 v96, v96
s_add_u32 s45, s45, 20480
ds_write_b32 v24, v96 offset:58368
s_branch k_pyd_49
k_py_48:
buffer_load_dword v16, v30, s[4:7], s44 offen offset:0 sc1
buffer_load_dword v17, v30, s[4:7], s44 offen offset:512 sc1
buffer_load_dword v19, v30, s[4:7], s44 offen offset:1536 sc1
s_sub_u32 s32, s32, 1
k_pyd_49:
s_waitcnt vmcnt(0)
v_max3_u32 v20, v16, v17, v19
v_cmp_eq_u32 vcc, -1, v20
s_cmp_gt_i32 s32, 0
s_cselect_b64 vcc, vcc, 0
s_cbranch_vccnz k_py_48
s_add_u32 s44, s44, 4096
s_waitcnt lgkmcnt(0)
s_barrier
ds_read_b128 v[12:15], v0 offset:58368
v_lshlrev_b32 v148, 16, v16
v_and_b32 v132, 0xffff0000, v16
v_lshlrev_b32 v149, 16, v17
v_and_b32 v133, 0xffff0000, v17
v_lshlrev_b32 v150, 16, v18
v_and_b32 v134, 0xffff0000, v18
v_lshlrev_b32 v151, 16, v19
v_and_b32 v135, 0xffff0000, v19
s_waitcnt lgkmcnt(0)
v_mul_f32 v8, v12, v148
v_mul_f32 v12, v12, v132
v_cvt_pk_bf16_f32 v8, v8, v12
v_and_b32 v8, s47, v8
v_mul_f32 v9, v13, v149
v_mul_f32 v13, v13, v133
v_cvt_pk_bf16_f32 v9, v9, v13
v_and_b32 v9, s47, v9
v_mul_f32 v10, v14, v150
v_mul_f32 v14, v14, v134
v_cvt_pk_bf16_f32 v10, v10, v14
v_and_b32 v10, s47, v10
v_mul_f32 v11, v15, v151
v_mul_f32 v15, v15, v135
v_cvt_pk_bf16_f32 v11, v11, v15
v_and_b32 v11, s47, v11
s_nop 1
v_mfma_f32_32x32x16_bf16 v[32:47], v[8:11], v[112:115], v[32:47]
v_mfma_f32_32x32x16_bf16 v[48:63], v[8:11], v[116:119], v[48:63]
v_mfma_f32_32x32x16_bf16 v[64:79], v[8:11], v[120:123], v[64:79]
v_mfma_f32_32x32x16_bf16 v[80:95], v[8:11], v[124:127], v[80:95]
ds_read_b128 v[112:115], v0 offset:8192
ds_read_b128 v[116:119], v0 offset:9216
ds_read_b128 v[120:123], v0 offset:10240
ds_read_b128 v[124:127], v0 offset:11264
k_pr_50:
buffer_load_dword v18, v30, s[4:7], s44 offen offset:1024 sc1
s_waitcnt vmcnt(0)
v_cmp_eq_u32 vcc, -1, v18
s_cbranch_vccz k_prd_51
s_sleep 8
s_sub_u32 s32, s32, 1
s_cmp_gt_i32 s32, 0
s_cbranch_scc1 k_pr_50
k_prd_51:
k_ps_52:
buffer_load_dword v96, v31, s[4:7], s45 offen offset:0 sc1
buffer_load_dword v97, v31, s[4:7], s45 offen offset:128 sc1
buffer_load_dword v98, v31, s[4:7], s45 offen offset:256 sc1
buffer_load_dword v99, v31, s[4:7], s45 offen offset:384 sc1
buffer_load_dword v100, v31, s[4:7], s45 offen offset:512 sc1
buffer_load_dword v101, v31, s[4:7], s45 offen offset:640 sc1
buffer_load_dword v102, v31, s[4:7], s45 offen offset:768 sc1
buffer_load_dword v103, v31, s[4:7], s45 offen offset:896 sc1
buffer_load_dword v104, v31, s[4:7], s45 offen offset:1024 sc1
buffer_load_dword v105, v31, s[4:7], s45 offen offset:1152 sc1
buffer_load_dword v106, v31, s[4:7], s45 offen offset:1280 sc1
buffer_load_dword v107, v31, s[4:7], s45 offen offset:1408 sc1
buffer_load_dword v108, v31, s[4:7], s45 offen offset:1536 sc1
buffer_load_dword v109, v31, s[4:7], s45 offen offset:1664 sc1
buffer_load_dword v110, v31, s[4:7], s45 offen offset:1792 sc1
buffer_load_dword v111, v31, s[4:7], s45 offen offset:1920 sc1
buffer_load_dword v20, v31, s[4:7], s45 offen offset:2048 sc1
buffer_load_dword v21, v31, s[4:7], s45 offen offset:2176 sc1
buffer_load_dword v22, v31, s[4:7], s45 offen offset:2304 sc1
buffer_load_dword v23, v31, s[4:7], s45 offen offset:2432 sc1
buffer_load_dword v16, v30, s[4:7], s44 offen offset:0 sc1
buffer_load_dword v17, v30, s[4:7], s44 offen offset:512 sc1
buffer_load_dword v19, v30, s[4:7], s44 offen offset:1536 sc1
s_waitcnt vmcnt(21)
v_add_f32 v96, v96, v97
s_waitcnt vmcnt(20)
v_add_f32 v96, v96, v98
s_waitcnt vmcnt(19)
v_add_f32 v96, v96, v99
s_waitcnt vmcnt(18)
v_add_f32 v96, v96, v100
s_waitcnt vmcnt(17)
v_add_f32 v96, v96, v101
s_waitcnt vmcnt(16)
v_add_f32 v96, v96, v102
s_waitcnt vmcnt(15)
v_add_f32 v96, v96, v103
s_waitcnt vmcnt(14)
v_add_f32 v96, v96, v104
s_waitcnt vmcnt(13)
v_add_f32 v96, v96, v105
s_waitcnt vmcnt(12)
v_add_f32 v96, v96, v106
s_waitcnt vmcnt(11)
v_add_f32 v96, v96, v107
s_waitcnt vmcnt(10)
v_add_f32 v96, v96, v108
s_waitcnt vmcnt(9)
v_add_f32 v96, v96, v109
s_waitcnt vmcnt(8)
v_add_f32 v96, v96, v110
s_waitcnt vmcnt(7)
v_add_f32 v96, v96, v111
s_waitcnt vmcnt(6)
v_add_f32 v96, v96, v20
s_waitcnt vmcnt(5)
v_add_f32 v96, v96, v21
s_waitcnt vmcnt(4)
v_add_f32 v96, v96, v22
s_waitcnt vmcnt(3)
v_add_f32 v96, v96, v23
v_cmp_u_f32 vcc, v96, v96
v_fma_f32 v96, v96, s49, v27
s_cbranch_vccz k_psd_53
s_sub_u32 s32, s32, 1
s_cmp_gt_i32 s32, 0
s_cbranch_scc1 k_ps_52
k_psd_53:
v_rsq_f32 v96, v96
s_add_u32 s45, s45, 20480
ds_write_b32 v24, v96 offset:57344
s_branch k_pyd_55
k_py_54:
buffer_load_dword v16, v30, s[4:7], s44 offen offset:0 sc1
buffer_load_dword v17, v30, s[4:7], s44 offen offset:512 sc1
buffer_load_dword v19, v30, s[4:7], s44 offen offset:1536 sc1
s_sub_u32 s32, s32, 1
k_pyd_55:
s_waitcnt vmcnt(0)
v_max3_u32 v20, v16, v17, v19
v_cmp_eq_u32 vcc, -1, v20
s_cmp_gt_i32 s32, 0
s_cselect_b64 vcc, vcc, 0
s_cbranch_vccnz k_py_54
s_add_u32 s44, s44, 4096
s_waitcnt lgkmcnt(0)
s_barrier
ds_read_b128 v[12:15], v0 offset:57344
v_lshlrev_b32 v152, 16, v16
v_and_b32 v136, 0xffff0000, v16
v_lshlrev_b32 v153, 16, v17
v_and_b32 v137, 0xffff0000, v17
v_lshlrev_b32 v154, 16, v18
v_and_b32 v138, 0xffff0000, v18
v_lshlrev_b32 v155, 16, v19
v_and_b32 v139, 0xffff0000, v19
s_waitcnt lgkmcnt(0)
v_mul_f32 v8, v12, v152
v_mul_f32 v12, v12, v136
v_cvt_pk_bf16_f32 v8, v8, v12
v_and_b32 v8, s47, v8
v_mul_f32 v9, v13, v153
v_mul_f32 v13, v13, v137
v_cvt_pk_bf16_f32 v9, v9, v13
v_and_b32 v9, s47, v9
v_mul_f32 v10, v14, v154
v_mul_f32 v14, v14, v138
v_cvt_pk_bf16_f32 v10, v10, v14
v_and_b32 v10, s47, v10
v_mul_f32 v11, v15, v155
v_mul_f32 v15, v15, v139
v_cvt_pk_bf16_f32 v11, v11, v15
v_and_b32 v11, s47, v11
s_nop 1
v_mfma_f32_32x32x16_bf16 v[32:47], v[8:11], v[112:115], v[32:47]
v_mfma_f32_32x32x16_bf16 v[48:63], v[8:11], v[116:119], v[48:63]
v_mfma_f32_32x32x16_bf16 v[64:79], v[8:11], v[120:123], v[64:79]
v_mfma_f32_32x32x16_bf16 v[80:95], v[8:11], v[124:127], v[80:95]
ds_read_b128 v[112:115], v0 offset:12288
ds_read_b128 v[116:119], v0 offset:13312
ds_read_b128 v[120:123], v0 offset:14336
ds_read_b128 v[124:127], v0 offset:15360
k_pr_56:
buffer_load_dword v18, v30, s[4:7], s44 offen offset:1024 sc1
s_waitcnt vmcnt(0)
v_cmp_eq_u32 vcc, -1, v18
s_cbranch_vccz k_prd_57
s_sleep 8
s_sub_u32 s32, s32, 1
s_cmp_gt_i32 s32, 0
s_cbranch_scc1 k_pr_56
k_prd_57:
k_ps_58:
buffer_load_dword v96, v31, s[4:7], s45 offen offset:0 sc1
buffer_load_dword v97, v31, s[4:7], s45 offen offset:128 sc1
buffer_load_dword v98, v31, s[4:7], s45 offen offset:256 sc1
buffer_load_dword v99, v31, s[4:7], s45 offen offset:384 sc1
buffer_load_dword v100, v31, s[4:7], s45 offen offset:512 sc1
buffer_load_dword v101, v31, s[4:7], s45 offen offset:640 sc1
buffer_load_dword v102, v31, s[4:7], s45 offen offset:768 sc1
buffer_load_dword v103, v31, s[4:7], s45 offen offset:896 sc1
buffer_load_dword v104, v31, s[4:7], s45 offen offset:1024 sc1
buffer_load_dword v105, v31, s[4:7], s45 offen offset:1152 sc1
buffer_load_dword v106, v31, s[4:7], s45 offen offset:1280 sc1
buffer_load_dword v107, v31, s[4:7], s45 offen offset:1408 sc1
buffer_load_dword v108, v31, s[4:7], s45 offen offset:1536 sc1
buffer_load_dword v109, v31, s[4:7], s45 offen offset:1664 sc1
buffer_load_dword v110, v31, s[4:7], s45 offen offset:1792 sc1
buffer_load_dword v111, v31, s[4:7], s45 offen offset:1920 sc1
buffer_load_dword v20, v31, s[4:7], s45 offen offset:2048 sc1
buffer_load_dword v21, v31, s[4:7], s45 offen offset:2176 sc1
buffer_load_dword v22, v31, s[4:7], s45 offen offset:2304 sc1
buffer_load_dword v23, v31, s[4:7], s45 offen offset:2432 sc1
buffer_load_dword v16, v30, s[4:7], s44 offen offset:0 sc1
buffer_load_dword v17, v30, s[4:7], s44 offen offset:512 sc1
buffer_load_dword v19, v30, s[4:7], s44 offen offset:1536 sc1
s_waitcnt vmcnt(21)
v_add_f32 v96, v96, v97
s_waitcnt vmcnt(20)
v_add_f32 v96, v96, v98
s_waitcnt vmcnt(19)
v_add_f32 v96, v96, v99
s_waitcnt vmcnt(18)
v_add_f32 v96, v96, v100
s_waitcnt vmcnt(17)
v_add_f32 v96, v96, v101
s_waitcnt vmcnt(16)
v_add_f32 v96, v96, v102
s_waitcnt vmcnt(15)
v_add_f32 v96, v96, v103
s_waitcnt vmcnt(14)
v_add_f32 v96, v96, v104
s_waitcnt vmcnt(13)
v_add_f32 v96, v96, v105
s_waitcnt vmcnt(12)
v_add_f32 v96, v96, v106
s_waitcnt vmcnt(11)
v_add_f32 v96, v96, v107
s_waitcnt vmcnt(10)
v_add_f32 v96, v96, v108
s_waitcnt vmcnt(9)
v_add_f32 v96, v96, v109
s_waitcnt vmcnt(8)
v_add_f32 v96, v96, v110
s_waitcnt vmcnt(7)
v_add_f32 v96, v96, v111
s_waitcnt vmcnt(6)
v_add_f32 v96, v96, v20
s_waitcnt vmcnt(5)
v_add_f32 v96, v96, v21
s_waitcnt vmcnt(4)
v_add_f32 v96, v96, v22
s_waitcnt vmcnt(3)
v_add_f32 v96, v96, v23
v_cmp_u_f32 vcc, v96, v96
v_fma_f32 v96, v96, s49, v27
s_cbranch_vccz k_psd_59
s_sub_u32 s32, s32, 1
s_cmp_gt_i32 s32, 0
s_cbranch_scc1 k_ps_58
k_psd_59:
v_rsq_f32 v96, v96
s_add_u32 s45, s45, 20480
ds_write_b32 v24, v96 offset:58368
s_branch k_pyd_61
k_py_60:
buffer_load_dword v16, v30, s[4:7], s44 offen offset:0 sc1
buffer_load_dword v17, v30, s[4:7], s44 offen offset:512 sc1
buffer_load_dword v19, v30, s[4:7], s44 offen offset:1536 sc1
s_sub_u32 s32, s32, 1
k_pyd_61:
s_waitcnt vmcnt(0)
v_max3_u32 v20, v16, v17, v19
v_cmp_eq_u32 vcc, -1, v20
s_cmp_gt_i32 s32, 0
s_cselect_b64 vcc, vcc, 0
s_cbranch_vccnz k_py_60
s_add_u32 s44, s44, 4096
s_waitcnt lgkmcnt(0)
s_barrier
ds_read_b128 v[12:15], v0 offset:58368
v_lshlrev_b32 v156, 16, v16
v_and_b32 v140, 0xffff0000, v16
v_lshlrev_b32 v157, 16, v17
v_and_b32 v141, 0xffff0000, v17
v_lshlrev_b32 v158, 16, v18
v_and_b32 v142, 0xffff0000, v18
v_lshlrev_b32 v159, 16, v19
v_and_b32 v143, 0xffff0000, v19
s_waitcnt lgkmcnt(0)
v_mul_f32 v8, v12, v156
v_mul_f32 v12, v12, v140
v_cvt_pk_bf16_f32 v8, v8, v12
v_and_b32 v8, s47, v8
v_mul_f32 v9, v13, v157
v_mul_f32 v13, v13, v141
v_cvt_pk_bf16_f32 v9, v9, v13
v_and_b32 v9, s47, v9
v_mul_f32 v10, v14, v158
v_mul_f32 v14, v14, v142
v_cvt_pk_bf16_f32 v10, v10, v14
v_and_b32 v10, s47, v10
v_mul_f32 v11, v15, v159
v_mul_f32 v15, v15, v143
v_cvt_pk_bf16_f32 v11, v11, v15
v_and_b32 v11, s47, v11
s_nop 1
v_mfma_f32_32x32x16_bf16 v[32:47], v[8:11], v[112:115], v[32:47]
v_mfma_f32_32x32x16_bf16 v[48:63], v[8:11], v[116:119], v[48:63]
v_mfma_f32_32x32x16_bf16 v[64:79], v[8:11], v[120:123], v[64:79]
v_mfma_f32_32x32x16_bf16 v[80:95], v[8:11], v[124:127], v[80:95]
ds_read_b128 v[112:115], v0 offset:16384
ds_read_b128 v[116:119], v0 offset:17408
ds_read_b128 v[120:123], v0 offset:18432
ds_read_b128 v[124:127], v0 offset:19456
k_pr_62:
buffer_load_dword v18, v30, s[4:7], s44 offen offset:1024 sc1
s_waitcnt vmcnt(0)
v_cmp_eq_u32 vcc, -1, v18
s_cbranch_vccz k_prd_63
s_sleep 8
s_sub_u32 s32, s32, 1
s_cmp_gt_i32 s32, 0
s_cbranch_scc1 k_pr_62
k_prd_63:
k_ps_64:
buffer_load_dword v96, v31, s[4:7], s45 offen offset:0 sc1
buffer_load_dword v97, v31, s[4:7], s45 offen offset:128 sc1
buffer_load_dword v98, v31, s[4:7], s45 offen offset:256 sc1
buffer_load_dword v99, v31, s[4:7], s45 offen offset:384 sc1
buffer_load_dword v100, v31, s[4:7], s45 offen offset:512 sc1
buffer_load_dword v101, v31, s[4:7], s45 offen offset:640 sc1
buffer_load_dword v102, v31, s[4:7], s45 offen offset:768 sc1
buffer_load_dword v103, v31, s[4:7], s45 offen offset:896 sc1
buffer_load_dword v104, v31, s[4:7], s45 offen offset:1024 sc1
buffer_load_dword v105, v31, s[4:7], s45 offen offset:1152 sc1
buffer_load_dword v106, v31, s[4:7], s45 offen offset:1280 sc1
buffer_load_dword v107, v31, s[4:7], s45 offen offset:1408 sc1
buffer_load_dword v108, v31, s[4:7], s45 offen offset:1536 sc1
buffer_load_dword v109, v31, s[4:7], s45 offen offset:1664 sc1
buffer_load_dword v110, v31, s[4:7], s45 offen offset:1792 sc1
buffer_load_dword v111, v31, s[4:7], s45 offen offset:1920 sc1
buffer_load_dword v20, v31, s[4:7], s45 offen offset:2048 sc1
buffer_load_dword v21, v31, s[4:7], s45 offen offset:2176 sc1
buffer_load_dword v22, v31, s[4:7], s45 offen offset:2304 sc1
buffer_load_dword v23, v31, s[4:7], s45 offen offset:2432 sc1
buffer_load_dword v16, v30, s[4:7], s44 offen offset:0 sc1
buffer_load_dword v17, v30, s[4:7], s44 offen offset:512 sc1
buffer_load_dword v19, v30, s[4:7], s44 offen offset:1536 sc1
s_waitcnt vmcnt(21)
v_add_f32 v96, v96, v97
s_waitcnt vmcnt(20)
v_add_f32 v96, v96, v98
s_waitcnt vmcnt(19)
v_add_f32 v96, v96, v99
s_waitcnt vmcnt(18)
v_add_f32 v96, v96, v100
s_waitcnt vmcnt(17)
v_add_f32 v96, v96, v101
s_waitcnt vmcnt(16)
v_add_f32 v96, v96, v102
s_waitcnt vmcnt(15)
v_add_f32 v96, v96, v103
s_waitcnt vmcnt(14)
v_add_f32 v96, v96, v104
s_waitcnt vmcnt(13)
v_add_f32 v96, v96, v105
s_waitcnt vmcnt(12)
v_add_f32 v96, v96, v106
s_waitcnt vmcnt(11)
v_add_f32 v96, v96, v107
s_waitcnt vmcnt(10)
v_add_f32 v96, v96, v108
s_waitcnt vmcnt(9)
v_add_f32 v96, v96, v109
s_waitcnt vmcnt(8)
v_add_f32 v96, v96, v110
s_waitcnt vmcnt(7)
v_add_f32 v96, v96, v111
s_waitcnt vmcnt(6)
v_add_f32 v96, v96, v20
s_waitcnt vmcnt(5)
v_add_f32 v96, v96, v21
s_waitcnt vmcnt(4)
v_add_f32 v96, v96, v22
s_waitcnt vmcnt(3)
v_add_f32 v96, v96, v23
v_cmp_u_f32 vcc, v96, v96
v_fma_f32 v96, v96, s49, v27
s_cbranch_vccz k_psd_65
s_sub_u32 s32, s32, 1
s_cmp_gt_i32 s32, 0
s_cbranch_scc1 k_ps_64
k_psd_65:
v_rsq_f32 v96, v96
s_add_u32 s45, s45, 20480
ds_write_b32 v24, v96 offset:57344
s_branch k_pyd_67
k_py_66:
buffer_load_dword v16, v30, s[4:7], s44 offen offset:0 sc1
buffer_load_dword v17, v30, s[4:7], s44 offen offset:512 sc1
buffer_load_dword v19, v30, s[4:7], s44 offen offset:1536 sc1
s_sub_u32 s32, s32, 1
k_pyd_67:
s_waitcnt vmcnt(0)
v_max3_u32 v20, v16, v17, v19
v_cmp_eq_u32 vcc, -1, v20
s_cmp_gt_i32 s32, 0
s_cselect_b64 vcc, vcc, 0
s_cbranch_vccnz k_py_66
s_add_u32 s44, s44, 4096
s_waitcnt lgkmcnt(0)
s_barrier
ds_read_b128 v[12:15], v0 offset:57344
v_lshlrev_b32 v176, 16, v16
v_and_b32 v160, 0xffff0000, v16
v_lshlrev_b32 v177, 16, v17
v_and_b32 v161, 0xffff0000, v17
v_lshlrev_b32 v178, 16, v18
v_and_b32 v162, 0xffff0000, v18
v_lshlrev_b32 v179, 16, v19
v_and_b32 v163, 0xffff0000, v19
s_waitcnt lgkmcnt(0)
v_mul_f32 v8, v12, v176
v_mul_f32 v12, v12, v160
v_cvt_pk_bf16_f32 v8, v8, v12
v_and_b32 v8, s47, v8
v_mul_f32 v9, v13, v177
v_mul_f32 v13, v13, v161
v_cvt_pk_bf16_f32 v9, v9, v13
v_and_b32 v9, s47, v9
v_mul_f32 v10, v14, v178
v_mul_f32 v14, v14, v162
v_cvt_pk_bf16_f32 v10, v10, v14
v_and_b32 v10, s47, v10
v_mul_f32 v11, v15, v179
v_mul_f32 v15, v15, v163
v_cvt_pk_bf16_f32 v11, v11, v15
v_and_b32 v11, s47, v11
s_nop 1
v_mfma_f32_32x32x16_bf16 v[32:47], v[8:11], v[112:115], v[32:47]
v_mfma_f32_32x32x16_bf16 v[48:63], v[8:11], v[116:119], v[48:63]
v_mfma_f32_32x32x16_bf16 v[64:79], v[8:11], v[120:123], v[64:79]
v_mfma_f32_32x32x16_bf16 v[80:95], v[8:11], v[124:127], v[80:95]
ds_read_b128 v[112:115], v0 offset:20480
ds_read_b128 v[116:119], v0 offset:21504
ds_read_b128 v[120:123], v0 offset:22528
ds_read_b128 v[124:127], v0 offset:23552
k_pr_68:
buffer_load_dword v18, v30, s[4:7], s44 offen offset:1024 sc1
s_waitcnt vmcnt(0)
v_cmp_eq_u32 vcc, -1, v18
s_cbranch_vccz k_prd_69
s_sleep 8
s_sub_u32 s32, s32, 1
s_cmp_gt_i32 s32, 0
s_cbranch_scc1 k_pr_68
k_prd_69:
k_ps_70:
buffer_load_dword v96, v31, s[4:7], s45 offen offset:0 sc1
buffer_load_dword v97, v31, s[4:7], s45 offen offset:128 sc1
buffer_load_dword v98, v31, s[4:7], s45 offen offset:256 sc1
buffer_load_dword v99, v31, s[4:7], s45 offen offset:384 sc1
buffer_load_dword v100, v31, s[4:7], s45 offen offset:512 sc1
buffer_load_dword v101, v31, s[4:7], s45 offen offset:640 sc1
buffer_load_dword v102, v31, s[4:7], s45 offen offset:768 sc1
buffer_load_dword v103, v31, s[4:7], s45 offen offset:896 sc1
buffer_load_dword v104, v31, s[4:7], s45 offen offset:1024 sc1
buffer_load_dword v105, v31, s[4:7], s45 offen offset:1152 sc1
buffer_load_dword v106, v31, s[4:7], s45 offen offset:1280 sc1
buffer_load_dword v107, v31, s[4:7], s45 offen offset:1408 sc1
buffer_load_dword v108, v31, s[4:7], s45 offen offset:1536 sc1
buffer_load_dword v109, v31, s[4:7], s45 offen offset:1664 sc1
buffer_load_dword v110, v31, s[4:7], s45 offen offset:1792 sc1
buffer_load_dword v111, v31, s[4:7], s45 offen offset:1920 sc1
buffer_load_dword v20, v31, s[4:7], s45 offen offset:2048 sc1
buffer_load_dword v21, v31, s[4:7], s45 offen offset:2176 sc1
buffer_load_dword v22, v31, s[4:7], s45 offen offset:2304 sc1
buffer_load_dword v23, v31, s[4:7], s45 offen offset:2432 sc1
buffer_load_dword v16, v30, s[4:7], s44 offen offset:0 sc1
buffer_load_dword v17, v30, s[4:7], s44 offen offset:512 sc1
buffer_load_dword v19, v30, s[4:7], s44 offen offset:1536 sc1
s_waitcnt vmcnt(21)
v_add_f32 v96, v96, v97
s_waitcnt vmcnt(20)
v_add_f32 v96, v96, v98
s_waitcnt vmcnt(19)
v_add_f32 v96, v96, v99
s_waitcnt vmcnt(18)
v_add_f32 v96, v96, v100
s_waitcnt vmcnt(17)
v_add_f32 v96, v96, v101
s_waitcnt vmcnt(16)
v_add_f32 v96, v96, v102
s_waitcnt vmcnt(15)
v_add_f32 v96, v96, v103
s_waitcnt vmcnt(14)
v_add_f32 v96, v96, v104
s_waitcnt vmcnt(13)
v_add_f32 v96, v96, v105
s_waitcnt vmcnt(12)
v_add_f32 v96, v96, v106
s_waitcnt vmcnt(11)
v_add_f32 v96, v96, v107
s_waitcnt vmcnt(10)
v_add_f32 v96, v96, v108
s_waitcnt vmcnt(9)
v_add_f32 v96, v96, v109
s_waitcnt vmcnt(8)
v_add_f32 v96, v96, v110
s_waitcnt vmcnt(7)
v_add_f32 v96, v96, v111
s_waitcnt vmcnt(6)
v_add_f32 v96, v96, v20
s_waitcnt vmcnt(5)
v_add_f32 v96, v96, v21
s_waitcnt vmcnt(4)
v_add_f32 v96, v96, v22
s_waitcnt vmcnt(3)
v_add_f32 v96, v96, v23
v_cmp_u_f32 vcc, v96, v96
v_fma_f32 v96, v96, s49, v27
s_cbranch_vccz k_psd_71
s_sub_u32 s32, s32, 1
s_cmp_gt_i32 s32, 0
s_cbranch_scc1 k_ps_70
k_psd_71:
v_rsq_f32 v96, v96
s_add_u32 s45, s45, 20480
ds_write_b32 v24, v96 offset:58368
s_branch k_pyd_73
k_py_72:
buffer_load_dword v16, v30, s[4:7], s44 offen offset:0 sc1
buffer_load_dword v17, v30, s[4:7], s44 offen offset:512 sc1
buffer_load_dword v19, v30, s[4:7], s44 offen offset:1536 sc1
s_sub_u32 s32, s32, 1
k_pyd_73:
s_waitcnt vmcnt(0)
v_max3_u32 v20, v16, v17, v19
v_cmp_eq_u32 vcc, -1, v20
s_cmp_gt_i32 s32, 0
s_cselect_b64 vcc, vcc, 0
s_cbranch_vccnz k_py_72
s_add_u32 s44, s44, 4096
s_waitcnt lgkmcnt(0)
s_barrier
ds_read_b128 v[12:15], v0 offset:58368
v_lshlrev_b32 v180, 16, v16
v_and_b32 v164, 0xffff0000, v16
v_lshlrev_b32 v181, 16, v17
v_and_b32 v165, 0xffff0000, v17
v_lshlrev_b32 v182, 16, v18
v_and_b32 v166, 0xffff0000, v18
v_lshlrev_b32 v183, 16, v19
v_and_b32 v167, 0xffff0000, v19
s_waitcnt lgkmcnt(0)
v_mul_f32 v8, v12, v180
v_mul_f32 v12, v12, v164
v_cvt_pk_bf16_f32 v8, v8, v12
v_and_b32 v8, s47, v8
v_mul_f32 v9, v13, v181
v_mul_f32 v13, v13, v165
v_cvt_pk_bf16_f32 v9, v9, v13
v_and_b32 v9, s47, v9
v_mul_f32 v10, v14, v182
v_mul_f32 v14, v14, v166
v_cvt_pk_bf16_f32 v10, v10, v14
v_and_b32 v10, s47, v10
v_mul_f32 v11, v15, v183
v_mul_f32 v15, v15, v167
v_cvt_pk_bf16_f32 v11, v11, v15
v_and_b32 v11, s47, v11
s_nop 1
v_mfma_f32_32x32x16_bf16 v[32:47], v[8:11], v[112:115], v[32:47]
v_mfma_f32_32x32x16_bf16 v[48:63], v[8:11], v[116:119], v[48:63]
v_mfma_f32_32x32x16_bf16 v[64:79], v[8:11], v[120:123], v[64:79]
v_mfma_f32_32x32x16_bf16 v[80:95], v[8:11], v[124:127], v[80:95]
ds_read_b128 v[112:115], v0 offset:24576
ds_read_b128 v[116:119], v0 offset:25600
ds_read_b128 v[120:123], v0 offset:26624
ds_read_b128 v[124:127], v0 offset:27648
k_pr_74:
buffer_load_dword v18, v30, s[4:7], s44 offen offset:1024 sc1
s_waitcnt vmcnt(0)
v_cmp_eq_u32 vcc, -1, v18
s_cbranch_vccz k_prd_75
s_sleep 8
s_sub_u32 s32, s32, 1
s_cmp_gt_i32 s32, 0
s_cbranch_scc1 k_pr_74
k_prd_75:
k_ps_76:
buffer_load_dword v96, v31, s[4:7], s45 offen offset:0 sc1
buffer_load_dword v97, v31, s[4:7], s45 offen offset:128 sc1
buffer_load_dword v98, v31, s[4:7], s45 offen offset:256 sc1
buffer_load_dword v99, v31, s[4:7], s45 offen offset:384 sc1
buffer_load_dword v100, v31, s[4:7], s45 offen offset:512 sc1
buffer_load_dword v101, v31, s[4:7], s45 offen offset:640 sc1
buffer_load_dword v102, v31, s[4:7], s45 offen offset:768 sc1
buffer_load_dword v103, v31, s[4:7], s45 offen offset:896 sc1
buffer_load_dword v104, v31, s[4:7], s45 offen offset:1024 sc1
buffer_load_dword v105, v31, s[4:7], s45 offen offset:1152 sc1
buffer_load_dword v106, v31, s[4:7], s45 offen offset:1280 sc1
buffer_load_dword v107, v31, s[4:7], s45 offen offset:1408 sc1
buffer_load_dword v108, v31, s[4:7], s45 offen offset:1536 sc1
buffer_load_dword v109, v31, s[4:7], s45 offen offset:1664 sc1
buffer_load_dword v110, v31, s[4:7], s45 offen offset:1792 sc1
buffer_load_dword v111, v31, s[4:7], s45 offen offset:1920 sc1
buffer_load_dword v20, v31, s[4:7], s45 offen offset:2048 sc1
buffer_load_dword v21, v31, s[4:7], s45 offen offset:2176 sc1
buffer_load_dword v22, v31, s[4:7], s45 offen offset:2304 sc1
buffer_load_dword v23, v31, s[4:7], s45 offen offset:2432 sc1
buffer_load_dword v16, v30, s[4:7], s44 offen offset:0 sc1
buffer_load_dword v17, v30, s[4:7], s44 offen offset:512 sc1
buffer_load_dword v19, v30, s[4:7], s44 offen offset:1536 sc1
s_waitcnt vmcnt(21)
v_add_f32 v96, v96, v97
s_waitcnt vmcnt(20)
v_add_f32 v96, v96, v98
s_waitcnt vmcnt(19)
v_add_f32 v96, v96, v99
s_waitcnt vmcnt(18)
v_add_f32 v96, v96, v100
s_waitcnt vmcnt(17)
v_add_f32 v96, v96, v101
s_waitcnt vmcnt(16)
v_add_f32 v96, v96, v102
s_waitcnt vmcnt(15)
v_add_f32 v96, v96, v103
s_waitcnt vmcnt(14)
v_add_f32 v96, v96, v104
s_waitcnt vmcnt(13)
v_add_f32 v96, v96, v105
s_waitcnt vmcnt(12)
v_add_f32 v96, v96, v106
s_waitcnt vmcnt(11)
v_add_f32 v96, v96, v107
s_waitcnt vmcnt(10)
v_add_f32 v96, v96, v108
s_waitcnt vmcnt(9)
v_add_f32 v96, v96, v109
s_waitcnt vmcnt(8)
v_add_f32 v96, v96, v110
s_waitcnt vmcnt(7)
v_add_f32 v96, v96, v111
s_waitcnt vmcnt(6)
v_add_f32 v96, v96, v20
s_waitcnt vmcnt(5)
v_add_f32 v96, v96, v21
s_waitcnt vmcnt(4)
v_add_f32 v96, v96, v22
s_waitcnt vmcnt(3)
v_add_f32 v96, v96, v23
v_cmp_u_f32 vcc, v96, v96
v_fma_f32 v96, v96, s49, v27
s_cbranch_vccz k_psd_77
s_sub_u32 s32, s32, 1
s_cmp_gt_i32 s32, 0
s_cbranch_scc1 k_ps_76
k_psd_77:
v_rsq_f32 v96, v96
s_add_u32 s45, s45, 20480
ds_write_b32 v24, v96 offset:57344
s_branch k_pyd_79
k_py_78:
buffer_load_dword v16, v30, s[4:7], s44 offen offset:0 sc1
buffer_load_dword v17, v30, s[4:7], s44 offen offset:512 sc1
buffer_load_dword v19, v30, s[4:7], s44 offen offset:1536 sc1
s_sub_u32 s32, s32, 1
k_pyd_79:
s_waitcnt vmcnt(0)
v_max3_u32 v20, v16, v17, v19
v_cmp_eq_u32 vcc, -1, v20
s_cmp_gt_i32 s32, 0
s_cselect_b64 vcc, vcc, 0
s_cbranch_vccnz k_py_78
s_add_u32 s44, s44, 4096
s_waitcnt lgkmcnt(0)
s_barrier
ds_read_b128 v[12:15], v0 offset:57344
v_lshlrev_b32 v184, 16, v16
v_and_b32 v168, 0xffff0000, v16
v_lshlrev_b32 v185, 16, v17
v_and_b32 v169, 0xffff0000, v17
v_lshlrev_b32 v186, 16, v18
v_and_b32 v170, 0xffff0000, v18
v_lshlrev_b32 v187, 16, v19
v_and_b32 v171, 0xffff0000, v19
s_waitcnt lgkmcnt(0)
v_mul_f32 v8, v12, v184
v_mul_f32 v12, v12, v168
v_cvt_pk_bf16_f32 v8, v8, v12
v_and_b32 v8, s47, v8
v_mul_f32 v9, v13, v185
v_mul_f32 v13, v13, v169
v_cvt_pk_bf16_f32 v9, v9, v13
v_and_b32 v9, s47, v9
v_mul_f32 v10, v14, v186
v_mul_f32 v14, v14, v170
v_cvt_pk_bf16_f32 v10, v10, v14
v_and_b32 v10, s47, v10
v_mul_f32 v11, v15, v187
v_mul_f32 v15, v15, v171
v_cvt_pk_bf16_f32 v11, v11, v15
v_and_b32 v11, s47, v11
s_nop 1
v_mfma_f32_32x32x16_bf16 v[32:47], v[8:11], v[112:115], v[32:47]
v_mfma_f32_32x32x16_bf16 v[48:63], v[8:11], v[116:119], v[48:63]
v_mfma_f32_32x32x16_bf16 v[64:79], v[8:11], v[120:123], v[64:79]
v_mfma_f32_32x32x16_bf16 v[80:95], v[8:11], v[124:127], v[80:95]
ds_read_b128 v[112:115], v0 offset:28672
ds_read_b128 v[116:119], v0 offset:29696
ds_read_b128 v[120:123], v0 offset:30720
ds_read_b128 v[124:127], v0 offset:31744
k_pr_80:
buffer_load_dword v18, v30, s[4:7], s44 offen offset:1024 sc1
s_waitcnt vmcnt(0)
v_cmp_eq_u32 vcc, -1, v18
s_cbranch_vccz k_prd_81
s_sleep 8
s_sub_u32 s32, s32, 1
s_cmp_gt_i32 s32, 0
s_cbranch_scc1 k_pr_80
k_prd_81:
k_ps_82:
buffer_load_dword v96, v31, s[4:7], s45 offen offset:0 sc1
buffer_load_dword v97, v31, s[4:7], s45 offen offset:128 sc1
buffer_load_dword v98, v31, s[4:7], s45 offen offset:256 sc1
buffer_load_dword v99, v31, s[4:7], s45 offen offset:384 sc1
buffer_load_dword v100, v31, s[4:7], s45 offen offset:512 sc1
buffer_load_dword v101, v31, s[4:7], s45 offen offset:640 sc1
buffer_load_dword v102, v31, s[4:7], s45 offen offset:768 sc1
buffer_load_dword v103, v31, s[4:7], s45 offen offset:896 sc1
buffer_load_dword v104, v31, s[4:7], s45 offen offset:1024 sc1
buffer_load_dword v105, v31, s[4:7], s45 offen offset:1152 sc1
buffer_load_dword v106, v31, s[4:7], s45 offen offset:1280 sc1
buffer_load_dword v107, v31, s[4:7], s45 offen offset:1408 sc1
buffer_load_dword v108, v31, s[4:7], s45 offen offset:1536 sc1
buffer_load_dword v109, v31, s[4:7], s45 offen offset:1664 sc1
buffer_load_dword v110, v31, s[4:7], s45 offen offset:1792 sc1
buffer_load_dword v111, v31, s[4:7], s45 offen offset:1920 sc1
buffer_load_dword v20, v31, s[4:7], s45 offen offset:2048 sc1
buffer_load_dword v21, v31, s[4:7], s45 offen offset:2176 sc1
buffer_load_dword v22, v31, s[4:7], s45 offen offset:2304 sc1
buffer_load_dword v23, v31, s[4:7], s45 offen offset:2432 sc1
buffer_load_dword v16, v30, s[4:7], s44 offen offset:0 sc1
buffer_load_dword v17, v30, s[4:7], s44 offen offset:512 sc1
buffer_load_dword v19, v30, s[4:7], s44 offen offset:1536 sc1
s_waitcnt vmcnt(21)
v_add_f32 v96, v96, v97
s_waitcnt vmcnt(20)
v_add_f32 v96, v96, v98
s_waitcnt vmcnt(19)
v_add_f32 v96, v96, v99
s_waitcnt vmcnt(18)
v_add_f32 v96, v96, v100
s_waitcnt vmcnt(17)
v_add_f32 v96, v96, v101
s_waitcnt vmcnt(16)
v_add_f32 v96, v96, v102
s_waitcnt vmcnt(15)
v_add_f32 v96, v96, v103
s_waitcnt vmcnt(14)
v_add_f32 v96, v96, v104
s_waitcnt vmcnt(13)
v_add_f32 v96, v96, v105
s_waitcnt vmcnt(12)
v_add_f32 v96, v96, v106
s_waitcnt vmcnt(11)
v_add_f32 v96, v96, v107
s_waitcnt vmcnt(10)
v_add_f32 v96, v96, v108
s_waitcnt vmcnt(9)
v_add_f32 v96, v96, v109
s_waitcnt vmcnt(8)
v_add_f32 v96, v96, v110
s_waitcnt vmcnt(7)
v_add_f32 v96, v96, v111
s_waitcnt vmcnt(6)
v_add_f32 v96, v96, v20
s_waitcnt vmcnt(5)
v_add_f32 v96, v96, v21
s_waitcnt vmcnt(4)
v_add_f32 v96, v96, v22
s_waitcnt vmcnt(3)
v_add_f32 v96, v96, v23
v_cmp_u_f32 vcc, v96, v96
v_fma_f32 v96, v96, s49, v27
s_cbranch_vccz k_psd_83
s_sub_u32 s32, s32, 1
s_cmp_gt_i32 s32, 0
s_cbranch_scc1 k_ps_82
k_psd_83:
v_rsq_f32 v96, v96
s_add_u32 s45, s45, 20480
ds_write_b32 v24, v96 offset:58368
s_branch k_pyd_85
k_py_84:
buffer_load_dword v16, v30, s[4:7], s44 offen offset:0 sc1
buffer_load_dword v17, v30, s[4:7], s44 offen offset:512 sc1
buffer_load_dword v19, v30, s[4:7], s44 offen offset:1536 sc1
s_sub_u32 s32, s32, 1
k_pyd_85:
s_waitcnt vmcnt(0)
v_max3_u32 v20, v16, v17, v19
v_cmp_eq_u32 vcc, -1, v20
s_cmp_gt_i32 s32, 0
s_cselect_b64 vcc, vcc, 0
s_cbranch_vccnz k_py_84
s_add_u32 s44, s44, 4096
s_waitcnt lgkmcnt(0)
s_barrier
ds_read_b128 v[12:15], v0 offset:58368
v_lshlrev_b32 v188, 16, v16
v_and_b32 v172, 0xffff0000, v16
v_lshlrev_b32 v189, 16, v17
v_and_b32 v173, 0xffff0000, v17
v_lshlrev_b32 v190, 16, v18
v_and_b32 v174, 0xffff0000, v18
v_lshlrev_b32 v191, 16, v19
v_and_b32 v175, 0xffff0000, v19
s_waitcnt lgkmcnt(0)
v_mul_f32 v8, v12, v188
v_mul_f32 v12, v12, v172
v_cvt_pk_bf16_f32 v8, v8, v12
v_and_b32 v8, s47, v8
v_mul_f32 v9, v13, v189
v_mul_f32 v13, v13, v173
v_cvt_pk_bf16_f32 v9, v9, v13
v_and_b32 v9, s47, v9
v_mul_f32 v10, v14, v190
v_mul_f32 v14, v14, v174
v_cvt_pk_bf16_f32 v10, v10, v14
v_and_b32 v10, s47, v10
v_mul_f32 v11, v15, v191
v_mul_f32 v15, v15, v175
v_cvt_pk_bf16_f32 v11, v11, v15
v_and_b32 v11, s47, v11
s_nop 1
v_mfma_f32_32x32x16_bf16 v[32:47], v[8:11], v[112:115], v[32:47]
v_mfma_f32_32x32x16_bf16 v[48:63], v[8:11], v[116:119], v[48:63]
v_mfma_f32_32x32x16_bf16 v[64:79], v[8:11], v[120:123], v[64:79]
v_mfma_f32_32x32x16_bf16 v[80:95], v[8:11], v[124:127], v[80:95]
ds_read_b128 v[112:115], v0 offset:32768
ds_read_b128 v[116:119], v0 offset:33792
ds_read_b128 v[120:123], v0 offset:34816
ds_read_b128 v[124:127], v0 offset:35840
s_waitcnt lgkmcnt(3)
v_mul_f32 v8, v32, v112
v_mul_f32 v9, v48, v112
s_waitcnt lgkmcnt(2)
v_fmac_f32 v8, v48, v116
v_fma_f32 v9, -v32, v116, v9
v_cvt_pk_bf16_f32 v32, v8, v9
v_mul_f32 v10, v33, v113
v_mul_f32 v11, v49, v113
v_fmac_f32 v10, v49, v117
v_fma_f32 v11, -v33, v117, v11
v_cvt_pk_bf16_f32 v33, v10, v11
v_mul_f32 v8, v34, v114
v_mul_f32 v9, v50, v114
v_fmac_f32 v8, v50, v118
v_fma_f32 v9, -v34, v118, v9
v_cvt_pk_bf16_f32 v34, v8, v9
v_mul_f32 v10, v35, v115
v_mul_f32 v11, v51, v115
v_fmac_f32 v10, v51, v119
v_fma_f32 v11, -v35, v119, v11
v_cvt_pk_bf16_f32 v35, v10, v11
ds_read_b128 v[112:115], v0 offset:36864
ds_read_b128 v[116:119], v0 offset:37888
s_waitcnt lgkmcnt(3)
v_mul_f32 v8, v36, v120
v_mul_f32 v9, v52, v120
s_waitcnt lgkmcnt(2)
v_fmac_f32 v8, v52, v124
v_fma_f32 v9, -v36, v124, v9
v_cvt_pk_bf16_f32 v36, v8, v9
v_mul_f32 v10, v37, v121
v_mul_f32 v11, v53, v121
v_fmac_f32 v10, v53, v125
v_fma_f32 v11, -v37, v125, v11
v_cvt_pk_bf16_f32 v37, v10, v11
v_mul_f32 v8, v38, v122
v_mul_f32 v9, v54, v122
v_fmac_f32 v8, v54, v126
v_fma_f32 v9, -v38, v126, v9
v_cvt_pk_bf16_f32 v38, v8, v9
v_mul_f32 v10, v39, v123
v_mul_f32 v11, v55, v123
v_fmac_f32 v10, v55, v127
v_fma_f32 v11, -v39, v127, v11
v_cvt_pk_bf16_f32 v39, v10, v11
ds_read_b128 v[120:123], v0 offset:38912
ds_read_b128 v[124:127], v0 offset:39936
s_waitcnt lgkmcnt(3)
v_mul_f32 v8, v40, v112
v_mul_f32 v9, v56, v112
s_waitcnt lgkmcnt(2)
v_fmac_f32 v8, v56, v116
v_fma_f32 v9, -v40, v116, v9
v_cvt_pk_bf16_f32 v40, v8, v9
v_mul_f32 v10, v41, v113
v_mul_f32 v11, v57, v113
v_fmac_f32 v10, v57, v117
v_fma_f32 v11, -v41, v117, v11
v_cvt_pk_bf16_f32 v41, v10, v11
v_mul_f32 v8, v42, v114
v_mul_f32 v9, v58, v114
v_fmac_f32 v8, v58, v118
v_fma_f32 v9, -v42, v118, v9
v_cvt_pk_bf16_f32 v42, v8, v9
v_mul_f32 v10, v43, v115
v_mul_f32 v11, v59, v115
v_fmac_f32 v10, v59, v119
v_fma_f32 v11, -v43, v119, v11
v_cvt_pk_bf16_f32 v43, v10, v11
ds_read_b128 v[112:115], v0 offset:40960
ds_read_b128 v[116:119], v0 offset:41984
s_waitcnt lgkmcnt(3)
v_mul_f32 v8, v44, v120
v_mul_f32 v9, v60, v120
s_waitcnt lgkmcnt(2)
v_fmac_f32 v8, v60, v124
v_fma_f32 v9, -v44, v124, v9
v_cvt_pk_bf16_f32 v44, v8, v9
v_mul_f32 v10, v45, v121
v_mul_f32 v11, v61, v121
v_fmac_f32 v10, v61, v125
v_fma_f32 v11, -v45, v125, v11
v_cvt_pk_bf16_f32 v45, v10, v11
v_mul_f32 v8, v46, v122
v_mul_f32 v9, v62, v122
v_fmac_f32 v8, v62, v126
v_fma_f32 v9, -v46, v126, v9
v_cvt_pk_bf16_f32 v46, v8, v9
v_mul_f32 v10, v47, v123
v_mul_f32 v11, v63, v123
v_fmac_f32 v10, v63, v127
v_fma_f32 v11, -v47, v127, v11
v_cvt_pk_bf16_f32 v47, v10, v11
ds_read_b128 v[120:123], v0 offset:43008
ds_read_b128 v[124:127], v0 offset:44032
v_mfma_f32_32x32x16_bf16 v[48:63], a[160:163], v[32:35], 0
s_waitcnt lgkmcnt(3)
v_mul_f32 v8, v64, v112
v_mul_f32 v9, v80, v112
s_waitcnt lgkmcnt(2)
v_fmac_f32 v8, v80, v116
v_fma_f32 v9, -v64, v116, v9
v_cvt_pk_bf16_f32 v64, v8, v9
v_mul_f32 v10, v65, v113
v_mul_f32 v11, v81, v113
v_fmac_f32 v10, v81, v117
v_mfma_f32_32x32x16_bf16 v[96:111], a[164:167], v[32:35], 0
v_fma_f32 v11, -v65, v117, v11
v_cvt_pk_bf16_f32 v65, v10, v11
v_mul_f32 v8, v66, v114
v_mul_f32 v9, v82, v114
v_fmac_f32 v8, v82, v118
v_fma_f32 v9, -v66, v118, v9
v_cvt_pk_bf16_f32 v66, v8, v9
v_mul_f32 v10, v67, v115
v_mfma_f32_32x32x16_bf16 v[48:63], a[168:171], v[36:39], v[48:63]
v_mul_f32 v11, v83, v115
v_fmac_f32 v10, v83, v119
v_fma_f32 v11, -v67, v119, v11
v_cvt_pk_bf16_f32 v67, v10, v11
ds_read_b128 v[112:115], v0 offset:45056
ds_read_b128 v[116:119], v0 offset:46080
s_waitcnt lgkmcnt(3)
v_mul_f32 v8, v68, v120
v_mul_f32 v9, v84, v120
v_mfma_f32_32x32x16_bf16 v[96:111], a[172:175], v[36:39], v[96:111]
s_waitcnt lgkmcnt(2)
v_fmac_f32 v8, v84, v124
v_fma_f32 v9, -v68, v124, v9
v_cvt_pk_bf16_f32 v68, v8, v9
v_mul_f32 v10, v69, v121
v_mul_f32 v11, v85, v121
v_fmac_f32 v10, v85, v125
v_fma_f32 v11, -v69, v125, v11
v_cvt_pk_bf16_f32 v69, v10, v11
v_mfma_f32_32x32x16_bf16 v[48:63], a[176:179], v[40:43], v[48:63]
v_mul_f32 v8, v70, v122
v_mul_f32 v9, v86, v122
v_fmac_f32 v8, v86, v126
v_fma_f32 v9, -v70, v126, v9
v_cvt_pk_bf16_f32 v70, v8, v9
v_mul_f32 v10, v71, v123
v_mul_f32 v11, v87, v123
v_fmac_f32 v10, v87, v127
v_mfma_f32_32x32x16_bf16 v[96:111], a[180:183], v[40:43], v[96:111]
v_fma_f32 v11, -v71, v127, v11
v_cvt_pk_bf16_f32 v71, v10, v11
ds_read_b128 v[120:123], v0 offset:47104
ds_read_b128 v[124:127], v0 offset:48128
s_waitcnt lgkmcnt(3)
v_mul_f32 v8, v72, v112
v_mul_f32 v9, v88, v112
s_waitcnt lgkmcnt(2)
v_fmac_f32 v8, v88, v116
v_fma_f32 v9, -v72, v116, v9
v_mfma_f32_32x32x16_bf16 v[48:63], a[184:187], v[44:47], v[48:63]
v_cvt_pk_bf16_f32 v72, v8, v9
v_mul_f32 v10, v73, v113
v_mul_f32 v11, v89, v113
v_fmac_f32 v10, v89, v117
v_fma_f32 v11, -v73, v117, v11
v_cvt_pk_bf16_f32 v73, v10, v11
v_mul_f32 v8, v74, v114
v_mul_f32 v9, v90, v114
v_mfma_f32_32x32x16_bf16 v[96:111], a[188:191], v[44:47], v[96:111]
v_fmac_f32 v8, v90, v118
v_fma_f32 v9, -v74, v118, v9
v_cvt_pk_bf16_f32 v74, v8, v9
v_mul_f32 v10, v75, v115
v_mul_f32 v11, v91, v115
v_fmac_f32 v10, v91, v119
v_fma_f32 v11, -v75, v119, v11
v_cvt_pk_bf16_f32 v75, v10, v11
ds_read_b128 v[112:115], v0 offset:32768
ds_read_b128 v[116:119], v0 offset:33792
s_waitcnt lgkmcnt(3)
v_mul_f32 v8, v76, v120
v_mul_f32 v9, v92, v120
s_waitcnt lgkmcnt(2)
v_fmac_f32 v8, v92, v124
v_fma_f32 v9, -v76, v124, v9
v_cvt_pk_bf16_f32 v76, v8, v9
v_mul_f32 v10, v77, v121
v_mul_f32 v11, v93, v121
v_fmac_f32 v10, v93, v125
v_fma_f32 v11, -v77, v125, v11
v_cvt_pk_bf16_f32 v77, v10, v11
v_mul_f32 v8, v78, v122
v_mul_f32 v9, v94, v122
v_fmac_f32 v8, v94, v126
v_fma_f32 v9, -v78, v126, v9
v_cvt_pk_bf16_f32 v78, v8, v9
v_mul_f32 v10, v79, v123
v_mul_f32 v11, v95, v123
v_fmac_f32 v10, v95, v127
v_fma_f32 v11, -v79, v127, v11
v_cvt_pk_bf16_f32 v79, v10, v11
ds_read_b128 v[120:123], v0 offset:34816
ds_read_b128 v[124:127], v0 offset:35840
v_mfma_f32_32x32x16_bf16 v[80:95], a[160:163], v[64:67], 0
v_mul_f32 v8, v48, v208
v_mul_f32 v9, v96, v208
v_fmac_f32 v8, v96, v192
v_fma_f32 v9, v48, v192, -v9
v_cvt_pk_bf16_f32 v48, v8, v9
v_mul_f32 v10, v49, v209
v_mul_f32 v11, v97, v209
v_fmac_f32 v10, v97, v193
v_mfma_f32_32x32x16_bf16 v[32:47], a[164:167], v[64:67], 0
v_fma_f32 v11, v49, v193, -v11
v_cvt_pk_bf16_f32 v49, v10, v11
v_mul_f32 v8, v50, v210
v_mul_f32 v9, v98, v210
v_fmac_f32 v8, v98, v194
v_fma_f32 v9, v50, v194, -v9
v_cvt_pk_bf16_f32 v50, v8, v9
v_mul_f32 v10, v51, v211
v_mfma_f32_32x32x16_bf16 v[80:95], a[168:171], v[68:71], v[80:95]
v_mul_f32 v11, v99, v211
v_fmac_f32 v10, v99, v195
v_fma_f32 v11, v51, v195, -v11
v_cvt_pk_bf16_f32 v51, v10, v11
v_mul_f32 v8, v52, v212
v_mul_f32 v9, v100, v212
v_fmac_f32 v8, v100, v196
v_fma_f32 v9, v52, v196, -v9
v_mfma_f32_32x32x16_bf16 v[32:47], a[172:175], v[68:71], v[32:47]
v_cvt_pk_bf16_f32 v52, v8, v9
v_mul_f32 v10, v53, v213
v_mul_f32 v11, v101, v213
v_fmac_f32 v10, v101, v197
v_fma_f32 v11, v53, v197, -v11
v_cvt_pk_bf16_f32 v53, v10, v11
v_mul_f32 v8, v54, v214
v_mul_f32 v9, v102, v214
v_mfma_f32_32x32x16_bf16 v[80:95], a[176:179], v[72:75], v[80:95]
v_fmac_f32 v8, v102, v198
v_fma_f32 v9, v54, v198, -v9
v_cvt_pk_bf16_f32 v54, v8, v9
v_mul_f32 v10, v55, v215
v_mul_f32 v11, v103, v215
v_fmac_f32 v10, v103, v199
v_fma_f32 v11, v55, v199, -v11
v_cvt_pk_bf16_f32 v55, v10, v11
v_mfma_f32_32x32x16_bf16 v[32:47], a[180:183], v[72:75], v[32:47]
v_mul_f32 v8, v56, v216
v_mul_f32 v9, v104, v216
v_fmac_f32 v8, v104, v200
v_fma_f32 v9, v56, v200, -v9
v_cvt_pk_bf16_f32 v56, v8, v9
v_mul_f32 v10, v57, v217
v_mul_f32 v11, v105, v217
v_fmac_f32 v10, v105, v201
v_mfma_f32_32x32x16_bf16 v[80:95], a[184:187], v[76:79], v[80:95]
v_fma_f32 v11, v57, v201, -v11
v_cvt_pk_bf16_f32 v57, v10, v11
v_mul_f32 v8, v58, v218
v_mul_f32 v9, v106, v218
v_fmac_f32 v8, v106, v202
v_fma_f32 v9, v58, v202, -v9
v_cvt_pk_bf16_f32 v58, v8, v9
v_mul_f32 v10, v59, v219
v_mfma_f32_32x32x16_bf16 v[32:47], a[188:191], v[76:79], v[32:47]
v_mul_f32 v11, v107, v219
v_fmac_f32 v10, v107, v203
v_fma_f32 v11, v59, v203, -v11
v_cvt_pk_bf16_f32 v59, v10, v11
v_mul_f32 v8, v60, v220
v_mul_f32 v9, v108, v220
v_fmac_f32 v8, v108, v204
v_fma_f32 v9, v60, v204, -v9
v_cvt_pk_bf16_f32 v60, v8, v9
v_mul_f32 v10, v61, v221
v_mul_f32 v11, v109, v221
v_fmac_f32 v10, v109, v205
v_fma_f32 v11, v61, v205, -v11
v_cvt_pk_bf16_f32 v61, v10, v11
v_mul_f32 v8, v62, v222
v_mul_f32 v9, v110, v222
v_fmac_f32 v8, v110, v206
v_fma_f32 v9, v62, v206, -v9
v_cvt_pk_bf16_f32 v62, v8, v9
v_mul_f32 v10, v63, v223
v_mul_f32 v11, v111, v223
v_fmac_f32 v10, v111, v207
v_fma_f32 v11, v63, v207, -v11
v_cvt_pk_bf16_f32 v63, v10, v11
v_mfma_f32_32x32x16_bf16 v[96:111], v[48:51], a[160:163], 0
v_mul_f32 v8, v80, v240
v_mul_f32 v9, v32, v240
v_fmac_f32 v8, v32, v224
v_fma_f32 v9, v80, v224, -v9
v_cvt_pk_bf16_f32 v80, v8, v9
v_mul_f32 v10, v81, v241
v_mul_f32 v11, v33, v241
v_fmac_f32 v10, v33, v225
v_mfma_f32_32x32x16_bf16 v[64:79], v[48:51], a[164:167], 0
v_fma_f32 v11, v81, v225, -v11
v_cvt_pk_bf16_f32 v81, v10, v11
v_mul_f32 v8, v82, v242
v_mul_f32 v9, v34, v242
v_fmac_f32 v8, v34, v226
v_fma_f32 v9, v82, v226, -v9
v_cvt_pk_bf16_f32 v82, v8, v9
v_mul_f32 v10, v83, v243
v_mfma_f32_32x32x16_bf16 v[96:111], v[52:55], a[168:171], v[96:111]
v_mul_f32 v11, v35, v243
v_fmac_f32 v10, v35, v227
v_fma_f32 v11, v83, v227, -v11
v_cvt_pk_bf16_f32 v83, v10, v11
v_mul_f32 v8, v84, v244
v_mul_f32 v9, v36, v244
v_fmac_f32 v8, v36, v228
v_fma_f32 v9, v84, v228, -v9
v_mfma_f32_32x32x16_bf16 v[64:79], v[52:55], a[172:175], v[64:79]
v_cvt_pk_bf16_f32 v84, v8, v9
v_mul_f32 v10, v85, v245
v_mul_f32 v11, v37, v245
v_fmac_f32 v10, v37, v229
v_fma_f32 v11, v85, v229, -v11
v_cvt_pk_bf16_f32 v85, v10, v11
v_mul_f32 v8, v86, v246
v_mul_f32 v9, v38, v246
v_mfma_f32_32x32x16_bf16 v[96:111], v[56:59], a[176:179], v[96:111]
v_fmac_f32 v8, v38, v230
v_fma_f32 v9, v86, v230, -v9
v_cvt_pk_bf16_f32 v86, v8, v9
v_mul_f32 v10, v87, v247
v_mul_f32 v11, v39, v247
v_fmac_f32 v10, v39, v231
v_fma_f32 v11, v87, v231, -v11
v_cvt_pk_bf16_f32 v87, v10, v11
v_mfma_f32_32x32x16_bf16 v[64:79], v[56:59], a[180:183], v[64:79]
v_mul_f32 v8, v88, v248
v_mul_f32 v9, v40, v248
v_fmac_f32 v8, v40, v232
v_fma_f32 v9, v88, v232, -v9
v_cvt_pk_bf16_f32 v88, v8, v9
v_mul_f32 v10, v89, v249
v_mul_f32 v11, v41, v249
v_fmac_f32 v10, v41, v233
v_mfma_f32_32x32x16_bf16 v[96:111], v[60:63], a[184:187], v[96:111]
v_fma_f32 v11, v89, v233, -v11
v_cvt_pk_bf16_f32 v89, v10, v11
v_mul_f32 v8, v90, v250
v_mul_f32 v9, v42, v250
v_fmac_f32 v8, v42, v234
v_fma_f32 v9, v90, v234, -v9
v_cvt_pk_bf16_f32 v90, v8, v9
v_mul_f32 v10, v91, v251
v_mfma_f32_32x32x16_bf16 v[64:79], v[60:63], a[188:191], v[64:79]
v_mul_f32 v11, v43, v251
v_fmac_f32 v10, v43, v235
v_fma_f32 v11, v91, v235, -v11
v_cvt_pk_bf16_f32 v91, v10, v11
v_mul_f32 v8, v92, v252
v_mul_f32 v9, v44, v252
v_fmac_f32 v8, v44, v236
v_fma_f32 v9, v92, v236, -v9
v_cvt_pk_bf16_f32 v92, v8, v9
v_mul_f32 v10, v93, v253
v_mul_f32 v11, v45, v253
v_fmac_f32 v10, v45, v237
v_fma_f32 v11, v93, v237, -v11
v_cvt_pk_bf16_f32 v93, v10, v11
v_mul_f32 v8, v94, v254
v_mul_f32 v9, v46, v254
v_fmac_f32 v8, v46, v238
v_fma_f32 v9, v94, v238, -v9
v_cvt_pk_bf16_f32 v94, v8, v9
v_mul_f32 v10, v95, v255
v_mul_f32 v11, v47, v255
v_fmac_f32 v10, v47, v239
v_fma_f32 v11, v95, v239, -v11
v_cvt_pk_bf16_f32 v95, v10, v11
v_mfma_f32_32x32x16_bf16 v[32:47], v[80:83], a[160:163], 0
s_waitcnt lgkmcnt(3)
v_mul_f32 v8, v96, v112
v_mul_f32 v9, v64, v112
s_waitcnt lgkmcnt(2)
v_fmac_f32 v8, v64, v116
v_fma_f32 v9, -v96, v116, v9
v_cvt_pk_bf16_f32 v96, v8, v9
v_mul_f32 v10, v97, v113
v_mul_f32 v11, v65, v113
v_fmac_f32 v10, v65, v117
v_mfma_f32_32x32x16_bf16 v[48:63], v[80:83], a[164:167], 0
v_fma_f32 v11, -v97, v117, v11
v_cvt_pk_bf16_f32 v97, v10, v11
v_mul_f32 v8, v98, v114
v_mul_f32 v9, v66, v114
v_fmac_f32 v8, v66, v118
v_fma_f32 v9, -v98, v118, v9
v_cvt_pk_bf16_f32 v98, v8, v9
v_mul_f32 v10, v99, v115
v_mfma_f32_32x32x16_bf16 v[32:47], v[84:87], a[168:171], v[32:47]
v_mul_f32 v11, v67, v115
v_fmac_f32 v10, v67, v119
v_fma_f32 v11, -v99, v119, v11
v_cvt_pk_bf16_f32 v99, v10, v11
ds_read_b128 v[112:115], v0 offset:36864
ds_read_b128 v[116:119], v0 offset:37888
s_waitcnt lgkmcnt(3)
v_mul_f32 v8, v100, v120
v_mul_f32 v9, v68, v120
v_mfma_f32_32x32x16_bf16 v[48:63], v[84:87], a[172:175], v[48:63]
s_waitcnt lgkmcnt(2)
v_fmac_f32 v8, v68, v124
v_fma_f32 v9, -v100, v124, v9
v_cvt_pk_bf16_f32 v100, v8, v9
v_mul_f32 v10, v101, v121
v_mul_f32 v11, v69, v121
v_fmac_f32 v10, v69, v125
v_fma_f32 v11, -v101, v125, v11
v_cvt_pk_bf16_f32 v101, v10, v11
v_mfma_f32_32x32x16_bf16 v[32:47], v[88:91], a[176:179], v[32:47]
v_mul_f32 v8, v102, v122
v_mul_f32 v9, v70, v122
v_fmac_f32 v8, v70, v126
v_fma_f32 v9, -v102, v126, v9
v_cvt_pk_bf16_f32 v102, v8, v9
v_mul_f32 v10, v103, v123
v_mul_f32 v11, v71, v123
v_fmac_f32 v10, v71, v127
v_mfma_f32_32x32x16_bf16 v[48:63], v[88:91], a[180:183], v[48:63]
v_fma_f32 v11, -v103, v127, v11
v_cvt_pk_bf16_f32 v103, v10, v11
ds_read_b128 v[120:123], v0 offset:38912
ds_read_b128 v[124:127], v0 offset:39936
s_waitcnt lgkmcnt(3)
v_mul_f32 v8, v104, v112
v_mul_f32 v9, v72, v112
s_waitcnt lgkmcnt(2)
v_fmac_f32 v8, v72, v116
v_fma_f32 v9, -v104, v116, v9
v_mfma_f32_32x32x16_bf16 v[32:47], v[92:95], a[184:187], v[32:47]
v_cvt_pk_bf16_f32 v104, v8, v9
v_mul_f32 v10, v105, v113
v_mul_f32 v11, v73, v113
v_fmac_f32 v10, v73, v117
v_fma_f32 v11, -v105, v117, v11
v_cvt_pk_bf16_f32 v105, v10, v11
v_mul_f32 v8, v106, v114
v_mul_f32 v9, v74, v114
v_mfma_f32_32x32x16_bf16 v[48:63], v[92:95], a[188:191], v[48:63]
v_fmac_f32 v8, v74, v118
v_fma_f32 v9, -v106, v118, v9
v_cvt_pk_bf16_f32 v106, v8, v9
v_mul_f32 v10, v107, v115
v_mul_f32 v11, v75, v115
v_fmac_f32 v10, v75, v119
v_fma_f32 v11, -v107, v119, v11
v_cvt_pk_bf16_f32 v107, v10, v11
ds_read_b128 v[112:115], v0 offset:49152
ds_read_b128 v[116:119], v0 offset:50176
s_waitcnt lgkmcnt(3)
v_mul_f32 v8, v108, v120
v_mul_f32 v9, v76, v120
s_waitcnt lgkmcnt(2)
v_fmac_f32 v8, v76, v124
v_fma_f32 v9, -v108, v124, v9
v_cvt_pk_bf16_f32 v108, v8, v9
v_mul_f32 v10, v109, v121
v_mul_f32 v11, v77, v121
v_fmac_f32 v10, v77, v125
v_fma_f32 v11, -v109, v125, v11
v_cvt_pk_bf16_f32 v109, v10, v11
v_mul_f32 v8, v110, v122
v_mul_f32 v9, v78, v122
v_fmac_f32 v8, v78, v126
v_fma_f32 v9, -v110, v126, v9
v_cvt_pk_bf16_f32 v110, v8, v9
v_mul_f32 v10, v111, v123
v_mul_f32 v11, v79, v123
v_fmac_f32 v10, v79, v127
v_fma_f32 v11, -v111, v127, v11
v_cvt_pk_bf16_f32 v111, v10, v11
ds_read_b128 v[120:123], v0 offset:51200
ds_read_b128 v[124:127], v0 offset:52224
ds_read_b128 v[80:83], v26 offset:0
ds_read_b128 v[84:87], v0 offset:1024
ds_read_b128 v[88:91], v26 offset:2048
ds_read_b128 v[92:95], v0 offset:3072
ds_read_b128 v[64:67], v26 offset:4096
ds_read_b128 v[68:71], v0 offset:5120
s_lshl_b32 s52, s3, 10
v_add_u32 v20, s52, v0
v_add_u32 v20, 65536, v20
s_waitcnt lgkmcnt(5)
v_mfma_f32_32x32x16_bf16 v[128:143], v[80:83], v[96:99], v[128:143]
ds_read_b128 v[72:75], v26 offset:6144
v_mul_f32 v8, v32, v112
v_mul_f32 v9, v48, v112
v_fmac_f32 v8, v48, v116
v_fma_f32 v9, -v32, v116, v9
v_cvt_pk_bf16_f32 v32, v8, v9
v_mul_f32 v10, v33, v113
s_waitcnt lgkmcnt(5)
v_mfma_f32_32x32x16_bf16 v[144:159], v[84:87], v[96:99], v[144:159]
ds_read_b128 v[76:79], v0 offset:7168
v_mul_f32 v11, v49, v113
v_fmac_f32 v10, v49, v117
v_fma_f32 v11, -v33, v117, v11
v_cvt_pk_bf16_f32 v33, v10, v11
v_mul_f32 v8, v34, v114
v_mul_f32 v9, v50, v114
s_waitcnt lgkmcnt(5)
v_mfma_f32_32x32x16_bf16 v[160:175], v[88:91], v[96:99], v[160:175]
ds_read_b128 v[80:83], v26 offset:8192
v_fmac_f32 v8, v50, v118
v_fma_f32 v9, -v34, v118, v9
v_cvt_pk_bf16_f32 v34, v8, v9
v_mul_f32 v10, v35, v115
v_mul_f32 v11, v51, v115
v_fmac_f32 v10, v51, v119
s_waitcnt lgkmcnt(5)
v_mfma_f32_32x32x16_bf16 v[176:191], v[92:95], v[96:99], v[176:191]
ds_read_b128 v[84:87], v0 offset:9216
v_fma_f32 v11, -v35, v119, v11
v_cvt_pk_bf16_f32 v35, v10, v11
ds_read_b128 v[112:115], v0 offset:53248
ds_read_b128 v[116:119], v0 offset:54272
v_mul_f32 v8, v36, v120
v_mul_f32 v9, v52, v120
s_waitcnt lgkmcnt(7)
v_mfma_f32_32x32x16_bf16 v[128:143], v[64:67], v[100:103], v[128:143]
ds_read_b128 v[88:91], v26 offset:10240
v_fmac_f32 v8, v52, v124
v_fma_f32 v9, -v36, v124, v9
v_cvt_pk_bf16_f32 v36, v8, v9
v_mul_f32 v10, v37, v121
v_mul_f32 v11, v53, v121
v_fmac_f32 v10, v53, v125
s_waitcnt lgkmcnt(7)
v_mfma_f32_32x32x16_bf16 v[144:159], v[68:71], v[100:103], v[144:159]
ds_read_b128 v[92:95], v0 offset:11264
v_fma_f32 v11, -v37, v125, v11
v_cvt_pk_bf16_f32 v37, v10, v11
v_mul_f32 v8, v38, v122
v_mul_f32 v9, v54, v122
v_fmac_f32 v8, v54, v126
v_fma_f32 v9, -v38, v126, v9
s_waitcnt lgkmcnt(7)
v_mfma_f32_32x32x16_bf16 v[160:175], v[72:75], v[100:103], v[160:175]
ds_read_b128 v[64:67], v26 offset:12288
v_cvt_pk_bf16_f32 v38, v8, v9
v_mul_f32 v10, v39, v123
v_mul_f32 v11, v55, v123
v_fmac_f32 v10, v55, v127
v_fma_f32 v11, -v39, v127, v11
v_cvt_pk_bf16_f32 v39, v10, v11
s_waitcnt lgkmcnt(7)
v_mfma_f32_32x32x16_bf16 v[176:191], v[76:79], v[100:103], v[176:191]
ds_read_b128 v[68:71], v0 offset:13312
ds_read_b128 v[120:123], v0 offset:55296
ds_read_b128 v[124:127], v0 offset:56320
s_waitcnt lgkmcnt(7)
v_mul_f32 v8, v40, v112
v_mul_f32 v9, v56, v112
s_waitcnt lgkmcnt(6)
v_fmac_f32 v8, v56, v116
v_fma_f32 v9, -v40, v116, v9
v_mfma_f32_32x32x16_bf16 v[128:143], v[80:83], v[104:107], v[128:143]
ds_read_b128 v[72:75], v26 offset:14336
v_cvt_pk_bf16_f32 v40, v8, v9
v_mul_f32 v10, v41, v113
v_mul_f32 v11, v57, v113
v_fmac_f32 v10, v57, v117
v_fma_f32 v11, -v41, v117, v11
v_cvt_pk_bf16_f32 v41, v10, v11
v_mfma_f32_32x32x16_bf16 v[144:159], v[84:87], v[104:107], v[144:159]
ds_read_b128 v[76:79], v0 offset:15360
v_mul_f32 v8, v42, v114
v_mul_f32 v9, v58, v114
v_fmac_f32 v8, v58, v118
v_fma_f32 v9, -v42, v118, v9
v_cvt_pk_bf16_f32 v42, v8, v9
v_mul_f32 v10, v43, v115
s_waitcnt lgkmcnt(7)
v_mfma_f32_32x32x16_bf16 v[160:175], v[88:91], v[104:107], v[160:175]
ds_read_b128 v[80:83], v26 offset:16384
v_mul_f32 v11, v59, v115
v_fmac_f32 v10, v59, v119
v_fma_f32 v11, -v43, v119, v11
v_cvt_pk_bf16_f32 v43, v10, v11
s_waitcnt lgkmcnt(4)
v_mul_f32 v8, v44, v120
v_mul_f32 v9, v60, v120
v_mfma_f32_32x32x16_bf16 v[176:191], v[92:95], v[104:107], v[176:191]
ds_read_b128 v[84:87], v0 offset:17408
s_waitcnt lgkmcnt(4)
v_fmac_f32 v8, v60, v124
v_fma_f32 v9, -v44, v124, v9
v_cvt_pk_bf16_f32 v44, v8, v9
v_mul_f32 v10, v45, v121
v_mul_f32 v11, v61, v121
v_fmac_f32 v10, v61, v125
v_mfma_f32_32x32x16_bf16 v[128:143], v[64:67], v[108:111], v[128:143]
ds_read_b128 v[88:91], v26 offset:20480
v_fma_f32 v11, -v45, v125, v11
v_cvt_pk_bf16_f32 v45, v10, v11
v_mul_f32 v8, v46, v122
v_mul_f32 v9, v62, v122
v_fmac_f32 v8, v62, v126
v_fma_f32 v9, -v46, v126, v9
v_mfma_f32_32x32x16_bf16 v[144:159], v[68:71], v[108:111], v[144:159]
ds_read_b128 v[92:95], v0 offset:21504
v_cvt_pk_bf16_f32 v46, v8, v9
v_mul_f32 v10, v47, v123
v_mul_f32 v11, v63, v123
v_fmac_f32 v10, v63, v127
v_fma_f32 v11, -v47, v127, v11
v_cvt_pk_bf16_f32 v47, v10, v11
s_waitcnt lgkmcnt(5)
v_mfma_f32_32x32x16_bf16 v[160:175], v[72:75], v[108:111], v[160:175]
ds_read_b128 v[64:67], v26 offset:24576
s_waitcnt lgkmcnt(5)
v_mfma_f32_32x32x16_bf16 v[176:191], v[76:79], v[108:111], v[176:191]
ds_read_b128 v[68:71], v0 offset:25600
s_waitcnt lgkmcnt(5)
v_mfma_f32_32x32x16_bf16 v[128:143], v[80:83], v[32:35], v[128:143]
ds_read_b128 v[72:75], v26 offset:28672
s_waitcnt lgkmcnt(5)
v_mfma_f32_32x32x16_bf16 v[144:159], v[84:87], v[32:35], v[144:159]
ds_read_b128 v[76:79], v0 offset:29696
s_waitcnt lgkmcnt(5)
v_mfma_f32_32x32x16_bf16 v[128:143], v[88:91], v[36:39], v[128:143]
ds_read_b128 v[80:83], v26 offset:18432
s_waitcnt lgkmcnt(5)
v_mfma_f32_32x32x16_bf16 v[144:159], v[92:95], v[36:39], v[144:159]
ds_read_b128 v[84:87], v0 offset:19456
s_waitcnt lgkmcnt(5)
v_mfma_f32_32x32x16_bf16 v[128:143], v[64:67], v[40:43], v[128:143]
ds_read_b128 v[88:91], v26 offset:22528
s_waitcnt lgkmcnt(5)
v_mfma_f32_32x32x16_bf16 v[144:159], v[68:71], v[40:43], v[144:159]
ds_read_b128 v[92:95], v0 offset:23552
s_waitcnt lgkmcnt(5)
v_mfma_f32_32x32x16_bf16 v[128:143], v[72:75], v[44:47], v[128:143]
ds_read_b128 v[64:67], v26 offset:26624
s_waitcnt lgkmcnt(5)
v_mfma_f32_32x32x16_bf16 v[144:159], v[76:79], v[44:47], v[144:159]
ds_read_b128 v[68:71], v0 offset:27648
s_waitcnt lgkmcnt(5)
v_mfma_f32_32x32x16_bf16 v[160:175], v[80:83], v[32:35], v[160:175]
ds_read_b128 v[72:75], v26 offset:30720
s_waitcnt lgkmcnt(5)
v_mfma_f32_32x32x16_bf16 v[176:191], v[84:87], v[32:35], v[176:191]
ds_read_b128 v[76:79], v0 offset:31744
v_cvt_pk_bf16_f32 v128, v144, v128
v_cvt_pk_bf16_f32 v129, v145, v129
v_cvt_pk_bf16_f32 v130, v146, v130
v_cvt_pk_bf16_f32 v131, v147, v131
ds_write_b128 v20, v[128:131] offset:0
v_cvt_pk_bf16_f32 v132, v148, v132
s_waitcnt lgkmcnt(6)
v_mfma_f32_32x32x16_bf16 v[160:175], v[88:91], v[36:39], v[160:175]
v_cvt_pk_bf16_f32 v133, v149, v133
v_cvt_pk_bf16_f32 v134, v150, v134
v_cvt_pk_bf16_f32 v135, v151, v135
ds_write_b128 v20, v[132:135] offset:4096
v_cvt_pk_bf16_f32 v136, v152, v136
v_cvt_pk_bf16_f32 v137, v153, v137
s_waitcnt lgkmcnt(6)
v_mfma_f32_32x32x16_bf16 v[176:191], v[92:95], v[36:39], v[176:191]
v_cvt_pk_bf16_f32 v138, v154, v138
v_cvt_pk_bf16_f32 v139, v155, v139
ds_write_b128 v20, v[136:139] offset:8192
v_cvt_pk_bf16_f32 v140, v156, v140
v_cvt_pk_bf16_f32 v141, v157, v141
v_cvt_pk_bf16_f32 v142, v158, v142
s_waitcnt lgkmcnt(6)
v_mfma_f32_32x32x16_bf16 v[160:175], v[64:67], v[40:43], v[160:175]
v_cvt_pk_bf16_f32 v143, v159, v143
ds_write_b128 v20, v[140:143] offset:12288
s_waitcnt lgkmcnt(6)
v_mfma_f32_32x32x16_bf16 v[176:191], v[68:71], v[40:43], v[176:191]
s_waitcnt lgkmcnt(5)
v_mfma_f32_32x32x16_bf16 v[160:175], v[72:75], v[44:47], v[160:175]
s_waitcnt lgkmcnt(4)
v_mfma_f32_32x32x16_bf16 v[176:191], v[76:79], v[44:47], v[176:191]
s_nop 11
v_cvt_pk_bf16_f32 v160, v176, v160
v_cvt_pk_bf16_f32 v161, v177, v161
v_cvt_pk_bf16_f32 v162, v178, v162
v_cvt_pk_bf16_f32 v163, v179, v163
ds_write_b128 v20, v[160:163] offset:16384
v_cvt_pk_bf16_f32 v164, v180, v164
v_cvt_pk_bf16_f32 v165, v181, v165
v_cvt_pk_bf16_f32 v166, v182, v166
v_cvt_pk_bf16_f32 v167, v183, v167
ds_write_b128 v20, v[164:167] offset:20480
v_cvt_pk_bf16_f32 v168, v184, v168
v_cvt_pk_bf16_f32 v169, v185, v169
v_cvt_pk_bf16_f32 v170, v186, v170
v_cvt_pk_bf16_f32 v171, v187, v171
ds_write_b128 v20, v[168:171] offset:24576
v_cvt_pk_bf16_f32 v172, v188, v172
v_cvt_pk_bf16_f32 v173, v189, v173
v_cvt_pk_bf16_f32 v174, v190, v174
v_cvt_pk_bf16_f32 v175, v191, v175
ds_write_b128 v20, v[172:175] offset:28672
s_lshl_b32 s52, s3, 12
s_add_u32 s52, s52, 65536
v_add_u32 v20, s52, v0
s_waitcnt lgkmcnt(0)
s_barrier
ds_read_b128 v[32:35], v20 offset:0
ds_read_b128 v[36:39], v20 offset:1024
ds_read_b128 v[40:43], v20 offset:2048
ds_read_b128 v[44:47], v20 offset:3072
ds_read_b128 v[48:51], v20 offset:16384
ds_read_b128 v[52:55], v20 offset:17408
ds_read_b128 v[56:59], v20 offset:18432
ds_read_b128 v[60:63], v20 offset:19456
s_waitcnt lgkmcnt(6)
v_swap_b32 v33, v36
s_waitcnt lgkmcnt(5)
v_swap_b32 v34, v40
s_waitcnt lgkmcnt(4)
v_swap_b32 v35, v44
buffer_store_dwordx4 v[32:35], v25, s[4:7], s48 offen sc1
s_add_u32 s48, s48, 40960
v_swap_b32 v38, v41
v_swap_b32 v39, v45
buffer_store_dwordx4 v[36:39], v25, s[4:7], s48 offen sc1
s_add_u32 s48, s48, 40960
v_swap_b32 v43, v46
buffer_store_dwordx4 v[40:43], v25, s[4:7], s48 offen sc1
s_add_u32 s48, s48, 40960
buffer_store_dwordx4 v[44:47], v25, s[4:7], s48 offen sc1
s_add_u32 s48, s48, 1187840
s_waitcnt lgkmcnt(2)
v_swap_b32 v49, v52
s_waitcnt lgkmcnt(1)
v_swap_b32 v50, v56
s_waitcnt lgkmcnt(0)
v_swap_b32 v51, v60
buffer_store_dwordx4 v[48:51], v25, s[4:7], s48 offen sc1
s_add_u32 s48, s48, 40960
v_swap_b32 v54, v57
v_swap_b32 v55, v61
buffer_store_dwordx4 v[52:55], v25, s[4:7], s48 offen sc1
s_add_u32 s48, s48, 40960
v_swap_b32 v59, v62
buffer_store_dwordx4 v[56:59], v25, s[4:7], s48 offen sc1
s_add_u32 s48, s48, 40960
buffer_store_dwordx4 v[60:63], v25, s[4:7], s48 offen sc1
s_add_u32 s48, s48, 1187840
s_lshl_b32 s54, s51, 13
s_lshl_b32 s52, s30, 6
s_add_u32 s54, s54, s52
s_add_u32 s54, s54, 222306304
s_waitcnt vmcnt(0)
s_barrier
s_cmp_lg_u32 s3, 0
s_cbranch_scc1 k_s8_86
s_mov_b64 exec, 1
v_mov_b32 v8, 1
buffer_store_dword v8, off, s[4:7], s54 sc1
s_mov_b64 exec, -1
k_s8_86:
k_fend_36:
s_add_u32 s51, s51, 1
s_cmp_lt_u32 s51, 2
s_cbranch_scc1 k_lay_27
s_add_u32 s30, s30, 64
s_cmp_ge_u32 s30, 144
s_cbranch_scc1 k_fin_7
s_endpgm
k_o_4:
s_load_dwordx2 s[36:37], s[0:1], 0
s_mov_b32 s38, 2621440
s_mov_b32 s39, 0x20000
s_mul_i32 s57, s30, 52429
s_lshr_b32 s57, s57, 18
s_mul_i32 s52, s57, 5
s_sub_u32 s58, s30, s52
s_lshl_b32 s58, s58, 2
s_add_u32 s58, s58, s3
v_mov_b64 v[4:5], -1
v_mov_b64 v[6:7], -1
s_lshl_b32 s52, s30, 2
s_add_u32 s52, s52, s3
s_lshl_b32 s53, s52, 13
s_lshl_b32 s52, s52, 9
v_lshrrev_b32 v2, 1, v0
s_add_u32 s54, s52, 211812352
buffer_store_dwordx2 v[4:5], v2, s[4:7], s54 offen sc1
s_add_u32 s54, s53, 205520896
buffer_store_dwordx4 v[4:7], v0, s[4:7], s54 offen offset:0 sc1
buffer_store_dwordx4 v[4:7], v0, s[4:7], s54 offen offset:1024 sc1
buffer_store_dwordx4 v[4:7], v0, s[4:7], s54 offen offset:2048 sc1
buffer_store_dwordx4 v[4:7], v0, s[4:7], s54 offen offset:3072 sc1
s_add_u32 s54, s53, 205524992
buffer_store_dwordx4 v[4:7], v0, s[4:7], s54 offen offset:0 sc1
buffer_store_dwordx4 v[4:7], v0, s[4:7], s54 offen offset:1024 sc1
buffer_store_dwordx4 v[4:7], v0, s[4:7], s54 offen offset:2048 sc1
buffer_store_dwordx4 v[4:7], v0, s[4:7], s54 offen offset:3072 sc1
s_add_u32 s54, s52, 212860928
buffer_store_dwordx2 v[4:5], v2, s[4:7], s54 offen sc1
s_add_u32 s54, s53, 208666624
buffer_store_dwordx4 v[4:7], v0, s[4:7], s54 offen offset:0 sc1
buffer_store_dwordx4 v[4:7], v0, s[4:7], s54 offen offset:1024 sc1
buffer_store_dwordx4 v[4:7], v0, s[4:7], s54 offen offset:2048 sc1
buffer_store_dwordx4 v[4:7], v0, s[4:7], s54 offen offset:3072 sc1
s_add_u32 s54, s53, 208670720
buffer_store_dwordx4 v[4:7], v0, s[4:7], s54 offen offset:0 sc1
buffer_store_dwordx4 v[4:7], v0, s[4:7], s54 offen offset:1024 sc1
buffer_store_dwordx4 v[4:7], v0, s[4:7], s54 offen offset:2048 sc1
buffer_store_dwordx4 v[4:7], v0, s[4:7], s54 offen offset:3072 sc1
s_mul_i32 s52, s3, 640
v_lshrrev_b32 v8, 4, v0
v_add_u32 v8, s52, v8
s_mov_b32 s53, 52429
v_add_u32 v9, 0, v8
v_mul_u32_u24 v10, s53, v9
v_lshrrev_b32 v10, 22, v10
v_mul_u32_u24 v11, 80, v10
v_sub_u32 v9, v9, v11
v_and_b32 v11, 15, v10
v_xor_b32 v9, v9, v11
v_mul_u32_u24 v10, 1280, v10
v_lshl_add_u32 v72, v9, 4, v10
v_add_u32 v9, 64, v8
v_mul_u32_u24 v10, s53, v9
v_lshrrev_b32 v10, 22, v10
v_mul_u32_u24 v11, 80, v10
v_sub_u32 v9, v9, v11
v_and_b32 v11, 15, v10
v_xor_b32 v9, v9, v11
v_mul_u32_u24 v10, 1280, v10
v_lshl_add_u32 v73, v9, 4, v10
v_add_u32 v9, 128, v8
v_mul_u32_u24 v10, s53, v9
v_lshrrev_b32 v10, 22, v10
v_mul_u32_u24 v11, 80, v10
v_sub_u32 v9, v9, v11
v_and_b32 v11, 15, v10
v_xor_b32 v9, v9, v11
v_mul_u32_u24 v10, 1280, v10
v_lshl_add_u32 v74, v9, 4, v10
v_add_u32 v9, 192, v8
v_mul_u32_u24 v10, s53, v9
v_lshrrev_b32 v10, 22, v10
v_mul_u32_u24 v11, 80, v10
v_sub_u32 v9, v9, v11
v_and_b32 v11, 15, v10
v_xor_b32 v9, v9, v11
v_mul_u32_u24 v10, 1280, v10
v_lshl_add_u32 v75, v9, 4, v10
v_add_u32 v9, 256, v8
v_mul_u32_u24 v10, s53, v9
v_lshrrev_b32 v10, 22, v10
v_mul_u32_u24 v11, 80, v10
v_sub_u32 v9, v9, v11
v_and_b32 v11, 15, v10
v_xor_b32 v9, v9, v11
v_mul_u32_u24 v10, 1280, v10
v_lshl_add_u32 v76, v9, 4, v10
v_add_u32 v9, 320, v8
v_mul_u32_u24 v10, s53, v9
v_lshrrev_b32 v10, 22, v10
v_mul_u32_u24 v11, 80, v10
v_sub_u32 v9, v9, v11
v_and_b32 v11, 15, v10
v_xor_b32 v9, v9, v11
v_mul_u32_u24 v10, 1280, v10
v_lshl_add_u32 v77, v9, 4, v10
v_add_u32 v9, 384, v8
v_mul_u32_u24 v10, s53, v9
v_lshrrev_b32 v10, 22, v10
v_mul_u32_u24 v11, 80, v10
v_sub_u32 v9, v9, v11
v_and_b32 v11, 15, v10
v_xor_b32 v9, v9, v11
v_mul_u32_u24 v10, 1280, v10
v_lshl_add_u32 v78, v9, 4, v10
v_add_u32 v9, 448, v8
v_mul_u32_u24 v10, s53, v9
v_lshrrev_b32 v10, 22, v10
v_mul_u32_u24 v11, 80, v10
v_sub_u32 v9, v9, v11
v_and_b32 v11, 15, v10
v_xor_b32 v9, v9, v11
v_mul_u32_u24 v10, 1280, v10
v_lshl_add_u32 v79, v9, 4, v10
v_add_u32 v9, 512, v8
v_mul_u32_u24 v10, s53, v9
v_lshrrev_b32 v10, 22, v10
v_mul_u32_u24 v11, 80, v10
v_sub_u32 v9, v9, v11
v_and_b32 v11, 15, v10
v_xor_b32 v9, v9, v11
v_mul_u32_u24 v10, 1280, v10
v_lshl_add_u32 v80, v9, 4, v10
v_add_u32 v9, 576, v8
v_mul_u32_u24 v10, s53, v9
v_lshrrev_b32 v10, 22, v10
v_mul_u32_u24 v11, 80, v10
v_sub_u32 v9, v9, v11
v_and_b32 v11, 15, v10
v_xor_b32 v9, v9, v11
v_mul_u32_u24 v10, 1280, v10
v_lshl_add_u32 v81, v9, 4, v10
s_cmp_lg_u32 s3, 0
s_cbranch_scc1 k_wdd_88
v_mov_b32 v2, 128
k_wd_87:
global_load_dword v3, v2, s[28:29] sc1
s_waitcnt vmcnt(0)
v_readfirstlane_b32 s52, v3
s_cmp_ge_u32 s52, 32
s_cbranch_scc1 k_wdd_88
s_sleep 2
s_sub_u32 s32, s32, 1
s_cmp_gt_i32 s32, 0
s_cbranch_scc1 k_wd_87
k_wdd_88:
s_barrier
s_mul_i32 s53, s58, 40960
s_add_u32 s53, s53, 213909504
buffer_load_dwordx4 v[96:99], v0, s[4:7], s53 offen offset:0 sc1
buffer_load_dwordx4 v[100:103], v0, s[4:7], s53 offen offset:1024 sc1
buffer_load_dwordx4 v[104:107], v0, s[4:7], s53 offen offset:2048 sc1
buffer_load_dwordx4 v[108:111], v0, s[4:7], s53 offen offset:3072 sc1
s_add_u32 s53, s53, 4096
buffer_load_dwordx4 v[112:115], v0, s[4:7], s53 offen offset:0 sc1
buffer_load_dwordx4 v[116:119], v0, s[4:7], s53 offen offset:1024 sc1
buffer_load_dwordx4 v[120:123], v0, s[4:7], s53 offen offset:2048 sc1
buffer_load_dwordx4 v[124:127], v0, s[4:7], s53 offen offset:3072 sc1
s_add_u32 s53, s53, 4096
buffer_load_dwordx4 v[128:131], v0, s[4:7], s53 offen offset:0 sc1
buffer_load_dwordx4 v[132:135], v0, s[4:7], s53 offen offset:1024 sc1
buffer_load_dwordx4 v[136:139], v0, s[4:7], s53 offen offset:2048 sc1
buffer_load_dwordx4 v[140:143], v0, s[4:7], s53 offen offset:3072 sc1
s_add_u32 s53, s53, 4096
buffer_load_dwordx4 v[144:147], v0, s[4:7], s53 offen offset:0 sc1
buffer_load_dwordx4 v[148:151], v0, s[4:7], s53 offen offset:1024 sc1
buffer_load_dwordx4 v[152:155], v0, s[4:7], s53 offen offset:2048 sc1
buffer_load_dwordx4 v[156:159], v0, s[4:7], s53 offen offset:3072 sc1
s_add_u32 s53, s53, 4096
buffer_load_dwordx4 v[160:163], v0, s[4:7], s53 offen offset:0 sc1
buffer_load_dwordx4 v[164:167], v0, s[4:7], s53 offen offset:1024 sc1
buffer_load_dwordx4 v[168:171], v0, s[4:7], s53 offen offset:2048 sc1
buffer_load_dwordx4 v[172:175], v0, s[4:7], s53 offen offset:3072 sc1
s_add_u32 s53, s53, 4096
buffer_load_dwordx4 v[176:179], v0, s[4:7], s53 offen offset:0 sc1
buffer_load_dwordx4 v[180:183], v0, s[4:7], s53 offen offset:1024 sc1
buffer_load_dwordx4 v[184:187], v0, s[4:7], s53 offen offset:2048 sc1
buffer_load_dwordx4 v[188:191], v0, s[4:7], s53 offen offset:3072 sc1
s_add_u32 s53, s53, 4096
buffer_load_dwordx4 v[192:195], v0, s[4:7], s53 offen offset:0 sc1
buffer_load_dwordx4 v[196:199], v0, s[4:7], s53 offen offset:1024 sc1
buffer_load_dwordx4 v[200:203], v0, s[4:7], s53 offen offset:2048 sc1
buffer_load_dwordx4 v[204:207], v0, s[4:7], s53 offen offset:3072 sc1
s_add_u32 s53, s53, 4096
buffer_load_dwordx4 v[208:211], v0, s[4:7], s53 offen offset:0 sc1
buffer_load_dwordx4 v[212:215], v0, s[4:7], s53 offen offset:1024 sc1
buffer_load_dwordx4 v[216:219], v0, s[4:7], s53 offen offset:2048 sc1
buffer_load_dwordx4 v[220:223], v0, s[4:7], s53 offen offset:3072 sc1
s_add_u32 s53, s53, 4096
buffer_load_dwordx4 v[224:227], v0, s[4:7], s53 offen offset:0 sc1
buffer_load_dwordx4 v[228:231], v0, s[4:7], s53 offen offset:1024 sc1
buffer_load_dwordx4 v[232:235], v0, s[4:7], s53 offen offset:2048 sc1
buffer_load_dwordx4 v[236:239], v0, s[4:7], s53 offen offset:3072 sc1
s_add_u32 s53, s53, 4096
buffer_load_dwordx4 v[240:243], v0, s[4:7], s53 offen offset:0 sc1
buffer_load_dwordx4 v[244:247], v0, s[4:7], s53 offen offset:1024 sc1
buffer_load_dwordx4 v[248:251], v0, s[4:7], s53 offen offset:2048 sc1
buffer_load_dwordx4 v[252:255], v0, s[4:7], s53 offen offset:3072 sc1
s_mul_i32 s46, s57, 163840
s_lshl_b32 s48, s58, 11
s_add_u32 s48, s48, s46
s_add_u32 s48, s48, 195035136
s_mov_b32 s47, 0
s_waitcnt lgkmcnt(0)
s_mul_i32 s45, s3, 10240
s_mov_b32 s44, 0
v_bfe_u32 v8, v0, 4, 5
v_mul_u32_u24 v9, 1280, v8
v_and_b32 v8, 15, v8
v_lshrrev_b32 v10, 9, v0
v_xor_b32 v8, v8, v10
v_xor_b32 v10, 0, v8
v_lshl_add_u32 v64, v10, 4, v9
v_xor_b32 v10, 2, v8
v_lshl_add_u32 v65, v10, 4, v9
v_xor_b32 v10, 4, v8
v_lshl_add_u32 v66, v10, 4, v9
v_xor_b32 v10, 6, v8
v_lshl_add_u32 v67, v10, 4, v9
v_xor_b32 v10, 8, v8
v_lshl_add_u32 v68, v10, 4, v9
v_xor_b32 v10, 10, v8
v_lshl_add_u32 v69, v10, 4, v9
v_xor_b32 v10, 12, v8
v_lshl_add_u32 v70, v10, 4, v9
v_xor_b32 v10, 14, v8
v_lshl_add_u32 v71, v10, 4, v9
s_add_u32 m0, s45, 0
s_nop 0
buffer_load_dwordx4 v72, s[36:39], s46 offen lds
s_add_u32 m0, s45, 1024
s_nop 0
buffer_load_dwordx4 v73, s[36:39], s46 offen lds
s_add_u32 m0, s45, 2048
s_nop 0
buffer_load_dwordx4 v74, s[36:39], s46 offen lds
s_add_u32 m0, s45, 3072
s_nop 0
buffer_load_dwordx4 v75, s[36:39], s46 offen lds
s_add_u32 m0, s45, 4096
s_nop 0
buffer_load_dwordx4 v76, s[36:39], s46 offen lds
s_add_u32 m0, s45, 5120
s_nop 0
buffer_load_dwordx4 v77, s[36:39], s46 offen lds
s_add_u32 m0, s45, 6144
s_nop 0
buffer_load_dwordx4 v78, s[36:39], s46 offen lds
s_add_u32 m0, s45, 7168
s_nop 0
buffer_load_dwordx4 v79, s[36:39], s46 offen lds
s_add_u32 m0, s45, 8192
s_nop 0
buffer_load_dwordx4 v80, s[36:39], s46 offen lds
s_add_u32 m0, s45, 9216
s_nop 0
buffer_load_dwordx4 v81, s[36:39], s46 offen lds
s_add_u32 s45, s45, 40960
s_cmp_ge_u32 s45, 122880
s_cselect_b32 s55, 122880, 0
s_sub_u32 s45, s45, s55
s_add_u32 s47, s47, 1
s_cmp_lt_u32 s47, 4
s_cselect_b32 s55, 40960, 0
s_add_u32 s46, s46, s55
s_add_u32 m0, s45, 0
s_nop 0
buffer_load_dwordx4 v72, s[36:39], s46 offen lds
s_add_u32 m0, s45, 1024
s_nop 0
buffer_load_dwordx4 v73, s[36:39], s46 offen lds
s_add_u32 m0, s45, 2048
s_nop 0
buffer_load_dwordx4 v74, s[36:39], s46 offen lds
s_add_u32 m0, s45, 3072
s_nop 0
buffer_load_dwordx4 v75, s[36:39], s46 offen lds
s_add_u32 m0, s45, 4096
s_nop 0
buffer_load_dwordx4 v76, s[36:39], s46 offen lds
s_add_u32 m0, s45, 5120
s_nop 0
buffer_load_dwordx4 v77, s[36:39], s46 offen lds
s_add_u32 m0, s45, 6144
s_nop 0
buffer_load_dwordx4 v78, s[36:39], s46 offen lds
s_add_u32 m0, s45, 7168
s_nop 0
buffer_load_dwordx4 v79, s[36:39], s46 offen lds
s_add_u32 m0, s45, 8192
s_nop 0
buffer_load_dwordx4 v80, s[36:39], s46 offen lds
s_add_u32 m0, s45, 9216
s_nop 0
buffer_load_dwordx4 v81, s[36:39], s46 offen lds
s_add_u32 s45, s45, 40960
s_cmp_ge_u32 s45, 122880
s_cselect_b32 s55, 122880, 0
s_sub_u32 s45, s45, s55
s_add_u32 s47, s47, 1
s_cmp_lt_u32 s47, 4
s_cselect_b32 s55, 40960, 0
s_add_u32 s46, s46, s55
s_waitcnt vmcnt(10)
s_barrier
ds_read_b128 v[8:11], v64 offset:0
ds_read_b128 v[12:15], v65 offset:0
ds_read_b128 v[16:19], v66 offset:0
ds_read_b128 v[20:23], v67 offset:0
s_mov_b32 s59, 2
s_waitcnt lgkmcnt(3)
v_mfma_f32_32x32x16_bf16 v[32:47], v[96:99], v[8:11], 0
s_waitcnt lgkmcnt(2)
ds_read_b128 v[24:27], v68 offset:0
v_mfma_f32_32x32x16_bf16 v[32:47], v[100:103], v[12:15], v[32:47]
s_waitcnt lgkmcnt(2)
ds_read_b128 v[8:11], v69 offset:0
s_add_u32 m0, s45, 0
s_nop 0
buffer_load_dwordx4 v72, s[36:39], s46 offen lds
s_add_u32 m0, s45, 1024
s_nop 0
buffer_load_dwordx4 v73, s[36:39], s46 offen lds
v_mfma_f32_32x32x16_bf16 v[32:47], v[104:107], v[16:19], v[32:47]
s_waitcnt lgkmcnt(2)
ds_read_b128 v[12:15], v70 offset:0
s_add_u32 m0, s45, 2048
s_nop 0
buffer_load_dwordx4 v74, s[36:39], s46 offen lds
s_add_u32 m0, s45, 3072
s_nop 0
buffer_load_dwordx4 v75, s[36:39], s46 offen lds
v_mfma_f32_32x32x16_bf16 v[32:47], v[108:111], v[20:23], v[32:47]
s_waitcnt lgkmcnt(2)
ds_read_b128 v[16:19], v71 offset:0
s_add_u32 m0, s45, 4096
s_nop 0
buffer_load_dwordx4 v76, s[36:39], s46 offen lds
s_add_u32 m0, s45, 5120
s_nop 0
buffer_load_dwordx4 v77, s[36:39], s46 offen lds
v_mfma_f32_32x32x16_bf16 v[32:47], v[112:115], v[24:27], v[32:47]
s_waitcnt lgkmcnt(2)
ds_read_b128 v[20:23], v64 offset:256
s_add_u32 m0, s45, 6144
s_nop 0
buffer_load_dwordx4 v78, s[36:39], s46 offen lds
s_add_u32 m0, s45, 7168
s_nop 0
buffer_load_dwordx4 v79, s[36:39], s46 offen lds
v_mfma_f32_32x32x16_bf16 v[32:47], v[116:119], v[8:11], v[32:47]
s_waitcnt lgkmcnt(2)
ds_read_b128 v[24:27], v65 offset:256
s_add_u32 m0, s45, 8192
s_nop 0
buffer_load_dwordx4 v80, s[36:39], s46 offen lds
s_add_u32 m0, s45, 9216
s_nop 0
buffer_load_dwordx4 v81, s[36:39], s46 offen lds
v_mfma_f32_32x32x16_bf16 v[32:47], v[120:123], v[12:15], v[32:47]
s_waitcnt lgkmcnt(2)
ds_read_b128 v[8:11], v66 offset:256
s_add_u32 s45, s45, 40960
s_cmp_ge_u32 s45, 122880
s_cselect_b32 s55, 122880, 0
s_sub_u32 s45, s45, s55
s_add_u32 s47, s47, 1
s_cmp_lt_u32 s47, 4
s_cselect_b32 s55, 40960, 0
s_add_u32 s46, s46, s55
v_mfma_f32_32x32x16_bf16 v[32:47], v[124:127], v[16:19], v[32:47]
s_waitcnt lgkmcnt(2)
ds_read_b128 v[12:15], v67 offset:256
v_mfma_f32_32x32x16_bf16 v[32:47], v[128:131], v[20:23], v[32:47]
s_waitcnt lgkmcnt(2)
ds_read_b128 v[16:19], v68 offset:256
v_mfma_f32_32x32x16_bf16 v[32:47], v[132:135], v[24:27], v[32:47]
s_waitcnt lgkmcnt(2)
ds_read_b128 v[20:23], v69 offset:256
v_mfma_f32_32x32x16_bf16 v[32:47], v[136:139], v[8:11], v[32:47]
s_waitcnt lgkmcnt(2)
ds_read_b128 v[24:27], v70 offset:256
v_mfma_f32_32x32x16_bf16 v[32:47], v[140:143], v[12:15], v[32:47]
s_waitcnt lgkmcnt(2)
ds_read_b128 v[8:11], v71 offset:256
v_mfma_f32_32x32x16_bf16 v[32:47], v[144:147], v[16:19], v[32:47]
s_waitcnt lgkmcnt(2)
ds_read_b128 v[12:15], v64 offset:512
v_mfma_f32_32x32x16_bf16 v[32:47], v[148:151], v[20:23], v[32:47]
s_waitcnt lgkmcnt(2)
ds_read_b128 v[16:19], v65 offset:512
v_mfma_f32_32x32x16_bf16 v[32:47], v[152:155], v[24:27], v[32:47]
s_waitcnt lgkmcnt(2)
ds_read_b128 v[20:23], v66 offset:512
v_mfma_f32_32x32x16_bf16 v[32:47], v[156:159], v[8:11], v[32:47]
s_waitcnt lgkmcnt(2)
ds_read_b128 v[24:27], v67 offset:512
v_mfma_f32_32x32x16_bf16 v[32:47], v[160:163], v[12:15], v[32:47]
s_waitcnt lgkmcnt(2)
ds_read_b128 v[8:11], v68 offset:512
v_mfma_f32_32x32x16_bf16 v[32:47], v[164:167], v[16:19], v[32:47]
s_waitcnt lgkmcnt(2)
ds_read_b128 v[12:15], v69 offset:512
v_mfma_f32_32x32x16_bf16 v[32:47], v[168:171], v[20:23], v[32:47]
s_waitcnt lgkmcnt(2)
ds_read_b128 v[16:19], v70 offset:512
v_mfma_f32_32x32x16_bf16 v[32:47], v[172:175], v[24:27], v[32:47]
s_waitcnt lgkmcnt(2)
ds_read_b128 v[20:23], v71 offset:512
v_mfma_f32_32x32x16_bf16 v[32:47], v[176:179], v[8:11], v[32:47]
s_waitcnt lgkmcnt(2)
ds_read_b128 v[24:27], v64 offset:768
v_mfma_f32_32x32x16_bf16 v[32:47], v[180:183], v[12:15], v[32:47]
s_waitcnt lgkmcnt(2)
ds_read_b128 v[8:11], v65 offset:768
v_mfma_f32_32x32x16_bf16 v[32:47], v[184:187], v[16:19], v[32:47]
s_waitcnt lgkmcnt(2)
ds_read_b128 v[12:15], v66 offset:768
v_mfma_f32_32x32x16_bf16 v[32:47], v[188:191], v[20:23], v[32:47]
s_waitcnt lgkmcnt(2)
ds_read_b128 v[16:19], v67 offset:768
v_mfma_f32_32x32x16_bf16 v[32:47], v[192:195], v[24:27], v[32:47]
s_waitcnt lgkmcnt(2)
ds_read_b128 v[20:23], v68 offset:768
v_mfma_f32_32x32x16_bf16 v[32:47], v[196:199], v[8:11], v[32:47]
s_waitcnt lgkmcnt(2)
ds_read_b128 v[24:27], v69 offset:768
v_mfma_f32_32x32x16_bf16 v[32:47], v[200:203], v[12:15], v[32:47]
s_waitcnt lgkmcnt(2)
ds_read_b128 v[8:11], v70 offset:768
v_mfma_f32_32x32x16_bf16 v[32:47], v[204:207], v[16:19], v[32:47]
s_waitcnt lgkmcnt(2)
ds_read_b128 v[12:15], v71 offset:768
v_mfma_f32_32x32x16_bf16 v[32:47], v[208:211], v[20:23], v[32:47]
s_waitcnt lgkmcnt(2)
ds_read_b128 v[16:19], v64 offset:1024
v_mfma_f32_32x32x16_bf16 v[32:47], v[212:215], v[24:27], v[32:47]
s_waitcnt lgkmcnt(2)
ds_read_b128 v[20:23], v65 offset:1024
v_mfma_f32_32x32x16_bf16 v[32:47], v[216:219], v[8:11], v[32:47]
s_waitcnt lgkmcnt(2)
ds_read_b128 v[24:27], v66 offset:1024
v_mfma_f32_32x32x16_bf16 v[32:47], v[220:223], v[12:15], v[32:47]
s_waitcnt lgkmcnt(2)
ds_read_b128 v[8:11], v67 offset:1024
v_mfma_f32_32x32x16_bf16 v[32:47], v[224:227], v[16:19], v[32:47]
s_waitcnt lgkmcnt(2)
ds_read_b128 v[12:15], v68 offset:1024
v_mfma_f32_32x32x16_bf16 v[32:47], v[228:231], v[20:23], v[32:47]
s_waitcnt lgkmcnt(2)
ds_read_b128 v[16:19], v69 offset:1024
v_mfma_f32_32x32x16_bf16 v[32:47], v[232:235], v[24:27], v[32:47]
s_waitcnt lgkmcnt(2)
ds_read_b128 v[20:23], v70 offset:1024
v_mfma_f32_32x32x16_bf16 v[32:47], v[236:239], v[8:11], v[32:47]
s_waitcnt lgkmcnt(2)
ds_read_b128 v[24:27], v71 offset:1024
v_mfma_f32_32x32x16_bf16 v[32:47], v[240:243], v[12:15], v[32:47]
s_add_u32 s44, s44, 1
s_cmp_eq_u32 s44, 3
s_mov_b32 s56, 40960
s_cmov_b32 s56, -81920
s_cselect_b32 s44, 0, s44
v_add_u32 v64, s56, v64
v_add_u32 v65, s56, v65
v_add_u32 v66, s56, v66
v_add_u32 v67, s56, v67
v_add_u32 v68, s56, v68
v_add_u32 v69, s56, v69
v_add_u32 v70, s56, v70
v_add_u32 v71, s56, v71
s_waitcnt vmcnt(10) lgkmcnt(2)
s_barrier
ds_read_b128 v[8:11], v64 offset:0
v_mfma_f32_32x32x16_bf16 v[32:47], v[244:247], v[16:19], v[32:47]
s_waitcnt lgkmcnt(2)
ds_read_b128 v[12:15], v65 offset:0
v_mfma_f32_32x32x16_bf16 v[32:47], v[248:251], v[20:23], v[32:47]
s_waitcnt lgkmcnt(2)
ds_read_b128 v[16:19], v66 offset:0
v_mfma_f32_32x32x16_bf16 v[32:47], v[252:255], v[24:27], v[32:47]
s_waitcnt lgkmcnt(2)
ds_read_b128 v[20:23], v67 offset:0
k_st_89:
v_mfma_f32_32x32x16_bf16 v[48:63], v[96:99], v[8:11], 0
s_waitcnt lgkmcnt(2)
ds_read_b128 v[24:27], v68 offset:0
v_mfma_f32_32x32x16_bf16 v[48:63], v[100:103], v[12:15], v[48:63]
s_waitcnt lgkmcnt(2)
ds_read_b128 v[8:11], v69 offset:0
v_cvt_pk_bf16_f32 v32, v32, v33
v_cvt_pk_bf16_f32 v33, v34, v35
v_mfma_f32_32x32x16_bf16 v[48:63], v[104:107], v[16:19], v[48:63]
s_waitcnt lgkmcnt(2)
ds_read_b128 v[12:15], v70 offset:0
v_cvt_pk_bf16_f32 v34, v36, v37
v_cvt_pk_bf16_f32 v35, v38, v39
v_mfma_f32_32x32x16_bf16 v[48:63], v[108:111], v[20:23], v[48:63]
s_waitcnt lgkmcnt(2)
ds_read_b128 v[16:19], v71 offset:0
v_cvt_pk_bf16_f32 v36, v40, v41
v_cvt_pk_bf16_f32 v37, v42, v43
v_mfma_f32_32x32x16_bf16 v[48:63], v[112:115], v[24:27], v[48:63]
s_waitcnt lgkmcnt(2)
ds_read_b128 v[20:23], v64 offset:256
v_cvt_pk_bf16_f32 v38, v44, v45
v_cvt_pk_bf16_f32 v39, v46, v47
v_mfma_f32_32x32x16_bf16 v[48:63], v[116:119], v[8:11], v[48:63]
s_waitcnt lgkmcnt(2)
ds_read_b128 v[24:27], v65 offset:256
buffer_store_dwordx4 v[32:35], v0, s[4:7], s48 offen offset:0 sc1
buffer_store_dwordx4 v[36:39], v0, s[4:7], s48 offen offset:1024 sc1
v_mfma_f32_32x32x16_bf16 v[48:63], v[120:123], v[12:15], v[48:63]
s_waitcnt lgkmcnt(2)
ds_read_b128 v[8:11], v66 offset:256
s_add_u32 s48, s48, 40960
s_add_u32 m0, s45, 0
s_nop 0
buffer_load_dwordx4 v72, s[36:39], s46 offen lds
v_mfma_f32_32x32x16_bf16 v[48:63], v[124:127], v[16:19], v[48:63]
s_waitcnt lgkmcnt(2)
ds_read_b128 v[12:15], v67 offset:256
s_add_u32 m0, s45, 1024
s_nop 0
buffer_load_dwordx4 v73, s[36:39], s46 offen lds
s_add_u32 m0, s45, 2048
s_nop 0
buffer_load_dwordx4 v74, s[36:39], s46 offen lds
v_mfma_f32_32x32x16_bf16 v[48:63], v[128:131], v[20:23], v[48:63]
s_waitcnt lgkmcnt(2)
ds_read_b128 v[16:19], v68 offset:256
s_add_u32 m0, s45, 3072
s_nop 0
buffer_load_dwordx4 v75, s[36:39], s46 offen lds
s_add_u32 m0, s45, 4096
s_nop 0
buffer_load_dwordx4 v76, s[36:39], s46 offen lds
v_mfma_f32_32x32x16_bf16 v[48:63], v[132:135], v[24:27], v[48:63]
s_waitcnt lgkmcnt(2)
ds_read_b128 v[20:23], v69 offset:256
s_add_u32 m0, s45, 5120
s_nop 0
buffer_load_dwordx4 v77, s[36:39], s46 offen lds
s_add_u32 m0, s45, 6144
s_nop 0
buffer_load_dwordx4 v78, s[36:39], s46 offen lds
v_mfma_f32_32x32x16_bf16 v[48:63], v[136:139], v[8:11], v[48:63]
s_waitcnt lgkmcnt(2)
ds_read_b128 v[24:27], v70 offset:256
s_add_u32 m0, s45, 7168
s_nop 0
buffer_load_dwordx4 v79, s[36:39], s46 offen lds
s_add_u32 m0, s45, 8192
s_nop 0
buffer_load_dwordx4 v80, s[36:39], s46 offen lds
v_mfma_f32_32x32x16_bf16 v[48:63], v[140:143], v[12:15], v[48:63]
s_waitcnt lgkmcnt(2)
ds_read_b128 v[8:11], v71 offset:256
s_add_u32 m0, s45, 9216
s_nop 0
buffer_load_dwordx4 v81, s[36:39], s46 offen lds
s_add_u32 s45, s45, 40960
s_cmp_ge_u32 s45, 122880
s_cselect_b32 s55, 122880, 0
s_sub_u32 s45, s45, s55
v_mfma_f32_32x32x16_bf16 v[48:63], v[144:147], v[16:19], v[48:63]
s_waitcnt lgkmcnt(2)
ds_read_b128 v[12:15], v64 offset:512
s_add_u32 s47, s47, 1
s_cmp_lt_u32 s47, 4
s_cselect_b32 s55, 40960, 0
s_add_u32 s46, s46, s55
v_mfma_f32_32x32x16_bf16 v[48:63], v[148:151], v[20:23], v[48:63]
s_waitcnt lgkmcnt(2)
ds_read_b128 v[16:19], v65 offset:512
v_mfma_f32_32x32x16_bf16 v[48:63], v[152:155], v[24:27], v[48:63]
s_waitcnt lgkmcnt(2)
ds_read_b128 v[20:23], v66 offset:512
v_mfma_f32_32x32x16_bf16 v[48:63], v[156:159], v[8:11], v[48:63]
s_waitcnt lgkmcnt(2)
ds_read_b128 v[24:27], v67 offset:512
v_mfma_f32_32x32x16_bf16 v[48:63], v[160:163], v[12:15], v[48:63]
s_waitcnt lgkmcnt(2)
ds_read_b128 v[8:11], v68 offset:512
v_mfma_f32_32x32x16_bf16 v[48:63], v[164:167], v[16:19], v[48:63]
s_waitcnt lgkmcnt(2)
ds_read_b128 v[12:15], v69 offset:512
v_mfma_f32_32x32x16_bf16 v[48:63], v[168:171], v[20:23], v[48:63]
s_waitcnt lgkmcnt(2)
ds_read_b128 v[16:19], v70 offset:512
v_mfma_f32_32x32x16_bf16 v[48:63], v[172:175], v[24:27], v[48:63]
s_waitcnt lgkmcnt(2)
ds_read_b128 v[20:23], v71 offset:512
v_mfma_f32_32x32x16_bf16 v[48:63], v[176:179], v[8:11], v[48:63]
s_waitcnt lgkmcnt(2)
ds_read_b128 v[24:27], v64 offset:768
v_mfma_f32_32x32x16_bf16 v[48:63], v[180:183], v[12:15], v[48:63]
s_waitcnt lgkmcnt(2)
ds_read_b128 v[8:11], v65 offset:768
v_mfma_f32_32x32x16_bf16 v[48:63], v[184:187], v[16:19], v[48:63]
s_waitcnt lgkmcnt(2)
ds_read_b128 v[12:15], v66 offset:768
v_mfma_f32_32x32x16_bf16 v[48:63], v[188:191], v[20:23], v[48:63]
s_waitcnt lgkmcnt(2)
ds_read_b128 v[16:19], v67 offset:768
v_mfma_f32_32x32x16_bf16 v[48:63], v[192:195], v[24:27], v[48:63]
s_waitcnt lgkmcnt(2)
ds_read_b128 v[20:23], v68 offset:768
v_mfma_f32_32x32x16_bf16 v[48:63], v[196:199], v[8:11], v[48:63]
s_waitcnt lgkmcnt(2)
ds_read_b128 v[24:27], v69 offset:768
v_mfma_f32_32x32x16_bf16 v[48:63], v[200:203], v[12:15], v[48:63]
s_waitcnt lgkmcnt(2)
ds_read_b128 v[8:11], v70 offset:768
v_mfma_f32_32x32x16_bf16 v[48:63], v[204:207], v[16:19], v[48:63]
s_waitcnt lgkmcnt(2)
ds_read_b128 v[12:15], v71 offset:768
v_mfma_f32_32x32x16_bf16 v[48:63], v[208:211], v[20:23], v[48:63]
s_waitcnt lgkmcnt(2)
ds_read_b128 v[16:19], v64 offset:1024
v_mfma_f32_32x32x16_bf16 v[48:63], v[212:215], v[24:27], v[48:63]
s_waitcnt lgkmcnt(2)
ds_read_b128 v[20:23], v65 offset:1024
v_mfma_f32_32x32x16_bf16 v[48:63], v[216:219], v[8:11], v[48:63]
s_waitcnt lgkmcnt(2)
ds_read_b128 v[24:27], v66 offset:1024
v_mfma_f32_32x32x16_bf16 v[48:63], v[220:223], v[12:15], v[48:63]
s_waitcnt lgkmcnt(2)
ds_read_b128 v[8:11], v67 offset:1024
v_mfma_f32_32x32x16_bf16 v[48:63], v[224:227], v[16:19], v[48:63]
s_waitcnt lgkmcnt(2)
ds_read_b128 v[12:15], v68 offset:1024
v_mfma_f32_32x32x16_bf16 v[48:63], v[228:231], v[20:23], v[48:63]
s_waitcnt lgkmcnt(2)
ds_read_b128 v[16:19], v69 offset:1024
v_mfma_f32_32x32x16_bf16 v[48:63], v[232:235], v[24:27], v[48:63]
s_waitcnt lgkmcnt(2)
ds_read_b128 v[20:23], v70 offset:1024
v_mfma_f32_32x32x16_bf16 v[48:63], v[236:239], v[8:11], v[48:63]
s_waitcnt lgkmcnt(2)
ds_read_b128 v[24:27], v71 offset:1024
v_mfma_f32_32x32x16_bf16 v[48:63], v[240:243], v[12:15], v[48:63]
s_add_u32 s44, s44, 1
s_cmp_eq_u32 s44, 3
s_mov_b32 s56, 40960
s_cmov_b32 s56, -81920
s_cselect_b32 s44, 0, s44
v_add_u32 v64, s56, v64
v_add_u32 v65, s56, v65
v_add_u32 v66, s56, v66
v_add_u32 v67, s56, v67
v_add_u32 v68, s56, v68
v_add_u32 v69, s56, v69
v_add_u32 v70, s56, v70
v_add_u32 v71, s56, v71
s_waitcnt vmcnt(10) lgkmcnt(2)
s_barrier
ds_read_b128 v[8:11], v64 offset:0
v_mfma_f32_32x32x16_bf16 v[48:63], v[244:247], v[16:19], v[48:63]
s_waitcnt lgkmcnt(2)
ds_read_b128 v[12:15], v65 offset:0
v_mfma_f32_32x32x16_bf16 v[48:63], v[248:251], v[20:23], v[48:63]
s_waitcnt lgkmcnt(2)
ds_read_b128 v[16:19], v66 offset:0
v_mfma_f32_32x32x16_bf16 v[48:63], v[252:255], v[24:27], v[48:63]
s_waitcnt lgkmcnt(2)
ds_read_b128 v[20:23], v67 offset:0
s_sub_u32 s59, s59, 1
s_cmp_eq_u32 s59, 0
s_cbranch_scc1 k_so_90
v_mfma_f32_32x32x16_bf16 v[32:47], v[96:99], v[8:11], 0
s_waitcnt lgkmcnt(2)
ds_read_b128 v[24:27], v68 offset:0
v_mfma_f32_32x32x16_bf16 v[32:47], v[100:103], v[12:15], v[32:47]
s_waitcnt lgkmcnt(2)
ds_read_b128 v[8:11], v69 offset:0
v_cvt_pk_bf16_f32 v48, v48, v49
v_cvt_pk_bf16_f32 v49, v50, v51
v_mfma_f32_32x32x16_bf16 v[32:47], v[104:107], v[16:19], v[32:47]
s_waitcnt lgkmcnt(2)
ds_read_b128 v[12:15], v70 offset:0
v_cvt_pk_bf16_f32 v50, v52, v53
v_cvt_pk_bf16_f32 v51, v54, v55
v_mfma_f32_32x32x16_bf16 v[32:47], v[108:111], v[20:23], v[32:47]
s_waitcnt lgkmcnt(2)
ds_read_b128 v[16:19], v71 offset:0
v_cvt_pk_bf16_f32 v52, v56, v57
v_cvt_pk_bf16_f32 v53, v58, v59
v_mfma_f32_32x32x16_bf16 v[32:47], v[112:115], v[24:27], v[32:47]
s_waitcnt lgkmcnt(2)
ds_read_b128 v[20:23], v64 offset:256
v_cvt_pk_bf16_f32 v54, v60, v61
v_cvt_pk_bf16_f32 v55, v62, v63
v_mfma_f32_32x32x16_bf16 v[32:47], v[116:119], v[8:11], v[32:47]
s_waitcnt lgkmcnt(2)
ds_read_b128 v[24:27], v65 offset:256
buffer_store_dwordx4 v[48:51], v0, s[4:7], s48 offen offset:0 sc1
buffer_store_dwordx4 v[52:55], v0, s[4:7], s48 offen offset:1024 sc1
v_mfma_f32_32x32x16_bf16 v[32:47], v[120:123], v[12:15], v[32:47]
s_waitcnt lgkmcnt(2)
ds_read_b128 v[8:11], v66 offset:256
s_add_u32 s48, s48, 40960
s_add_u32 m0, s45, 0
s_nop 0
buffer_load_dwordx4 v72, s[36:39], s46 offen lds
v_mfma_f32_32x32x16_bf16 v[32:47], v[124:127], v[16:19], v[32:47]
s_waitcnt lgkmcnt(2)
ds_read_b128 v[12:15], v67 offset:256
s_add_u32 m0, s45, 1024
s_nop 0
buffer_load_dwordx4 v73, s[36:39], s46 offen lds
s_add_u32 m0, s45, 2048
s_nop 0
buffer_load_dwordx4 v74, s[36:39], s46 offen lds
v_mfma_f32_32x32x16_bf16 v[32:47], v[128:131], v[20:23], v[32:47]
s_waitcnt lgkmcnt(2)
ds_read_b128 v[16:19], v68 offset:256
s_add_u32 m0, s45, 3072
s_nop 0
buffer_load_dwordx4 v75, s[36:39], s46 offen lds
s_add_u32 m0, s45, 4096
s_nop 0
buffer_load_dwordx4 v76, s[36:39], s46 offen lds
v_mfma_f32_32x32x16_bf16 v[32:47], v[132:135], v[24:27], v[32:47]
s_waitcnt lgkmcnt(2)
ds_read_b128 v[20:23], v69 offset:256
s_add_u32 m0, s45, 5120
s_nop 0
buffer_load_dwordx4 v77, s[36:39], s46 offen lds
s_add_u32 m0, s45, 6144
s_nop 0
buffer_load_dwordx4 v78, s[36:39], s46 offen lds
v_mfma_f32_32x32x16_bf16 v[32:47], v[136:139], v[8:11], v[32:47]
s_waitcnt lgkmcnt(2)
ds_read_b128 v[24:27], v70 offset:256
s_add_u32 m0, s45, 7168
s_nop 0
buffer_load_dwordx4 v79, s[36:39], s46 offen lds
s_add_u32 m0, s45, 8192
s_nop 0
buffer_load_dwordx4 v80, s[36:39], s46 offen lds
v_mfma_f32_32x32x16_bf16 v[32:47], v[140:143], v[12:15], v[32:47]
s_waitcnt lgkmcnt(2)
ds_read_b128 v[8:11], v71 offset:256
s_add_u32 m0, s45, 9216
s_nop 0
buffer_load_dwordx4 v81, s[36:39], s46 offen lds
s_add_u32 s45, s45, 40960
s_cmp_ge_u32 s45, 122880
s_cselect_b32 s55, 122880, 0
s_sub_u32 s45, s45, s55
v_mfma_f32_32x32x16_bf16 v[32:47], v[144:147], v[16:19], v[32:47]
s_waitcnt lgkmcnt(2)
ds_read_b128 v[12:15], v64 offset:512
s_add_u32 s47, s47, 1
s_cmp_lt_u32 s47, 4
s_cselect_b32 s55, 40960, 0
s_add_u32 s46, s46, s55
v_mfma_f32_32x32x16_bf16 v[32:47], v[148:151], v[20:23], v[32:47]
s_waitcnt lgkmcnt(2)
ds_read_b128 v[16:19], v65 offset:512
v_mfma_f32_32x32x16_bf16 v[32:47], v[152:155], v[24:27], v[32:47]
s_waitcnt lgkmcnt(2)
ds_read_b128 v[20:23], v66 offset:512
v_mfma_f32_32x32x16_bf16 v[32:47], v[156:159], v[8:11], v[32:47]
s_waitcnt lgkmcnt(2)
ds_read_b128 v[24:27], v67 offset:512
v_mfma_f32_32x32x16_bf16 v[32:47], v[160:163], v[12:15], v[32:47]
s_waitcnt lgkmcnt(2)
ds_read_b128 v[8:11], v68 offset:512
v_mfma_f32_32x32x16_bf16 v[32:47], v[164:167], v[16:19], v[32:47]
s_waitcnt lgkmcnt(2)
ds_read_b128 v[12:15], v69 offset:512
v_mfma_f32_32x32x16_bf16 v[32:47], v[168:171], v[20:23], v[32:47]
s_waitcnt lgkmcnt(2)
ds_read_b128 v[16:19], v70 offset:512
v_mfma_f32_32x32x16_bf16 v[32:47], v[172:175], v[24:27], v[32:47]
s_waitcnt lgkmcnt(2)
ds_read_b128 v[20:23], v71 offset:512
v_mfma_f32_32x32x16_bf16 v[32:47], v[176:179], v[8:11], v[32:47]
s_waitcnt lgkmcnt(2)
ds_read_b128 v[24:27], v64 offset:768
v_mfma_f32_32x32x16_bf16 v[32:47], v[180:183], v[12:15], v[32:47]
s_waitcnt lgkmcnt(2)
ds_read_b128 v[8:11], v65 offset:768
v_mfma_f32_32x32x16_bf16 v[32:47], v[184:187], v[16:19], v[32:47]
s_waitcnt lgkmcnt(2)
ds_read_b128 v[12:15], v66 offset:768
v_mfma_f32_32x32x16_bf16 v[32:47], v[188:191], v[20:23], v[32:47]
s_waitcnt lgkmcnt(2)
ds_read_b128 v[16:19], v67 offset:768
v_mfma_f32_32x32x16_bf16 v[32:47], v[192:195], v[24:27], v[32:47]
s_waitcnt lgkmcnt(2)
ds_read_b128 v[20:23], v68 offset:768
v_mfma_f32_32x32x16_bf16 v[32:47], v[196:199], v[8:11], v[32:47]
s_waitcnt lgkmcnt(2)
ds_read_b128 v[24:27], v69 offset:768
v_mfma_f32_32x32x16_bf16 v[32:47], v[200:203], v[12:15], v[32:47]
s_waitcnt lgkmcnt(2)
ds_read_b128 v[8:11], v70 offset:768
v_mfma_f32_32x32x16_bf16 v[32:47], v[204:207], v[16:19], v[32:47]
s_waitcnt lgkmcnt(2)
ds_read_b128 v[12:15], v71 offset:768
v_mfma_f32_32x32x16_bf16 v[32:47], v[208:211], v[20:23], v[32:47]
s_waitcnt lgkmcnt(2)
ds_read_b128 v[16:19], v64 offset:1024
v_mfma_f32_32x32x16_bf16 v[32:47], v[212:215], v[24:27], v[32:47]
s_waitcnt lgkmcnt(2)
ds_read_b128 v[20:23], v65 offset:1024
v_mfma_f32_32x32x16_bf16 v[32:47], v[216:219], v[8:11], v[32:47]
s_waitcnt lgkmcnt(2)
ds_read_b128 v[24:27], v66 offset:1024
v_mfma_f32_32x32x16_bf16 v[32:47], v[220:223], v[12:15], v[32:47]
s_waitcnt lgkmcnt(2)
ds_read_b128 v[8:11], v67 offset:1024
v_mfma_f32_32x32x16_bf16 v[32:47], v[224:227], v[16:19], v[32:47]
s_waitcnt lgkmcnt(2)
ds_read_b128 v[12:15], v68 offset:1024
v_mfma_f32_32x32x16_bf16 v[32:47], v[228:231], v[20:23], v[32:47]
s_waitcnt lgkmcnt(2)
ds_read_b128 v[16:19], v69 offset:1024
v_mfma_f32_32x32x16_bf16 v[32:47], v[232:235], v[24:27], v[32:47]
s_waitcnt lgkmcnt(2)
ds_read_b128 v[20:23], v70 offset:1024
v_mfma_f32_32x32x16_bf16 v[32:47], v[236:239], v[8:11], v[32:47]
s_waitcnt lgkmcnt(2)
ds_read_b128 v[24:27], v71 offset:1024
v_mfma_f32_32x32x16_bf16 v[32:47], v[240:243], v[12:15], v[32:47]
s_add_u32 s44, s44, 1
s_cmp_eq_u32 s44, 3
s_mov_b32 s56, 40960
s_cmov_b32 s56, -81920
s_cselect_b32 s44, 0, s44
v_add_u32 v64, s56, v64
v_add_u32 v65, s56, v65
v_add_u32 v66, s56, v66
v_add_u32 v67, s56, v67
v_add_u32 v68, s56, v68
v_add_u32 v69, s56, v69
v_add_u32 v70, s56, v70
v_add_u32 v71, s56, v71
s_waitcnt vmcnt(10) lgkmcnt(2)
s_barrier
ds_read_b128 v[8:11], v64 offset:0
v_mfma_f32_32x32x16_bf16 v[32:47], v[244:247], v[16:19], v[32:47]
s_waitcnt lgkmcnt(2)
ds_read_b128 v[12:15], v65 offset:0
v_mfma_f32_32x32x16_bf16 v[32:47], v[248:251], v[20:23], v[32:47]
s_waitcnt lgkmcnt(2)
ds_read_b128 v[16:19], v66 offset:0
v_mfma_f32_32x32x16_bf16 v[32:47], v[252:255], v[24:27], v[32:47]
s_waitcnt lgkmcnt(2)
ds_read_b128 v[20:23], v67 offset:0
s_branch k_st_89
k_so_90:
s_nop 6
v_cvt_pk_bf16_f32 v48, v48, v49
v_cvt_pk_bf16_f32 v49, v50, v51
v_cvt_pk_bf16_f32 v50, v52, v53
v_cvt_pk_bf16_f32 v51, v54, v55
v_cvt_pk_bf16_f32 v52, v56, v57
v_cvt_pk_bf16_f32 v53, v58, v59
v_cvt_pk_bf16_f32 v54, v60, v61
v_cvt_pk_bf16_f32 v55, v62, v63
buffer_store_dwordx4 v[48:51], v0, s[4:7], s48 offen offset:0 sc1
buffer_store_dwordx4 v[52:55], v0, s[4:7], s48 offen offset:1024 sc1
s_add_u32 s48, s48, 40960
s_lshl_b32 s54, s30, 6
s_add_u32 s54, s54, 222298112
s_waitcnt lgkmcnt(0)
s_waitcnt vmcnt(0)
s_barrier
s_cmp_lg_u32 s3, 0
s_cbranch_scc1 k_s8_91
s_mov_b64 exec, 1
v_mov_b32 v2, 1
buffer_store_dword v2, off, s[4:7], s54 sc1
s_mov_b64 exec, -1
k_s8_91:
s_mul_i32 s52, s3, 640
v_lshrrev_b32 v8, 4, v0
v_add_u32 v8, s52, v8
s_mov_b32 s53, 52429
v_add_u32 v9, 0, v8
v_mul_u32_u24 v10, s53, v9
v_lshrrev_b32 v10, 22, v10
v_mul_u32_u24 v11, 80, v10
v_sub_u32 v9, v9, v11
v_and_b32 v11, 15, v10
v_xor_b32 v9, v9, v11
v_and_b32 v11, 1, v10
v_bfe_u32 v12, v10, 1, 1
v_lshl_add_u32 v11, v12, 4, v11
v_bfe_u32 v12, v10, 2, 1
v_lshl_add_u32 v11, v12, 6, v11
v_bfe_u32 v12, v10, 3, 1
v_lshl_add_u32 v11, v12, 1, v11
v_bfe_u32 v12, v10, 4, 1
v_lshl_add_u32 v10, v12, 3, v11
v_mul_u32_u24 v10, 1280, v10
v_lshl_add_u32 v72, v9, 4, v10
v_add_u32 v9, 64, v8
v_mul_u32_u24 v10, s53, v9
v_lshrrev_b32 v10, 22, v10
v_mul_u32_u24 v11, 80, v10
v_sub_u32 v9, v9, v11
v_and_b32 v11, 15, v10
v_xor_b32 v9, v9, v11
v_and_b32 v11, 1, v10
v_bfe_u32 v12, v10, 1, 1
v_lshl_add_u32 v11, v12, 4, v11
v_bfe_u32 v12, v10, 2, 1
v_lshl_add_u32 v11, v12, 6, v11
v_bfe_u32 v12, v10, 3, 1
v_lshl_add_u32 v11, v12, 1, v11
v_bfe_u32 v12, v10, 4, 1
v_lshl_add_u32 v10, v12, 3, v11
v_mul_u32_u24 v10, 1280, v10
v_lshl_add_u32 v73, v9, 4, v10
v_add_u32 v9, 128, v8
v_mul_u32_u24 v10, s53, v9
v_lshrrev_b32 v10, 22, v10
v_mul_u32_u24 v11, 80, v10
v_sub_u32 v9, v9, v11
v_and_b32 v11, 15, v10
v_xor_b32 v9, v9, v11
v_and_b32 v11, 1, v10
v_bfe_u32 v12, v10, 1, 1
v_lshl_add_u32 v11, v12, 4, v11
v_bfe_u32 v12, v10, 2, 1
v_lshl_add_u32 v11, v12, 6, v11
v_bfe_u32 v12, v10, 3, 1
v_lshl_add_u32 v11, v12, 1, v11
v_bfe_u32 v12, v10, 4, 1
v_lshl_add_u32 v10, v12, 3, v11
v_mul_u32_u24 v10, 1280, v10
v_lshl_add_u32 v74, v9, 4, v10
v_add_u32 v9, 192, v8
v_mul_u32_u24 v10, s53, v9
v_lshrrev_b32 v10, 22, v10
v_mul_u32_u24 v11, 80, v10
v_sub_u32 v9, v9, v11
v_and_b32 v11, 15, v10
v_xor_b32 v9, v9, v11
v_and_b32 v11, 1, v10
v_bfe_u32 v12, v10, 1, 1
v_lshl_add_u32 v11, v12, 4, v11
v_bfe_u32 v12, v10, 2, 1
v_lshl_add_u32 v11, v12, 6, v11
v_bfe_u32 v12, v10, 3, 1
v_lshl_add_u32 v11, v12, 1, v11
v_bfe_u32 v12, v10, 4, 1
v_lshl_add_u32 v10, v12, 3, v11
v_mul_u32_u24 v10, 1280, v10
v_lshl_add_u32 v75, v9, 4, v10
v_add_u32 v9, 256, v8
v_mul_u32_u24 v10, s53, v9
v_lshrrev_b32 v10, 22, v10
v_mul_u32_u24 v11, 80, v10
v_sub_u32 v9, v9, v11
v_and_b32 v11, 15, v10
v_xor_b32 v9, v9, v11
v_and_b32 v11, 1, v10
v_bfe_u32 v12, v10, 1, 1
v_lshl_add_u32 v11, v12, 4, v11
v_bfe_u32 v12, v10, 2, 1
v_lshl_add_u32 v11, v12, 6, v11
v_bfe_u32 v12, v10, 3, 1
v_lshl_add_u32 v11, v12, 1, v11
v_bfe_u32 v12, v10, 4, 1
v_lshl_add_u32 v10, v12, 3, v11
v_mul_u32_u24 v10, 1280, v10
v_lshl_add_u32 v76, v9, 4, v10
v_add_u32 v9, 320, v8
v_mul_u32_u24 v10, s53, v9
v_lshrrev_b32 v10, 22, v10
v_mul_u32_u24 v11, 80, v10
v_sub_u32 v9, v9, v11
v_and_b32 v11, 15, v10
v_xor_b32 v9, v9, v11
v_and_b32 v11, 1, v10
v_bfe_u32 v12, v10, 1, 1
v_lshl_add_u32 v11, v12, 4, v11
v_bfe_u32 v12, v10, 2, 1
v_lshl_add_u32 v11, v12, 6, v11
v_bfe_u32 v12, v10, 3, 1
v_lshl_add_u32 v11, v12, 1, v11
v_bfe_u32 v12, v10, 4, 1
v_lshl_add_u32 v10, v12, 3, v11
v_mul_u32_u24 v10, 1280, v10
v_lshl_add_u32 v77, v9, 4, v10
v_add_u32 v9, 384, v8
v_mul_u32_u24 v10, s53, v9
v_lshrrev_b32 v10, 22, v10
v_mul_u32_u24 v11, 80, v10
v_sub_u32 v9, v9, v11
v_and_b32 v11, 15, v10
v_xor_b32 v9, v9, v11
v_and_b32 v11, 1, v10
v_bfe_u32 v12, v10, 1, 1
v_lshl_add_u32 v11, v12, 4, v11
v_bfe_u32 v12, v10, 2, 1
v_lshl_add_u32 v11, v12, 6, v11
v_bfe_u32 v12, v10, 3, 1
v_lshl_add_u32 v11, v12, 1, v11
v_bfe_u32 v12, v10, 4, 1
v_lshl_add_u32 v10, v12, 3, v11
v_mul_u32_u24 v10, 1280, v10
v_lshl_add_u32 v78, v9, 4, v10
v_add_u32 v9, 448, v8
v_mul_u32_u24 v10, s53, v9
v_lshrrev_b32 v10, 22, v10
v_mul_u32_u24 v11, 80, v10
v_sub_u32 v9, v9, v11
v_and_b32 v11, 15, v10
v_xor_b32 v9, v9, v11
v_and_b32 v11, 1, v10
v_bfe_u32 v12, v10, 1, 1
v_lshl_add_u32 v11, v12, 4, v11
v_bfe_u32 v12, v10, 2, 1
v_lshl_add_u32 v11, v12, 6, v11
v_bfe_u32 v12, v10, 3, 1
v_lshl_add_u32 v11, v12, 1, v11
v_bfe_u32 v12, v10, 4, 1
v_lshl_add_u32 v10, v12, 3, v11
v_mul_u32_u24 v10, 1280, v10
v_lshl_add_u32 v79, v9, 4, v10
v_add_u32 v9, 512, v8
v_mul_u32_u24 v10, s53, v9
v_lshrrev_b32 v10, 22, v10
v_mul_u32_u24 v11, 80, v10
v_sub_u32 v9, v9, v11
v_and_b32 v11, 15, v10
v_xor_b32 v9, v9, v11
v_and_b32 v11, 1, v10
v_bfe_u32 v12, v10, 1, 1
v_lshl_add_u32 v11, v12, 4, v11
v_bfe_u32 v12, v10, 2, 1
v_lshl_add_u32 v11, v12, 6, v11
v_bfe_u32 v12, v10, 3, 1
v_lshl_add_u32 v11, v12, 1, v11
v_bfe_u32 v12, v10, 4, 1
v_lshl_add_u32 v10, v12, 3, v11
v_mul_u32_u24 v10, 1280, v10
v_lshl_add_u32 v80, v9, 4, v10
v_add_u32 v9, 576, v8
v_mul_u32_u24 v10, s53, v9
v_lshrrev_b32 v10, 22, v10
v_mul_u32_u24 v11, 80, v10
v_sub_u32 v9, v9, v11
v_and_b32 v11, 15, v10
v_xor_b32 v9, v9, v11
v_and_b32 v11, 1, v10
v_bfe_u32 v12, v10, 1, 1
v_lshl_add_u32 v11, v12, 4, v11
v_bfe_u32 v12, v10, 2, 1
v_lshl_add_u32 v11, v12, 6, v11
v_bfe_u32 v12, v10, 3, 1
v_lshl_add_u32 v11, v12, 1, v11
v_bfe_u32 v12, v10, 4, 1
v_lshl_add_u32 v10, v12, 3, v11
v_mul_u32_u24 v10, 1280, v10
v_lshl_add_u32 v81, v9, 4, v10
s_mul_i32 s49, s57, 327680
s_mov_b32 s46, s49
s_mov_b32 s47, 0
s_lshl_b32 s48, s58, 18
s_lshl_b32 s52, s57, 14
s_add_u32 s48, s48, s52
s_add_u32 s48, s48, 216006656
s_mov_b32 s50, 512
v_bfe_u32 v2, v0, 6, 1
v_bfe_u32 v3, v0, 7, 1
v_and_b32 v1, 0x30, v0
v_lshl_add_u32 v1, v2, 7, v1
v_lshl_add_u32 v1, v3, 6, v1
v_bfe_u32 v2, v0, 8, 1
v_lshl_add_u32 v1, v2, 11, v1
v_bfe_u32 v2, v0, 9, 1
v_lshl_add_u32 v1, v2, 8, v1
s_mul_i32 s45, s3, 10240
s_mov_b32 s44, 0
v_bfe_u32 v8, v0, 4, 5
v_mul_u32_u24 v9, 1280, v8
v_and_b32 v8, 15, v8
v_lshrrev_b32 v10, 9, v0
v_xor_b32 v8, v8, v10
v_xor_b32 v10, 0, v8
v_lshl_add_u32 v64, v10, 4, v9
v_xor_b32 v10, 2, v8
v_lshl_add_u32 v65, v10, 4, v9
v_xor_b32 v10, 4, v8
v_lshl_add_u32 v66, v10, 4, v9
v_xor_b32 v10, 6, v8
v_lshl_add_u32 v67, v10, 4, v9
v_xor_b32 v10, 8, v8
v_lshl_add_u32 v68, v10, 4, v9
v_xor_b32 v10, 10, v8
v_lshl_add_u32 v69, v10, 4, v9
v_xor_b32 v10, 12, v8
v_lshl_add_u32 v70, v10, 4, v9
v_xor_b32 v10, 14, v8
v_lshl_add_u32 v71, v10, 4, v9
s_add_u32 m0, s45, 0
s_nop 0
buffer_load_dwordx4 v72, s[20:23], s46 offen lds
s_add_u32 m0, s45, 1024
s_nop 0
buffer_load_dwordx4 v73, s[20:23], s46 offen lds
s_add_u32 m0, s45, 2048
s_nop 0
buffer_load_dwordx4 v74, s[20:23], s46 offen lds
s_add_u32 m0, s45, 3072
s_nop 0
buffer_load_dwordx4 v75, s[20:23], s46 offen lds
s_add_u32 m0, s45, 4096
s_nop 0
buffer_load_dwordx4 v76, s[20:23], s46 offen lds
s_add_u32 m0, s45, 5120
s_nop 0
buffer_load_dwordx4 v77, s[20:23], s46 offen lds
s_add_u32 m0, s45, 6144
s_nop 0
buffer_load_dwordx4 v78, s[20:23], s46 offen lds
s_add_u32 m0, s45, 7168
s_nop 0
buffer_load_dwordx4 v79, s[20:23], s46 offen lds
s_add_u32 m0, s45, 8192
s_nop 0
buffer_load_dwordx4 v80, s[20:23], s46 offen lds
s_add_u32 m0, s45, 9216
s_nop 0
buffer_load_dwordx4 v81, s[20:23], s46 offen lds
s_add_u32 s45, s45, 40960
s_cmp_ge_u32 s45, 122880
s_cselect_b32 s55, 122880, 0
s_sub_u32 s45, s45, s55
s_add_u32 s47, s47, 1
s_and_b32 s55, s47, 1
s_mul_i32 s46, s55, 5120
s_and_b32 s55, s47, 2
s_mul_i32 s55, s55, 20480
s_add_u32 s46, s46, s55
s_and_b32 s55, s47, 4
s_mul_i32 s55, s55, 40960
s_add_u32 s46, s46, s55
s_add_u32 s46, s46, s49
s_add_u32 m0, s45, 0
s_nop 0
buffer_load_dwordx4 v72, s[20:23], s46 offen lds
s_add_u32 m0, s45, 1024
s_nop 0
buffer_load_dwordx4 v73, s[20:23], s46 offen lds
s_add_u32 m0, s45, 2048
s_nop 0
buffer_load_dwordx4 v74, s[20:23], s46 offen lds
s_add_u32 m0, s45, 3072
s_nop 0
buffer_load_dwordx4 v75, s[20:23], s46 offen lds
s_add_u32 m0, s45, 4096
s_nop 0
buffer_load_dwordx4 v76, s[20:23], s46 offen lds
s_add_u32 m0, s45, 5120
s_nop 0
buffer_load_dwordx4 v77, s[20:23], s46 offen lds
s_add_u32 m0, s45, 6144
s_nop 0
buffer_load_dwordx4 v78, s[20:23], s46 offen lds
s_add_u32 m0, s45, 7168
s_nop 0
buffer_load_dwordx4 v79, s[20:23], s46 offen lds
s_add_u32 m0, s45, 8192
s_nop 0
buffer_load_dwordx4 v80, s[20:23], s46 offen lds
s_add_u32 m0, s45, 9216
s_nop 0
buffer_load_dwordx4 v81, s[20:23], s46 offen lds
s_add_u32 s45, s45, 40960
s_cmp_ge_u32 s45, 122880
s_cselect_b32 s55, 122880, 0
s_sub_u32 s45, s45, s55
s_add_u32 s47, s47, 1
s_and_b32 s55, s47, 1
s_mul_i32 s46, s55, 5120
s_and_b32 s55, s47, 2
s_mul_i32 s55, s55, 20480
s_add_u32 s46, s46, s55
s_and_b32 s55, s47, 4
s_mul_i32 s55, s55, 40960
s_add_u32 s46, s46, s55
s_add_u32 s46, s46, s49
s_waitcnt vmcnt(10)
s_barrier
ds_read_b128 v[8:11], v64 offset:0
ds_read_b128 v[12:15], v65 offset:0
ds_read_b128 v[16:19], v66 offset:0
ds_read_b128 v[20:23], v67 offset:0
s_mov_b32 s59, 4
s_waitcnt lgkmcnt(3)
v_mfma_f32_32x32x16_bf16 v[32:47], v[8:11], v[96:99], 0
s_waitcnt lgkmcnt(2)
ds_read_b128 v[24:27], v68 offset:0
v_mfma_f32_32x32x16_bf16 v[32:47], v[12:15], v[100:103], v[32:47]
s_waitcnt lgkmcnt(2)
ds_read_b128 v[8:11], v69 offset:0
s_add_u32 m0, s45, 0
s_nop 0
buffer_load_dwordx4 v72, s[20:23], s46 offen lds
s_add_u32 m0, s45, 1024
s_nop 0
buffer_load_dwordx4 v73, s[20:23], s46 offen lds
v_mfma_f32_32x32x16_bf16 v[32:47], v[16:19], v[104:107], v[32:47]
s_waitcnt lgkmcnt(2)
ds_read_b128 v[12:15], v70 offset:0
s_add_u32 m0, s45, 2048
s_nop 0
buffer_load_dwordx4 v74, s[20:23], s46 offen lds
s_add_u32 m0, s45, 3072
s_nop 0
buffer_load_dwordx4 v75, s[20:23], s46 offen lds
v_mfma_f32_32x32x16_bf16 v[32:47], v[20:23], v[108:111], v[32:47]
s_waitcnt lgkmcnt(2)
ds_read_b128 v[16:19], v71 offset:0
s_add_u32 m0, s45, 4096
s_nop 0
buffer_load_dwordx4 v76, s[20:23], s46 offen lds
s_add_u32 m0, s45, 5120
s_nop 0
buffer_load_dwordx4 v77, s[20:23], s46 offen lds
v_mfma_f32_32x32x16_bf16 v[32:47], v[24:27], v[112:115], v[32:47]
s_waitcnt lgkmcnt(2)
ds_read_b128 v[20:23], v64 offset:256
s_add_u32 m0, s45, 6144
s_nop 0
buffer_load_dwordx4 v78, s[20:23], s46 offen lds
s_add_u32 m0, s45, 7168
s_nop 0
buffer_load_dwordx4 v79, s[20:23], s46 offen lds
v_mfma_f32_32x32x16_bf16 v[32:47], v[8:11], v[116:119], v[32:47]
s_waitcnt lgkmcnt(2)
ds_read_b128 v[24:27], v65 offset:256
s_add_u32 m0, s45, 8192
s_nop 0
buffer_load_dwordx4 v80, s[20:23], s46 offen lds
s_add_u32 m0, s45, 9216
s_nop 0
buffer_load_dwordx4 v81, s[20:23], s46 offen lds
v_mfma_f32_32x32x16_bf16 v[32:47], v[12:15], v[120:123], v[32:47]
s_waitcnt lgkmcnt(2)
ds_read_b128 v[8:11], v66 offset:256
s_add_u32 s45, s45, 40960
s_cmp_ge_u32 s45, 122880
s_cselect_b32 s55, 122880, 0
s_sub_u32 s45, s45, s55
s_add_u32 s47, s47, 1
s_and_b32 s55, s47, 1
s_mul_i32 s46, s55, 5120
s_and_b32 s55, s47, 2
s_mul_i32 s55, s55, 20480
s_add_u32 s46, s46, s55
s_and_b32 s55, s47, 4
s_mul_i32 s55, s55, 40960
s_add_u32 s46, s46, s55
s_add_u32 s46, s46, s49
v_mfma_f32_32x32x16_bf16 v[32:47], v[16:19], v[124:127], v[32:47]
s_waitcnt lgkmcnt(2)
ds_read_b128 v[12:15], v67 offset:256
v_mfma_f32_32x32x16_bf16 v[32:47], v[20:23], v[128:131], v[32:47]
s_waitcnt lgkmcnt(2)
ds_read_b128 v[16:19], v68 offset:256
v_mfma_f32_32x32x16_bf16 v[32:47], v[24:27], v[132:135], v[32:47]
s_waitcnt lgkmcnt(2)
ds_read_b128 v[20:23], v69 offset:256
v_mfma_f32_32x32x16_bf16 v[32:47], v[8:11], v[136:139], v[32:47]
s_waitcnt lgkmcnt(2)
ds_read_b128 v[24:27], v70 offset:256
v_mfma_f32_32x32x16_bf16 v[32:47], v[12:15], v[140:143], v[32:47]
s_waitcnt lgkmcnt(2)
ds_read_b128 v[8:11], v71 offset:256
v_mfma_f32_32x32x16_bf16 v[32:47], v[16:19], v[144:147], v[32:47]
s_waitcnt lgkmcnt(2)
ds_read_b128 v[12:15], v64 offset:512
v_mfma_f32_32x32x16_bf16 v[32:47], v[20:23], v[148:151], v[32:47]
s_waitcnt lgkmcnt(2)
ds_read_b128 v[16:19], v65 offset:512
v_mfma_f32_32x32x16_bf16 v[32:47], v[24:27], v[152:155], v[32:47]
s_waitcnt lgkmcnt(2)
ds_read_b128 v[20:23], v66 offset:512
v_mfma_f32_32x32x16_bf16 v[32:47], v[8:11], v[156:159], v[32:47]
s_waitcnt lgkmcnt(2)
ds_read_b128 v[24:27], v67 offset:512
v_mfma_f32_32x32x16_bf16 v[32:47], v[12:15], v[160:163], v[32:47]
s_waitcnt lgkmcnt(2)
ds_read_b128 v[8:11], v68 offset:512
v_mfma_f32_32x32x16_bf16 v[32:47], v[16:19], v[164:167], v[32:47]
s_waitcnt lgkmcnt(2)
ds_read_b128 v[12:15], v69 offset:512
v_mfma_f32_32x32x16_bf16 v[32:47], v[20:23], v[168:171], v[32:47]
s_waitcnt lgkmcnt(2)
ds_read_b128 v[16:19], v70 offset:512
v_mfma_f32_32x32x16_bf16 v[32:47], v[24:27], v[172:175], v[32:47]
s_waitcnt lgkmcnt(2)
ds_read_b128 v[20:23], v71 offset:512
v_mfma_f32_32x32x16_bf16 v[32:47], v[8:11], v[176:179], v[32:47]
s_waitcnt lgkmcnt(2)
ds_read_b128 v[24:27], v64 offset:768
v_mfma_f32_32x32x16_bf16 v[32:47], v[12:15], v[180:183], v[32:47]
s_waitcnt lgkmcnt(2)
ds_read_b128 v[8:11], v65 offset:768
v_mfma_f32_32x32x16_bf16 v[32:47], v[16:19], v[184:187], v[32:47]
s_waitcnt lgkmcnt(2)
ds_read_b128 v[12:15], v66 offset:768
v_mfma_f32_32x32x16_bf16 v[32:47], v[20:23], v[188:191], v[32:47]
s_waitcnt lgkmcnt(2)
ds_read_b128 v[16:19], v67 offset:768
v_mfma_f32_32x32x16_bf16 v[32:47], v[24:27], v[192:195], v[32:47]
s_waitcnt lgkmcnt(2)
ds_read_b128 v[20:23], v68 offset:768
v_mfma_f32_32x32x16_bf16 v[32:47], v[8:11], v[196:199], v[32:47]
s_waitcnt lgkmcnt(2)
ds_read_b128 v[24:27], v69 offset:768
v_mfma_f32_32x32x16_bf16 v[32:47], v[12:15], v[200:203], v[32:47]
s_waitcnt lgkmcnt(2)
ds_read_b128 v[8:11], v70 offset:768
v_mfma_f32_32x32x16_bf16 v[32:47], v[16:19], v[204:207], v[32:47]
s_waitcnt lgkmcnt(2)
ds_read_b128 v[12:15], v71 offset:768
v_mfma_f32_32x32x16_bf16 v[32:47], v[20:23], v[208:211], v[32:47]
s_waitcnt lgkmcnt(2)
ds_read_b128 v[16:19], v64 offset:1024
v_mfma_f32_32x32x16_bf16 v[32:47], v[24:27], v[212:215], v[32:47]
s_waitcnt lgkmcnt(2)
ds_read_b128 v[20:23], v65 offset:1024
v_mfma_f32_32x32x16_bf16 v[32:47], v[8:11], v[216:219], v[32:47]
s_waitcnt lgkmcnt(2)
ds_read_b128 v[24:27], v66 offset:1024
v_mfma_f32_32x32x16_bf16 v[32:47], v[12:15], v[220:223], v[32:47]
s_waitcnt lgkmcnt(2)
ds_read_b128 v[8:11], v67 offset:1024
v_mfma_f32_32x32x16_bf16 v[32:47], v[16:19], v[224:227], v[32:47]
s_waitcnt lgkmcnt(2)
ds_read_b128 v[12:15], v68 offset:1024
v_mfma_f32_32x32x16_bf16 v[32:47], v[20:23], v[228:231], v[32:47]
s_waitcnt lgkmcnt(2)
ds_read_b128 v[16:19], v69 offset:1024
v_mfma_f32_32x32x16_bf16 v[32:47], v[24:27], v[232:235], v[32:47]
s_waitcnt lgkmcnt(2)
ds_read_b128 v[20:23], v70 offset:1024
v_mfma_f32_32x32x16_bf16 v[32:47], v[8:11], v[236:239], v[32:47]
s_waitcnt lgkmcnt(2)
ds_read_b128 v[24:27], v71 offset:1024
v_mfma_f32_32x32x16_bf16 v[32:47], v[12:15], v[240:243], v[32:47]
s_add_u32 s44, s44, 1
s_cmp_eq_u32 s44, 3
s_mov_b32 s56, 40960
s_cmov_b32 s56, -81920
s_cselect_b32 s44, 0, s44
v_add_u32 v64, s56, v64
v_add_u32 v65, s56, v65
v_add_u32 v66, s56, v66
v_add_u32 v67, s56, v67
v_add_u32 v68, s56, v68
v_add_u32 v69, s56, v69
v_add_u32 v70, s56, v70
v_add_u32 v71, s56, v71
s_waitcnt vmcnt(10) lgkmcnt(2)
s_barrier
ds_read_b128 v[8:11], v64 offset:0
v_mfma_f32_32x32x16_bf16 v[32:47], v[16:19], v[244:247], v[32:47]
s_waitcnt lgkmcnt(2)
ds_read_b128 v[12:15], v65 offset:0
v_mfma_f32_32x32x16_bf16 v[32:47], v[20:23], v[248:251], v[32:47]
s_waitcnt lgkmcnt(2)
ds_read_b128 v[16:19], v66 offset:0
v_mfma_f32_32x32x16_bf16 v[32:47], v[24:27], v[252:255], v[32:47]
s_waitcnt lgkmcnt(2)
ds_read_b128 v[20:23], v67 offset:0
k_st_92:
v_mfma_f32_32x32x16_bf16 v[48:63], v[8:11], v[96:99], 0
s_waitcnt lgkmcnt(2)
ds_read_b128 v[24:27], v68 offset:0
v_mfma_f32_32x32x16_bf16 v[48:63], v[12:15], v[100:103], v[48:63]
s_waitcnt lgkmcnt(2)
ds_read_b128 v[8:11], v69 offset:0
v_cvt_pk_bf16_f32 v32, v32, v33
v_cvt_pk_bf16_f32 v33, v34, v35
v_mfma_f32_32x32x16_bf16 v[48:63], v[16:19], v[104:107], v[48:63]
s_waitcnt lgkmcnt(2)
ds_read_b128 v[12:15], v70 offset:0
v_cvt_pk_bf16_f32 v34, v36, v37
v_cvt_pk_bf16_f32 v35, v38, v39
v_mfma_f32_32x32x16_bf16 v[48:63], v[20:23], v[108:111], v[48:63]
s_waitcnt lgkmcnt(2)
ds_read_b128 v[16:19], v71 offset:0
v_cvt_pk_bf16_f32 v36, v40, v41
v_cvt_pk_bf16_f32 v37, v42, v43
v_mfma_f32_32x32x16_bf16 v[48:63], v[24:27], v[112:115], v[48:63]
s_waitcnt lgkmcnt(2)
ds_read_b128 v[20:23], v64 offset:256
v_cvt_pk_bf16_f32 v38, v44, v45
v_cvt_pk_bf16_f32 v39, v46, v47
v_mfma_f32_32x32x16_bf16 v[48:63], v[8:11], v[116:119], v[48:63]
s_waitcnt lgkmcnt(2)
ds_read_b128 v[24:27], v65 offset:256
buffer_store_dwordx4 v[32:35], v1, s[4:7], s48 offen offset:0 sc1
buffer_store_dwordx4 v[36:39], v1, s[4:7], s48 offen offset:1024 sc1
v_mfma_f32_32x32x16_bf16 v[48:63], v[12:15], v[120:123], v[48:63]
s_waitcnt lgkmcnt(2)
ds_read_b128 v[8:11], v66 offset:256
s_add_u32 s48, s48, s50
s_sub_u32 s50, 4096, s50
s_add_u32 m0, s45, 0
s_nop 0
buffer_load_dwordx4 v72, s[20:23], s46 offen lds
v_mfma_f32_32x32x16_bf16 v[48:63], v[16:19], v[124:127], v[48:63]
s_waitcnt lgkmcnt(2)
ds_read_b128 v[12:15], v67 offset:256
s_add_u32 m0, s45, 1024
s_nop 0
buffer_load_dwordx4 v73, s[20:23], s46 offen lds
s_add_u32 m0, s45, 2048
s_nop 0
buffer_load_dwordx4 v74, s[20:23], s46 offen lds
v_mfma_f32_32x32x16_bf16 v[48:63], v[20:23], v[128:131], v[48:63]
s_waitcnt lgkmcnt(2)
ds_read_b128 v[16:19], v68 offset:256
s_add_u32 m0, s45, 3072
s_nop 0
buffer_load_dwordx4 v75, s[20:23], s46 offen lds
s_add_u32 m0, s45, 4096
s_nop 0
buffer_load_dwordx4 v76, s[20:23], s46 offen lds
v_mfma_f32_32x32x16_bf16 v[48:63], v[24:27], v[132:135], v[48:63]
s_waitcnt lgkmcnt(2)
ds_read_b128 v[20:23], v69 offset:256
s_add_u32 m0, s45, 5120
s_nop 0
buffer_load_dwordx4 v77, s[20:23], s46 offen lds
s_add_u32 m0, s45, 6144
s_nop 0
buffer_load_dwordx4 v78, s[20:23], s46 offen lds
v_mfma_f32_32x32x16_bf16 v[48:63], v[8:11], v[136:139], v[48:63]
s_waitcnt lgkmcnt(2)
ds_read_b128 v[24:27], v70 offset:256
s_add_u32 m0, s45, 7168
s_nop 0
buffer_load_dwordx4 v79, s[20:23], s46 offen lds
s_add_u32 m0, s45, 8192
s_nop 0
buffer_load_dwordx4 v80, s[20:23], s46 offen lds
v_mfma_f32_32x32x16_bf16 v[48:63], v[12:15], v[140:143], v[48:63]
s_waitcnt lgkmcnt(2)
ds_read_b128 v[8:11], v71 offset:256
s_add_u32 m0, s45, 9216
s_nop 0
buffer_load_dwordx4 v81, s[20:23], s46 offen lds
s_add_u32 s45, s45, 40960
s_cmp_ge_u32 s45, 122880
s_cselect_b32 s55, 122880, 0
s_sub_u32 s45, s45, s55
v_mfma_f32_32x32x16_bf16 v[48:63], v[16:19], v[144:147], v[48:63]
s_waitcnt lgkmcnt(2)
ds_read_b128 v[12:15], v64 offset:512
s_add_u32 s47, s47, 1
s_and_b32 s55, s47, 1
s_mul_i32 s46, s55, 5120
s_and_b32 s55, s47, 2
s_mul_i32 s55, s55, 20480
s_add_u32 s46, s46, s55
s_and_b32 s55, s47, 4
s_mul_i32 s55, s55, 40960
s_add_u32 s46, s46, s55
s_add_u32 s46, s46, s49
v_mfma_f32_32x32x16_bf16 v[48:63], v[20:23], v[148:151], v[48:63]
s_waitcnt lgkmcnt(2)
ds_read_b128 v[16:19], v65 offset:512
v_mfma_f32_32x32x16_bf16 v[48:63], v[24:27], v[152:155], v[48:63]
s_waitcnt lgkmcnt(2)
ds_read_b128 v[20:23], v66 offset:512
v_mfma_f32_32x32x16_bf16 v[48:63], v[8:11], v[156:159], v[48:63]
s_waitcnt lgkmcnt(2)
ds_read_b128 v[24:27], v67 offset:512
v_mfma_f32_32x32x16_bf16 v[48:63], v[12:15], v[160:163], v[48:63]
s_waitcnt lgkmcnt(2)
ds_read_b128 v[8:11], v68 offset:512
v_mfma_f32_32x32x16_bf16 v[48:63], v[16:19], v[164:167], v[48:63]
s_waitcnt lgkmcnt(2)
ds_read_b128 v[12:15], v69 offset:512
v_mfma_f32_32x32x16_bf16 v[48:63], v[20:23], v[168:171], v[48:63]
s_waitcnt lgkmcnt(2)
ds_read_b128 v[16:19], v70 offset:512
v_mfma_f32_32x32x16_bf16 v[48:63], v[24:27], v[172:175], v[48:63]
s_waitcnt lgkmcnt(2)
ds_read_b128 v[20:23], v71 offset:512
v_mfma_f32_32x32x16_bf16 v[48:63], v[8:11], v[176:179], v[48:63]
s_waitcnt lgkmcnt(2)
ds_read_b128 v[24:27], v64 offset:768
v_mfma_f32_32x32x16_bf16 v[48:63], v[12:15], v[180:183], v[48:63]
s_waitcnt lgkmcnt(2)
ds_read_b128 v[8:11], v65 offset:768
v_mfma_f32_32x32x16_bf16 v[48:63], v[16:19], v[184:187], v[48:63]
s_waitcnt lgkmcnt(2)
ds_read_b128 v[12:15], v66 offset:768
v_mfma_f32_32x32x16_bf16 v[48:63], v[20:23], v[188:191], v[48:63]
s_waitcnt lgkmcnt(2)
ds_read_b128 v[16:19], v67 offset:768
v_mfma_f32_32x32x16_bf16 v[48:63], v[24:27], v[192:195], v[48:63]
s_waitcnt lgkmcnt(2)
ds_read_b128 v[20:23], v68 offset:768
v_mfma_f32_32x32x16_bf16 v[48:63], v[8:11], v[196:199], v[48:63]
s_waitcnt lgkmcnt(2)
ds_read_b128 v[24:27], v69 offset:768
v_mfma_f32_32x32x16_bf16 v[48:63], v[12:15], v[200:203], v[48:63]
s_waitcnt lgkmcnt(2)
ds_read_b128 v[8:11], v70 offset:768
v_mfma_f32_32x32x16_bf16 v[48:63], v[16:19], v[204:207], v[48:63]
s_waitcnt lgkmcnt(2)
ds_read_b128 v[12:15], v71 offset:768
v_mfma_f32_32x32x16_bf16 v[48:63], v[20:23], v[208:211], v[48:63]
s_waitcnt lgkmcnt(2)
ds_read_b128 v[16:19], v64 offset:1024
v_mfma_f32_32x32x16_bf16 v[48:63], v[24:27], v[212:215], v[48:63]
s_waitcnt lgkmcnt(2)
ds_read_b128 v[20:23], v65 offset:1024
v_mfma_f32_32x32x16_bf16 v[48:63], v[8:11], v[216:219], v[48:63]
s_waitcnt lgkmcnt(2)
ds_read_b128 v[24:27], v66 offset:1024
v_mfma_f32_32x32x16_bf16 v[48:63], v[12:15], v[220:223], v[48:63]
s_waitcnt lgkmcnt(2)
ds_read_b128 v[8:11], v67 offset:1024
v_mfma_f32_32x32x16_bf16 v[48:63], v[16:19], v[224:227], v[48:63]
s_waitcnt lgkmcnt(2)
ds_read_b128 v[12:15], v68 offset:1024
v_mfma_f32_32x32x16_bf16 v[48:63], v[20:23], v[228:231], v[48:63]
s_waitcnt lgkmcnt(2)
ds_read_b128 v[16:19], v69 offset:1024
v_mfma_f32_32x32x16_bf16 v[48:63], v[24:27], v[232:235], v[48:63]
s_waitcnt lgkmcnt(2)
ds_read_b128 v[20:23], v70 offset:1024
v_mfma_f32_32x32x16_bf16 v[48:63], v[8:11], v[236:239], v[48:63]
s_waitcnt lgkmcnt(2)
ds_read_b128 v[24:27], v71 offset:1024
v_mfma_f32_32x32x16_bf16 v[48:63], v[12:15], v[240:243], v[48:63]
s_add_u32 s44, s44, 1
s_cmp_eq_u32 s44, 3
s_mov_b32 s56, 40960
s_cmov_b32 s56, -81920
s_cselect_b32 s44, 0, s44
v_add_u32 v64, s56, v64
v_add_u32 v65, s56, v65
v_add_u32 v66, s56, v66
v_add_u32 v67, s56, v67
v_add_u32 v68, s56, v68
v_add_u32 v69, s56, v69
v_add_u32 v70, s56, v70
v_add_u32 v71, s56, v71
s_waitcnt vmcnt(10) lgkmcnt(2)
s_barrier
ds_read_b128 v[8:11], v64 offset:0
v_mfma_f32_32x32x16_bf16 v[48:63], v[16:19], v[244:247], v[48:63]
s_waitcnt lgkmcnt(2)
ds_read_b128 v[12:15], v65 offset:0
v_mfma_f32_32x32x16_bf16 v[48:63], v[20:23], v[248:251], v[48:63]
s_waitcnt lgkmcnt(2)
ds_read_b128 v[16:19], v66 offset:0
v_mfma_f32_32x32x16_bf16 v[48:63], v[24:27], v[252:255], v[48:63]
s_waitcnt lgkmcnt(2)
ds_read_b128 v[20:23], v67 offset:0
s_sub_u32 s59, s59, 1
s_cmp_eq_u32 s59, 0
s_cbranch_scc1 k_so_93
v_mfma_f32_32x32x16_bf16 v[32:47], v[8:11], v[96:99], 0
s_waitcnt lgkmcnt(2)
ds_read_b128 v[24:27], v68 offset:0
v_mfma_f32_32x32x16_bf16 v[32:47], v[12:15], v[100:103], v[32:47]
s_waitcnt lgkmcnt(2)
ds_read_b128 v[8:11], v69 offset:0
v_cvt_pk_bf16_f32 v48, v48, v49
v_cvt_pk_bf16_f32 v49, v50, v51
v_mfma_f32_32x32x16_bf16 v[32:47], v[16:19], v[104:107], v[32:47]
s_waitcnt lgkmcnt(2)
ds_read_b128 v[12:15], v70 offset:0
v_cvt_pk_bf16_f32 v50, v52, v53
v_cvt_pk_bf16_f32 v51, v54, v55
v_mfma_f32_32x32x16_bf16 v[32:47], v[20:23], v[108:111], v[32:47]
s_waitcnt lgkmcnt(2)
ds_read_b128 v[16:19], v71 offset:0
v_cvt_pk_bf16_f32 v52, v56, v57
v_cvt_pk_bf16_f32 v53, v58, v59
v_mfma_f32_32x32x16_bf16 v[32:47], v[24:27], v[112:115], v[32:47]
s_waitcnt lgkmcnt(2)
ds_read_b128 v[20:23], v64 offset:256
v_cvt_pk_bf16_f32 v54, v60, v61
v_cvt_pk_bf16_f32 v55, v62, v63
v_mfma_f32_32x32x16_bf16 v[32:47], v[8:11], v[116:119], v[32:47]
s_waitcnt lgkmcnt(2)
ds_read_b128 v[24:27], v65 offset:256
buffer_store_dwordx4 v[48:51], v1, s[4:7], s48 offen offset:0 sc1
buffer_store_dwordx4 v[52:55], v1, s[4:7], s48 offen offset:1024 sc1
v_mfma_f32_32x32x16_bf16 v[32:47], v[12:15], v[120:123], v[32:47]
s_waitcnt lgkmcnt(2)
ds_read_b128 v[8:11], v66 offset:256
s_add_u32 s48, s48, s50
s_sub_u32 s50, 4096, s50
s_add_u32 m0, s45, 0
s_nop 0
buffer_load_dwordx4 v72, s[20:23], s46 offen lds
v_mfma_f32_32x32x16_bf16 v[32:47], v[16:19], v[124:127], v[32:47]
s_waitcnt lgkmcnt(2)
ds_read_b128 v[12:15], v67 offset:256
s_add_u32 m0, s45, 1024
s_nop 0
buffer_load_dwordx4 v73, s[20:23], s46 offen lds
s_add_u32 m0, s45, 2048
s_nop 0
buffer_load_dwordx4 v74, s[20:23], s46 offen lds
v_mfma_f32_32x32x16_bf16 v[32:47], v[20:23], v[128:131], v[32:47]
s_waitcnt lgkmcnt(2)
ds_read_b128 v[16:19], v68 offset:256
s_add_u32 m0, s45, 3072
s_nop 0
buffer_load_dwordx4 v75, s[20:23], s46 offen lds
s_add_u32 m0, s45, 4096
s_nop 0
buffer_load_dwordx4 v76, s[20:23], s46 offen lds
v_mfma_f32_32x32x16_bf16 v[32:47], v[24:27], v[132:135], v[32:47]
s_waitcnt lgkmcnt(2)
ds_read_b128 v[20:23], v69 offset:256
s_add_u32 m0, s45, 5120
s_nop 0
buffer_load_dwordx4 v77, s[20:23], s46 offen lds
s_add_u32 m0, s45, 6144
s_nop 0
buffer_load_dwordx4 v78, s[20:23], s46 offen lds
v_mfma_f32_32x32x16_bf16 v[32:47], v[8:11], v[136:139], v[32:47]
s_waitcnt lgkmcnt(2)
ds_read_b128 v[24:27], v70 offset:256
s_add_u32 m0, s45, 7168
s_nop 0
buffer_load_dwordx4 v79, s[20:23], s46 offen lds
s_add_u32 m0, s45, 8192
s_nop 0
buffer_load_dwordx4 v80, s[20:23], s46 offen lds
v_mfma_f32_32x32x16_bf16 v[32:47], v[12:15], v[140:143], v[32:47]
s_waitcnt lgkmcnt(2)
ds_read_b128 v[8:11], v71 offset:256
s_add_u32 m0, s45, 9216
s_nop 0
buffer_load_dwordx4 v81, s[20:23], s46 offen lds
s_add_u32 s45, s45, 40960
s_cmp_ge_u32 s45, 122880
s_cselect_b32 s55, 122880, 0
s_sub_u32 s45, s45, s55
v_mfma_f32_32x32x16_bf16 v[32:47], v[16:19], v[144:147], v[32:47]
s_waitcnt lgkmcnt(2)
ds_read_b128 v[12:15], v64 offset:512
s_add_u32 s47, s47, 1
s_and_b32 s55, s47, 1
s_mul_i32 s46, s55, 5120
s_and_b32 s55, s47, 2
s_mul_i32 s55, s55, 20480
s_add_u32 s46, s46, s55
s_and_b32 s55, s47, 4
s_mul_i32 s55, s55, 40960
s_add_u32 s46, s46, s55
s_add_u32 s46, s46, s49
v_mfma_f32_32x32x16_bf16 v[32:47], v[20:23], v[148:151], v[32:47]
s_waitcnt lgkmcnt(2)
ds_read_b128 v[16:19], v65 offset:512
v_mfma_f32_32x32x16_bf16 v[32:47], v[24:27], v[152:155], v[32:47]
s_waitcnt lgkmcnt(2)
ds_read_b128 v[20:23], v66 offset:512
v_mfma_f32_32x32x16_bf16 v[32:47], v[8:11], v[156:159], v[32:47]
s_waitcnt lgkmcnt(2)
ds_read_b128 v[24:27], v67 offset:512
v_mfma_f32_32x32x16_bf16 v[32:47], v[12:15], v[160:163], v[32:47]
s_waitcnt lgkmcnt(2)
ds_read_b128 v[8:11], v68 offset:512
v_mfma_f32_32x32x16_bf16 v[32:47], v[16:19], v[164:167], v[32:47]
s_waitcnt lgkmcnt(2)
ds_read_b128 v[12:15], v69 offset:512
v_mfma_f32_32x32x16_bf16 v[32:47], v[20:23], v[168:171], v[32:47]
s_waitcnt lgkmcnt(2)
ds_read_b128 v[16:19], v70 offset:512
v_mfma_f32_32x32x16_bf16 v[32:47], v[24:27], v[172:175], v[32:47]
s_waitcnt lgkmcnt(2)
ds_read_b128 v[20:23], v71 offset:512
v_mfma_f32_32x32x16_bf16 v[32:47], v[8:11], v[176:179], v[32:47]
s_waitcnt lgkmcnt(2)
ds_read_b128 v[24:27], v64 offset:768
v_mfma_f32_32x32x16_bf16 v[32:47], v[12:15], v[180:183], v[32:47]
s_waitcnt lgkmcnt(2)
ds_read_b128 v[8:11], v65 offset:768
v_mfma_f32_32x32x16_bf16 v[32:47], v[16:19], v[184:187], v[32:47]
s_waitcnt lgkmcnt(2)
ds_read_b128 v[12:15], v66 offset:768
v_mfma_f32_32x32x16_bf16 v[32:47], v[20:23], v[188:191], v[32:47]
s_waitcnt lgkmcnt(2)
ds_read_b128 v[16:19], v67 offset:768
v_mfma_f32_32x32x16_bf16 v[32:47], v[24:27], v[192:195], v[32:47]
s_waitcnt lgkmcnt(2)
ds_read_b128 v[20:23], v68 offset:768
v_mfma_f32_32x32x16_bf16 v[32:47], v[8:11], v[196:199], v[32:47]
s_waitcnt lgkmcnt(2)
ds_read_b128 v[24:27], v69 offset:768
v_mfma_f32_32x32x16_bf16 v[32:47], v[12:15], v[200:203], v[32:47]
s_waitcnt lgkmcnt(2)
ds_read_b128 v[8:11], v70 offset:768
v_mfma_f32_32x32x16_bf16 v[32:47], v[16:19], v[204:207], v[32:47]
s_waitcnt lgkmcnt(2)
ds_read_b128 v[12:15], v71 offset:768
v_mfma_f32_32x32x16_bf16 v[32:47], v[20:23], v[208:211], v[32:47]
s_waitcnt lgkmcnt(2)
ds_read_b128 v[16:19], v64 offset:1024
v_mfma_f32_32x32x16_bf16 v[32:47], v[24:27], v[212:215], v[32:47]
s_waitcnt lgkmcnt(2)
ds_read_b128 v[20:23], v65 offset:1024
v_mfma_f32_32x32x16_bf16 v[32:47], v[8:11], v[216:219], v[32:47]
s_waitcnt lgkmcnt(2)
ds_read_b128 v[24:27], v66 offset:1024
v_mfma_f32_32x32x16_bf16 v[32:47], v[12:15], v[220:223], v[32:47]
s_waitcnt lgkmcnt(2)
ds_read_b128 v[8:11], v67 offset:1024
v_mfma_f32_32x32x16_bf16 v[32:47], v[16:19], v[224:227], v[32:47]
s_waitcnt lgkmcnt(2)
ds_read_b128 v[12:15], v68 offset:1024
v_mfma_f32_32x32x16_bf16 v[32:47], v[20:23], v[228:231], v[32:47]
s_waitcnt lgkmcnt(2)
ds_read_b128 v[16:19], v69 offset:1024
v_mfma_f32_32x32x16_bf16 v[32:47], v[24:27], v[232:235], v[32:47]
s_waitcnt lgkmcnt(2)
ds_read_b128 v[20:23], v70 offset:1024
v_mfma_f32_32x32x16_bf16 v[32:47], v[8:11], v[236:239], v[32:47]
s_waitcnt lgkmcnt(2)
ds_read_b128 v[24:27], v71 offset:1024
v_mfma_f32_32x32x16_bf16 v[32:47], v[12:15], v[240:243], v[32:47]
s_add_u32 s44, s44, 1
s_cmp_eq_u32 s44, 3
s_mov_b32 s56, 40960
s_cmov_b32 s56, -81920
s_cselect_b32 s44, 0, s44
v_add_u32 v64, s56, v64
v_add_u32 v65, s56, v65
v_add_u32 v66, s56, v66
v_add_u32 v67, s56, v67
v_add_u32 v68, s56, v68
v_add_u32 v69, s56, v69
v_add_u32 v70, s56, v70
v_add_u32 v71, s56, v71
s_waitcnt vmcnt(10) lgkmcnt(2)
s_barrier
ds_read_b128 v[8:11], v64 offset:0
v_mfma_f32_32x32x16_bf16 v[32:47], v[16:19], v[244:247], v[32:47]
s_waitcnt lgkmcnt(2)
ds_read_b128 v[12:15], v65 offset:0
v_mfma_f32_32x32x16_bf16 v[32:47], v[20:23], v[248:251], v[32:47]
s_waitcnt lgkmcnt(2)
ds_read_b128 v[16:19], v66 offset:0
v_mfma_f32_32x32x16_bf16 v[32:47], v[24:27], v[252:255], v[32:47]
s_waitcnt lgkmcnt(2)
ds_read_b128 v[20:23], v67 offset:0
s_branch k_st_92
k_so_93:
s_nop 6
v_cvt_pk_bf16_f32 v48, v48, v49
v_cvt_pk_bf16_f32 v49, v50, v51
v_cvt_pk_bf16_f32 v50, v52, v53
v_cvt_pk_bf16_f32 v51, v54, v55
v_cvt_pk_bf16_f32 v52, v56, v57
v_cvt_pk_bf16_f32 v53, v58, v59
v_cvt_pk_bf16_f32 v54, v60, v61
v_cvt_pk_bf16_f32 v55, v62, v63
buffer_store_dwordx4 v[48:51], v1, s[4:7], s48 offen offset:0 sc1
buffer_store_dwordx4 v[52:55], v1, s[4:7], s48 offen offset:1024 sc1
s_add_u32 s48, s48, s50
s_sub_u32 s50, 4096, s50
s_lshl_b32 s54, s30, 6
s_add_u32 s54, s54, 222322688
s_waitcnt lgkmcnt(0)
s_waitcnt vmcnt(0)
s_barrier
s_cmp_lg_u32 s3, 0
s_cbranch_scc1 k_s8_94
s_mov_b64 exec, 1
v_mov_b32 v2, 1
buffer_store_dword v2, off, s[4:7], s54 sc1
s_mov_b64 exec, -1
k_s8_94:
s_mul_i32 s57, s30, 3277
s_lshr_b32 s57, s57, 16
s_mul_i32 s52, s57, 20
s_sub_u32 s58, s30, s52
s_mov_b32 s54, 222322688
v_add_u32 v10, 4096, v0
v_add_u32 v11, 8192, v0
v_add_u32 v12, 12288, v0
s_cmp_lg_u32 s3, 0
s_cbranch_scc1 k_w8d_96
v_lshlrev_b32 v96, 2, v0
k_w8_95:
buffer_load_dword v97, v96, s[4:7], s54 offen sc1
buffer_load_dword v98, v96, s[4:7], s54 offen offset:1024 sc1
s_waitcnt vmcnt(0)
v_and_b32 v97, v97, v98
v_cmp_eq_u32 vcc, 0, v97
s_cbranch_vccz k_w8d_96
s_sleep 1
s_sub_u32 s32, s32, 1
s_cmp_gt_i32 s32, 0
s_cbranch_scc1 k_w8_95
k_w8d_96:
s_barrier
s_lshl_b32 s52, s58, 2
s_add_u32 s52, s52, s3
s_lshl_b32 s52, s52, 16
s_add_u32 s52, s52, 216006656
buffer_load_dwordx4 a[0:3], v0, s[4:7], s52 offen offset:0 sc1
buffer_load_dwordx4 a[4:7], v0, s[4:7], s52 offen offset:1024 sc1
buffer_load_dwordx4 a[8:11], v0, s[4:7], s52 offen offset:2048 sc1
buffer_load_dwordx4 a[12:15], v0, s[4:7], s52 offen offset:3072 sc1
buffer_load_dwordx4 a[16:19], v10, s[4:7], s52 offen offset:0 sc1
buffer_load_dwordx4 a[20:23], v10, s[4:7], s52 offen offset:1024 sc1
buffer_load_dwordx4 a[24:27], v10, s[4:7], s52 offen offset:2048 sc1
buffer_load_dwordx4 a[28:31], v10, s[4:7], s52 offen offset:3072 sc1
buffer_load_dwordx4 a[32:35], v11, s[4:7], s52 offen offset:0 sc1
buffer_load_dwordx4 a[36:39], v11, s[4:7], s52 offen offset:1024 sc1
buffer_load_dwordx4 a[40:43], v11, s[4:7], s52 offen offset:2048 sc1
buffer_load_dwordx4 a[44:47], v11, s[4:7], s52 offen offset:3072 sc1
buffer_load_dwordx4 a[48:51], v12, s[4:7], s52 offen offset:0 sc1
buffer_load_dwordx4 a[52:55], v12, s[4:7], s52 offen offset:1024 sc1
buffer_load_dwordx4 a[56:59], v12, s[4:7], s52 offen offset:2048 sc1
buffer_load_dwordx4 a[60:63], v12, s[4:7], s52 offen offset:3072 sc1
s_add_u32 s52, s52, 16384
buffer_load_dwordx4 a[64:67], v0, s[4:7], s52 offen offset:0 sc1
buffer_load_dwordx4 a[68:71], v0, s[4:7], s52 offen offset:1024 sc1
buffer_load_dwordx4 a[72:75], v0, s[4:7], s52 offen offset:2048 sc1
buffer_load_dwordx4 a[76:79], v0, s[4:7], s52 offen offset:3072 sc1
buffer_load_dwordx4 a[80:83], v10, s[4:7], s52 offen offset:0 sc1
buffer_load_dwordx4 a[84:87], v10, s[4:7], s52 offen offset:1024 sc1
buffer_load_dwordx4 a[88:91], v10, s[4:7], s52 offen offset:2048 sc1
buffer_load_dwordx4 a[92:95], v10, s[4:7], s52 offen offset:3072 sc1
buffer_load_dwordx4 a[96:99], v11, s[4:7], s52 offen offset:0 sc1
buffer_load_dwordx4 a[100:103], v11, s[4:7], s52 offen offset:1024 sc1
buffer_load_dwordx4 a[104:107], v11, s[4:7], s52 offen offset:2048 sc1
buffer_load_dwordx4 a[108:111], v11, s[4:7], s52 offen offset:3072 sc1
buffer_load_dwordx4 a[112:115], v12, s[4:7], s52 offen offset:0 sc1
buffer_load_dwordx4 a[116:119], v12, s[4:7], s52 offen offset:1024 sc1
buffer_load_dwordx4 a[120:123], v12, s[4:7], s52 offen offset:2048 sc1
buffer_load_dwordx4 a[124:127], v12, s[4:7], s52 offen offset:3072 sc1
s_waitcnt vmcnt(0)
s_add_u32 s52, s52, 16384
buffer_load_dwordx4 a[128:131], v0, s[4:7], s52 offen offset:0 sc1
buffer_load_dwordx4 a[132:135], v0, s[4:7], s52 offen offset:1024 sc1
buffer_load_dwordx4 a[136:139], v0, s[4:7], s52 offen offset:2048 sc1
buffer_load_dwordx4 a[140:143], v0, s[4:7], s52 offen offset:3072 sc1
buffer_load_dwordx4 a[144:147], v10, s[4:7], s52 offen offset:0 sc1
buffer_load_dwordx4 a[148:151], v10, s[4:7], s52 offen offset:1024 sc1
buffer_load_dwordx4 a[152:155], v10, s[4:7], s52 offen offset:2048 sc1
buffer_load_dwordx4 a[156:159], v10, s[4:7], s52 offen offset:3072 sc1
buffer_load_dwordx4 a[160:163], v11, s[4:7], s52 offen offset:0 sc1
buffer_load_dwordx4 a[164:167], v11, s[4:7], s52 offen offset:1024 sc1
buffer_load_dwordx4 a[168:171], v11, s[4:7], s52 offen offset:2048 sc1
buffer_load_dwordx4 a[172:175], v11, s[4:7], s52 offen offset:3072 sc1
buffer_load_dwordx4 a[176:179], v12, s[4:7], s52 offen offset:0 sc1
buffer_load_dwordx4 a[180:183], v12, s[4:7], s52 offen offset:1024 sc1
buffer_load_dwordx4 a[184:187], v12, s[4:7], s52 offen offset:2048 sc1
buffer_load_dwordx4 a[188:191], v12, s[4:7], s52 offen offset:3072 sc1
s_add_u32 s52, s52, 16384
buffer_load_dwordx4 a[192:195], v0, s[4:7], s52 offen offset:0 sc1
buffer_load_dwordx4 a[196:199], v0, s[4:7], s52 offen offset:1024 sc1
buffer_load_dwordx4 a[200:203], v0, s[4:7], s52 offen offset:2048 sc1
buffer_load_dwordx4 a[204:207], v0, s[4:7], s52 offen offset:3072 sc1
buffer_load_dwordx4 a[208:211], v10, s[4:7], s52 offen offset:0 sc1
buffer_load_dwordx4 a[212:215], v10, s[4:7], s52 offen offset:1024 sc1
buffer_load_dwordx4 a[216:219], v10, s[4:7], s52 offen offset:2048 sc1
buffer_load_dwordx4 a[220:223], v10, s[4:7], s52 offen offset:3072 sc1
buffer_load_dwordx4 a[224:227], v11, s[4:7], s52 offen offset:0 sc1
buffer_load_dwordx4 a[228:231], v11, s[4:7], s52 offen offset:1024 sc1
buffer_load_dwordx4 a[232:235], v11, s[4:7], s52 offen offset:2048 sc1
buffer_load_dwordx4 a[236:239], v11, s[4:7], s52 offen offset:3072 sc1
buffer_load_dwordx4 a[240:243], v12, s[4:7], s52 offen offset:0 sc1
buffer_load_dwordx4 a[244:247], v12, s[4:7], s52 offen offset:1024 sc1
buffer_load_dwordx4 a[248:251], v12, s[4:7], s52 offen offset:2048 sc1
buffer_load_dwordx4 a[252:255], v12, s[4:7], s52 offen offset:3072 sc1
s_waitcnt vmcnt(0)
s_lshl_b32 s46, s57, 16
s_lshl_b32 s52, s3, 14
s_add_u32 s46, s46, s52
s_add_u32 s46, s46, 159383552
s_lshl_b32 s53, s57, 7
s_lshl_b32 s44, s58, 11
s_add_u32 s44, s44, s53
s_add_u32 s44, s44, 195035136
s_lshl_b32 s45, s58, 17
s_add_u32 s45, s45, s53
s_add_u32 s45, s45, 205520896
s_lshl_b32 s48, s58, 7
s_lshl_b32 s53, s57, 5
s_add_u32 s48, s48, s53
s_add_u32 s48, s48, 211812352
s_lshr_b32 s49, s57, 1
s_lshl_b32 s49, s49, 8
s_lshl_b32 s53, s3, 5
s_add_u32 s49, s49, s53
s_add_u32 s49, s49, 222339072
s_mov_b32 s50, 1
v_lshrrev_b32 v96, 4, v0
v_and_b32 v97, 8, v96
v_cmp_ne_u32 vcc, 0, v97
v_mov_b32 v1, 0x4444
v_mov_b32 v97, 0xeeee
v_cndmask_b32 v1, v1, v97, vcc
v_and_b32 v97, 7, v96
v_lshrrev_b32 v98, 3, v96
v_lshlrev_b32 v2, 2, v97
v_mul_u32_u24 v4, 144, v98
v_lshl_add_u32 v4, v97, 4, v4
v_and_b32 v99, 1, v96
v_lshlrev_b32 v99, 3, v99
v_lshl_add_u32 v99, v98, 4, v99
v_bfe_u32 v100, v96, 1, 2
v_lshl_add_u32 v5, v100, 9, v99
v_lshl_add_u32 v6, v100, 15, v99
v_lshlrev_b32 v7, 2, v98
v_mov_b32 v99, 2146435072
v_cmp_eq_u32 vcc, 0, v97
s_nop 1
v_cndmask_b32 v7, v99, v7, vcc
v_add_u32 v97, s58, v97
v_cmp_eq_u32 vcc, 0, v97
s_nop 1
v_cndmask_b32 v9, 1.0, 0, vcc
v_and_b32 v3, 15, v96
v_bfe_u32 v97, v96, 4, 1
v_mul_u32_u24 v97, 144, v97
v_add_u32 v3, v3, v97
v_lshrrev_b32 v97, 5, v96
v_lshl_add_u32 v3, v97, 4, v3
v_lshlrev_b32 v3, 2, v3
s_mul_i32 s52, s3, 1152
v_add_u32 v3, s52, v3
s_mov_b32 s56, 8192
k_poll_98:
buffer_load_dword v8, v2, s[4:7], s49 offen sc1
s_waitcnt vmcnt(0)
v_cmp_gt_u32 vcc, s50, v8
s_cbranch_vccz k_pd_99
s_sleep 1
s_sub_u32 s32, s32, 1
s_cmp_gt_i32 s32, 0
s_cbranch_scc1 k_poll_98
k_pd_99:
buffer_load_dwordx2 v[14:15], v5, s[4:7], s44 offen sc1
buffer_load_dwordx4 v[32:35], v0, s[4:7], s46 offen offset:0 sc1
buffer_load_dwordx4 v[36:39], v0, s[4:7], s46 offen offset:1024 sc1
buffer_load_dwordx4 v[40:43], v0, s[4:7], s46 offen offset:2048 sc1
buffer_load_dwordx4 v[44:47], v0, s[4:7], s46 offen offset:3072 sc1
buffer_load_dwordx4 v[48:51], v10, s[4:7], s46 offen offset:0 sc1
buffer_load_dwordx4 v[52:55], v10, s[4:7], s46 offen offset:1024 sc1
buffer_load_dwordx4 v[56:59], v10, s[4:7], s46 offen offset:2048 sc1
buffer_load_dwordx4 v[60:63], v10, s[4:7], s46 offen offset:3072 sc1
buffer_load_dwordx4 v[64:67], v11, s[4:7], s46 offen offset:0 sc1
buffer_load_dwordx4 v[68:71], v11, s[4:7], s46 offen offset:1024 sc1
buffer_load_dwordx4 v[72:75], v11, s[4:7], s46 offen offset:2048 sc1
buffer_load_dwordx4 v[76:79], v11, s[4:7], s46 offen offset:3072 sc1
buffer_load_dwordx4 v[80:83], v12, s[4:7], s46 offen offset:0 sc1
buffer_load_dwordx4 v[84:87], v12, s[4:7], s46 offen offset:1024 sc1
buffer_load_dwordx4 v[88:91], v12, s[4:7], s46 offen offset:2048 sc1
buffer_load_dwordx4 v[92:95], v12, s[4:7], s46 offen offset:3072 sc1
s_xor_b32 s49, s49, 512
buffer_load_dword v8, v2, s[4:7], s49 offen sc1
k_top_97:
v_mov_b64 v[24:25], 0
v_mov_b64 v[26:27], 0
v_mov_b64 v[28:29], 0
v_mov_b64 v[30:31], 0
s_add_u32 s50, s50, 1
s_add_u32 s46, s46, 262144
s_add_u32 s44, s44, 40960
s_cmp_eq_u32 s50, 65
s_cselect_b32 s52, 1048576, 0
s_cselect_b32 s53, 524288, 0
s_add_u32 s46, s46, s52
s_add_u32 s44, s44, s53
s_waitcnt vmcnt(17)
v_lshlrev_b32 v16, 16, v14
v_and_b32 v17, 0xffff0000, v14
v_lshlrev_b32 v18, 16, v15
v_and_b32 v19, 0xffff0000, v15
s_waitcnt vmcnt(16)
v_smfmac_f32_16x16x64_bf16 v[24:27], v[32:35], a[0:7], v1
v_smfmac_f32_16x16x64_bf16 v[28:31], v[32:35], a[8:15], v1
s_waitcnt vmcnt(15)
v_smfmac_f32_16x16x64_bf16 v[24:27], v[36:39], a[16:23], v1
v_smfmac_f32_16x16x64_bf16 v[28:31], v[36:39], a[24:31], v1
s_waitcnt vmcnt(14)
v_smfmac_f32_16x16x64_bf16 v[24:27], v[40:43], a[32:39], v1
v_smfmac_f32_16x16x64_bf16 v[28:31], v[40:43], a[40:47], v1
s_waitcnt vmcnt(13)
v_smfmac_f32_16x16x64_bf16 v[24:27], v[44:47], a[48:55], v1
v_smfmac_f32_16x16x64_bf16 v[28:31], v[44:47], a[56:63], v1
s_waitcnt vmcnt(12)
v_smfmac_f32_16x16x64_bf16 v[24:27], v[48:51], a[64:71], v1
v_smfmac_f32_16x16x64_bf16 v[28:31], v[48:51], a[72:79], v1
s_waitcnt vmcnt(11)
v_smfmac_f32_16x16x64_bf16 v[24:27], v[52:55], a[80:87], v1
v_smfmac_f32_16x16x64_bf16 v[28:31], v[52:55], a[88:95], v1
s_waitcnt vmcnt(10)
v_smfmac_f32_16x16x64_bf16 v[24:27], v[56:59], a[96:103], v1
v_smfmac_f32_16x16x64_bf16 v[28:31], v[56:59], a[104:111], v1
s_waitcnt vmcnt(9)
v_smfmac_f32_16x16x64_bf16 v[24:27], v[60:63], a[112:119], v1
v_smfmac_f32_16x16x64_bf16 v[28:31], v[60:63], a[120:127], v1
s_waitcnt vmcnt(8)
v_smfmac_f32_16x16x64_bf16 v[24:27], v[64:67], a[128:135], v1
v_smfmac_f32_16x16x64_bf16 v[28:31], v[64:67], a[136:143], v1
s_waitcnt vmcnt(7)
v_smfmac_f32_16x16x64_bf16 v[24:27], v[68:71], a[144:151], v1
v_smfmac_f32_16x16x64_bf16 v[28:31], v[68:71], a[152:159], v1
s_waitcnt vmcnt(6)
v_smfmac_f32_16x16x64_bf16 v[24:27], v[72:75], a[160:167], v1
v_smfmac_f32_16x16x64_bf16 v[28:31], v[72:75], a[168:175], v1
s_waitcnt vmcnt(5)
v_smfmac_f32_16x16x64_bf16 v[24:27], v[76:79], a[176:183], v1
v_smfmac_f32_16x16x64_bf16 v[28:31], v[76:79], a[184:191], v1
s_waitcnt vmcnt(4)
v_smfmac_f32_16x16x64_bf16 v[24:27], v[80:83], a[192:199], v1
v_smfmac_f32_16x16x64_bf16 v[28:31], v[80:83], a[200:207], v1
s_waitcnt vmcnt(3)
v_smfmac_f32_16x16x64_bf16 v[24:27], v[84:87], a[208:215], v1
v_smfmac_f32_16x16x64_bf16 v[28:31], v[84:87], a[216:223], v1
s_waitcnt vmcnt(2)
v_smfmac_f32_16x16x64_bf16 v[24:27], v[88:91], a[224:231], v1
v_smfmac_f32_16x16x64_bf16 v[28:31], v[88:91], a[232:239], v1
s_waitcnt vmcnt(1)
v_smfmac_f32_16x16x64_bf16 v[24:27], v[92:95], a[240:247], v1
v_smfmac_f32_16x16x64_bf16 v[28:31], v[92:95], a[248:255], v1
s_waitcnt vmcnt(0)
v_cmp_gt_u32 vcc, s50, v8
s_mov_b32 s47, 0
s_cbranch_vccnz k_nr_100
s_mov_b32 s47, 1
buffer_load_dwordx2 v[14:15], v5, s[4:7], s44 offen sc1
buffer_load_dwordx4 v[32:35], v0, s[4:7], s46 offen offset:0 sc1
buffer_load_dwordx4 v[36:39], v0, s[4:7], s46 offen offset:1024 sc1
buffer_load_dwordx4 v[40:43], v0, s[4:7], s46 offen offset:2048 sc1
buffer_load_dwordx4 v[44:47], v0, s[4:7], s46 offen offset:3072 sc1
buffer_load_dwordx4 v[48:51], v10, s[4:7], s46 offen offset:0 sc1
buffer_load_dwordx4 v[52:55], v10, s[4:7], s46 offen offset:1024 sc1
buffer_load_dwordx4 v[56:59], v10, s[4:7], s46 offen offset:2048 sc1
buffer_load_dwordx4 v[60:63], v10, s[4:7], s46 offen offset:3072 sc1
buffer_load_dwordx4 v[64:67], v11, s[4:7], s46 offen offset:0 sc1
buffer_load_dwordx4 v[68:71], v11, s[4:7], s46 offen offset:1024 sc1
buffer_load_dwordx4 v[72:75], v11, s[4:7], s46 offen offset:2048 sc1
buffer_load_dwordx4 v[76:79], v11, s[4:7], s46 offen offset:3072 sc1
buffer_load_dwordx4 v[80:83], v12, s[4:7], s46 offen offset:0 sc1
buffer_load_dwordx4 v[84:87], v12, s[4:7], s46 offen offset:1024 sc1
buffer_load_dwordx4 v[88:91], v12, s[4:7], s46 offen offset:2048 sc1
buffer_load_dwordx4 v[92:95], v12, s[4:7], s46 offen offset:3072 sc1
s_xor_b32 s49, s49, 512
buffer_load_dword v8, v2, s[4:7], s49 offen sc1
k_nr_100:
s_nop 2
v_permlane32_swap_b32 v24, v28
v_permlane32_swap_b32 v25, v29
v_permlane32_swap_b32 v26, v30
v_permlane32_swap_b32 v27, v31
v_add_f32 v24, v24, v28
ds_write_b32 v3, v24 offset:0
v_add_f32 v25, v25, v29
ds_write_b32 v3, v25 offset:144
v_add_f32 v26, v26, v30
ds_write_b32 v3, v26 offset:288
v_add_f32 v27, v27, v31
ds_write_b32 v3, v27 offset:432
v_add_u32 v3, s56, v3
s_waitcnt lgkmcnt(0)
s_barrier
s_cmp_lg_u32 s3, 0
s_cbranch_scc1 k_ne_101
ds_read_b128 v[96:99], v4 offset:0
ds_read_b128 v[100:103], v4 offset:1152
ds_read_b128 v[104:107], v4 offset:2304
ds_read_b128 v[108:111], v4 offset:3456
v_add_u32 v4, s56, v4
s_waitcnt lgkmcnt(3)
v_add_f32 v16, v16, v96
v_add_f32 v17, v17, v97
v_add_f32 v18, v18, v98
v_add_f32 v19, v19, v99
s_waitcnt lgkmcnt(2)
v_add_f32 v16, v16, v100
v_add_f32 v17, v17, v101
v_add_f32 v18, v18, v102
v_add_f32 v19, v19, v103
s_waitcnt lgkmcnt(1)
v_add_f32 v16, v16, v104
v_add_f32 v17, v17, v105
v_add_f32 v18, v18, v106
v_add_f32 v19, v19, v107
s_waitcnt lgkmcnt(0)
v_add_f32 v16, v16, v108
v_add_f32 v17, v17, v109
v_add_f32 v18, v18, v110
v_add_f32 v19, v19, v111
v_cvt_pk_bf16_f32 v96, v16, v17
v_cvt_pk_bf16_f32 v97, v18, v19
buffer_store_dwordx2 v[96:97], v6, s[4:7], s45 offen sc1
v_mul_f32 v17, v9, v17
v_mul_f32 v16, v16, v16
v_fmac_f32 v16, v17, v17
v_fmac_f32 v16, v18, v18
v_fmac_f32 v16, v19, v19
s_nop 1
v_add_f32_dpp v16, v16, v16 quad_perm:[1,0,3,2] row_mask:0xf bank_mask:0xf
s_nop 1
v_add_f32_dpp v16, v16, v16 quad_perm:[2,3,0,1] row_mask:0xf bank_mask:0xf
s_nop 1
v_add_f32_dpp v16, v16, v16 row_half_mirror row_mask:0xf bank_mask:0xf
buffer_store_dword v16, v7, s[4:7], s48 offen sc1
s_add_u32 s45, s45, 512
s_add_u32 s48, s48, 2560
s_cmp_eq_u32 s50, 65
s_cbranch_scc0 k_ne_101
s_add_u32 s45, s45, 3112960
s_add_u32 s48, s48, 884736
k_ne_101:
s_sub_u32 s56, 0, s56
s_cmp_eq_u32 s47, 1
s_cbranch_scc1 k_top_97
s_cmp_le_u32 s50, 128
s_cbranch_scc1 k_poll_98
s_waitcnt vmcnt(0) lgkmcnt(0)
s_barrier
k_fin_7:
s_mul_i32 s57, s30, 52429
s_lshr_b32 s57, s57, 18
s_mul_i32 s52, s57, 5
s_sub_u32 s58, s30, s52
s_lshl_b32 s58, s58, 2
s_add_u32 s58, s58, s3
s_mul_i32 s53, s58, 40960
s_add_u32 s53, s53, 214958080
s_load_dwordx2 s[36:37], s[0:1], 80
s_mov_b32 s38, 2621440
s_mov_b32 s39, 0x20000
buffer_load_dwordx4 v[96:99], v0, s[4:7], s53 offen offset:0 sc1
buffer_load_dwordx4 v[100:103], v0, s[4:7], s53 offen offset:1024 sc1
buffer_load_dwordx4 v[104:107], v0, s[4:7], s53 offen offset:2048 sc1
buffer_load_dwordx4 v[108:111], v0, s[4:7], s53 offen offset:3072 sc1
s_add_u32 s53, s53, 4096
buffer_load_dwordx4 v[112:115], v0, s[4:7], s53 offen offset:0 sc1
buffer_load_dwordx4 v[116:119], v0, s[4:7], s53 offen offset:1024 sc1
buffer_load_dwordx4 v[120:123], v0, s[4:7], s53 offen offset:2048 sc1
buffer_load_dwordx4 v[124:127], v0, s[4:7], s53 offen offset:3072 sc1
s_add_u32 s53, s53, 4096
buffer_load_dwordx4 v[128:131], v0, s[4:7], s53 offen offset:0 sc1
buffer_load_dwordx4 v[132:135], v0, s[4:7], s53 offen offset:1024 sc1
buffer_load_dwordx4 v[136:139], v0, s[4:7], s53 offen offset:2048 sc1
buffer_load_dwordx4 v[140:143], v0, s[4:7], s53 offen offset:3072 sc1
s_add_u32 s53, s53, 4096
buffer_load_dwordx4 v[144:147], v0, s[4:7], s53 offen offset:0 sc1
buffer_load_dwordx4 v[148:151], v0, s[4:7], s53 offen offset:1024 sc1
buffer_load_dwordx4 v[152:155], v0, s[4:7], s53 offen offset:2048 sc1
buffer_load_dwordx4 v[156:159], v0, s[4:7], s53 offen offset:3072 sc1
s_add_u32 s53, s53, 4096
buffer_load_dwordx4 v[160:163], v0, s[4:7], s53 offen offset:0 sc1
buffer_load_dwordx4 v[164:167], v0, s[4:7], s53 offen offset:1024 sc1
buffer_load_dwordx4 v[168:171], v0, s[4:7], s53 offen offset:2048 sc1
buffer_load_dwordx4 v[172:175], v0, s[4:7], s53 offen offset:3072 sc1
s_add_u32 s53, s53, 4096
buffer_load_dwordx4 v[176:179], v0, s[4:7], s53 offen offset:0 sc1
buffer_load_dwordx4 v[180:183], v0, s[4:7], s53 offen offset:1024 sc1
buffer_load_dwordx4 v[184:187], v0, s[4:7], s53 offen offset:2048 sc1
buffer_load_dwordx4 v[188:191], v0, s[4:7], s53 offen offset:3072 sc1
s_add_u32 s53, s53, 4096
buffer_load_dwordx4 v[192:195], v0, s[4:7], s53 offen offset:0 sc1
buffer_load_dwordx4 v[196:199], v0, s[4:7], s53 offen offset:1024 sc1
buffer_load_dwordx4 v[200:203], v0, s[4:7], s53 offen offset:2048 sc1
buffer_load_dwordx4 v[204:207], v0, s[4:7], s53 offen offset:3072 sc1
s_add_u32 s53, s53, 4096
buffer_load_dwordx4 v[208:211], v0, s[4:7], s53 offen offset:0 sc1
buffer_load_dwordx4 v[212:215], v0, s[4:7], s53 offen offset:1024 sc1
buffer_load_dwordx4 v[216:219], v0, s[4:7], s53 offen offset:2048 sc1
buffer_load_dwordx4 v[220:223], v0, s[4:7], s53 offen offset:3072 sc1
s_add_u32 s53, s53, 4096
buffer_load_dwordx4 v[224:227], v0, s[4:7], s53 offen offset:0 sc1
buffer_load_dwordx4 v[228:231], v0, s[4:7], s53 offen offset:1024 sc1
buffer_load_dwordx4 v[232:235], v0, s[4:7], s53 offen offset:2048 sc1
buffer_load_dwordx4 v[236:239], v0, s[4:7], s53 offen offset:3072 sc1
s_add_u32 s53, s53, 4096
buffer_load_dwordx4 v[240:243], v0, s[4:7], s53 offen offset:0 sc1
buffer_load_dwordx4 v[244:247], v0, s[4:7], s53 offen offset:1024 sc1
buffer_load_dwordx4 v[248:251], v0, s[4:7], s53 offen offset:2048 sc1
buffer_load_dwordx4 v[252:255], v0, s[4:7], s53 offen offset:3072 sc1
s_mul_i32 s48, s57, 40960
s_mul_i32 s52, s3, 10240
s_add_u32 s46, s48, s52
s_add_u32 s46, s46, 201326592
s_lshl_b32 s58, s58, 6
s_add_u32 s48, s48, s58
v_bfe_u32 v1, v0, 4, 5
v_mul_u32_u24 v1, 1280, v1
v_lshrrev_b32 v2, 9, v0
v_lshl_add_u32 v1, v2, 5, v1
s_mov_b32 s49, 1310720
s_mov_b32 s54, 222314496
s_waitcnt vmcnt(0) lgkmcnt(0)
s_cmp_lg_u32 s3, 0
s_cbranch_scc1 k_w8d_105
v_lshlrev_b32 v2, 2, v0
k_w8_104:
buffer_load_dword v3, v2, s[4:7], s54 offen sc1
buffer_load_dword v4, v2, s[4:7], s54 offen offset:1024 sc1
s_waitcnt vmcnt(0)
v_and_b32 v3, v3, v4
v_cmp_eq_u32 vcc, 0, v3
s_cbranch_vccz k_w8d_105
s_sleep 1
s_sub_u32 s32, s32, 1
s_cmp_gt_i32 s32, 0
s_cbranch_scc1 k_w8_104
k_w8d_105:
s_barrier
s_mul_i32 s45, s3, 10240
s_mov_b32 s44, 0
v_mov_b32 v64, v0
s_add_u32 m0, s45, 0
s_add_u32 s55, s46, 0
buffer_load_dwordx4 v0, s[4:7], s55 offen offset:0 sc1 lds
buffer_load_dwordx4 v0, s[4:7], s55 offen offset:1024 sc1 lds
buffer_load_dwordx4 v0, s[4:7], s55 offen offset:2048 sc1 lds
buffer_load_dwordx4 v0, s[4:7], s55 offen offset:3072 sc1 lds
s_add_u32 m0, s45, 4096
s_add_u32 s55, s46, 4096
buffer_load_dwordx4 v0, s[4:7], s55 offen offset:0 sc1 lds
buffer_load_dwordx4 v0, s[4:7], s55 offen offset:1024 sc1 lds
buffer_load_dwordx4 v0, s[4:7], s55 offen offset:2048 sc1 lds
buffer_load_dwordx4 v0, s[4:7], s55 offen offset:3072 sc1 lds
s_add_u32 m0, s45, 8192
s_add_u32 s55, s46, 8192
buffer_load_dwordx4 v0, s[4:7], s55 offen offset:0 sc1 lds
buffer_load_dwordx4 v0, s[4:7], s55 offen offset:1024 sc1 lds
s_add_u32 s45, s45, 40960
s_cmp_ge_u32 s45, 122880
s_cselect_b32 s55, 122880, 0
s_sub_u32 s45, s45, s55
s_add_u32 s46, s46, s49
s_mov_b32 s49, 0
s_add_u32 m0, s45, 0
s_add_u32 s55, s46, 0
buffer_load_dwordx4 v0, s[4:7], s55 offen offset:0 sc1 lds
buffer_load_dwordx4 v0, s[4:7], s55 offen offset:1024 sc1 lds
buffer_load_dwordx4 v0, s[4:7], s55 offen offset:2048 sc1 lds
buffer_load_dwordx4 v0, s[4:7], s55 offen offset:3072 sc1 lds
s_add_u32 m0, s45, 4096
s_add_u32 s55, s46, 4096
buffer_load_dwordx4 v0, s[4:7], s55 offen offset:0 sc1 lds
buffer_load_dwordx4 v0, s[4:7], s55 offen offset:1024 sc1 lds
buffer_load_dwordx4 v0, s[4:7], s55 offen offset:2048 sc1 lds
buffer_load_dwordx4 v0, s[4:7], s55 offen offset:3072 sc1 lds
s_add_u32 m0, s45, 8192
s_add_u32 s55, s46, 8192
buffer_load_dwordx4 v0, s[4:7], s55 offen offset:0 sc1 lds
buffer_load_dwordx4 v0, s[4:7], s55 offen offset:1024 sc1 lds
s_add_u32 s45, s45, 40960
s_cmp_ge_u32 s45, 122880
s_cselect_b32 s55, 122880, 0
s_sub_u32 s45, s45, s55
s_add_u32 s46, s46, s49
s_mov_b32 s49, 0
s_waitcnt vmcnt(10)
s_barrier
ds_read_b128 v[8:11], v64 offset:0
ds_read_b128 v[12:15], v64 offset:1024
ds_read_b128 v[16:19], v64 offset:2048
ds_read_b128 v[20:23], v64 offset:3072
s_mov_b32 s59, 1
s_waitcnt lgkmcnt(3)
v_mfma_f32_32x32x16_bf16 v[32:47], v[96:99], v[8:11], 0
s_waitcnt lgkmcnt(2)
ds_read_b128 v[24:27], v64 offset:4096
v_mfma_f32_32x32x16_bf16 v[32:47], v[100:103], v[12:15], v[32:47]
s_waitcnt lgkmcnt(2)
ds_read_b128 v[8:11], v64 offset:5120
s_add_u32 m0, s45, 0
s_add_u32 s55, s46, 0
buffer_load_dwordx4 v0, s[4:7], s55 offen offset:0 sc1 lds
buffer_load_dwordx4 v0, s[4:7], s55 offen offset:1024 sc1 lds
v_mfma_f32_32x32x16_bf16 v[32:47], v[104:107], v[16:19], v[32:47]
s_waitcnt lgkmcnt(2)
ds_read_b128 v[12:15], v64 offset:6144
buffer_load_dwordx4 v0, s[4:7], s55 offen offset:2048 sc1 lds
buffer_load_dwordx4 v0, s[4:7], s55 offen offset:3072 sc1 lds
v_mfma_f32_32x32x16_bf16 v[32:47], v[108:111], v[20:23], v[32:47]
s_waitcnt lgkmcnt(2)
ds_read_b128 v[16:19], v64 offset:7168
s_add_u32 m0, s45, 4096
s_add_u32 s55, s46, 4096
buffer_load_dwordx4 v0, s[4:7], s55 offen offset:0 sc1 lds
buffer_load_dwordx4 v0, s[4:7], s55 offen offset:1024 sc1 lds
v_mfma_f32_32x32x16_bf16 v[32:47], v[112:115], v[24:27], v[32:47]
s_waitcnt lgkmcnt(2)
ds_read_b128 v[20:23], v64 offset:8192
buffer_load_dwordx4 v0, s[4:7], s55 offen offset:2048 sc1 lds
buffer_load_dwordx4 v0, s[4:7], s55 offen offset:3072 sc1 lds
v_mfma_f32_32x32x16_bf16 v[32:47], v[116:119], v[8:11], v[32:47]
s_waitcnt lgkmcnt(2)
ds_read_b128 v[24:27], v64 offset:9216
s_add_u32 m0, s45, 8192
s_add_u32 s55, s46, 8192
buffer_load_dwordx4 v0, s[4:7], s55 offen offset:0 sc1 lds
buffer_load_dwordx4 v0, s[4:7], s55 offen offset:1024 sc1 lds
v_mfma_f32_32x32x16_bf16 v[32:47], v[120:123], v[12:15], v[32:47]
s_waitcnt lgkmcnt(2)
ds_read_b128 v[8:11], v64 offset:10240
s_add_u32 s45, s45, 40960
s_cmp_ge_u32 s45, 122880
s_cselect_b32 s55, 122880, 0
s_sub_u32 s45, s45, s55
s_add_u32 s46, s46, s49
s_mov_b32 s49, 0
v_mfma_f32_32x32x16_bf16 v[32:47], v[124:127], v[16:19], v[32:47]
s_waitcnt lgkmcnt(2)
ds_read_b128 v[12:15], v64 offset:11264
v_mfma_f32_32x32x16_bf16 v[32:47], v[128:131], v[20:23], v[32:47]
s_waitcnt lgkmcnt(2)
ds_read_b128 v[16:19], v64 offset:12288
v_mfma_f32_32x32x16_bf16 v[32:47], v[132:135], v[24:27], v[32:47]
s_waitcnt lgkmcnt(2)
ds_read_b128 v[20:23], v64 offset:13312
v_mfma_f32_32x32x16_bf16 v[32:47], v[136:139], v[8:11], v[32:47]
s_waitcnt lgkmcnt(2)
ds_read_b128 v[24:27], v64 offset:14336
v_mfma_f32_32x32x16_bf16 v[32:47], v[140:143], v[12:15], v[32:47]
s_waitcnt lgkmcnt(2)
ds_read_b128 v[8:11], v64 offset:15360
v_mfma_f32_32x32x16_bf16 v[32:47], v[144:147], v[16:19], v[32:47]
s_waitcnt lgkmcnt(2)
ds_read_b128 v[12:15], v64 offset:16384
v_mfma_f32_32x32x16_bf16 v[32:47], v[148:151], v[20:23], v[32:47]
s_waitcnt lgkmcnt(2)
ds_read_b128 v[16:19], v64 offset:17408
v_mfma_f32_32x32x16_bf16 v[32:47], v[152:155], v[24:27], v[32:47]
s_waitcnt lgkmcnt(2)
ds_read_b128 v[20:23], v64 offset:18432
v_mfma_f32_32x32x16_bf16 v[32:47], v[156:159], v[8:11], v[32:47]
s_waitcnt lgkmcnt(2)
ds_read_b128 v[24:27], v64 offset:19456
v_mfma_f32_32x32x16_bf16 v[32:47], v[160:163], v[12:15], v[32:47]
s_waitcnt lgkmcnt(2)
ds_read_b128 v[8:11], v64 offset:20480
v_mfma_f32_32x32x16_bf16 v[32:47], v[164:167], v[16:19], v[32:47]
s_waitcnt lgkmcnt(2)
ds_read_b128 v[12:15], v64 offset:21504
v_mfma_f32_32x32x16_bf16 v[32:47], v[168:171], v[20:23], v[32:47]
s_waitcnt lgkmcnt(2)
ds_read_b128 v[16:19], v64 offset:22528
v_mfma_f32_32x32x16_bf16 v[32:47], v[172:175], v[24:27], v[32:47]
s_waitcnt lgkmcnt(2)
ds_read_b128 v[20:23], v64 offset:23552
v_mfma_f32_32x32x16_bf16 v[32:47], v[176:179], v[8:11], v[32:47]
s_waitcnt lgkmcnt(2)
ds_read_b128 v[24:27], v64 offset:24576
v_mfma_f32_32x32x16_bf16 v[32:47], v[180:183], v[12:15], v[32:47]
s_waitcnt lgkmcnt(2)
ds_read_b128 v[8:11], v64 offset:25600
v_mfma_f32_32x32x16_bf16 v[32:47], v[184:187], v[16:19], v[32:47]
s_waitcnt lgkmcnt(2)
ds_read_b128 v[12:15], v64 offset:26624
v_mfma_f32_32x32x16_bf16 v[32:47], v[188:191], v[20:23], v[32:47]
s_waitcnt lgkmcnt(2)
ds_read_b128 v[16:19], v64 offset:27648
v_mfma_f32_32x32x16_bf16 v[32:47], v[192:195], v[24:27], v[32:47]
s_waitcnt lgkmcnt(2)
ds_read_b128 v[20:23], v64 offset:28672
v_mfma_f32_32x32x16_bf16 v[32:47], v[196:199], v[8:11], v[32:47]
s_waitcnt lgkmcnt(2)
ds_read_b128 v[24:27], v64 offset:29696
v_mfma_f32_32x32x16_bf16 v[32:47], v[200:203], v[12:15], v[32:47]
s_waitcnt lgkmcnt(2)
ds_read_b128 v[8:11], v64 offset:30720
v_mfma_f32_32x32x16_bf16 v[32:47], v[204:207], v[16:19], v[32:47]
s_waitcnt lgkmcnt(2)
ds_read_b128 v[12:15], v64 offset:31744
v_mfma_f32_32x32x16_bf16 v[32:47], v[208:211], v[20:23], v[32:47]
s_waitcnt lgkmcnt(2)
ds_read_b128 v[16:19], v64 offset:32768
v_mfma_f32_32x32x16_bf16 v[32:47], v[212:215], v[24:27], v[32:47]
s_waitcnt lgkmcnt(2)
ds_read_b128 v[20:23], v64 offset:33792
v_mfma_f32_32x32x16_bf16 v[32:47], v[216:219], v[8:11], v[32:47]
s_waitcnt lgkmcnt(2)
ds_read_b128 v[24:27], v64 offset:34816
v_mfma_f32_32x32x16_bf16 v[32:47], v[220:223], v[12:15], v[32:47]
s_waitcnt lgkmcnt(2)
ds_read_b128 v[8:11], v64 offset:35840
v_mfma_f32_32x32x16_bf16 v[32:47], v[224:227], v[16:19], v[32:47]
s_waitcnt lgkmcnt(2)
ds_read_b128 v[12:15], v64 offset:36864
v_mfma_f32_32x32x16_bf16 v[32:47], v[228:231], v[20:23], v[32:47]
s_waitcnt lgkmcnt(2)
ds_read_b128 v[16:19], v64 offset:37888
v_mfma_f32_32x32x16_bf16 v[32:47], v[232:235], v[24:27], v[32:47]
s_waitcnt lgkmcnt(2)
ds_read_b128 v[20:23], v64 offset:38912
v_mfma_f32_32x32x16_bf16 v[32:47], v[236:239], v[8:11], v[32:47]
s_waitcnt lgkmcnt(2)
ds_read_b128 v[24:27], v64 offset:39936
v_mfma_f32_32x32x16_bf16 v[32:47], v[240:243], v[12:15], v[32:47]
s_add_u32 s44, s44, 1
s_cmp_eq_u32 s44, 3
s_mov_b32 s56, 40960
s_cmov_b32 s56, -81920
s_cselect_b32 s44, 0, s44
v_add_u32 v64, s56, v64
s_waitcnt vmcnt(10) lgkmcnt(2)
s_barrier
ds_read_b128 v[8:11], v64 offset:0
v_mfma_f32_32x32x16_bf16 v[32:47], v[244:247], v[16:19], v[32:47]
s_waitcnt lgkmcnt(2)
ds_read_b128 v[12:15], v64 offset:1024
v_mfma_f32_32x32x16_bf16 v[32:47], v[248:251], v[20:23], v[32:47]
s_waitcnt lgkmcnt(2)
ds_read_b128 v[16:19], v64 offset:2048
v_mfma_f32_32x32x16_bf16 v[32:47], v[252:255], v[24:27], v[32:47]
s_waitcnt lgkmcnt(2)
ds_read_b128 v[20:23], v64 offset:3072
k_st_106:
v_mfma_f32_32x32x16_bf16 v[48:63], v[96:99], v[8:11], 0
s_waitcnt lgkmcnt(2)
ds_read_b128 v[24:27], v64 offset:4096
v_mfma_f32_32x32x16_bf16 v[48:63], v[100:103], v[12:15], v[48:63]
s_waitcnt lgkmcnt(2)
ds_read_b128 v[8:11], v64 offset:5120
v_cvt_pk_bf16_f32 v32, v32, v33
v_cvt_pk_bf16_f32 v33, v34, v35
v_mfma_f32_32x32x16_bf16 v[48:63], v[104:107], v[16:19], v[48:63]
s_waitcnt lgkmcnt(2)
ds_read_b128 v[12:15], v64 offset:6144
v_cvt_pk_bf16_f32 v34, v36, v37
v_cvt_pk_bf16_f32 v35, v38, v39
v_mfma_f32_32x32x16_bf16 v[48:63], v[108:111], v[20:23], v[48:63]
s_waitcnt lgkmcnt(2)
ds_read_b128 v[16:19], v64 offset:7168
v_cvt_pk_bf16_f32 v36, v40, v41
v_cvt_pk_bf16_f32 v37, v42, v43
v_mfma_f32_32x32x16_bf16 v[48:63], v[112:115], v[24:27], v[48:63]
s_waitcnt lgkmcnt(2)
ds_read_b128 v[20:23], v64 offset:8192
v_cvt_pk_bf16_f32 v38, v44, v45
v_cvt_pk_bf16_f32 v39, v46, v47
v_mfma_f32_32x32x16_bf16 v[48:63], v[116:119], v[8:11], v[48:63]
s_waitcnt lgkmcnt(2)
ds_read_b128 v[24:27], v64 offset:9216
buffer_store_dwordx4 v[32:35], v1, s[36:39], s48 offen offset:0
buffer_store_dwordx4 v[36:39], v1, s[36:39], s48 offen offset:16
v_mfma_f32_32x32x16_bf16 v[48:63], v[120:123], v[12:15], v[48:63]
s_waitcnt lgkmcnt(2)
ds_read_b128 v[8:11], v64 offset:10240
s_add_u32 s48, s48, 1310720
s_add_u32 m0, s45, 0
s_add_u32 s55, s46, 0
buffer_load_dwordx4 v0, s[4:7], s55 offen offset:0 sc1 lds
v_mfma_f32_32x32x16_bf16 v[48:63], v[124:127], v[16:19], v[48:63]
s_waitcnt lgkmcnt(2)
ds_read_b128 v[12:15], v64 offset:11264
buffer_load_dwordx4 v0, s[4:7], s55 offen offset:1024 sc1 lds
buffer_load_dwordx4 v0, s[4:7], s55 offen offset:2048 sc1 lds
v_mfma_f32_32x32x16_bf16 v[48:63], v[128:131], v[20:23], v[48:63]
s_waitcnt lgkmcnt(2)
ds_read_b128 v[16:19], v64 offset:12288
buffer_load_dwordx4 v0, s[4:7], s55 offen offset:3072 sc1 lds
s_add_u32 m0, s45, 4096
s_add_u32 s55, s46, 4096
buffer_load_dwordx4 v0, s[4:7], s55 offen offset:0 sc1 lds
v_mfma_f32_32x32x16_bf16 v[48:63], v[132:135], v[24:27], v[48:63]
s_waitcnt lgkmcnt(2)
ds_read_b128 v[20:23], v64 offset:13312
buffer_load_dwordx4 v0, s[4:7], s55 offen offset:1024 sc1 lds
buffer_load_dwordx4 v0, s[4:7], s55 offen offset:2048 sc1 lds
v_mfma_f32_32x32x16_bf16 v[48:63], v[136:139], v[8:11], v[48:63]
s_waitcnt lgkmcnt(2)
ds_read_b128 v[24:27], v64 offset:14336
buffer_load_dwordx4 v0, s[4:7], s55 offen offset:3072 sc1 lds
s_add_u32 m0, s45, 8192
s_add_u32 s55, s46, 8192
buffer_load_dwordx4 v0, s[4:7], s55 offen offset:0 sc1 lds
v_mfma_f32_32x32x16_bf16 v[48:63], v[140:143], v[12:15], v[48:63]
s_waitcnt lgkmcnt(2)
ds_read_b128 v[8:11], v64 offset:15360
buffer_load_dwordx4 v0, s[4:7], s55 offen offset:1024 sc1 lds
s_add_u32 s45, s45, 40960
s_cmp_ge_u32 s45, 122880
s_cselect_b32 s55, 122880, 0
s_sub_u32 s45, s45, s55
v_mfma_f32_32x32x16_bf16 v[48:63], v[144:147], v[16:19], v[48:63]
s_waitcnt lgkmcnt(2)
ds_read_b128 v[12:15], v64 offset:16384
s_add_u32 s46, s46, s49
s_mov_b32 s49, 0
v_mfma_f32_32x32x16_bf16 v[48:63], v[148:151], v[20:23], v[48:63]
s_waitcnt lgkmcnt(2)
ds_read_b128 v[16:19], v64 offset:17408
v_mfma_f32_32x32x16_bf16 v[48:63], v[152:155], v[24:27], v[48:63]
s_waitcnt lgkmcnt(2)
ds_read_b128 v[20:23], v64 offset:18432
v_mfma_f32_32x32x16_bf16 v[48:63], v[156:159], v[8:11], v[48:63]
s_waitcnt lgkmcnt(2)
ds_read_b128 v[24:27], v64 offset:19456
v_mfma_f32_32x32x16_bf16 v[48:63], v[160:163], v[12:15], v[48:63]
s_waitcnt lgkmcnt(2)
ds_read_b128 v[8:11], v64 offset:20480
v_mfma_f32_32x32x16_bf16 v[48:63], v[164:167], v[16:19], v[48:63]
s_waitcnt lgkmcnt(2)
ds_read_b128 v[12:15], v64 offset:21504
v_mfma_f32_32x32x16_bf16 v[48:63], v[168:171], v[20:23], v[48:63]
s_waitcnt lgkmcnt(2)
ds_read_b128 v[16:19], v64 offset:22528
v_mfma_f32_32x32x16_bf16 v[48:63], v[172:175], v[24:27], v[48:63]
s_waitcnt lgkmcnt(2)
ds_read_b128 v[20:23], v64 offset:23552
v_mfma_f32_32x32x16_bf16 v[48:63], v[176:179], v[8:11], v[48:63]
s_waitcnt lgkmcnt(2)
ds_read_b128 v[24:27], v64 offset:24576
v_mfma_f32_32x32x16_bf16 v[48:63], v[180:183], v[12:15], v[48:63]
s_waitcnt lgkmcnt(2)
ds_read_b128 v[8:11], v64 offset:25600
v_mfma_f32_32x32x16_bf16 v[48:63], v[184:187], v[16:19], v[48:63]
s_waitcnt lgkmcnt(2)
ds_read_b128 v[12:15], v64 offset:26624
v_mfma_f32_32x32x16_bf16 v[48:63], v[188:191], v[20:23], v[48:63]
s_waitcnt lgkmcnt(2)
ds_read_b128 v[16:19], v64 offset:27648
v_mfma_f32_32x32x16_bf16 v[48:63], v[192:195], v[24:27], v[48:63]
s_waitcnt lgkmcnt(2)
ds_read_b128 v[20:23], v64 offset:28672
v_mfma_f32_32x32x16_bf16 v[48:63], v[196:199], v[8:11], v[48:63]
s_waitcnt lgkmcnt(2)
ds_read_b128 v[24:27], v64 offset:29696
v_mfma_f32_32x32x16_bf16 v[48:63], v[200:203], v[12:15], v[48:63]
s_waitcnt lgkmcnt(2)
ds_read_b128 v[8:11], v64 offset:30720
v_mfma_f32_32x32x16_bf16 v[48:63], v[204:207], v[16:19], v[48:63]
s_waitcnt lgkmcnt(2)
ds_read_b128 v[12:15], v64 offset:31744
v_mfma_f32_32x32x16_bf16 v[48:63], v[208:211], v[20:23], v[48:63]
s_waitcnt lgkmcnt(2)
ds_read_b128 v[16:19], v64 offset:32768
v_mfma_f32_32x32x16_bf16 v[48:63], v[212:215], v[24:27], v[48:63]
s_waitcnt lgkmcnt(2)
ds_read_b128 v[20:23], v64 offset:33792
v_mfma_f32_32x32x16_bf16 v[48:63], v[216:219], v[8:11], v[48:63]
s_waitcnt lgkmcnt(2)
ds_read_b128 v[24:27], v64 offset:34816
v_mfma_f32_32x32x16_bf16 v[48:63], v[220:223], v[12:15], v[48:63]
s_waitcnt lgkmcnt(2)
ds_read_b128 v[8:11], v64 offset:35840
v_mfma_f32_32x32x16_bf16 v[48:63], v[224:227], v[16:19], v[48:63]
s_waitcnt lgkmcnt(2)
ds_read_b128 v[12:15], v64 offset:36864
v_mfma_f32_32x32x16_bf16 v[48:63], v[228:231], v[20:23], v[48:63]
s_waitcnt lgkmcnt(2)
ds_read_b128 v[16:19], v64 offset:37888
v_mfma_f32_32x32x16_bf16 v[48:63], v[232:235], v[24:27], v[48:63]
s_waitcnt lgkmcnt(2)
ds_read_b128 v[20:23], v64 offset:38912
v_mfma_f32_32x32x16_bf16 v[48:63], v[236:239], v[8:11], v[48:63]
s_waitcnt lgkmcnt(2)
ds_read_b128 v[24:27], v64 offset:39936
v_mfma_f32_32x32x16_bf16 v[48:63], v[240:243], v[12:15], v[48:63]
s_add_u32 s44, s44, 1
s_cmp_eq_u32 s44, 3
s_mov_b32 s56, 40960
s_cmov_b32 s56, -81920
s_cselect_b32 s44, 0, s44
v_add_u32 v64, s56, v64
s_waitcnt vmcnt(10) lgkmcnt(2)
s_barrier
ds_read_b128 v[8:11], v64 offset:0
v_mfma_f32_32x32x16_bf16 v[48:63], v[244:247], v[16:19], v[48:63]
s_waitcnt lgkmcnt(2)
ds_read_b128 v[12:15], v64 offset:1024
v_mfma_f32_32x32x16_bf16 v[48:63], v[248:251], v[20:23], v[48:63]
s_waitcnt lgkmcnt(2)
ds_read_b128 v[16:19], v64 offset:2048
v_mfma_f32_32x32x16_bf16 v[48:63], v[252:255], v[24:27], v[48:63]
s_waitcnt lgkmcnt(2)
ds_read_b128 v[20:23], v64 offset:3072
s_nop 9
v_cvt_pk_bf16_f32 v48, v48, v49
v_cvt_pk_bf16_f32 v49, v50, v51
v_cvt_pk_bf16_f32 v50, v52, v53
v_cvt_pk_bf16_f32 v51, v54, v55
v_cvt_pk_bf16_f32 v52, v56, v57
v_cvt_pk_bf16_f32 v53, v58, v59
v_cvt_pk_bf16_f32 v54, v60, v61
v_cvt_pk_bf16_f32 v55, v62, v63
buffer_store_dwordx4 v[48:51], v1, s[36:39], s48 offen offset:0
buffer_store_dwordx4 v[52:55], v1, s[36:39], s48 offen offset:16
s_add_u32 s48, s48, 1310720
s_waitcnt vmcnt(0)
s_endpgm
k_team_3:
s_cmp_eq_u32 s3, 1
s_cbranch_scc1 k_w1_109
s_cmp_eq_u32 s3, 2
s_cbranch_scc1 k_w2_110
s_cmp_eq_u32 s3, 3
s_cbranch_scc1 k_w3_111
k_w0_108:
v_lshrrev_b32 v12, 3, v0
v_lshlrev_b32 v10, 13, v12
v_bfe_u32 v12, v0, 1, 2
v_lshrrev_b32 v13, 4, v0
v_xor_b32 v12, v12, v13
v_lshl_add_u32 v10, v12, 5, v10
v_and_b32 v14, 1, v0
v_lshl_add_u32 v10, v14, 4, v10
v_mul_u32_u24 v11, 1280, v13
v_bfe_u32 v12, v0, 1, 3
v_and_b32 v13, 1, v13
v_lshlrev_b32 v13, 1, v13
v_xor_b32 v12, v12, v13
v_xor_b32 v12, 0, v12
v_lshl_add_u32 v11, v12, 5, v11
v_lshl_add_u32 v11, v14, 4, v11
v_bfe_u32 v12, v0, 5, 1
v_lshlrev_b32 v12, 4, v12
v_bfe_u32 v13, v0, 4, 1
v_lshl_add_u32 v12, v13, 1, v12
v_bfe_u32 v13, v0, 2, 1
v_lshl_add_u32 v12, v13, 2, v12
v_bfe_u32 v13, v0, 3, 1
v_mul_u32_u24 v15, 4224, v13
v_add_u32 v12, v13, v12
v_bfe_u32 v13, v12, 1, 2
v_xor_b32 v13, 0, v13
v_lshlrev_b32 v13, 5, v13
v_lshl_add_u32 v4, v12, 7, v13
v_and_b32 v14, 3, v0
v_lshl_add_u32 v4, v14, 3, v4
v_add_u32 v5, 0x10000, v4
v_add_u32 v6, 0x20000, v4
v_bfe_u32 v12, v0, 4, 1
v_lshlrev_b32 v13, 4, v12
v_lshlrev_b32 v12, 2, v12
v_bfe_u32 v8, v0, 5, 1
v_lshl_add_u32 v13, v8, 2, v13
v_bfe_u32 v8, v0, 2, 1
v_add_u32 v13, v8, v13
v_lshl_add_u32 v12, v8, 1, v12
v_bfe_u32 v8, v0, 3, 1
v_add_u32 v8, 0, v8
v_xor_b32 v12, v12, v8
v_lshlrev_b32 v12, 5, v12
v_lshl_add_u32 v7, v13, 8, v12
v_lshl_add_u32 v7, v14, 3, v7
v_add_u32 v8, 0x10000, v7
v_add_u32 v9, 0x20000, v7
v_lshlrev_b32 v0, 4, v0
v_add_u32 v2, 98304, v0
s_lshl_b32 s49, s30, 8
s_mul_i32 s50, s30, 163840
s_mul_i32 s60, s30, 131072
s_add_u32 s60, s60, 120586240
s_add_u32 s61, s60, 4096
s_add_u32 s62, s60, 8192
s_mov_b32 m0, 0
s_add_u32 s48, s49, 0
buffer_load_dwordx4 v10, s[8:11], s48 offen lds
s_mov_b32 m0, 1024
s_add_u32 s48, s49, 65536
buffer_load_dwordx4 v10, s[8:11], s48 offen lds
s_mov_b32 m0, 8192
s_add_u32 s48, s49, 128
buffer_load_dwordx4 v10, s[12:15], s48 offen lds
s_mov_b32 m0, 9216
s_add_u32 s48, s49, 65664
buffer_load_dwordx4 v10, s[12:15], s48 offen lds
s_mov_b32 m0, 16384
s_add_u32 s48, s49, 0
buffer_load_dwordx4 v10, s[16:19], s48 offen lds
s_mov_b32 m0, 17408
s_add_u32 s48, s49, 65536
buffer_load_dwordx4 v10, s[16:19], s48 offen lds
s_mov_b32 m0, 24576
s_add_u32 s48, s49, 128
buffer_load_dwordx4 v10, s[16:19], s48 offen lds
s_mov_b32 m0, 25600
s_add_u32 s48, s49, 65664
buffer_load_dwordx4 v10, s[16:19], s48 offen lds
s_mov_b32 m0, 32768
s_add_u32 s48, s49, 524288
buffer_load_dwordx4 v10, s[8:11], s48 offen lds
s_mov_b32 m0, 33792
s_add_u32 s48, s49, 589824
buffer_load_dwordx4 v10, s[8:11], s48 offen lds
s_mov_b32 m0, 40960
s_add_u32 s48, s49, 524416
buffer_load_dwordx4 v10, s[12:15], s48 offen lds
s_mov_b32 m0, 41984
s_add_u32 s48, s49, 589952
buffer_load_dwordx4 v10, s[12:15], s48 offen lds
s_mov_b32 m0, 49152
s_add_u32 s48, s49, 524288
buffer_load_dwordx4 v10, s[16:19], s48 offen lds
s_mov_b32 m0, 50176
s_add_u32 s48, s49, 589824
buffer_load_dwordx4 v10, s[16:19], s48 offen lds
s_mov_b32 m0, 57344
s_add_u32 s48, s49, 524416
buffer_load_dwordx4 v10, s[16:19], s48 offen lds
s_mov_b32 m0, 58368
s_add_u32 s48, s49, 589952
buffer_load_dwordx4 v10, s[16:19], s48 offen lds
s_mov_b32 m0, 65536
s_add_u32 s48, s49, 1048576
buffer_load_dwordx4 v10, s[8:11], s48 offen lds
s_mov_b32 m0, 66560
s_add_u32 s48, s49, 1114112
buffer_load_dwordx4 v10, s[8:11], s48 offen lds
s_mov_b32 m0, 73728
s_add_u32 s48, s49, 1048704
buffer_load_dwordx4 v10, s[12:15], s48 offen lds
s_mov_b32 m0, 74752
s_add_u32 s48, s49, 1114240
buffer_load_dwordx4 v10, s[12:15], s48 offen lds
s_mov_b32 m0, 81920
s_add_u32 s48, s49, 3145728
buffer_load_dwordx4 v10, s[12:15], s48 offen lds
s_mov_b32 m0, 82944
s_add_u32 s48, s49, 3211264
buffer_load_dwordx4 v10, s[12:15], s48 offen lds
s_mov_b32 m0, 90112
s_add_u32 s48, s49, 3145856
buffer_load_dwordx4 v10, s[12:15], s48 offen lds
s_mov_b32 m0, 91136
s_add_u32 s48, s49, 3211392
buffer_load_dwordx4 v10, s[12:15], s48 offen lds
s_mov_b32 m0, 98304
s_add_u32 s48, s49, 3145728
buffer_load_dwordx4 v10, s[16:19], s48 offen lds
s_mov_b32 m0, 99328
s_add_u32 s48, s49, 3211264
buffer_load_dwordx4 v10, s[16:19], s48 offen lds
s_mov_b32 m0, 106496
s_add_u32 s48, s49, 3145856
buffer_load_dwordx4 v10, s[16:19], s48 offen lds
s_mov_b32 m0, 107520
s_add_u32 s48, s49, 3211392
buffer_load_dwordx4 v10, s[16:19], s48 offen lds
s_mov_b32 m0, 114688
s_add_u32 s48, s49, 1572864
buffer_load_dwordx4 v10, s[8:11], s48 offen lds
s_mov_b32 m0, 115712
s_add_u32 s48, s49, 1638400
buffer_load_dwordx4 v10, s[8:11], s48 offen lds
s_mov_b32 m0, 122880
s_add_u32 s48, s49, 2097152
buffer_load_dwordx4 v10, s[8:11], s48 offen lds
s_mov_b32 m0, 123904
s_add_u32 s48, s49, 2162688
buffer_load_dwordx4 v10, s[8:11], s48 offen lds
s_waitcnt vmcnt(24)
s_barrier
s_mov_b32 m0, 131072
s_add_u32 s48, s49, 2621440
buffer_load_dwordx4 v10, s[8:11], s48 offen lds
s_mov_b32 m0, 132096
s_add_u32 s48, s49, 2686976
buffer_load_dwordx4 v10, s[8:11], s48 offen lds
s_mov_b32 m0, 139264
s_add_u32 s48, s49, 3670016
buffer_load_dwordx4 v10, s[8:11], s48 offen lds
s_mov_b32 m0, 140288
s_add_u32 s48, s49, 3735552
buffer_load_dwordx4 v10, s[8:11], s48 offen lds
s_mov_b32 m0, 147456
s_add_u32 s48, s49, 3670144
buffer_load_dwordx4 v10, s[8:11], s48 offen lds
s_mov_b32 m0, 148480
s_add_u32 s48, s49, 3735680
buffer_load_dwordx4 v10, s[8:11], s48 offen lds
s_mov_b32 m0, 155648
s_add_u32 s48, s49, 4194304
buffer_load_dwordx4 v10, s[8:11], s48 offen lds
s_mov_b32 m0, 156672
s_add_u32 s48, s49, 4259840
buffer_load_dwordx4 v10, s[8:11], s48 offen lds
ds_read_b64_tr_b16 v[16:17], v4 offset:0
ds_read_b64_tr_b16 v[18:19], v4 offset:1024
ds_read_b64_tr_b16 v[20:21], v4 offset:4096
ds_read_b64_tr_b16 v[22:23], v4 offset:5120
ds_read_b64_tr_b16 a[0:1], v4 offset:8192
ds_read_b64_tr_b16 a[2:3], v4 offset:9216
ds_read_b64_tr_b16 a[4:5], v4 offset:12288
ds_read_b64_tr_b16 a[6:7], v4 offset:13312
ds_read_b64_tr_b16 a[8:9], v4 offset:16384
ds_read_b64_tr_b16 a[10:11], v4 offset:17408
ds_read_b64_tr_b16 a[12:13], v4 offset:20480
ds_read_b64_tr_b16 a[14:15], v4 offset:21504
ds_read_b64_tr_b16 a[16:17], v4 offset:24576
ds_read_b64_tr_b16 a[18:19], v4 offset:25600
ds_read_b64_tr_b16 a[20:21], v4 offset:28672
ds_read_b64_tr_b16 a[22:23], v4 offset:29696
s_waitcnt lgkmcnt(0)
buffer_store_dwordx4 v[16:19], v0, s[4:7], s60 offen offset:0
buffer_store_dwordx4 v[20:23], v0, s[4:7], s60 offen offset:1024
s_waitcnt vmcnt(26)
s_barrier
s_mov_b32 m0, 0
s_add_u32 s48, s49, 4194432
buffer_load_dwordx4 v10, s[8:11], s48 offen lds
s_mov_b32 m0, 1024
s_add_u32 s48, s49, 4259968
buffer_load_dwordx4 v10, s[8:11], s48 offen lds
s_mov_b32 m0, 8192
s_add_u32 s48, s49, 4718592
buffer_load_dwordx4 v10, s[8:11], s48 offen lds
s_mov_b32 m0, 9216
s_add_u32 s48, s49, 4784128
buffer_load_dwordx4 v10, s[8:11], s48 offen lds
s_mov_b32 m0, 16384
s_add_u32 s48, s49, 4718720
buffer_load_dwordx4 v10, s[8:11], s48 offen lds
s_mov_b32 m0, 17408
s_add_u32 s48, s49, 4784256
buffer_load_dwordx4 v10, s[8:11], s48 offen lds
s_mov_b32 m0, 24576
s_add_u32 s48, s49, 3670016
buffer_load_dwordx4 v10, s[12:15], s48 offen lds
s_mov_b32 m0, 25600
s_add_u32 s48, s49, 3735552
buffer_load_dwordx4 v10, s[12:15], s48 offen lds
ds_read_b64_tr_b16 a[24:25], v4 offset:32768
ds_read_b64_tr_b16 a[26:27], v4 offset:33792
ds_read_b64_tr_b16 a[28:29], v4 offset:36864
ds_read_b64_tr_b16 a[30:31], v4 offset:37888
ds_read_b64_tr_b16 a[32:33], v4 offset:40960
ds_read_b64_tr_b16 a[34:35], v4 offset:41984
ds_read_b64_tr_b16 a[36:37], v4 offset:45056
ds_read_b64_tr_b16 a[38:39], v4 offset:46080
ds_read_b64_tr_b16 a[40:41], v4 offset:49152
ds_read_b64_tr_b16 a[42:43], v4 offset:50176
ds_read_b64_tr_b16 a[44:45], v4 offset:53248
ds_read_b64_tr_b16 a[46:47], v4 offset:54272
ds_read_b64_tr_b16 a[48:49], v4 offset:57344
ds_read_b64_tr_b16 a[50:51], v4 offset:58368
ds_read_b64_tr_b16 a[52:53], v4 offset:61440
ds_read_b64_tr_b16 a[54:55], v4 offset:62464
s_waitcnt lgkmcnt(0)
s_waitcnt vmcnt(26)
s_barrier
s_mov_b32 m0, 32768
s_add_u32 s48, s49, 3670144
buffer_load_dwordx4 v10, s[12:15], s48 offen lds
s_mov_b32 m0, 33792
s_add_u32 s48, s49, 3735680
buffer_load_dwordx4 v10, s[12:15], s48 offen lds
s_mov_b32 m0, 40960
s_add_u32 s48, s49, 3670016
buffer_load_dwordx4 v10, s[16:19], s48 offen lds
s_mov_b32 m0, 41984
s_add_u32 s48, s49, 3735552
buffer_load_dwordx4 v10, s[16:19], s48 offen lds
s_mov_b32 m0, 49152
s_add_u32 s48, s49, 3670144
buffer_load_dwordx4 v10, s[16:19], s48 offen lds
s_mov_b32 m0, 50176
s_add_u32 s48, s49, 3735680
buffer_load_dwordx4 v10, s[16:19], s48 offen lds
s_mov_b32 m0, 57344
s_add_u32 s48, s49, 4194304
buffer_load_dwordx4 v10, s[12:15], s48 offen lds
s_mov_b32 m0, 58368
s_add_u32 s48, s49, 4259840
buffer_load_dwordx4 v10, s[12:15], s48 offen lds
ds_read_b64_tr_b16 a[56:57], v5 offset:0
ds_read_b64_tr_b16 a[58:59], v5 offset:1024
ds_read_b64_tr_b16 a[60:61], v5 offset:4096
ds_read_b64_tr_b16 a[62:63], v5 offset:5120
ds_read_b64_tr_b16 a[72:73], v5 offset:8192
ds_read_b64_tr_b16 a[74:75], v5 offset:9216
ds_read_b64_tr_b16 a[76:77], v5 offset:12288
ds_read_b64_tr_b16 a[78:79], v5 offset:13312
ds_read_b64_tr_b16 a[152:153], v5 offset:16384
ds_read_b64_tr_b16 a[154:155], v5 offset:17408
ds_read_b64_tr_b16 a[156:157], v5 offset:20480
ds_read_b64_tr_b16 a[158:159], v5 offset:21504
ds_read_b64_tr_b16 a[96:97], v5 offset:24576
ds_read_b64_tr_b16 a[98:99], v5 offset:25600
ds_read_b64_tr_b16 a[100:101], v5 offset:28672
ds_read_b64_tr_b16 a[102:103], v5 offset:29696
s_waitcnt lgkmcnt(0)
s_waitcnt vmcnt(26)
s_barrier
s_mov_b32 m0, 65536
s_add_u32 s48, s49, 4194432
buffer_load_dwordx4 v10, s[12:15], s48 offen lds
s_mov_b32 m0, 66560
s_add_u32 s48, s49, 4259968
buffer_load_dwordx4 v10, s[12:15], s48 offen lds
s_mov_b32 m0, 73728
s_add_u32 s48, s49, 4194304
buffer_load_dwordx4 v10, s[16:19], s48 offen lds
s_mov_b32 m0, 74752
s_add_u32 s48, s49, 4259840
buffer_load_dwordx4 v10, s[16:19], s48 offen lds
s_mov_b32 m0, 81920
s_add_u32 s48, s49, 4194432
buffer_load_dwordx4 v10, s[16:19], s48 offen lds
s_mov_b32 m0, 82944
s_add_u32 s48, s49, 4259968
buffer_load_dwordx4 v10, s[16:19], s48 offen lds
s_mov_b32 m0, 90112
s_add_u32 s48, s49, 4718592
buffer_load_dwordx4 v10, s[12:15], s48 offen lds
s_mov_b32 m0, 91136
s_add_u32 s48, s49, 4784128
buffer_load_dwordx4 v10, s[12:15], s48 offen lds
ds_read_b64_tr_b16 a[104:105], v5 offset:32768
ds_read_b64_tr_b16 a[106:107], v5 offset:33792
ds_read_b64_tr_b16 a[108:109], v5 offset:36864
ds_read_b64_tr_b16 a[110:111], v5 offset:37888
ds_read_b64_tr_b16 a[112:113], v5 offset:40960
ds_read_b64_tr_b16 a[114:115], v5 offset:41984
ds_read_b64_tr_b16 a[116:117], v5 offset:45056
ds_read_b64_tr_b16 a[118:119], v5 offset:46080
ds_read_b64_tr_b16 a[120:121], v5 offset:49152
ds_read_b64_tr_b16 a[122:123], v5 offset:50176
ds_read_b64_tr_b16 a[124:125], v5 offset:53248
ds_read_b64_tr_b16 a[126:127], v5 offset:54272
ds_read_b64_tr_b16 a[128:129], v5 offset:57344
ds_read_b64_tr_b16 a[130:131], v5 offset:58368
ds_read_b64_tr_b16 a[132:133], v5 offset:61440
ds_read_b64_tr_b16 a[134:135], v5 offset:62464
s_waitcnt lgkmcnt(0)
s_waitcnt vmcnt(26)
s_barrier
s_mov_b32 m0, 98304
s_add_u32 s48, s49, 4718720
buffer_load_dwordx4 v10, s[12:15], s48 offen lds
s_mov_b32 m0, 99328
s_add_u32 s48, s49, 4784256
buffer_load_dwordx4 v10, s[12:15], s48 offen lds
s_mov_b32 m0, 106496
s_add_u32 s48, s49, 4718592
buffer_load_dwordx4 v10, s[16:19], s48 offen lds
s_mov_b32 m0, 107520
s_add_u32 s48, s49, 4784128
buffer_load_dwordx4 v10, s[16:19], s48 offen lds
s_mov_b32 m0, 114688
s_add_u32 s48, s49, 4718720
buffer_load_dwordx4 v10, s[16:19], s48 offen lds
s_mov_b32 m0, 115712
s_add_u32 s48, s49, 4784256
buffer_load_dwordx4 v10, s[16:19], s48 offen lds
s_mov_b32 m0, 122880
s_add_u32 s48, s49, 2621440
buffer_load_dwordx4 v10, s[12:15], s48 offen lds
s_mov_b32 m0, 123904
s_add_u32 s48, s49, 2686976
buffer_load_dwordx4 v10, s[12:15], s48 offen lds
ds_read_b64_tr_b16 a[144:145], v6 offset:0
ds_read_b64_tr_b16 a[146:147], v6 offset:1024
ds_read_b64_tr_b16 a[148:149], v6 offset:4096
ds_read_b64_tr_b16 a[150:151], v6 offset:5120
ds_read_b64_tr_b16 v[224:225], v6 offset:8192
ds_read_b64_tr_b16 v[226:227], v6 offset:9216
ds_read_b64_tr_b16 v[228:229], v6 offset:12288
ds_read_b64_tr_b16 v[230:231], v6 offset:13312
ds_read_b64_tr_b16 a[160:161], v6 offset:16384
ds_read_b64_tr_b16 a[162:163], v6 offset:17408
ds_read_b64_tr_b16 a[164:165], v6 offset:20480
ds_read_b64_tr_b16 a[166:167], v6 offset:21504
ds_read_b64_tr_b16 a[168:169], v6 offset:24576
ds_read_b64_tr_b16 a[170:171], v6 offset:25600
ds_read_b64_tr_b16 a[172:173], v6 offset:28672
ds_read_b64_tr_b16 a[174:175], v6 offset:29696
s_waitcnt lgkmcnt(0)
s_waitcnt vmcnt(24)
s_barrier
s_mov_b32 m0, 131072
s_add_u32 s48, s49, 2621568
buffer_load_dwordx4 v10, s[12:15], s48 offen lds
s_mov_b32 m0, 132096
s_add_u32 s48, s49, 2687104
buffer_load_dwordx4 v10, s[12:15], s48 offen lds
s_mov_b32 m0, 139264
s_add_u32 s48, s49, 1572864
buffer_load_dwordx4 v10, s[12:15], s48 offen lds
s_mov_b32 m0, 140288
s_add_u32 s48, s49, 1638400
buffer_load_dwordx4 v10, s[12:15], s48 offen lds
s_mov_b32 m0, 147456
s_add_u32 s48, s49, 1572992
buffer_load_dwordx4 v10, s[12:15], s48 offen lds
s_mov_b32 m0, 148480
s_add_u32 s48, s49, 1638528
buffer_load_dwordx4 v10, s[12:15], s48 offen lds
s_mov_b32 m0, 155648
s_add_u32 s48, s49, 2097152
buffer_load_dwordx4 v10, s[12:15], s48 offen lds
s_mov_b32 m0, 156672
s_add_u32 s48, s49, 2162688
buffer_load_dwordx4 v10, s[12:15], s48 offen lds
ds_read_b64_tr_b16 a[176:177], v4 offset:0
ds_read_b64_tr_b16 a[178:179], v4 offset:1024
ds_read_b64_tr_b16 a[180:181], v4 offset:4096
ds_read_b64_tr_b16 a[182:183], v4 offset:5120
ds_read_b64_tr_b16 a[184:185], v4 offset:8192
ds_read_b64_tr_b16 a[186:187], v4 offset:9216
ds_read_b64_tr_b16 a[188:189], v4 offset:12288
ds_read_b64_tr_b16 a[190:191], v4 offset:13312
ds_read_b64_tr_b16 v[232:233], v4 offset:16384
ds_read_b64_tr_b16 v[234:235], v4 offset:17408
ds_read_b64_tr_b16 v[236:237], v4 offset:20480
ds_read_b64_tr_b16 v[238:239], v4 offset:21504
ds_read_b64_tr_b16 v[40:41], v4 offset:24576
ds_read_b64_tr_b16 v[42:43], v4 offset:25600
ds_read_b64_tr_b16 v[44:45], v4 offset:28672
ds_read_b64_tr_b16 v[46:47], v4 offset:29696
s_waitcnt lgkmcnt(0)
buffer_store_dwordx4 v[40:43], v0, s[4:7], s60 offen offset:2048
buffer_store_dwordx4 v[44:47], v0, s[4:7], s60 offen offset:3072
s_waitcnt vmcnt(26)
s_barrier
s_mov_b32 m0, 0
s_add_u32 s48, s49, 2097280
buffer_load_dwordx4 v10, s[12:15], s48 offen lds
s_mov_b32 m0, 1024
s_add_u32 s48, s49, 2162816
buffer_load_dwordx4 v10, s[12:15], s48 offen lds
s_mov_b32 m0, 8192
s_add_u32 s48, s49, 1572864
buffer_load_dwordx4 v10, s[16:19], s48 offen lds
s_mov_b32 m0, 9216
s_add_u32 s48, s49, 1638400
buffer_load_dwordx4 v10, s[16:19], s48 offen lds
s_mov_b32 m0, 16384
s_add_u32 s48, s49, 1572992
buffer_load_dwordx4 v10, s[16:19], s48 offen lds
s_mov_b32 m0, 17408
s_add_u32 s48, s49, 1638528
buffer_load_dwordx4 v10, s[16:19], s48 offen lds
s_mov_b32 m0, 24576
s_add_u32 s48, s49, 2621440
buffer_load_dwordx4 v10, s[16:19], s48 offen lds
s_mov_b32 m0, 25600
s_add_u32 s48, s49, 2686976
buffer_load_dwordx4 v10, s[16:19], s48 offen lds
ds_read_b64_tr_b16 a[192:193], v4 offset:32768
ds_read_b64_tr_b16 a[194:195], v4 offset:33792
ds_read_b64_tr_b16 a[196:197], v4 offset:36864
ds_read_b64_tr_b16 a[198:199], v4 offset:37888
ds_read_b64_tr_b16 a[200:201], v4 offset:40960
ds_read_b64_tr_b16 a[202:203], v4 offset:41984
ds_read_b64_tr_b16 a[204:205], v4 offset:45056
ds_read_b64_tr_b16 a[206:207], v4 offset:46080
ds_read_b64_tr_b16 a[208:209], v4 offset:49152
ds_read_b64_tr_b16 a[210:211], v4 offset:50176
ds_read_b64_tr_b16 a[212:213], v4 offset:53248
ds_read_b64_tr_b16 a[214:215], v4 offset:54272
ds_read_b64_tr_b16 v[240:241], v4 offset:57344
ds_read_b64_tr_b16 v[242:243], v4 offset:58368
ds_read_b64_tr_b16 v[244:245], v4 offset:61440
ds_read_b64_tr_b16 v[246:247], v4 offset:62464
s_waitcnt lgkmcnt(0)
s_waitcnt vmcnt(26)
s_barrier
s_mov_b32 m0, 32768
s_add_u32 s48, s49, 2621568
buffer_load_dwordx4 v10, s[16:19], s48 offen lds
s_mov_b32 m0, 33792
s_add_u32 s48, s49, 2687104
buffer_load_dwordx4 v10, s[16:19], s48 offen lds
s_mov_b32 m0, 40960
s_add_u32 s48, s49, 2097152
buffer_load_dwordx4 v10, s[16:19], s48 offen lds
s_mov_b32 m0, 41984
s_add_u32 s48, s49, 2162688
buffer_load_dwordx4 v10, s[16:19], s48 offen lds
s_mov_b32 m0, 49152
s_add_u32 s48, s49, 2097280
buffer_load_dwordx4 v10, s[16:19], s48 offen lds
s_mov_b32 m0, 50176
s_add_u32 s48, s49, 2162816
buffer_load_dwordx4 v10, s[16:19], s48 offen lds
s_mov_b32 m0, 57344
s_add_u32 s48, s49, 1048576
buffer_load_dwordx4 v10, s[16:19], s48 offen lds
s_mov_b32 m0, 58368
s_add_u32 s48, s49, 1114112
buffer_load_dwordx4 v10, s[16:19], s48 offen lds
ds_read_b64_tr_b16 a[216:217], v5 offset:0
ds_read_b64_tr_b16 a[218:219], v5 offset:1024
ds_read_b64_tr_b16 a[220:221], v5 offset:4096
ds_read_b64_tr_b16 a[222:223], v5 offset:5120
ds_read_b64_tr_b16 a[224:225], v5 offset:8192
ds_read_b64_tr_b16 a[226:227], v5 offset:9216
ds_read_b64_tr_b16 a[228:229], v5 offset:12288
ds_read_b64_tr_b16 a[230:231], v5 offset:13312
ds_read_b64_tr_b16 a[232:233], v5 offset:16384
ds_read_b64_tr_b16 a[234:235], v5 offset:17408
ds_read_b64_tr_b16 a[236:237], v5 offset:20480
ds_read_b64_tr_b16 a[238:239], v5 offset:21504
ds_read_b64_tr_b16 a[240:241], v5 offset:24576
ds_read_b64_tr_b16 a[242:243], v5 offset:25600
ds_read_b64_tr_b16 a[244:245], v5 offset:28672
ds_read_b64_tr_b16 a[246:247], v5 offset:29696
s_waitcnt lgkmcnt(0)
s_waitcnt vmcnt(26)
s_barrier
s_mov_b32 m0, 65536
s_add_u32 s48, s49, 1048704
buffer_load_dwordx4 v10, s[16:19], s48 offen lds
s_mov_b32 m0, 66560
s_add_u32 s48, s49, 1114240
buffer_load_dwordx4 v10, s[16:19], s48 offen lds
s_mov_b32 m0, 73728
s_add_u32 s48, s50, 0
buffer_load_dwordx4 v11, s[20:23], s48 offen lds
s_mov_b32 m0, 74752
s_add_u32 s48, s50, 5120
buffer_load_dwordx4 v11, s[20:23], s48 offen lds
s_mov_b32 m0, 81920
s_add_u32 s48, s50, 20480
buffer_load_dwordx4 v11, s[20:23], s48 offen lds
s_mov_b32 m0, 82944
s_add_u32 s48, s50, 25600
buffer_load_dwordx4 v11, s[20:23], s48 offen lds
s_mov_b32 m0, 90112
s_add_u32 s48, s50, 40960
buffer_load_dwordx4 v11, s[20:23], s48 offen lds
s_mov_b32 m0, 91136
s_add_u32 s48, s50, 46080
buffer_load_dwordx4 v11, s[20:23], s48 offen lds
ds_read_b64_tr_b16 v[248:249], v5 offset:32768
ds_read_b64_tr_b16 v[250:251], v5 offset:33792
ds_read_b64_tr_b16 v[252:253], v5 offset:36864
ds_read_b64_tr_b16 v[254:255], v5 offset:37888
ds_read_b64_tr_b16 a[248:249], v5 offset:40960
ds_read_b64_tr_b16 a[250:251], v5 offset:41984
ds_read_b64_tr_b16 a[252:253], v5 offset:45056
ds_read_b64_tr_b16 a[254:255], v5 offset:46080
ds_read_b64_tr_b16 v[72:73], v5 offset:49152
ds_read_b64_tr_b16 v[74:75], v5 offset:50176
ds_read_b64_tr_b16 v[76:77], v5 offset:53248
ds_read_b64_tr_b16 v[78:79], v5 offset:54272
ds_read_b64_tr_b16 v[80:81], v5 offset:57344
ds_read_b64_tr_b16 v[82:83], v5 offset:58368
ds_read_b64_tr_b16 v[84:85], v5 offset:61440
ds_read_b64_tr_b16 v[86:87], v5 offset:62464
s_waitcnt lgkmcnt(0)
s_waitcnt vmcnt(26)
s_barrier
s_mov_b32 m0, 98304
s_add_u32 s48, s50, 61440
buffer_load_dwordx4 v11, s[20:23], s48 offen lds
s_mov_b32 m0, 99328
s_add_u32 s48, s50, 66560
buffer_load_dwordx4 v11, s[20:23], s48 offen lds
s_mov_b32 m0, 106496
s_add_u32 s48, s50, 256
buffer_load_dwordx4 v11, s[20:23], s48 offen lds
s_mov_b32 m0, 107520
s_add_u32 s48, s50, 5376
buffer_load_dwordx4 v11, s[20:23], s48 offen lds
s_mov_b32 m0, 114688
s_add_u32 s48, s50, 20736
buffer_load_dwordx4 v11, s[20:23], s48 offen lds
s_mov_b32 m0, 115712
s_add_u32 s48, s50, 25856
buffer_load_dwordx4 v11, s[20:23], s48 offen lds
s_mov_b32 m0, 122880
s_add_u32 s48, s50, 41216
buffer_load_dwordx4 v11, s[20:23], s48 offen lds
s_mov_b32 m0, 123904
s_add_u32 s48, s50, 46336
buffer_load_dwordx4 v11, s[20:23], s48 offen lds
ds_read_b64_tr_b16 v[88:89], v6 offset:0
ds_read_b64_tr_b16 v[90:91], v6 offset:1024
ds_read_b64_tr_b16 v[92:93], v6 offset:4096
ds_read_b64_tr_b16 v[94:95], v6 offset:5120
ds_read_b64_tr_b16 a[64:65], v6 offset:8192
ds_read_b64_tr_b16 a[66:67], v6 offset:9216
ds_read_b64_tr_b16 a[68:69], v6 offset:12288
ds_read_b64_tr_b16 a[70:71], v6 offset:13312
ds_read_b64_tr_b16 v[96:97], v6 offset:16384
ds_read_b64_tr_b16 v[98:99], v6 offset:17408
ds_read_b64_tr_b16 v[100:101], v6 offset:20480
ds_read_b64_tr_b16 v[102:103], v6 offset:21504
ds_read_b64_tr_b16 v[104:105], v6 offset:24576
ds_read_b64_tr_b16 v[106:107], v6 offset:25600
ds_read_b64_tr_b16 v[108:109], v6 offset:28672
ds_read_b64_tr_b16 v[110:111], v6 offset:29696
s_waitcnt lgkmcnt(0)
s_waitcnt vmcnt(24)
s_barrier
s_mov_b32 m0, 131072
s_add_u32 s48, s50, 61696
buffer_load_dwordx4 v11, s[20:23], s48 offen lds
s_mov_b32 m0, 132096
s_add_u32 s48, s50, 66816
buffer_load_dwordx4 v11, s[20:23], s48 offen lds
s_mov_b32 m0, 139264
s_add_u32 s48, s50, 512
buffer_load_dwordx4 v11, s[20:23], s48 offen lds
s_mov_b32 m0, 140288
s_add_u32 s48, s50, 5632
buffer_load_dwordx4 v11, s[20:23], s48 offen lds
s_mov_b32 m0, 147456
s_add_u32 s48, s50, 20992
buffer_load_dwordx4 v11, s[20:23], s48 offen lds
s_mov_b32 m0, 148480
s_add_u32 s48, s50, 26112
buffer_load_dwordx4 v11, s[20:23], s48 offen lds
s_mov_b32 m0, 155648
s_add_u32 s48, s50, 41472
buffer_load_dwordx4 v11, s[20:23], s48 offen lds
s_mov_b32 m0, 156672
s_add_u32 s48, s50, 46592
buffer_load_dwordx4 v11, s[20:23], s48 offen lds
ds_read_b64_tr_b16 v[112:113], v4 offset:0
ds_read_b64_tr_b16 v[114:115], v4 offset:1024
ds_read_b64_tr_b16 v[116:117], v4 offset:4096
ds_read_b64_tr_b16 v[118:119], v4 offset:5120
ds_read_b64_tr_b16 v[120:121], v4 offset:8192
ds_read_b64_tr_b16 v[122:123], v4 offset:9216
ds_read_b64_tr_b16 v[124:125], v4 offset:12288
ds_read_b64_tr_b16 v[126:127], v4 offset:13312
ds_read_b64_tr_b16 a[80:81], v4 offset:16384
ds_read_b64_tr_b16 a[82:83], v4 offset:17408
ds_read_b64_tr_b16 a[84:85], v4 offset:20480
ds_read_b64_tr_b16 a[86:87], v4 offset:21504
ds_read_b64_tr_b16 v[128:129], v4 offset:24576
ds_read_b64_tr_b16 v[130:131], v4 offset:25600
ds_read_b64_tr_b16 v[132:133], v4 offset:28672
ds_read_b64_tr_b16 v[134:135], v4 offset:29696
s_waitcnt lgkmcnt(0)
s_waitcnt vmcnt(24)
s_barrier
s_mov_b32 m0, 0
s_add_u32 s48, s50, 61952
buffer_load_dwordx4 v11, s[20:23], s48 offen lds
s_mov_b32 m0, 1024
s_add_u32 s48, s50, 67072
buffer_load_dwordx4 v11, s[20:23], s48 offen lds
s_mov_b32 m0, 8192
s_add_u32 s48, s49, 128
buffer_load_dwordx4 v10, s[8:11], s48 offen lds
s_mov_b32 m0, 9216
s_add_u32 s48, s49, 65664
buffer_load_dwordx4 v10, s[8:11], s48 offen lds
s_mov_b32 m0, 16384
s_add_u32 s48, s49, 0
buffer_load_dwordx4 v10, s[12:15], s48 offen lds
s_mov_b32 m0, 17408
s_add_u32 s48, s49, 65536
buffer_load_dwordx4 v10, s[12:15], s48 offen lds
s_mov_b32 m0, 24576
s_add_u32 s48, s49, 524416
buffer_load_dwordx4 v10, s[8:11], s48 offen lds
s_mov_b32 m0, 25600
s_add_u32 s48, s49, 589952
buffer_load_dwordx4 v10, s[8:11], s48 offen lds
ds_read_b64_tr_b16 v[136:137], v4 offset:32768
ds_read_b64_tr_b16 v[138:139], v4 offset:33792
ds_read_b64_tr_b16 v[140:141], v4 offset:36864
ds_read_b64_tr_b16 v[142:143], v4 offset:37888
ds_read_b64_tr_b16 v[144:145], v4 offset:40960
ds_read_b64_tr_b16 v[146:147], v4 offset:41984
ds_read_b64_tr_b16 v[148:149], v4 offset:45056
ds_read_b64_tr_b16 v[150:151], v4 offset:46080
ds_read_b64_tr_b16 v[152:153], v4 offset:49152
ds_read_b64_tr_b16 v[154:155], v4 offset:50176
ds_read_b64_tr_b16 v[156:157], v4 offset:53248
ds_read_b64_tr_b16 v[158:159], v4 offset:54272
ds_read_b64_tr_b16 v[160:161], v4 offset:57344
ds_read_b64_tr_b16 v[162:163], v4 offset:58368
ds_read_b64_tr_b16 v[164:165], v4 offset:61440
ds_read_b64_tr_b16 v[166:167], v4 offset:62464
s_waitcnt lgkmcnt(0)
s_waitcnt vmcnt(24)
s_barrier
s_mov_b32 m0, 32768
s_add_u32 s48, s49, 524288
buffer_load_dwordx4 v10, s[12:15], s48 offen lds
s_mov_b32 m0, 33792
s_add_u32 s48, s49, 589824
buffer_load_dwordx4 v10, s[12:15], s48 offen lds
s_mov_b32 m0, 40960
s_add_u32 s48, s49, 1048704
buffer_load_dwordx4 v10, s[8:11], s48 offen lds
s_mov_b32 m0, 41984
s_add_u32 s48, s49, 1114240
buffer_load_dwordx4 v10, s[8:11], s48 offen lds
s_mov_b32 m0, 49152
s_add_u32 s48, s49, 1572992
buffer_load_dwordx4 v10, s[8:11], s48 offen lds
s_mov_b32 m0, 50176
s_add_u32 s48, s49, 1638528
buffer_load_dwordx4 v10, s[8:11], s48 offen lds
s_mov_b32 m0, 57344
s_add_u32 s48, s49, 2097280
buffer_load_dwordx4 v10, s[8:11], s48 offen lds
s_mov_b32 m0, 58368
s_add_u32 s48, s49, 2162816
buffer_load_dwordx4 v10, s[8:11], s48 offen lds
ds_read_b64_tr_b16 v[168:169], v5 offset:0
ds_read_b64_tr_b16 v[170:171], v5 offset:1024
ds_read_b64_tr_b16 v[172:173], v5 offset:4096
ds_read_b64_tr_b16 v[174:175], v5 offset:5120
v_xor_b32 v12, v15, v8
ds_read_b64_tr_b16 v[24:25], v12 offset:8192
ds_read_b64_tr_b16 v[26:27], v12 offset:8704
ds_read_b64_tr_b16 v[28:29], v12 offset:10240
ds_read_b64_tr_b16 v[30:31], v12 offset:10752
ds_read_b64_tr_b16 v[176:177], v8 offset:16384
ds_read_b64_tr_b16 v[178:179], v8 offset:16896
ds_read_b64_tr_b16 v[180:181], v8 offset:18432
ds_read_b64_tr_b16 v[182:183], v8 offset:18944
ds_read_b64_tr_b16 v[184:185], v8 offset:24576
ds_read_b64_tr_b16 v[186:187], v8 offset:25088
ds_read_b64_tr_b16 v[188:189], v8 offset:26624
ds_read_b64_tr_b16 v[190:191], v8 offset:27136
s_waitcnt lgkmcnt(0)
buffer_store_dwordx4 v[24:27], v0, s[4:7], s61 offen offset:0
buffer_store_dwordx4 v[28:31], v0, s[4:7], s61 offen offset:1024
s_waitcnt vmcnt(26)
s_barrier
s_mov_b32 m0, 65536
s_add_u32 s48, s49, 2621568
buffer_load_dwordx4 v10, s[8:11], s48 offen lds
s_mov_b32 m0, 66560
s_add_u32 s48, s49, 2687104
buffer_load_dwordx4 v10, s[8:11], s48 offen lds
s_mov_b32 m0, 73728
s_add_u32 s48, s50, 768
buffer_load_dwordx4 v11, s[20:23], s48 offen lds
s_mov_b32 m0, 74752
s_add_u32 s48, s50, 5888
buffer_load_dwordx4 v11, s[20:23], s48 offen lds
s_mov_b32 m0, 81920
s_add_u32 s48, s50, 21248
buffer_load_dwordx4 v11, s[20:23], s48 offen lds
s_mov_b32 m0, 82944
s_add_u32 s48, s50, 26368
buffer_load_dwordx4 v11, s[20:23], s48 offen lds
s_mov_b32 m0, 90112
s_add_u32 s48, s50, 41728
buffer_load_dwordx4 v11, s[20:23], s48 offen lds
s_mov_b32 m0, 91136
s_add_u32 s48, s50, 46848
buffer_load_dwordx4 v11, s[20:23], s48 offen lds
ds_read_b64_tr_b16 v[192:193], v8 offset:32768
ds_read_b64_tr_b16 v[194:195], v8 offset:33280
ds_read_b64_tr_b16 v[196:197], v8 offset:34816
ds_read_b64_tr_b16 v[198:199], v8 offset:35328
v_xor_b32 v12, v15, v8
ds_read_b64_tr_b16 v[24:25], v12 offset:40960
ds_read_b64_tr_b16 v[26:27], v12 offset:41472
ds_read_b64_tr_b16 v[28:29], v12 offset:43008
ds_read_b64_tr_b16 v[30:31], v12 offset:43520
ds_read_b64_tr_b16 a[88:89], v8 offset:49152
ds_read_b64_tr_b16 a[90:91], v8 offset:49664
ds_read_b64_tr_b16 a[92:93], v8 offset:51200
ds_read_b64_tr_b16 a[94:95], v8 offset:51712
ds_read_b64_tr_b16 a[136:137], v8 offset:57344
ds_read_b64_tr_b16 a[138:139], v8 offset:57856
ds_read_b64_tr_b16 a[140:141], v8 offset:59392
ds_read_b64_tr_b16 a[142:143], v8 offset:59904
s_waitcnt lgkmcnt(0)
buffer_store_dwordx4 v[24:27], v0, s[4:7], s61 offen offset:2048
buffer_store_dwordx4 v[28:31], v0, s[4:7], s61 offen offset:3072
s_waitcnt vmcnt(28)
s_barrier
s_mov_b32 m0, 98304
s_add_u32 s48, s50, 62208
buffer_load_dwordx4 v11, s[20:23], s48 offen lds
s_mov_b32 m0, 99328
s_add_u32 s48, s50, 67328
buffer_load_dwordx4 v11, s[20:23], s48 offen lds
s_mov_b32 m0, 106496
s_add_u32 s48, s50, 1024
buffer_load_dwordx4 v11, s[20:23], s48 offen lds
s_mov_b32 m0, 107520
s_add_u32 s48, s50, 6144
buffer_load_dwordx4 v11, s[20:23], s48 offen lds
s_mov_b32 m0, 114688
s_add_u32 s48, s50, 21504
buffer_load_dwordx4 v11, s[20:23], s48 offen lds
s_mov_b32 m0, 115712
s_add_u32 s48, s50, 26624
buffer_load_dwordx4 v11, s[20:23], s48 offen lds
s_mov_b32 m0, 122880
s_add_u32 s48, s50, 41984
buffer_load_dwordx4 v11, s[20:23], s48 offen lds
s_mov_b32 m0, 123904
s_add_u32 s48, s50, 47104
buffer_load_dwordx4 v11, s[20:23], s48 offen lds
ds_read_b64_tr_b16 v[16:17], v9 offset:0
ds_read_b64_tr_b16 v[18:19], v9 offset:512
ds_read_b64_tr_b16 v[20:21], v9 offset:2048
ds_read_b64_tr_b16 v[22:23], v9 offset:2560
v_xor_b32 v12, v15, v9
ds_read_b64_tr_b16 v[200:201], v12 offset:8192
ds_read_b64_tr_b16 v[202:203], v12 offset:8704
ds_read_b64_tr_b16 v[204:205], v12 offset:10240
ds_read_b64_tr_b16 v[206:207], v12 offset:10752
ds_read_b64_tr_b16 v[32:33], v9 offset:16384
ds_read_b64_tr_b16 v[34:35], v9 offset:16896
ds_read_b64_tr_b16 v[36:37], v9 offset:18432
ds_read_b64_tr_b16 v[38:39], v9 offset:18944
ds_read_b64_tr_b16 v[208:209], v9 offset:24576
ds_read_b64_tr_b16 v[210:211], v9 offset:25088
ds_read_b64_tr_b16 v[212:213], v9 offset:26624
ds_read_b64_tr_b16 v[214:215], v9 offset:27136
s_waitcnt lgkmcnt(0)
buffer_store_dwordx4 v[16:19], v0, s[4:7], s62 offen offset:0
buffer_store_dwordx4 v[20:23], v0, s[4:7], s62 offen offset:1024
buffer_store_dwordx4 v[32:35], v0, s[4:7], s62 offen offset:2048
buffer_store_dwordx4 v[36:39], v0, s[4:7], s62 offen offset:3072
s_waitcnt vmcnt(38)
s_barrier
s_mov_b32 m0, 131072
s_add_u32 s48, s50, 62464
buffer_load_dwordx4 v11, s[20:23], s48 offen lds
s_mov_b32 m0, 132096
s_add_u32 s48, s50, 67584
buffer_load_dwordx4 v11, s[20:23], s48 offen lds
s_mov_b32 m0, 139264
s_add_u32 s48, s49, 1048576
buffer_load_dwordx4 v10, s[12:15], s48 offen lds
s_mov_b32 m0, 140288
s_add_u32 s48, s49, 1114112
buffer_load_dwordx4 v10, s[12:15], s48 offen lds
s_mov_b32 m0, 147456
s_add_u32 s48, s49, 3145728
buffer_load_dwordx4 v10, s[8:11], s48 offen lds
s_mov_b32 m0, 148480
s_add_u32 s48, s49, 3211264
buffer_load_dwordx4 v10, s[8:11], s48 offen lds
s_mov_b32 m0, 155648
s_add_u32 s48, s49, 3145856
buffer_load_dwordx4 v10, s[8:11], s48 offen lds
s_mov_b32 m0, 156672
s_add_u32 s48, s49, 3211392
buffer_load_dwordx4 v10, s[8:11], s48 offen lds
ds_read_b64_tr_b16 v[216:217], v7 offset:0
ds_read_b64_tr_b16 v[218:219], v7 offset:512
ds_read_b64_tr_b16 v[220:221], v7 offset:2048
ds_read_b64_tr_b16 v[222:223], v7 offset:2560
s_waitcnt lgkmcnt(0)
s_waitcnt vmcnt(32)
s_barrier
ds_read_b64_tr_b16 v[16:17], v4 offset:8192
ds_read_b64_tr_b16 v[18:19], v4 offset:9216
ds_read_b64_tr_b16 v[20:21], v4 offset:12288
ds_read_b64_tr_b16 v[22:23], v4 offset:13312
ds_read_b64_tr_b16 v[24:25], v4 offset:16384
ds_read_b64_tr_b16 v[26:27], v4 offset:17408
ds_read_b64_tr_b16 v[28:29], v4 offset:20480
ds_read_b64_tr_b16 v[30:31], v4 offset:21504
ds_read_b64_tr_b16 v[32:33], v4 offset:24576
ds_read_b64_tr_b16 v[34:35], v4 offset:25600
ds_read_b64_tr_b16 v[36:37], v4 offset:28672
ds_read_b64_tr_b16 v[38:39], v4 offset:29696
ds_read_b64_tr_b16 v[40:41], v4 offset:32768
ds_read_b64_tr_b16 v[42:43], v4 offset:33792
ds_read_b64_tr_b16 v[44:45], v4 offset:36864
ds_read_b64_tr_b16 v[46:47], v4 offset:37888
ds_read_b64_tr_b16 v[48:49], v4 offset:40960
ds_read_b64_tr_b16 v[50:51], v4 offset:41984
ds_read_b64_tr_b16 v[52:53], v4 offset:45056
ds_read_b64_tr_b16 v[54:55], v4 offset:46080
ds_read_b64_tr_b16 v[56:57], v4 offset:49152
ds_read_b64_tr_b16 v[58:59], v4 offset:50176
ds_read_b64_tr_b16 v[60:61], v4 offset:53248
ds_read_b64_tr_b16 v[62:63], v4 offset:54272
ds_read_b64_tr_b16 v[64:65], v4 offset:57344
ds_read_b64_tr_b16 v[66:67], v4 offset:58368
ds_read_b64_tr_b16 v[68:69], v4 offset:61440
ds_read_b64_tr_b16 v[70:71], v4 offset:62464
s_waitcnt lgkmcnt(0)
s_barrier
ds_write_b128 v0, v[16:19] offset:8192
ds_write_b128 v0, v[20:23] offset:9216
ds_write_b128 v0, v[24:27] offset:10240
ds_write_b128 v0, v[28:31] offset:11264
ds_write_b128 v0, v[32:35] offset:12288
ds_write_b128 v0, v[36:39] offset:13312
ds_write_b128 v0, v[40:43] offset:14336
ds_write_b128 v0, v[44:47] offset:15360
ds_write_b128 v0, v[48:51] offset:16384
ds_write_b128 v0, v[52:55] offset:17408
ds_write_b128 v0, v[56:59] offset:18432
ds_write_b128 v0, v[60:63] offset:19456
ds_write_b128 v0, a[136:139] offset:20480
ds_write_b128 v0, a[140:143] offset:21504
s_waitcnt lgkmcnt(0)
v_accvgpr_write_b32 a136, v64
v_accvgpr_write_b32 a137, v65
v_accvgpr_write_b32 a138, v66
v_accvgpr_write_b32 a139, v67
v_accvgpr_write_b32 a140, v68
v_accvgpr_write_b32 a141, v69
v_accvgpr_write_b32 a142, v70
v_accvgpr_write_b32 a143, v71
s_waitcnt vmcnt(6)
s_barrier
ds_read_b64_tr_b16 v[16:17], v8 offset:24576
ds_read_b64_tr_b16 v[18:19], v8 offset:25088
ds_read_b64_tr_b16 v[20:21], v8 offset:26624
ds_read_b64_tr_b16 v[22:23], v8 offset:27136
ds_read_b64_tr_b16 v[24:25], v8 offset:32768
ds_read_b64_tr_b16 v[26:27], v8 offset:33280
ds_read_b64_tr_b16 v[28:29], v8 offset:34816
ds_read_b64_tr_b16 v[30:31], v8 offset:35328
v_xor_b32 v12, v15, v8
ds_read_b64_tr_b16 v[32:33], v12 offset:40960
ds_read_b64_tr_b16 v[34:35], v12 offset:41472
ds_read_b64_tr_b16 v[36:37], v12 offset:43008
ds_read_b64_tr_b16 v[38:39], v12 offset:43520
ds_read_b64_tr_b16 v[40:41], v8 offset:49152
ds_read_b64_tr_b16 v[42:43], v8 offset:49664
ds_read_b64_tr_b16 v[44:45], v8 offset:51200
ds_read_b64_tr_b16 v[46:47], v8 offset:51712
ds_read_b64_tr_b16 v[48:49], v8 offset:57344
ds_read_b64_tr_b16 v[50:51], v8 offset:57856
ds_read_b64_tr_b16 v[52:53], v8 offset:59392
ds_read_b64_tr_b16 v[54:55], v8 offset:59904
ds_read_b64_tr_b16 v[56:57], v9 offset:0
ds_read_b64_tr_b16 v[58:59], v9 offset:512
ds_read_b64_tr_b16 v[60:61], v9 offset:2048
ds_read_b64_tr_b16 v[62:63], v9 offset:2560
s_waitcnt lgkmcnt(0)
s_barrier
ds_write_b128 v2, v[16:19] offset:16384
ds_write_b128 v2, v[20:23] offset:17408
ds_write_b128 v2, v[232:235] offset:18432
ds_write_b128 v2, v[236:239] offset:19456
ds_write_b128 v2, v[240:243] offset:20480
ds_write_b128 v2, v[244:247] offset:21504
ds_write_b128 v2, v[40:43] offset:22528
ds_write_b128 v2, v[44:47] offset:23552
ds_write_b128 v2, v[48:51] offset:24576
ds_write_b128 v2, v[52:55] offset:25600
ds_write_b128 v2, v[248:251] offset:26624
ds_write_b128 v2, v[252:255] offset:27648
s_waitcnt lgkmcnt(0)
v_mov_b32 v232, v24
v_mov_b32 v233, v25
v_mov_b32 v234, v26
v_mov_b32 v235, v27
v_mov_b32 v236, v28
v_mov_b32 v237, v29
v_mov_b32 v238, v30
v_mov_b32 v239, v31
v_mov_b32 v240, v32
v_mov_b32 v241, v33
v_mov_b32 v242, v34
v_mov_b32 v243, v35
v_mov_b32 v244, v36
v_mov_b32 v245, v37
v_mov_b32 v246, v38
v_mov_b32 v247, v39
v_mov_b32 v248, v56
v_mov_b32 v249, v57
v_mov_b32 v250, v58
v_mov_b32 v251, v59
v_mov_b32 v252, v60
v_mov_b32 v253, v61
v_mov_b32 v254, v62
v_mov_b32 v255, v63
s_waitcnt vmcnt(0)
s_barrier
ds_read_b64_tr_b16 v[16:17], v5 offset:0
ds_read_b64_tr_b16 v[18:19], v5 offset:1024
ds_read_b64_tr_b16 v[20:21], v5 offset:4096
ds_read_b64_tr_b16 v[22:23], v5 offset:5120
v_xor_b32 v12, v15, v8
ds_read_b64_tr_b16 v[24:25], v12 offset:8192
ds_read_b64_tr_b16 v[26:27], v12 offset:8704
ds_read_b64_tr_b16 v[28:29], v12 offset:10240
ds_read_b64_tr_b16 v[30:31], v12 offset:10752
ds_read_b64_tr_b16 v[32:33], v8 offset:16384
ds_read_b64_tr_b16 v[34:35], v8 offset:16896
ds_read_b64_tr_b16 v[36:37], v8 offset:18432
ds_read_b64_tr_b16 v[38:39], v8 offset:18944
ds_read_b64_tr_b16 v[40:41], v6 offset:8192
ds_read_b64_tr_b16 v[42:43], v6 offset:9216
ds_read_b64_tr_b16 v[44:45], v6 offset:12288
ds_read_b64_tr_b16 v[46:47], v6 offset:13312
ds_read_b64_tr_b16 v[48:49], v6 offset:16384
ds_read_b64_tr_b16 v[50:51], v6 offset:17408
ds_read_b64_tr_b16 v[52:53], v6 offset:20480
ds_read_b64_tr_b16 v[54:55], v6 offset:21504
ds_read_b64_tr_b16 v[56:57], v6 offset:24576
ds_read_b64_tr_b16 v[58:59], v6 offset:25600
ds_read_b64_tr_b16 v[60:61], v6 offset:28672
ds_read_b64_tr_b16 v[62:63], v6 offset:29696
s_waitcnt lgkmcnt(0)
s_barrier
ds_write_b128 v2, a[152:155] offset:40960
ds_write_b128 v2, a[156:159] offset:41984
ds_write_b128 v2, v[224:227] offset:43008
ds_write_b128 v2, v[228:231] offset:44032
ds_write_b128 v2, v[32:35] offset:45056
ds_write_b128 v2, v[36:39] offset:46080
ds_write_b128 v2, a[64:67] offset:47104
ds_write_b128 v2, a[68:71] offset:48128
ds_write_b128 v2, a[80:83] offset:49152
ds_write_b128 v2, a[84:87] offset:50176
ds_write_b128 v2, a[88:91] offset:51200
ds_write_b128 v2, a[92:95] offset:52224
s_waitcnt lgkmcnt(0)
v_accvgpr_write_b32 a152, v16
v_accvgpr_write_b32 a153, v17
v_accvgpr_write_b32 a154, v18
v_accvgpr_write_b32 a155, v19
v_accvgpr_write_b32 a156, v20
v_accvgpr_write_b32 a157, v21
v_accvgpr_write_b32 a158, v22
v_accvgpr_write_b32 a159, v23
v_mov_b32 v224, v24
v_mov_b32 v225, v25
v_mov_b32 v226, v26
v_mov_b32 v227, v27
v_mov_b32 v228, v28
v_mov_b32 v229, v29
v_mov_b32 v230, v30
v_mov_b32 v231, v31
v_accvgpr_write_b32 a64, v40
v_accvgpr_write_b32 a65, v41
v_accvgpr_write_b32 a66, v42
v_accvgpr_write_b32 a67, v43
v_accvgpr_write_b32 a68, v44
v_accvgpr_write_b32 a69, v45
v_accvgpr_write_b32 a70, v46
v_accvgpr_write_b32 a71, v47
v_accvgpr_write_b32 a80, v48
v_accvgpr_write_b32 a81, v49
v_accvgpr_write_b32 a82, v50
v_accvgpr_write_b32 a83, v51
v_accvgpr_write_b32 a84, v52
v_accvgpr_write_b32 a85, v53
v_accvgpr_write_b32 a86, v54
v_accvgpr_write_b32 a87, v55
v_accvgpr_write_b32 a88, v56
v_accvgpr_write_b32 a89, v57
v_accvgpr_write_b32 a90, v58
v_accvgpr_write_b32 a91, v59
v_accvgpr_write_b32 a92, v60
v_accvgpr_write_b32 a93, v61
v_accvgpr_write_b32 a94, v62
v_accvgpr_write_b32 a95, v63
s_mov_b32 s90, 0x300003
s_mov_b32 s91, 0x300003
s_mov_b32 s12, 0x3030303
s_mov_b32 s13, 0x3030303
s_mov_b32 s92, 0xc0000c
s_mov_b32 s93, 0xc0000c
s_mov_b32 s14, 0xc0c0c0c
s_mov_b32 s15, 0xc0c0c0c
s_mov_b32 s94, 0x30000300
s_mov_b32 s95, 0x30000300
s_mov_b32 s16, 0x30303030
s_mov_b32 s17, 0x30303030
s_mov_b32 s96, 0xc0000c00
s_mov_b32 s97, 0xc0000c00
s_mov_b32 s18, 0xc0c0c0c0
s_mov_b32 s19, 0xc0c0c0c0
s_mov_b32 s98, 0xff00ff00
s_mov_b32 s99, 0xff00ff00
v_mov_b32 v1, 0x4444
v_mov_b32 v4, 0xeeee
v_cndmask_b32 v1, v1, v4, s[98:99]
v_lshrrev_b32 v4, 8, v0
v_lshl_or_b32 v1, v4, 28, v1
v_bfe_u32 v4, v0, 4, 4
v_lshl_or_b32 v1, v4, 19, v1
s_mov_b32 s51, 0x3e0293ee
s_mov_b32 s52, 0x3f803f80
s_mov_b32 s53, 0x3f803f80
s_mov_b32 s54, 0x3f003f00
s_mov_b32 s55, 0x3f003f00
s_mov_b32 s56, 0xff800000
s_mov_b32 s57, 0xff800000
s_mov_b32 s58, 0x3f80
s_mov_b32 s8, s4
s_mov_b32 s9, s5
s_cmp_lt_u32 s30, 10
s_cselect_b32 s10, s6, 0
s_mov_b32 s31, 0
s_mov_b32 s45, -2
s_lshl_b32 s46, s30, 6
s_add_u32 s46, s46, 222330880
s_mul_i32 s48, s30, 0
s_add_u32 s48, s48, 120389632
s_add_u32 s20, s4, s48
s_addc_u32 s21, s5, 0
s_mov_b32 s22, 512
s_lshl_b32 s48, s30, 7
s_and_b32 s49, s30, 15
s_lshl_b32 s49, s49, 12
s_add_u32 s43, s49, 119537664
v_mov_b64 v[12:13], -1
s_add_u32 s38, s48, 119537664
s_add_u32 s39, s48, 119603200
s_add_u32 s40, s48, 119668736
s_add_u32 s41, s48, 119734272
s_add_u32 s42, s48, 119799808
v_lshrrev_b32 v4, 16, v1
buffer_store_dwordx2 v[12:13], v4, s[4:7], s38 offen
buffer_store_dwordx2 v[12:13], v4, s[4:7], s39 offen
buffer_store_dwordx2 v[12:13], v4, s[4:7], s40 offen
buffer_store_dwordx2 v[12:13], v4, s[4:7], s41 offen
buffer_store_dwordx2 v[12:13], v4, s[4:7], s42 offen
s_cmp_lg_u32 s3, 0
s_cbranch_scc1 k_wdd_113
v_mov_b32 v8, 192
k_wd_112:
global_load_dword v9, v8, s[28:29] sc1
s_waitcnt vmcnt(0)
v_readfirstlane_b32 s48, v9
s_cmp_ge_u32 s48, 32
s_cbranch_scc1 k_wdd_113
s_sleep 2
s_sub_u32 s32, s32, 1
s_cmp_gt_i32 s32, 0
s_cbranch_scc1 k_wd_112
k_wdd_113:
s_barrier
k_lay_114:
s_add_u32 s47, s31, 63
s_mov_b32 s33, 120324096
s_mov_b32 s34, 120326144
s_mov_b32 s35, 120330240
s_mul_i32 s48, s31, 655360
s_lshl_b32 s36, s30, 14
s_add_u32 s36, s36, s48
s_add_u32 s36, s36, 0
s_waitcnt vmcnt(1)
v_mov_b32 v12, -1
s_and_b32 s48, s30, 15
s_add_u32 s48, s48, 0
s_lshr_b32 s49, s48, 1
s_and_b32 s48, s48, 1
s_lshl_b32 s44, s49, 8
s_lshl_b32 s50, s48, 6
s_add_u32 s44, s44, s50
s_add_u32 s44, s44, s33
s_mul_i32 s48, s48, 5120
s_lshl_b32 s49, s49, 5
s_add_u32 s48, s48, s49
v_lshrrev_b32 v8, 4, v0
v_and_b32 v9, 3, v8
v_mul_u32_u24 v9, 1280, v9
v_bfe_u32 v10, v8, 2, 1
v_lshl_add_u32 v9, v10, 1, v9
v_bfe_u32 v10, v8, 4, 1
v_lshl_add_u32 v9, v10, 4, v9
v_bfe_u32 v10, v8, 5, 1
v_lshl_add_u32 v9, v10, 2, v9
buffer_load_ushort v10, v9, s[24:27], s48 offen
buffer_load_ushort v11, v9, s[24:27], s48 offen offset:8
v_and_b32 v45, 0x30, v0
v_lshrrev_b32 v46, 8, v0
v_lshl_or_b32 v45, v46, 2, v45
v_bfe_u32 v46, v0, 6, 1
v_lshl_or_b32 v45, v46, 7, v45
v_cndmask_b32 v45, v45, 2.0, s[98:99]
s_waitcnt vmcnt(0)
v_lshl_or_b32 v10, v11, 16, v10
s_waitcnt vmcnt(0)
s_barrier
s_mov_b64 exec, 1
v_mov_b32 v8, 160
v_mov_b32 v9, 1
global_atomic_add v8, v9, s[28:29] sc1
s_add_u32 s49, s31, 32
k_tb_115:
global_load_dword v9, v8, s[28:29] sc1
s_waitcnt vmcnt(0)
v_readfirstlane_b32 s48, v9
s_cmp_ge_u32 s48, s49
s_cbranch_scc1 k_tbd_116
s_sub_u32 s32, s32, 1
s_cmp_gt_i32 s32, 0
s_cbranch_scc1 k_tb_115
k_tbd_116:
s_mov_b64 exec, -1
s_barrier
buffer_store_dword v10, v45, s[4:7], s44 offen
s_add_u32 s44, s44, 16384
buffer_store_dword v12, v45, s[4:7], s44 offen
s_waitcnt vmcnt(0)
s_barrier
s_mov_b64 exec, 1
v_mov_b32 v8, 160
v_mov_b32 v9, 1
global_atomic_add v8, v9, s[28:29] sc1
s_add_u32 s49, s31, 64
k_tb_117:
global_load_dword v9, v8, s[28:29] sc1
s_waitcnt vmcnt(0)
v_readfirstlane_b32 s48, v9
s_cmp_ge_u32 s48, s49
s_cbranch_scc1 k_tbd_118
s_sub_u32 s32, s32, 1
s_cmp_gt_i32 s32, 0
s_cbranch_scc1 k_tb_117
k_tbd_118:
s_mov_b64 exec, -1
s_barrier
v_lshlrev_b32 v3, v0, s58
v_cndmask_b32 v20, 0, v3, s[90:91]
v_cndmask_b32 v21, 0, v3, s[92:93]
v_cndmask_b32 v22, 0, v3, s[94:95]
v_cndmask_b32 v23, 0, v3, s[96:97]
k_fl2_129:
buffer_load_dwordx2 v[46:47], off, s[4:7], s46 sc1
s_waitcnt vmcnt(0)
v_min_u32 v46, v46, v47
v_cmp_lt_u32 vcc, s31, v46
v_mov_b64 v[46:47], 0
s_cbranch_vccnz k_cold2_121
s_sub_u32 s32, s32, 1
s_cmp_gt_i32 s32, 0
s_cbranch_scc1 k_fl2_129
s_branch k_cold2_121
k_T0_119:
s_waitcnt vmcnt(3)
s_waitcnt lgkmcnt(0)
v_smfmac_f32_16x16x64_bf16 v[28:31], v[4:7], v[56:63], v1
ds_read_b128 v[56:59], v0 offset:12288
v_smfmac_f32_16x16x64_bf16 v[32:35], v[4:7], v[64:71], v1
ds_read_b128 v[60:63], v0 offset:13312
v_smfmac_f32_16x16x64_bf16 v[40:43], v[4:7], a[8:15], v1
ds_read_b128 v[64:67], v0 offset:14336
v_smfmac_f32_16x16x64_bf16 v[44:47], v[4:7], a[16:23], v1
ds_read_b128 v[68:71], v0 offset:15360
s_waitcnt vmcnt(2)
v_smfmac_f32_16x16x64_bf16 v[24:27], v[8:11], a[24:31], v1
s_waitcnt lgkmcnt(2)
v_smfmac_f32_16x16x64_bf16 v[28:31], v[8:11], v[56:63], v1
buffer_load_dwordx4 v[56:59], v0, s[4:7], s60 offen offset:2048
v_smfmac_f32_16x16x64_bf16 v[24:27], v[4:7], v[48:55], v1
s_waitcnt lgkmcnt(0)
v_smfmac_f32_16x16x64_bf16 v[32:35], v[8:11], v[64:71], v1
ds_read_b128 v[64:67], v0 offset:16384
s_waitcnt vmcnt(2)
v_smfmac_f32_16x16x64_bf16 v[36:39], v[8:11], a[32:39], v1
ds_read_b128 v[68:71], v0 offset:17408
buffer_load_dwordx4 v[60:63], v0, s[4:7], s60 offen offset:3072
v_smfmac_f32_16x16x64_bf16 v[36:39], v[12:15], a[72:79], v1
ds_write_b128 v0, v[12:15] offset:0
v_smfmac_f32_16x16x64_bf16 v[36:39], v[4:7], a[0:7], v1
v_smfmac_f32_16x16x64_bf16 v[24:27], v[12:15], a[56:63], v1
buffer_load_dwordx4 v[48:51], v0, s[4:7], s36 offen offset:0 sc1
s_waitcnt vmcnt(3)
v_smfmac_f32_16x16x64_bf16 v[24:27], v[16:19], a[80:87], v1
s_waitcnt lgkmcnt(1)
ds_write_b128 v0, v[16:19] offset:4096
v_smfmac_f32_16x16x64_bf16 v[28:31], v[12:15], v[64:71], v1
ds_read_b128 v[64:67], v2 offset:40960
v_fma_f32 v3, v24, v25, v26
v_smfmac_f32_16x16x64_bf16 v[40:43], v[8:11], a[40:47], v1
buffer_load_dwordx4 v[52:55], v0, s[4:7], s36 offen offset:1024 sc1
v_cmp_u_f32 vcc, v3, v27
v_smfmac_f32_16x16x64_bf16 v[44:47], v[16:19], a[112:119], v1
ds_read_b128 v[68:71], v2 offset:41984
v_smfmac_f32_16x16x64_bf16 v[44:47], v[8:11], a[48:55], v1
s_cbranch_vccnz k_cold_120
k_okC_122:
v_smfmac_f32_16x16x64_bf16 v[36:39], v[16:19], a[96:103], v1
s_waitcnt lgkmcnt(2)
s_barrier
ds_read_b128 v[8:11], v0 offset:2048
v_smfmac_f32_16x16x64_bf16 v[28:31], v[16:19], a[88:95], v1
ds_read_b128 v[4:7], v0 offset:1024
s_waitcnt lgkmcnt(2)
v_smfmac_f32_16x16x64_bf16 v[32:35], v[16:19], v[64:71], v1
ds_read_b128 v[64:67], v0 offset:18432
ds_read_b128 v[68:71], v0 offset:19456
v_smfmac_f32_16x16x64_bf16 v[40:43], v[16:19], a[104:111], v1
v_smfmac_f32_16x16x64_bf16 v[32:35], v[12:15], a[64:71], v1
ds_read_b128 v[16:19], v0 offset:5120
s_waitcnt lgkmcnt(4)
v_smfmac_f32_16x16x64_bf16 v[28:31], v[8:11], a[136:143], v1
ds_read_b128 v[12:15], v0 offset:3072
v_smfmac_f32_16x16x64_bf16 v[24:27], v[8:11], a[128:135], v1
ds_read_b128 v[8:11], v0 offset:7168
s_waitcnt lgkmcnt(3)
v_smfmac_f32_16x16x64_bf16 v[28:31], v[4:7], v[64:71], v1
ds_read_b128 v[64:67], v2 offset:43008
s_waitcnt lgkmcnt(3)
v_smfmac_f32_16x16x64_bf16 v[24:27], v[4:7], a[120:127], v1
ds_read_b128 v[68:71], v2 offset:44032
s_waitcnt lgkmcnt(3)
v_smfmac_f32_16x16x64_bf16 v[28:31], v[12:15], a[152:159], v1
ds_read_b128 v[4:7], v0 offset:6144
s_waitcnt vmcnt(2)
v_smfmac_f32_16x16x64_bf16 v[32:35], v[16:19], v[56:63], v1
buffer_load_dwordx4 v[56:59], v0, s[4:7], s36 offen offset:2048 sc1
v_and_b32 v3, 0xffffff7f, v0
v_smfmac_f32_16x16x64_bf16 v[44:47], v[16:19], a[208:215], v1
s_waitcnt lgkmcnt(1)
v_smfmac_f32_16x16x64_bf16 v[24:27], v[16:19], v[64:71], v1
ds_read_b128 v[64:67], v2 offset:18432
v_smfmac_f32_16x16x64_bf16 v[24:27], v[12:15], a[144:151], v1
s_waitcnt lgkmcnt(1)
ds_read_b128 v[68:71], v2 offset:19456
buffer_load_dwordx4 v[60:63], v0, s[4:7], s36 offen offset:3072 sc1
v_smfmac_f32_16x16x64_bf16 v[24:27], v[4:7], a[168:175], v1
s_barrier
v_smfmac_f32_16x16x64_bf16 v[24:27], v[8:11], a[184:191], v1
v_smfmac_f32_16x16x64_bf16 v[28:31], v[16:19], a[160:167], v1
s_waitcnt lgkmcnt(0)
v_smfmac_f32_16x16x64_bf16 v[28:31], v[8:11], v[64:71], v1
ds_read_b128 v[64:67], v2 offset:20480
v_cvt_pk_bf16_f32 v24, v24, v25
v_smfmac_f32_16x16x64_bf16 v[28:31], v[4:7], a[176:183], v1
ds_read_b128 v[68:71], v2 offset:21504
v_cvt_pk_bf16_f32 v25, v26, v27
v_smfmac_f32_16x16x64_bf16 v[36:39], v[16:19], a[192:199], v1
v_smfmac_f32_16x16x64_bf16 v[40:43], v[16:19], a[200:207], v1
v_cvt_pk_bf16_f32 v27, v30, v31
v_smfmac_f32_16x16x64_bf16 v[40:43], v[4:7], a[224:231], v1
ds_read_b128 v[16:19], v0 offset:1024
s_waitcnt lgkmcnt(1)
v_smfmac_f32_16x16x64_bf16 v[32:35], v[4:7], v[64:71], v1
ds_read_b128 v[64:67], v2 offset:26624
v_cvt_pk_bf16_f32 v26, v28, v29
v_smfmac_f32_16x16x64_bf16 v[44:47], v[4:7], a[232:239], v1
ds_read_b128 v[68:71], v2 offset:27648
v_and_or_b32 v3, v1, 8, v3
v_mfma_f32_16x16x32_bf16 v[28:31], v[24:27], v[20:23], 0
v_smfmac_f32_16x16x64_bf16 v[36:39], v[4:7], a[216:223], v1
ds_read_b128 v[4:7], v0 offset:2048
v_smfmac_f32_16x16x64_bf16 v[40:43], v[8:11], a[248:255], v1
s_waitcnt lgkmcnt(1)
v_mul_f32 v28, s51, v28
v_smfmac_f32_16x16x64_bf16 v[36:39], v[8:11], v[64:71], v1
ds_read_b128 v[64:67], v2 offset:47104
v_mul_f32 v31, s51, v31
v_mul_f32 v29, s51, v29
v_smfmac_f32_16x16x64_bf16 v[32:35], v[8:11], a[240:247], v1
ds_read_b128 v[68:71], v2 offset:48128
v_mul_f32 v30, s51, v30
v_smfmac_f32_16x16x64_bf16 v[44:47], v[8:11], v[72:79], v1
ds_read_b128 v[8:11], v0 offset:0
v_cvt_pk_bf16_f32 v24, v28, v29
v_cvt_pk_bf16_f32 v25, v30, v31
v_smfmac_f32_16x16x64_bf16 v[32:35], v[12:15], v[80:87], v1
ds_write_b64 v3, v[24:25] offset:4096
s_waitcnt lgkmcnt(2)
v_smfmac_f32_16x16x64_bf16 v[32:35], v[16:19], v[64:71], v1
ds_read_b128 v[64:67], v2 offset:49152
s_waitcnt lgkmcnt(2)
v_smfmac_f32_16x16x64_bf16 v[32:35], v[4:7], v[104:111], v1
ds_read_b128 v[68:71], v2 offset:50176
v_smfmac_f32_16x16x64_bf16 v[36:39], v[16:19], v[96:103], v1
s_waitcnt lgkmcnt(2)
s_barrier
ds_read_b128 v[24:27], v0 offset:4096
v_smfmac_f32_16x16x64_bf16 v[36:39], v[12:15], v[88:95], v1
ds_read_b128 v[28:31], v0 offset:5120
v_cvt_pk_bf16_f32 v32, v32, v33
v_smfmac_f32_16x16x64_bf16 v[36:39], v[4:7], v[112:119], v1
s_waitcnt lgkmcnt(2)
v_smfmac_f32_16x16x64_bf16 v[44:47], v[16:19], v[64:71], v1
buffer_load_dwordx4 v[64:67], v0, s[4:7], s61 offen offset:0
s_waitcnt vmcnt(3)
s_waitcnt lgkmcnt(1)
v_mfma_f32_16x16x32_bf16 v[48:51], v[48:51], v[24:27], 0
v_cvt_pk_bf16_f32 v33, v34, v35
s_waitcnt lgkmcnt(0)
v_mfma_f32_16x16x32_bf16 v[48:51], v[52:55], v[28:31], v[48:51]
v_cvt_pk_bf16_f32 v35, v38, v39
v_cvt_pk_bf16_f32 v34, v36, v37
v_mov_b64 v[52:53], s[56:57]
s_nop 0
v_mfma_f32_16x16x32_bf16 v[36:39], v[32:35], v[20:23], 0
buffer_load_dwordx4 v[68:71], v0, s[4:7], s61 offen offset:1024
v_permlane32_swap_b32 v49, v51
v_permlane32_swap_b32 v48, v50
v_add_f32_dpp v53, v51, v49 row_ror:8 row_mask:0xf bank_mask:0x3
v_exp_f32 v53, v53
v_add_f32_dpp v52, v50, v48 row_ror:8 row_mask:0xf bank_mask:0x3
v_exp_f32 v52, v52
v_cvt_pk_bf16_f32 v32, v36, v37
v_cvt_pk_bf16_f32 v33, v38, v39
v_smfmac_f32_16x16x64_bf16 v[40:43], v[16:19], v[120:127], v1
ds_write_b64 v3, v[32:33] offset:6144
v_cvt_pk_bf16_f32 v48, v52, v53
v_smfmac_f32_16x16x64_bf16 v[40:43], v[8:11], v[160:167], v1
ds_write_b32 v0, v48 offset:0
v_smfmac_f32_16x16x64_bf16 v[44:47], v[4:7], v[152:159], v1
buffer_load_dwordx4 v[48:51], v0, s[4:7], s61 offen offset:2048
v_mov_b64 v[20:21], s[52:53]
v_smfmac_f32_16x16x64_bf16 v[40:43], v[12:15], v[128:135], v1
s_waitcnt lgkmcnt(1)
v_mov_b64 v[22:23], s[52:53]
v_smfmac_f32_16x16x64_bf16 v[40:43], v[4:7], v[144:151], v1
s_waitcnt lgkmcnt(0)
s_barrier
ds_read_b128 v[32:35], v0 offset:6144
v_smfmac_f32_16x16x64_bf16 v[44:47], v[12:15], v[136:143], v1
ds_read_b128 v[36:39], v0 offset:7168
ds_read_b128 v[16:19], v0 offset:0
buffer_load_dwordx4 v[52:55], v0, s[4:7], s61 offen offset:3072
v_xor_b32 v12, 0x80, v0
v_cvt_pk_bf16_f32 v40, v40, v41
v_cvt_pk_bf16_f32 v41, v42, v43
v_smfmac_f32_16x16x64_bf16 v[44:47], v[8:11], v[168:175], v1
ds_read_b128 v[12:15], v12 offset:0
s_waitcnt lgkmcnt(3)
v_mfma_f32_16x16x32_bf16 v[24:27], v[32:35], v[24:27], 0
s_waitcnt lgkmcnt(2)
v_mfma_f32_16x16x32_bf16 v[24:27], v[36:39], v[28:31], v[24:27]
v_cvt_pk_bf16_f32 v42, v44, v45
s_waitcnt lgkmcnt(1)
s_waitcnt vmcnt(4)
v_mfma_f32_16x16x32_bf16 v[8:11], v[56:59], v[16:19], 0
buffer_load_dwordx4 v[56:59], v0, s[4:7], s62 offen offset:0
v_mov_b64 v[28:29], s[56:57]
v_permlane32_swap_b32 v24, v26
v_permlane32_swap_b32 v25, v27
v_add_f32_dpp v28, v26, v24 row_ror:8 row_mask:0xf bank_mask:0x3
v_mfma_f32_16x16x32_bf16 v[4:7], v[20:23], v[16:19], 0
s_waitcnt lgkmcnt(0)
v_add_f32_dpp v29, v27, v25 row_ror:8 row_mask:0xf bank_mask:0x3
v_exp_f32 v29, v29
v_mov_b64 v[44:45], s[54:55]
v_exp_f32 v28, v28
v_mfma_f32_16x16x32_bf16 v[8:11], v[60:63], v[12:15], v[8:11]
buffer_load_dwordx4 v[60:63], v0, s[4:7], s62 offen offset:1024
v_cvt_pk_bf16_f32 v24, v28, v29
v_cvt_pk_bf16_f32 v43, v46, v47
v_cvt_pk_bf16_f32 v25, v28, v29
v_permlane32_swap_b32 v40, v41
v_mov_b32_dpp v26, v24 row_ror:8 row_mask:0xf bank_mask:0xf
v_mfma_f32_16x16x16_bf16 v[4:7], v[44:45], v[24:25], v[4:7]
v_mov_b32_dpp v27, v24 row_ror:8 row_mask:0xf bank_mask:0xf
v_permlane32_swap_b32 v42, v43
v_mov_b64 v[28:29], 0
v_mov_b64 v[34:35], 0
v_mfma_f32_16x16x32_bf16 v[8:11], v[40:43], v[24:27], v[8:11]
buffer_load_dwordx4 v[16:19], v0, s[4:7], s62 offen offset:2048
v_rcp_f32 v6, v4
v_mov_b64 v[32:33], 0
s_nop 0
v_rcp_f32_dpp v6, v4 row_ror:8 row_mask:0xf bank_mask:0xc
v_mov_b64 v[26:27], 0
v_pk_mul_f32 v[8:9], v[8:9], v[6:7] op_sel_hi:[1,0]
v_pk_mul_f32 v[10:11], v[10:11], v[6:7] op_sel_hi:[1,0]
v_add_u32 v6, 0xd4800000, v6
v_mov_b64 v[24:25], 0
v_cvt_pk_bf16_f32 v45, v10, v11
v_cvt_pk_bf16_f32 v44, v8, v9
s_waitcnt vmcnt(5)
buffer_load_dwordx4 v[20:23], v0, s[4:7], s62 offen offset:3072
ds_write_b64 v3, v[44:45] offset:2048
v_cmp_lt_u32 vcc, 0x28000000, v6
v_mov_b32_dpp v46, v44 row_ror:8 row_mask:0xf bank_mask:0xf
v_and_b32 v3, -9, v3
v_mov_b32_dpp v47, v45 row_ror:8 row_mask:0xf bank_mask:0xf
v_mov_b64 v[30:31], 0
s_cbranch_vccnz k_slow_123
k_okS_124:
v_mov_b64 v[38:39], 0
v_mov_b64 v[36:37], 0
v_smfmac_f32_16x16x64_bf16 v[32:35], v[44:47], v[200:207], v1
s_waitcnt lgkmcnt(0)
s_barrier
ds_read_b128 v[12:15], v3 offset:3200
v_mov_b64 v[40:41], 0
v_smfmac_f32_16x16x64_bf16 v[36:39], v[44:47], v[224:231], v1
s_waitcnt vmcnt(4)
ds_read_b128 v[4:7], v3 offset:2176
ds_read_b128 v[8:11], v3 offset:3072
v_smfmac_f32_16x16x64_bf16 v[28:31], v[44:47], v[48:55], v1
v_mov_b64 v[42:43], 0
v_smfmac_f32_16x16x64_bf16 v[24:27], v[44:47], v[64:71], v1
ds_read_b128 v[64:67], v2 offset:51200
ds_read_b128 v[68:71], v2 offset:52224
v_smfmac_f32_16x16x64_bf16 v[40:43], v[44:47], v[240:247], v1
s_waitcnt lgkmcnt(4)
ds_read_b128 v[48:51], v0 offset:20480
v_smfmac_f32_16x16x64_bf16 v[24:27], v[12:15], v[192:199], v1
s_waitcnt lgkmcnt(3)
v_smfmac_f32_16x16x64_bf16 v[24:27], v[4:7], v[176:183], v1
ds_read_b128 v[52:55], v0 offset:21504
v_smfmac_f32_16x16x64_bf16 v[24:27], v[8:11], v[184:191], v1
v_smfmac_f32_16x16x64_bf16 v[36:39], v[12:15], v[232:239], v1
s_waitcnt lgkmcnt(2)
s_waitcnt vmcnt(2)
v_lshrrev_b32 v44, 16, v1
v_cvt_pk_bf16_f32 v24, v24, v25
v_bfi_b32 v24, 1, s45, v24
v_smfmac_f32_16x16x64_bf16 v[28:31], v[12:15], v[56:63], v1
ds_read_b128 v[56:59], v2 offset:22528
v_cvt_pk_bf16_f32 v25, v26, v27
v_smfmac_f32_16x16x64_bf16 v[28:31], v[4:7], v[64:71], v1
s_waitcnt lgkmcnt(1)
buffer_store_dwordx2 v[24:25], v44, s[4:7], s38 offen
ds_read_b128 v[64:67], v2 offset:45056
v_smfmac_f32_16x16x64_bf16 v[28:31], v[8:11], v[48:55], v1
ds_read_b128 v[68:71], v2 offset:46080
ds_read_b128 v[48:51], v2 offset:16384
ds_read_b128 v[52:55], v2 offset:17408
v_smfmac_f32_16x16x64_bf16 v[32:35], v[12:15], v[216:223], v1
v_cvt_pk_bf16_f32 v28, v28, v29
v_cvt_pk_bf16_f32 v29, v30, v31
v_bfi_b32 v28, 1, s45, v28
v_smfmac_f32_16x16x64_bf16 v[32:35], v[8:11], v[208:215], v1
buffer_store_dwordx2 v[28:29], v44, s[4:7], s39 offen
ds_read_b128 v[60:63], v2 offset:23552
s_waitcnt vmcnt(2)
v_smfmac_f32_16x16x64_bf16 v[32:35], v[4:7], v[16:23], v1
s_waitcnt lgkmcnt(3)
ds_read_b128 v[16:19], v2 offset:24576
v_smfmac_f32_16x16x64_bf16 v[36:39], v[4:7], v[64:71], v1
ds_read_b128 v[20:23], v2 offset:25600
s_waitcnt lgkmcnt(3)
v_cvt_pk_bf16_f32 v32, v32, v33
v_cvt_pk_bf16_f32 v33, v34, v35
v_bfi_b32 v32, 1, s45, v32
v_smfmac_f32_16x16x64_bf16 v[36:39], v[8:11], v[48:55], v1
s_waitcnt lgkmcnt(2)
buffer_store_dwordx2 v[32:33], v44, s[4:7], s40 offen
v_smfmac_f32_16x16x64_bf16 v[40:43], v[12:15], v[248:255], v1
s_nop 2
v_cvt_pk_bf16_f32 v36, v36, v37
v_cvt_pk_bf16_f32 v37, v38, v39
v_bfi_b32 v36, 1, s45, v36
s_waitcnt lgkmcnt(0)
v_smfmac_f32_16x16x64_bf16 v[40:43], v[8:11], v[16:23], v1
buffer_store_dwordx2 v[36:37], v44, s[4:7], s41 offen
v_smfmac_f32_16x16x64_bf16 v[40:43], v[4:7], v[56:63], v1
s_nop 6
v_cvt_pk_bf16_f32 v40, v40, v41
v_cvt_pk_bf16_f32 v41, v42, v43
v_bfi_b32 v40, 1, s45, v40
buffer_store_dwordx2 v[40:41], v44, s[4:7], s42 offen
v_lshlrev_b32 v3, v0, s58
v_cndmask_b32 v16, 0, v3, s[12:13]
v_cndmask_b32 v17, 0, v3, s[14:15]
v_cndmask_b32 v18, 0, v3, s[16:17]
v_cndmask_b32 v19, 0, v3, s[18:19]
s_barrier
buffer_load_dwordx4 v[24:27], v0, s[4:7], s43 offen offset:0 sc1
buffer_load_dwordx4 v[28:31], v0, s[4:7], s43 offen offset:1024 sc1
buffer_load_dwordx4 v[32:35], v0, s[4:7], s43 offen offset:2048 sc1
buffer_load_dwordx4 v[36:39], v0, s[4:7], s43 offen offset:3072 sc1
v_and_b32 v45, 0x30, v0
v_lshrrev_b32 v46, 8, v0
v_lshl_or_b32 v45, v46, 2, v45
v_bfe_u32 v46, v0, 6, 1
v_lshl_or_b32 v45, v46, 7, v45
v_cndmask_b32 v45, v45, 2.0, s[98:99]
v_cndmask_b32 v20, 0, v3, s[90:91]
v_cndmask_b32 v21, 0, v3, s[92:93]
v_cndmask_b32 v22, 0, v3, s[94:95]
v_cndmask_b32 v23, 0, v3, s[96:97]
s_add_u32 s33, s33, 16384
s_bitset0_b32 s33, 16
s_add_u32 s34, s33, 2048
s_add_u32 s35, s33, 6144
s_add_u32 s36, s36, 524288
s_add_u32 s31, s31, 1
s_buffer_load_dwordx2 s[66:67], s[4:7], s46 glc
ds_read_b128 v[56:59], v0 offset:8192
ds_read_b128 v[60:63], v0 offset:9216
ds_read_b128 v[64:67], v0 offset:10240
ds_read_b128 v[68:71], v0 offset:11264
buffer_load_dwordx4 v[48:51], v0, s[4:7], s60 offen offset:0
buffer_load_dwordx4 v[52:55], v0, s[4:7], s60 offen offset:1024
s_waitcnt vmcnt(5)
v_mfma_f32_16x16x32_bf16 v[40:43], v[24:27], v[16:19], 0
s_waitcnt vmcnt(4)
v_mfma_f32_16x16x32_bf16 v[40:43], v[28:31], v[16:19], v[40:43]
v_bitop3_b32 v46, v24, v28, s45 bitop3:0x7e
s_waitcnt vmcnt(3)
v_mfma_f32_16x16x32_bf16 v[40:43], v[32:35], v[16:19], v[40:43]
s_waitcnt vmcnt(2)
v_mfma_f32_16x16x32_bf16 v[40:43], v[36:39], v[16:19], v[40:43]
v_bitop3_b32 v47, v32, v36, s45 bitop3:0x7e
v_bitop3_b32 v46, v46, v47, 1 bitop3:0xa8
v_cmp_ne_u32 vcc, 0, v46
v_mov_b64 v[24:25], 0
v_mov_b64 v[26:27], 0
v_mov_b64 v[28:29], 0
v_mov_b64 v[30:31], 0
v_permlane32_swap_b32 v40, v41
v_permlane32_swap_b32 v42, v43
v_add_f32 v40, v40, v41
v_add_f32 v41, v42, v43
v_cvt_pk_bf16_f32 v42, v40, v41
s_cbranch_vccnz k_r1_126
k_ok1_127:
buffer_store_dword v42, v45, s[4:7], s44 offen
s_barrier
v_mov_b64 v[32:33], 0
v_mov_b64 v[34:35], 0
v_mov_b64 v[36:37], 0
v_mov_b64 v[38:39], 0
v_mov_b64 v[40:41], 0
v_mov_b64 v[42:43], 0
v_mov_b64 v[44:45], 0
v_mov_b64 v[46:47], 0
buffer_load_dwordx4 v[4:7], v0, s[4:7], s33 offen offset:0 sc1
buffer_load_dwordx4 v[8:11], v0, s[4:7], s33 offen offset:1024 sc1
s_add_u32 s44, s44, 16384
s_bitset0_b32 s44, 16
s_sub_u32 s45, s45, 1
s_waitcnt lgkmcnt(0)
buffer_load_dwordx4 v[12:15], v0, s[4:7], s34 offen offset:0 sc1
s_min_u32 s66, s66, s67
s_cmp_gt_u32 s66, s31
s_cbranch_scc0 k_fl_128
k_okF_130:
buffer_load_dwordx4 v[16:19], v0, s[4:7], s35 offen offset:0 sc1
s_barrier
s_cmp_lg_u32 s31, s47
s_cbranch_scc1 k_T0_119
s_branch k_done_125
k_cold_120:
s_sub_u32 s32, s32, 1
s_cmp_gt_i32 s32, 0
s_cbranch_scc0 k_okC_122
k_cold2_121:
s_waitcnt lgkmcnt(0)
buffer_load_dwordx4 v[4:7], v0, s[4:7], s33 offen offset:0 sc1
buffer_load_dwordx4 v[8:11], v0, s[4:7], s33 offen offset:1024 sc1
buffer_load_dwordx4 v[12:15], v0, s[4:7], s34 offen offset:0 sc1
buffer_load_dwordx4 v[16:19], v0, s[4:7], s35 offen offset:0 sc1
buffer_load_dwordx4 v[48:51], v0, s[4:7], s60 offen offset:0
buffer_load_dwordx4 v[52:55], v0, s[4:7], s60 offen offset:1024
s_waitcnt vmcnt(9)
ds_read_b128 v[56:59], v0 offset:8192
s_waitcnt vmcnt(8)
ds_read_b128 v[60:63], v0 offset:9216
ds_read_b128 v[64:67], v0 offset:10240
ds_read_b128 v[68:71], v0 offset:11264
v_mov_b64 v[24:25], 0
v_mov_b64 v[26:27], 0
v_mov_b64 v[28:29], 0
v_mov_b64 v[30:31], 0
v_mov_b64 v[32:33], 0
v_mov_b64 v[34:35], 0
v_mov_b64 v[36:37], 0
v_mov_b64 v[38:39], 0
v_mov_b64 v[40:41], 0
v_mov_b64 v[42:43], 0
v_mov_b64 v[44:45], 0
v_mov_b64 v[46:47], 0
s_waitcnt vmcnt(0)
s_branch k_T0_119
k_fl_128:
buffer_load_dwordx2 v[46:47], off, s[4:7], s46 sc1
s_waitcnt vmcnt(0)
v_min_u32 v46, v46, v47
v_cmp_lt_u32 vcc, s31, v46
v_mov_b64 v[46:47], 0
s_cbranch_vccnz k_okF_130
s_sub_u32 s32, s32, 1
s_cmp_gt_i32 s32, 0
s_cbranch_scc1 k_fl_128
s_branch k_okF_130
k_r1_126:
buffer_load_dwordx4 v[24:27], v0, s[4:7], s43 offen offset:0 sc1
buffer_load_dwordx4 v[28:31], v0, s[4:7], s43 offen offset:1024 sc1
buffer_load_dwordx4 v[32:35], v0, s[4:7], s43 offen offset:2048 sc1
buffer_load_dwordx4 v[36:39], v0, s[4:7], s43 offen offset:3072 sc1
s_sub_u32 s32, s32, 1
s_cmp_gt_i32 s32, 0
s_waitcnt vmcnt(3)
v_mfma_f32_16x16x32_bf16 v[40:43], v[24:27], v[16:19], 0
s_waitcnt vmcnt(2)
v_mfma_f32_16x16x32_bf16 v[40:43], v[28:31], v[16:19], v[40:43]
v_bitop3_b32 v46, v24, v28, s45 bitop3:0x7e
s_waitcnt vmcnt(1)
v_mfma_f32_16x16x32_bf16 v[40:43], v[32:35], v[16:19], v[40:43]
s_waitcnt vmcnt(0)
v_mfma_f32_16x16x32_bf16 v[40:43], v[36:39], v[16:19], v[40:43]
v_bitop3_b32 v47, v32, v36, s45 bitop3:0x7e
v_bitop3_b32 v46, v46, v47, 1 bitop3:0xa8
v_cmp_ne_u32 vcc, 0, v46
v_mov_b64 v[24:25], 0
v_mov_b64 v[26:27], 0
v_mov_b64 v[28:29], 0
v_mov_b64 v[30:31], 0
v_permlane32_swap_b32 v40, v41
v_permlane32_swap_b32 v42, v43
v_add_f32 v40, v40, v41
v_add_f32 v41, v42, v43
v_cvt_pk_bf16_f32 v42, v40, v41
s_cbranch_vccz k_ok1_127
s_cbranch_scc1 k_r1_126
s_branch k_ok1_127
k_slow_123:
ds_read_b128 v[24:27], v0 offset:4096
ds_read_b128 v[28:31], v0 offset:5120
v_mov_b32 v46, 0xff7fffff
s_add_u32 s48, s36, 0x0
buffer_load_dwordx4 v[32:35], v0, s[4:7], s48 offen offset:0 sc1
buffer_load_dwordx4 v[36:39], v0, s[4:7], s48 offen offset:1024 sc1
s_waitcnt vmcnt(1) lgkmcnt(1)
v_mfma_f32_16x16x32_bf16 v[4:7], v[32:35], v[24:27], 0
s_waitcnt vmcnt(0) lgkmcnt(0)
v_mfma_f32_16x16x32_bf16 v[4:7], v[36:39], v[28:31], v[4:7]
v_mov_b64 v[8:9], s[56:57]
s_nop 5
v_permlane32_swap_b32 v4, v6
v_permlane32_swap_b32 v5, v7
v_add_f32_dpp v8, v6, v4 row_ror:8 row_mask:0xf bank_mask:0x3
s_nop 0
v_add_f32_dpp v9, v7, v5 row_ror:8 row_mask:0xf bank_mask:0x3
v_max3_f32 v46, v46, v8, v9
s_add_u32 s48, s36, 0x1000
buffer_load_dwordx4 v[32:35], v0, s[4:7], s48 offen offset:0 sc1
buffer_load_dwordx4 v[36:39], v0, s[4:7], s48 offen offset:1024 sc1
s_waitcnt vmcnt(1)
v_mfma_f32_16x16x32_bf16 v[4:7], v[32:35], v[24:27], 0
s_waitcnt vmcnt(0)
v_mfma_f32_16x16x32_bf16 v[4:7], v[36:39], v[28:31], v[4:7]
v_mov_b64 v[10:11], s[56:57]
s_nop 5
v_permlane32_swap_b32 v4, v6
v_permlane32_swap_b32 v5, v7
v_add_f32_dpp v10, v6, v4 row_ror:8 row_mask:0xf bank_mask:0x3
s_nop 0
v_add_f32_dpp v11, v7, v5 row_ror:8 row_mask:0xf bank_mask:0x3
v_max3_f32 v46, v46, v10, v11
s_add_u32 s48, s36, 0x2000
buffer_load_dwordx4 v[32:35], v0, s[4:7], s48 offen offset:0 sc1
buffer_load_dwordx4 v[36:39], v0, s[4:7], s48 offen offset:1024 sc1
s_waitcnt vmcnt(1)
v_mfma_f32_16x16x32_bf16 v[4:7], v[32:35], v[24:27], 0
s_waitcnt vmcnt(0)
v_mfma_f32_16x16x32_bf16 v[4:7], v[36:39], v[28:31], v[4:7]
v_mov_b64 v[12:13], s[56:57]
s_nop 5
v_permlane32_swap_b32 v4, v6
v_permlane32_swap_b32 v5, v7
v_add_f32_dpp v12, v6, v4 row_ror:8 row_mask:0xf bank_mask:0x3
s_nop 0
v_add_f32_dpp v13, v7, v5 row_ror:8 row_mask:0xf bank_mask:0x3
v_max3_f32 v46, v46, v12, v13
s_add_u32 s48, s36, 0x3000
buffer_load_dwordx4 v[32:35], v0, s[4:7], s48 offen offset:0 sc1
buffer_load_dwordx4 v[36:39], v0, s[4:7], s48 offen offset:1024 sc1
s_waitcnt vmcnt(1)
v_mfma_f32_16x16x32_bf16 v[4:7], v[32:35], v[24:27], 0
s_waitcnt vmcnt(0)
v_mfma_f32_16x16x32_bf16 v[4:7], v[36:39], v[28:31], v[4:7]
v_mov_b64 v[14:15], s[56:57]
s_nop 5
v_permlane32_swap_b32 v4, v6
v_permlane32_swap_b32 v5, v7
v_add_f32_dpp v14, v6, v4 row_ror:8 row_mask:0xf bank_mask:0x3
s_nop 0
v_add_f32_dpp v15, v7, v5 row_ror:8 row_mask:0xf bank_mask:0x3
v_max3_f32 v46, v46, v14, v15
ds_read_b128 v[32:35], v0 offset:6144
ds_read_b128 v[36:39], v0 offset:7168
s_waitcnt lgkmcnt(1)
v_mfma_f32_16x16x32_bf16 v[4:7], v[32:35], v[24:27], 0
s_waitcnt lgkmcnt(0)
v_mfma_f32_16x16x32_bf16 v[4:7], v[36:39], v[28:31], v[4:7]
v_mov_b64 v[44:45], s[56:57]
s_nop 5
v_permlane32_swap_b32 v4, v6
v_permlane32_swap_b32 v5, v7
v_add_f32_dpp v44, v6, v4 row_ror:8 row_mask:0xf bank_mask:0x3
s_nop 0
v_add_f32_dpp v45, v7, v5 row_ror:8 row_mask:0xf bank_mask:0x3
v_max3_f32 v46, v46, v44, v45
buffer_load_dwordx4 v[32:35], v0, s[4:7], s36 offen offset:2048 sc1
buffer_load_dwordx4 v[36:39], v0, s[4:7], s36 offen offset:3072 sc1
v_mov_b32 v47, v46
s_nop 1
v_permlane32_swap_b32 v46, v47
v_max_f32 v46, v46, v47
v_mov_b32 v47, v46
s_nop 1
v_permlane16_swap_b32 v46, v47
v_max_f32 v46, v46, v47
v_sub_f32 v8, v8, v46
v_exp_f32 v8, v8
v_sub_f32 v9, v9, v46
v_exp_f32 v9, v9
v_sub_f32 v10, v10, v46
v_exp_f32 v10, v10
v_sub_f32 v11, v11, v46
v_exp_f32 v11, v11
v_sub_f32 v12, v12, v46
v_exp_f32 v12, v12
v_sub_f32 v13, v13, v46
v_exp_f32 v13, v13
v_sub_f32 v14, v14, v46
v_exp_f32 v14, v14
v_sub_f32 v15, v15, v46
v_exp_f32 v15, v15
v_sub_f32 v44, v44, v46
v_exp_f32 v44, v44
v_sub_f32 v45, v45, v46
v_exp_f32 v45, v45
v_cvt_pk_bf16_f32 v4, v8, v9
v_cvt_pk_bf16_f32 v5, v10, v11
v_cvt_pk_bf16_f32 v6, v12, v13
v_cvt_pk_bf16_f32 v7, v14, v15
v_mov_b32_dpp v8, v4 row_ror:8 row_mask:0xf bank_mask:0xf
v_mov_b32_dpp v9, v5 row_ror:8 row_mask:0xf bank_mask:0xf
v_mov_b32_dpp v10, v6 row_ror:8 row_mask:0xf bank_mask:0xf
v_mov_b32_dpp v11, v7 row_ror:8 row_mask:0xf bank_mask:0xf
v_cvt_pk_bf16_f32 v24, v44, v45
v_cvt_pk_bf16_f32 v25, v44, v45
s_nop 0
v_mov_b32_dpp v26, v24 row_ror:8 row_mask:0xf bank_mask:0xf
v_mov_b32_dpp v27, v24 row_ror:8 row_mask:0xf bank_mask:0xf
v_mov_b64 v[28:29], s[52:53]
v_mov_b64 v[30:31], s[52:53]
s_nop 1
v_mfma_f32_16x16x32_bf16 v[44:47], v[28:31], v[4:7], 0
s_waitcnt vmcnt(1)
v_mfma_f32_16x16x32_bf16 v[12:15], v[32:35], v[4:7], 0
s_waitcnt vmcnt(0)
v_mfma_f32_16x16x32_bf16 v[12:15], v[36:39], v[8:11], v[12:15]
v_mfma_f32_16x16x32_bf16 v[12:15], v[40:43], v[24:27], v[12:15]
v_mov_b64 v[28:29], s[54:55]
s_nop 1
v_mfma_f32_16x16x16_bf16 v[44:47], v[28:29], v[24:25], v[44:47]
s_nop 6
v_rcp_f32 v4, v44
s_nop 1
v_rcp_f32_dpp v4, v44 row_ror:8 row_mask:0xf bank_mask:0xc
s_nop 0
v_mul_f32 v12, v4, v12
v_mul_f32 v13, v4, v13
v_mul_f32 v14, v4, v14
v_mul_f32 v15, v4, v15
v_cvt_pk_bf16_f32 v44, v12, v13
v_cvt_pk_bf16_f32 v45, v14, v15
v_and_or_b32 v8, v1, 8, v3
ds_write_b64 v8, v[44:45] offset:2048
v_mov_b32_dpp v46, v44 row_ror:8 row_mask:0xf bank_mask:0xf
v_mov_b32_dpp v47, v45 row_ror:8 row_mask:0xf bank_mask:0xf
v_mov_b64 v[24:25], 0
v_mov_b64 v[26:27], 0
v_mov_b64 v[28:29], 0
v_mov_b64 v[30:31], 0
v_mov_b64 v[32:33], 0
v_mov_b64 v[34:35], 0
v_mov_b64 v[36:37], 0
v_mov_b64 v[38:39], 0
s_waitcnt lgkmcnt(0)
s_branch k_okS_124
k_done_125:
s_add_u32 s31, s31, 1
s_cmp_lt_u32 s31, 128
s_cbranch_scc1 k_lay_114
s_add_u32 s30, s30, 112
s_waitcnt vmcnt(0) lgkmcnt(0)
s_barrier
s_branch k_fin_7
k_w1_109:
v_lshrrev_b32 v12, 3, v0
v_lshlrev_b32 v10, 13, v12
v_bfe_u32 v12, v0, 1, 2
v_lshrrev_b32 v13, 4, v0
v_xor_b32 v12, v12, v13
v_lshl_add_u32 v10, v12, 5, v10
v_and_b32 v14, 1, v0
v_lshl_add_u32 v10, v14, 4, v10
v_mul_u32_u24 v11, 1280, v13
v_bfe_u32 v12, v0, 1, 3
v_and_b32 v13, 1, v13
v_lshlrev_b32 v13, 1, v13
v_xor_b32 v12, v12, v13
v_xor_b32 v12, 0, v12
v_lshl_add_u32 v11, v12, 5, v11
v_lshl_add_u32 v11, v14, 4, v11
v_bfe_u32 v12, v0, 5, 1
v_lshlrev_b32 v12, 4, v12
v_bfe_u32 v13, v0, 4, 1
v_lshl_add_u32 v12, v13, 1, v12
v_bfe_u32 v13, v0, 2, 1
v_lshl_add_u32 v12, v13, 2, v12
v_bfe_u32 v13, v0, 3, 1
v_mul_u32_u24 v15, 4224, v13
v_add_u32 v12, v13, v12
v_bfe_u32 v13, v12, 1, 2
v_xor_b32 v13, 1, v13
v_lshlrev_b32 v13, 5, v13
v_lshl_add_u32 v4, v12, 7, v13
v_and_b32 v14, 3, v0
v_lshl_add_u32 v4, v14, 3, v4
v_add_u32 v5, 0x10000, v4
v_add_u32 v6, 0x20000, v4
v_bfe_u32 v12, v0, 4, 1
v_lshlrev_b32 v13, 4, v12
v_lshlrev_b32 v12, 2, v12
v_bfe_u32 v8, v0, 5, 1
v_lshl_add_u32 v13, v8, 2, v13
v_bfe_u32 v8, v0, 2, 1
v_add_u32 v13, v8, v13
v_lshl_add_u32 v12, v8, 1, v12
v_bfe_u32 v8, v0, 3, 1
v_add_u32 v8, 2, v8
v_xor_b32 v12, v12, v8
v_lshlrev_b32 v12, 5, v12
v_lshl_add_u32 v7, v13, 8, v12
v_lshl_add_u32 v7, v14, 3, v7
v_add_u32 v8, 0x10000, v7
v_add_u32 v9, 0x20000, v7
v_lshlrev_b32 v0, 4, v0
v_add_u32 v2, 98304, v0
s_lshl_b32 s49, s30, 8
s_mul_i32 s50, s30, 163840
s_mul_i32 s60, s30, 131072
s_add_u32 s60, s60, 120619008
s_add_u32 s61, s60, 4096
s_add_u32 s62, s60, 8192
s_mov_b32 m0, 2048
s_add_u32 s48, s49, 131072
buffer_load_dwordx4 v10, s[8:11], s48 offen lds
s_mov_b32 m0, 3072
s_add_u32 s48, s49, 196608
buffer_load_dwordx4 v10, s[8:11], s48 offen lds
s_mov_b32 m0, 10240
s_add_u32 s48, s49, 131200
buffer_load_dwordx4 v10, s[12:15], s48 offen lds
s_mov_b32 m0, 11264
s_add_u32 s48, s49, 196736
buffer_load_dwordx4 v10, s[12:15], s48 offen lds
s_mov_b32 m0, 18432
s_add_u32 s48, s49, 131072
buffer_load_dwordx4 v10, s[16:19], s48 offen lds
s_mov_b32 m0, 19456
s_add_u32 s48, s49, 196608
buffer_load_dwordx4 v10, s[16:19], s48 offen lds
s_mov_b32 m0, 26624
s_add_u32 s48, s49, 131200
buffer_load_dwordx4 v10, s[16:19], s48 offen lds
s_mov_b32 m0, 27648
s_add_u32 s48, s49, 196736
buffer_load_dwordx4 v10, s[16:19], s48 offen lds
s_mov_b32 m0, 34816
s_add_u32 s48, s49, 655360
buffer_load_dwordx4 v10, s[8:11], s48 offen lds
s_mov_b32 m0, 35840
s_add_u32 s48, s49, 720896
buffer_load_dwordx4 v10, s[8:11], s48 offen lds
s_mov_b32 m0, 43008
s_add_u32 s48, s49, 655488
buffer_load_dwordx4 v10, s[12:15], s48 offen lds
s_mov_b32 m0, 44032
s_add_u32 s48, s49, 721024
buffer_load_dwordx4 v10, s[12:15], s48 offen lds
s_mov_b32 m0, 51200
s_add_u32 s48, s49, 655360
buffer_load_dwordx4 v10, s[16:19], s48 offen lds
s_mov_b32 m0, 52224
s_add_u32 s48, s49, 720896
buffer_load_dwordx4 v10, s[16:19], s48 offen lds
s_mov_b32 m0, 59392
s_add_u32 s48, s49, 655488
buffer_load_dwordx4 v10, s[16:19], s48 offen lds
s_mov_b32 m0, 60416
s_add_u32 s48, s49, 721024
buffer_load_dwordx4 v10, s[16:19], s48 offen lds
s_mov_b32 m0, 67584
s_add_u32 s48, s49, 1179648
buffer_load_dwordx4 v10, s[8:11], s48 offen lds
s_mov_b32 m0, 68608
s_add_u32 s48, s49, 1245184
buffer_load_dwordx4 v10, s[8:11], s48 offen lds
s_mov_b32 m0, 75776
s_add_u32 s48, s49, 1179776
buffer_load_dwordx4 v10, s[12:15], s48 offen lds
s_mov_b32 m0, 76800
s_add_u32 s48, s49, 1245312
buffer_load_dwordx4 v10, s[12:15], s48 offen lds
s_mov_b32 m0, 83968
s_add_u32 s48, s49, 3276800
buffer_load_dwordx4 v10, s[12:15], s48 offen lds
s_mov_b32 m0, 84992
s_add_u32 s48, s49, 3342336
buffer_load_dwordx4 v10, s[12:15], s48 offen lds
s_mov_b32 m0, 92160
s_add_u32 s48, s49, 3276928
buffer_load_dwordx4 v10, s[12:15], s48 offen lds
s_mov_b32 m0, 93184
s_add_u32 s48, s49, 3342464
buffer_load_dwordx4 v10, s[12:15], s48 offen lds
s_mov_b32 m0, 100352
s_add_u32 s48, s49, 3276800
buffer_load_dwordx4 v10, s[16:19], s48 offen lds
s_mov_b32 m0, 101376
s_add_u32 s48, s49, 3342336
buffer_load_dwordx4 v10, s[16:19], s48 offen lds
s_mov_b32 m0, 108544
s_add_u32 s48, s49, 3276928
buffer_load_dwordx4 v10, s[16:19], s48 offen lds
s_mov_b32 m0, 109568
s_add_u32 s48, s49, 3342464
buffer_load_dwordx4 v10, s[16:19], s48 offen lds
s_mov_b32 m0, 116736
s_add_u32 s48, s49, 1703936
buffer_load_dwordx4 v10, s[8:11], s48 offen lds
s_mov_b32 m0, 117760
s_add_u32 s48, s49, 1769472
buffer_load_dwordx4 v10, s[8:11], s48 offen lds
s_mov_b32 m0, 124928
s_add_u32 s48, s49, 2228224
buffer_load_dwordx4 v10, s[8:11], s48 offen lds
s_mov_b32 m0, 125952
s_add_u32 s48, s49, 2293760
buffer_load_dwordx4 v10, s[8:11], s48 offen lds
s_waitcnt vmcnt(24)
s_barrier
s_mov_b32 m0, 133120
s_add_u32 s48, s49, 2752512
buffer_load_dwordx4 v10, s[8:11], s48 offen lds
s_mov_b32 m0, 134144
s_add_u32 s48, s49, 2818048
buffer_load_dwordx4 v10, s[8:11], s48 offen lds
s_mov_b32 m0, 141312
s_add_u32 s48, s49, 3801088
buffer_load_dwordx4 v10, s[8:11], s48 offen lds
s_mov_b32 m0, 142336
s_add_u32 s48, s49, 3866624
buffer_load_dwordx4 v10, s[8:11], s48 offen lds
s_mov_b32 m0, 149504
s_add_u32 s48, s49, 3801216
buffer_load_dwordx4 v10, s[8:11], s48 offen lds
s_mov_b32 m0, 150528
s_add_u32 s48, s49, 3866752
buffer_load_dwordx4 v10, s[8:11], s48 offen lds
s_mov_b32 m0, 157696
s_add_u32 s48, s49, 4325376
buffer_load_dwordx4 v10, s[8:11], s48 offen lds
s_mov_b32 m0, 158720
s_add_u32 s48, s49, 4390912
buffer_load_dwordx4 v10, s[8:11], s48 offen lds
ds_read_b64_tr_b16 a[24:25], v4 offset:0
ds_read_b64_tr_b16 a[26:27], v4 offset:1024
ds_read_b64_tr_b16 a[28:29], v4 offset:4096
ds_read_b64_tr_b16 a[30:31], v4 offset:5120
ds_read_b64_tr_b16 a[32:33], v4 offset:8192
ds_read_b64_tr_b16 a[34:35], v4 offset:9216
ds_read_b64_tr_b16 a[36:37], v4 offset:12288
ds_read_b64_tr_b16 a[38:39], v4 offset:13312
ds_read_b64_tr_b16 a[40:41], v4 offset:16384
ds_read_b64_tr_b16 a[42:43], v4 offset:17408
ds_read_b64_tr_b16 a[44:45], v4 offset:20480
ds_read_b64_tr_b16 a[46:47], v4 offset:21504
ds_read_b64_tr_b16 a[48:49], v4 offset:24576
ds_read_b64_tr_b16 a[50:51], v4 offset:25600
ds_read_b64_tr_b16 a[52:53], v4 offset:28672
ds_read_b64_tr_b16 a[54:55], v4 offset:29696
s_waitcnt lgkmcnt(0)
s_waitcnt vmcnt(24)
s_barrier
s_mov_b32 m0, 2048
s_add_u32 s48, s49, 4325504
buffer_load_dwordx4 v10, s[8:11], s48 offen lds
s_mov_b32 m0, 3072
s_add_u32 s48, s49, 4391040
buffer_load_dwordx4 v10, s[8:11], s48 offen lds
s_mov_b32 m0, 10240
s_add_u32 s48, s49, 4849664
buffer_load_dwordx4 v10, s[8:11], s48 offen lds
s_mov_b32 m0, 11264
s_add_u32 s48, s49, 4915200
buffer_load_dwordx4 v10, s[8:11], s48 offen lds
s_mov_b32 m0, 18432
s_add_u32 s48, s49, 4849792
buffer_load_dwordx4 v10, s[8:11], s48 offen lds
s_mov_b32 m0, 19456
s_add_u32 s48, s49, 4915328
buffer_load_dwordx4 v10, s[8:11], s48 offen lds
s_mov_b32 m0, 26624
s_add_u32 s48, s49, 3801088
buffer_load_dwordx4 v10, s[12:15], s48 offen lds
s_mov_b32 m0, 27648
s_add_u32 s48, s49, 3866624
buffer_load_dwordx4 v10, s[12:15], s48 offen lds
ds_read_b64_tr_b16 v[16:17], v4 offset:32768
ds_read_b64_tr_b16 v[18:19], v4 offset:33792
ds_read_b64_tr_b16 v[20:21], v4 offset:36864
ds_read_b64_tr_b16 v[22:23], v4 offset:37888
ds_read_b64_tr_b16 a[0:1], v4 offset:40960
ds_read_b64_tr_b16 a[2:3], v4 offset:41984
ds_read_b64_tr_b16 a[4:5], v4 offset:45056
ds_read_b64_tr_b16 a[6:7], v4 offset:46080
ds_read_b64_tr_b16 a[8:9], v4 offset:49152
ds_read_b64_tr_b16 a[10:11], v4 offset:50176
ds_read_b64_tr_b16 a[12:13], v4 offset:53248
ds_read_b64_tr_b16 a[14:15], v4 offset:54272
ds_read_b64_tr_b16 a[16:17], v4 offset:57344
ds_read_b64_tr_b16 a[18:19], v4 offset:58368
ds_read_b64_tr_b16 a[20:21], v4 offset:61440
ds_read_b64_tr_b16 a[22:23], v4 offset:62464
s_waitcnt lgkmcnt(0)
buffer_store_dwordx4 v[16:19], v0, s[4:7], s60 offen offset:0
buffer_store_dwordx4 v[20:23], v0, s[4:7], s60 offen offset:1024
s_waitcnt vmcnt(26)
s_barrier
s_mov_b32 m0, 34816
s_add_u32 s48, s49, 3801216
buffer_load_dwordx4 v10, s[12:15], s48 offen lds
s_mov_b32 m0, 35840
s_add_u32 s48, s49, 3866752
buffer_load_dwordx4 v10, s[12:15], s48 offen lds
s_mov_b32 m0, 43008
s_add_u32 s48, s49, 3801088
buffer_load_dwordx4 v10, s[16:19], s48 offen lds
s_mov_b32 m0, 44032
s_add_u32 s48, s49, 3866624
buffer_load_dwordx4 v10, s[16:19], s48 offen lds
s_mov_b32 m0, 51200
s_add_u32 s48, s49, 3801216
buffer_load_dwordx4 v10, s[16:19], s48 offen lds
s_mov_b32 m0, 52224
s_add_u32 s48, s49, 3866752
buffer_load_dwordx4 v10, s[16:19], s48 offen lds
s_mov_b32 m0, 59392
s_add_u32 s48, s49, 4325376
buffer_load_dwordx4 v10, s[12:15], s48 offen lds
s_mov_b32 m0, 60416
s_add_u32 s48, s49, 4390912
buffer_load_dwordx4 v10, s[12:15], s48 offen lds
ds_read_b64_tr_b16 a[144:145], v5 offset:0
ds_read_b64_tr_b16 a[146:147], v5 offset:1024
ds_read_b64_tr_b16 a[148:149], v5 offset:4096
ds_read_b64_tr_b16 a[150:151], v5 offset:5120
ds_read_b64_tr_b16 v[88:89], v5 offset:8192
ds_read_b64_tr_b16 v[90:91], v5 offset:9216
ds_read_b64_tr_b16 v[92:93], v5 offset:12288
ds_read_b64_tr_b16 v[94:95], v5 offset:13312
ds_read_b64_tr_b16 a[240:241], v5 offset:16384
ds_read_b64_tr_b16 a[242:243], v5 offset:17408
ds_read_b64_tr_b16 a[244:245], v5 offset:20480
ds_read_b64_tr_b16 a[246:247], v5 offset:21504
ds_read_b64_tr_b16 v[248:249], v5 offset:24576
ds_read_b64_tr_b16 v[250:251], v5 offset:25600
ds_read_b64_tr_b16 v[252:253], v5 offset:28672
ds_read_b64_tr_b16 v[254:255], v5 offset:29696
s_waitcnt lgkmcnt(0)
s_waitcnt vmcnt(26)
s_barrier
s_mov_b32 m0, 67584
s_add_u32 s48, s49, 4325504
buffer_load_dwordx4 v10, s[12:15], s48 offen lds
s_mov_b32 m0, 68608
s_add_u32 s48, s49, 4391040
buffer_load_dwordx4 v10, s[12:15], s48 offen lds
s_mov_b32 m0, 75776
s_add_u32 s48, s49, 4325376
buffer_load_dwordx4 v10, s[16:19], s48 offen lds
s_mov_b32 m0, 76800
s_add_u32 s48, s49, 4390912
buffer_load_dwordx4 v10, s[16:19], s48 offen lds
s_mov_b32 m0, 83968
s_add_u32 s48, s49, 4325504
buffer_load_dwordx4 v10, s[16:19], s48 offen lds
s_mov_b32 m0, 84992
s_add_u32 s48, s49, 4391040
buffer_load_dwordx4 v10, s[16:19], s48 offen lds
s_mov_b32 m0, 92160
s_add_u32 s48, s49, 4849664
buffer_load_dwordx4 v10, s[12:15], s48 offen lds
s_mov_b32 m0, 93184
s_add_u32 s48, s49, 4915200
buffer_load_dwordx4 v10, s[12:15], s48 offen lds
ds_read_b64_tr_b16 a[248:249], v5 offset:32768
ds_read_b64_tr_b16 a[250:251], v5 offset:33792
ds_read_b64_tr_b16 a[252:253], v5 offset:36864
ds_read_b64_tr_b16 a[254:255], v5 offset:37888
ds_read_b64_tr_b16 v[72:73], v5 offset:40960
ds_read_b64_tr_b16 v[74:75], v5 offset:41984
ds_read_b64_tr_b16 v[76:77], v5 offset:45056
ds_read_b64_tr_b16 v[78:79], v5 offset:46080
ds_read_b64_tr_b16 a[56:57], v5 offset:49152
ds_read_b64_tr_b16 a[58:59], v5 offset:50176
ds_read_b64_tr_b16 a[60:61], v5 offset:53248
ds_read_b64_tr_b16 a[62:63], v5 offset:54272
ds_read_b64_tr_b16 a[120:121], v5 offset:57344
ds_read_b64_tr_b16 a[122:123], v5 offset:58368
ds_read_b64_tr_b16 a[124:125], v5 offset:61440
ds_read_b64_tr_b16 a[126:127], v5 offset:62464
s_waitcnt lgkmcnt(0)
s_waitcnt vmcnt(26)
s_barrier
s_mov_b32 m0, 100352
s_add_u32 s48, s49, 4849792
buffer_load_dwordx4 v10, s[12:15], s48 offen lds
s_mov_b32 m0, 101376
s_add_u32 s48, s49, 4915328
buffer_load_dwordx4 v10, s[12:15], s48 offen lds
s_mov_b32 m0, 108544
s_add_u32 s48, s49, 4849664
buffer_load_dwordx4 v10, s[16:19], s48 offen lds
s_mov_b32 m0, 109568
s_add_u32 s48, s49, 4915200
buffer_load_dwordx4 v10, s[16:19], s48 offen lds
s_mov_b32 m0, 116736
s_add_u32 s48, s49, 4849792
buffer_load_dwordx4 v10, s[16:19], s48 offen lds
s_mov_b32 m0, 117760
s_add_u32 s48, s49, 4915328
buffer_load_dwordx4 v10, s[16:19], s48 offen lds
s_mov_b32 m0, 124928
s_add_u32 s48, s49, 2752512
buffer_load_dwordx4 v10, s[12:15], s48 offen lds
s_mov_b32 m0, 125952
s_add_u32 s48, s49, 2818048
buffer_load_dwordx4 v10, s[12:15], s48 offen lds
ds_read_b64_tr_b16 a[128:129], v6 offset:0
ds_read_b64_tr_b16 a[130:131], v6 offset:1024
ds_read_b64_tr_b16 a[132:133], v6 offset:4096
ds_read_b64_tr_b16 a[134:135], v6 offset:5120
ds_read_b64_tr_b16 a[80:81], v6 offset:8192
ds_read_b64_tr_b16 a[82:83], v6 offset:9216
ds_read_b64_tr_b16 a[84:85], v6 offset:12288
ds_read_b64_tr_b16 a[86:87], v6 offset:13312
ds_read_b64_tr_b16 a[88:89], v6 offset:16384
ds_read_b64_tr_b16 a[90:91], v6 offset:17408
ds_read_b64_tr_b16 a[92:93], v6 offset:20480
ds_read_b64_tr_b16 a[94:95], v6 offset:21504
ds_read_b64_tr_b16 v[232:233], v6 offset:24576
ds_read_b64_tr_b16 v[234:235], v6 offset:25600
ds_read_b64_tr_b16 v[236:237], v6 offset:28672
ds_read_b64_tr_b16 v[238:239], v6 offset:29696
s_waitcnt lgkmcnt(0)
s_waitcnt vmcnt(26)
s_barrier
s_mov_b32 m0, 133120
s_add_u32 s48, s49, 2752640
buffer_load_dwordx4 v10, s[12:15], s48 offen lds
s_mov_b32 m0, 134144
s_add_u32 s48, s49, 2818176
buffer_load_dwordx4 v10, s[12:15], s48 offen lds
s_mov_b32 m0, 141312
s_add_u32 s48, s49, 1703936
buffer_load_dwordx4 v10, s[12:15], s48 offen lds
s_mov_b32 m0, 142336
s_add_u32 s48, s49, 1769472
buffer_load_dwordx4 v10, s[12:15], s48 offen lds
s_mov_b32 m0, 149504
s_add_u32 s48, s49, 1704064
buffer_load_dwordx4 v10, s[12:15], s48 offen lds
s_mov_b32 m0, 150528
s_add_u32 s48, s49, 1769600
buffer_load_dwordx4 v10, s[12:15], s48 offen lds
s_mov_b32 m0, 157696
s_add_u32 s48, s49, 2228224
buffer_load_dwordx4 v10, s[12:15], s48 offen lds
s_mov_b32 m0, 158720
s_add_u32 s48, s49, 2293760
buffer_load_dwordx4 v10, s[12:15], s48 offen lds
ds_read_b64_tr_b16 a[160:161], v4 offset:0
ds_read_b64_tr_b16 a[162:163], v4 offset:1024
ds_read_b64_tr_b16 a[164:165], v4 offset:4096
ds_read_b64_tr_b16 a[166:167], v4 offset:5120
ds_read_b64_tr_b16 a[168:169], v4 offset:8192
ds_read_b64_tr_b16 a[170:171], v4 offset:9216
ds_read_b64_tr_b16 a[172:173], v4 offset:12288
ds_read_b64_tr_b16 a[174:175], v4 offset:13312
ds_read_b64_tr_b16 a[176:177], v4 offset:16384
ds_read_b64_tr_b16 a[178:179], v4 offset:17408
ds_read_b64_tr_b16 a[180:181], v4 offset:20480
ds_read_b64_tr_b16 a[182:183], v4 offset:21504
ds_read_b64_tr_b16 a[136:137], v4 offset:24576
ds_read_b64_tr_b16 a[138:139], v4 offset:25600
ds_read_b64_tr_b16 a[140:141], v4 offset:28672
ds_read_b64_tr_b16 a[142:143], v4 offset:29696
s_waitcnt lgkmcnt(0)
s_waitcnt vmcnt(24)
s_barrier
s_mov_b32 m0, 2048
s_add_u32 s48, s49, 2228352
buffer_load_dwordx4 v10, s[12:15], s48 offen lds
s_mov_b32 m0, 3072
s_add_u32 s48, s49, 2293888
buffer_load_dwordx4 v10, s[12:15], s48 offen lds
s_mov_b32 m0, 10240
s_add_u32 s48, s49, 1703936
buffer_load_dwordx4 v10, s[16:19], s48 offen lds
s_mov_b32 m0, 11264
s_add_u32 s48, s49, 1769472
buffer_load_dwordx4 v10, s[16:19], s48 offen lds
s_mov_b32 m0, 18432
s_add_u32 s48, s49, 1704064
buffer_load_dwordx4 v10, s[16:19], s48 offen lds
s_mov_b32 m0, 19456
s_add_u32 s48, s49, 1769600
buffer_load_dwordx4 v10, s[16:19], s48 offen lds
s_mov_b32 m0, 26624
s_add_u32 s48, s49, 2752512
buffer_load_dwordx4 v10, s[16:19], s48 offen lds
s_mov_b32 m0, 27648
s_add_u32 s48, s49, 2818048
buffer_load_dwordx4 v10, s[16:19], s48 offen lds
ds_read_b64_tr_b16 a[96:97], v4 offset:32768
ds_read_b64_tr_b16 a[98:99], v4 offset:33792
ds_read_b64_tr_b16 a[100:101], v4 offset:36864
ds_read_b64_tr_b16 a[102:103], v4 offset:37888
ds_read_b64_tr_b16 a[104:105], v4 offset:40960
ds_read_b64_tr_b16 a[106:107], v4 offset:41984
ds_read_b64_tr_b16 a[108:109], v4 offset:45056
ds_read_b64_tr_b16 a[110:111], v4 offset:46080
ds_read_b64_tr_b16 a[112:113], v4 offset:49152
ds_read_b64_tr_b16 a[114:115], v4 offset:50176
ds_read_b64_tr_b16 a[116:117], v4 offset:53248
ds_read_b64_tr_b16 a[118:119], v4 offset:54272
ds_read_b64_tr_b16 v[40:41], v4 offset:57344
ds_read_b64_tr_b16 v[42:43], v4 offset:58368
ds_read_b64_tr_b16 v[44:45], v4 offset:61440
ds_read_b64_tr_b16 v[46:47], v4 offset:62464
s_waitcnt lgkmcnt(0)
buffer_store_dwordx4 v[40:43], v0, s[4:7], s60 offen offset:2048
buffer_store_dwordx4 v[44:47], v0, s[4:7], s60 offen offset:3072
s_waitcnt vmcnt(26)
s_barrier
s_mov_b32 m0, 34816
s_add_u32 s48, s49, 2752640
buffer_load_dwordx4 v10, s[16:19], s48 offen lds
s_mov_b32 m0, 35840
s_add_u32 s48, s49, 2818176
buffer_load_dwordx4 v10, s[16:19], s48 offen lds
s_mov_b32 m0, 43008
s_add_u32 s48, s49, 2228224
buffer_load_dwordx4 v10, s[16:19], s48 offen lds
s_mov_b32 m0, 44032
s_add_u32 s48, s49, 2293760
buffer_load_dwordx4 v10, s[16:19], s48 offen lds
s_mov_b32 m0, 51200
s_add_u32 s48, s49, 2228352
buffer_load_dwordx4 v10, s[16:19], s48 offen lds
s_mov_b32 m0, 52224
s_add_u32 s48, s49, 2293888
buffer_load_dwordx4 v10, s[16:19], s48 offen lds
s_mov_b32 m0, 59392
s_add_u32 s48, s49, 1179648
buffer_load_dwordx4 v10, s[16:19], s48 offen lds
s_mov_b32 m0, 60416
s_add_u32 s48, s49, 1245184
buffer_load_dwordx4 v10, s[16:19], s48 offen lds
ds_read_b64_tr_b16 a[192:193], v5 offset:0
ds_read_b64_tr_b16 a[194:195], v5 offset:1024
ds_read_b64_tr_b16 a[196:197], v5 offset:4096
ds_read_b64_tr_b16 a[198:199], v5 offset:5120
ds_read_b64_tr_b16 a[200:201], v5 offset:8192
ds_read_b64_tr_b16 a[202:203], v5 offset:9216
ds_read_b64_tr_b16 a[204:205], v5 offset:12288
ds_read_b64_tr_b16 a[206:207], v5 offset:13312
ds_read_b64_tr_b16 a[208:209], v5 offset:16384
ds_read_b64_tr_b16 a[210:211], v5 offset:17408
ds_read_b64_tr_b16 a[212:213], v5 offset:20480
ds_read_b64_tr_b16 a[214:215], v5 offset:21504
ds_read_b64_tr_b16 v[224:225], v5 offset:24576
ds_read_b64_tr_b16 v[226:227], v5 offset:25600
ds_read_b64_tr_b16 v[228:229], v5 offset:28672
ds_read_b64_tr_b16 v[230:231], v5 offset:29696
s_waitcnt lgkmcnt(0)
s_waitcnt vmcnt(26)
s_barrier
s_mov_b32 m0, 67584
s_add_u32 s48, s49, 1179776
buffer_load_dwordx4 v10, s[16:19], s48 offen lds
s_mov_b32 m0, 68608
s_add_u32 s48, s49, 1245312
buffer_load_dwordx4 v10, s[16:19], s48 offen lds
s_mov_b32 m0, 75776
s_add_u32 s48, s50, 10240
buffer_load_dwordx4 v11, s[20:23], s48 offen lds
s_mov_b32 m0, 76800
s_add_u32 s48, s50, 15360
buffer_load_dwordx4 v11, s[20:23], s48 offen lds
s_mov_b32 m0, 83968
s_add_u32 s48, s50, 30720
buffer_load_dwordx4 v11, s[20:23], s48 offen lds
s_mov_b32 m0, 84992
s_add_u32 s48, s50, 35840
buffer_load_dwordx4 v11, s[20:23], s48 offen lds
s_mov_b32 m0, 92160
s_add_u32 s48, s50, 51200
buffer_load_dwordx4 v11, s[20:23], s48 offen lds
s_mov_b32 m0, 93184
s_add_u32 s48, s50, 56320
buffer_load_dwordx4 v11, s[20:23], s48 offen lds
ds_read_b64_tr_b16 a[216:217], v5 offset:32768
ds_read_b64_tr_b16 a[218:219], v5 offset:33792
ds_read_b64_tr_b16 a[220:221], v5 offset:36864
ds_read_b64_tr_b16 a[222:223], v5 offset:37888
ds_read_b64_tr_b16 a[224:225], v5 offset:40960
ds_read_b64_tr_b16 a[226:227], v5 offset:41984
ds_read_b64_tr_b16 a[228:229], v5 offset:45056
ds_read_b64_tr_b16 a[230:231], v5 offset:46080
ds_read_b64_tr_b16 a[232:233], v5 offset:49152
ds_read_b64_tr_b16 a[234:235], v5 offset:50176
ds_read_b64_tr_b16 a[236:237], v5 offset:53248
ds_read_b64_tr_b16 a[238:239], v5 offset:54272
ds_read_b64_tr_b16 v[104:105], v5 offset:57344
ds_read_b64_tr_b16 v[106:107], v5 offset:58368
ds_read_b64_tr_b16 v[108:109], v5 offset:61440
ds_read_b64_tr_b16 v[110:111], v5 offset:62464
s_waitcnt lgkmcnt(0)
s_waitcnt vmcnt(26)
s_barrier
s_mov_b32 m0, 100352
s_add_u32 s48, s50, 71680
buffer_load_dwordx4 v11, s[20:23], s48 offen lds
s_mov_b32 m0, 101376
s_add_u32 s48, s50, 76800
buffer_load_dwordx4 v11, s[20:23], s48 offen lds
s_mov_b32 m0, 108544
s_add_u32 s48, s50, 10496
buffer_load_dwordx4 v11, s[20:23], s48 offen lds
s_mov_b32 m0, 109568
s_add_u32 s48, s50, 15616
buffer_load_dwordx4 v11, s[20:23], s48 offen lds
s_mov_b32 m0, 116736
s_add_u32 s48, s50, 30976
buffer_load_dwordx4 v11, s[20:23], s48 offen lds
s_mov_b32 m0, 117760
s_add_u32 s48, s50, 36096
buffer_load_dwordx4 v11, s[20:23], s48 offen lds
s_mov_b32 m0, 124928
s_add_u32 s48, s50, 51456
buffer_load_dwordx4 v11, s[20:23], s48 offen lds
s_mov_b32 m0, 125952
s_add_u32 s48, s50, 56576
buffer_load_dwordx4 v11, s[20:23], s48 offen lds
ds_read_b64_tr_b16 v[112:113], v6 offset:0
ds_read_b64_tr_b16 v[114:115], v6 offset:1024
ds_read_b64_tr_b16 v[116:117], v6 offset:4096
ds_read_b64_tr_b16 v[118:119], v6 offset:5120
ds_read_b64_tr_b16 a[64:65], v6 offset:8192
ds_read_b64_tr_b16 a[66:67], v6 offset:9216
ds_read_b64_tr_b16 a[68:69], v6 offset:12288
ds_read_b64_tr_b16 a[70:71], v6 offset:13312
ds_read_b64_tr_b16 a[72:73], v6 offset:16384
ds_read_b64_tr_b16 a[74:75], v6 offset:17408
ds_read_b64_tr_b16 a[76:77], v6 offset:20480
ds_read_b64_tr_b16 a[78:79], v6 offset:21504
ds_read_b64_tr_b16 v[240:241], v6 offset:24576
ds_read_b64_tr_b16 v[242:243], v6 offset:25600
ds_read_b64_tr_b16 v[244:245], v6 offset:28672
ds_read_b64_tr_b16 v[246:247], v6 offset:29696
s_waitcnt lgkmcnt(0)
s_waitcnt vmcnt(26)
s_barrier
s_mov_b32 m0, 133120
s_add_u32 s48, s50, 71936
buffer_load_dwordx4 v11, s[20:23], s48 offen lds
s_mov_b32 m0, 134144
s_add_u32 s48, s50, 77056
buffer_load_dwordx4 v11, s[20:23], s48 offen lds
s_mov_b32 m0, 141312
s_add_u32 s48, s50, 10752
buffer_load_dwordx4 v11, s[20:23], s48 offen lds
s_mov_b32 m0, 142336
s_add_u32 s48, s50, 15872
buffer_load_dwordx4 v11, s[20:23], s48 offen lds
s_mov_b32 m0, 149504
s_add_u32 s48, s50, 31232
buffer_load_dwordx4 v11, s[20:23], s48 offen lds
s_mov_b32 m0, 150528
s_add_u32 s48, s50, 36352
buffer_load_dwordx4 v11, s[20:23], s48 offen lds
s_mov_b32 m0, 157696
s_add_u32 s48, s50, 51712
buffer_load_dwordx4 v11, s[20:23], s48 offen lds
s_mov_b32 m0, 158720
s_add_u32 s48, s50, 56832
buffer_load_dwordx4 v11, s[20:23], s48 offen lds
ds_read_b64_tr_b16 v[96:97], v4 offset:0
ds_read_b64_tr_b16 v[98:99], v4 offset:1024
ds_read_b64_tr_b16 v[100:101], v4 offset:4096
ds_read_b64_tr_b16 v[102:103], v4 offset:5120
ds_read_b64_tr_b16 v[160:161], v4 offset:8192
ds_read_b64_tr_b16 v[162:163], v4 offset:9216
ds_read_b64_tr_b16 v[164:165], v4 offset:12288
ds_read_b64_tr_b16 v[166:167], v4 offset:13312
ds_read_b64_tr_b16 v[168:169], v4 offset:16384
ds_read_b64_tr_b16 v[170:171], v4 offset:17408
ds_read_b64_tr_b16 v[172:173], v4 offset:20480
ds_read_b64_tr_b16 v[174:175], v4 offset:21504
ds_read_b64_tr_b16 v[144:145], v4 offset:24576
ds_read_b64_tr_b16 v[146:147], v4 offset:25600
ds_read_b64_tr_b16 v[148:149], v4 offset:28672
ds_read_b64_tr_b16 v[150:151], v4 offset:29696
s_waitcnt lgkmcnt(0)
s_waitcnt vmcnt(24)
s_barrier
s_mov_b32 m0, 2048
s_add_u32 s48, s50, 72192
buffer_load_dwordx4 v11, s[20:23], s48 offen lds
s_mov_b32 m0, 3072
s_add_u32 s48, s50, 77312
buffer_load_dwordx4 v11, s[20:23], s48 offen lds
s_mov_b32 m0, 10240
s_add_u32 s48, s49, 131200
buffer_load_dwordx4 v10, s[8:11], s48 offen lds
s_mov_b32 m0, 11264
s_add_u32 s48, s49, 196736
buffer_load_dwordx4 v10, s[8:11], s48 offen lds
s_mov_b32 m0, 18432
s_add_u32 s48, s49, 131072
buffer_load_dwordx4 v10, s[12:15], s48 offen lds
s_mov_b32 m0, 19456
s_add_u32 s48, s49, 196608
buffer_load_dwordx4 v10, s[12:15], s48 offen lds
s_mov_b32 m0, 26624
s_add_u32 s48, s49, 655488
buffer_load_dwordx4 v10, s[8:11], s48 offen lds
s_mov_b32 m0, 27648
s_add_u32 s48, s49, 721024
buffer_load_dwordx4 v10, s[8:11], s48 offen lds
ds_read_b64_tr_b16 v[152:153], v4 offset:32768
ds_read_b64_tr_b16 v[154:155], v4 offset:33792
ds_read_b64_tr_b16 v[156:157], v4 offset:36864
ds_read_b64_tr_b16 v[158:159], v4 offset:37888
ds_read_b64_tr_b16 v[120:121], v4 offset:40960
ds_read_b64_tr_b16 v[122:123], v4 offset:41984
ds_read_b64_tr_b16 v[124:125], v4 offset:45056
ds_read_b64_tr_b16 v[126:127], v4 offset:46080
ds_read_b64_tr_b16 v[80:81], v4 offset:49152
ds_read_b64_tr_b16 v[82:83], v4 offset:50176
ds_read_b64_tr_b16 v[84:85], v4 offset:53248
ds_read_b64_tr_b16 v[86:87], v4 offset:54272
ds_read_b64_tr_b16 v[128:129], v4 offset:57344
ds_read_b64_tr_b16 v[130:131], v4 offset:58368
ds_read_b64_tr_b16 v[132:133], v4 offset:61440
ds_read_b64_tr_b16 v[134:135], v4 offset:62464
s_waitcnt lgkmcnt(0)
s_waitcnt vmcnt(24)
s_barrier
s_mov_b32 m0, 34816
s_add_u32 s48, s49, 655360
buffer_load_dwordx4 v10, s[12:15], s48 offen lds
s_mov_b32 m0, 35840
s_add_u32 s48, s49, 720896
buffer_load_dwordx4 v10, s[12:15], s48 offen lds
s_mov_b32 m0, 43008
s_add_u32 s48, s49, 1179776
buffer_load_dwordx4 v10, s[8:11], s48 offen lds
s_mov_b32 m0, 44032
s_add_u32 s48, s49, 1245312
buffer_load_dwordx4 v10, s[8:11], s48 offen lds
s_mov_b32 m0, 51200
s_add_u32 s48, s49, 1704064
buffer_load_dwordx4 v10, s[8:11], s48 offen lds
s_mov_b32 m0, 52224
s_add_u32 s48, s49, 1769600
buffer_load_dwordx4 v10, s[8:11], s48 offen lds
s_mov_b32 m0, 59392
s_add_u32 s48, s49, 2228352
buffer_load_dwordx4 v10, s[8:11], s48 offen lds
s_mov_b32 m0, 60416
s_add_u32 s48, s49, 2293888
buffer_load_dwordx4 v10, s[8:11], s48 offen lds
ds_read_b64_tr_b16 v[136:137], v5 offset:0
ds_read_b64_tr_b16 v[138:139], v5 offset:1024
ds_read_b64_tr_b16 v[140:141], v5 offset:4096
ds_read_b64_tr_b16 v[142:143], v5 offset:5120
ds_read_b64_tr_b16 v[192:193], v8 offset:8192
ds_read_b64_tr_b16 v[194:195], v8 offset:8704
ds_read_b64_tr_b16 v[196:197], v8 offset:10240
ds_read_b64_tr_b16 v[198:199], v8 offset:10752
v_xor_b32 v12, v15, v8
ds_read_b64_tr_b16 v[32:33], v12 offset:16384
ds_read_b64_tr_b16 v[34:35], v12 offset:16896
ds_read_b64_tr_b16 v[36:37], v12 offset:18432
ds_read_b64_tr_b16 v[38:39], v12 offset:18944
ds_read_b64_tr_b16 v[176:177], v8 offset:24576
ds_read_b64_tr_b16 v[178:179], v8 offset:25088
ds_read_b64_tr_b16 v[180:181], v8 offset:26624
ds_read_b64_tr_b16 v[182:183], v8 offset:27136
s_waitcnt lgkmcnt(0)
buffer_store_dwordx4 v[32:35], v0, s[4:7], s61 offen offset:0
buffer_store_dwordx4 v[36:39], v0, s[4:7], s61 offen offset:1024
s_waitcnt vmcnt(26)
s_barrier
s_mov_b32 m0, 67584
s_add_u32 s48, s49, 2752640
buffer_load_dwordx4 v10, s[8:11], s48 offen lds
s_mov_b32 m0, 68608
s_add_u32 s48, s49, 2818176
buffer_load_dwordx4 v10, s[8:11], s48 offen lds
s_mov_b32 m0, 75776
s_add_u32 s48, s50, 11008
buffer_load_dwordx4 v11, s[20:23], s48 offen lds
s_mov_b32 m0, 76800
s_add_u32 s48, s50, 16128
buffer_load_dwordx4 v11, s[20:23], s48 offen lds
s_mov_b32 m0, 83968
s_add_u32 s48, s50, 31488
buffer_load_dwordx4 v11, s[20:23], s48 offen lds
s_mov_b32 m0, 84992
s_add_u32 s48, s50, 36608
buffer_load_dwordx4 v11, s[20:23], s48 offen lds
s_mov_b32 m0, 92160
s_add_u32 s48, s50, 51968
buffer_load_dwordx4 v11, s[20:23], s48 offen lds
s_mov_b32 m0, 93184
s_add_u32 s48, s50, 57088
buffer_load_dwordx4 v11, s[20:23], s48 offen lds
ds_read_b64_tr_b16 v[184:185], v8 offset:32768
ds_read_b64_tr_b16 v[186:187], v8 offset:33280
ds_read_b64_tr_b16 v[188:189], v8 offset:34816
ds_read_b64_tr_b16 v[190:191], v8 offset:35328
ds_read_b64_tr_b16 v[24:25], v8 offset:40960
ds_read_b64_tr_b16 v[26:27], v8 offset:41472
ds_read_b64_tr_b16 v[28:29], v8 offset:43008
ds_read_b64_tr_b16 v[30:31], v8 offset:43520
v_xor_b32 v12, v15, v8
ds_read_b64_tr_b16 v[32:33], v12 offset:49152
ds_read_b64_tr_b16 v[34:35], v12 offset:49664
ds_read_b64_tr_b16 v[36:37], v12 offset:51200
ds_read_b64_tr_b16 v[38:39], v12 offset:51712
ds_read_b64_tr_b16 a[184:185], v8 offset:57344
ds_read_b64_tr_b16 a[186:187], v8 offset:57856
ds_read_b64_tr_b16 a[188:189], v8 offset:59392
ds_read_b64_tr_b16 a[190:191], v8 offset:59904
s_waitcnt lgkmcnt(0)
buffer_store_dwordx4 v[24:27], v0, s[4:7], s62 offen offset:0
buffer_store_dwordx4 v[28:31], v0, s[4:7], s62 offen offset:1024
buffer_store_dwordx4 v[32:35], v0, s[4:7], s61 offen offset:2048
buffer_store_dwordx4 v[36:39], v0, s[4:7], s61 offen offset:3072
s_waitcnt vmcnt(30)
s_barrier
s_mov_b32 m0, 100352
s_add_u32 s48, s50, 72448
buffer_load_dwordx4 v11, s[20:23], s48 offen lds
s_mov_b32 m0, 101376
s_add_u32 s48, s50, 77568
buffer_load_dwordx4 v11, s[20:23], s48 offen lds
s_mov_b32 m0, 108544
s_add_u32 s48, s50, 11264
buffer_load_dwordx4 v11, s[20:23], s48 offen lds
s_mov_b32 m0, 109568
s_add_u32 s48, s50, 16384
buffer_load_dwordx4 v11, s[20:23], s48 offen lds
s_mov_b32 m0, 116736
s_add_u32 s48, s50, 31744
buffer_load_dwordx4 v11, s[20:23], s48 offen lds
s_mov_b32 m0, 117760
s_add_u32 s48, s50, 36864
buffer_load_dwordx4 v11, s[20:23], s48 offen lds
s_mov_b32 m0, 124928
s_add_u32 s48, s50, 52224
buffer_load_dwordx4 v11, s[20:23], s48 offen lds
s_mov_b32 m0, 125952
s_add_u32 s48, s50, 57344
buffer_load_dwordx4 v11, s[20:23], s48 offen lds
ds_read_b64_tr_b16 a[152:153], v9 offset:0
ds_read_b64_tr_b16 a[154:155], v9 offset:512
ds_read_b64_tr_b16 a[156:157], v9 offset:2048
ds_read_b64_tr_b16 a[158:159], v9 offset:2560
ds_read_b64_tr_b16 v[216:217], v9 offset:8192
ds_read_b64_tr_b16 v[218:219], v9 offset:8704
ds_read_b64_tr_b16 v[220:221], v9 offset:10240
ds_read_b64_tr_b16 v[222:223], v9 offset:10752
v_xor_b32 v12, v15, v9
ds_read_b64_tr_b16 v[200:201], v12 offset:16384
ds_read_b64_tr_b16 v[202:203], v12 offset:16896
ds_read_b64_tr_b16 v[204:205], v12 offset:18432
ds_read_b64_tr_b16 v[206:207], v12 offset:18944
ds_read_b64_tr_b16 v[40:41], v9 offset:24576
ds_read_b64_tr_b16 v[42:43], v9 offset:25088
ds_read_b64_tr_b16 v[44:45], v9 offset:26624
ds_read_b64_tr_b16 v[46:47], v9 offset:27136
s_waitcnt lgkmcnt(0)
buffer_store_dwordx4 v[40:43], v0, s[4:7], s62 offen offset:2048
buffer_store_dwordx4 v[44:47], v0, s[4:7], s62 offen offset:3072
s_waitcnt vmcnt(38)
s_barrier
s_mov_b32 m0, 133120
s_add_u32 s48, s50, 72704
buffer_load_dwordx4 v11, s[20:23], s48 offen lds
s_mov_b32 m0, 134144
s_add_u32 s48, s50, 77824
buffer_load_dwordx4 v11, s[20:23], s48 offen lds
s_mov_b32 m0, 141312
s_add_u32 s48, s49, 1179648
buffer_load_dwordx4 v10, s[12:15], s48 offen lds
s_mov_b32 m0, 142336
s_add_u32 s48, s49, 1245184
buffer_load_dwordx4 v10, s[12:15], s48 offen lds
s_mov_b32 m0, 149504
s_add_u32 s48, s49, 3276800
buffer_load_dwordx4 v10, s[8:11], s48 offen lds
s_mov_b32 m0, 150528
s_add_u32 s48, s49, 3342336
buffer_load_dwordx4 v10, s[8:11], s48 offen lds
s_mov_b32 m0, 157696
s_add_u32 s48, s49, 3276928
buffer_load_dwordx4 v10, s[8:11], s48 offen lds
s_mov_b32 m0, 158720
s_add_u32 s48, s49, 3342464
buffer_load_dwordx4 v10, s[8:11], s48 offen lds
ds_read_b64_tr_b16 v[208:209], v7 offset:0
ds_read_b64_tr_b16 v[210:211], v7 offset:512
ds_read_b64_tr_b16 v[212:213], v7 offset:2048
ds_read_b64_tr_b16 v[214:215], v7 offset:2560
s_waitcnt lgkmcnt(0)
s_waitcnt vmcnt(32)
s_barrier
ds_read_b64_tr_b16 v[16:17], v4 offset:8192
ds_read_b64_tr_b16 v[18:19], v4 offset:9216
ds_read_b64_tr_b16 v[20:21], v4 offset:12288
ds_read_b64_tr_b16 v[22:23], v4 offset:13312
ds_read_b64_tr_b16 v[24:25], v4 offset:16384
ds_read_b64_tr_b16 v[26:27], v4 offset:17408
ds_read_b64_tr_b16 v[28:29], v4 offset:20480
ds_read_b64_tr_b16 v[30:31], v4 offset:21504
ds_read_b64_tr_b16 v[32:33], v4 offset:24576
ds_read_b64_tr_b16 v[34:35], v4 offset:25600
ds_read_b64_tr_b16 v[36:37], v4 offset:28672
ds_read_b64_tr_b16 v[38:39], v4 offset:29696
ds_read_b64_tr_b16 v[40:41], v4 offset:32768
ds_read_b64_tr_b16 v[42:43], v4 offset:33792
ds_read_b64_tr_b16 v[44:45], v4 offset:36864
ds_read_b64_tr_b16 v[46:47], v4 offset:37888
ds_read_b64_tr_b16 v[48:49], v4 offset:40960
ds_read_b64_tr_b16 v[50:51], v4 offset:41984
ds_read_b64_tr_b16 v[52:53], v4 offset:45056
ds_read_b64_tr_b16 v[54:55], v4 offset:46080
ds_read_b64_tr_b16 v[56:57], v4 offset:49152
ds_read_b64_tr_b16 v[58:59], v4 offset:50176
ds_read_b64_tr_b16 v[60:61], v4 offset:53248
ds_read_b64_tr_b16 v[62:63], v4 offset:54272
ds_read_b64_tr_b16 v[64:65], v4 offset:57344
ds_read_b64_tr_b16 v[66:67], v4 offset:58368
ds_read_b64_tr_b16 v[68:69], v4 offset:61440
ds_read_b64_tr_b16 v[70:71], v4 offset:62464
s_waitcnt lgkmcnt(0)
s_barrier
ds_write_b128 v0, v[16:19] offset:22528
ds_write_b128 v0, v[20:23] offset:23552
ds_write_b128 v0, v[24:27] offset:24576
ds_write_b128 v0, v[28:31] offset:25600
ds_write_b128 v0, v[32:35] offset:26624
ds_write_b128 v0, v[36:39] offset:27648
ds_write_b128 v0, v[40:43] offset:28672
ds_write_b128 v0, v[44:47] offset:29696
ds_write_b128 v0, a[152:155] offset:30720
ds_write_b128 v0, a[156:159] offset:31744
ds_write_b128 v0, v[56:59] offset:32768
ds_write_b128 v0, v[60:63] offset:33792
ds_write_b128 v0, v[64:67] offset:34816
ds_write_b128 v0, v[68:71] offset:35840
s_waitcnt lgkmcnt(0)
v_accvgpr_write_b32 a152, v48
v_accvgpr_write_b32 a153, v49
v_accvgpr_write_b32 a154, v50
v_accvgpr_write_b32 a155, v51
v_accvgpr_write_b32 a156, v52
v_accvgpr_write_b32 a157, v53
v_accvgpr_write_b32 a158, v54
v_accvgpr_write_b32 a159, v55
s_waitcnt vmcnt(6)
s_barrier
ds_read_b64_tr_b16 v[16:17], v8 offset:24576
ds_read_b64_tr_b16 v[18:19], v8 offset:25088
ds_read_b64_tr_b16 v[20:21], v8 offset:26624
ds_read_b64_tr_b16 v[22:23], v8 offset:27136
ds_read_b64_tr_b16 v[24:25], v8 offset:32768
ds_read_b64_tr_b16 v[26:27], v8 offset:33280
ds_read_b64_tr_b16 v[28:29], v8 offset:34816
ds_read_b64_tr_b16 v[30:31], v8 offset:35328
ds_read_b64_tr_b16 v[32:33], v8 offset:40960
ds_read_b64_tr_b16 v[34:35], v8 offset:41472
ds_read_b64_tr_b16 v[36:37], v8 offset:43008
ds_read_b64_tr_b16 v[38:39], v8 offset:43520
v_xor_b32 v12, v15, v8
ds_read_b64_tr_b16 v[40:41], v12 offset:49152
ds_read_b64_tr_b16 v[42:43], v12 offset:49664
ds_read_b64_tr_b16 v[44:45], v12 offset:51200
ds_read_b64_tr_b16 v[46:47], v12 offset:51712
ds_read_b64_tr_b16 v[48:49], v8 offset:57344
ds_read_b64_tr_b16 v[50:51], v8 offset:57856
ds_read_b64_tr_b16 v[52:53], v8 offset:59392
ds_read_b64_tr_b16 v[54:55], v8 offset:59904
ds_read_b64_tr_b16 v[56:57], v9 offset:0
ds_read_b64_tr_b16 v[58:59], v9 offset:512
ds_read_b64_tr_b16 v[60:61], v9 offset:2048
ds_read_b64_tr_b16 v[62:63], v9 offset:2560
s_waitcnt lgkmcnt(0)
s_barrier
ds_write_b128 v2, v[16:19] offset:28672
ds_write_b128 v2, v[20:23] offset:29696
ds_write_b128 v2, v[24:27] offset:30720
ds_write_b128 v2, v[28:31] offset:31744
ds_write_b128 v2, v[248:251] offset:32768
ds_write_b128 v2, v[252:255] offset:33792
ds_write_b128 v2, v[240:243] offset:34816
ds_write_b128 v2, v[244:247] offset:35840
ds_write_b128 v2, v[48:51] offset:36864
ds_write_b128 v2, v[52:55] offset:37888
ds_write_b128 v2, v[56:59] offset:38912
ds_write_b128 v2, v[60:63] offset:39936
s_waitcnt lgkmcnt(0)
v_mov_b32 v248, v32
v_mov_b32 v249, v33
v_mov_b32 v250, v34
v_mov_b32 v251, v35
v_mov_b32 v252, v36
v_mov_b32 v253, v37
v_mov_b32 v254, v38
v_mov_b32 v255, v39
v_mov_b32 v240, v40
v_mov_b32 v241, v41
v_mov_b32 v242, v42
v_mov_b32 v243, v43
v_mov_b32 v244, v44
v_mov_b32 v245, v45
v_mov_b32 v246, v46
v_mov_b32 v247, v47
s_waitcnt vmcnt(0)
s_barrier
ds_read_b64_tr_b16 v[16:17], v5 offset:0
ds_read_b64_tr_b16 v[18:19], v5 offset:1024
ds_read_b64_tr_b16 v[20:21], v5 offset:4096
ds_read_b64_tr_b16 v[22:23], v5 offset:5120
ds_read_b64_tr_b16 v[24:25], v8 offset:8192
ds_read_b64_tr_b16 v[26:27], v8 offset:8704
ds_read_b64_tr_b16 v[28:29], v8 offset:10240
ds_read_b64_tr_b16 v[30:31], v8 offset:10752
v_xor_b32 v12, v15, v8
ds_read_b64_tr_b16 v[32:33], v12 offset:16384
ds_read_b64_tr_b16 v[34:35], v12 offset:16896
ds_read_b64_tr_b16 v[36:37], v12 offset:18432
ds_read_b64_tr_b16 v[38:39], v12 offset:18944
ds_read_b64_tr_b16 v[40:41], v6 offset:8192
ds_read_b64_tr_b16 v[42:43], v6 offset:9216
ds_read_b64_tr_b16 v[44:45], v6 offset:12288
ds_read_b64_tr_b16 v[46:47], v6 offset:13312
ds_read_b64_tr_b16 v[48:49], v6 offset:16384
ds_read_b64_tr_b16 v[50:51], v6 offset:17408
ds_read_b64_tr_b16 v[52:53], v6 offset:20480
ds_read_b64_tr_b16 v[54:55], v6 offset:21504
ds_read_b64_tr_b16 v[56:57], v6 offset:24576
ds_read_b64_tr_b16 v[58:59], v6 offset:25600
ds_read_b64_tr_b16 v[60:61], v6 offset:28672
ds_read_b64_tr_b16 v[62:63], v6 offset:29696
s_waitcnt lgkmcnt(0)
s_barrier
ds_write_b128 v2, a[136:139] offset:53248
ds_write_b128 v2, a[140:143] offset:54272
ds_write_b128 v2, v[232:235] offset:55296
ds_write_b128 v2, v[236:239] offset:56320
ds_write_b128 v2, v[224:227] offset:57344
ds_write_b128 v2, v[228:231] offset:58368
ds_write_b128 v2, v[80:83] offset:59392
ds_write_b128 v2, v[84:87] offset:60416
ds_write_b128 v2, a[184:187] offset:61440
ds_write_b128 v2, a[188:191] offset:62464
ds_write_b128 v2, v[56:59] offset:63488
ds_write_b128 v2, v[60:63] offset:64512
s_waitcnt lgkmcnt(0)
v_accvgpr_write_b32 a136, v16
v_accvgpr_write_b32 a137, v17
v_accvgpr_write_b32 a138, v18
v_accvgpr_write_b32 a139, v19
v_accvgpr_write_b32 a140, v20
v_accvgpr_write_b32 a141, v21
v_accvgpr_write_b32 a142, v22
v_accvgpr_write_b32 a143, v23
v_mov_b32 v232, v24
v_mov_b32 v233, v25
v_mov_b32 v234, v26
v_mov_b32 v235, v27
v_mov_b32 v236, v28
v_mov_b32 v237, v29
v_mov_b32 v238, v30
v_mov_b32 v239, v31
v_mov_b32 v224, v32
v_mov_b32 v225, v33
v_mov_b32 v226, v34
v_mov_b32 v227, v35
v_mov_b32 v228, v36
v_mov_b32 v229, v37
v_mov_b32 v230, v38
v_mov_b32 v231, v39
v_mov_b32 v80, v40
v_mov_b32 v81, v41
v_mov_b32 v82, v42
v_mov_b32 v83, v43
v_mov_b32 v84, v44
v_mov_b32 v85, v45
v_mov_b32 v86, v46
v_mov_b32 v87, v47
v_accvgpr_write_b32 a184, v48
v_accvgpr_write_b32 a185, v49
v_accvgpr_write_b32 a186, v50
v_accvgpr_write_b32 a187, v51
v_accvgpr_write_b32 a188, v52
v_accvgpr_write_b32 a189, v53
v_accvgpr_write_b32 a190, v54
v_accvgpr_write_b32 a191, v55
s_mov_b32 s90, 0x300003
s_mov_b32 s91, 0x300003
s_mov_b32 s12, 0x3030303
s_mov_b32 s13, 0x3030303
s_mov_b32 s92, 0xc0000c
s_mov_b32 s93, 0xc0000c
s_mov_b32 s14, 0xc0c0c0c
s_mov_b32 s15, 0xc0c0c0c
s_mov_b32 s94, 0x30000300
s_mov_b32 s95, 0x30000300
s_mov_b32 s16, 0x30303030
s_mov_b32 s17, 0x30303030
s_mov_b32 s96, 0xc0000c00
s_mov_b32 s97, 0xc0000c00
s_mov_b32 s18, 0xc0c0c0c0
s_mov_b32 s19, 0xc0c0c0c0
s_mov_b32 s98, 0xff00ff00
s_mov_b32 s99, 0xff00ff00
v_mov_b32 v1, 0x4444
v_mov_b32 v4, 0xeeee
v_cndmask_b32 v1, v1, v4, s[98:99]
v_lshrrev_b32 v4, 8, v0
v_lshl_or_b32 v1, v4, 28, v1
v_bfe_u32 v4, v0, 4, 4
v_lshl_or_b32 v1, v4, 19, v1
s_mov_b32 s51, 0x3e0293ee
s_mov_b32 s52, 0x3f803f80
s_mov_b32 s53, 0x3f803f80
s_mov_b32 s54, 0x3f003f00
s_mov_b32 s55, 0x3f003f00
s_mov_b32 s56, 0xff800000
s_mov_b32 s57, 0xff800000
s_mov_b32 s58, 0x3f80
s_mov_b32 s8, s4
s_mov_b32 s9, s5
s_cmp_lt_u32 s30, 10
s_cselect_b32 s10, s6, 0
s_mov_b32 s31, 0
s_mov_b32 s45, -2
s_lshl_b32 s46, s30, 6
s_add_u32 s46, s46, 222330880
s_mul_i32 s48, s30, 0
s_add_u32 s48, s48, 120389632
s_add_u32 s20, s4, s48
s_addc_u32 s21, s5, 0
s_mov_b32 s22, 512
s_lshl_b32 s48, s30, 7
s_and_b32 s49, s30, 31
s_lshl_b32 s49, s49, 12
s_add_u32 s43, s49, 119603200
v_mov_b64 v[12:13], -1
s_add_u32 s38, s48, 119554048
s_add_u32 s39, s48, 119619584
s_add_u32 s40, s48, 119685120
s_add_u32 s41, s48, 119750656
s_add_u32 s42, s48, 119816192
v_lshrrev_b32 v4, 16, v1
buffer_store_dwordx2 v[12:13], v4, s[4:7], s38 offen
buffer_store_dwordx2 v[12:13], v4, s[4:7], s39 offen
buffer_store_dwordx2 v[12:13], v4, s[4:7], s40 offen
buffer_store_dwordx2 v[12:13], v4, s[4:7], s41 offen
buffer_store_dwordx2 v[12:13], v4, s[4:7], s42 offen
s_cmp_lg_u32 s3, 0
s_cbranch_scc1 k_wdd_136
v_mov_b32 v8, 192
k_wd_135:
global_load_dword v9, v8, s[28:29] sc1
s_waitcnt vmcnt(0)
v_readfirstlane_b32 s48, v9
s_cmp_ge_u32 s48, 32
s_cbranch_scc1 k_wdd_136
s_sleep 2
s_sub_u32 s32, s32, 1
s_cmp_gt_i32 s32, 0
s_cbranch_scc1 k_wd_135
k_wdd_136:
s_barrier
k_lay_137:
s_add_u32 s47, s31, 63
s_mov_b32 s33, 120324096
s_mov_b32 s34, 120327168
s_mov_b32 s35, 120331264
s_mul_i32 s48, s31, 655360
s_lshl_b32 s36, s30, 14
s_add_u32 s36, s36, s48
s_add_u32 s36, s36, 4096
s_waitcnt vmcnt(1)
v_mov_b32 v12, -1
s_and_b32 s48, s30, 31
s_add_u32 s48, s48, 16
s_lshr_b32 s49, s48, 1
s_and_b32 s48, s48, 1
s_lshl_b32 s44, s49, 8
s_lshl_b32 s50, s48, 6
s_add_u32 s44, s44, s50
s_add_u32 s44, s44, s33
s_mul_i32 s48, s48, 5120
s_lshl_b32 s49, s49, 5
s_add_u32 s48, s48, s49
v_lshrrev_b32 v8, 4, v0
v_and_b32 v9, 3, v8
v_mul_u32_u24 v9, 1280, v9
v_bfe_u32 v10, v8, 2, 1
v_lshl_add_u32 v9, v10, 1, v9
v_bfe_u32 v10, v8, 4, 1
v_lshl_add_u32 v9, v10, 4, v9
v_bfe_u32 v10, v8, 5, 1
v_lshl_add_u32 v9, v10, 2, v9
buffer_load_ushort v10, v9, s[24:27], s48 offen
buffer_load_ushort v11, v9, s[24:27], s48 offen offset:8
v_and_b32 v45, 0x30, v0
v_lshrrev_b32 v46, 8, v0
v_lshl_or_b32 v45, v46, 2, v45
v_bfe_u32 v46, v0, 6, 1
v_lshl_or_b32 v45, v46, 7, v45
v_cndmask_b32 v45, v45, 2.0, s[98:99]
s_waitcnt vmcnt(0)
v_lshl_or_b32 v10, v11, 16, v10
s_waitcnt vmcnt(0)
s_barrier
s_barrier
buffer_store_dword v10, v45, s[4:7], s44 offen
s_add_u32 s44, s44, 16384
buffer_store_dword v12, v45, s[4:7], s44 offen
s_waitcnt vmcnt(0)
s_barrier
s_barrier
v_lshlrev_b32 v3, v0, s58
v_cndmask_b32 v20, 0, v3, s[90:91]
v_cndmask_b32 v21, 0, v3, s[92:93]
v_cndmask_b32 v22, 0, v3, s[94:95]
v_cndmask_b32 v23, 0, v3, s[96:97]
k_fl2_148:
buffer_load_dwordx2 v[46:47], off, s[4:7], s46 sc1
s_waitcnt vmcnt(0)
v_min_u32 v46, v46, v47
v_cmp_lt_u32 vcc, s31, v46
v_mov_b64 v[46:47], 0
s_cbranch_vccnz k_cold2_140
s_sub_u32 s32, s32, 1
s_cmp_gt_i32 s32, 0
s_cbranch_scc1 k_fl2_148
s_branch k_cold2_140
k_T0_138:
s_waitcnt vmcnt(3)
s_waitcnt lgkmcnt(0)
v_smfmac_f32_16x16x64_bf16 v[28:31], v[4:7], v[56:63], v1
ds_read_b128 v[56:59], v0 offset:22528
v_smfmac_f32_16x16x64_bf16 v[32:35], v[4:7], v[64:71], v1
ds_read_b128 v[60:63], v0 offset:23552
v_smfmac_f32_16x16x64_bf16 v[40:43], v[4:7], a[8:15], v1
ds_read_b128 v[64:67], v0 offset:24576
v_smfmac_f32_16x16x64_bf16 v[44:47], v[4:7], a[16:23], v1
ds_read_b128 v[68:71], v0 offset:25600
s_waitcnt vmcnt(2)
v_smfmac_f32_16x16x64_bf16 v[24:27], v[8:11], a[24:31], v1
s_waitcnt lgkmcnt(2)
v_smfmac_f32_16x16x64_bf16 v[28:31], v[8:11], v[56:63], v1
buffer_load_dwordx4 v[56:59], v0, s[4:7], s60 offen offset:2048
v_smfmac_f32_16x16x64_bf16 v[24:27], v[4:7], v[48:55], v1
s_waitcnt lgkmcnt(0)
v_smfmac_f32_16x16x64_bf16 v[32:35], v[8:11], v[64:71], v1
ds_read_b128 v[64:67], v0 offset:32768
s_waitcnt vmcnt(2)
v_smfmac_f32_16x16x64_bf16 v[36:39], v[8:11], a[32:39], v1
ds_read_b128 v[68:71], v0 offset:33792
buffer_load_dwordx4 v[60:63], v0, s[4:7], s60 offen offset:3072
v_smfmac_f32_16x16x64_bf16 v[36:39], v[12:15], a[72:79], v1
ds_write_b128 v0, v[12:15] offset:1024
v_smfmac_f32_16x16x64_bf16 v[36:39], v[4:7], a[0:7], v1
v_smfmac_f32_16x16x64_bf16 v[24:27], v[12:15], a[56:63], v1
buffer_load_dwordx4 v[48:51], v0, s[4:7], s36 offen offset:0 sc1
s_waitcnt vmcnt(3)
v_smfmac_f32_16x16x64_bf16 v[24:27], v[16:19], a[80:87], v1
s_waitcnt lgkmcnt(1)
ds_write_b128 v0, v[16:19] offset:5120
v_smfmac_f32_16x16x64_bf16 v[28:31], v[12:15], v[64:71], v1
ds_read_b128 v[64:67], v2 offset:53248
v_fma_f32 v3, v24, v25, v26
v_smfmac_f32_16x16x64_bf16 v[40:43], v[8:11], a[40:47], v1
buffer_load_dwordx4 v[52:55], v0, s[4:7], s36 offen offset:1024 sc1
v_cmp_u_f32 vcc, v3, v27
v_smfmac_f32_16x16x64_bf16 v[44:47], v[16:19], a[112:119], v1
ds_read_b128 v[68:71], v2 offset:54272
v_smfmac_f32_16x16x64_bf16 v[44:47], v[8:11], a[48:55], v1
s_cbranch_vccnz k_cold_139
k_okC_141:
v_smfmac_f32_16x16x64_bf16 v[36:39], v[16:19], a[96:103], v1
s_waitcnt lgkmcnt(2)
s_barrier
ds_read_b128 v[8:11], v0 offset:3072
v_smfmac_f32_16x16x64_bf16 v[28:31], v[16:19], a[88:95], v1
ds_read_b128 v[4:7], v0 offset:2048
s_waitcnt lgkmcnt(2)
v_smfmac_f32_16x16x64_bf16 v[32:35], v[16:19], v[64:71], v1
ds_read_b128 v[64:67], v0 offset:34816
ds_read_b128 v[68:71], v0 offset:35840
v_smfmac_f32_16x16x64_bf16 v[40:43], v[16:19], a[104:111], v1
v_smfmac_f32_16x16x64_bf16 v[32:35], v[12:15], a[64:71], v1
ds_read_b128 v[16:19], v0 offset:6144
s_waitcnt lgkmcnt(4)
v_smfmac_f32_16x16x64_bf16 v[28:31], v[8:11], a[136:143], v1
ds_read_b128 v[12:15], v0 offset:0
v_smfmac_f32_16x16x64_bf16 v[24:27], v[8:11], a[128:135], v1
ds_read_b128 v[8:11], v0 offset:4096
s_waitcnt lgkmcnt(3)
v_smfmac_f32_16x16x64_bf16 v[28:31], v[4:7], v[64:71], v1
ds_read_b128 v[64:67], v2 offset:55296
s_waitcnt lgkmcnt(3)
v_smfmac_f32_16x16x64_bf16 v[24:27], v[4:7], a[120:127], v1
ds_read_b128 v[68:71], v2 offset:56320
s_waitcnt lgkmcnt(3)
v_smfmac_f32_16x16x64_bf16 v[28:31], v[12:15], a[152:159], v1
ds_read_b128 v[4:7], v0 offset:7168
s_waitcnt vmcnt(2)
v_smfmac_f32_16x16x64_bf16 v[32:35], v[16:19], v[56:63], v1
buffer_load_dwordx4 v[56:59], v0, s[4:7], s36 offen offset:2048 sc1
v_and_b32 v3, 0xffffff7f, v0
v_smfmac_f32_16x16x64_bf16 v[44:47], v[16:19], a[208:215], v1
s_waitcnt lgkmcnt(1)
v_smfmac_f32_16x16x64_bf16 v[24:27], v[16:19], v[64:71], v1
ds_read_b128 v[64:67], v2 offset:63488
v_smfmac_f32_16x16x64_bf16 v[24:27], v[12:15], a[144:151], v1
s_waitcnt lgkmcnt(1)
ds_read_b128 v[68:71], v2 offset:64512
buffer_load_dwordx4 v[60:63], v0, s[4:7], s36 offen offset:3072 sc1
v_smfmac_f32_16x16x64_bf16 v[24:27], v[4:7], a[168:175], v1
s_barrier
v_smfmac_f32_16x16x64_bf16 v[24:27], v[8:11], a[184:191], v1
v_smfmac_f32_16x16x64_bf16 v[28:31], v[16:19], a[160:167], v1
s_waitcnt lgkmcnt(0)
v_smfmac_f32_16x16x64_bf16 v[28:31], v[8:11], v[64:71], v1
ds_read_b128 v[64:67], v2 offset:57344
v_cvt_pk_bf16_f32 v24, v24, v25
v_smfmac_f32_16x16x64_bf16 v[28:31], v[4:7], a[176:183], v1
ds_read_b128 v[68:71], v2 offset:58368
v_cvt_pk_bf16_f32 v25, v26, v27
v_smfmac_f32_16x16x64_bf16 v[36:39], v[16:19], a[192:199], v1
v_smfmac_f32_16x16x64_bf16 v[40:43], v[16:19], a[200:207], v1
v_cvt_pk_bf16_f32 v27, v30, v31
v_smfmac_f32_16x16x64_bf16 v[40:43], v[4:7], a[224:231], v1
ds_read_b128 v[16:19], v0 offset:2048
s_waitcnt lgkmcnt(1)
v_smfmac_f32_16x16x64_bf16 v[32:35], v[4:7], v[64:71], v1
ds_read_b128 v[64:67], v2 offset:32768
v_cvt_pk_bf16_f32 v26, v28, v29
v_smfmac_f32_16x16x64_bf16 v[44:47], v[4:7], a[232:239], v1
ds_read_b128 v[68:71], v2 offset:33792
v_and_or_b32 v3, v1, 8, v3
v_mfma_f32_16x16x32_bf16 v[28:31], v[24:27], v[20:23], 0
v_smfmac_f32_16x16x64_bf16 v[36:39], v[4:7], a[216:223], v1
ds_read_b128 v[4:7], v0 offset:3072
v_smfmac_f32_16x16x64_bf16 v[40:43], v[8:11], a[248:255], v1
s_waitcnt lgkmcnt(1)
v_mul_f32 v28, s51, v28
v_smfmac_f32_16x16x64_bf16 v[36:39], v[8:11], v[64:71], v1
ds_read_b128 v[64:67], v2 offset:34816
v_mul_f32 v31, s51, v31
v_mul_f32 v29, s51, v29
v_smfmac_f32_16x16x64_bf16 v[32:35], v[8:11], a[240:247], v1
ds_read_b128 v[68:71], v2 offset:35840
v_mul_f32 v30, s51, v30
v_smfmac_f32_16x16x64_bf16 v[44:47], v[8:11], v[72:79], v1
ds_read_b128 v[8:11], v0 offset:1024
v_cvt_pk_bf16_f32 v24, v28, v29
v_cvt_pk_bf16_f32 v25, v30, v31
v_smfmac_f32_16x16x64_bf16 v[32:35], v[12:15], v[80:87], v1
ds_write_b64 v3, v[24:25] offset:4224
s_waitcnt lgkmcnt(2)
v_smfmac_f32_16x16x64_bf16 v[32:35], v[16:19], v[64:71], v1
ds_read_b128 v[64:67], v2 offset:59392
s_waitcnt lgkmcnt(2)
v_smfmac_f32_16x16x64_bf16 v[32:35], v[4:7], v[104:111], v1
ds_read_b128 v[68:71], v2 offset:60416
v_smfmac_f32_16x16x64_bf16 v[36:39], v[16:19], v[96:103], v1
s_waitcnt lgkmcnt(2)
s_barrier
ds_read_b128 v[24:27], v0 offset:4096
v_smfmac_f32_16x16x64_bf16 v[36:39], v[12:15], v[88:95], v1
ds_read_b128 v[28:31], v0 offset:5120
v_cvt_pk_bf16_f32 v32, v32, v33
v_smfmac_f32_16x16x64_bf16 v[36:39], v[4:7], v[112:119], v1
s_waitcnt lgkmcnt(2)
v_smfmac_f32_16x16x64_bf16 v[44:47], v[16:19], v[64:71], v1
buffer_load_dwordx4 v[64:67], v0, s[4:7], s61 offen offset:0
s_waitcnt vmcnt(3)
s_waitcnt lgkmcnt(1)
v_mfma_f32_16x16x32_bf16 v[48:51], v[48:51], v[24:27], 0
v_cvt_pk_bf16_f32 v33, v34, v35
s_waitcnt lgkmcnt(0)
v_mfma_f32_16x16x32_bf16 v[48:51], v[52:55], v[28:31], v[48:51]
v_cvt_pk_bf16_f32 v35, v38, v39
v_cvt_pk_bf16_f32 v34, v36, v37
v_mov_b64 v[52:53], s[56:57]
s_nop 0
v_mfma_f32_16x16x32_bf16 v[36:39], v[32:35], v[20:23], 0
buffer_load_dwordx4 v[68:71], v0, s[4:7], s61 offen offset:1024
v_permlane32_swap_b32 v49, v51
v_permlane32_swap_b32 v48, v50
v_add_f32_dpp v53, v51, v49 row_ror:8 row_mask:0xf bank_mask:0x3
v_exp_f32 v53, v53
v_add_f32_dpp v52, v50, v48 row_ror:8 row_mask:0xf bank_mask:0x3
v_exp_f32 v52, v52
v_cvt_pk_bf16_f32 v32, v36, v37
v_cvt_pk_bf16_f32 v33, v38, v39
v_smfmac_f32_16x16x64_bf16 v[40:43], v[16:19], v[120:127], v1
ds_write_b64 v3, v[32:33] offset:6272
v_cvt_pk_bf16_f32 v48, v52, v53
v_smfmac_f32_16x16x64_bf16 v[40:43], v[8:11], v[160:167], v1
ds_write_b32 v0, v48 offset:4
v_smfmac_f32_16x16x64_bf16 v[44:47], v[4:7], v[152:159], v1
buffer_load_dwordx4 v[48:51], v0, s[4:7], s61 offen offset:2048
v_mov_b64 v[20:21], s[52:53]
v_smfmac_f32_16x16x64_bf16 v[40:43], v[12:15], v[128:135], v1
s_waitcnt lgkmcnt(1)
v_mov_b64 v[22:23], s[52:53]
v_smfmac_f32_16x16x64_bf16 v[40:43], v[4:7], v[144:151], v1
s_waitcnt lgkmcnt(0)
s_barrier
ds_read_b128 v[32:35], v0 offset:6144
v_smfmac_f32_16x16x64_bf16 v[44:47], v[12:15], v[136:143], v1
ds_read_b128 v[36:39], v0 offset:7168
ds_read_b128 v[16:19], v0 offset:0
buffer_load_dwordx4 v[52:55], v0, s[4:7], s61 offen offset:3072
v_xor_b32 v12, 0x80, v0
v_cvt_pk_bf16_f32 v40, v40, v41
v_cvt_pk_bf16_f32 v41, v42, v43
v_smfmac_f32_16x16x64_bf16 v[44:47], v[8:11], v[168:175], v1
ds_read_b128 v[12:15], v12 offset:0
s_waitcnt lgkmcnt(3)
v_mfma_f32_16x16x32_bf16 v[24:27], v[32:35], v[24:27], 0
s_waitcnt lgkmcnt(2)
v_mfma_f32_16x16x32_bf16 v[24:27], v[36:39], v[28:31], v[24:27]
v_cvt_pk_bf16_f32 v42, v44, v45
s_waitcnt lgkmcnt(1)
s_waitcnt vmcnt(4)
v_mfma_f32_16x16x32_bf16 v[8:11], v[56:59], v[16:19], 0
buffer_load_dwordx4 v[56:59], v0, s[4:7], s62 offen offset:0
v_mov_b64 v[28:29], s[56:57]
v_permlane32_swap_b32 v24, v26
v_permlane32_swap_b32 v25, v27
v_add_f32_dpp v28, v26, v24 row_ror:8 row_mask:0xf bank_mask:0x3
v_mfma_f32_16x16x32_bf16 v[4:7], v[20:23], v[16:19], 0
s_waitcnt lgkmcnt(0)
v_add_f32_dpp v29, v27, v25 row_ror:8 row_mask:0xf bank_mask:0x3
v_exp_f32 v29, v29
v_mov_b64 v[44:45], s[54:55]
v_exp_f32 v28, v28
v_mfma_f32_16x16x32_bf16 v[8:11], v[60:63], v[12:15], v[8:11]
buffer_load_dwordx4 v[60:63], v0, s[4:7], s62 offen offset:1024
v_cvt_pk_bf16_f32 v24, v28, v29
v_cvt_pk_bf16_f32 v43, v46, v47
v_cvt_pk_bf16_f32 v25, v28, v29
v_permlane32_swap_b32 v40, v41
v_mov_b32_dpp v26, v24 row_ror:8 row_mask:0xf bank_mask:0xf
v_mfma_f32_16x16x16_bf16 v[4:7], v[44:45], v[24:25], v[4:7]
v_mov_b32_dpp v27, v24 row_ror:8 row_mask:0xf bank_mask:0xf
v_permlane32_swap_b32 v42, v43
v_mov_b64 v[28:29], 0
v_mov_b64 v[34:35], 0
v_mfma_f32_16x16x32_bf16 v[8:11], v[40:43], v[24:27], v[8:11]
buffer_load_dwordx4 v[16:19], v0, s[4:7], s62 offen offset:2048
v_rcp_f32 v6, v4
v_mov_b64 v[32:33], 0
s_nop 0
v_rcp_f32_dpp v6, v4 row_ror:8 row_mask:0xf bank_mask:0xc
v_mov_b64 v[26:27], 0
v_pk_mul_f32 v[8:9], v[8:9], v[6:7] op_sel_hi:[1,0]
v_pk_mul_f32 v[10:11], v[10:11], v[6:7] op_sel_hi:[1,0]
v_add_u32 v6, 0xd4800000, v6
v_mov_b64 v[24:25], 0
v_cvt_pk_bf16_f32 v45, v10, v11
v_cvt_pk_bf16_f32 v44, v8, v9
s_waitcnt vmcnt(5)
buffer_load_dwordx4 v[20:23], v0, s[4:7], s62 offen offset:3072
ds_write_b64 v3, v[44:45] offset:2176
v_cmp_lt_u32 vcc, 0x28000000, v6
v_mov_b32_dpp v46, v44 row_ror:8 row_mask:0xf bank_mask:0xf
v_and_b32 v3, -9, v3
v_mov_b32_dpp v47, v45 row_ror:8 row_mask:0xf bank_mask:0xf
v_mov_b64 v[30:31], 0
s_cbranch_vccnz k_slow_142
k_okS_143:
v_mov_b64 v[38:39], 0
v_mov_b64 v[36:37], 0
v_smfmac_f32_16x16x64_bf16 v[32:35], v[44:47], v[200:207], v1
s_waitcnt lgkmcnt(0)
s_barrier
ds_read_b128 v[12:15], v3 offset:2048
v_mov_b64 v[40:41], 0
v_smfmac_f32_16x16x64_bf16 v[36:39], v[44:47], v[224:231], v1
s_waitcnt vmcnt(4)
ds_read_b128 v[4:7], v3 offset:3072
ds_read_b128 v[8:11], v3 offset:3200
v_smfmac_f32_16x16x64_bf16 v[28:31], v[44:47], v[48:55], v1
v_mov_b64 v[42:43], 0
v_smfmac_f32_16x16x64_bf16 v[24:27], v[44:47], v[64:71], v1
ds_read_b128 v[64:67], v2 offset:61440
ds_read_b128 v[68:71], v2 offset:62464
v_smfmac_f32_16x16x64_bf16 v[40:43], v[44:47], v[240:247], v1
s_waitcnt lgkmcnt(4)
ds_read_b128 v[48:51], v0 offset:30720
v_smfmac_f32_16x16x64_bf16 v[24:27], v[12:15], v[192:199], v1
s_waitcnt lgkmcnt(3)
v_smfmac_f32_16x16x64_bf16 v[24:27], v[4:7], v[176:183], v1
ds_read_b128 v[52:55], v0 offset:31744
v_smfmac_f32_16x16x64_bf16 v[24:27], v[8:11], v[184:191], v1
v_smfmac_f32_16x16x64_bf16 v[36:39], v[12:15], v[232:239], v1
s_waitcnt lgkmcnt(2)
s_waitcnt vmcnt(2)
v_lshrrev_b32 v44, 16, v1
v_cvt_pk_bf16_f32 v24, v24, v25
v_bfi_b32 v24, 1, s45, v24
v_smfmac_f32_16x16x64_bf16 v[28:31], v[12:15], v[56:63], v1
ds_read_b128 v[56:59], v2 offset:36864
v_cvt_pk_bf16_f32 v25, v26, v27
v_smfmac_f32_16x16x64_bf16 v[28:31], v[4:7], v[64:71], v1
s_waitcnt lgkmcnt(1)
buffer_store_dwordx2 v[24:25], v44, s[4:7], s38 offen
ds_read_b128 v[64:67], v2 offset:28672
v_smfmac_f32_16x16x64_bf16 v[28:31], v[8:11], v[48:55], v1
ds_read_b128 v[68:71], v2 offset:29696
ds_read_b128 v[48:51], v2 offset:30720
ds_read_b128 v[52:55], v2 offset:31744
v_smfmac_f32_16x16x64_bf16 v[32:35], v[12:15], v[216:223], v1
v_cvt_pk_bf16_f32 v28, v28, v29
v_cvt_pk_bf16_f32 v29, v30, v31
v_bfi_b32 v28, 1, s45, v28
v_smfmac_f32_16x16x64_bf16 v[32:35], v[8:11], v[208:215], v1
buffer_store_dwordx2 v[28:29], v44, s[4:7], s39 offen
ds_read_b128 v[60:63], v2 offset:37888
s_waitcnt vmcnt(2)
v_smfmac_f32_16x16x64_bf16 v[32:35], v[4:7], v[16:23], v1
s_waitcnt lgkmcnt(3)
ds_read_b128 v[16:19], v2 offset:38912
v_smfmac_f32_16x16x64_bf16 v[36:39], v[4:7], v[64:71], v1
ds_read_b128 v[20:23], v2 offset:39936
s_waitcnt lgkmcnt(3)
v_cvt_pk_bf16_f32 v32, v32, v33
v_cvt_pk_bf16_f32 v33, v34, v35
v_bfi_b32 v32, 1, s45, v32
v_smfmac_f32_16x16x64_bf16 v[36:39], v[8:11], v[48:55], v1
s_waitcnt lgkmcnt(2)
buffer_store_dwordx2 v[32:33], v44, s[4:7], s40 offen
v_smfmac_f32_16x16x64_bf16 v[40:43], v[12:15], v[248:255], v1
s_nop 2
v_cvt_pk_bf16_f32 v36, v36, v37
v_cvt_pk_bf16_f32 v37, v38, v39
v_bfi_b32 v36, 1, s45, v36
s_waitcnt lgkmcnt(0)
v_smfmac_f32_16x16x64_bf16 v[40:43], v[8:11], v[16:23], v1
buffer_store_dwordx2 v[36:37], v44, s[4:7], s41 offen
v_smfmac_f32_16x16x64_bf16 v[40:43], v[4:7], v[56:63], v1
s_nop 6
v_cvt_pk_bf16_f32 v40, v40, v41
v_cvt_pk_bf16_f32 v41, v42, v43
v_bfi_b32 v40, 1, s45, v40
buffer_store_dwordx2 v[40:41], v44, s[4:7], s42 offen
v_lshlrev_b32 v3, v0, s58
v_cndmask_b32 v16, 0, v3, s[12:13]
v_cndmask_b32 v17, 0, v3, s[14:15]
v_cndmask_b32 v18, 0, v3, s[16:17]
v_cndmask_b32 v19, 0, v3, s[18:19]
s_barrier
v_and_b32 v45, 0x30, v0
v_lshrrev_b32 v46, 8, v0
v_lshl_or_b32 v45, v46, 2, v45
v_bfe_u32 v46, v0, 6, 1
v_lshl_or_b32 v45, v46, 7, v45
v_cndmask_b32 v45, v45, 2.0, s[98:99]
buffer_load_dwordx4 v[24:27], v0, s[4:7], s43 offen offset:0 sc1
buffer_load_dwordx4 v[28:31], v0, s[4:7], s43 offen offset:1024 sc1
buffer_load_dwordx4 v[32:35], v0, s[4:7], s43 offen offset:2048 sc1
buffer_load_dwordx4 v[36:39], v0, s[4:7], s43 offen offset:3072 sc1
v_cndmask_b32 v20, 0, v3, s[90:91]
v_cndmask_b32 v21, 0, v3, s[92:93]
v_cndmask_b32 v22, 0, v3, s[94:95]
v_cndmask_b32 v23, 0, v3, s[96:97]
s_add_u32 s33, s33, 16384
s_bitset0_b32 s33, 16
s_add_u32 s34, s33, 3072
s_add_u32 s35, s33, 7168
s_add_u32 s36, s36, 524288
s_add_u32 s31, s31, 1
s_buffer_load_dwordx2 s[66:67], s[4:7], s46 glc
ds_read_b128 v[56:59], v0 offset:26624
ds_read_b128 v[60:63], v0 offset:27648
ds_read_b128 v[64:67], v0 offset:28672
ds_read_b128 v[68:71], v0 offset:29696
buffer_load_dwordx4 v[48:51], v0, s[4:7], s60 offen offset:0
buffer_load_dwordx4 v[52:55], v0, s[4:7], s60 offen offset:1024
s_waitcnt vmcnt(5)
v_mfma_f32_16x16x32_bf16 v[40:43], v[24:27], v[16:19], 0
s_waitcnt vmcnt(4)
v_mfma_f32_16x16x32_bf16 v[40:43], v[28:31], v[16:19], v[40:43]
v_bitop3_b32 v46, v24, v28, s45 bitop3:0x7e
s_waitcnt vmcnt(3)
v_mfma_f32_16x16x32_bf16 v[40:43], v[32:35], v[16:19], v[40:43]
s_waitcnt vmcnt(2)
v_mfma_f32_16x16x32_bf16 v[40:43], v[36:39], v[16:19], v[40:43]
v_bitop3_b32 v47, v32, v36, s45 bitop3:0x7e
v_bitop3_b32 v46, v46, v47, 1 bitop3:0xa8
v_cmp_ne_u32 vcc, 0, v46
v_mov_b64 v[24:25], 0
v_mov_b64 v[26:27], 0
v_mov_b64 v[28:29], 0
v_mov_b64 v[30:31], 0
v_permlane32_swap_b32 v40, v41
v_permlane32_swap_b32 v42, v43
v_add_f32 v40, v40, v41
v_add_f32 v41, v42, v43
v_cvt_pk_bf16_f32 v42, v40, v41
s_cbranch_vccnz k_r1_145
k_ok1_146:
buffer_store_dword v42, v45, s[4:7], s44 offen
s_barrier
v_mov_b64 v[32:33], 0
v_mov_b64 v[34:35], 0
v_mov_b64 v[36:37], 0
v_mov_b64 v[38:39], 0
v_mov_b64 v[40:41], 0
v_mov_b64 v[42:43], 0
v_mov_b64 v[44:45], 0
v_mov_b64 v[46:47], 0
buffer_load_dwordx4 v[4:7], v0, s[4:7], s33 offen offset:1024 sc1
buffer_load_dwordx4 v[8:11], v0, s[4:7], s33 offen offset:0 sc1
s_add_u32 s44, s44, 16384
s_bitset0_b32 s44, 16
s_sub_u32 s45, s45, 1
s_waitcnt lgkmcnt(0)
buffer_load_dwordx4 v[12:15], v0, s[4:7], s34 offen offset:0 sc1
s_min_u32 s66, s66, s67
s_cmp_gt_u32 s66, s31
s_cbranch_scc0 k_fl_147
k_okF_149:
buffer_load_dwordx4 v[16:19], v0, s[4:7], s35 offen offset:0 sc1
s_barrier
s_cmp_lg_u32 s31, s47
s_cbranch_scc1 k_T0_138
s_branch k_done_144
k_cold_139:
s_sub_u32 s32, s32, 1
s_cmp_gt_i32 s32, 0
s_cbranch_scc0 k_okC_141
k_cold2_140:
s_waitcnt lgkmcnt(0)
buffer_load_dwordx4 v[4:7], v0, s[4:7], s33 offen offset:1024 sc1
buffer_load_dwordx4 v[8:11], v0, s[4:7], s33 offen offset:0 sc1
buffer_load_dwordx4 v[12:15], v0, s[4:7], s34 offen offset:0 sc1
buffer_load_dwordx4 v[16:19], v0, s[4:7], s35 offen offset:0 sc1
buffer_load_dwordx4 v[48:51], v0, s[4:7], s60 offen offset:0
buffer_load_dwordx4 v[52:55], v0, s[4:7], s60 offen offset:1024
s_waitcnt vmcnt(9)
ds_read_b128 v[56:59], v0 offset:26624
s_waitcnt vmcnt(8)
ds_read_b128 v[60:63], v0 offset:27648
ds_read_b128 v[64:67], v0 offset:28672
ds_read_b128 v[68:71], v0 offset:29696
v_mov_b64 v[24:25], 0
v_mov_b64 v[26:27], 0
v_mov_b64 v[28:29], 0
v_mov_b64 v[30:31], 0
v_mov_b64 v[32:33], 0
v_mov_b64 v[34:35], 0
v_mov_b64 v[36:37], 0
v_mov_b64 v[38:39], 0
v_mov_b64 v[40:41], 0
v_mov_b64 v[42:43], 0
v_mov_b64 v[44:45], 0
v_mov_b64 v[46:47], 0
s_waitcnt vmcnt(0)
s_branch k_T0_138
k_fl_147:
buffer_load_dwordx2 v[46:47], off, s[4:7], s46 sc1
s_waitcnt vmcnt(0)
v_min_u32 v46, v46, v47
v_cmp_lt_u32 vcc, s31, v46
v_mov_b64 v[46:47], 0
s_cbranch_vccnz k_okF_149
s_sub_u32 s32, s32, 1
s_cmp_gt_i32 s32, 0
s_cbranch_scc1 k_fl_147
s_branch k_okF_149
k_r1_145:
buffer_load_dwordx4 v[24:27], v0, s[4:7], s43 offen offset:0 sc1
buffer_load_dwordx4 v[28:31], v0, s[4:7], s43 offen offset:1024 sc1
buffer_load_dwordx4 v[32:35], v0, s[4:7], s43 offen offset:2048 sc1
buffer_load_dwordx4 v[36:39], v0, s[4:7], s43 offen offset:3072 sc1
s_sub_u32 s32, s32, 1
s_cmp_gt_i32 s32, 0
s_waitcnt vmcnt(3)
v_mfma_f32_16x16x32_bf16 v[40:43], v[24:27], v[16:19], 0
s_waitcnt vmcnt(2)
v_mfma_f32_16x16x32_bf16 v[40:43], v[28:31], v[16:19], v[40:43]
v_bitop3_b32 v46, v24, v28, s45 bitop3:0x7e
s_waitcnt vmcnt(1)
v_mfma_f32_16x16x32_bf16 v[40:43], v[32:35], v[16:19], v[40:43]
s_waitcnt vmcnt(0)
v_mfma_f32_16x16x32_bf16 v[40:43], v[36:39], v[16:19], v[40:43]
v_bitop3_b32 v47, v32, v36, s45 bitop3:0x7e
v_bitop3_b32 v46, v46, v47, 1 bitop3:0xa8
v_cmp_ne_u32 vcc, 0, v46
v_mov_b64 v[24:25], 0
v_mov_b64 v[26:27], 0
v_mov_b64 v[28:29], 0
v_mov_b64 v[30:31], 0
v_permlane32_swap_b32 v40, v41
v_permlane32_swap_b32 v42, v43
v_add_f32 v40, v40, v41
v_add_f32 v41, v42, v43
v_cvt_pk_bf16_f32 v42, v40, v41
s_cbranch_vccz k_ok1_146
s_cbranch_scc1 k_r1_145
s_branch k_ok1_146
k_slow_142:
ds_read_b128 v[24:27], v0 offset:4096
ds_read_b128 v[28:31], v0 offset:5120
v_mov_b32 v46, 0xff7fffff
s_add_u32 s48, s36, 0xfffff000
buffer_load_dwordx4 v[32:35], v0, s[4:7], s48 offen offset:0 sc1
buffer_load_dwordx4 v[36:39], v0, s[4:7], s48 offen offset:1024 sc1
s_waitcnt vmcnt(1) lgkmcnt(1)
v_mfma_f32_16x16x32_bf16 v[4:7], v[32:35], v[24:27], 0
s_waitcnt vmcnt(0) lgkmcnt(0)
v_mfma_f32_16x16x32_bf16 v[4:7], v[36:39], v[28:31], v[4:7]
v_mov_b64 v[8:9], s[56:57]
s_nop 5
v_permlane32_swap_b32 v4, v6
v_permlane32_swap_b32 v5, v7
v_add_f32_dpp v8, v6, v4 row_ror:8 row_mask:0xf bank_mask:0x3
s_nop 0
v_add_f32_dpp v9, v7, v5 row_ror:8 row_mask:0xf bank_mask:0x3
v_max3_f32 v46, v46, v8, v9
s_add_u32 s48, s36, 0x0
buffer_load_dwordx4 v[32:35], v0, s[4:7], s48 offen offset:0 sc1
buffer_load_dwordx4 v[36:39], v0, s[4:7], s48 offen offset:1024 sc1
s_waitcnt vmcnt(1)
v_mfma_f32_16x16x32_bf16 v[4:7], v[32:35], v[24:27], 0
s_waitcnt vmcnt(0)
v_mfma_f32_16x16x32_bf16 v[4:7], v[36:39], v[28:31], v[4:7]
v_mov_b64 v[10:11], s[56:57]
s_nop 5
v_permlane32_swap_b32 v4, v6
v_permlane32_swap_b32 v5, v7
v_add_f32_dpp v10, v6, v4 row_ror:8 row_mask:0xf bank_mask:0x3
s_nop 0
v_add_f32_dpp v11, v7, v5 row_ror:8 row_mask:0xf bank_mask:0x3
v_max3_f32 v46, v46, v10, v11
s_add_u32 s48, s36, 0x1000
buffer_load_dwordx4 v[32:35], v0, s[4:7], s48 offen offset:0 sc1
buffer_load_dwordx4 v[36:39], v0, s[4:7], s48 offen offset:1024 sc1
s_waitcnt vmcnt(1)
v_mfma_f32_16x16x32_bf16 v[4:7], v[32:35], v[24:27], 0
s_waitcnt vmcnt(0)
v_mfma_f32_16x16x32_bf16 v[4:7], v[36:39], v[28:31], v[4:7]
v_mov_b64 v[12:13], s[56:57]
s_nop 5
v_permlane32_swap_b32 v4, v6
v_permlane32_swap_b32 v5, v7
v_add_f32_dpp v12, v6, v4 row_ror:8 row_mask:0xf bank_mask:0x3
s_nop 0
v_add_f32_dpp v13, v7, v5 row_ror:8 row_mask:0xf bank_mask:0x3
v_max3_f32 v46, v46, v12, v13
s_add_u32 s48, s36, 0x2000
buffer_load_dwordx4 v[32:35], v0, s[4:7], s48 offen offset:0 sc1
buffer_load_dwordx4 v[36:39], v0, s[4:7], s48 offen offset:1024 sc1
s_waitcnt vmcnt(1)
v_mfma_f32_16x16x32_bf16 v[4:7], v[32:35], v[24:27], 0
s_waitcnt vmcnt(0)
v_mfma_f32_16x16x32_bf16 v[4:7], v[36:39], v[28:31], v[4:7]
v_mov_b64 v[14:15], s[56:57]
s_nop 5
v_permlane32_swap_b32 v4, v6
v_permlane32_swap_b32 v5, v7
v_add_f32_dpp v14, v6, v4 row_ror:8 row_mask:0xf bank_mask:0x3
s_nop 0
v_add_f32_dpp v15, v7, v5 row_ror:8 row_mask:0xf bank_mask:0x3
v_max3_f32 v46, v46, v14, v15
ds_read_b128 v[32:35], v0 offset:6144
ds_read_b128 v[36:39], v0 offset:7168
s_waitcnt lgkmcnt(1)
v_mfma_f32_16x16x32_bf16 v[4:7], v[32:35], v[24:27], 0
s_waitcnt lgkmcnt(0)
v_mfma_f32_16x16x32_bf16 v[4:7], v[36:39], v[28:31], v[4:7]
v_mov_b64 v[44:45], s[56:57]
s_nop 5
v_permlane32_swap_b32 v4, v6
v_permlane32_swap_b32 v5, v7
v_add_f32_dpp v44, v6, v4 row_ror:8 row_mask:0xf bank_mask:0x3
s_nop 0
v_add_f32_dpp v45, v7, v5 row_ror:8 row_mask:0xf bank_mask:0x3
v_max3_f32 v46, v46, v44, v45
buffer_load_dwordx4 v[32:35], v0, s[4:7], s36 offen offset:2048 sc1
buffer_load_dwordx4 v[36:39], v0, s[4:7], s36 offen offset:3072 sc1
v_mov_b32 v47, v46
s_nop 1
v_permlane32_swap_b32 v46, v47
v_max_f32 v46, v46, v47
v_mov_b32 v47, v46
s_nop 1
v_permlane16_swap_b32 v46, v47
v_max_f32 v46, v46, v47
v_sub_f32 v8, v8, v46
v_exp_f32 v8, v8
v_sub_f32 v9, v9, v46
v_exp_f32 v9, v9
v_sub_f32 v10, v10, v46
v_exp_f32 v10, v10
v_sub_f32 v11, v11, v46
v_exp_f32 v11, v11
v_sub_f32 v12, v12, v46
v_exp_f32 v12, v12
v_sub_f32 v13, v13, v46
v_exp_f32 v13, v13
v_sub_f32 v14, v14, v46
v_exp_f32 v14, v14
v_sub_f32 v15, v15, v46
v_exp_f32 v15, v15
v_sub_f32 v44, v44, v46
v_exp_f32 v44, v44
v_sub_f32 v45, v45, v46
v_exp_f32 v45, v45
v_cvt_pk_bf16_f32 v4, v8, v9
v_cvt_pk_bf16_f32 v5, v10, v11
v_cvt_pk_bf16_f32 v6, v12, v13
v_cvt_pk_bf16_f32 v7, v14, v15
v_mov_b32_dpp v8, v4 row_ror:8 row_mask:0xf bank_mask:0xf
v_mov_b32_dpp v9, v5 row_ror:8 row_mask:0xf bank_mask:0xf
v_mov_b32_dpp v10, v6 row_ror:8 row_mask:0xf bank_mask:0xf
v_mov_b32_dpp v11, v7 row_ror:8 row_mask:0xf bank_mask:0xf
v_cvt_pk_bf16_f32 v24, v44, v45
v_cvt_pk_bf16_f32 v25, v44, v45
s_nop 0
v_mov_b32_dpp v26, v24 row_ror:8 row_mask:0xf bank_mask:0xf
v_mov_b32_dpp v27, v24 row_ror:8 row_mask:0xf bank_mask:0xf
v_mov_b64 v[28:29], s[52:53]
v_mov_b64 v[30:31], s[52:53]
s_nop 1
v_mfma_f32_16x16x32_bf16 v[44:47], v[28:31], v[4:7], 0
s_waitcnt vmcnt(1)
v_mfma_f32_16x16x32_bf16 v[12:15], v[32:35], v[4:7], 0
s_waitcnt vmcnt(0)
v_mfma_f32_16x16x32_bf16 v[12:15], v[36:39], v[8:11], v[12:15]
v_mfma_f32_16x16x32_bf16 v[12:15], v[40:43], v[24:27], v[12:15]
v_mov_b64 v[28:29], s[54:55]
s_nop 1
v_mfma_f32_16x16x16_bf16 v[44:47], v[28:29], v[24:25], v[44:47]
s_nop 6
v_rcp_f32 v4, v44
s_nop 1
v_rcp_f32_dpp v4, v44 row_ror:8 row_mask:0xf bank_mask:0xc
s_nop 0
v_mul_f32 v12, v4, v12
v_mul_f32 v13, v4, v13
v_mul_f32 v14, v4, v14
v_mul_f32 v15, v4, v15
v_cvt_pk_bf16_f32 v44, v12, v13
v_cvt_pk_bf16_f32 v45, v14, v15
v_and_or_b32 v8, v1, 8, v3
ds_write_b64 v8, v[44:45] offset:2176
v_mov_b32_dpp v46, v44 row_ror:8 row_mask:0xf bank_mask:0xf
v_mov_b32_dpp v47, v45 row_ror:8 row_mask:0xf bank_mask:0xf
v_mov_b64 v[24:25], 0
v_mov_b64 v[26:27], 0
v_mov_b64 v[28:29], 0
v_mov_b64 v[30:31], 0
v_mov_b64 v[32:33], 0
v_mov_b64 v[34:35], 0
v_mov_b64 v[36:37], 0
v_mov_b64 v[38:39], 0
s_waitcnt lgkmcnt(0)
s_branch k_okS_143
k_done_144:
s_add_u32 s31, s31, 1
s_cmp_lt_u32 s31, 128
s_cbranch_scc1 k_lay_137
s_add_u32 s30, s30, 112
s_waitcnt vmcnt(0) lgkmcnt(0)
s_barrier
s_branch k_fin_7
k_w2_110:
v_lshrrev_b32 v12, 3, v0
v_lshlrev_b32 v10, 13, v12
v_bfe_u32 v12, v0, 1, 2
v_lshrrev_b32 v13, 4, v0
v_xor_b32 v12, v12, v13
v_lshl_add_u32 v10, v12, 5, v10
v_and_b32 v14, 1, v0
v_lshl_add_u32 v10, v14, 4, v10
v_mul_u32_u24 v11, 1280, v13
v_bfe_u32 v12, v0, 1, 3
v_and_b32 v13, 1, v13
v_lshlrev_b32 v13, 1, v13
v_xor_b32 v12, v12, v13
v_xor_b32 v12, 4, v12
v_lshl_add_u32 v11, v12, 5, v11
v_lshl_add_u32 v11, v14, 4, v11
v_bfe_u32 v12, v0, 5, 1
v_lshlrev_b32 v12, 4, v12
v_bfe_u32 v13, v0, 4, 1
v_lshl_add_u32 v12, v13, 1, v12
v_bfe_u32 v13, v0, 2, 1
v_lshl_add_u32 v12, v13, 2, v12
v_bfe_u32 v13, v0, 3, 1
v_mul_u32_u24 v15, 4224, v13
v_add_u32 v12, v13, v12
v_bfe_u32 v13, v12, 1, 2
v_xor_b32 v13, 2, v13
v_lshlrev_b32 v13, 5, v13
v_lshl_add_u32 v4, v12, 7, v13
v_and_b32 v14, 3, v0
v_lshl_add_u32 v4, v14, 3, v4
v_add_u32 v5, 0x10000, v4
v_add_u32 v6, 0x20000, v4
v_bfe_u32 v12, v0, 4, 1
v_lshlrev_b32 v13, 4, v12
v_lshlrev_b32 v12, 2, v12
v_bfe_u32 v8, v0, 5, 1
v_lshl_add_u32 v13, v8, 2, v13
v_bfe_u32 v8, v0, 2, 1
v_add_u32 v13, v8, v13
v_lshl_add_u32 v12, v8, 1, v12
v_bfe_u32 v8, v0, 3, 1
v_add_u32 v8, 4, v8
v_xor_b32 v12, v12, v8
v_lshlrev_b32 v12, 5, v12
v_lshl_add_u32 v7, v13, 8, v12
v_lshl_add_u32 v7, v14, 3, v7
v_add_u32 v8, 0x10000, v7
v_add_u32 v9, 0x20000, v7
v_lshlrev_b32 v0, 4, v0
v_add_u32 v2, 65536, v0
s_lshl_b32 s49, s30, 8
s_mul_i32 s50, s30, 163840
s_mul_i32 s60, s30, 131072
s_add_u32 s60, s60, 120651776
s_add_u32 s61, s60, 4096
s_add_u32 s62, s60, 8192
s_mov_b32 m0, 4096
s_add_u32 s48, s49, 262144
buffer_load_dwordx4 v10, s[8:11], s48 offen lds
s_mov_b32 m0, 5120
s_add_u32 s48, s49, 327680
buffer_load_dwordx4 v10, s[8:11], s48 offen lds
s_mov_b32 m0, 12288
s_add_u32 s48, s49, 262272
buffer_load_dwordx4 v10, s[12:15], s48 offen lds
s_mov_b32 m0, 13312
s_add_u32 s48, s49, 327808
buffer_load_dwordx4 v10, s[12:15], s48 offen lds
s_mov_b32 m0, 20480
s_add_u32 s48, s49, 262144
buffer_load_dwordx4 v10, s[16:19], s48 offen lds
s_mov_b32 m0, 21504
s_add_u32 s48, s49, 327680
buffer_load_dwordx4 v10, s[16:19], s48 offen lds
s_mov_b32 m0, 28672
s_add_u32 s48, s49, 262272
buffer_load_dwordx4 v10, s[16:19], s48 offen lds
s_mov_b32 m0, 29696
s_add_u32 s48, s49, 327808
buffer_load_dwordx4 v10, s[16:19], s48 offen lds
s_mov_b32 m0, 36864
s_add_u32 s48, s49, 786432
buffer_load_dwordx4 v10, s[8:11], s48 offen lds
s_mov_b32 m0, 37888
s_add_u32 s48, s49, 851968
buffer_load_dwordx4 v10, s[8:11], s48 offen lds
s_mov_b32 m0, 45056
s_add_u32 s48, s49, 786560
buffer_load_dwordx4 v10, s[12:15], s48 offen lds
s_mov_b32 m0, 46080
s_add_u32 s48, s49, 852096
buffer_load_dwordx4 v10, s[12:15], s48 offen lds
s_mov_b32 m0, 53248
s_add_u32 s48, s49, 786432
buffer_load_dwordx4 v10, s[16:19], s48 offen lds
s_mov_b32 m0, 54272
s_add_u32 s48, s49, 851968
buffer_load_dwordx4 v10, s[16:19], s48 offen lds
s_mov_b32 m0, 61440
s_add_u32 s48, s49, 786560
buffer_load_dwordx4 v10, s[16:19], s48 offen lds
s_mov_b32 m0, 62464
s_add_u32 s48, s49, 852096
buffer_load_dwordx4 v10, s[16:19], s48 offen lds
s_mov_b32 m0, 69632
s_add_u32 s48, s49, 1310720
buffer_load_dwordx4 v10, s[8:11], s48 offen lds
s_mov_b32 m0, 70656
s_add_u32 s48, s49, 1376256
buffer_load_dwordx4 v10, s[8:11], s48 offen lds
s_mov_b32 m0, 77824
s_add_u32 s48, s49, 1310848
buffer_load_dwordx4 v10, s[12:15], s48 offen lds
s_mov_b32 m0, 78848
s_add_u32 s48, s49, 1376384
buffer_load_dwordx4 v10, s[12:15], s48 offen lds
s_mov_b32 m0, 86016
s_add_u32 s48, s49, 3407872
buffer_load_dwordx4 v10, s[12:15], s48 offen lds
s_mov_b32 m0, 87040
s_add_u32 s48, s49, 3473408
buffer_load_dwordx4 v10, s[12:15], s48 offen lds
s_mov_b32 m0, 94208
s_add_u32 s48, s49, 3408000
buffer_load_dwordx4 v10, s[12:15], s48 offen lds
s_mov_b32 m0, 95232
s_add_u32 s48, s49, 3473536
buffer_load_dwordx4 v10, s[12:15], s48 offen lds
s_mov_b32 m0, 102400
s_add_u32 s48, s49, 3407872
buffer_load_dwordx4 v10, s[16:19], s48 offen lds
s_mov_b32 m0, 103424
s_add_u32 s48, s49, 3473408
buffer_load_dwordx4 v10, s[16:19], s48 offen lds
s_mov_b32 m0, 110592
s_add_u32 s48, s49, 3408000
buffer_load_dwordx4 v10, s[16:19], s48 offen lds
s_mov_b32 m0, 111616
s_add_u32 s48, s49, 3473536
buffer_load_dwordx4 v10, s[16:19], s48 offen lds
s_mov_b32 m0, 118784
s_add_u32 s48, s49, 1835008
buffer_load_dwordx4 v10, s[8:11], s48 offen lds
s_mov_b32 m0, 119808
s_add_u32 s48, s49, 1900544
buffer_load_dwordx4 v10, s[8:11], s48 offen lds
s_mov_b32 m0, 126976
s_add_u32 s48, s49, 2359296
buffer_load_dwordx4 v10, s[8:11], s48 offen lds
s_mov_b32 m0, 128000
s_add_u32 s48, s49, 2424832
buffer_load_dwordx4 v10, s[8:11], s48 offen lds
s_waitcnt vmcnt(24)
s_barrier
s_mov_b32 m0, 135168
s_add_u32 s48, s49, 2883584
buffer_load_dwordx4 v10, s[8:11], s48 offen lds
s_mov_b32 m0, 136192
s_add_u32 s48, s49, 2949120
buffer_load_dwordx4 v10, s[8:11], s48 offen lds
s_mov_b32 m0, 143360
s_add_u32 s48, s49, 3932160
buffer_load_dwordx4 v10, s[8:11], s48 offen lds
s_mov_b32 m0, 144384
s_add_u32 s48, s49, 3997696
buffer_load_dwordx4 v10, s[8:11], s48 offen lds
s_mov_b32 m0, 151552
s_add_u32 s48, s49, 3932288
buffer_load_dwordx4 v10, s[8:11], s48 offen lds
s_mov_b32 m0, 152576
s_add_u32 s48, s49, 3997824
buffer_load_dwordx4 v10, s[8:11], s48 offen lds
s_mov_b32 m0, 159744
s_add_u32 s48, s49, 4456448
buffer_load_dwordx4 v10, s[8:11], s48 offen lds
s_mov_b32 m0, 160768
s_add_u32 s48, s49, 4521984
buffer_load_dwordx4 v10, s[8:11], s48 offen lds
ds_read_b64_tr_b16 v[16:17], v4 offset:0
ds_read_b64_tr_b16 v[18:19], v4 offset:1024
ds_read_b64_tr_b16 v[20:21], v4 offset:4096
ds_read_b64_tr_b16 v[22:23], v4 offset:5120
ds_read_b64_tr_b16 a[0:1], v4 offset:8192
ds_read_b64_tr_b16 a[2:3], v4 offset:9216
ds_read_b64_tr_b16 a[4:5], v4 offset:12288
ds_read_b64_tr_b16 a[6:7], v4 offset:13312
ds_read_b64_tr_b16 a[8:9], v4 offset:16384
ds_read_b64_tr_b16 a[10:11], v4 offset:17408
ds_read_b64_tr_b16 a[12:13], v4 offset:20480
ds_read_b64_tr_b16 a[14:15], v4 offset:21504
ds_read_b64_tr_b16 a[16:17], v4 offset:24576
ds_read_b64_tr_b16 a[18:19], v4 offset:25600
ds_read_b64_tr_b16 a[20:21], v4 offset:28672
ds_read_b64_tr_b16 a[22:23], v4 offset:29696
s_waitcnt lgkmcnt(0)
buffer_store_dwordx4 v[16:19], v0, s[4:7], s60 offen offset:0
buffer_store_dwordx4 v[20:23], v0, s[4:7], s60 offen offset:1024
s_waitcnt vmcnt(26)
s_barrier
s_mov_b32 m0, 4096
s_add_u32 s48, s49, 4456576
buffer_load_dwordx4 v10, s[8:11], s48 offen lds
s_mov_b32 m0, 5120
s_add_u32 s48, s49, 4522112
buffer_load_dwordx4 v10, s[8:11], s48 offen lds
s_mov_b32 m0, 12288
s_add_u32 s48, s49, 4980736
buffer_load_dwordx4 v10, s[8:11], s48 offen lds
s_mov_b32 m0, 13312
s_add_u32 s48, s49, 5046272
buffer_load_dwordx4 v10, s[8:11], s48 offen lds
s_mov_b32 m0, 20480
s_add_u32 s48, s49, 4980864
buffer_load_dwordx4 v10, s[8:11], s48 offen lds
s_mov_b32 m0, 21504
s_add_u32 s48, s49, 5046400
buffer_load_dwordx4 v10, s[8:11], s48 offen lds
s_mov_b32 m0, 28672
s_add_u32 s48, s49, 3932160
buffer_load_dwordx4 v10, s[12:15], s48 offen lds
s_mov_b32 m0, 29696
s_add_u32 s48, s49, 3997696
buffer_load_dwordx4 v10, s[12:15], s48 offen lds
ds_read_b64_tr_b16 a[24:25], v4 offset:32768
ds_read_b64_tr_b16 a[26:27], v4 offset:33792
ds_read_b64_tr_b16 a[28:29], v4 offset:36864
ds_read_b64_tr_b16 a[30:31], v4 offset:37888
ds_read_b64_tr_b16 a[32:33], v4 offset:40960
ds_read_b64_tr_b16 a[34:35], v4 offset:41984
ds_read_b64_tr_b16 a[36:37], v4 offset:45056
ds_read_b64_tr_b16 a[38:39], v4 offset:46080
ds_read_b64_tr_b16 a[40:41], v4 offset:49152
ds_read_b64_tr_b16 a[42:43], v4 offset:50176
ds_read_b64_tr_b16 a[44:45], v4 offset:53248
ds_read_b64_tr_b16 a[46:47], v4 offset:54272
ds_read_b64_tr_b16 a[48:49], v4 offset:57344
ds_read_b64_tr_b16 a[50:51], v4 offset:58368
ds_read_b64_tr_b16 a[52:53], v4 offset:61440
ds_read_b64_tr_b16 a[54:55], v4 offset:62464
s_waitcnt lgkmcnt(0)
s_waitcnt vmcnt(26)
s_barrier
s_mov_b32 m0, 36864
s_add_u32 s48, s49, 3932288
buffer_load_dwordx4 v10, s[12:15], s48 offen lds
s_mov_b32 m0, 37888
s_add_u32 s48, s49, 3997824
buffer_load_dwordx4 v10, s[12:15], s48 offen lds
s_mov_b32 m0, 45056
s_add_u32 s48, s49, 3932160
buffer_load_dwordx4 v10, s[16:19], s48 offen lds
s_mov_b32 m0, 46080
s_add_u32 s48, s49, 3997696
buffer_load_dwordx4 v10, s[16:19], s48 offen lds
s_mov_b32 m0, 53248
s_add_u32 s48, s49, 3932288
buffer_load_dwordx4 v10, s[16:19], s48 offen lds
s_mov_b32 m0, 54272
s_add_u32 s48, s49, 3997824
buffer_load_dwordx4 v10, s[16:19], s48 offen lds
s_mov_b32 m0, 61440
s_add_u32 s48, s49, 4456448
buffer_load_dwordx4 v10, s[12:15], s48 offen lds
s_mov_b32 m0, 62464
s_add_u32 s48, s49, 4521984
buffer_load_dwordx4 v10, s[12:15], s48 offen lds
ds_read_b64_tr_b16 a[128:129], v5 offset:0
ds_read_b64_tr_b16 a[130:131], v5 offset:1024
ds_read_b64_tr_b16 a[132:133], v5 offset:4096
ds_read_b64_tr_b16 a[134:135], v5 offset:5120
ds_read_b64_tr_b16 v[112:113], v5 offset:8192
ds_read_b64_tr_b16 v[114:115], v5 offset:9216
ds_read_b64_tr_b16 v[116:117], v5 offset:12288
ds_read_b64_tr_b16 v[118:119], v5 offset:13312
ds_read_b64_tr_b16 v[248:249], v5 offset:16384
ds_read_b64_tr_b16 v[250:251], v5 offset:17408
ds_read_b64_tr_b16 v[252:253], v5 offset:20480
ds_read_b64_tr_b16 v[254:255], v5 offset:21504
ds_read_b64_tr_b16 a[216:217], v5 offset:24576
ds_read_b64_tr_b16 a[218:219], v5 offset:25600
ds_read_b64_tr_b16 a[220:221], v5 offset:28672
ds_read_b64_tr_b16 a[222:223], v5 offset:29696
s_waitcnt lgkmcnt(0)
s_waitcnt vmcnt(26)
s_barrier
s_mov_b32 m0, 69632
s_add_u32 s48, s49, 4456576
buffer_load_dwordx4 v10, s[12:15], s48 offen lds
s_mov_b32 m0, 70656
s_add_u32 s48, s49, 4522112
buffer_load_dwordx4 v10, s[12:15], s48 offen lds
s_mov_b32 m0, 77824
s_add_u32 s48, s49, 4456448
buffer_load_dwordx4 v10, s[16:19], s48 offen lds
s_mov_b32 m0, 78848
s_add_u32 s48, s49, 4521984
buffer_load_dwordx4 v10, s[16:19], s48 offen lds
s_mov_b32 m0, 86016
s_add_u32 s48, s49, 4456576
buffer_load_dwordx4 v10, s[16:19], s48 offen lds
s_mov_b32 m0, 87040
s_add_u32 s48, s49, 4522112
buffer_load_dwordx4 v10, s[16:19], s48 offen lds
s_mov_b32 m0, 94208
s_add_u32 s48, s49, 4980736
buffer_load_dwordx4 v10, s[12:15], s48 offen lds
s_mov_b32 m0, 95232
s_add_u32 s48, s49, 5046272
buffer_load_dwordx4 v10, s[12:15], s48 offen lds
ds_read_b64_tr_b16 a[224:225], v5 offset:32768
ds_read_b64_tr_b16 a[226:227], v5 offset:33792
ds_read_b64_tr_b16 a[228:229], v5 offset:36864
ds_read_b64_tr_b16 a[230:231], v5 offset:37888
ds_read_b64_tr_b16 a[232:233], v5 offset:40960
ds_read_b64_tr_b16 a[234:235], v5 offset:41984
ds_read_b64_tr_b16 a[236:237], v5 offset:45056
ds_read_b64_tr_b16 a[238:239], v5 offset:46080
ds_read_b64_tr_b16 a[144:145], v5 offset:49152
ds_read_b64_tr_b16 a[146:147], v5 offset:50176
ds_read_b64_tr_b16 a[148:149], v5 offset:53248
ds_read_b64_tr_b16 a[150:151], v5 offset:54272
ds_read_b64_tr_b16 a[56:57], v5 offset:57344
ds_read_b64_tr_b16 a[58:59], v5 offset:58368
ds_read_b64_tr_b16 a[60:61], v5 offset:61440
ds_read_b64_tr_b16 a[62:63], v5 offset:62464
s_waitcnt lgkmcnt(0)
s_waitcnt vmcnt(26)
s_barrier
s_mov_b32 m0, 102400
s_add_u32 s48, s49, 4980864
buffer_load_dwordx4 v10, s[12:15], s48 offen lds
s_mov_b32 m0, 103424
s_add_u32 s48, s49, 5046400
buffer_load_dwordx4 v10, s[12:15], s48 offen lds
s_mov_b32 m0, 110592
s_add_u32 s48, s49, 4980736
buffer_load_dwordx4 v10, s[16:19], s48 offen lds
s_mov_b32 m0, 111616
s_add_u32 s48, s49, 5046272
buffer_load_dwordx4 v10, s[16:19], s48 offen lds
s_mov_b32 m0, 118784
s_add_u32 s48, s49, 4980864
buffer_load_dwordx4 v10, s[16:19], s48 offen lds
s_mov_b32 m0, 119808
s_add_u32 s48, s49, 5046400
buffer_load_dwordx4 v10, s[16:19], s48 offen lds
s_mov_b32 m0, 126976
s_add_u32 s48, s49, 2883584
buffer_load_dwordx4 v10, s[12:15], s48 offen lds
s_mov_b32 m0, 128000
s_add_u32 s48, s49, 2949120
buffer_load_dwordx4 v10, s[12:15], s48 offen lds
ds_read_b64_tr_b16 a[120:121], v6 offset:0
ds_read_b64_tr_b16 a[122:123], v6 offset:1024
ds_read_b64_tr_b16 a[124:125], v6 offset:4096
ds_read_b64_tr_b16 a[126:127], v6 offset:5120
ds_read_b64_tr_b16 a[184:185], v6 offset:8192
ds_read_b64_tr_b16 a[186:187], v6 offset:9216
ds_read_b64_tr_b16 a[188:189], v6 offset:12288
ds_read_b64_tr_b16 a[190:191], v6 offset:13312
ds_read_b64_tr_b16 v[224:225], v6 offset:16384
ds_read_b64_tr_b16 v[226:227], v6 offset:17408
ds_read_b64_tr_b16 v[228:229], v6 offset:20480
ds_read_b64_tr_b16 v[230:231], v6 offset:21504
ds_read_b64_tr_b16 a[80:81], v6 offset:24576
ds_read_b64_tr_b16 a[82:83], v6 offset:25600
ds_read_b64_tr_b16 a[84:85], v6 offset:28672
ds_read_b64_tr_b16 a[86:87], v6 offset:29696
s_waitcnt lgkmcnt(0)
s_waitcnt vmcnt(24)
s_barrier
s_mov_b32 m0, 135168
s_add_u32 s48, s49, 2883712
buffer_load_dwordx4 v10, s[12:15], s48 offen lds
s_mov_b32 m0, 136192
s_add_u32 s48, s49, 2949248
buffer_load_dwordx4 v10, s[12:15], s48 offen lds
s_mov_b32 m0, 143360
s_add_u32 s48, s49, 1835008
buffer_load_dwordx4 v10, s[12:15], s48 offen lds
s_mov_b32 m0, 144384
s_add_u32 s48, s49, 1900544
buffer_load_dwordx4 v10, s[12:15], s48 offen lds
s_mov_b32 m0, 151552
s_add_u32 s48, s49, 1835136
buffer_load_dwordx4 v10, s[12:15], s48 offen lds
s_mov_b32 m0, 152576
s_add_u32 s48, s49, 1900672
buffer_load_dwordx4 v10, s[12:15], s48 offen lds
s_mov_b32 m0, 159744
s_add_u32 s48, s49, 2359296
buffer_load_dwordx4 v10, s[12:15], s48 offen lds
s_mov_b32 m0, 160768
s_add_u32 s48, s49, 2424832
buffer_load_dwordx4 v10, s[12:15], s48 offen lds
ds_read_b64_tr_b16 a[88:89], v4 offset:0
ds_read_b64_tr_b16 a[90:91], v4 offset:1024
ds_read_b64_tr_b16 a[92:93], v4 offset:4096
ds_read_b64_tr_b16 a[94:95], v4 offset:5120
ds_read_b64_tr_b16 v[232:233], v4 offset:8192
ds_read_b64_tr_b16 v[234:235], v4 offset:9216
ds_read_b64_tr_b16 v[236:237], v4 offset:12288
ds_read_b64_tr_b16 v[238:239], v4 offset:13312
ds_read_b64_tr_b16 a[160:161], v4 offset:16384
ds_read_b64_tr_b16 a[162:163], v4 offset:17408
ds_read_b64_tr_b16 a[164:165], v4 offset:20480
ds_read_b64_tr_b16 a[166:167], v4 offset:21504
ds_read_b64_tr_b16 a[240:241], v4 offset:24576
ds_read_b64_tr_b16 a[242:243], v4 offset:25600
ds_read_b64_tr_b16 a[244:245], v4 offset:28672
ds_read_b64_tr_b16 a[246:247], v4 offset:29696
s_waitcnt lgkmcnt(0)
s_waitcnt vmcnt(24)
s_barrier
s_mov_b32 m0, 4096
s_add_u32 s48, s49, 2359424
buffer_load_dwordx4 v10, s[12:15], s48 offen lds
s_mov_b32 m0, 5120
s_add_u32 s48, s49, 2424960
buffer_load_dwordx4 v10, s[12:15], s48 offen lds
s_mov_b32 m0, 12288
s_add_u32 s48, s49, 1835008
buffer_load_dwordx4 v10, s[16:19], s48 offen lds
s_mov_b32 m0, 13312
s_add_u32 s48, s49, 1900544
buffer_load_dwordx4 v10, s[16:19], s48 offen lds
s_mov_b32 m0, 20480
s_add_u32 s48, s49, 1835136
buffer_load_dwordx4 v10, s[16:19], s48 offen lds
s_mov_b32 m0, 21504
s_add_u32 s48, s49, 1900672
buffer_load_dwordx4 v10, s[16:19], s48 offen lds
s_mov_b32 m0, 28672
s_add_u32 s48, s49, 2883584
buffer_load_dwordx4 v10, s[16:19], s48 offen lds
s_mov_b32 m0, 29696
s_add_u32 s48, s49, 2949120
buffer_load_dwordx4 v10, s[16:19], s48 offen lds
ds_read_b64_tr_b16 v[240:241], v4 offset:32768
ds_read_b64_tr_b16 v[242:243], v4 offset:33792
ds_read_b64_tr_b16 v[244:245], v4 offset:36864
ds_read_b64_tr_b16 v[246:247], v4 offset:37888
ds_read_b64_tr_b16 a[248:249], v4 offset:40960
ds_read_b64_tr_b16 a[250:251], v4 offset:41984
ds_read_b64_tr_b16 a[252:253], v4 offset:45056
ds_read_b64_tr_b16 a[254:255], v4 offset:46080
ds_read_b64_tr_b16 v[72:73], v4 offset:49152
ds_read_b64_tr_b16 v[74:75], v4 offset:50176
ds_read_b64_tr_b16 v[76:77], v4 offset:53248
ds_read_b64_tr_b16 v[78:79], v4 offset:54272
ds_read_b64_tr_b16 a[152:153], v4 offset:57344
ds_read_b64_tr_b16 a[154:155], v4 offset:58368
ds_read_b64_tr_b16 a[156:157], v4 offset:61440
ds_read_b64_tr_b16 a[158:159], v4 offset:62464
s_waitcnt lgkmcnt(0)
s_waitcnt vmcnt(24)
s_barrier
s_mov_b32 m0, 36864
s_add_u32 s48, s49, 2883712
buffer_load_dwordx4 v10, s[16:19], s48 offen lds
s_mov_b32 m0, 37888
s_add_u32 s48, s49, 2949248
buffer_load_dwordx4 v10, s[16:19], s48 offen lds
s_mov_b32 m0, 45056
s_add_u32 s48, s49, 2359296
buffer_load_dwordx4 v10, s[16:19], s48 offen lds
s_mov_b32 m0, 46080
s_add_u32 s48, s49, 2424832
buffer_load_dwordx4 v10, s[16:19], s48 offen lds
s_mov_b32 m0, 53248
s_add_u32 s48, s49, 2359424
buffer_load_dwordx4 v10, s[16:19], s48 offen lds
s_mov_b32 m0, 54272
s_add_u32 s48, s49, 2424960
buffer_load_dwordx4 v10, s[16:19], s48 offen lds
s_mov_b32 m0, 61440
s_add_u32 s48, s49, 1310720
buffer_load_dwordx4 v10, s[16:19], s48 offen lds
s_mov_b32 m0, 62464
s_add_u32 s48, s49, 1376256
buffer_load_dwordx4 v10, s[16:19], s48 offen lds
ds_read_b64_tr_b16 a[96:97], v5 offset:0
ds_read_b64_tr_b16 a[98:99], v5 offset:1024
ds_read_b64_tr_b16 a[100:101], v5 offset:4096
ds_read_b64_tr_b16 a[102:103], v5 offset:5120
ds_read_b64_tr_b16 a[104:105], v5 offset:8192
ds_read_b64_tr_b16 a[106:107], v5 offset:9216
ds_read_b64_tr_b16 a[108:109], v5 offset:12288
ds_read_b64_tr_b16 a[110:111], v5 offset:13312
ds_read_b64_tr_b16 a[112:113], v5 offset:16384
ds_read_b64_tr_b16 a[114:115], v5 offset:17408
ds_read_b64_tr_b16 a[116:117], v5 offset:20480
ds_read_b64_tr_b16 a[118:119], v5 offset:21504
ds_read_b64_tr_b16 v[40:41], v5 offset:24576
ds_read_b64_tr_b16 v[42:43], v5 offset:25600
ds_read_b64_tr_b16 v[44:45], v5 offset:28672
ds_read_b64_tr_b16 v[46:47], v5 offset:29696
s_waitcnt lgkmcnt(0)
buffer_store_dwordx4 v[40:43], v0, s[4:7], s60 offen offset:2048
buffer_store_dwordx4 v[44:47], v0, s[4:7], s60 offen offset:3072
s_waitcnt vmcnt(26)
s_barrier
s_mov_b32 m0, 69632
s_add_u32 s48, s49, 1310848
buffer_load_dwordx4 v10, s[16:19], s48 offen lds
s_mov_b32 m0, 70656
s_add_u32 s48, s49, 1376384
buffer_load_dwordx4 v10, s[16:19], s48 offen lds
s_mov_b32 m0, 77824
s_add_u32 s48, s50, 81920
buffer_load_dwordx4 v11, s[20:23], s48 offen lds
s_mov_b32 m0, 78848
s_add_u32 s48, s50, 87040
buffer_load_dwordx4 v11, s[20:23], s48 offen lds
s_mov_b32 m0, 86016
s_add_u32 s48, s50, 102400
buffer_load_dwordx4 v11, s[20:23], s48 offen lds
s_mov_b32 m0, 87040
s_add_u32 s48, s50, 107520
buffer_load_dwordx4 v11, s[20:23], s48 offen lds
s_mov_b32 m0, 94208
s_add_u32 s48, s50, 122880
buffer_load_dwordx4 v11, s[20:23], s48 offen lds
s_mov_b32 m0, 95232
s_add_u32 s48, s50, 128000
buffer_load_dwordx4 v11, s[20:23], s48 offen lds
ds_read_b64_tr_b16 a[192:193], v5 offset:32768
ds_read_b64_tr_b16 a[194:195], v5 offset:33792
ds_read_b64_tr_b16 a[196:197], v5 offset:36864
ds_read_b64_tr_b16 a[198:199], v5 offset:37888
ds_read_b64_tr_b16 a[200:201], v5 offset:40960
ds_read_b64_tr_b16 a[202:203], v5 offset:41984
ds_read_b64_tr_b16 a[204:205], v5 offset:45056
ds_read_b64_tr_b16 a[206:207], v5 offset:46080
ds_read_b64_tr_b16 a[208:209], v5 offset:49152
ds_read_b64_tr_b16 a[210:211], v5 offset:50176
ds_read_b64_tr_b16 a[212:213], v5 offset:53248
ds_read_b64_tr_b16 a[214:215], v5 offset:54272
ds_read_b64_tr_b16 v[104:105], v5 offset:57344
ds_read_b64_tr_b16 v[106:107], v5 offset:58368
ds_read_b64_tr_b16 v[108:109], v5 offset:61440
ds_read_b64_tr_b16 v[110:111], v5 offset:62464
s_waitcnt lgkmcnt(0)
s_waitcnt vmcnt(26)
s_barrier
s_mov_b32 m0, 102400
s_add_u32 s48, s50, 143360
buffer_load_dwordx4 v11, s[20:23], s48 offen lds
s_mov_b32 m0, 103424
s_add_u32 s48, s50, 148480
buffer_load_dwordx4 v11, s[20:23], s48 offen lds
s_mov_b32 m0, 110592
s_add_u32 s48, s50, 82176
buffer_load_dwordx4 v11, s[20:23], s48 offen lds
s_mov_b32 m0, 111616
s_add_u32 s48, s50, 87296
buffer_load_dwordx4 v11, s[20:23], s48 offen lds
s_mov_b32 m0, 118784
s_add_u32 s48, s50, 102656
buffer_load_dwordx4 v11, s[20:23], s48 offen lds
s_mov_b32 m0, 119808
s_add_u32 s48, s50, 107776
buffer_load_dwordx4 v11, s[20:23], s48 offen lds
s_mov_b32 m0, 126976
s_add_u32 s48, s50, 123136
buffer_load_dwordx4 v11, s[20:23], s48 offen lds
s_mov_b32 m0, 128000
s_add_u32 s48, s50, 128256
buffer_load_dwordx4 v11, s[20:23], s48 offen lds
ds_read_b64_tr_b16 v[96:97], v6 offset:0
ds_read_b64_tr_b16 v[98:99], v6 offset:1024
ds_read_b64_tr_b16 v[100:101], v6 offset:4096
ds_read_b64_tr_b16 v[102:103], v6 offset:5120
ds_read_b64_tr_b16 v[80:81], v6 offset:8192
ds_read_b64_tr_b16 v[82:83], v6 offset:9216
ds_read_b64_tr_b16 v[84:85], v6 offset:12288
ds_read_b64_tr_b16 v[86:87], v6 offset:13312
ds_read_b64_tr_b16 v[88:89], v6 offset:16384
ds_read_b64_tr_b16 v[90:91], v6 offset:17408
ds_read_b64_tr_b16 v[92:93], v6 offset:20480
ds_read_b64_tr_b16 v[94:95], v6 offset:21504
ds_read_b64_tr_b16 a[64:65], v6 offset:24576
ds_read_b64_tr_b16 a[66:67], v6 offset:25600
ds_read_b64_tr_b16 a[68:69], v6 offset:28672
ds_read_b64_tr_b16 a[70:71], v6 offset:29696
s_waitcnt lgkmcnt(0)
s_waitcnt vmcnt(26)
s_barrier
s_mov_b32 m0, 135168
s_add_u32 s48, s50, 143616
buffer_load_dwordx4 v11, s[20:23], s48 offen lds
s_mov_b32 m0, 136192
s_add_u32 s48, s50, 148736
buffer_load_dwordx4 v11, s[20:23], s48 offen lds
s_mov_b32 m0, 143360
s_add_u32 s48, s50, 82432
buffer_load_dwordx4 v11, s[20:23], s48 offen lds
s_mov_b32 m0, 144384
s_add_u32 s48, s50, 87552
buffer_load_dwordx4 v11, s[20:23], s48 offen lds
s_mov_b32 m0, 151552
s_add_u32 s48, s50, 102912
buffer_load_dwordx4 v11, s[20:23], s48 offen lds
s_mov_b32 m0, 152576
s_add_u32 s48, s50, 108032
buffer_load_dwordx4 v11, s[20:23], s48 offen lds
s_mov_b32 m0, 159744
s_add_u32 s48, s50, 123392
buffer_load_dwordx4 v11, s[20:23], s48 offen lds
s_mov_b32 m0, 160768
s_add_u32 s48, s50, 128512
buffer_load_dwordx4 v11, s[20:23], s48 offen lds
ds_read_b64_tr_b16 a[72:73], v4 offset:0
ds_read_b64_tr_b16 a[74:75], v4 offset:1024
ds_read_b64_tr_b16 a[76:77], v4 offset:4096
ds_read_b64_tr_b16 a[78:79], v4 offset:5120
ds_read_b64_tr_b16 v[128:129], v4 offset:8192
ds_read_b64_tr_b16 v[130:131], v4 offset:9216
ds_read_b64_tr_b16 v[132:133], v4 offset:12288
ds_read_b64_tr_b16 v[134:135], v4 offset:13312
ds_read_b64_tr_b16 v[136:137], v4 offset:16384
ds_read_b64_tr_b16 v[138:139], v4 offset:17408
ds_read_b64_tr_b16 v[140:141], v4 offset:20480
ds_read_b64_tr_b16 v[142:143], v4 offset:21504
ds_read_b64_tr_b16 v[120:121], v4 offset:24576
ds_read_b64_tr_b16 v[122:123], v4 offset:25600
ds_read_b64_tr_b16 v[124:125], v4 offset:28672
ds_read_b64_tr_b16 v[126:127], v4 offset:29696
s_waitcnt lgkmcnt(0)
s_waitcnt vmcnt(26)
s_barrier
s_mov_b32 m0, 4096
s_add_u32 s48, s50, 143872
buffer_load_dwordx4 v11, s[20:23], s48 offen lds
s_mov_b32 m0, 5120
s_add_u32 s48, s50, 148992
buffer_load_dwordx4 v11, s[20:23], s48 offen lds
s_mov_b32 m0, 12288
s_add_u32 s48, s49, 262272
buffer_load_dwordx4 v10, s[8:11], s48 offen lds
s_mov_b32 m0, 13312
s_add_u32 s48, s49, 327808
buffer_load_dwordx4 v10, s[8:11], s48 offen lds
s_mov_b32 m0, 20480
s_add_u32 s48, s49, 262144
buffer_load_dwordx4 v10, s[12:15], s48 offen lds
s_mov_b32 m0, 21504
s_add_u32 s48, s49, 327680
buffer_load_dwordx4 v10, s[12:15], s48 offen lds
s_mov_b32 m0, 28672
s_add_u32 s48, s49, 786560
buffer_load_dwordx4 v10, s[8:11], s48 offen lds
s_mov_b32 m0, 29696
s_add_u32 s48, s49, 852096
buffer_load_dwordx4 v10, s[8:11], s48 offen lds
ds_read_b64_tr_b16 a[168:169], v4 offset:32768
ds_read_b64_tr_b16 a[170:171], v4 offset:33792
ds_read_b64_tr_b16 a[172:173], v4 offset:36864
ds_read_b64_tr_b16 a[174:175], v4 offset:37888
ds_read_b64_tr_b16 v[160:161], v4 offset:40960
ds_read_b64_tr_b16 v[162:163], v4 offset:41984
ds_read_b64_tr_b16 v[164:165], v4 offset:45056
ds_read_b64_tr_b16 v[166:167], v4 offset:46080
ds_read_b64_tr_b16 v[168:169], v4 offset:49152
ds_read_b64_tr_b16 v[170:171], v4 offset:50176
ds_read_b64_tr_b16 v[172:173], v4 offset:53248
ds_read_b64_tr_b16 v[174:175], v4 offset:54272
ds_read_b64_tr_b16 v[144:145], v4 offset:57344
ds_read_b64_tr_b16 v[146:147], v4 offset:58368
ds_read_b64_tr_b16 v[148:149], v4 offset:61440
ds_read_b64_tr_b16 v[150:151], v4 offset:62464
s_waitcnt lgkmcnt(0)
s_waitcnt vmcnt(24)
s_barrier
s_mov_b32 m0, 36864
s_add_u32 s48, s49, 786432
buffer_load_dwordx4 v10, s[12:15], s48 offen lds
s_mov_b32 m0, 37888
s_add_u32 s48, s49, 851968
buffer_load_dwordx4 v10, s[12:15], s48 offen lds
s_mov_b32 m0, 45056
s_add_u32 s48, s49, 1310848
buffer_load_dwordx4 v10, s[8:11], s48 offen lds
s_mov_b32 m0, 46080
s_add_u32 s48, s49, 1376384
buffer_load_dwordx4 v10, s[8:11], s48 offen lds
s_mov_b32 m0, 53248
s_add_u32 s48, s49, 1835136
buffer_load_dwordx4 v10, s[8:11], s48 offen lds
s_mov_b32 m0, 54272
s_add_u32 s48, s49, 1900672
buffer_load_dwordx4 v10, s[8:11], s48 offen lds
s_mov_b32 m0, 61440
s_add_u32 s48, s49, 2359424
buffer_load_dwordx4 v10, s[8:11], s48 offen lds
s_mov_b32 m0, 62464
s_add_u32 s48, s49, 2424960
buffer_load_dwordx4 v10, s[8:11], s48 offen lds
ds_read_b64_tr_b16 v[152:153], v5 offset:0
ds_read_b64_tr_b16 v[154:155], v5 offset:1024
ds_read_b64_tr_b16 v[156:157], v5 offset:4096
ds_read_b64_tr_b16 v[158:159], v5 offset:5120
ds_read_b64_tr_b16 v[184:185], v8 offset:8192
ds_read_b64_tr_b16 v[186:187], v8 offset:8704
ds_read_b64_tr_b16 v[188:189], v8 offset:10240
ds_read_b64_tr_b16 v[190:191], v8 offset:10752
ds_read_b64_tr_b16 v[192:193], v8 offset:16384
ds_read_b64_tr_b16 v[194:195], v8 offset:16896
ds_read_b64_tr_b16 v[196:197], v8 offset:18432
ds_read_b64_tr_b16 v[198:199], v8 offset:18944
v_xor_b32 v12, v15, v8
ds_read_b64_tr_b16 v[40:41], v12 offset:24576
ds_read_b64_tr_b16 v[42:43], v12 offset:25088
ds_read_b64_tr_b16 v[44:45], v12 offset:26624
ds_read_b64_tr_b16 v[46:47], v12 offset:27136
s_waitcnt lgkmcnt(0)
buffer_store_dwordx4 v[40:43], v0, s[4:7], s61 offen offset:0
buffer_store_dwordx4 v[44:47], v0, s[4:7], s61 offen offset:1024
s_waitcnt vmcnt(26)
s_barrier
s_mov_b32 m0, 69632
s_add_u32 s48, s49, 2883712
buffer_load_dwordx4 v10, s[8:11], s48 offen lds
s_mov_b32 m0, 70656
s_add_u32 s48, s49, 2949248
buffer_load_dwordx4 v10, s[8:11], s48 offen lds
s_mov_b32 m0, 77824
s_add_u32 s48, s50, 82688
buffer_load_dwordx4 v11, s[20:23], s48 offen lds
s_mov_b32 m0, 78848
s_add_u32 s48, s50, 87808
buffer_load_dwordx4 v11, s[20:23], s48 offen lds
s_mov_b32 m0, 86016
s_add_u32 s48, s50, 103168
buffer_load_dwordx4 v11, s[20:23], s48 offen lds
s_mov_b32 m0, 87040
s_add_u32 s48, s50, 108288
buffer_load_dwordx4 v11, s[20:23], s48 offen lds
s_mov_b32 m0, 94208
s_add_u32 s48, s50, 123648
buffer_load_dwordx4 v11, s[20:23], s48 offen lds
s_mov_b32 m0, 95232
s_add_u32 s48, s50, 128768
buffer_load_dwordx4 v11, s[20:23], s48 offen lds
ds_read_b64_tr_b16 v[176:177], v8 offset:32768
ds_read_b64_tr_b16 v[178:179], v8 offset:33280
ds_read_b64_tr_b16 v[180:181], v8 offset:34816
ds_read_b64_tr_b16 v[182:183], v8 offset:35328
ds_read_b64_tr_b16 a[136:137], v8 offset:40960
ds_read_b64_tr_b16 a[138:139], v8 offset:41472
ds_read_b64_tr_b16 a[140:141], v8 offset:43008
ds_read_b64_tr_b16 a[142:143], v8 offset:43520
ds_read_b64_tr_b16 v[32:33], v8 offset:49152
ds_read_b64_tr_b16 v[34:35], v8 offset:49664
ds_read_b64_tr_b16 v[36:37], v8 offset:51200
ds_read_b64_tr_b16 v[38:39], v8 offset:51712
v_xor_b32 v12, v15, v8
ds_read_b64_tr_b16 v[40:41], v12 offset:57344
ds_read_b64_tr_b16 v[42:43], v12 offset:57856
ds_read_b64_tr_b16 v[44:45], v12 offset:59392
ds_read_b64_tr_b16 v[46:47], v12 offset:59904
s_waitcnt lgkmcnt(0)
buffer_store_dwordx4 v[32:35], v0, s[4:7], s62 offen offset:0
buffer_store_dwordx4 v[36:39], v0, s[4:7], s62 offen offset:1024
buffer_store_dwordx4 v[40:43], v0, s[4:7], s61 offen offset:2048
buffer_store_dwordx4 v[44:47], v0, s[4:7], s61 offen offset:3072
s_waitcnt vmcnt(30)
s_barrier
s_mov_b32 m0, 102400
s_add_u32 s48, s50, 144128
buffer_load_dwordx4 v11, s[20:23], s48 offen lds
s_mov_b32 m0, 103424
s_add_u32 s48, s50, 149248
buffer_load_dwordx4 v11, s[20:23], s48 offen lds
s_mov_b32 m0, 110592
s_add_u32 s48, s50, 82944
buffer_load_dwordx4 v11, s[20:23], s48 offen lds
s_mov_b32 m0, 111616
s_add_u32 s48, s50, 88064
buffer_load_dwordx4 v11, s[20:23], s48 offen lds
s_mov_b32 m0, 118784
s_add_u32 s48, s50, 103424
buffer_load_dwordx4 v11, s[20:23], s48 offen lds
s_mov_b32 m0, 119808
s_add_u32 s48, s50, 108544
buffer_load_dwordx4 v11, s[20:23], s48 offen lds
s_mov_b32 m0, 126976
s_add_u32 s48, s50, 123904
buffer_load_dwordx4 v11, s[20:23], s48 offen lds
s_mov_b32 m0, 128000
s_add_u32 s48, s50, 129024
buffer_load_dwordx4 v11, s[20:23], s48 offen lds
ds_read_b64_tr_b16 a[176:177], v9 offset:0
ds_read_b64_tr_b16 a[178:179], v9 offset:512
ds_read_b64_tr_b16 a[180:181], v9 offset:2048
ds_read_b64_tr_b16 a[182:183], v9 offset:2560
ds_read_b64_tr_b16 v[208:209], v9 offset:8192
ds_read_b64_tr_b16 v[210:211], v9 offset:8704
ds_read_b64_tr_b16 v[212:213], v9 offset:10240
ds_read_b64_tr_b16 v[214:215], v9 offset:10752
ds_read_b64_tr_b16 v[216:217], v9 offset:16384
ds_read_b64_tr_b16 v[218:219], v9 offset:16896
ds_read_b64_tr_b16 v[220:221], v9 offset:18432
ds_read_b64_tr_b16 v[222:223], v9 offset:18944
v_xor_b32 v12, v15, v9
ds_read_b64_tr_b16 v[200:201], v12 offset:24576
ds_read_b64_tr_b16 v[202:203], v12 offset:25088
ds_read_b64_tr_b16 v[204:205], v12 offset:26624
ds_read_b64_tr_b16 v[206:207], v12 offset:27136
s_waitcnt lgkmcnt(0)
s_waitcnt vmcnt(36)
s_barrier
s_mov_b32 m0, 135168
s_add_u32 s48, s50, 144384
buffer_load_dwordx4 v11, s[20:23], s48 offen lds
s_mov_b32 m0, 136192
s_add_u32 s48, s50, 149504
buffer_load_dwordx4 v11, s[20:23], s48 offen lds
s_mov_b32 m0, 143360
s_add_u32 s48, s49, 1310720
buffer_load_dwordx4 v10, s[12:15], s48 offen lds
s_mov_b32 m0, 144384
s_add_u32 s48, s49, 1376256
buffer_load_dwordx4 v10, s[12:15], s48 offen lds
s_mov_b32 m0, 151552
s_add_u32 s48, s49, 3407872
buffer_load_dwordx4 v10, s[8:11], s48 offen lds
s_mov_b32 m0, 152576
s_add_u32 s48, s49, 3473408
buffer_load_dwordx4 v10, s[8:11], s48 offen lds
s_mov_b32 m0, 159744
s_add_u32 s48, s49, 3408000
buffer_load_dwordx4 v10, s[8:11], s48 offen lds
s_mov_b32 m0, 160768
s_add_u32 s48, s49, 3473536
buffer_load_dwordx4 v10, s[8:11], s48 offen lds
ds_read_b64_tr_b16 v[16:17], v7 offset:0
ds_read_b64_tr_b16 v[18:19], v7 offset:512
ds_read_b64_tr_b16 v[20:21], v7 offset:2048
ds_read_b64_tr_b16 v[22:23], v7 offset:2560
s_waitcnt lgkmcnt(0)
buffer_store_dwordx4 v[16:19], v0, s[4:7], s62 offen offset:2048
buffer_store_dwordx4 v[20:23], v0, s[4:7], s62 offen offset:3072
s_waitcnt vmcnt(32)
s_barrier
ds_read_b64_tr_b16 v[16:17], v4 offset:8192
ds_read_b64_tr_b16 v[18:19], v4 offset:9216
ds_read_b64_tr_b16 v[20:21], v4 offset:12288
ds_read_b64_tr_b16 v[22:23], v4 offset:13312
ds_read_b64_tr_b16 v[24:25], v4 offset:16384
ds_read_b64_tr_b16 v[26:27], v4 offset:17408
ds_read_b64_tr_b16 v[28:29], v4 offset:20480
ds_read_b64_tr_b16 v[30:31], v4 offset:21504
ds_read_b64_tr_b16 v[32:33], v4 offset:24576
ds_read_b64_tr_b16 v[34:35], v4 offset:25600
ds_read_b64_tr_b16 v[36:37], v4 offset:28672
ds_read_b64_tr_b16 v[38:39], v4 offset:29696
ds_read_b64_tr_b16 v[40:41], v4 offset:32768
ds_read_b64_tr_b16 v[42:43], v4 offset:33792
ds_read_b64_tr_b16 v[44:45], v4 offset:36864
ds_read_b64_tr_b16 v[46:47], v4 offset:37888
ds_read_b64_tr_b16 v[48:49], v4 offset:40960
ds_read_b64_tr_b16 v[50:51], v4 offset:41984
ds_read_b64_tr_b16 v[52:53], v4 offset:45056
ds_read_b64_tr_b16 v[54:55], v4 offset:46080
ds_read_b64_tr_b16 v[56:57], v4 offset:49152
ds_read_b64_tr_b16 v[58:59], v4 offset:50176
ds_read_b64_tr_b16 v[60:61], v4 offset:53248
ds_read_b64_tr_b16 v[62:63], v4 offset:54272
ds_read_b64_tr_b16 v[64:65], v4 offset:57344
ds_read_b64_tr_b16 v[66:67], v4 offset:58368
ds_read_b64_tr_b16 v[68:69], v4 offset:61440
ds_read_b64_tr_b16 v[70:71], v4 offset:62464
s_waitcnt lgkmcnt(0)
s_barrier
ds_write_b128 v0, v[16:19] offset:36864
ds_write_b128 v0, v[20:23] offset:37888
ds_write_b128 v0, v[24:27] offset:38912
ds_write_b128 v0, v[28:31] offset:39936
ds_write_b128 v0, v[32:35] offset:40960
ds_write_b128 v0, v[36:39] offset:41984
ds_write_b128 v0, v[40:43] offset:43008
ds_write_b128 v0, v[44:47] offset:44032
ds_write_b128 v0, a[136:139] offset:45056
ds_write_b128 v0, a[140:143] offset:46080
ds_write_b128 v0, a[152:155] offset:47104
ds_write_b128 v0, a[156:159] offset:48128
ds_write_b128 v0, v[64:67] offset:49152
ds_write_b128 v0, v[68:71] offset:50176
s_waitcnt lgkmcnt(0)
v_accvgpr_write_b32 a136, v48
v_accvgpr_write_b32 a137, v49
v_accvgpr_write_b32 a138, v50
v_accvgpr_write_b32 a139, v51
v_accvgpr_write_b32 a140, v52
v_accvgpr_write_b32 a141, v53
v_accvgpr_write_b32 a142, v54
v_accvgpr_write_b32 a143, v55
v_accvgpr_write_b32 a152, v56
v_accvgpr_write_b32 a153, v57
v_accvgpr_write_b32 a154, v58
v_accvgpr_write_b32 a155, v59
v_accvgpr_write_b32 a156, v60
v_accvgpr_write_b32 a157, v61
v_accvgpr_write_b32 a158, v62
v_accvgpr_write_b32 a159, v63
s_waitcnt vmcnt(8)
s_barrier
v_xor_b32 v12, v15, v8
ds_read_b64_tr_b16 v[16:17], v12 offset:24576
ds_read_b64_tr_b16 v[18:19], v12 offset:25088
ds_read_b64_tr_b16 v[20:21], v12 offset:26624
ds_read_b64_tr_b16 v[22:23], v12 offset:27136
ds_read_b64_tr_b16 v[24:25], v8 offset:32768
ds_read_b64_tr_b16 v[26:27], v8 offset:33280
ds_read_b64_tr_b16 v[28:29], v8 offset:34816
ds_read_b64_tr_b16 v[30:31], v8 offset:35328
ds_read_b64_tr_b16 v[32:33], v8 offset:40960
ds_read_b64_tr_b16 v[34:35], v8 offset:41472
ds_read_b64_tr_b16 v[36:37], v8 offset:43008
ds_read_b64_tr_b16 v[38:39], v8 offset:43520
ds_read_b64_tr_b16 v[40:41], v8 offset:49152
ds_read_b64_tr_b16 v[42:43], v8 offset:49664
ds_read_b64_tr_b16 v[44:45], v8 offset:51200
ds_read_b64_tr_b16 v[46:47], v8 offset:51712
v_xor_b32 v12, v15, v8
ds_read_b64_tr_b16 v[48:49], v12 offset:57344
ds_read_b64_tr_b16 v[50:51], v12 offset:57856
ds_read_b64_tr_b16 v[52:53], v12 offset:59392
ds_read_b64_tr_b16 v[54:55], v12 offset:59904
ds_read_b64_tr_b16 v[56:57], v9 offset:0
ds_read_b64_tr_b16 v[58:59], v9 offset:512
ds_read_b64_tr_b16 v[60:61], v9 offset:2048
ds_read_b64_tr_b16 v[62:63], v9 offset:2560
s_waitcnt lgkmcnt(0)
s_barrier
ds_write_b128 v2, v[224:227] offset:24576
ds_write_b128 v2, v[228:231] offset:25600
ds_write_b128 v2, v[24:27] offset:26624
ds_write_b128 v2, v[28:31] offset:27648
ds_write_b128 v2, v[32:35] offset:28672
ds_write_b128 v2, v[36:39] offset:29696
ds_write_b128 v2, v[248:251] offset:30720
ds_write_b128 v2, v[252:255] offset:31744
ds_write_b128 v2, v[240:243] offset:32768
ds_write_b128 v2, v[244:247] offset:33792
ds_write_b128 v2, v[56:59] offset:34816
ds_write_b128 v2, v[60:63] offset:35840
s_waitcnt lgkmcnt(0)
v_mov_b32 v224, v16
v_mov_b32 v225, v17
v_mov_b32 v226, v18
v_mov_b32 v227, v19
v_mov_b32 v228, v20
v_mov_b32 v229, v21
v_mov_b32 v230, v22
v_mov_b32 v231, v23
v_mov_b32 v248, v40
v_mov_b32 v249, v41
v_mov_b32 v250, v42
v_mov_b32 v251, v43
v_mov_b32 v252, v44
v_mov_b32 v253, v45
v_mov_b32 v254, v46
v_mov_b32 v255, v47
v_mov_b32 v240, v48
v_mov_b32 v241, v49
v_mov_b32 v242, v50
v_mov_b32 v243, v51
v_mov_b32 v244, v52
v_mov_b32 v245, v53
v_mov_b32 v246, v54
v_mov_b32 v247, v55
s_waitcnt vmcnt(2)
s_barrier
ds_read_b64_tr_b16 v[16:17], v5 offset:0
ds_read_b64_tr_b16 v[18:19], v5 offset:1024
ds_read_b64_tr_b16 v[20:21], v5 offset:4096
ds_read_b64_tr_b16 v[22:23], v5 offset:5120
ds_read_b64_tr_b16 v[24:25], v8 offset:8192
ds_read_b64_tr_b16 v[26:27], v8 offset:8704
ds_read_b64_tr_b16 v[28:29], v8 offset:10240
ds_read_b64_tr_b16 v[30:31], v8 offset:10752
ds_read_b64_tr_b16 v[32:33], v8 offset:16384
ds_read_b64_tr_b16 v[34:35], v8 offset:16896
ds_read_b64_tr_b16 v[36:37], v8 offset:18432
ds_read_b64_tr_b16 v[38:39], v8 offset:18944
ds_read_b64_tr_b16 v[40:41], v6 offset:8192
ds_read_b64_tr_b16 v[42:43], v6 offset:9216
ds_read_b64_tr_b16 v[44:45], v6 offset:12288
ds_read_b64_tr_b16 v[46:47], v6 offset:13312
ds_read_b64_tr_b16 v[48:49], v6 offset:16384
ds_read_b64_tr_b16 v[50:51], v6 offset:17408
ds_read_b64_tr_b16 v[52:53], v6 offset:20480
ds_read_b64_tr_b16 v[54:55], v6 offset:21504
ds_read_b64_tr_b16 v[56:57], v6 offset:24576
ds_read_b64_tr_b16 v[58:59], v6 offset:25600
ds_read_b64_tr_b16 v[60:61], v6 offset:28672
ds_read_b64_tr_b16 v[62:63], v6 offset:29696
s_waitcnt lgkmcnt(0)
s_barrier
ds_write_b128 v2, v[16:19] offset:0
ds_write_b128 v2, v[20:23] offset:1024
ds_write_b128 v2, v[24:27] offset:2048
ds_write_b128 v2, v[28:31] offset:3072
ds_write_b128 v2, v[232:235] offset:4096
ds_write_b128 v2, v[236:239] offset:5120
ds_write_b128 v2, v[104:107] offset:6144
ds_write_b128 v2, v[108:111] offset:7168
ds_write_b128 v2, a[168:171] offset:8192
ds_write_b128 v2, a[172:175] offset:9216
ds_write_b128 v2, a[176:179] offset:10240
ds_write_b128 v2, a[180:183] offset:11264
s_waitcnt lgkmcnt(0)
v_mov_b32 v232, v32
v_mov_b32 v233, v33
v_mov_b32 v234, v34
v_mov_b32 v235, v35
v_mov_b32 v236, v36
v_mov_b32 v237, v37
v_mov_b32 v238, v38
v_mov_b32 v239, v39
v_mov_b32 v104, v40
v_mov_b32 v105, v41
v_mov_b32 v106, v42
v_mov_b32 v107, v43
v_mov_b32 v108, v44
v_mov_b32 v109, v45
v_mov_b32 v110, v46
v_mov_b32 v111, v47
v_accvgpr_write_b32 a168, v48
v_accvgpr_write_b32 a169, v49
v_accvgpr_write_b32 a170, v50
v_accvgpr_write_b32 a171, v51
v_accvgpr_write_b32 a172, v52
v_accvgpr_write_b32 a173, v53
v_accvgpr_write_b32 a174, v54
v_accvgpr_write_b32 a175, v55
v_accvgpr_write_b32 a176, v56
v_accvgpr_write_b32 a177, v57
v_accvgpr_write_b32 a178, v58
v_accvgpr_write_b32 a179, v59
v_accvgpr_write_b32 a180, v60
v_accvgpr_write_b32 a181, v61
v_accvgpr_write_b32 a182, v62
v_accvgpr_write_b32 a183, v63
s_mov_b32 s90, 0x300003
s_mov_b32 s91, 0x300003
s_mov_b32 s12, 0x3030303
s_mov_b32 s13, 0x3030303
s_mov_b32 s92, 0xc0000c
s_mov_b32 s93, 0xc0000c
s_mov_b32 s14, 0xc0c0c0c
s_mov_b32 s15, 0xc0c0c0c
s_mov_b32 s94, 0x30000300
s_mov_b32 s95, 0x30000300
s_mov_b32 s16, 0x30303030
s_mov_b32 s17, 0x30303030
s_mov_b32 s96, 0xc0000c00
s_mov_b32 s97, 0xc0000c00
s_mov_b32 s18, 0xc0c0c0c0
s_mov_b32 s19, 0xc0c0c0c0
s_mov_b32 s98, 0xff00ff00
s_mov_b32 s99, 0xff00ff00
v_mov_b32 v1, 0x4444
v_mov_b32 v4, 0xeeee
v_cndmask_b32 v1, v1, v4, s[98:99]
v_lshrrev_b32 v4, 8, v0
v_lshl_or_b32 v1, v4, 28, v1
v_bfe_u32 v4, v0, 4, 4
v_lshl_or_b32 v1, v4, 19, v1
s_mov_b32 s51, 0x3e0293ee
s_mov_b32 s52, 0x3f803f80
s_mov_b32 s53, 0x3f803f80
s_mov_b32 s54, 0x3f003f00
s_mov_b32 s55, 0x3f003f00
s_mov_b32 s56, 0xff800000
s_mov_b32 s57, 0xff800000
s_mov_b32 s58, 0x3f80
s_mov_b32 s8, s4
s_mov_b32 s9, s5
s_cmp_lt_u32 s30, 10
s_cselect_b32 s10, s6, 0
s_mov_b32 s31, 0
s_mov_b32 s45, -2
s_lshl_b32 s46, s30, 6
s_add_u32 s46, s46, 222330880
s_mul_i32 s48, s30, 16
s_add_u32 s48, s48, 120389632
s_add_u32 s20, s4, s48
s_addc_u32 s21, s5, 0
s_mov_b32 s22, 16
s_lshl_b32 s48, s30, 7
s_and_b32 s49, s30, 31
s_lshl_b32 s49, s49, 12
s_add_u32 s43, s49, 119734272
v_mov_b64 v[12:13], -1
s_add_u32 s38, s48, 119570432
s_add_u32 s39, s48, 119635968
s_add_u32 s40, s48, 119701504
s_add_u32 s41, s48, 119767040
s_add_u32 s42, s48, 119832576
v_lshrrev_b32 v4, 16, v1
buffer_store_dwordx2 v[12:13], v4, s[4:7], s38 offen
buffer_store_dwordx2 v[12:13], v4, s[4:7], s39 offen
buffer_store_dwordx2 v[12:13], v4, s[4:7], s40 offen
buffer_store_dwordx2 v[12:13], v4, s[4:7], s41 offen
buffer_store_dwordx2 v[12:13], v4, s[4:7], s42 offen
buffer_store_dword v12, v0, s[20:23], 0 offen
s_cmp_lg_u32 s3, 0
s_cbranch_scc1 k_wdd_155
v_mov_b32 v8, 192
k_wd_154:
global_load_dword v9, v8, s[28:29] sc1
s_waitcnt vmcnt(0)
v_readfirstlane_b32 s48, v9
s_cmp_ge_u32 s48, 32
s_cbranch_scc1 k_wdd_155
s_sleep 2
s_sub_u32 s32, s32, 1
s_cmp_gt_i32 s32, 0
s_cbranch_scc1 k_wd_154
k_wdd_155:
s_barrier
k_lay_156:
s_add_u32 s47, s31, 63
s_mov_b32 s33, 120324096
s_mov_b32 s34, 120328192
s_mov_b32 s35, 120332288
s_mul_i32 s48, s31, 655360
s_lshl_b32 s36, s30, 14
s_add_u32 s36, s36, s48
s_add_u32 s36, s36, 8192
s_waitcnt vmcnt(1)
v_mov_b32 v12, -1
s_and_b32 s48, s30, 31
s_add_u32 s48, s48, 48
s_lshr_b32 s49, s48, 1
s_and_b32 s48, s48, 1
s_lshl_b32 s44, s49, 8
s_lshl_b32 s50, s48, 6
s_add_u32 s44, s44, s50
s_add_u32 s44, s44, s33
s_mul_i32 s48, s48, 5120
s_lshl_b32 s49, s49, 5
s_add_u32 s48, s48, s49
v_lshrrev_b32 v8, 4, v0
v_and_b32 v9, 3, v8
v_mul_u32_u24 v9, 1280, v9
v_bfe_u32 v10, v8, 2, 1
v_lshl_add_u32 v9, v10, 1, v9
v_bfe_u32 v10, v8, 4, 1
v_lshl_add_u32 v9, v10, 4, v9
v_bfe_u32 v10, v8, 5, 1
v_lshl_add_u32 v9, v10, 2, v9
buffer_load_ushort v10, v9, s[24:27], s48 offen
buffer_load_ushort v11, v9, s[24:27], s48 offen offset:8
v_and_b32 v45, 0x30, v0
v_lshrrev_b32 v46, 8, v0
v_lshl_or_b32 v45, v46, 2, v45
v_bfe_u32 v46, v0, 6, 1
v_lshl_or_b32 v45, v46, 7, v45
v_cndmask_b32 v45, v45, 2.0, s[98:99]
s_waitcnt vmcnt(0)
v_lshl_or_b32 v10, v11, 16, v10
s_waitcnt vmcnt(0)
s_barrier
s_barrier
buffer_store_dword v10, v45, s[4:7], s44 offen
s_add_u32 s44, s44, 16384
buffer_store_dword v12, v45, s[4:7], s44 offen
s_waitcnt vmcnt(0)
s_barrier
s_barrier
v_lshlrev_b32 v3, v0, s58
v_cndmask_b32 v20, 0, v3, s[90:91]
v_cndmask_b32 v21, 0, v3, s[92:93]
v_cndmask_b32 v22, 0, v3, s[94:95]
v_cndmask_b32 v23, 0, v3, s[96:97]
k_fl2_167:
buffer_load_dwordx2 v[46:47], off, s[4:7], s46 sc1
s_waitcnt vmcnt(0)
v_min_u32 v46, v46, v47
v_cmp_lt_u32 vcc, s31, v46
v_mov_b64 v[46:47], 0
s_cbranch_vccnz k_cold2_159
s_sub_u32 s32, s32, 1
s_cmp_gt_i32 s32, 0
s_cbranch_scc1 k_fl2_167
s_branch k_cold2_159
k_T0_157:
s_waitcnt vmcnt(3)
s_waitcnt lgkmcnt(0)
v_smfmac_f32_16x16x64_bf16 v[28:31], v[4:7], v[56:63], v1
ds_read_b128 v[56:59], v0 offset:40960
v_smfmac_f32_16x16x64_bf16 v[32:35], v[4:7], v[64:71], v1
ds_read_b128 v[60:63], v0 offset:41984
v_smfmac_f32_16x16x64_bf16 v[40:43], v[4:7], a[8:15], v1
ds_read_b128 v[64:67], v0 offset:43008
v_smfmac_f32_16x16x64_bf16 v[44:47], v[4:7], a[16:23], v1
ds_read_b128 v[68:71], v0 offset:44032
s_waitcnt vmcnt(2)
v_smfmac_f32_16x16x64_bf16 v[24:27], v[8:11], a[24:31], v1
s_waitcnt lgkmcnt(2)
v_smfmac_f32_16x16x64_bf16 v[28:31], v[8:11], v[56:63], v1
buffer_load_dwordx4 v[56:59], v0, s[4:7], s60 offen offset:2048
v_smfmac_f32_16x16x64_bf16 v[24:27], v[4:7], v[48:55], v1
s_waitcnt lgkmcnt(0)
v_smfmac_f32_16x16x64_bf16 v[32:35], v[8:11], v[64:71], v1
ds_read_b128 v[64:67], v0 offset:49152
s_waitcnt vmcnt(2)
v_smfmac_f32_16x16x64_bf16 v[36:39], v[8:11], a[32:39], v1
ds_read_b128 v[68:71], v0 offset:50176
buffer_load_dwordx4 v[60:63], v0, s[4:7], s60 offen offset:3072
v_smfmac_f32_16x16x64_bf16 v[36:39], v[12:15], a[72:79], v1
ds_write_b128 v0, v[12:15] offset:2048
v_smfmac_f32_16x16x64_bf16 v[36:39], v[4:7], a[0:7], v1
v_smfmac_f32_16x16x64_bf16 v[24:27], v[12:15], a[56:63], v1
buffer_load_dwordx4 v[48:51], v0, s[4:7], s36 offen offset:0 sc1
s_waitcnt vmcnt(3)
v_smfmac_f32_16x16x64_bf16 v[24:27], v[16:19], a[80:87], v1
s_waitcnt lgkmcnt(1)
ds_write_b128 v0, v[16:19] offset:6144
v_smfmac_f32_16x16x64_bf16 v[28:31], v[12:15], v[64:71], v1
ds_read_b128 v[64:67], v0 offset:47104
v_fma_f32 v3, v24, v25, v26
v_smfmac_f32_16x16x64_bf16 v[40:43], v[8:11], a[40:47], v1
buffer_load_dwordx4 v[52:55], v0, s[4:7], s36 offen offset:1024 sc1
v_cmp_u_f32 vcc, v3, v27
v_smfmac_f32_16x16x64_bf16 v[44:47], v[16:19], a[112:119], v1
ds_read_b128 v[68:71], v0 offset:48128
v_smfmac_f32_16x16x64_bf16 v[44:47], v[8:11], a[48:55], v1
s_cbranch_vccnz k_cold_158
k_okC_160:
v_smfmac_f32_16x16x64_bf16 v[36:39], v[16:19], a[96:103], v1
s_waitcnt lgkmcnt(2)
s_barrier
ds_read_b128 v[8:11], v0 offset:0
v_smfmac_f32_16x16x64_bf16 v[28:31], v[16:19], a[88:95], v1
ds_read_b128 v[4:7], v0 offset:3072
s_waitcnt lgkmcnt(2)
v_smfmac_f32_16x16x64_bf16 v[32:35], v[16:19], v[64:71], v1
ds_read_b128 v[64:67], v2 offset:0
ds_read_b128 v[68:71], v2 offset:1024
v_smfmac_f32_16x16x64_bf16 v[40:43], v[16:19], a[104:111], v1
v_smfmac_f32_16x16x64_bf16 v[32:35], v[12:15], a[64:71], v1
ds_read_b128 v[16:19], v0 offset:7168
s_waitcnt lgkmcnt(4)
v_smfmac_f32_16x16x64_bf16 v[28:31], v[8:11], a[136:143], v1
ds_read_b128 v[12:15], v0 offset:1024
v_smfmac_f32_16x16x64_bf16 v[24:27], v[8:11], a[128:135], v1
ds_read_b128 v[8:11], v0 offset:5120
s_waitcnt lgkmcnt(3)
v_smfmac_f32_16x16x64_bf16 v[28:31], v[4:7], v[64:71], v1
ds_read_b128 v[64:67], v2 offset:4096
s_waitcnt lgkmcnt(3)
v_smfmac_f32_16x16x64_bf16 v[24:27], v[4:7], a[120:127], v1
ds_read_b128 v[68:71], v2 offset:5120
s_waitcnt lgkmcnt(3)
v_smfmac_f32_16x16x64_bf16 v[28:31], v[12:15], a[152:159], v1
ds_read_b128 v[4:7], v0 offset:4096
s_waitcnt vmcnt(2)
v_smfmac_f32_16x16x64_bf16 v[32:35], v[16:19], v[56:63], v1
buffer_load_dwordx4 v[56:59], v0, s[4:7], s36 offen offset:2048 sc1
v_and_b32 v3, 0xffffff7f, v0
v_smfmac_f32_16x16x64_bf16 v[44:47], v[16:19], a[208:215], v1
s_waitcnt lgkmcnt(1)
v_smfmac_f32_16x16x64_bf16 v[24:27], v[16:19], v[64:71], v1
ds_read_b128 v[64:67], v2 offset:24576
v_smfmac_f32_16x16x64_bf16 v[24:27], v[12:15], a[144:151], v1
s_waitcnt lgkmcnt(1)
ds_read_b128 v[68:71], v2 offset:25600
buffer_load_dwordx4 v[60:63], v0, s[4:7], s36 offen offset:3072 sc1
v_smfmac_f32_16x16x64_bf16 v[24:27], v[4:7], a[168:175], v1
s_barrier
v_smfmac_f32_16x16x64_bf16 v[24:27], v[8:11], a[184:191], v1
v_smfmac_f32_16x16x64_bf16 v[28:31], v[16:19], a[160:167], v1
s_waitcnt lgkmcnt(0)
v_smfmac_f32_16x16x64_bf16 v[28:31], v[8:11], v[64:71], v1
ds_read_b128 v[64:67], v2 offset:30720
v_cvt_pk_bf16_f32 v24, v24, v25
v_smfmac_f32_16x16x64_bf16 v[28:31], v[4:7], a[176:183], v1
ds_read_b128 v[68:71], v2 offset:31744
v_cvt_pk_bf16_f32 v25, v26, v27
v_smfmac_f32_16x16x64_bf16 v[36:39], v[16:19], a[192:199], v1
v_smfmac_f32_16x16x64_bf16 v[40:43], v[16:19], a[200:207], v1
v_cvt_pk_bf16_f32 v27, v30, v31
v_smfmac_f32_16x16x64_bf16 v[40:43], v[4:7], a[224:231], v1
ds_read_b128 v[16:19], v0 offset:3072
s_waitcnt lgkmcnt(1)
v_smfmac_f32_16x16x64_bf16 v[32:35], v[4:7], v[64:71], v1
ds_read_b128 v[64:67], v2 offset:32768
v_cvt_pk_bf16_f32 v26, v28, v29
v_smfmac_f32_16x16x64_bf16 v[44:47], v[4:7], a[232:239], v1
ds_read_b128 v[68:71], v2 offset:33792
v_and_or_b32 v3, v1, 8, v3
v_mfma_f32_16x16x32_bf16 v[28:31], v[24:27], v[20:23], 0
v_smfmac_f32_16x16x64_bf16 v[36:39], v[4:7], a[216:223], v1
ds_read_b128 v[4:7], v0 offset:0
v_smfmac_f32_16x16x64_bf16 v[40:43], v[8:11], a[248:255], v1
s_waitcnt lgkmcnt(1)
v_mul_f32 v28, s51, v28
v_smfmac_f32_16x16x64_bf16 v[36:39], v[8:11], v[64:71], v1
ds_read_b128 v[64:67], v2 offset:6144
v_mul_f32 v31, s51, v31
v_mul_f32 v29, s51, v29
v_smfmac_f32_16x16x64_bf16 v[32:35], v[8:11], a[240:247], v1
ds_read_b128 v[68:71], v2 offset:7168
v_mul_f32 v30, s51, v30
v_smfmac_f32_16x16x64_bf16 v[44:47], v[8:11], v[72:79], v1
ds_read_b128 v[8:11], v0 offset:2048
v_cvt_pk_bf16_f32 v24, v28, v29
v_cvt_pk_bf16_f32 v25, v30, v31
v_smfmac_f32_16x16x64_bf16 v[32:35], v[12:15], v[80:87], v1
ds_write_b64 v3, v[24:25] offset:5120
s_waitcnt lgkmcnt(2)
v_smfmac_f32_16x16x64_bf16 v[32:35], v[16:19], v[64:71], v1
ds_read_b128 v[64:67], v2 offset:8192
s_waitcnt lgkmcnt(2)
v_smfmac_f32_16x16x64_bf16 v[32:35], v[4:7], v[104:111], v1
ds_read_b128 v[68:71], v2 offset:9216
v_smfmac_f32_16x16x64_bf16 v[36:39], v[16:19], v[96:103], v1
s_waitcnt lgkmcnt(2)
s_barrier
ds_read_b128 v[24:27], v0 offset:4096
v_smfmac_f32_16x16x64_bf16 v[36:39], v[12:15], v[88:95], v1
ds_read_b128 v[28:31], v0 offset:5120
v_cvt_pk_bf16_f32 v32, v32, v33
v_smfmac_f32_16x16x64_bf16 v[36:39], v[4:7], v[112:119], v1
s_waitcnt lgkmcnt(2)
v_smfmac_f32_16x16x64_bf16 v[44:47], v[16:19], v[64:71], v1
buffer_load_dwordx4 v[64:67], v0, s[4:7], s61 offen offset:0
s_waitcnt vmcnt(3)
s_waitcnt lgkmcnt(1)
v_mfma_f32_16x16x32_bf16 v[48:51], v[48:51], v[24:27], 0
v_cvt_pk_bf16_f32 v33, v34, v35
s_waitcnt lgkmcnt(0)
v_mfma_f32_16x16x32_bf16 v[48:51], v[52:55], v[28:31], v[48:51]
v_cvt_pk_bf16_f32 v35, v38, v39
v_cvt_pk_bf16_f32 v34, v36, v37
v_mov_b64 v[52:53], s[56:57]
s_nop 0
v_mfma_f32_16x16x32_bf16 v[36:39], v[32:35], v[20:23], 0
buffer_load_dwordx4 v[68:71], v0, s[4:7], s61 offen offset:1024
v_permlane32_swap_b32 v49, v51
v_permlane32_swap_b32 v48, v50
v_add_f32_dpp v53, v51, v49 row_ror:8 row_mask:0xf bank_mask:0x3
v_exp_f32 v53, v53
v_add_f32_dpp v52, v50, v48 row_ror:8 row_mask:0xf bank_mask:0x3
v_exp_f32 v52, v52
v_cvt_pk_bf16_f32 v32, v36, v37
v_cvt_pk_bf16_f32 v33, v38, v39
v_smfmac_f32_16x16x64_bf16 v[40:43], v[16:19], v[120:127], v1
ds_write_b64 v3, v[32:33] offset:7168
v_cvt_pk_bf16_f32 v48, v52, v53
v_smfmac_f32_16x16x64_bf16 v[40:43], v[8:11], v[160:167], v1
ds_write_b32 v0, v48 offset:8
v_smfmac_f32_16x16x64_bf16 v[44:47], v[4:7], v[152:159], v1
buffer_load_dwordx4 v[48:51], v0, s[4:7], s61 offen offset:2048
v_mov_b64 v[20:21], s[52:53]
v_smfmac_f32_16x16x64_bf16 v[40:43], v[12:15], v[128:135], v1
s_waitcnt lgkmcnt(1)
v_mov_b64 v[22:23], s[52:53]
v_smfmac_f32_16x16x64_bf16 v[40:43], v[4:7], v[144:151], v1
s_waitcnt lgkmcnt(0)
s_barrier
ds_read_b128 v[32:35], v0 offset:6144
v_smfmac_f32_16x16x64_bf16 v[44:47], v[12:15], v[136:143], v1
ds_read_b128 v[36:39], v0 offset:7168
ds_read_b128 v[16:19], v0 offset:0
buffer_load_dwordx4 v[52:55], v0, s[4:7], s61 offen offset:3072
v_xor_b32 v12, 0x80, v0
v_cvt_pk_bf16_f32 v40, v40, v41
v_cvt_pk_bf16_f32 v41, v42, v43
v_smfmac_f32_16x16x64_bf16 v[44:47], v[8:11], v[168:175], v1
ds_read_b128 v[12:15], v12 offset:0
s_waitcnt lgkmcnt(3)
v_mfma_f32_16x16x32_bf16 v[24:27], v[32:35], v[24:27], 0
s_waitcnt lgkmcnt(2)
v_mfma_f32_16x16x32_bf16 v[24:27], v[36:39], v[28:31], v[24:27]
v_cvt_pk_bf16_f32 v42, v44, v45
s_waitcnt lgkmcnt(1)
s_waitcnt vmcnt(4)
v_mfma_f32_16x16x32_bf16 v[8:11], v[56:59], v[16:19], 0
buffer_load_dwordx4 v[56:59], v0, s[4:7], s62 offen offset:0
v_mov_b64 v[28:29], s[56:57]
v_permlane32_swap_b32 v24, v26
v_permlane32_swap_b32 v25, v27
v_add_f32_dpp v28, v26, v24 row_ror:8 row_mask:0xf bank_mask:0x3
v_mfma_f32_16x16x32_bf16 v[4:7], v[20:23], v[16:19], 0
s_waitcnt lgkmcnt(0)
v_add_f32_dpp v29, v27, v25 row_ror:8 row_mask:0xf bank_mask:0x3
v_exp_f32 v29, v29
v_mov_b64 v[44:45], s[54:55]
v_exp_f32 v28, v28
v_mfma_f32_16x16x32_bf16 v[8:11], v[60:63], v[12:15], v[8:11]
buffer_load_dwordx4 v[60:63], v0, s[4:7], s62 offen offset:1024
v_cvt_pk_bf16_f32 v24, v28, v29
v_cvt_pk_bf16_f32 v43, v46, v47
v_cvt_pk_bf16_f32 v25, v28, v29
v_permlane32_swap_b32 v40, v41
v_mov_b32_dpp v26, v24 row_ror:8 row_mask:0xf bank_mask:0xf
v_mfma_f32_16x16x16_bf16 v[4:7], v[44:45], v[24:25], v[4:7]
v_mov_b32_dpp v27, v24 row_ror:8 row_mask:0xf bank_mask:0xf
v_permlane32_swap_b32 v42, v43
v_mov_b64 v[28:29], 0
v_mov_b64 v[34:35], 0
v_mfma_f32_16x16x32_bf16 v[8:11], v[40:43], v[24:27], v[8:11]
v_mov_b32 v12, s45
buffer_load_dwordx4 v[16:19], v0, s[4:7], s62 offen offset:2048
v_rcp_f32 v6, v4
v_mov_b64 v[32:33], 0
s_nop 0
v_rcp_f32_dpp v6, v4 row_ror:8 row_mask:0xf bank_mask:0xc
v_mov_b64 v[26:27], 0
v_pk_mul_f32 v[8:9], v[8:9], v[6:7] op_sel_hi:[1,0]
v_pk_mul_f32 v[10:11], v[10:11], v[6:7] op_sel_hi:[1,0]
v_add_u32 v6, 0xd4800000, v6
v_mov_b64 v[24:25], 0
v_cvt_pk_bf16_f32 v45, v10, v11
v_cvt_pk_bf16_f32 v44, v8, v9
s_waitcnt vmcnt(5)
buffer_load_dwordx4 v[20:23], v0, s[4:7], s62 offen offset:3072
ds_write_b64 v3, v[44:45] offset:3072
v_cmp_lt_u32 vcc, 0x28000000, v6
v_mov_b32_dpp v46, v44 row_ror:8 row_mask:0xf bank_mask:0xf
v_and_b32 v3, -9, v3
v_mov_b32_dpp v47, v45 row_ror:8 row_mask:0xf bank_mask:0xf
v_mov_b64 v[30:31], 0
s_cbranch_vccnz k_slow_161
k_okS_162:
v_mov_b64 v[38:39], 0
v_mov_b64 v[36:37], 0
v_smfmac_f32_16x16x64_bf16 v[32:35], v[44:47], v[200:207], v1
s_waitcnt lgkmcnt(0)
s_barrier
buffer_store_dword v12, v0, s[20:23], 0 offen
ds_read_b128 v[12:15], v3 offset:2176
v_mov_b64 v[40:41], 0
v_smfmac_f32_16x16x64_bf16 v[36:39], v[44:47], v[224:231], v1
s_waitcnt vmcnt(5)
ds_read_b128 v[4:7], v3 offset:3200
ds_read_b128 v[8:11], v3 offset:2048
v_smfmac_f32_16x16x64_bf16 v[28:31], v[44:47], v[48:55], v1
v_mov_b64 v[42:43], 0
v_smfmac_f32_16x16x64_bf16 v[24:27], v[44:47], v[64:71], v1
ds_read_b128 v[64:67], v2 offset:10240
ds_read_b128 v[68:71], v2 offset:11264
v_smfmac_f32_16x16x64_bf16 v[40:43], v[44:47], v[240:247], v1
s_waitcnt lgkmcnt(4)
ds_read_b128 v[48:51], v0 offset:45056
v_smfmac_f32_16x16x64_bf16 v[24:27], v[12:15], v[192:199], v1
s_waitcnt lgkmcnt(3)
v_smfmac_f32_16x16x64_bf16 v[24:27], v[4:7], v[176:183], v1
ds_read_b128 v[52:55], v0 offset:46080
v_smfmac_f32_16x16x64_bf16 v[24:27], v[8:11], v[184:191], v1
v_smfmac_f32_16x16x64_bf16 v[36:39], v[12:15], v[232:239], v1
s_waitcnt lgkmcnt(2)
s_waitcnt vmcnt(3)
v_lshrrev_b32 v44, 16, v1
v_cvt_pk_bf16_f32 v24, v24, v25
v_bfi_b32 v24, 1, s45, v24
v_smfmac_f32_16x16x64_bf16 v[28:31], v[12:15], v[56:63], v1
ds_read_b128 v[56:59], v2 offset:34816
v_cvt_pk_bf16_f32 v25, v26, v27
v_smfmac_f32_16x16x64_bf16 v[28:31], v[4:7], v[64:71], v1
s_waitcnt lgkmcnt(1)
buffer_store_dwordx2 v[24:25], v44, s[4:7], s38 offen
ds_read_b128 v[64:67], v2 offset:26624
v_smfmac_f32_16x16x64_bf16 v[28:31], v[8:11], v[48:55], v1
ds_read_b128 v[68:71], v2 offset:27648
ds_read_b128 v[48:51], v2 offset:2048
ds_read_b128 v[52:55], v2 offset:3072
v_smfmac_f32_16x16x64_bf16 v[32:35], v[12:15], v[216:223], v1
v_cvt_pk_bf16_f32 v28, v28, v29
v_cvt_pk_bf16_f32 v29, v30, v31
v_bfi_b32 v28, 1, s45, v28
v_smfmac_f32_16x16x64_bf16 v[32:35], v[8:11], v[208:215], v1
buffer_store_dwordx2 v[28:29], v44, s[4:7], s39 offen
ds_read_b128 v[60:63], v2 offset:35840
s_waitcnt vmcnt(3)
v_smfmac_f32_16x16x64_bf16 v[32:35], v[4:7], v[16:23], v1
s_waitcnt lgkmcnt(3)
ds_read_b128 v[16:19], v2 offset:28672
v_smfmac_f32_16x16x64_bf16 v[36:39], v[4:7], v[64:71], v1
ds_read_b128 v[20:23], v2 offset:29696
s_waitcnt lgkmcnt(3)
v_cvt_pk_bf16_f32 v32, v32, v33
v_cvt_pk_bf16_f32 v33, v34, v35
v_bfi_b32 v32, 1, s45, v32
v_smfmac_f32_16x16x64_bf16 v[36:39], v[8:11], v[48:55], v1
s_waitcnt lgkmcnt(2)
buffer_store_dwordx2 v[32:33], v44, s[4:7], s40 offen
v_smfmac_f32_16x16x64_bf16 v[40:43], v[12:15], v[248:255], v1
s_nop 2
v_cvt_pk_bf16_f32 v36, v36, v37
v_cvt_pk_bf16_f32 v37, v38, v39
v_bfi_b32 v36, 1, s45, v36
s_waitcnt lgkmcnt(0)
v_smfmac_f32_16x16x64_bf16 v[40:43], v[8:11], v[16:23], v1
buffer_store_dwordx2 v[36:37], v44, s[4:7], s41 offen
v_smfmac_f32_16x16x64_bf16 v[40:43], v[4:7], v[56:63], v1
s_nop 6
v_cvt_pk_bf16_f32 v40, v40, v41
v_cvt_pk_bf16_f32 v41, v42, v43
v_bfi_b32 v40, 1, s45, v40
buffer_store_dwordx2 v[40:41], v44, s[4:7], s42 offen
v_lshlrev_b32 v3, v0, s58
v_cndmask_b32 v16, 0, v3, s[12:13]
v_cndmask_b32 v17, 0, v3, s[14:15]
v_cndmask_b32 v18, 0, v3, s[16:17]
v_cndmask_b32 v19, 0, v3, s[18:19]
s_barrier
v_and_b32 v45, 0x30, v0
v_lshrrev_b32 v46, 8, v0
v_lshl_or_b32 v45, v46, 2, v45
v_bfe_u32 v46, v0, 6, 1
v_lshl_or_b32 v45, v46, 7, v45
v_cndmask_b32 v45, v45, 2.0, s[98:99]
v_cndmask_b32 v20, 0, v3, s[90:91]
v_cndmask_b32 v21, 0, v3, s[92:93]
v_cndmask_b32 v22, 0, v3, s[94:95]
v_cndmask_b32 v23, 0, v3, s[96:97]
s_add_u32 s33, s33, 16384
s_bitset0_b32 s33, 16
buffer_load_dwordx4 v[24:27], v0, s[4:7], s43 offen offset:0 sc1
buffer_load_dwordx4 v[28:31], v0, s[4:7], s43 offen offset:1024 sc1
buffer_load_dwordx4 v[32:35], v0, s[4:7], s43 offen offset:2048 sc1
buffer_load_dwordx4 v[36:39], v0, s[4:7], s43 offen offset:3072 sc1
s_add_u32 s34, s33, 4096
s_add_u32 s35, s33, 8192
s_add_u32 s36, s36, 524288
s_add_u32 s31, s31, 1
s_buffer_load_dwordx2 s[66:67], s[4:7], s46 glc
ds_read_b128 v[56:59], v0 offset:36864
ds_read_b128 v[60:63], v0 offset:37888
ds_read_b128 v[64:67], v0 offset:38912
ds_read_b128 v[68:71], v0 offset:39936
buffer_load_dwordx4 v[48:51], v0, s[4:7], s60 offen offset:0
buffer_load_dwordx4 v[52:55], v0, s[4:7], s60 offen offset:1024
s_waitcnt vmcnt(5)
v_mfma_f32_16x16x32_bf16 v[40:43], v[24:27], v[16:19], 0
s_waitcnt vmcnt(4)
v_mfma_f32_16x16x32_bf16 v[40:43], v[28:31], v[16:19], v[40:43]
v_bitop3_b32 v46, v24, v28, s45 bitop3:0x7e
s_waitcnt vmcnt(3)
v_mfma_f32_16x16x32_bf16 v[40:43], v[32:35], v[16:19], v[40:43]
s_waitcnt vmcnt(2)
v_mfma_f32_16x16x32_bf16 v[40:43], v[36:39], v[16:19], v[40:43]
v_bitop3_b32 v47, v32, v36, s45 bitop3:0x7e
v_bitop3_b32 v46, v46, v47, 1 bitop3:0xa8
v_cmp_ne_u32 vcc, 0, v46
v_mov_b64 v[24:25], 0
v_mov_b64 v[26:27], 0
v_mov_b64 v[28:29], 0
v_mov_b64 v[30:31], 0
v_permlane32_swap_b32 v40, v41
v_permlane32_swap_b32 v42, v43
v_add_f32 v40, v40, v41
v_add_f32 v41, v42, v43
v_cvt_pk_bf16_f32 v42, v40, v41
s_cbranch_vccnz k_r1_164
k_ok1_165:
buffer_store_dword v42, v45, s[4:7], s44 offen
s_barrier
v_mov_b64 v[32:33], 0
v_mov_b64 v[34:35], 0
v_mov_b64 v[36:37], 0
v_mov_b64 v[38:39], 0
v_mov_b64 v[40:41], 0
v_mov_b64 v[42:43], 0
v_mov_b64 v[44:45], 0
v_mov_b64 v[46:47], 0
buffer_load_dwordx4 v[4:7], v0, s[4:7], s33 offen offset:0 sc1
buffer_load_dwordx4 v[8:11], v0, s[4:7], s33 offen offset:1024 sc1
s_add_u32 s44, s44, 16384
s_bitset0_b32 s44, 16
s_sub_u32 s45, s45, 1
s_waitcnt lgkmcnt(0)
buffer_load_dwordx4 v[12:15], v0, s[4:7], s34 offen offset:0 sc1
s_min_u32 s66, s66, s67
s_cmp_gt_u32 s66, s31
s_cbranch_scc0 k_fl_166
k_okF_168:
buffer_load_dwordx4 v[16:19], v0, s[4:7], s35 offen offset:0 sc1
s_barrier
s_cmp_lg_u32 s31, s47
s_cbranch_scc1 k_T0_157
s_branch k_done_163
k_cold_158:
s_sub_u32 s32, s32, 1
s_cmp_gt_i32 s32, 0
s_cbranch_scc0 k_okC_160
k_cold2_159:
s_waitcnt lgkmcnt(0)
buffer_load_dwordx4 v[4:7], v0, s[4:7], s33 offen offset:0 sc1
buffer_load_dwordx4 v[8:11], v0, s[4:7], s33 offen offset:1024 sc1
buffer_load_dwordx4 v[12:15], v0, s[4:7], s34 offen offset:0 sc1
buffer_load_dwordx4 v[16:19], v0, s[4:7], s35 offen offset:0 sc1
buffer_load_dwordx4 v[48:51], v0, s[4:7], s60 offen offset:0
buffer_load_dwordx4 v[52:55], v0, s[4:7], s60 offen offset:1024
s_waitcnt vmcnt(9)
ds_read_b128 v[56:59], v0 offset:36864
s_waitcnt vmcnt(8)
ds_read_b128 v[60:63], v0 offset:37888
ds_read_b128 v[64:67], v0 offset:38912
ds_read_b128 v[68:71], v0 offset:39936
v_mov_b64 v[24:25], 0
v_mov_b64 v[26:27], 0
v_mov_b64 v[28:29], 0
v_mov_b64 v[30:31], 0
v_mov_b64 v[32:33], 0
v_mov_b64 v[34:35], 0
v_mov_b64 v[36:37], 0
v_mov_b64 v[38:39], 0
v_mov_b64 v[40:41], 0
v_mov_b64 v[42:43], 0
v_mov_b64 v[44:45], 0
v_mov_b64 v[46:47], 0
s_waitcnt vmcnt(0)
s_branch k_T0_157
k_fl_166:
buffer_load_dwordx2 v[46:47], off, s[4:7], s46 sc1
s_waitcnt vmcnt(0)
v_min_u32 v46, v46, v47
v_cmp_lt_u32 vcc, s31, v46
v_mov_b64 v[46:47], 0
s_cbranch_vccnz k_okF_168
s_sub_u32 s32, s32, 1
s_cmp_gt_i32 s32, 0
s_cbranch_scc1 k_fl_166
s_branch k_okF_168
k_r1_164:
buffer_load_dwordx4 v[24:27], v0, s[4:7], s43 offen offset:0 sc1
buffer_load_dwordx4 v[28:31], v0, s[4:7], s43 offen offset:1024 sc1
buffer_load_dwordx4 v[32:35], v0, s[4:7], s43 offen offset:2048 sc1
buffer_load_dwordx4 v[36:39], v0, s[4:7], s43 offen offset:3072 sc1
s_sub_u32 s32, s32, 1
s_cmp_gt_i32 s32, 0
s_waitcnt vmcnt(3)
v_mfma_f32_16x16x32_bf16 v[40:43], v[24:27], v[16:19], 0
s_waitcnt vmcnt(2)
v_mfma_f32_16x16x32_bf16 v[40:43], v[28:31], v[16:19], v[40:43]
v_bitop3_b32 v46, v24, v28, s45 bitop3:0x7e
s_waitcnt vmcnt(1)
v_mfma_f32_16x16x32_bf16 v[40:43], v[32:35], v[16:19], v[40:43]
s_waitcnt vmcnt(0)
v_mfma_f32_16x16x32_bf16 v[40:43], v[36:39], v[16:19], v[40:43]
v_bitop3_b32 v47, v32, v36, s45 bitop3:0x7e
v_bitop3_b32 v46, v46, v47, 1 bitop3:0xa8
v_cmp_ne_u32 vcc, 0, v46
v_mov_b64 v[24:25], 0
v_mov_b64 v[26:27], 0
v_mov_b64 v[28:29], 0
v_mov_b64 v[30:31], 0
v_permlane32_swap_b32 v40, v41
v_permlane32_swap_b32 v42, v43
v_add_f32 v40, v40, v41
v_add_f32 v41, v42, v43
v_cvt_pk_bf16_f32 v42, v40, v41
s_cbranch_vccz k_ok1_165
s_cbranch_scc1 k_r1_164
s_branch k_ok1_165
k_slow_161:
ds_read_b128 v[24:27], v0 offset:4096
ds_read_b128 v[28:31], v0 offset:5120
v_mov_b32 v46, 0xff7fffff
s_add_u32 s48, s36, 0xffffe000
buffer_load_dwordx4 v[32:35], v0, s[4:7], s48 offen offset:0 sc1
buffer_load_dwordx4 v[36:39], v0, s[4:7], s48 offen offset:1024 sc1
s_waitcnt vmcnt(1) lgkmcnt(1)
v_mfma_f32_16x16x32_bf16 v[4:7], v[32:35], v[24:27], 0
s_waitcnt vmcnt(0) lgkmcnt(0)
v_mfma_f32_16x16x32_bf16 v[4:7], v[36:39], v[28:31], v[4:7]
v_mov_b64 v[8:9], s[56:57]
s_nop 5
v_permlane32_swap_b32 v4, v6
v_permlane32_swap_b32 v5, v7
v_add_f32_dpp v8, v6, v4 row_ror:8 row_mask:0xf bank_mask:0x3
s_nop 0
v_add_f32_dpp v9, v7, v5 row_ror:8 row_mask:0xf bank_mask:0x3
v_max3_f32 v46, v46, v8, v9
s_add_u32 s48, s36, 0xfffff000
buffer_load_dwordx4 v[32:35], v0, s[4:7], s48 offen offset:0 sc1
buffer_load_dwordx4 v[36:39], v0, s[4:7], s48 offen offset:1024 sc1
s_waitcnt vmcnt(1)
v_mfma_f32_16x16x32_bf16 v[4:7], v[32:35], v[24:27], 0
s_waitcnt vmcnt(0)
v_mfma_f32_16x16x32_bf16 v[4:7], v[36:39], v[28:31], v[4:7]
v_mov_b64 v[10:11], s[56:57]
s_nop 5
v_permlane32_swap_b32 v4, v6
v_permlane32_swap_b32 v5, v7
v_add_f32_dpp v10, v6, v4 row_ror:8 row_mask:0xf bank_mask:0x3
s_nop 0
v_add_f32_dpp v11, v7, v5 row_ror:8 row_mask:0xf bank_mask:0x3
v_max3_f32 v46, v46, v10, v11
s_add_u32 s48, s36, 0x0
buffer_load_dwordx4 v[32:35], v0, s[4:7], s48 offen offset:0 sc1
buffer_load_dwordx4 v[36:39], v0, s[4:7], s48 offen offset:1024 sc1
s_waitcnt vmcnt(1)
v_mfma_f32_16x16x32_bf16 v[4:7], v[32:35], v[24:27], 0
s_waitcnt vmcnt(0)
v_mfma_f32_16x16x32_bf16 v[4:7], v[36:39], v[28:31], v[4:7]
v_mov_b64 v[12:13], s[56:57]
s_nop 5
v_permlane32_swap_b32 v4, v6
v_permlane32_swap_b32 v5, v7
v_add_f32_dpp v12, v6, v4 row_ror:8 row_mask:0xf bank_mask:0x3
s_nop 0
v_add_f32_dpp v13, v7, v5 row_ror:8 row_mask:0xf bank_mask:0x3
v_max3_f32 v46, v46, v12, v13
s_add_u32 s48, s36, 0x1000
buffer_load_dwordx4 v[32:35], v0, s[4:7], s48 offen offset:0 sc1
buffer_load_dwordx4 v[36:39], v0, s[4:7], s48 offen offset:1024 sc1
s_waitcnt vmcnt(1)
v_mfma_f32_16x16x32_bf16 v[4:7], v[32:35], v[24:27], 0
s_waitcnt vmcnt(0)
v_mfma_f32_16x16x32_bf16 v[4:7], v[36:39], v[28:31], v[4:7]
v_mov_b64 v[14:15], s[56:57]
s_nop 5
v_permlane32_swap_b32 v4, v6
v_permlane32_swap_b32 v5, v7
v_add_f32_dpp v14, v6, v4 row_ror:8 row_mask:0xf bank_mask:0x3
s_nop 0
v_add_f32_dpp v15, v7, v5 row_ror:8 row_mask:0xf bank_mask:0x3
v_max3_f32 v46, v46, v14, v15
ds_read_b128 v[32:35], v0 offset:6144
ds_read_b128 v[36:39], v0 offset:7168
s_waitcnt lgkmcnt(1)
v_mfma_f32_16x16x32_bf16 v[4:7], v[32:35], v[24:27], 0
s_waitcnt lgkmcnt(0)
v_mfma_f32_16x16x32_bf16 v[4:7], v[36:39], v[28:31], v[4:7]
v_mov_b64 v[44:45], s[56:57]
s_nop 5
v_permlane32_swap_b32 v4, v6
v_permlane32_swap_b32 v5, v7
v_add_f32_dpp v44, v6, v4 row_ror:8 row_mask:0xf bank_mask:0x3
s_nop 0
v_add_f32_dpp v45, v7, v5 row_ror:8 row_mask:0xf bank_mask:0x3
v_max3_f32 v46, v46, v44, v45
buffer_load_dwordx4 v[32:35], v0, s[4:7], s36 offen offset:2048 sc1
buffer_load_dwordx4 v[36:39], v0, s[4:7], s36 offen offset:3072 sc1
v_mov_b32 v47, v46
s_nop 1
v_permlane32_swap_b32 v46, v47
v_max_f32 v46, v46, v47
v_mov_b32 v47, v46
s_nop 1
v_permlane16_swap_b32 v46, v47
v_max_f32 v46, v46, v47
v_sub_f32 v8, v8, v46
v_exp_f32 v8, v8
v_sub_f32 v9, v9, v46
v_exp_f32 v9, v9
v_sub_f32 v10, v10, v46
v_exp_f32 v10, v10
v_sub_f32 v11, v11, v46
v_exp_f32 v11, v11
v_sub_f32 v12, v12, v46
v_exp_f32 v12, v12
v_sub_f32 v13, v13, v46
v_exp_f32 v13, v13
v_sub_f32 v14, v14, v46
v_exp_f32 v14, v14
v_sub_f32 v15, v15, v46
v_exp_f32 v15, v15
v_sub_f32 v44, v44, v46
v_exp_f32 v44, v44
v_sub_f32 v45, v45, v46
v_exp_f32 v45, v45
v_cvt_pk_bf16_f32 v4, v8, v9
v_cvt_pk_bf16_f32 v5, v10, v11
v_cvt_pk_bf16_f32 v6, v12, v13
v_cvt_pk_bf16_f32 v7, v14, v15
v_mov_b32_dpp v8, v4 row_ror:8 row_mask:0xf bank_mask:0xf
v_mov_b32_dpp v9, v5 row_ror:8 row_mask:0xf bank_mask:0xf
v_mov_b32_dpp v10, v6 row_ror:8 row_mask:0xf bank_mask:0xf
v_mov_b32_dpp v11, v7 row_ror:8 row_mask:0xf bank_mask:0xf
v_cvt_pk_bf16_f32 v24, v44, v45
v_cvt_pk_bf16_f32 v25, v44, v45
s_nop 0
v_mov_b32_dpp v26, v24 row_ror:8 row_mask:0xf bank_mask:0xf
v_mov_b32_dpp v27, v24 row_ror:8 row_mask:0xf bank_mask:0xf
v_mov_b64 v[28:29], s[52:53]
v_mov_b64 v[30:31], s[52:53]
s_nop 1
v_mfma_f32_16x16x32_bf16 v[44:47], v[28:31], v[4:7], 0
s_waitcnt vmcnt(1)
v_mfma_f32_16x16x32_bf16 v[12:15], v[32:35], v[4:7], 0
s_waitcnt vmcnt(0)
v_mfma_f32_16x16x32_bf16 v[12:15], v[36:39], v[8:11], v[12:15]
v_mfma_f32_16x16x32_bf16 v[12:15], v[40:43], v[24:27], v[12:15]
v_mov_b64 v[28:29], s[54:55]
s_nop 1
v_mfma_f32_16x16x16_bf16 v[44:47], v[28:29], v[24:25], v[44:47]
s_nop 6
v_rcp_f32 v4, v44
s_nop 1
v_rcp_f32_dpp v4, v44 row_ror:8 row_mask:0xf bank_mask:0xc
s_nop 0
v_mul_f32 v12, v4, v12
v_mul_f32 v13, v4, v13
v_mul_f32 v14, v4, v14
v_mul_f32 v15, v4, v15
v_cvt_pk_bf16_f32 v44, v12, v13
v_cvt_pk_bf16_f32 v45, v14, v15
v_and_or_b32 v8, v1, 8, v3
ds_write_b64 v8, v[44:45] offset:3072
v_mov_b32_dpp v46, v44 row_ror:8 row_mask:0xf bank_mask:0xf
v_mov_b32_dpp v47, v45 row_ror:8 row_mask:0xf bank_mask:0xf
v_mov_b64 v[24:25], 0
v_mov_b64 v[26:27], 0
v_mov_b64 v[28:29], 0
v_mov_b64 v[30:31], 0
v_mov_b64 v[32:33], 0
v_mov_b64 v[34:35], 0
v_mov_b64 v[36:37], 0
v_mov_b64 v[38:39], 0
v_mov_b32 v12, s45
s_waitcnt lgkmcnt(0)
s_branch k_okS_162
k_done_163:
s_add_u32 s31, s31, 1
s_cmp_lt_u32 s31, 128
s_cbranch_scc1 k_lay_156
s_add_u32 s30, s30, 112
s_waitcnt vmcnt(0) lgkmcnt(0)
s_barrier
s_branch k_fin_7
k_w3_111:
v_lshrrev_b32 v12, 3, v0
v_lshlrev_b32 v10, 13, v12
v_bfe_u32 v12, v0, 1, 2
v_lshrrev_b32 v13, 4, v0
v_xor_b32 v12, v12, v13
v_lshl_add_u32 v10, v12, 5, v10
v_and_b32 v14, 1, v0
v_lshl_add_u32 v10, v14, 4, v10
v_mul_u32_u24 v11, 1280, v13
v_bfe_u32 v12, v0, 1, 3
v_and_b32 v13, 1, v13
v_lshlrev_b32 v13, 1, v13
v_xor_b32 v12, v12, v13
v_xor_b32 v12, 4, v12
v_lshl_add_u32 v11, v12, 5, v11
v_lshl_add_u32 v11, v14, 4, v11
v_bfe_u32 v12, v0, 5, 1
v_lshlrev_b32 v12, 4, v12
v_bfe_u32 v13, v0, 4, 1
v_lshl_add_u32 v12, v13, 1, v12
v_bfe_u32 v13, v0, 2, 1
v_lshl_add_u32 v12, v13, 2, v12
v_bfe_u32 v13, v0, 3, 1
v_mul_u32_u24 v15, 4224, v13
v_add_u32 v12, v13, v12
v_bfe_u32 v13, v12, 1, 2
v_xor_b32 v13, 3, v13
v_lshlrev_b32 v13, 5, v13
v_lshl_add_u32 v4, v12, 7, v13
v_and_b32 v14, 3, v0
v_lshl_add_u32 v4, v14, 3, v4
v_add_u32 v5, 0x10000, v4
v_add_u32 v6, 0x20000, v4
v_bfe_u32 v12, v0, 4, 1
v_lshlrev_b32 v13, 4, v12
v_lshlrev_b32 v12, 2, v12
v_bfe_u32 v8, v0, 5, 1
v_lshl_add_u32 v13, v8, 2, v13
v_bfe_u32 v8, v0, 2, 1
v_add_u32 v13, v8, v13
v_lshl_add_u32 v12, v8, 1, v12
v_bfe_u32 v8, v0, 3, 1
v_add_u32 v8, 6, v8
v_xor_b32 v12, v12, v8
v_lshlrev_b32 v12, 5, v12
v_lshl_add_u32 v7, v13, 8, v12
v_lshl_add_u32 v7, v14, 3, v7
v_add_u32 v8, 0x10000, v7
v_add_u32 v9, 0x20000, v7
v_lshlrev_b32 v0, 4, v0
v_add_u32 v2, 65536, v0
s_lshl_b32 s49, s30, 8
s_mul_i32 s50, s30, 163840
s_mul_i32 s60, s30, 131072
s_add_u32 s60, s60, 120684544
s_add_u32 s61, s60, 4096
s_add_u32 s62, s60, 8192
s_mov_b32 m0, 6144
s_add_u32 s48, s49, 393216
buffer_load_dwordx4 v10, s[8:11], s48 offen lds
s_mov_b32 m0, 7168
s_add_u32 s48, s49, 458752
buffer_load_dwordx4 v10, s[8:11], s48 offen lds
s_mov_b32 m0, 14336
s_add_u32 s48, s49, 393344
buffer_load_dwordx4 v10, s[12:15], s48 offen lds
s_mov_b32 m0, 15360
s_add_u32 s48, s49, 458880
buffer_load_dwordx4 v10, s[12:15], s48 offen lds
s_mov_b32 m0, 22528
s_add_u32 s48, s49, 393216
buffer_load_dwordx4 v10, s[16:19], s48 offen lds
s_mov_b32 m0, 23552
s_add_u32 s48, s49, 458752
buffer_load_dwordx4 v10, s[16:19], s48 offen lds
s_mov_b32 m0, 30720
s_add_u32 s48, s49, 393344
buffer_load_dwordx4 v10, s[16:19], s48 offen lds
s_mov_b32 m0, 31744
s_add_u32 s48, s49, 458880
buffer_load_dwordx4 v10, s[16:19], s48 offen lds
s_mov_b32 m0, 38912
s_add_u32 s48, s49, 917504
buffer_load_dwordx4 v10, s[8:11], s48 offen lds
s_mov_b32 m0, 39936
s_add_u32 s48, s49, 983040
buffer_load_dwordx4 v10, s[8:11], s48 offen lds
s_mov_b32 m0, 47104
s_add_u32 s48, s49, 917632
buffer_load_dwordx4 v10, s[12:15], s48 offen lds
s_mov_b32 m0, 48128
s_add_u32 s48, s49, 983168
buffer_load_dwordx4 v10, s[12:15], s48 offen lds
s_mov_b32 m0, 55296
s_add_u32 s48, s49, 917504
buffer_load_dwordx4 v10, s[16:19], s48 offen lds
s_mov_b32 m0, 56320
s_add_u32 s48, s49, 983040
buffer_load_dwordx4 v10, s[16:19], s48 offen lds
s_mov_b32 m0, 63488
s_add_u32 s48, s49, 917632
buffer_load_dwordx4 v10, s[16:19], s48 offen lds
s_mov_b32 m0, 64512
s_add_u32 s48, s49, 983168
buffer_load_dwordx4 v10, s[16:19], s48 offen lds
s_mov_b32 m0, 71680
s_add_u32 s48, s49, 1441792
buffer_load_dwordx4 v10, s[8:11], s48 offen lds
s_mov_b32 m0, 72704
s_add_u32 s48, s49, 1507328
buffer_load_dwordx4 v10, s[8:11], s48 offen lds
s_mov_b32 m0, 79872
s_add_u32 s48, s49, 1441920
buffer_load_dwordx4 v10, s[12:15], s48 offen lds
s_mov_b32 m0, 80896
s_add_u32 s48, s49, 1507456
buffer_load_dwordx4 v10, s[12:15], s48 offen lds
s_mov_b32 m0, 88064
s_add_u32 s48, s49, 3538944
buffer_load_dwordx4 v10, s[12:15], s48 offen lds
s_mov_b32 m0, 89088
s_add_u32 s48, s49, 3604480
buffer_load_dwordx4 v10, s[12:15], s48 offen lds
s_mov_b32 m0, 96256
s_add_u32 s48, s49, 3539072
buffer_load_dwordx4 v10, s[12:15], s48 offen lds
s_mov_b32 m0, 97280
s_add_u32 s48, s49, 3604608
buffer_load_dwordx4 v10, s[12:15], s48 offen lds
s_mov_b32 m0, 104448
s_add_u32 s48, s49, 3538944
buffer_load_dwordx4 v10, s[16:19], s48 offen lds
s_mov_b32 m0, 105472
s_add_u32 s48, s49, 3604480
buffer_load_dwordx4 v10, s[16:19], s48 offen lds
s_mov_b32 m0, 112640
s_add_u32 s48, s49, 3539072
buffer_load_dwordx4 v10, s[16:19], s48 offen lds
s_mov_b32 m0, 113664
s_add_u32 s48, s49, 3604608
buffer_load_dwordx4 v10, s[16:19], s48 offen lds
s_mov_b32 m0, 120832
s_add_u32 s48, s49, 1966080
buffer_load_dwordx4 v10, s[8:11], s48 offen lds
s_mov_b32 m0, 121856
s_add_u32 s48, s49, 2031616
buffer_load_dwordx4 v10, s[8:11], s48 offen lds
s_mov_b32 m0, 129024
s_add_u32 s48, s49, 2490368
buffer_load_dwordx4 v10, s[8:11], s48 offen lds
s_mov_b32 m0, 130048
s_add_u32 s48, s49, 2555904
buffer_load_dwordx4 v10, s[8:11], s48 offen lds
s_waitcnt vmcnt(24)
s_barrier
s_mov_b32 m0, 137216
s_add_u32 s48, s49, 3014656
buffer_load_dwordx4 v10, s[8:11], s48 offen lds
s_mov_b32 m0, 138240
s_add_u32 s48, s49, 3080192
buffer_load_dwordx4 v10, s[8:11], s48 offen lds
s_mov_b32 m0, 145408
s_add_u32 s48, s49, 4063232
buffer_load_dwordx4 v10, s[8:11], s48 offen lds
s_mov_b32 m0, 146432
s_add_u32 s48, s49, 4128768
buffer_load_dwordx4 v10, s[8:11], s48 offen lds
s_mov_b32 m0, 153600
s_add_u32 s48, s49, 4063360
buffer_load_dwordx4 v10, s[8:11], s48 offen lds
s_mov_b32 m0, 154624
s_add_u32 s48, s49, 4128896
buffer_load_dwordx4 v10, s[8:11], s48 offen lds
s_mov_b32 m0, 161792
s_add_u32 s48, s49, 4587520
buffer_load_dwordx4 v10, s[8:11], s48 offen lds
s_mov_b32 m0, 162816
s_add_u32 s48, s49, 4653056
buffer_load_dwordx4 v10, s[8:11], s48 offen lds
ds_read_b64_tr_b16 a[24:25], v4 offset:0
ds_read_b64_tr_b16 a[26:27], v4 offset:1024
ds_read_b64_tr_b16 a[28:29], v4 offset:4096
ds_read_b64_tr_b16 a[30:31], v4 offset:5120
ds_read_b64_tr_b16 a[32:33], v4 offset:8192
ds_read_b64_tr_b16 a[34:35], v4 offset:9216
ds_read_b64_tr_b16 a[36:37], v4 offset:12288
ds_read_b64_tr_b16 a[38:39], v4 offset:13312
ds_read_b64_tr_b16 a[40:41], v4 offset:16384
ds_read_b64_tr_b16 a[42:43], v4 offset:17408
ds_read_b64_tr_b16 a[44:45], v4 offset:20480
ds_read_b64_tr_b16 a[46:47], v4 offset:21504
ds_read_b64_tr_b16 a[48:49], v4 offset:24576
ds_read_b64_tr_b16 a[50:51], v4 offset:25600
ds_read_b64_tr_b16 a[52:53], v4 offset:28672
ds_read_b64_tr_b16 a[54:55], v4 offset:29696
s_waitcnt lgkmcnt(0)
s_waitcnt vmcnt(24)
s_barrier
s_mov_b32 m0, 6144
s_add_u32 s48, s49, 4587648
buffer_load_dwordx4 v10, s[8:11], s48 offen lds
s_mov_b32 m0, 7168
s_add_u32 s48, s49, 4653184
buffer_load_dwordx4 v10, s[8:11], s48 offen lds
s_mov_b32 m0, 14336
s_add_u32 s48, s49, 5111808
buffer_load_dwordx4 v10, s[8:11], s48 offen lds
s_mov_b32 m0, 15360
s_add_u32 s48, s49, 5177344
buffer_load_dwordx4 v10, s[8:11], s48 offen lds
s_mov_b32 m0, 22528
s_add_u32 s48, s49, 5111936
buffer_load_dwordx4 v10, s[8:11], s48 offen lds
s_mov_b32 m0, 23552
s_add_u32 s48, s49, 5177472
buffer_load_dwordx4 v10, s[8:11], s48 offen lds
s_mov_b32 m0, 30720
s_add_u32 s48, s49, 4063232
buffer_load_dwordx4 v10, s[12:15], s48 offen lds
s_mov_b32 m0, 31744
s_add_u32 s48, s49, 4128768
buffer_load_dwordx4 v10, s[12:15], s48 offen lds
ds_read_b64_tr_b16 v[16:17], v4 offset:32768
ds_read_b64_tr_b16 v[18:19], v4 offset:33792
ds_read_b64_tr_b16 v[20:21], v4 offset:36864
ds_read_b64_tr_b16 v[22:23], v4 offset:37888
ds_read_b64_tr_b16 a[0:1], v4 offset:40960
ds_read_b64_tr_b16 a[2:3], v4 offset:41984
ds_read_b64_tr_b16 a[4:5], v4 offset:45056
ds_read_b64_tr_b16 a[6:7], v4 offset:46080
ds_read_b64_tr_b16 a[8:9], v4 offset:49152
ds_read_b64_tr_b16 a[10:11], v4 offset:50176
ds_read_b64_tr_b16 a[12:13], v4 offset:53248
ds_read_b64_tr_b16 a[14:15], v4 offset:54272
ds_read_b64_tr_b16 a[16:17], v4 offset:57344
ds_read_b64_tr_b16 a[18:19], v4 offset:58368
ds_read_b64_tr_b16 a[20:21], v4 offset:61440
ds_read_b64_tr_b16 a[22:23], v4 offset:62464
s_waitcnt lgkmcnt(0)
buffer_store_dwordx4 v[16:19], v0, s[4:7], s60 offen offset:0
buffer_store_dwordx4 v[20:23], v0, s[4:7], s60 offen offset:1024
s_waitcnt vmcnt(26)
s_barrier
s_mov_b32 m0, 38912
s_add_u32 s48, s49, 4063360
buffer_load_dwordx4 v10, s[12:15], s48 offen lds
s_mov_b32 m0, 39936
s_add_u32 s48, s49, 4128896
buffer_load_dwordx4 v10, s[12:15], s48 offen lds
s_mov_b32 m0, 47104
s_add_u32 s48, s49, 4063232
buffer_load_dwordx4 v10, s[16:19], s48 offen lds
s_mov_b32 m0, 48128
s_add_u32 s48, s49, 4128768
buffer_load_dwordx4 v10, s[16:19], s48 offen lds
s_mov_b32 m0, 55296
s_add_u32 s48, s49, 4063360
buffer_load_dwordx4 v10, s[16:19], s48 offen lds
s_mov_b32 m0, 56320
s_add_u32 s48, s49, 4128896
buffer_load_dwordx4 v10, s[16:19], s48 offen lds
s_mov_b32 m0, 63488
s_add_u32 s48, s49, 4587520
buffer_load_dwordx4 v10, s[12:15], s48 offen lds
s_mov_b32 m0, 64512
s_add_u32 s48, s49, 4653056
buffer_load_dwordx4 v10, s[12:15], s48 offen lds
ds_read_b64_tr_b16 a[120:121], v5 offset:0
ds_read_b64_tr_b16 a[122:123], v5 offset:1024
ds_read_b64_tr_b16 a[124:125], v5 offset:4096
ds_read_b64_tr_b16 a[126:127], v5 offset:5120
ds_read_b64_tr_b16 v[96:97], v5 offset:8192
ds_read_b64_tr_b16 v[98:99], v5 offset:9216
ds_read_b64_tr_b16 v[100:101], v5 offset:12288
ds_read_b64_tr_b16 v[102:103], v5 offset:13312
ds_read_b64_tr_b16 v[32:33], v5 offset:16384
ds_read_b64_tr_b16 v[34:35], v5 offset:17408
ds_read_b64_tr_b16 v[36:37], v5 offset:20480
ds_read_b64_tr_b16 v[38:39], v5 offset:21504
ds_read_b64_tr_b16 a[192:193], v5 offset:24576
ds_read_b64_tr_b16 a[194:195], v5 offset:25600
ds_read_b64_tr_b16 a[196:197], v5 offset:28672
ds_read_b64_tr_b16 a[198:199], v5 offset:29696
s_waitcnt lgkmcnt(0)
buffer_store_dwordx4 v[32:35], v0, s[4:7], s60 offen offset:2048
buffer_store_dwordx4 v[36:39], v0, s[4:7], s60 offen offset:3072
s_waitcnt vmcnt(28)
s_barrier
s_mov_b32 m0, 71680
s_add_u32 s48, s49, 4587648
buffer_load_dwordx4 v10, s[12:15], s48 offen lds
s_mov_b32 m0, 72704
s_add_u32 s48, s49, 4653184
buffer_load_dwordx4 v10, s[12:15], s48 offen lds
s_mov_b32 m0, 79872
s_add_u32 s48, s49, 4587520
buffer_load_dwordx4 v10, s[16:19], s48 offen lds
s_mov_b32 m0, 80896
s_add_u32 s48, s49, 4653056
buffer_load_dwordx4 v10, s[16:19], s48 offen lds
s_mov_b32 m0, 88064
s_add_u32 s48, s49, 4587648
buffer_load_dwordx4 v10, s[16:19], s48 offen lds
s_mov_b32 m0, 89088
s_add_u32 s48, s49, 4653184
buffer_load_dwordx4 v10, s[16:19], s48 offen lds
s_mov_b32 m0, 96256
s_add_u32 s48, s49, 5111808
buffer_load_dwordx4 v10, s[12:15], s48 offen lds
s_mov_b32 m0, 97280
s_add_u32 s48, s49, 5177344
buffer_load_dwordx4 v10, s[12:15], s48 offen lds
ds_read_b64_tr_b16 a[200:201], v5 offset:32768
ds_read_b64_tr_b16 a[202:203], v5 offset:33792
ds_read_b64_tr_b16 a[204:205], v5 offset:36864
ds_read_b64_tr_b16 a[206:207], v5 offset:37888
ds_read_b64_tr_b16 a[208:209], v5 offset:40960
ds_read_b64_tr_b16 a[210:211], v5 offset:41984
ds_read_b64_tr_b16 a[212:213], v5 offset:45056
ds_read_b64_tr_b16 a[214:215], v5 offset:46080
ds_read_b64_tr_b16 a[128:129], v5 offset:49152
ds_read_b64_tr_b16 a[130:131], v5 offset:50176
ds_read_b64_tr_b16 a[132:133], v5 offset:53248
ds_read_b64_tr_b16 a[134:135], v5 offset:54272
ds_read_b64_tr_b16 a[144:145], v5 offset:57344
ds_read_b64_tr_b16 a[146:147], v5 offset:58368
ds_read_b64_tr_b16 a[148:149], v5 offset:61440
ds_read_b64_tr_b16 a[150:151], v5 offset:62464
s_waitcnt lgkmcnt(0)
s_waitcnt vmcnt(28)
s_barrier
s_mov_b32 m0, 104448
s_add_u32 s48, s49, 5111936
buffer_load_dwordx4 v10, s[12:15], s48 offen lds
s_mov_b32 m0, 105472
s_add_u32 s48, s49, 5177472
buffer_load_dwordx4 v10, s[12:15], s48 offen lds
s_mov_b32 m0, 112640
s_add_u32 s48, s49, 5111808
buffer_load_dwordx4 v10, s[16:19], s48 offen lds
s_mov_b32 m0, 113664
s_add_u32 s48, s49, 5177344
buffer_load_dwordx4 v10, s[16:19], s48 offen lds
s_mov_b32 m0, 120832
s_add_u32 s48, s49, 5111936
buffer_load_dwordx4 v10, s[16:19], s48 offen lds
s_mov_b32 m0, 121856
s_add_u32 s48, s49, 5177472
buffer_load_dwordx4 v10, s[16:19], s48 offen lds
s_mov_b32 m0, 129024
s_add_u32 s48, s49, 3014656
buffer_load_dwordx4 v10, s[12:15], s48 offen lds
s_mov_b32 m0, 130048
s_add_u32 s48, s49, 3080192
buffer_load_dwordx4 v10, s[12:15], s48 offen lds
ds_read_b64_tr_b16 a[56:57], v6 offset:0
ds_read_b64_tr_b16 a[58:59], v6 offset:1024
ds_read_b64_tr_b16 a[60:61], v6 offset:4096
ds_read_b64_tr_b16 a[62:63], v6 offset:5120
ds_read_b64_tr_b16 a[168:169], v6 offset:8192
ds_read_b64_tr_b16 a[170:171], v6 offset:9216
ds_read_b64_tr_b16 a[172:173], v6 offset:12288
ds_read_b64_tr_b16 a[174:175], v6 offset:13312
ds_read_b64_tr_b16 a[176:177], v6 offset:16384
ds_read_b64_tr_b16 a[178:179], v6 offset:17408
ds_read_b64_tr_b16 a[180:181], v6 offset:20480
ds_read_b64_tr_b16 a[182:183], v6 offset:21504
ds_read_b64_tr_b16 a[184:185], v6 offset:24576
ds_read_b64_tr_b16 a[186:187], v6 offset:25600
ds_read_b64_tr_b16 a[188:189], v6 offset:28672
ds_read_b64_tr_b16 a[190:191], v6 offset:29696
s_waitcnt lgkmcnt(0)
s_waitcnt vmcnt(28)
s_barrier
s_mov_b32 m0, 137216
s_add_u32 s48, s49, 3014784
buffer_load_dwordx4 v10, s[12:15], s48 offen lds
s_mov_b32 m0, 138240
s_add_u32 s48, s49, 3080320
buffer_load_dwordx4 v10, s[12:15], s48 offen lds
s_mov_b32 m0, 145408
s_add_u32 s48, s49, 1966080
buffer_load_dwordx4 v10, s[12:15], s48 offen lds
s_mov_b32 m0, 146432
s_add_u32 s48, s49, 2031616
buffer_load_dwordx4 v10, s[12:15], s48 offen lds
s_mov_b32 m0, 153600
s_add_u32 s48, s49, 1966208
buffer_load_dwordx4 v10, s[12:15], s48 offen lds
s_mov_b32 m0, 154624
s_add_u32 s48, s49, 2031744
buffer_load_dwordx4 v10, s[12:15], s48 offen lds
s_mov_b32 m0, 161792
s_add_u32 s48, s49, 2490368
buffer_load_dwordx4 v10, s[12:15], s48 offen lds
s_mov_b32 m0, 162816
s_add_u32 s48, s49, 2555904
buffer_load_dwordx4 v10, s[12:15], s48 offen lds
ds_read_b64_tr_b16 v[232:233], v4 offset:0
ds_read_b64_tr_b16 v[234:235], v4 offset:1024
ds_read_b64_tr_b16 v[236:237], v4 offset:4096
ds_read_b64_tr_b16 v[238:239], v4 offset:5120
ds_read_b64_tr_b16 a[80:81], v4 offset:8192
ds_read_b64_tr_b16 a[82:83], v4 offset:9216
ds_read_b64_tr_b16 a[84:85], v4 offset:12288
ds_read_b64_tr_b16 a[86:87], v4 offset:13312
ds_read_b64_tr_b16 a[88:89], v4 offset:16384
ds_read_b64_tr_b16 a[90:91], v4 offset:17408
ds_read_b64_tr_b16 a[92:93], v4 offset:20480
ds_read_b64_tr_b16 a[94:95], v4 offset:21504
ds_read_b64_tr_b16 v[224:225], v4 offset:24576
ds_read_b64_tr_b16 v[226:227], v4 offset:25600
ds_read_b64_tr_b16 v[228:229], v4 offset:28672
ds_read_b64_tr_b16 v[230:231], v4 offset:29696
s_waitcnt lgkmcnt(0)
s_waitcnt vmcnt(26)
s_barrier
s_mov_b32 m0, 6144
s_add_u32 s48, s49, 2490496
buffer_load_dwordx4 v10, s[12:15], s48 offen lds
s_mov_b32 m0, 7168
s_add_u32 s48, s49, 2556032
buffer_load_dwordx4 v10, s[12:15], s48 offen lds
s_mov_b32 m0, 14336
s_add_u32 s48, s49, 1966080
buffer_load_dwordx4 v10, s[16:19], s48 offen lds
s_mov_b32 m0, 15360
s_add_u32 s48, s49, 2031616
buffer_load_dwordx4 v10, s[16:19], s48 offen lds
s_mov_b32 m0, 22528
s_add_u32 s48, s49, 1966208
buffer_load_dwordx4 v10, s[16:19], s48 offen lds
s_mov_b32 m0, 23552
s_add_u32 s48, s49, 2031744
buffer_load_dwordx4 v10, s[16:19], s48 offen lds
s_mov_b32 m0, 30720
s_add_u32 s48, s49, 3014656
buffer_load_dwordx4 v10, s[16:19], s48 offen lds
s_mov_b32 m0, 31744
s_add_u32 s48, s49, 3080192
buffer_load_dwordx4 v10, s[16:19], s48 offen lds
ds_read_b64_tr_b16 a[216:217], v4 offset:32768
ds_read_b64_tr_b16 a[218:219], v4 offset:33792
ds_read_b64_tr_b16 a[220:221], v4 offset:36864
ds_read_b64_tr_b16 a[222:223], v4 offset:37888
ds_read_b64_tr_b16 a[224:225], v4 offset:40960
ds_read_b64_tr_b16 a[226:227], v4 offset:41984
ds_read_b64_tr_b16 a[228:229], v4 offset:45056
ds_read_b64_tr_b16 a[230:231], v4 offset:46080
ds_read_b64_tr_b16 a[232:233], v4 offset:49152
ds_read_b64_tr_b16 a[234:235], v4 offset:50176
ds_read_b64_tr_b16 a[236:237], v4 offset:53248
ds_read_b64_tr_b16 a[238:239], v4 offset:54272
ds_read_b64_tr_b16 a[240:241], v4 offset:57344
ds_read_b64_tr_b16 a[242:243], v4 offset:58368
ds_read_b64_tr_b16 a[244:245], v4 offset:61440
ds_read_b64_tr_b16 a[246:247], v4 offset:62464
s_waitcnt lgkmcnt(0)
s_waitcnt vmcnt(24)
s_barrier
s_mov_b32 m0, 38912
s_add_u32 s48, s49, 3014784
buffer_load_dwordx4 v10, s[16:19], s48 offen lds
s_mov_b32 m0, 39936
s_add_u32 s48, s49, 3080320
buffer_load_dwordx4 v10, s[16:19], s48 offen lds
s_mov_b32 m0, 47104
s_add_u32 s48, s49, 2490368
buffer_load_dwordx4 v10, s[16:19], s48 offen lds
s_mov_b32 m0, 48128
s_add_u32 s48, s49, 2555904
buffer_load_dwordx4 v10, s[16:19], s48 offen lds
s_mov_b32 m0, 55296
s_add_u32 s48, s49, 2490496
buffer_load_dwordx4 v10, s[16:19], s48 offen lds
s_mov_b32 m0, 56320
s_add_u32 s48, s49, 2556032
buffer_load_dwordx4 v10, s[16:19], s48 offen lds
s_mov_b32 m0, 63488
s_add_u32 s48, s49, 1441792
buffer_load_dwordx4 v10, s[16:19], s48 offen lds
s_mov_b32 m0, 64512
s_add_u32 s48, s49, 1507328
buffer_load_dwordx4 v10, s[16:19], s48 offen lds
ds_read_b64_tr_b16 v[248:249], v5 offset:0
ds_read_b64_tr_b16 v[250:251], v5 offset:1024
ds_read_b64_tr_b16 v[252:253], v5 offset:4096
ds_read_b64_tr_b16 v[254:255], v5 offset:5120
ds_read_b64_tr_b16 a[248:249], v5 offset:8192
ds_read_b64_tr_b16 a[250:251], v5 offset:9216
ds_read_b64_tr_b16 a[252:253], v5 offset:12288
ds_read_b64_tr_b16 a[254:255], v5 offset:13312
ds_read_b64_tr_b16 v[72:73], v5 offset:16384
ds_read_b64_tr_b16 v[74:75], v5 offset:17408
ds_read_b64_tr_b16 v[76:77], v5 offset:20480
ds_read_b64_tr_b16 v[78:79], v5 offset:21504
ds_read_b64_tr_b16 a[152:153], v5 offset:24576
ds_read_b64_tr_b16 a[154:155], v5 offset:25600
ds_read_b64_tr_b16 a[156:157], v5 offset:28672
ds_read_b64_tr_b16 a[158:159], v5 offset:29696
s_waitcnt lgkmcnt(0)
s_waitcnt vmcnt(24)
s_barrier
s_mov_b32 m0, 71680
s_add_u32 s48, s49, 1441920
buffer_load_dwordx4 v10, s[16:19], s48 offen lds
s_mov_b32 m0, 72704
s_add_u32 s48, s49, 1507456
buffer_load_dwordx4 v10, s[16:19], s48 offen lds
s_mov_b32 m0, 79872
s_add_u32 s48, s50, 92160
buffer_load_dwordx4 v11, s[20:23], s48 offen lds
s_mov_b32 m0, 80896
s_add_u32 s48, s50, 97280
buffer_load_dwordx4 v11, s[20:23], s48 offen lds
s_mov_b32 m0, 88064
s_add_u32 s48, s50, 112640
buffer_load_dwordx4 v11, s[20:23], s48 offen lds
s_mov_b32 m0, 89088
s_add_u32 s48, s50, 117760
buffer_load_dwordx4 v11, s[20:23], s48 offen lds
s_mov_b32 m0, 96256
s_add_u32 s48, s50, 133120
buffer_load_dwordx4 v11, s[20:23], s48 offen lds
s_mov_b32 m0, 97280
s_add_u32 s48, s50, 138240
buffer_load_dwordx4 v11, s[20:23], s48 offen lds
ds_read_b64_tr_b16 a[96:97], v5 offset:32768
ds_read_b64_tr_b16 a[98:99], v5 offset:33792
ds_read_b64_tr_b16 a[100:101], v5 offset:36864
ds_read_b64_tr_b16 a[102:103], v5 offset:37888
ds_read_b64_tr_b16 a[104:105], v5 offset:40960
ds_read_b64_tr_b16 a[106:107], v5 offset:41984
ds_read_b64_tr_b16 a[108:109], v5 offset:45056
ds_read_b64_tr_b16 a[110:111], v5 offset:46080
ds_read_b64_tr_b16 a[112:113], v5 offset:49152
ds_read_b64_tr_b16 a[114:115], v5 offset:50176
ds_read_b64_tr_b16 a[116:117], v5 offset:53248
ds_read_b64_tr_b16 a[118:119], v5 offset:54272
ds_read_b64_tr_b16 a[64:65], v5 offset:57344
ds_read_b64_tr_b16 a[66:67], v5 offset:58368
ds_read_b64_tr_b16 a[68:69], v5 offset:61440
ds_read_b64_tr_b16 a[70:71], v5 offset:62464
s_waitcnt lgkmcnt(0)
s_waitcnt vmcnt(24)
s_barrier
s_mov_b32 m0, 104448
s_add_u32 s48, s50, 153600
buffer_load_dwordx4 v11, s[20:23], s48 offen lds
s_mov_b32 m0, 105472
s_add_u32 s48, s50, 158720
buffer_load_dwordx4 v11, s[20:23], s48 offen lds
s_mov_b32 m0, 112640
s_add_u32 s48, s50, 92416
buffer_load_dwordx4 v11, s[20:23], s48 offen lds
s_mov_b32 m0, 113664
s_add_u32 s48, s50, 97536
buffer_load_dwordx4 v11, s[20:23], s48 offen lds
s_mov_b32 m0, 120832
s_add_u32 s48, s50, 112896
buffer_load_dwordx4 v11, s[20:23], s48 offen lds
s_mov_b32 m0, 121856
s_add_u32 s48, s50, 118016
buffer_load_dwordx4 v11, s[20:23], s48 offen lds
s_mov_b32 m0, 129024
s_add_u32 s48, s50, 133376
buffer_load_dwordx4 v11, s[20:23], s48 offen lds
s_mov_b32 m0, 130048
s_add_u32 s48, s50, 138496
buffer_load_dwordx4 v11, s[20:23], s48 offen lds
ds_read_b64_tr_b16 a[72:73], v6 offset:0
ds_read_b64_tr_b16 a[74:75], v6 offset:1024
ds_read_b64_tr_b16 a[76:77], v6 offset:4096
ds_read_b64_tr_b16 a[78:79], v6 offset:5120
ds_read_b64_tr_b16 v[104:105], v6 offset:8192
ds_read_b64_tr_b16 v[106:107], v6 offset:9216
ds_read_b64_tr_b16 v[108:109], v6 offset:12288
ds_read_b64_tr_b16 v[110:111], v6 offset:13312
ds_read_b64_tr_b16 v[112:113], v6 offset:16384
ds_read_b64_tr_b16 v[114:115], v6 offset:17408
ds_read_b64_tr_b16 v[116:117], v6 offset:20480
ds_read_b64_tr_b16 v[118:119], v6 offset:21504
ds_read_b64_tr_b16 v[80:81], v6 offset:24576
ds_read_b64_tr_b16 v[82:83], v6 offset:25600
ds_read_b64_tr_b16 v[84:85], v6 offset:28672
ds_read_b64_tr_b16 v[86:87], v6 offset:29696
s_waitcnt lgkmcnt(0)
s_waitcnt vmcnt(24)
s_barrier
s_mov_b32 m0, 137216
s_add_u32 s48, s50, 153856
buffer_load_dwordx4 v11, s[20:23], s48 offen lds
s_mov_b32 m0, 138240
s_add_u32 s48, s50, 158976
buffer_load_dwordx4 v11, s[20:23], s48 offen lds
s_mov_b32 m0, 145408
s_add_u32 s48, s50, 92672
buffer_load_dwordx4 v11, s[20:23], s48 offen lds
s_mov_b32 m0, 146432
s_add_u32 s48, s50, 97792
buffer_load_dwordx4 v11, s[20:23], s48 offen lds
s_mov_b32 m0, 153600
s_add_u32 s48, s50, 113152
buffer_load_dwordx4 v11, s[20:23], s48 offen lds
s_mov_b32 m0, 154624
s_add_u32 s48, s50, 118272
buffer_load_dwordx4 v11, s[20:23], s48 offen lds
s_mov_b32 m0, 161792
s_add_u32 s48, s50, 133632
buffer_load_dwordx4 v11, s[20:23], s48 offen lds
s_mov_b32 m0, 162816
s_add_u32 s48, s50, 138752
buffer_load_dwordx4 v11, s[20:23], s48 offen lds
ds_read_b64_tr_b16 v[88:89], v4 offset:0
ds_read_b64_tr_b16 v[90:91], v4 offset:1024
ds_read_b64_tr_b16 v[92:93], v4 offset:4096
ds_read_b64_tr_b16 v[94:95], v4 offset:5120
ds_read_b64_tr_b16 v[144:145], v4 offset:8192
ds_read_b64_tr_b16 v[146:147], v4 offset:9216
ds_read_b64_tr_b16 v[148:149], v4 offset:12288
ds_read_b64_tr_b16 v[150:151], v4 offset:13312
ds_read_b64_tr_b16 v[152:153], v4 offset:16384
ds_read_b64_tr_b16 v[154:155], v4 offset:17408
ds_read_b64_tr_b16 v[156:157], v4 offset:20480
ds_read_b64_tr_b16 v[158:159], v4 offset:21504
ds_read_b64_tr_b16 v[160:161], v4 offset:24576
ds_read_b64_tr_b16 v[162:163], v4 offset:25600
ds_read_b64_tr_b16 v[164:165], v4 offset:28672
ds_read_b64_tr_b16 v[166:167], v4 offset:29696
s_waitcnt lgkmcnt(0)
s_waitcnt vmcnt(24)
s_barrier
s_mov_b32 m0, 6144
s_add_u32 s48, s50, 154112
buffer_load_dwordx4 v11, s[20:23], s48 offen lds
s_mov_b32 m0, 7168
s_add_u32 s48, s50, 159232
buffer_load_dwordx4 v11, s[20:23], s48 offen lds
s_mov_b32 m0, 14336
s_add_u32 s48, s49, 393344
buffer_load_dwordx4 v10, s[8:11], s48 offen lds
s_mov_b32 m0, 15360
s_add_u32 s48, s49, 458880
buffer_load_dwordx4 v10, s[8:11], s48 offen lds
s_mov_b32 m0, 22528
s_add_u32 s48, s49, 393216
buffer_load_dwordx4 v10, s[12:15], s48 offen lds
s_mov_b32 m0, 23552
s_add_u32 s48, s49, 458752
buffer_load_dwordx4 v10, s[12:15], s48 offen lds
s_mov_b32 m0, 30720
s_add_u32 s48, s49, 917632
buffer_load_dwordx4 v10, s[8:11], s48 offen lds
s_mov_b32 m0, 31744
s_add_u32 s48, s49, 983168
buffer_load_dwordx4 v10, s[8:11], s48 offen lds
ds_read_b64_tr_b16 v[168:169], v4 offset:32768
ds_read_b64_tr_b16 v[170:171], v4 offset:33792
ds_read_b64_tr_b16 v[172:173], v4 offset:36864
ds_read_b64_tr_b16 v[174:175], v4 offset:37888
ds_read_b64_tr_b16 v[128:129], v4 offset:40960
ds_read_b64_tr_b16 v[130:131], v4 offset:41984
ds_read_b64_tr_b16 v[132:133], v4 offset:45056
ds_read_b64_tr_b16 v[134:135], v4 offset:46080
ds_read_b64_tr_b16 v[136:137], v4 offset:49152
ds_read_b64_tr_b16 v[138:139], v4 offset:50176
ds_read_b64_tr_b16 v[140:141], v4 offset:53248
ds_read_b64_tr_b16 v[142:143], v4 offset:54272
ds_read_b64_tr_b16 v[120:121], v4 offset:57344
ds_read_b64_tr_b16 v[122:123], v4 offset:58368
ds_read_b64_tr_b16 v[124:125], v4 offset:61440
ds_read_b64_tr_b16 v[126:127], v4 offset:62464
s_waitcnt lgkmcnt(0)
s_waitcnt vmcnt(24)
s_barrier
s_mov_b32 m0, 38912
s_add_u32 s48, s49, 917504
buffer_load_dwordx4 v10, s[12:15], s48 offen lds
s_mov_b32 m0, 39936
s_add_u32 s48, s49, 983040
buffer_load_dwordx4 v10, s[12:15], s48 offen lds
s_mov_b32 m0, 47104
s_add_u32 s48, s49, 1441920
buffer_load_dwordx4 v10, s[8:11], s48 offen lds
s_mov_b32 m0, 48128
s_add_u32 s48, s49, 1507456
buffer_load_dwordx4 v10, s[8:11], s48 offen lds
s_mov_b32 m0, 55296
s_add_u32 s48, s49, 1966208
buffer_load_dwordx4 v10, s[8:11], s48 offen lds
s_mov_b32 m0, 56320
s_add_u32 s48, s49, 2031744
buffer_load_dwordx4 v10, s[8:11], s48 offen lds
s_mov_b32 m0, 63488
s_add_u32 s48, s49, 2490496
buffer_load_dwordx4 v10, s[8:11], s48 offen lds
s_mov_b32 m0, 64512
s_add_u32 s48, s49, 2556032
buffer_load_dwordx4 v10, s[8:11], s48 offen lds
ds_read_b64_tr_b16 v[240:241], v5 offset:0
ds_read_b64_tr_b16 v[242:243], v5 offset:1024
ds_read_b64_tr_b16 v[244:245], v5 offset:4096
ds_read_b64_tr_b16 v[246:247], v5 offset:5120
ds_read_b64_tr_b16 v[176:177], v8 offset:8192
ds_read_b64_tr_b16 v[178:179], v8 offset:8704
ds_read_b64_tr_b16 v[180:181], v8 offset:10240
ds_read_b64_tr_b16 v[182:183], v8 offset:10752
ds_read_b64_tr_b16 v[184:185], v8 offset:16384
ds_read_b64_tr_b16 v[186:187], v8 offset:16896
ds_read_b64_tr_b16 v[188:189], v8 offset:18432
ds_read_b64_tr_b16 v[190:191], v8 offset:18944
ds_read_b64_tr_b16 v[192:193], v8 offset:24576
ds_read_b64_tr_b16 v[194:195], v8 offset:25088
ds_read_b64_tr_b16 v[196:197], v8 offset:26624
ds_read_b64_tr_b16 v[198:199], v8 offset:27136
s_waitcnt lgkmcnt(0)
s_waitcnt vmcnt(24)
s_barrier
s_mov_b32 m0, 71680
s_add_u32 s48, s49, 3014784
buffer_load_dwordx4 v10, s[8:11], s48 offen lds
s_mov_b32 m0, 72704
s_add_u32 s48, s49, 3080320
buffer_load_dwordx4 v10, s[8:11], s48 offen lds
s_mov_b32 m0, 79872
s_add_u32 s48, s50, 92928
buffer_load_dwordx4 v11, s[20:23], s48 offen lds
s_mov_b32 m0, 80896
s_add_u32 s48, s50, 98048
buffer_load_dwordx4 v11, s[20:23], s48 offen lds
s_mov_b32 m0, 88064
s_add_u32 s48, s50, 113408
buffer_load_dwordx4 v11, s[20:23], s48 offen lds
s_mov_b32 m0, 89088
s_add_u32 s48, s50, 118528
buffer_load_dwordx4 v11, s[20:23], s48 offen lds
s_mov_b32 m0, 96256
s_add_u32 s48, s50, 133888
buffer_load_dwordx4 v11, s[20:23], s48 offen lds
s_mov_b32 m0, 97280
s_add_u32 s48, s50, 139008
buffer_load_dwordx4 v11, s[20:23], s48 offen lds
v_xor_b32 v12, v15, v8
ds_read_b64_tr_b16 v[16:17], v12 offset:32768
ds_read_b64_tr_b16 v[18:19], v12 offset:33280
ds_read_b64_tr_b16 v[20:21], v12 offset:34816
ds_read_b64_tr_b16 v[22:23], v12 offset:35328
ds_read_b64_tr_b16 a[160:161], v8 offset:40960
ds_read_b64_tr_b16 a[162:163], v8 offset:41472
ds_read_b64_tr_b16 a[164:165], v8 offset:43008
ds_read_b64_tr_b16 a[166:167], v8 offset:43520
ds_read_b64_tr_b16 a[136:137], v8 offset:49152
ds_read_b64_tr_b16 a[138:139], v8 offset:49664
ds_read_b64_tr_b16 a[140:141], v8 offset:51200
ds_read_b64_tr_b16 a[142:143], v8 offset:51712
ds_read_b64_tr_b16 v[40:41], v8 offset:57344
ds_read_b64_tr_b16 v[42:43], v8 offset:57856
ds_read_b64_tr_b16 v[44:45], v8 offset:59392
ds_read_b64_tr_b16 v[46:47], v8 offset:59904
s_waitcnt lgkmcnt(0)
buffer_store_dwordx4 v[16:19], v0, s[4:7], s61 offen offset:0
buffer_store_dwordx4 v[20:23], v0, s[4:7], s61 offen offset:1024
buffer_store_dwordx4 v[40:43], v0, s[4:7], s62 offen offset:0
buffer_store_dwordx4 v[44:47], v0, s[4:7], s62 offen offset:1024
s_waitcnt vmcnt(28)
s_barrier
s_mov_b32 m0, 104448
s_add_u32 s48, s50, 154368
buffer_load_dwordx4 v11, s[20:23], s48 offen lds
s_mov_b32 m0, 105472
s_add_u32 s48, s50, 159488
buffer_load_dwordx4 v11, s[20:23], s48 offen lds
s_mov_b32 m0, 112640
s_add_u32 s48, s50, 93184
buffer_load_dwordx4 v11, s[20:23], s48 offen lds
s_mov_b32 m0, 113664
s_add_u32 s48, s50, 98304
buffer_load_dwordx4 v11, s[20:23], s48 offen lds
s_mov_b32 m0, 120832
s_add_u32 s48, s50, 113664
buffer_load_dwordx4 v11, s[20:23], s48 offen lds
s_mov_b32 m0, 121856
s_add_u32 s48, s50, 118784
buffer_load_dwordx4 v11, s[20:23], s48 offen lds
s_mov_b32 m0, 129024
s_add_u32 s48, s50, 134144
buffer_load_dwordx4 v11, s[20:23], s48 offen lds
s_mov_b32 m0, 130048
s_add_u32 s48, s50, 139264
buffer_load_dwordx4 v11, s[20:23], s48 offen lds
v_xor_b32 v12, v15, v9
ds_read_b64_tr_b16 v[16:17], v12 offset:0
ds_read_b64_tr_b16 v[18:19], v12 offset:512
ds_read_b64_tr_b16 v[20:21], v12 offset:2048
ds_read_b64_tr_b16 v[22:23], v12 offset:2560
ds_read_b64_tr_b16 v[24:25], v9 offset:8192
ds_read_b64_tr_b16 v[26:27], v9 offset:8704
ds_read_b64_tr_b16 v[28:29], v9 offset:10240
ds_read_b64_tr_b16 v[30:31], v9 offset:10752
ds_read_b64_tr_b16 v[208:209], v9 offset:16384
ds_read_b64_tr_b16 v[210:211], v9 offset:16896
ds_read_b64_tr_b16 v[212:213], v9 offset:18432
ds_read_b64_tr_b16 v[214:215], v9 offset:18944
ds_read_b64_tr_b16 v[216:217], v9 offset:24576
ds_read_b64_tr_b16 v[218:219], v9 offset:25088
ds_read_b64_tr_b16 v[220:221], v9 offset:26624
ds_read_b64_tr_b16 v[222:223], v9 offset:27136
s_waitcnt lgkmcnt(0)
buffer_store_dwordx4 v[16:19], v0, s[4:7], s61 offen offset:2048
buffer_store_dwordx4 v[20:23], v0, s[4:7], s61 offen offset:3072
buffer_store_dwordx4 v[24:27], v0, s[4:7], s62 offen offset:2048
buffer_store_dwordx4 v[28:31], v0, s[4:7], s62 offen offset:3072
s_waitcnt vmcnt(38)
s_barrier
s_mov_b32 m0, 137216
s_add_u32 s48, s50, 154624
buffer_load_dwordx4 v11, s[20:23], s48 offen lds
s_mov_b32 m0, 138240
s_add_u32 s48, s50, 159744
buffer_load_dwordx4 v11, s[20:23], s48 offen lds
s_mov_b32 m0, 145408
s_add_u32 s48, s49, 1441792
buffer_load_dwordx4 v10, s[12:15], s48 offen lds
s_mov_b32 m0, 146432
s_add_u32 s48, s49, 1507328
buffer_load_dwordx4 v10, s[12:15], s48 offen lds
s_mov_b32 m0, 153600
s_add_u32 s48, s49, 3538944
buffer_load_dwordx4 v10, s[8:11], s48 offen lds
s_mov_b32 m0, 154624
s_add_u32 s48, s49, 3604480
buffer_load_dwordx4 v10, s[8:11], s48 offen lds
s_mov_b32 m0, 161792
s_add_u32 s48, s49, 3539072
buffer_load_dwordx4 v10, s[8:11], s48 offen lds
s_mov_b32 m0, 162816
s_add_u32 s48, s49, 3604608
buffer_load_dwordx4 v10, s[8:11], s48 offen lds
v_xor_b32 v12, v15, v7
ds_read_b64_tr_b16 v[200:201], v12 offset:0
ds_read_b64_tr_b16 v[202:203], v12 offset:512
ds_read_b64_tr_b16 v[204:205], v12 offset:2048
ds_read_b64_tr_b16 v[206:207], v12 offset:2560
s_waitcnt lgkmcnt(0)
s_waitcnt vmcnt(32)
s_barrier
ds_read_b64_tr_b16 v[16:17], v4 offset:8192
ds_read_b64_tr_b16 v[18:19], v4 offset:9216
ds_read_b64_tr_b16 v[20:21], v4 offset:12288
ds_read_b64_tr_b16 v[22:23], v4 offset:13312
ds_read_b64_tr_b16 v[24:25], v4 offset:16384
ds_read_b64_tr_b16 v[26:27], v4 offset:17408
ds_read_b64_tr_b16 v[28:29], v4 offset:20480
ds_read_b64_tr_b16 v[30:31], v4 offset:21504
ds_read_b64_tr_b16 v[32:33], v4 offset:24576
ds_read_b64_tr_b16 v[34:35], v4 offset:25600
ds_read_b64_tr_b16 v[36:37], v4 offset:28672
ds_read_b64_tr_b16 v[38:39], v4 offset:29696
ds_read_b64_tr_b16 v[40:41], v4 offset:32768
ds_read_b64_tr_b16 v[42:43], v4 offset:33792
ds_read_b64_tr_b16 v[44:45], v4 offset:36864
ds_read_b64_tr_b16 v[46:47], v4 offset:37888
ds_read_b64_tr_b16 v[48:49], v4 offset:40960
ds_read_b64_tr_b16 v[50:51], v4 offset:41984
ds_read_b64_tr_b16 v[52:53], v4 offset:45056
ds_read_b64_tr_b16 v[54:55], v4 offset:46080
ds_read_b64_tr_b16 v[56:57], v4 offset:49152
ds_read_b64_tr_b16 v[58:59], v4 offset:50176
ds_read_b64_tr_b16 v[60:61], v4 offset:53248
ds_read_b64_tr_b16 v[62:63], v4 offset:54272
ds_read_b64_tr_b16 v[64:65], v4 offset:57344
ds_read_b64_tr_b16 v[66:67], v4 offset:58368
ds_read_b64_tr_b16 v[68:69], v4 offset:61440
ds_read_b64_tr_b16 v[70:71], v4 offset:62464
s_waitcnt lgkmcnt(0)
s_barrier
ds_write_b128 v0, v[16:19] offset:51200
ds_write_b128 v0, v[20:23] offset:52224
ds_write_b128 v0, v[24:27] offset:53248
ds_write_b128 v0, v[28:31] offset:54272
ds_write_b128 v0, v[32:35] offset:55296
ds_write_b128 v0, v[36:39] offset:56320
ds_write_b128 v0, v[40:43] offset:57344
ds_write_b128 v0, v[44:47] offset:58368
ds_write_b128 v0, v[48:51] offset:59392
ds_write_b128 v0, v[52:55] offset:60416
ds_write_b128 v0, a[136:139] offset:61440
ds_write_b128 v0, a[140:143] offset:62464
ds_write_b128 v0, a[152:155] offset:63488
ds_write_b128 v0, a[156:159] offset:64512
s_waitcnt lgkmcnt(0)
v_accvgpr_write_b32 a136, v56
v_accvgpr_write_b32 a137, v57
v_accvgpr_write_b32 a138, v58
v_accvgpr_write_b32 a139, v59
v_accvgpr_write_b32 a140, v60
v_accvgpr_write_b32 a141, v61
v_accvgpr_write_b32 a142, v62
v_accvgpr_write_b32 a143, v63
v_accvgpr_write_b32 a152, v64
v_accvgpr_write_b32 a153, v65
v_accvgpr_write_b32 a154, v66
v_accvgpr_write_b32 a155, v67
v_accvgpr_write_b32 a156, v68
v_accvgpr_write_b32 a157, v69
v_accvgpr_write_b32 a158, v70
v_accvgpr_write_b32 a159, v71
s_waitcnt vmcnt(6)
s_barrier
ds_read_b64_tr_b16 v[16:17], v8 offset:24576
ds_read_b64_tr_b16 v[18:19], v8 offset:25088
ds_read_b64_tr_b16 v[20:21], v8 offset:26624
ds_read_b64_tr_b16 v[22:23], v8 offset:27136
v_xor_b32 v12, v15, v8
ds_read_b64_tr_b16 v[24:25], v12 offset:32768
ds_read_b64_tr_b16 v[26:27], v12 offset:33280
ds_read_b64_tr_b16 v[28:29], v12 offset:34816
ds_read_b64_tr_b16 v[30:31], v12 offset:35328
ds_read_b64_tr_b16 v[32:33], v8 offset:40960
ds_read_b64_tr_b16 v[34:35], v8 offset:41472
ds_read_b64_tr_b16 v[36:37], v8 offset:43008
ds_read_b64_tr_b16 v[38:39], v8 offset:43520
ds_read_b64_tr_b16 v[40:41], v8 offset:49152
ds_read_b64_tr_b16 v[42:43], v8 offset:49664
ds_read_b64_tr_b16 v[44:45], v8 offset:51200
ds_read_b64_tr_b16 v[46:47], v8 offset:51712
ds_read_b64_tr_b16 v[48:49], v8 offset:57344
ds_read_b64_tr_b16 v[50:51], v8 offset:57856
ds_read_b64_tr_b16 v[52:53], v8 offset:59392
ds_read_b64_tr_b16 v[54:55], v8 offset:59904
v_xor_b32 v12, v15, v9
ds_read_b64_tr_b16 v[56:57], v12 offset:0
ds_read_b64_tr_b16 v[58:59], v12 offset:512
ds_read_b64_tr_b16 v[60:61], v12 offset:2048
ds_read_b64_tr_b16 v[62:63], v12 offset:2560
s_waitcnt lgkmcnt(0)
s_barrier
ds_write_b128 v2, v[232:235] offset:36864
ds_write_b128 v2, v[236:239] offset:37888
ds_write_b128 v2, v[224:227] offset:38912
ds_write_b128 v2, v[228:231] offset:39936
ds_write_b128 v2, v[32:35] offset:40960
ds_write_b128 v2, v[36:39] offset:41984
ds_write_b128 v2, v[40:43] offset:43008
ds_write_b128 v2, v[44:47] offset:44032
ds_write_b128 v2, v[248:251] offset:45056
ds_write_b128 v2, v[252:255] offset:46080
ds_write_b128 v2, v[240:243] offset:47104
ds_write_b128 v2, v[244:247] offset:48128
s_waitcnt lgkmcnt(0)
v_mov_b32 v232, v16
v_mov_b32 v233, v17
v_mov_b32 v234, v18
v_mov_b32 v235, v19
v_mov_b32 v236, v20
v_mov_b32 v237, v21
v_mov_b32 v238, v22
v_mov_b32 v239, v23
v_mov_b32 v224, v24
v_mov_b32 v225, v25
v_mov_b32 v226, v26
v_mov_b32 v227, v27
v_mov_b32 v228, v28
v_mov_b32 v229, v29
v_mov_b32 v230, v30
v_mov_b32 v231, v31
v_mov_b32 v248, v48
v_mov_b32 v249, v49
v_mov_b32 v250, v50
v_mov_b32 v251, v51
v_mov_b32 v252, v52
v_mov_b32 v253, v53
v_mov_b32 v254, v54
v_mov_b32 v255, v55
v_mov_b32 v240, v56
v_mov_b32 v241, v57
v_mov_b32 v242, v58
v_mov_b32 v243, v59
v_mov_b32 v244, v60
v_mov_b32 v245, v61
v_mov_b32 v246, v62
v_mov_b32 v247, v63
s_waitcnt vmcnt(0)
s_barrier
ds_read_b64_tr_b16 v[16:17], v5 offset:0
ds_read_b64_tr_b16 v[18:19], v5 offset:1024
ds_read_b64_tr_b16 v[20:21], v5 offset:4096
ds_read_b64_tr_b16 v[22:23], v5 offset:5120
ds_read_b64_tr_b16 v[24:25], v8 offset:8192
ds_read_b64_tr_b16 v[26:27], v8 offset:8704
ds_read_b64_tr_b16 v[28:29], v8 offset:10240
ds_read_b64_tr_b16 v[30:31], v8 offset:10752
ds_read_b64_tr_b16 v[32:33], v8 offset:16384
ds_read_b64_tr_b16 v[34:35], v8 offset:16896
ds_read_b64_tr_b16 v[36:37], v8 offset:18432
ds_read_b64_tr_b16 v[38:39], v8 offset:18944
ds_read_b64_tr_b16 v[40:41], v6 offset:8192
ds_read_b64_tr_b16 v[42:43], v6 offset:9216
ds_read_b64_tr_b16 v[44:45], v6 offset:12288
ds_read_b64_tr_b16 v[46:47], v6 offset:13312
ds_read_b64_tr_b16 v[48:49], v6 offset:16384
ds_read_b64_tr_b16 v[50:51], v6 offset:17408
ds_read_b64_tr_b16 v[52:53], v6 offset:20480
ds_read_b64_tr_b16 v[54:55], v6 offset:21504
ds_read_b64_tr_b16 v[56:57], v6 offset:24576
ds_read_b64_tr_b16 v[58:59], v6 offset:25600
ds_read_b64_tr_b16 v[60:61], v6 offset:28672
ds_read_b64_tr_b16 v[62:63], v6 offset:29696
s_waitcnt lgkmcnt(0)
s_barrier
ds_write_b128 v2, v[16:19] offset:12288
ds_write_b128 v2, v[20:23] offset:13312
ds_write_b128 v2, v[24:27] offset:14336
ds_write_b128 v2, v[28:31] offset:15360
ds_write_b128 v2, v[32:35] offset:16384
ds_write_b128 v2, v[36:39] offset:17408
ds_write_b128 v2, v[40:43] offset:18432
ds_write_b128 v2, v[44:47] offset:19456
ds_write_b128 v2, v[48:51] offset:20480
ds_write_b128 v2, v[52:55] offset:21504
ds_write_b128 v2, a[160:163] offset:22528
ds_write_b128 v2, a[164:167] offset:23552
s_waitcnt lgkmcnt(0)
v_accvgpr_write_b32 a160, v56
v_accvgpr_write_b32 a161, v57
v_accvgpr_write_b32 a162, v58
v_accvgpr_write_b32 a163, v59
v_accvgpr_write_b32 a164, v60
v_accvgpr_write_b32 a165, v61
v_accvgpr_write_b32 a166, v62
v_accvgpr_write_b32 a167, v63
s_mov_b32 s90, 0x300003
s_mov_b32 s91, 0x300003
s_mov_b32 s12, 0x3030303
s_mov_b32 s13, 0x3030303
s_mov_b32 s92, 0xc0000c
s_mov_b32 s93, 0xc0000c
s_mov_b32 s14, 0xc0c0c0c
s_mov_b32 s15, 0xc0c0c0c
s_mov_b32 s94, 0x30000300
s_mov_b32 s95, 0x30000300
s_mov_b32 s16, 0x30303030
s_mov_b32 s17, 0x30303030
s_mov_b32 s96, 0xc0000c00
s_mov_b32 s97, 0xc0000c00
s_mov_b32 s18, 0xc0c0c0c0
s_mov_b32 s19, 0xc0c0c0c0
s_mov_b32 s98, 0xff00ff00
s_mov_b32 s99, 0xff00ff00
v_mov_b32 v1, 0x4444
v_mov_b32 v4, 0xeeee
v_cndmask_b32 v1, v1, v4, s[98:99]
v_lshrrev_b32 v4, 8, v0
v_lshl_or_b32 v1, v4, 28, v1
v_bfe_u32 v4, v0, 4, 4
v_lshl_or_b32 v1, v4, 19, v1
s_mov_b32 s51, 0x3e0293ee
s_mov_b32 s52, 0x3f803f80
s_mov_b32 s53, 0x3f803f80
s_mov_b32 s54, 0x3f003f00
s_mov_b32 s55, 0x3f003f00
s_mov_b32 s56, 0xff800000
s_mov_b32 s57, 0xff800000
s_mov_b32 s58, 0x3f80
s_mov_b32 s8, s4
s_mov_b32 s9, s5
s_cmp_lt_u32 s30, 10
s_cselect_b32 s10, s6, 0
s_mov_b32 s31, 0
s_mov_b32 s45, -2
s_lshl_b32 s46, s30, 6
s_add_u32 s46, s46, 222330880
s_mul_i32 s48, s30, 0
s_add_u32 s48, s48, 120389632
s_add_u32 s20, s4, s48
s_addc_u32 s21, s5, 0
s_mov_b32 s22, 512
s_lshl_b32 s48, s30, 7
s_and_b32 s49, s30, 31
s_lshl_b32 s49, s49, 12
s_add_u32 s43, s49, 119537664
v_mov_b64 v[12:13], -1
s_add_u32 s38, s48, 119586816
s_add_u32 s39, s48, 119652352
s_add_u32 s40, s48, 119717888
s_add_u32 s41, s48, 119783424
s_add_u32 s42, s48, 119848960
v_lshrrev_b32 v4, 16, v1
buffer_store_dwordx2 v[12:13], v4, s[4:7], s38 offen
buffer_store_dwordx2 v[12:13], v4, s[4:7], s39 offen
buffer_store_dwordx2 v[12:13], v4, s[4:7], s40 offen
buffer_store_dwordx2 v[12:13], v4, s[4:7], s41 offen
buffer_store_dwordx2 v[12:13], v4, s[4:7], s42 offen
s_cmp_lg_u32 s3, 0
s_cbranch_scc1 k_wdd_174
v_mov_b32 v8, 192
k_wd_173:
global_load_dword v9, v8, s[28:29] sc1
s_waitcnt vmcnt(0)
v_readfirstlane_b32 s48, v9
s_cmp_ge_u32 s48, 32
s_cbranch_scc1 k_wdd_174
s_sleep 2
s_sub_u32 s32, s32, 1
s_cmp_gt_i32 s32, 0
s_cbranch_scc1 k_wd_173
k_wdd_174:
s_barrier
k_lay_175:
s_add_u32 s47, s31, 63
s_mov_b32 s33, 120324096
s_mov_b32 s34, 120329216
s_mov_b32 s35, 120333312
s_mul_i32 s48, s31, 655360
s_lshl_b32 s36, s30, 14
s_add_u32 s36, s36, s48
s_add_u32 s36, s36, 12288
v_mov_b32 v12, -1
s_lshl_b32 s48, s30, 10
s_add_u32 s59, s48, 120324096
s_lshl_b32 s37, s31, 14
s_add_u32 s37, s37, s48
s_add_u32 s37, s37, 117440512
s_waitcnt vmcnt(0)
s_barrier
s_barrier
s_waitcnt vmcnt(0)
s_barrier
s_barrier
v_lshlrev_b32 v3, v0, s58
v_cndmask_b32 v20, 0, v3, s[90:91]
v_cndmask_b32 v21, 0, v3, s[92:93]
v_cndmask_b32 v22, 0, v3, s[94:95]
v_cndmask_b32 v23, 0, v3, s[96:97]
k_fl2_186:
buffer_load_dwordx2 v[46:47], off, s[4:7], s46 sc1
s_waitcnt vmcnt(0)
v_min_u32 v46, v46, v47
v_cmp_lt_u32 vcc, s31, v46
v_mov_b64 v[46:47], 0
s_cbranch_vccnz k_cold2_178
s_sub_u32 s32, s32, 1
s_cmp_gt_i32 s32, 0
s_cbranch_scc1 k_fl2_186
s_branch k_cold2_178
k_T0_176:
s_waitcnt vmcnt(4)
s_waitcnt lgkmcnt(0)
v_smfmac_f32_16x16x64_bf16 v[28:31], v[4:7], v[56:63], v1
ds_read_b128 v[56:59], v0 offset:51200
v_smfmac_f32_16x16x64_bf16 v[32:35], v[4:7], v[64:71], v1
ds_read_b128 v[60:63], v0 offset:52224
v_smfmac_f32_16x16x64_bf16 v[40:43], v[4:7], a[8:15], v1
ds_read_b128 v[64:67], v0 offset:53248
v_smfmac_f32_16x16x64_bf16 v[44:47], v[4:7], a[16:23], v1
ds_read_b128 v[68:71], v0 offset:54272
s_waitcnt vmcnt(3)
v_smfmac_f32_16x16x64_bf16 v[24:27], v[8:11], a[24:31], v1
s_waitcnt lgkmcnt(2)
v_smfmac_f32_16x16x64_bf16 v[28:31], v[8:11], v[56:63], v1
buffer_load_dwordx4 v[56:59], v0, s[4:7], s60 offen offset:2048
v_smfmac_f32_16x16x64_bf16 v[24:27], v[4:7], v[48:55], v1
s_waitcnt lgkmcnt(0)
v_smfmac_f32_16x16x64_bf16 v[32:35], v[8:11], v[64:71], v1
ds_read_b128 v[64:67], v2 offset:12288
s_waitcnt vmcnt(3)
v_smfmac_f32_16x16x64_bf16 v[36:39], v[8:11], a[32:39], v1
ds_read_b128 v[68:71], v2 offset:13312
buffer_load_dwordx4 v[60:63], v0, s[4:7], s60 offen offset:3072
v_smfmac_f32_16x16x64_bf16 v[36:39], v[12:15], a[72:79], v1
ds_write_b128 v0, v[12:15] offset:3072
v_smfmac_f32_16x16x64_bf16 v[36:39], v[4:7], a[0:7], v1
v_smfmac_f32_16x16x64_bf16 v[24:27], v[12:15], a[56:63], v1
buffer_load_dwordx4 v[48:51], v0, s[4:7], s36 offen offset:0 sc1
s_waitcnt vmcnt(4)
v_smfmac_f32_16x16x64_bf16 v[24:27], v[16:19], a[80:87], v1
s_waitcnt lgkmcnt(1)
ds_write_b128 v0, v[16:19] offset:7168
v_smfmac_f32_16x16x64_bf16 v[28:31], v[12:15], v[64:71], v1
ds_read_b128 v[64:67], v0 offset:63488
v_fma_f32 v3, v24, v25, v26
v_smfmac_f32_16x16x64_bf16 v[40:43], v[8:11], a[40:47], v1
buffer_load_dwordx4 v[52:55], v0, s[4:7], s36 offen offset:1024 sc1
v_cmp_u_f32 vcc, v3, v27
v_smfmac_f32_16x16x64_bf16 v[44:47], v[16:19], a[112:119], v1
ds_read_b128 v[68:71], v0 offset:64512
v_smfmac_f32_16x16x64_bf16 v[44:47], v[8:11], a[48:55], v1
s_cbranch_vccnz k_cold_177
k_okC_179:
v_smfmac_f32_16x16x64_bf16 v[36:39], v[16:19], a[96:103], v1
s_waitcnt lgkmcnt(2)
s_barrier
ds_read_b128 v[8:11], v0 offset:1024
v_smfmac_f32_16x16x64_bf16 v[28:31], v[16:19], a[88:95], v1
ds_read_b128 v[4:7], v0 offset:0
s_waitcnt lgkmcnt(2)
v_smfmac_f32_16x16x64_bf16 v[32:35], v[16:19], v[64:71], v1
ds_read_b128 v[64:67], v0 offset:59392
ds_read_b128 v[68:71], v0 offset:60416
v_smfmac_f32_16x16x64_bf16 v[40:43], v[16:19], a[104:111], v1
v_smfmac_f32_16x16x64_bf16 v[32:35], v[12:15], a[64:71], v1
ds_read_b128 v[16:19], v0 offset:4096
s_waitcnt lgkmcnt(4)
v_smfmac_f32_16x16x64_bf16 v[28:31], v[8:11], a[136:143], v1
ds_read_b128 v[12:15], v0 offset:2048
v_smfmac_f32_16x16x64_bf16 v[24:27], v[8:11], a[128:135], v1
ds_read_b128 v[8:11], v0 offset:6144
s_waitcnt lgkmcnt(3)
v_smfmac_f32_16x16x64_bf16 v[28:31], v[4:7], v[64:71], v1
ds_read_b128 v[64:67], v2 offset:20480
s_waitcnt lgkmcnt(3)
v_smfmac_f32_16x16x64_bf16 v[24:27], v[4:7], a[120:127], v1
ds_read_b128 v[68:71], v2 offset:21504
s_waitcnt lgkmcnt(3)
v_smfmac_f32_16x16x64_bf16 v[28:31], v[12:15], a[152:159], v1
ds_read_b128 v[4:7], v0 offset:5120
s_waitcnt vmcnt(2)
v_smfmac_f32_16x16x64_bf16 v[32:35], v[16:19], v[56:63], v1
buffer_load_dwordx4 v[56:59], v0, s[4:7], s36 offen offset:2048 sc1
v_and_b32 v3, 0xffffff7f, v0
v_smfmac_f32_16x16x64_bf16 v[44:47], v[16:19], a[208:215], v1
s_waitcnt lgkmcnt(1)
v_smfmac_f32_16x16x64_bf16 v[24:27], v[16:19], v[64:71], v1
ds_read_b128 v[64:67], v2 offset:36864
v_smfmac_f32_16x16x64_bf16 v[24:27], v[12:15], a[144:151], v1
s_waitcnt lgkmcnt(1)
ds_read_b128 v[68:71], v2 offset:37888
buffer_load_dwordx4 v[60:63], v0, s[4:7], s36 offen offset:3072 sc1
v_smfmac_f32_16x16x64_bf16 v[24:27], v[4:7], a[168:175], v1
s_barrier
v_smfmac_f32_16x16x64_bf16 v[24:27], v[8:11], a[184:191], v1
v_smfmac_f32_16x16x64_bf16 v[28:31], v[16:19], a[160:167], v1
s_waitcnt lgkmcnt(0)
v_smfmac_f32_16x16x64_bf16 v[28:31], v[8:11], v[64:71], v1
ds_read_b128 v[64:67], v2 offset:38912
v_cvt_pk_bf16_f32 v24, v24, v25
v_smfmac_f32_16x16x64_bf16 v[28:31], v[4:7], a[176:183], v1
ds_read_b128 v[68:71], v2 offset:39936
v_cvt_pk_bf16_f32 v25, v26, v27
v_smfmac_f32_16x16x64_bf16 v[36:39], v[16:19], a[192:199], v1
v_smfmac_f32_16x16x64_bf16 v[40:43], v[16:19], a[200:207], v1
v_cvt_pk_bf16_f32 v27, v30, v31
v_smfmac_f32_16x16x64_bf16 v[40:43], v[4:7], a[224:231], v1
ds_read_b128 v[16:19], v0 offset:0
s_waitcnt lgkmcnt(1)
v_smfmac_f32_16x16x64_bf16 v[32:35], v[4:7], v[64:71], v1
ds_read_b128 v[64:67], v2 offset:45056
v_cvt_pk_bf16_f32 v26, v28, v29
v_smfmac_f32_16x16x64_bf16 v[44:47], v[4:7], a[232:239], v1
ds_read_b128 v[68:71], v2 offset:46080
v_and_or_b32 v3, v1, 8, v3
v_mfma_f32_16x16x32_bf16 v[28:31], v[24:27], v[20:23], 0
v_smfmac_f32_16x16x64_bf16 v[36:39], v[4:7], a[216:223], v1
ds_read_b128 v[4:7], v0 offset:1024
v_smfmac_f32_16x16x64_bf16 v[40:43], v[8:11], a[248:255], v1
s_waitcnt lgkmcnt(1)
v_mul_f32 v28, s51, v28
v_smfmac_f32_16x16x64_bf16 v[36:39], v[8:11], v[64:71], v1
ds_read_b128 v[64:67], v2 offset:18432
v_mul_f32 v31, s51, v31
v_mul_f32 v29, s51, v29
v_smfmac_f32_16x16x64_bf16 v[32:35], v[8:11], a[240:247], v1
ds_read_b128 v[68:71], v2 offset:19456
v_mul_f32 v30, s51, v30
v_smfmac_f32_16x16x64_bf16 v[44:47], v[8:11], v[72:79], v1
ds_read_b128 v[8:11], v0 offset:3072
v_cvt_pk_bf16_f32 v24, v28, v29
v_cvt_pk_bf16_f32 v25, v30, v31
v_smfmac_f32_16x16x64_bf16 v[32:35], v[12:15], v[80:87], v1
ds_write_b64 v3, v[24:25] offset:5248
s_waitcnt lgkmcnt(2)
v_smfmac_f32_16x16x64_bf16 v[32:35], v[16:19], v[64:71], v1
ds_read_b128 v[64:67], v2 offset:47104
s_waitcnt lgkmcnt(2)
v_smfmac_f32_16x16x64_bf16 v[32:35], v[4:7], v[104:111], v1
ds_read_b128 v[68:71], v2 offset:48128
v_smfmac_f32_16x16x64_bf16 v[36:39], v[16:19], v[96:103], v1
s_waitcnt lgkmcnt(2)
s_barrier
ds_read_b128 v[24:27], v0 offset:4096
v_smfmac_f32_16x16x64_bf16 v[36:39], v[12:15], v[88:95], v1
ds_read_b128 v[28:31], v0 offset:5120
v_cvt_pk_bf16_f32 v32, v32, v33
v_smfmac_f32_16x16x64_bf16 v[36:39], v[4:7], v[112:119], v1
s_waitcnt lgkmcnt(2)
v_smfmac_f32_16x16x64_bf16 v[44:47], v[16:19], v[64:71], v1
buffer_load_dwordx4 v[64:67], v0, s[4:7], s61 offen offset:0
s_waitcnt vmcnt(3)
s_waitcnt lgkmcnt(1)
v_mfma_f32_16x16x32_bf16 v[48:51], v[48:51], v[24:27], 0
v_cvt_pk_bf16_f32 v33, v34, v35
s_waitcnt lgkmcnt(0)
v_mfma_f32_16x16x32_bf16 v[48:51], v[52:55], v[28:31], v[48:51]
v_cvt_pk_bf16_f32 v35, v38, v39
v_cvt_pk_bf16_f32 v34, v36, v37
v_mov_b64 v[52:53], s[56:57]
s_nop 0
v_mfma_f32_16x16x32_bf16 v[36:39], v[32:35], v[20:23], 0
buffer_load_dwordx4 v[68:71], v0, s[4:7], s61 offen offset:1024
v_permlane32_swap_b32 v49, v51
v_permlane32_swap_b32 v48, v50
v_add_f32_dpp v53, v51, v49 row_ror:8 row_mask:0xf bank_mask:0x3
v_exp_f32 v53, v53
v_add_f32_dpp v52, v50, v48 row_ror:8 row_mask:0xf bank_mask:0x3
v_exp_f32 v52, v52
v_cvt_pk_bf16_f32 v32, v36, v37
v_cvt_pk_bf16_f32 v33, v38, v39
v_smfmac_f32_16x16x64_bf16 v[40:43], v[16:19], v[120:127], v1
ds_write_b64 v3, v[32:33] offset:7296
v_cvt_pk_bf16_f32 v48, v52, v53
v_smfmac_f32_16x16x64_bf16 v[40:43], v[8:11], v[160:167], v1
ds_write_b32 v0, v48 offset:12
v_smfmac_f32_16x16x64_bf16 v[44:47], v[4:7], v[152:159], v1
buffer_load_dwordx4 v[48:51], v0, s[4:7], s61 offen offset:2048
v_mov_b64 v[20:21], s[52:53]
v_smfmac_f32_16x16x64_bf16 v[40:43], v[12:15], v[128:135], v1
s_waitcnt lgkmcnt(1)
v_mov_b64 v[22:23], s[52:53]
v_smfmac_f32_16x16x64_bf16 v[40:43], v[4:7], v[144:151], v1
s_waitcnt lgkmcnt(0)
s_barrier
ds_read_b128 v[32:35], v0 offset:6144
v_smfmac_f32_16x16x64_bf16 v[44:47], v[12:15], v[136:143], v1
ds_read_b128 v[36:39], v0 offset:7168
ds_read_b128 v[16:19], v0 offset:0
buffer_load_dwordx4 v[52:55], v0, s[4:7], s61 offen offset:3072
v_xor_b32 v12, 0x80, v0
v_cvt_pk_bf16_f32 v40, v40, v41
v_cvt_pk_bf16_f32 v41, v42, v43
v_smfmac_f32_16x16x64_bf16 v[44:47], v[8:11], v[168:175], v1
ds_read_b128 v[12:15], v12 offset:0
s_waitcnt lgkmcnt(3)
v_mfma_f32_16x16x32_bf16 v[24:27], v[32:35], v[24:27], 0
s_waitcnt lgkmcnt(2)
v_mfma_f32_16x16x32_bf16 v[24:27], v[36:39], v[28:31], v[24:27]
v_cvt_pk_bf16_f32 v42, v44, v45
s_waitcnt lgkmcnt(1)
s_waitcnt vmcnt(4)
v_mfma_f32_16x16x32_bf16 v[8:11], v[56:59], v[16:19], 0
buffer_load_dwordx4 v[56:59], v0, s[4:7], s62 offen offset:0
v_mov_b64 v[28:29], s[56:57]
v_permlane32_swap_b32 v24, v26
v_permlane32_swap_b32 v25, v27
v_add_f32_dpp v28, v26, v24 row_ror:8 row_mask:0xf bank_mask:0x3
v_mfma_f32_16x16x32_bf16 v[4:7], v[20:23], v[16:19], 0
s_waitcnt lgkmcnt(0)
v_add_f32_dpp v29, v27, v25 row_ror:8 row_mask:0xf bank_mask:0x3
v_exp_f32 v29, v29
v_mov_b64 v[44:45], s[54:55]
v_exp_f32 v28, v28
v_mfma_f32_16x16x32_bf16 v[8:11], v[60:63], v[12:15], v[8:11]
buffer_load_dwordx4 v[60:63], v0, s[4:7], s62 offen offset:1024
v_cvt_pk_bf16_f32 v24, v28, v29
v_cvt_pk_bf16_f32 v43, v46, v47
v_cvt_pk_bf16_f32 v25, v28, v29
v_permlane32_swap_b32 v40, v41
v_mov_b32_dpp v26, v24 row_ror:8 row_mask:0xf bank_mask:0xf
v_mfma_f32_16x16x16_bf16 v[4:7], v[44:45], v[24:25], v[4:7]
v_mov_b32_dpp v27, v24 row_ror:8 row_mask:0xf bank_mask:0xf
v_permlane32_swap_b32 v42, v43
v_mov_b64 v[28:29], 0
v_mov_b64 v[34:35], 0
v_mfma_f32_16x16x32_bf16 v[8:11], v[40:43], v[24:27], v[8:11]
buffer_load_dwordx4 v[16:19], v0, s[4:7], s62 offen offset:2048
v_rcp_f32 v6, v4
v_mov_b64 v[32:33], 0
s_nop 0
v_rcp_f32_dpp v6, v4 row_ror:8 row_mask:0xf bank_mask:0xc
v_mov_b64 v[26:27], 0
v_pk_mul_f32 v[8:9], v[8:9], v[6:7] op_sel_hi:[1,0]
v_pk_mul_f32 v[10:11], v[10:11], v[6:7] op_sel_hi:[1,0]
v_add_u32 v6, 0xd4800000, v6
v_mov_b64 v[24:25], 0
v_cvt_pk_bf16_f32 v45, v10, v11
v_cvt_pk_bf16_f32 v44, v8, v9
s_waitcnt vmcnt(5)
buffer_load_dwordx4 v[20:23], v0, s[4:7], s62 offen offset:3072
ds_write_b64 v3, v[44:45] offset:3200
v_cmp_lt_u32 vcc, 0x28000000, v6
v_mov_b32_dpp v46, v44 row_ror:8 row_mask:0xf bank_mask:0xf
v_and_b32 v3, -9, v3
v_mov_b32_dpp v47, v45 row_ror:8 row_mask:0xf bank_mask:0xf
v_mov_b64 v[30:31], 0
s_cbranch_vccnz k_slow_180
k_okS_181:
v_mov_b64 v[38:39], 0
v_mov_b64 v[36:37], 0
v_smfmac_f32_16x16x64_bf16 v[32:35], v[44:47], v[200:207], v1
s_waitcnt lgkmcnt(0)
s_barrier
ds_read_b128 v[12:15], v3 offset:3072
v_mov_b64 v[40:41], 0
v_smfmac_f32_16x16x64_bf16 v[36:39], v[44:47], v[224:231], v1
s_waitcnt vmcnt(4)
ds_read_b128 v[4:7], v3 offset:2048
ds_read_b128 v[8:11], v3 offset:2176
v_smfmac_f32_16x16x64_bf16 v[28:31], v[44:47], v[48:55], v1
v_mov_b64 v[42:43], 0
v_smfmac_f32_16x16x64_bf16 v[24:27], v[44:47], v[64:71], v1
ds_read_b128 v[64:67], v2 offset:22528
ds_read_b128 v[68:71], v2 offset:23552
v_smfmac_f32_16x16x64_bf16 v[40:43], v[44:47], v[240:247], v1
v_mov_b32 v45, -1
s_waitcnt lgkmcnt(4)
ds_read_b128 v[48:51], v0 offset:61440
v_smfmac_f32_16x16x64_bf16 v[24:27], v[12:15], v[192:199], v1
s_waitcnt lgkmcnt(3)
v_smfmac_f32_16x16x64_bf16 v[24:27], v[4:7], v[176:183], v1
ds_read_b128 v[52:55], v0 offset:62464
v_smfmac_f32_16x16x64_bf16 v[24:27], v[8:11], v[184:191], v1
v_smfmac_f32_16x16x64_bf16 v[36:39], v[12:15], v[232:239], v1
buffer_load_dword v45, v0, s[20:23], 0 offen sc1
s_waitcnt lgkmcnt(2)
s_waitcnt vmcnt(3)
v_lshrrev_b32 v44, 16, v1
v_cvt_pk_bf16_f32 v24, v24, v25
v_bfi_b32 v24, 1, s45, v24
v_smfmac_f32_16x16x64_bf16 v[28:31], v[12:15], v[56:63], v1
ds_read_b128 v[56:59], v2 offset:40960
v_cvt_pk_bf16_f32 v25, v26, v27
v_smfmac_f32_16x16x64_bf16 v[28:31], v[4:7], v[64:71], v1
buffer_load_dword v45, v0, s[20:23], 0 offen sc1
s_waitcnt lgkmcnt(1)
buffer_store_dwordx2 v[24:25], v44, s[4:7], s38 offen
ds_read_b128 v[64:67], v2 offset:14336
v_smfmac_f32_16x16x64_bf16 v[28:31], v[8:11], v[48:55], v1
ds_read_b128 v[68:71], v2 offset:15360
ds_read_b128 v[48:51], v2 offset:16384
ds_read_b128 v[52:55], v2 offset:17408
v_smfmac_f32_16x16x64_bf16 v[32:35], v[12:15], v[216:223], v1
v_cvt_pk_bf16_f32 v28, v28, v29
v_cvt_pk_bf16_f32 v29, v30, v31
v_bfi_b32 v28, 1, s45, v28
v_smfmac_f32_16x16x64_bf16 v[32:35], v[8:11], v[208:215], v1
buffer_load_dword v45, v0, s[20:23], 0 offen sc1
buffer_store_dwordx2 v[28:29], v44, s[4:7], s39 offen
ds_read_b128 v[60:63], v2 offset:41984
s_waitcnt vmcnt(5)
v_smfmac_f32_16x16x64_bf16 v[32:35], v[4:7], v[16:23], v1
buffer_load_dword v45, v0, s[20:23], 0 offen sc1
s_waitcnt lgkmcnt(3)
ds_read_b128 v[16:19], v2 offset:43008
v_smfmac_f32_16x16x64_bf16 v[36:39], v[4:7], v[64:71], v1
ds_read_b128 v[20:23], v2 offset:44032
s_waitcnt lgkmcnt(3)
v_cvt_pk_bf16_f32 v32, v32, v33
v_cvt_pk_bf16_f32 v33, v34, v35
v_bfi_b32 v32, 1, s45, v32
v_smfmac_f32_16x16x64_bf16 v[36:39], v[8:11], v[48:55], v1
buffer_load_dword v45, v0, s[20:23], 0 offen sc1
s_waitcnt lgkmcnt(2)
buffer_store_dwordx2 v[32:33], v44, s[4:7], s40 offen
v_smfmac_f32_16x16x64_bf16 v[40:43], v[12:15], v[248:255], v1
v_cvt_pk_bf16_f32 v36, v36, v37
v_cvt_pk_bf16_f32 v37, v38, v39
v_bfi_b32 v36, 1, s45, v36
s_waitcnt lgkmcnt(0)
v_smfmac_f32_16x16x64_bf16 v[40:43], v[8:11], v[16:23], v1
buffer_store_dwordx2 v[36:37], v44, s[4:7], s41 offen
v_cmp_lt_u32 vcc, s45, v45
v_smfmac_f32_16x16x64_bf16 v[40:43], v[4:7], v[56:63], v1
s_nop 6
v_cvt_pk_bf16_f32 v40, v40, v41
v_cvt_pk_bf16_f32 v41, v42, v43
v_bfi_b32 v40, 1, s45, v40
buffer_store_dwordx2 v[40:41], v44, s[4:7], s42 offen
s_cbranch_vccnz k_gs_188
k_okG_189:
s_barrier
v_mov_b64 v[32:33], -1
v_mov_b64 v[34:35], -1
s_xor_b32 s48, s59, 0x8000
v_lshlrev_b32 v3, v0, s58
v_cndmask_b32 v20, 0, v3, s[90:91]
v_cndmask_b32 v21, 0, v3, s[92:93]
v_cndmask_b32 v22, 0, v3, s[94:95]
v_cndmask_b32 v23, 0, v3, s[96:97]
s_add_u32 s33, s33, 16384
s_bitset0_b32 s33, 16
s_add_u32 s34, s33, 5120
s_add_u32 s35, s33, 9216
s_add_u32 s36, s36, 524288
s_add_u32 s31, s31, 1
s_buffer_load_dwordx2 s[66:67], s[4:7], s46 glc
v_mov_b64 v[24:25], 0
v_mov_b64 v[26:27], 0
v_mov_b64 v[28:29], 0
v_mov_b64 v[30:31], 0
buffer_store_dwordx4 v[32:35], v0, s[8:11], s48 offen
buffer_load_dwordx4 v[36:39], v0, s[8:11], s59 offen sc1
s_add_u32 s59, s59, 16384
s_bitset0_b32 s59, 16
ds_read_b128 v[56:59], v0 offset:55296
ds_read_b128 v[60:63], v0 offset:56320
ds_read_b128 v[64:67], v0 offset:57344
ds_read_b128 v[68:71], v0 offset:58368
buffer_load_dwordx4 v[48:51], v0, s[4:7], s60 offen offset:0
buffer_load_dwordx4 v[52:55], v0, s[4:7], s60 offen offset:1024
s_barrier
v_mov_b64 v[32:33], 0
v_mov_b64 v[34:35], 0
v_mov_b64 v[40:41], 0
v_mov_b64 v[42:43], 0
s_waitcnt vmcnt(4)
v_mov_b64 v[44:45], 0
v_mov_b64 v[46:47], 0
buffer_load_dwordx4 v[4:7], v0, s[4:7], s33 offen offset:1024 sc1
buffer_load_dwordx4 v[8:11], v0, s[4:7], s33 offen offset:0 sc1
s_sub_u32 s45, s45, 1
s_waitcnt lgkmcnt(0)
buffer_load_dwordx4 v[12:15], v0, s[4:7], s34 offen offset:0 sc1
s_min_u32 s66, s66, s67
s_cmp_gt_u32 s66, s31
s_cbranch_scc0 k_fl_185
k_okF_187:
buffer_load_dwordx4 v[16:19], v0, s[4:7], s35 offen offset:0 sc1
s_barrier
s_waitcnt vmcnt(6)
buffer_store_dwordx4 v[36:39], v0, s[8:11], s37 offen sc1
s_add_u32 s37, s37, 10240
s_nop 0
v_mov_b64 v[36:37], 0
v_mov_b64 v[38:39], 0
s_cmp_lg_u32 s31, s47
s_cbranch_scc1 k_T0_176
s_branch k_done_182
k_cold_177:
s_sub_u32 s32, s32, 1
s_cmp_gt_i32 s32, 0
s_cbranch_scc0 k_okC_179
k_cold2_178:
s_waitcnt lgkmcnt(0)
buffer_load_dwordx4 v[4:7], v0, s[4:7], s33 offen offset:1024 sc1
buffer_load_dwordx4 v[8:11], v0, s[4:7], s33 offen offset:0 sc1
buffer_load_dwordx4 v[12:15], v0, s[4:7], s34 offen offset:0 sc1
buffer_load_dwordx4 v[16:19], v0, s[4:7], s35 offen offset:0 sc1
buffer_load_dwordx4 v[48:51], v0, s[4:7], s60 offen offset:0
buffer_load_dwordx4 v[52:55], v0, s[4:7], s60 offen offset:1024
s_waitcnt vmcnt(9)
ds_read_b128 v[56:59], v0 offset:55296
s_waitcnt vmcnt(8)
ds_read_b128 v[60:63], v0 offset:56320
ds_read_b128 v[64:67], v0 offset:57344
ds_read_b128 v[68:71], v0 offset:58368
v_mov_b64 v[24:25], 0
v_mov_b64 v[26:27], 0
v_mov_b64 v[28:29], 0
v_mov_b64 v[30:31], 0
v_mov_b64 v[32:33], 0
v_mov_b64 v[34:35], 0
v_mov_b64 v[36:37], 0
v_mov_b64 v[38:39], 0
v_mov_b64 v[40:41], 0
v_mov_b64 v[42:43], 0
v_mov_b64 v[44:45], 0
v_mov_b64 v[46:47], 0
s_waitcnt vmcnt(0)
s_branch k_T0_176
k_fl_185:
buffer_load_dwordx2 v[46:47], off, s[4:7], s46 sc1
s_waitcnt vmcnt(0)
v_min_u32 v46, v46, v47
v_cmp_lt_u32 vcc, s31, v46
v_mov_b64 v[46:47], 0
s_cbranch_vccnz k_okF_187
s_sub_u32 s32, s32, 1
s_cmp_gt_i32 s32, 0
s_cbranch_scc1 k_fl_185
s_branch k_okF_187
k_gs_188:
v_cmp_lt_u32 vcc, s45, v45
buffer_load_dword v45, v0, s[20:23], 0 offen sc1
s_sub_u32 s32, s32, 1
s_cmp_gt_i32 s32, 0
s_cbranch_vccz k_okG_189
s_cbranch_scc1 k_gs_188
s_branch k_okG_189
k_slow_180:
ds_read_b128 v[24:27], v0 offset:4096
ds_read_b128 v[28:31], v0 offset:5120
v_mov_b32 v46, 0xff7fffff
s_add_u32 s48, s36, 0xffffd000
buffer_load_dwordx4 v[32:35], v0, s[4:7], s48 offen offset:0 sc1
buffer_load_dwordx4 v[36:39], v0, s[4:7], s48 offen offset:1024 sc1
s_waitcnt vmcnt(1) lgkmcnt(1)
v_mfma_f32_16x16x32_bf16 v[4:7], v[32:35], v[24:27], 0
s_waitcnt vmcnt(0) lgkmcnt(0)
v_mfma_f32_16x16x32_bf16 v[4:7], v[36:39], v[28:31], v[4:7]
v_mov_b64 v[8:9], s[56:57]
s_nop 5
v_permlane32_swap_b32 v4, v6
v_permlane32_swap_b32 v5, v7
v_add_f32_dpp v8, v6, v4 row_ror:8 row_mask:0xf bank_mask:0x3
s_nop 0
v_add_f32_dpp v9, v7, v5 row_ror:8 row_mask:0xf bank_mask:0x3
v_max3_f32 v46, v46, v8, v9
s_add_u32 s48, s36, 0xffffe000
buffer_load_dwordx4 v[32:35], v0, s[4:7], s48 offen offset:0 sc1
buffer_load_dwordx4 v[36:39], v0, s[4:7], s48 offen offset:1024 sc1
s_waitcnt vmcnt(1)
v_mfma_f32_16x16x32_bf16 v[4:7], v[32:35], v[24:27], 0
s_waitcnt vmcnt(0)
v_mfma_f32_16x16x32_bf16 v[4:7], v[36:39], v[28:31], v[4:7]
v_mov_b64 v[10:11], s[56:57]
s_nop 5
v_permlane32_swap_b32 v4, v6
v_permlane32_swap_b32 v5, v7
v_add_f32_dpp v10, v6, v4 row_ror:8 row_mask:0xf bank_mask:0x3
s_nop 0
v_add_f32_dpp v11, v7, v5 row_ror:8 row_mask:0xf bank_mask:0x3
v_max3_f32 v46, v46, v10, v11
s_add_u32 s48, s36, 0xfffff000
buffer_load_dwordx4 v[32:35], v0, s[4:7], s48 offen offset:0 sc1
buffer_load_dwordx4 v[36:39], v0, s[4:7], s48 offen offset:1024 sc1
s_waitcnt vmcnt(1)
v_mfma_f32_16x16x32_bf16 v[4:7], v[32:35], v[24:27], 0
s_waitcnt vmcnt(0)
v_mfma_f32_16x16x32_bf16 v[4:7], v[36:39], v[28:31], v[4:7]
v_mov_b64 v[12:13], s[56:57]
s_nop 5
v_permlane32_swap_b32 v4, v6
v_permlane32_swap_b32 v5, v7
v_add_f32_dpp v12, v6, v4 row_ror:8 row_mask:0xf bank_mask:0x3
s_nop 0
v_add_f32_dpp v13, v7, v5 row_ror:8 row_mask:0xf bank_mask:0x3
v_max3_f32 v46, v46, v12, v13
s_add_u32 s48, s36, 0x0
buffer_load_dwordx4 v[32:35], v0, s[4:7], s48 offen offset:0 sc1
buffer_load_dwordx4 v[36:39], v0, s[4:7], s48 offen offset:1024 sc1
s_waitcnt vmcnt(1)
v_mfma_f32_16x16x32_bf16 v[4:7], v[32:35], v[24:27], 0
s_waitcnt vmcnt(0)
v_mfma_f32_16x16x32_bf16 v[4:7], v[36:39], v[28:31], v[4:7]
v_mov_b64 v[14:15], s[56:57]
s_nop 5
v_permlane32_swap_b32 v4, v6
v_permlane32_swap_b32 v5, v7
v_add_f32_dpp v14, v6, v4 row_ror:8 row_mask:0xf bank_mask:0x3
s_nop 0
v_add_f32_dpp v15, v7, v5 row_ror:8 row_mask:0xf bank_mask:0x3
v_max3_f32 v46, v46, v14, v15
ds_read_b128 v[32:35], v0 offset:6144
ds_read_b128 v[36:39], v0 offset:7168
s_waitcnt lgkmcnt(1)
v_mfma_f32_16x16x32_bf16 v[4:7], v[32:35], v[24:27], 0
s_waitcnt lgkmcnt(0)
v_mfma_f32_16x16x32_bf16 v[4:7], v[36:39], v[28:31], v[4:7]
v_mov_b64 v[44:45], s[56:57]
s_nop 5
v_permlane32_swap_b32 v4, v6
v_permlane32_swap_b32 v5, v7
v_add_f32_dpp v44, v6, v4 row_ror:8 row_mask:0xf bank_mask:0x3
s_nop 0
v_add_f32_dpp v45, v7, v5 row_ror:8 row_mask:0xf bank_mask:0x3
v_max3_f32 v46, v46, v44, v45
buffer_load_dwordx4 v[32:35], v0, s[4:7], s36 offen offset:2048 sc1
buffer_load_dwordx4 v[36:39], v0, s[4:7], s36 offen offset:3072 sc1
v_mov_b32 v47, v46
s_nop 1
v_permlane32_swap_b32 v46, v47
v_max_f32 v46, v46, v47
v_mov_b32 v47, v46
s_nop 1
v_permlane16_swap_b32 v46, v47
v_max_f32 v46, v46, v47
v_sub_f32 v8, v8, v46
v_exp_f32 v8, v8
v_sub_f32 v9, v9, v46
v_exp_f32 v9, v9
v_sub_f32 v10, v10, v46
v_exp_f32 v10, v10
v_sub_f32 v11, v11, v46
v_exp_f32 v11, v11
v_sub_f32 v12, v12, v46
v_exp_f32 v12, v12
v_sub_f32 v13, v13, v46
v_exp_f32 v13, v13
v_sub_f32 v14, v14, v46
v_exp_f32 v14, v14
v_sub_f32 v15, v15, v46
v_exp_f32 v15, v15
v_sub_f32 v44, v44, v46
v_exp_f32 v44, v44
v_sub_f32 v45, v45, v46
v_exp_f32 v45, v45
v_cvt_pk_bf16_f32 v4, v8, v9
v_cvt_pk_bf16_f32 v5, v10, v11
v_cvt_pk_bf16_f32 v6, v12, v13
v_cvt_pk_bf16_f32 v7, v14, v15
v_mov_b32_dpp v8, v4 row_ror:8 row_mask:0xf bank_mask:0xf
v_mov_b32_dpp v9, v5 row_ror:8 row_mask:0xf bank_mask:0xf
v_mov_b32_dpp v10, v6 row_ror:8 row_mask:0xf bank_mask:0xf
v_mov_b32_dpp v11, v7 row_ror:8 row_mask:0xf bank_mask:0xf
v_cvt_pk_bf16_f32 v24, v44, v45
v_cvt_pk_bf16_f32 v25, v44, v45
s_nop 0
v_mov_b32_dpp v26, v24 row_ror:8 row_mask:0xf bank_mask:0xf
v_mov_b32_dpp v27, v24 row_ror:8 row_mask:0xf bank_mask:0xf
v_mov_b64 v[28:29], s[52:53]
v_mov_b64 v[30:31], s[52:53]
s_nop 1
v_mfma_f32_16x16x32_bf16 v[44:47], v[28:31], v[4:7], 0
s_waitcnt vmcnt(1)
v_mfma_f32_16x16x32_bf16 v[12:15], v[32:35], v[4:7], 0
s_waitcnt vmcnt(0)
v_mfma_f32_16x16x32_bf16 v[12:15], v[36:39], v[8:11], v[12:15]
v_mfma_f32_16x16x32_bf16 v[12:15], v[40:43], v[24:27], v[12:15]
v_mov_b64 v[28:29], s[54:55]
s_nop 1
v_mfma_f32_16x16x16_bf16 v[44:47], v[28:29], v[24:25], v[44:47]
s_nop 6
v_rcp_f32 v4, v44
s_nop 1
v_rcp_f32_dpp v4, v44 row_ror:8 row_mask:0xf bank_mask:0xc
s_nop 0
v_mul_f32 v12, v4, v12
v_mul_f32 v13, v4, v13
v_mul_f32 v14, v4, v14
v_mul_f32 v15, v4, v15
v_cvt_pk_bf16_f32 v44, v12, v13
v_cvt_pk_bf16_f32 v45, v14, v15
v_and_or_b32 v8, v1, 8, v3
ds_write_b64 v8, v[44:45] offset:3200
v_mov_b32_dpp v46, v44 row_ror:8 row_mask:0xf bank_mask:0xf
v_mov_b32_dpp v47, v45 row_ror:8 row_mask:0xf bank_mask:0xf
v_mov_b64 v[24:25], 0
v_mov_b64 v[26:27], 0
v_mov_b64 v[28:29], 0
v_mov_b64 v[30:31], 0
v_mov_b64 v[32:33], 0
v_mov_b64 v[34:35], 0
v_mov_b64 v[36:37], 0
v_mov_b64 v[38:39], 0
s_waitcnt lgkmcnt(0)
s_branch k_okS_181
k_done_182:
k_xs_190:
buffer_load_dwordx4 v[36:39], v0, s[8:11], s59 offen sc1
s_sub_u32 s32, s32, 1
s_cmp_gt_i32 s32, 0
s_waitcnt vmcnt(0)
v_max3_u32 v32, v36, v37, v38
v_cmp_u_f32 vcc, v32, v39
s_cbranch_vccz k_xd_191
s_cbranch_scc1 k_xs_190
k_xd_191:
buffer_store_dwordx4 v[36:39], v0, s[8:11], s37 offen sc1
s_add_u32 s37, s37, 10240
s_add_u32 s31, s31, 1
s_cmp_lt_u32 s31, 128
s_cbranch_scc1 k_lay_175
s_add_u32 s30, s30, 112
s_waitcnt vmcnt(0) lgkmcnt(0)
s_barrier
s_branch k_fin_7
.section .rodata,"a"
.p2align 6
.amdhsa_kernel interleave_layers__memory_aug_recurrent_mem_tr__spectral_gfnet__prompt_kernel
  .amdhsa_next_free_vgpr 512
  .amdhsa_next_free_sgpr 102
  .amdhsa_accum_offset 256
  .amdhsa_group_segment_fixed_size 0
  .amdhsa_kernarg_size 104
  .amdhsa_user_sgpr_count 2
  .amdhsa_user_sgpr_kernarg_segment_ptr 1
  .amdhsa_system_sgpr_workgroup_id_x 1
  .amdhsa_float_denorm_mode_32 3
.end_amdhsa_kernel
```

```asm
; @launch grid=(256,1,1) block=(256,1,1) lds=163840
.amdgcn_target "amdgcn-amd-amdhsa--gfx950"
.text
.globl interleave_layers__memory_aug_recurrent_mem_tr__spectral_gfnet__prompt_kernel
.p2align 8
.type interleave_layers__memory_aug_recurrent_mem_tr__spectral_gfnet__prompt_kernel,@function
interleave_layers__memory_aug_recurrent_mem_tr__spectral_gfnet__prompt_kernel:
s_load_dwordx2 s[72:73], s[0:1], 8
s_load_dwordx4 s[76:79], s[0:1], 16
s_load_dwordx4 s[80:83], s[0:1], 32
s_load_dwordx2 s[28:29], s[0:1], 88
s_load_dwordx2 s[74:75], s[0:1], 96
v_lshrrev_b32 v1, 6, v0
v_and_b32 v0, 63, v0
v_readfirstlane_b32 s3, v1
s_waitcnt lgkmcnt(0)
s_mov_b32 s4, s74
s_mov_b32 s5, s75
s_mov_b32 s6, 268435456
s_mov_b32 s7, 0x20000
s_mov_b32 s8, s76
s_mov_b32 s9, s77
s_mov_b32 s10, 5242880
s_mov_b32 s11, 0x20000
s_mov_b32 s12, s78
s_mov_b32 s13, s79
s_mov_b32 s14, 5242880
s_mov_b32 s15, 0x20000
s_mov_b32 s16, s80
s_mov_b32 s17, s81
s_mov_b32 s18, 5242880
s_mov_b32 s19, 0x20000
s_mov_b32 s20, s82
s_mov_b32 s21, s83
s_mov_b32 s22, 5242880
s_mov_b32 s23, 0x20000
s_mov_b32 s24, s72
s_mov_b32 s25, s73
s_mov_b32 s26, 10240
s_mov_b32 s27, 0x20000
s_mov_b32 s32, 400000
s_getreg_b32 s52, hwreg(HW_REG_XCC_ID, 0, 4)
s_cmp_lg_u32 s3, 0
s_cbranch_scc1 k_skip_1
s_mov_b64 exec, 1
s_lshl_b32 s53, s52, 2
v_mov_b32 v1, s53
v_mov_b32 v2, 1
global_atomic_add v3, v1, v2, s[28:29] sc0 sc1
v_mov_b32 v1, 0
s_waitcnt vmcnt(0)
ds_write_b32 v1, v3
s_mov_b64 exec, -1
s_waitcnt lgkmcnt(0)
k_skip_1:
s_barrier
v_mov_b32 v1, 0
ds_read_b32 v2, v1
s_waitcnt lgkmcnt(0)
v_readfirstlane_b32 s30, v2
s_barrier
s_cmp_gt_u32 s30, 31
s_cbranch_scc1 k_end_2
s_cmp_eq_u32 s52, 0
s_cbranch_scc1 k_team_3
v_lshlrev_b32 v0, 4, v0
s_cmp_gt_u32 s52, 7
s_cbranch_scc1 k_end_2
s_cmp_gt_u32 s30, 29
s_cbranch_scc1 k_end_2
s_cmp_gt_u32 s52, 4
s_cbranch_scc1 k_nb_8
s_mul_i32 s53, s52, 20
s_add_u32 s53, s53, s30
s_sub_u32 s53, s53, 20
s_cmp_lt_u32 s30, 20
s_cmov_b32 s30, s53
s_cbranch_scc1 k_o_4
s_mul_i32 s53, s52, 10
s_add_u32 s30, s30, s53
s_sub_u32 s30, s30, 30
s_cmp_lt_u32 s30, 32
s_cbranch_scc1 k_at_5
s_sub_u32 s30, s30, 32
s_branch k_p_6
k_nb_8:
s_mul_i32 s53, s52, 30
s_add_u32 s30, s30, s53
s_sub_u32 s30, s30, 142
s_cmp_lt_u32 s30, 96
s_cbranch_scc1 k_p_6
k_end_2:
s_endpgm
k_at_5:
s_lshl_b32 s52, s30, 2
s_add_u32 s52, s52, s3
s_lshl_b32 s52, s52, 9
s_add_u32 s52, s52, 222298112
v_mov_b64 v[2:3], 0
v_lshrrev_b32 v1, 1, v0
buffer_store_dwordx2 v[2:3], v1, s[4:7], s52 offen sc1
s_lshl_b32 s47, s30, 2
s_add_u32 s47, s47, s3
v_bfe_u32 v6, v0, 4, 5
v_lshrrev_b32 v2, 9, v0
v_bfe_u32 v8, v6, 2, 1
s_mov_b32 s56, 0x3acccccd
v_bfe_u32 v9, v6, 3, 1
v_and_b32 v1, 0x13, v6
v_lshl_add_u32 v1, v8, 3, v1
v_lshl_add_u32 v1, v9, 2, v1
k_gt_9:
s_mul_i32 s52, s47, 1639
s_lshr_b32 s52, s52, 16
s_mul_i32 s53, s52, 40
s_sub_u32 s53, s47, s53
s_lshl_b32 s52, s52, 5
s_lshl_b32 s53, s53, 1
v_add_u32 v3, s52, v1
v_add_u32 v6, s53, v2
v_and_b32 v4, 1, v3
v_cvt_f32_u32 v4, v4
v_mul_f32 v4, 0.5, v4
v_mul_f32 v4, 0.5, v4
v_cmp_gt_u32 vcc, 2, v3
s_nop 1
v_cndmask_b32 v4, v4, 0, vcc
v_mov_b32 v5, 0x3d64f92e
v_mov_b32 v8, 0x3d21e89b
v_cndmask_b32 v5, v5, v8, vcc
v_cmp_eq_u32 vcc, 0, v3
v_lshrrev_b32 v3, 1, v3
v_mov_b32 v8, 320
v_cndmask_b32 v3, v3, v8, vcc
v_lshlrev_b32 v6, 3, v6
v_mul_u32_u24 v6, v6, v3
v_cvt_f32_u32 v6, v6
v_cvt_f32_u32 v3, v3
v_fma_f32 v8, v6, s56, v4
v_add_f32 v6, v6, v3
v_fract_f32 v8, v8
v_cos_f32 v8, v8
v_fma_f32 v9, v6, s56, v4
v_add_f32 v6, v6, v3
v_fract_f32 v9, v9
v_cos_f32 v9, v9
v_fma_f32 v10, v6, s56, v4
v_add_f32 v6, v6, v3
v_fract_f32 v10, v10
v_cos_f32 v10, v10
v_fma_f32 v11, v6, s56, v4
v_add_f32 v6, v6, v3
v_fract_f32 v11, v11
v_cos_f32 v11, v11
v_fma_f32 v12, v6, s56, v4
v_add_f32 v6, v6, v3
v_fract_f32 v12, v12
v_cos_f32 v12, v12
v_fma_f32 v13, v6, s56, v4
v_add_f32 v6, v6, v3
v_fract_f32 v13, v13
v_cos_f32 v13, v13
v_fma_f32 v14, v6, s56, v4
v_add_f32 v6, v6, v3
v_fract_f32 v14, v14
v_cos_f32 v14, v14
v_fma_f32 v15, v6, s56, v4
v_add_f32 v6, v6, v3
v_fract_f32 v15, v15
v_cos_f32 v15, v15
v_mul_f32 v8, v5, v8
v_mul_f32 v9, v5, v9
v_mul_f32 v10, v5, v10
v_mul_f32 v11, v5, v11
v_mul_f32 v12, v5, v12
v_mul_f32 v13, v5, v13
v_mul_f32 v14, v5, v14
v_mul_f32 v15, v5, v15
v_cvt_pk_bf16_f32 v16, v8, v9
v_cvt_pk_bf16_f32 v17, v10, v11
v_cvt_pk_bf16_f32 v18, v12, v13
v_cvt_pk_bf16_f32 v19, v14, v15
s_lshl_b32 s52, s47, 10
s_add_u32 s52, s52, 213909504
buffer_store_dwordx4 v[16:19], v0, s[4:7], s52 offen sc1
s_add_u32 s47, s47, 128
s_cmp_lt_u32 s47, 800
s_cbranch_scc1 k_gt_9
s_waitcnt vmcnt(0)
s_barrier
s_cmp_lg_u32 s3, 0
s_cbranch_scc1 k_sd_11
s_mov_b64 exec, 1
v_mov_b32 v2, 128
v_mov_b32 v3, 1
global_atomic_add v2, v3, s[28:29] sc1
s_mov_b64 exec, -1
k_sd_11:
s_lshl_b32 s47, s30, 2
s_add_u32 s47, s47, s3
v_bfe_u32 v6, v0, 4, 5
v_lshrrev_b32 v2, 9, v0
v_bfe_u32 v8, v6, 2, 1
s_mov_b32 s56, 0x3acccccd
v_lshrrev_b32 v9, 3, v6
v_and_b32 v1, 3, v6
v_lshl_add_u32 v1, v8, 4, v1
v_lshl_add_u32 v1, v9, 2, v1
k_gt_12:
s_mul_i32 s52, s47, 1639
s_lshr_b32 s52, s52, 16
s_mul_i32 s53, s52, 40
s_sub_u32 s53, s47, s53
s_lshl_b32 s52, s52, 5
s_lshl_b32 s53, s53, 1
v_add_u32 v3, s52, v1
v_add_u32 v6, s53, v2
v_cmp_eq_u32 vcc, 0, v6
v_lshlrev_b32 v6, 2, v6
v_mul_u32_u24 v6, v6, v3
v_cvt_f32_u32 v6, v6
v_lshlrev_b32 v4, 31, v3
v_cvt_f32_u32 v3, v3
v_mul_f32 v8, s56, v6
v_add_f32 v6, v6, v3
v_fract_f32 v8, v8
v_sin_f32 v9, v8
v_cos_f32 v8, v8
v_mul_f32 v10, s56, v6
v_add_f32 v6, v6, v3
v_fract_f32 v10, v10
v_sin_f32 v11, v10
v_cos_f32 v10, v10
v_mul_f32 v12, s56, v6
v_add_f32 v6, v6, v3
v_fract_f32 v12, v12
v_sin_f32 v13, v12
v_cos_f32 v12, v12
v_mul_f32 v14, s56, v6
v_add_f32 v6, v6, v3
v_fract_f32 v14, v14
v_sin_f32 v15, v14
v_cos_f32 v14, v14
v_mul_f32 v8, 0x3d64f92e, v8
v_mul_f32 v9, 0xbd64f92e, v9
v_mul_f32 v10, 0x3d64f92e, v10
v_mul_f32 v11, 0xbd64f92e, v11
v_mul_f32 v12, 0x3d64f92e, v12
v_mul_f32 v13, 0xbd64f92e, v13
v_mul_f32 v14, 0x3d64f92e, v14
v_mul_f32 v15, 0xbd64f92e, v15
v_mov_b32 v5, 0x3d21e89b
v_xor_b32 v4, v4, v5
v_cndmask_b32 v8, v8, v4, vcc
v_cndmask_b32 v9, v9, v5, vcc
v_cvt_pk_bf16_f32 v16, v8, v9
v_cvt_pk_bf16_f32 v17, v10, v11
v_cvt_pk_bf16_f32 v18, v12, v13
v_cvt_pk_bf16_f32 v19, v14, v15
s_lshl_b32 s52, s47, 10
s_add_u32 s52, s52, 214958080
buffer_store_dwordx4 v[16:19], v0, s[4:7], s52 offen sc1
s_add_u32 s47, s47, 128
s_cmp_lt_u32 s47, 800
s_cbranch_scc1 k_gt_12
s_lshl_b32 s52, s30, 2
s_add_u32 s52, s52, s3
s_lshr_b32 s53, s52, 6
s_mul_i32 s53, s53, 393216
s_mul_i32 s52, s52, 10240
s_add_u32 s52, s52, s53
s_add_u32 s52, s52, 117440512
v_mov_b64 v[4:5], -1
v_mov_b64 v[6:7], -1
buffer_store_dwordx4 v[4:7], v0, s[4:7], s52 offen offset:0 sc1
buffer_store_dwordx4 v[4:7], v0, s[4:7], s52 offen offset:1024 sc1
buffer_store_dwordx4 v[4:7], v0, s[4:7], s52 offen offset:2048 sc1
buffer_store_dwordx4 v[4:7], v0, s[4:7], s52 offen offset:3072 sc1
s_add_u32 s52, s52, 4096
buffer_store_dwordx4 v[4:7], v0, s[4:7], s52 offen offset:0 sc1
buffer_store_dwordx4 v[4:7], v0, s[4:7], s52 offen offset:1024 sc1
buffer_store_dwordx4 v[4:7], v0, s[4:7], s52 offen offset:2048 sc1
buffer_store_dwordx4 v[4:7], v0, s[4:7], s52 offen offset:3072 sc1
s_add_u32 s52, s52, 4096
buffer_store_dwordx4 v[4:7], v0, s[4:7], s52 offen offset:0 sc1
buffer_store_dwordx4 v[4:7], v0, s[4:7], s52 offen offset:1024 sc1
s_waitcnt vmcnt(0)
s_barrier
s_cmp_lg_u32 s3, 0
s_cbranch_scc1 k_sd_14
s_mov_b64 exec, 1
v_mov_b32 v2, 192
v_mov_b32 v3, 1
global_atomic_add v2, v3, s[28:29] sc1
s_mov_b64 exec, -1
k_sd_14:
v_lshrrev_b32 v1, 8, v0
v_and_b32 v2, 0xf0, v0
v_lshl_add_u32 v8, v1, 13, v2
v_bfe_u32 v2, v0, 6, 4
v_and_b32 v3, 7, v2
v_xor_b32 v3, s3, v3
v_lshlrev_b32 v3, 5, v3
v_lshl_add_u32 v16, v2, 10, v3
v_bfe_u32 v2, v0, 4, 2
v_lshl_add_u32 v16, v2, 3, v16
v_xor_b32 v19, 0x80, v16
v_xor_b32 v9, 32, v8
v_xor_b32 v10, 64, v8
v_xor_b32 v11, 96, v8
v_xor_b32 v12, 128, v8
v_xor_b32 v13, 160, v8
v_xor_b32 v14, 192, v8
v_xor_b32 v15, 224, v8
v_add_u32 v17, 65536, v16
v_add_u32 v18, 131072, v16
v_add_u32 v20, 65536, v19
v_add_u32 v21, 131072, v19
s_mul_i32 s52, s3, 1310720
s_lshl_b32 s53, s30, 8
s_add_u32 s52, s52, s53
s_mul_i32 s53, s3, 40960
s_add_u32 m0, s53, 0
s_add_u32 s54, s52, 0
buffer_load_dwordx4 v8, s[12:15], s54 offen lds
s_add_u32 m0, s53, 1024
s_add_u32 s54, s52, 32768
buffer_load_dwordx4 v9, s[12:15], s54 offen lds
s_add_u32 m0, s53, 2048
s_add_u32 s54, s52, 65536
buffer_load_dwordx4 v10, s[12:15], s54 offen lds
s_add_u32 m0, s53, 3072
s_add_u32 s54, s52, 98304
buffer_load_dwordx4 v11, s[12:15], s54 offen lds
s_add_u32 m0, s53, 4096
s_add_u32 s54, s52, 131072
buffer_load_dwordx4 v12, s[12:15], s54 offen lds
s_add_u32 m0, s53, 5120
s_add_u32 s54, s52, 163840
buffer_load_dwordx4 v13, s[12:15], s54 offen lds
s_add_u32 m0, s53, 6144
s_add_u32 s54, s52, 196608
buffer_load_dwordx4 v14, s[12:15], s54 offen lds
s_add_u32 m0, s53, 7168
s_add_u32 s54, s52, 229376
buffer_load_dwordx4 v15, s[12:15], s54 offen lds
s_add_u32 m0, s53, 8192
s_add_u32 s54, s52, 262144
buffer_load_dwordx4 v8, s[12:15], s54 offen lds
s_add_u32 m0, s53, 9216
s_add_u32 s54, s52, 294912
buffer_load_dwordx4 v9, s[12:15], s54 offen lds
s_add_u32 m0, s53, 10240
s_add_u32 s54, s52, 327680
buffer_load_dwordx4 v10, s[12:15], s54 offen lds
s_add_u32 m0, s53, 11264
s_add_u32 s54, s52, 360448
buffer_load_dwordx4 v11, s[12:15], s54 offen lds
s_add_u32 m0, s53, 12288
s_add_u32 s54, s52, 393216
buffer_load_dwordx4 v12, s[12:15], s54 offen lds
s_add_u32 m0, s53, 13312
s_add_u32 s54, s52, 425984
buffer_load_dwordx4 v13, s[12:15], s54 offen lds
s_add_u32 m0, s53, 14336
s_add_u32 s54, s52, 458752
buffer_load_dwordx4 v14, s[12:15], s54 offen lds
s_add_u32 m0, s53, 15360
s_add_u32 s54, s52, 491520
buffer_load_dwordx4 v15, s[12:15], s54 offen lds
s_add_u32 m0, s53, 16384
s_add_u32 s54, s52, 524288
buffer_load_dwordx4 v8, s[12:15], s54 offen lds
s_add_u32 m0, s53, 17408
s_add_u32 s54, s52, 557056
buffer_load_dwordx4 v9, s[12:15], s54 offen lds
s_add_u32 m0, s53, 18432
s_add_u32 s54, s52, 589824
buffer_load_dwordx4 v10, s[12:15], s54 offen lds
s_add_u32 m0, s53, 19456
s_add_u32 s54, s52, 622592
buffer_load_dwordx4 v11, s[12:15], s54 offen lds
s_add_u32 m0, s53, 20480
s_add_u32 s54, s52, 655360
buffer_load_dwordx4 v12, s[12:15], s54 offen lds
s_add_u32 m0, s53, 21504
s_add_u32 s54, s52, 688128
buffer_load_dwordx4 v13, s[12:15], s54 offen lds
s_add_u32 m0, s53, 22528
s_add_u32 s54, s52, 720896
buffer_load_dwordx4 v14, s[12:15], s54 offen lds
s_add_u32 m0, s53, 23552
s_add_u32 s54, s52, 753664
buffer_load_dwordx4 v15, s[12:15], s54 offen lds
s_add_u32 m0, s53, 24576
s_add_u32 s54, s52, 786432
buffer_load_dwordx4 v8, s[12:15], s54 offen lds
s_add_u32 m0, s53, 25600
s_add_u32 s54, s52, 819200
buffer_load_dwordx4 v9, s[12:15], s54 offen lds
s_add_u32 m0, s53, 26624
s_add_u32 s54, s52, 851968
buffer_load_dwordx4 v10, s[12:15], s54 offen lds
s_add_u32 m0, s53, 27648
s_add_u32 s54, s52, 884736
buffer_load_dwordx4 v11, s[12:15], s54 offen lds
s_add_u32 m0, s53, 28672
s_add_u32 s54, s52, 917504
buffer_load_dwordx4 v12, s[12:15], s54 offen lds
s_add_u32 m0, s53, 29696
s_add_u32 s54, s52, 950272
buffer_load_dwordx4 v13, s[12:15], s54 offen lds
s_add_u32 m0, s53, 30720
s_add_u32 s54, s52, 983040
buffer_load_dwordx4 v14, s[12:15], s54 offen lds
s_add_u32 m0, s53, 31744
s_add_u32 s54, s52, 1015808
buffer_load_dwordx4 v15, s[12:15], s54 offen lds
s_add_u32 m0, s53, 32768
s_add_u32 s54, s52, 1048576
buffer_load_dwordx4 v8, s[12:15], s54 offen lds
s_add_u32 m0, s53, 33792
s_add_u32 s54, s52, 1081344
buffer_load_dwordx4 v9, s[12:15], s54 offen lds
s_add_u32 m0, s53, 34816
s_add_u32 s54, s52, 1114112
buffer_load_dwordx4 v10, s[12:15], s54 offen lds
s_add_u32 m0, s53, 35840
s_add_u32 s54, s52, 1146880
buffer_load_dwordx4 v11, s[12:15], s54 offen lds
s_add_u32 m0, s53, 36864
s_add_u32 s54, s52, 1179648
buffer_load_dwordx4 v12, s[12:15], s54 offen lds
s_add_u32 m0, s53, 37888
s_add_u32 s54, s52, 1212416
buffer_load_dwordx4 v13, s[12:15], s54 offen lds
s_add_u32 m0, s53, 38912
s_add_u32 s54, s52, 1245184
buffer_load_dwordx4 v14, s[12:15], s54 offen lds
s_add_u32 m0, s53, 39936
s_add_u32 s54, s52, 1277952
buffer_load_dwordx4 v15, s[12:15], s54 offen lds
s_waitcnt vmcnt(0)
s_barrier
ds_read_b64_tr_b16 a[0:1], v16 offset:0
ds_read_b64_tr_b16 a[2:3], v16 offset:512
ds_read_b64_tr_b16 a[4:5], v19 offset:0
ds_read_b64_tr_b16 a[6:7], v19 offset:512
ds_read_b64_tr_b16 a[16:17], v16 offset:256
ds_read_b64_tr_b16 a[18:19], v16 offset:768
ds_read_b64_tr_b16 a[20:21], v19 offset:256
ds_read_b64_tr_b16 a[22:23], v19 offset:768
ds_read_b64_tr_b16 a[32:33], v16 offset:16384
ds_read_b64_tr_b16 a[34:35], v16 offset:16896
ds_read_b64_tr_b16 a[36:37], v19 offset:16384
ds_read_b64_tr_b16 a[38:39], v19 offset:16896
ds_read_b64_tr_b16 a[48:49], v16 offset:16640
ds_read_b64_tr_b16 a[50:51], v16 offset:17152
ds_read_b64_tr_b16 a[52:53], v19 offset:16640
ds_read_b64_tr_b16 a[54:55], v19 offset:17152
ds_read_b64_tr_b16 a[64:65], v16 offset:32768
ds_read_b64_tr_b16 a[66:67], v16 offset:33280
ds_read_b64_tr_b16 a[68:69], v19 offset:32768
ds_read_b64_tr_b16 a[70:71], v19 offset:33280
ds_read_b64_tr_b16 a[80:81], v16 offset:33024
ds_read_b64_tr_b16 a[82:83], v16 offset:33536
ds_read_b64_tr_b16 a[84:85], v19 offset:33024
ds_read_b64_tr_b16 a[86:87], v19 offset:33536
ds_read_b64_tr_b16 a[96:97], v16 offset:49152
ds_read_b64_tr_b16 a[98:99], v16 offset:49664
ds_read_b64_tr_b16 a[100:101], v19 offset:49152
ds_read_b64_tr_b16 a[102:103], v19 offset:49664
ds_read_b64_tr_b16 a[112:113], v16 offset:49408
ds_read_b64_tr_b16 a[114:115], v16 offset:49920
ds_read_b64_tr_b16 a[116:117], v19 offset:49408
ds_read_b64_tr_b16 a[118:119], v19 offset:49920
ds_read_b64_tr_b16 a[128:129], v17 offset:0
ds_read_b64_tr_b16 a[130:131], v17 offset:512
ds_read_b64_tr_b16 a[132:133], v20 offset:0
ds_read_b64_tr_b16 a[134:135], v20 offset:512
ds_read_b64_tr_b16 a[144:145], v17 offset:256
ds_read_b64_tr_b16 a[146:147], v17 offset:768
ds_read_b64_tr_b16 a[148:149], v20 offset:256
ds_read_b64_tr_b16 a[150:151], v20 offset:768
ds_read_b64_tr_b16 a[160:161], v17 offset:16384
ds_read_b64_tr_b16 a[162:163], v17 offset:16896
ds_read_b64_tr_b16 a[164:165], v20 offset:16384
ds_read_b64_tr_b16 a[166:167], v20 offset:16896
ds_read_b64_tr_b16 a[176:177], v17 offset:16640
ds_read_b64_tr_b16 a[178:179], v17 offset:17152
ds_read_b64_tr_b16 a[180:181], v20 offset:16640
ds_read_b64_tr_b16 a[182:183], v20 offset:17152
ds_read_b64_tr_b16 a[192:193], v17 offset:32768
ds_read_b64_tr_b16 a[194:195], v17 offset:33280
ds_read_b64_tr_b16 a[196:197], v20 offset:32768
ds_read_b64_tr_b16 a[198:199], v20 offset:33280
ds_read_b64_tr_b16 a[208:209], v17 offset:33024
ds_read_b64_tr_b16 a[210:211], v17 offset:33536
ds_read_b64_tr_b16 a[212:213], v20 offset:33024
ds_read_b64_tr_b16 a[214:215], v20 offset:33536
ds_read_b64_tr_b16 a[224:225], v17 offset:49152
ds_read_b64_tr_b16 a[226:227], v17 offset:49664
ds_read_b64_tr_b16 a[228:229], v20 offset:49152
ds_read_b64_tr_b16 a[230:231], v20 offset:49664
ds_read_b64_tr_b16 a[240:241], v17 offset:49408
ds_read_b64_tr_b16 a[242:243], v17 offset:49920
ds_read_b64_tr_b16 a[244:245], v20 offset:49408
ds_read_b64_tr_b16 a[246:247], v20 offset:49920
ds_read_b64_tr_b16 v[192:193], v18 offset:0
ds_read_b64_tr_b16 v[194:195], v18 offset:512
ds_read_b64_tr_b16 v[196:197], v21 offset:0
ds_read_b64_tr_b16 v[198:199], v21 offset:512
ds_read_b64_tr_b16 v[208:209], v18 offset:256
ds_read_b64_tr_b16 v[210:211], v18 offset:768
ds_read_b64_tr_b16 v[212:213], v21 offset:256
ds_read_b64_tr_b16 v[214:215], v21 offset:768
ds_read_b64_tr_b16 v[224:225], v18 offset:16384
ds_read_b64_tr_b16 v[226:227], v18 offset:16896
ds_read_b64_tr_b16 v[228:229], v21 offset:16384
ds_read_b64_tr_b16 v[230:231], v21 offset:16896
ds_read_b64_tr_b16 v[240:241], v18 offset:16640
ds_read_b64_tr_b16 v[242:243], v18 offset:17152
ds_read_b64_tr_b16 v[244:245], v21 offset:16640
ds_read_b64_tr_b16 v[246:247], v21 offset:17152
s_waitcnt lgkmcnt(0)
s_barrier
s_mul_i32 s52, s3, 1310720
s_lshl_b32 s53, s30, 8
s_add_u32 s52, s52, s53
s_mul_i32 s53, s3, 40960
s_add_u32 m0, s53, 0
s_add_u32 s54, s52, 0
buffer_load_dwordx4 v8, s[16:19], s54 offen lds
s_add_u32 m0, s53, 1024
s_add_u32 s54, s52, 32768
buffer_load_dwordx4 v9, s[16:19], s54 offen lds
s_add_u32 m0, s53, 2048
s_add_u32 s54, s52, 65536
buffer_load_dwordx4 v10, s[16:19], s54 offen lds
s_add_u32 m0, s53, 3072
s_add_u32 s54, s52, 98304
buffer_load_dwordx4 v11, s[16:19], s54 offen lds
s_add_u32 m0, s53, 4096
s_add_u32 s54, s52, 131072
buffer_load_dwordx4 v12, s[16:19], s54 offen lds
s_add_u32 m0, s53, 5120
s_add_u32 s54, s52, 163840
buffer_load_dwordx4 v13, s[16:19], s54 offen lds
s_add_u32 m0, s53, 6144
s_add_u32 s54, s52, 196608
buffer_load_dwordx4 v14, s[16:19], s54 offen lds
s_add_u32 m0, s53, 7168
s_add_u32 s54, s52, 229376
buffer_load_dwordx4 v15, s[16:19], s54 offen lds
s_add_u32 m0, s53, 8192
s_add_u32 s54, s52, 262144
buffer_load_dwordx4 v8, s[16:19], s54 offen lds
s_add_u32 m0, s53, 9216
s_add_u32 s54, s52, 294912
buffer_load_dwordx4 v9, s[16:19], s54 offen lds
s_add_u32 m0, s53, 10240
s_add_u32 s54, s52, 327680
buffer_load_dwordx4 v10, s[16:19], s54 offen lds
s_add_u32 m0, s53, 11264
s_add_u32 s54, s52, 360448
buffer_load_dwordx4 v11, s[16:19], s54 offen lds
s_add_u32 m0, s53, 12288
s_add_u32 s54, s52, 393216
buffer_load_dwordx4 v12, s[16:19], s54 offen lds
s_add_u32 m0, s53, 13312
s_add_u32 s54, s52, 425984
buffer_load_dwordx4 v13, s[16:19], s54 offen lds
s_add_u32 m0, s53, 14336
s_add_u32 s54, s52, 458752
buffer_load_dwordx4 v14, s[16:19], s54 offen lds
s_add_u32 m0, s53, 15360
s_add_u32 s54, s52, 491520
buffer_load_dwordx4 v15, s[16:19], s54 offen lds
s_add_u32 m0, s53, 16384
s_add_u32 s54, s52, 524288
buffer_load_dwordx4 v8, s[16:19], s54 offen lds
s_add_u32 m0, s53, 17408
s_add_u32 s54, s52, 557056
buffer_load_dwordx4 v9, s[16:19], s54 offen lds
s_add_u32 m0, s53, 18432
s_add_u32 s54, s52, 589824
buffer_load_dwordx4 v10, s[16:19], s54 offen lds
s_add_u32 m0, s53, 19456
s_add_u32 s54, s52, 622592
buffer_load_dwordx4 v11, s[16:19], s54 offen lds
s_add_u32 m0, s53, 20480
s_add_u32 s54, s52, 655360
buffer_load_dwordx4 v12, s[16:19], s54 offen lds
s_add_u32 m0, s53, 21504
s_add_u32 s54, s52, 688128
buffer_load_dwordx4 v13, s[16:19], s54 offen lds
s_add_u32 m0, s53, 22528
s_add_u32 s54, s52, 720896
buffer_load_dwordx4 v14, s[16:19], s54 offen lds
s_add_u32 m0, s53, 23552
s_add_u32 s54, s52, 753664
buffer_load_dwordx4 v15, s[16:19], s54 offen lds
s_add_u32 m0, s53, 24576
s_add_u32 s54, s52, 786432
buffer_load_dwordx4 v8, s[16:19], s54 offen lds
s_add_u32 m0, s53, 25600
s_add_u32 s54, s52, 819200
buffer_load_dwordx4 v9, s[16:19], s54 offen lds
s_add_u32 m0, s53, 26624
s_add_u32 s54, s52, 851968
buffer_load_dwordx4 v10, s[16:19], s54 offen lds
s_add_u32 m0, s53, 27648
s_add_u32 s54, s52, 884736
buffer_load_dwordx4 v11, s[16:19], s54 offen lds
s_add_u32 m0, s53, 28672
s_add_u32 s54, s52, 917504
buffer_load_dwordx4 v12, s[16:19], s54 offen lds
s_add_u32 m0, s53, 29696
s_add_u32 s54, s52, 950272
buffer_load_dwordx4 v13, s[16:19], s54 offen lds
s_add_u32 m0, s53, 30720
s_add_u32 s54, s52, 983040
buffer_load_dwordx4 v14, s[16:19], s54 offen lds
s_add_u32 m0, s53, 31744
s_add_u32 s54, s52, 1015808
buffer_load_dwordx4 v15, s[16:19], s54 offen lds
s_add_u32 m0, s53, 32768
s_add_u32 s54, s52, 1048576
buffer_load_dwordx4 v8, s[16:19], s54 offen lds
s_add_u32 m0, s53, 33792
s_add_u32 s54, s52, 1081344
buffer_load_dwordx4 v9, s[16:19], s54 offen lds
s_add_u32 m0, s53, 34816
s_add_u32 s54, s52, 1114112
buffer_load_dwordx4 v10, s[16:19], s54 offen lds
s_add_u32 m0, s53, 35840
s_add_u32 s54, s52, 1146880
buffer_load_dwordx4 v11, s[16:19], s54 offen lds
s_add_u32 m0, s53, 36864
s_add_u32 s54, s52, 1179648
buffer_load_dwordx4 v12, s[16:19], s54 offen lds
s_add_u32 m0, s53, 37888
s_add_u32 s54, s52, 1212416
buffer_load_dwordx4 v13, s[16:19], s54 offen lds
s_add_u32 m0, s53, 38912
s_add_u32 s54, s52, 1245184
buffer_load_dwordx4 v14, s[16:19], s54 offen lds
s_add_u32 m0, s53, 39936
s_add_u32 s54, s52, 1277952
buffer_load_dwordx4 v15, s[16:19], s54 offen lds
s_waitcnt vmcnt(0)
s_barrier
ds_read_b64_tr_b16 a[8:9], v16 offset:0
ds_read_b64_tr_b16 a[10:11], v16 offset:512
ds_read_b64_tr_b16 a[12:13], v19 offset:0
ds_read_b64_tr_b16 a[14:15], v19 offset:512
ds_read_b64_tr_b16 a[24:25], v16 offset:256
ds_read_b64_tr_b16 a[26:27], v16 offset:768
ds_read_b64_tr_b16 a[28:29], v19 offset:256
ds_read_b64_tr_b16 a[30:31], v19 offset:768
ds_read_b64_tr_b16 a[40:41], v16 offset:16384
ds_read_b64_tr_b16 a[42:43], v16 offset:16896
ds_read_b64_tr_b16 a[44:45], v19 offset:16384
ds_read_b64_tr_b16 a[46:47], v19 offset:16896
ds_read_b64_tr_b16 a[56:57], v16 offset:16640
ds_read_b64_tr_b16 a[58:59], v16 offset:17152
ds_read_b64_tr_b16 a[60:61], v19 offset:16640
ds_read_b64_tr_b16 a[62:63], v19 offset:17152
ds_read_b64_tr_b16 a[72:73], v16 offset:32768
ds_read_b64_tr_b16 a[74:75], v16 offset:33280
ds_read_b64_tr_b16 a[76:77], v19 offset:32768
ds_read_b64_tr_b16 a[78:79], v19 offset:33280
ds_read_b64_tr_b16 a[88:89], v16 offset:33024
ds_read_b64_tr_b16 a[90:91], v16 offset:33536
ds_read_b64_tr_b16 a[92:93], v19 offset:33024
ds_read_b64_tr_b16 a[94:95], v19 offset:33536
ds_read_b64_tr_b16 a[104:105], v16 offset:49152
ds_read_b64_tr_b16 a[106:107], v16 offset:49664
ds_read_b64_tr_b16 a[108:109], v19 offset:49152
ds_read_b64_tr_b16 a[110:111], v19 offset:49664
ds_read_b64_tr_b16 a[120:121], v16 offset:49408
ds_read_b64_tr_b16 a[122:123], v16 offset:49920
ds_read_b64_tr_b16 a[124:125], v19 offset:49408
ds_read_b64_tr_b16 a[126:127], v19 offset:49920
ds_read_b64_tr_b16 a[136:137], v17 offset:0
ds_read_b64_tr_b16 a[138:139], v17 offset:512
ds_read_b64_tr_b16 a[140:141], v20 offset:0
ds_read_b64_tr_b16 a[142:143], v20 offset:512
ds_read_b64_tr_b16 a[152:153], v17 offset:256
ds_read_b64_tr_b16 a[154:155], v17 offset:768
ds_read_b64_tr_b16 a[156:157], v20 offset:256
ds_read_b64_tr_b16 a[158:159], v20 offset:768
ds_read_b64_tr_b16 a[168:169], v17 offset:16384
ds_read_b64_tr_b16 a[170:171], v17 offset:16896
ds_read_b64_tr_b16 a[172:173], v20 offset:16384
ds_read_b64_tr_b16 a[174:175], v20 offset:16896
ds_read_b64_tr_b16 a[184:185], v17 offset:16640
ds_read_b64_tr_b16 a[186:187], v17 offset:17152
ds_read_b64_tr_b16 a[188:189], v20 offset:16640
ds_read_b64_tr_b16 a[190:191], v20 offset:17152
ds_read_b64_tr_b16 a[200:201], v17 offset:32768
ds_read_b64_tr_b16 a[202:203], v17 offset:33280
ds_read_b64_tr_b16 a[204:205], v20 offset:32768
ds_read_b64_tr_b16 a[206:207], v20 offset:33280
ds_read_b64_tr_b16 a[216:217], v17 offset:33024
ds_read_b64_tr_b16 a[218:219], v17 offset:33536
ds_read_b64_tr_b16 a[220:221], v20 offset:33024
ds_read_b64_tr_b16 a[222:223], v20 offset:33536
ds_read_b64_tr_b16 a[232:233], v17 offset:49152
ds_read_b64_tr_b16 a[234:235], v17 offset:49664
ds_read_b64_tr_b16 a[236:237], v20 offset:49152
ds_read_b64_tr_b16 a[238:239], v20 offset:49664
ds_read_b64_tr_b16 a[248:249], v17 offset:49408
ds_read_b64_tr_b16 a[250:251], v17 offset:49920
ds_read_b64_tr_b16 a[252:253], v20 offset:49408
ds_read_b64_tr_b16 a[254:255], v20 offset:49920
ds_read_b64_tr_b16 v[200:201], v18 offset:0
ds_read_b64_tr_b16 v[202:203], v18 offset:512
ds_read_b64_tr_b16 v[204:205], v21 offset:0
ds_read_b64_tr_b16 v[206:207], v21 offset:512
ds_read_b64_tr_b16 v[216:217], v18 offset:256
ds_read_b64_tr_b16 v[218:219], v18 offset:768
ds_read_b64_tr_b16 v[220:221], v21 offset:256
ds_read_b64_tr_b16 v[222:223], v21 offset:768
ds_read_b64_tr_b16 v[232:233], v18 offset:16384
ds_read_b64_tr_b16 v[234:235], v18 offset:16896
ds_read_b64_tr_b16 v[236:237], v21 offset:16384
ds_read_b64_tr_b16 v[238:239], v21 offset:16896
ds_read_b64_tr_b16 v[248:249], v18 offset:16640
ds_read_b64_tr_b16 v[250:251], v18 offset:17152
ds_read_b64_tr_b16 v[252:253], v21 offset:16640
ds_read_b64_tr_b16 v[254:255], v21 offset:17152
s_waitcnt lgkmcnt(0)
s_barrier
s_and_b32 s47, s3, 1
s_lshr_b32 s52, s3, 1
s_add_u32 s50, s52, 1
v_lshrrev_b32 v20, 9, v0
v_mov_b32 v21, 0xff800000
v_cmp_eq_u32 vcc, s52, v20
s_lshl_b32 s46, s52, 10
s_lshl_b32 s53, s47, 7
s_add_u32 s46, s46, s53
s_add_u32 s46, s46, 117440512
s_lshl_b32 s53, s52, 5
s_add_u32 s53, s53, s30
s_lshl_b32 s44, s53, 14
s_add_u32 s44, s44, 0
s_lshl_b32 s53, s53, 13
s_lshl_b32 s45, s47, 10
s_add_u32 s45, s45, s53
s_add_u32 s45, s45, 125829120
s_lshl_b32 s48, s3, 17
s_lshl_b32 s53, s30, 11
s_add_u32 s48, s48, s53
s_add_u32 s48, s48, 159383552
s_lshl_b32 s56, s30, 6
s_add_u32 s56, s56, 222330880
s_lshl_b32 s57, s3, 8
s_lshl_b32 s53, s30, 2
s_add_u32 s57, s57, s53
s_add_u32 s57, s57, 222339072
s_mov_b32 s58, 0x3e0293ee
v_cndmask_b32 v156, v21, 0, vcc
v_cndmask_b32 v157, v21, 0, vcc
v_cndmask_b32 v158, v21, 0, vcc
v_cndmask_b32 v159, v21, 0, vcc
v_bfe_u32 v20, v0, 7, 1
v_and_b32 v1, 0x370, v0
v_mul_u32_u24 v23, 10240, v20
v_add_u32 v23, v23, v1
v_lshl_add_u32 v1, v20, 16, v1
v_and_b32 v16, 0x350, v0
v_lshl_add_u32 v16, v20, 5, v16
v_bfe_u32 v20, v0, 5, 1
v_lshl_add_u32 v16, v20, 12, v16
v_add_u32 v17, 8192, v16
s_lshl_b32 s52, s3, 10
v_add_u32 v155, s52, v0
v_mov_b32 v2, 2146435072
v_cmp_eq_u32 vcc, 0, v0
s_nop 1
v_cndmask_b32 v2, v2, 0, vcc
v_bfe_u32 v20, v0, 4, 4
s_lshl_b32 s52, s47, 4
v_add_u32 v20, s52, v20
v_lshrrev_b32 v22, 8, v0
v_lshlrev_b32 v22, 2, v22
v_sub_u32 v20, v20, v22
v_add_u32 v3, 4096, v0
v_add_u32 v18, 8192, v0
v_add_u32 v19, 12288, v0
v_cmp_le_i32 vcc, 0, v20
s_nop 1
v_cndmask_b32 v4, v21, 0, vcc
v_cmp_le_i32 vcc, 1, v20
s_nop 1
v_cndmask_b32 v5, v21, 0, vcc
v_cmp_le_i32 vcc, 2, v20
s_nop 1
v_cndmask_b32 v6, v21, 0, vcc
v_cmp_le_i32 vcc, 3, v20
s_nop 1
v_cndmask_b32 v7, v21, 0, vcc
v_cmp_le_i32 vcc, 16, v20
s_nop 1
v_cndmask_b32 v8, v21, 0, vcc
v_cmp_le_i32 vcc, 17, v20
s_nop 1
v_cndmask_b32 v9, v21, 0, vcc
v_cmp_le_i32 vcc, 18, v20
s_nop 1
v_cndmask_b32 v10, v21, 0, vcc
v_cmp_le_i32 vcc, 19, v20
s_nop 1
v_cndmask_b32 v11, v21, 0, vcc
v_mov_b32 v12, 0x3f803f80
v_mov_b32 v13, 0x3f803f80
v_mov_b32 v14, 0x3f803f80
v_mov_b32 v15, 0x3f803f80
s_cmp_lg_u32 s3, 0
s_cbranch_scc1 k_wdd_16
v_mov_b32 v20, 192
k_wd_15:
global_load_dword v21, v20, s[28:29] sc1
s_waitcnt vmcnt(0)
v_readfirstlane_b32 s52, v21
s_cmp_ge_u32 s52, 32
s_cbranch_scc1 k_wdd_16
s_sleep 2
s_sub_u32 s32, s32, 1
s_cmp_gt_i32 s32, 0
s_cbranch_scc1 k_wd_15
k_wdd_16:
s_barrier
v_mov_b32 v154, 0
k_top_17:
s_waitcnt vmcnt(0)
buffer_store_dword v154, v2, s[4:7], s57 offen sc1
s_cmp_gt_u32 s50, 128
s_cbranch_scc1 k_out_24
k_ck_18:
buffer_load_dwordx3 v[20:22], off, s[4:7], s56 sc1
s_waitcnt vmcnt(0)
v_min3_u32 v20, v20, v21, v22
v_cmp_le_u32 vcc, s50, v20
s_cbranch_vccnz k_cd_19
s_sleep 4
s_sub_u32 s32, s32, 1
s_cmp_gt_i32 s32, 0
s_cbranch_scc1 k_ck_18
k_cd_19:
s_add_u32 s52, s46, 10240
buffer_load_dword v20, off, s[4:7], s52 sc1
buffer_load_dwordx4 v[24:27], v0, s[4:7], s45 offen offset:0 sc1
buffer_load_dwordx4 v[40:43], v16, s[4:7], s44 offen offset:0 sc1
buffer_load_dwordx4 v[44:47], v17, s[4:7], s44 offen offset:0 sc1
buffer_load_dwordx4 v[28:31], v0, s[4:7], s45 offen offset:2048 sc1
buffer_load_dwordx4 v[48:51], v16, s[4:7], s44 offen offset:128 sc1
buffer_load_dwordx4 v[52:55], v17, s[4:7], s44 offen offset:128 sc1
buffer_load_dwordx4 v[32:35], v3, s[4:7], s45 offen offset:0 sc1
buffer_load_dwordx4 v[56:59], v16, s[4:7], s44 offen offset:1024 sc1
buffer_load_dwordx4 v[60:63], v17, s[4:7], s44 offen offset:1024 sc1
buffer_load_dwordx4 v[36:39], v3, s[4:7], s45 offen offset:2048 sc1
buffer_load_dwordx4 v[64:67], v16, s[4:7], s44 offen offset:1152 sc1
buffer_load_dwordx4 v[68:71], v17, s[4:7], s44 offen offset:1152 sc1
buffer_load_dwordx4 v[72:75], v0, s[4:7], s44 offen offset:2048 sc1
buffer_load_dwordx4 v[76:79], v0, s[4:7], s44 offen offset:3072 sc1
buffer_load_dwordx4 v[80:83], v3, s[4:7], s44 offen offset:2048 sc1
buffer_load_dwordx4 v[84:87], v3, s[4:7], s44 offen offset:3072 sc1
buffer_load_dwordx4 v[88:91], v18, s[4:7], s44 offen offset:2048 sc1
buffer_load_dwordx4 v[92:95], v18, s[4:7], s44 offen offset:3072 sc1
buffer_load_dwordx4 v[96:99], v19, s[4:7], s44 offen offset:2048 sc1
buffer_load_dwordx4 v[100:103], v19, s[4:7], s44 offen offset:3072 sc1
s_waitcnt vmcnt(20)
v_cmp_eq_u32 vcc, -1, v20
buffer_store_dword v154, v2, s[4:7], s57 offen sc1
s_cbranch_vccz k_pm_21
k_pr_20:
buffer_load_dword v20, off, s[4:7], s52 sc1
s_waitcnt vmcnt(0)
v_cmp_eq_u32 vcc, -1, v20
s_cbranch_vccz k_pm_21
s_sleep 2
s_sub_u32 s32, s32, 1
s_cmp_gt_i32 s32, 0
s_cbranch_scc1 k_pr_20
k_pm_21:
s_add_u32 s52, s46, 4096
s_add_u32 s53, s46, 8192
buffer_load_dwordx4 v[160:163], v23, s[4:7], s46 offen offset:0 sc1
buffer_load_dwordx4 v[164:167], v23, s[4:7], s46 offen offset:2048 sc1
buffer_load_dwordx4 v[168:171], v23, s[4:7], s52 offen offset:0 sc1
buffer_load_dwordx4 v[172:175], v23, s[4:7], s52 offen offset:2048 sc1
buffer_load_dwordx4 v[176:179], v23, s[4:7], s53 offen offset:0 sc1
s_waitcnt vmcnt(2)
v_max3_u32 v20, v160, v164, v168
s_waitcnt vmcnt(0)
v_max3_u32 v20, v20, v172, v176
v_cmp_eq_u32 vcc, -1, v20
s_cbranch_vccz k_pmd_22
s_sleep 2
s_sub_u32 s32, s32, 1
s_cmp_gt_i32 s32, 0
s_cbranch_scc1 k_pm_21
k_pmd_22:
ds_write_b128 v155, v[160:163] offset:0
ds_write_b128 v155, v[164:167] offset:4096
ds_write_b128 v155, v[168:171] offset:8192
ds_write_b128 v155, v[172:175] offset:12288
ds_write_b128 v155, v[176:179] offset:16384
s_waitcnt lgkmcnt(0)
s_barrier
ds_read_b128 v[160:163], v0 offset:0
ds_read_b128 v[164:167], v0 offset:1024
ds_read_b128 v[168:171], v0 offset:2048
ds_read_b128 v[172:175], v0 offset:3072
buffer_load_dwordx3 v[20:22], off, s[4:7], s56 sc1
s_waitcnt lgkmcnt(3)
v_mfma_f32_16x16x32_bf16 v[104:107], a[0:3], v[160:163], 0
ds_read_b128 v[176:179], v0 offset:4096
v_mfma_f32_16x16x32_bf16 v[108:111], a[4:7], v[160:163], 0
v_mfma_f32_16x16x32_bf16 v[112:115], v[160:163], a[8:11], 0
v_mfma_f32_16x16x32_bf16 v[116:119], v[160:163], a[12:15], 0
s_waitcnt lgkmcnt(3)
v_mfma_f32_16x16x32_bf16 v[104:107], a[16:19], v[164:167], v[104:107]
ds_read_b128 v[180:183], v0 offset:5120
v_mfma_f32_16x16x32_bf16 v[108:111], a[20:23], v[164:167], v[108:111]
v_mfma_f32_16x16x32_bf16 v[112:115], v[164:167], a[24:27], v[112:115]
v_mfma_f32_16x16x32_bf16 v[116:119], v[164:167], a[28:31], v[116:119]
s_waitcnt lgkmcnt(3)
v_mfma_f32_16x16x32_bf16 v[104:107], a[32:35], v[168:171], v[104:107]
ds_read_b128 v[184:187], v0 offset:6144
v_mfma_f32_16x16x32_bf16 v[108:111], a[36:39], v[168:171], v[108:111]
v_mfma_f32_16x16x32_bf16 v[112:115], v[168:171], a[40:43], v[112:115]
v_mfma_f32_16x16x32_bf16 v[116:119], v[168:171], a[44:47], v[116:119]
s_waitcnt lgkmcnt(3)
v_mfma_f32_16x16x32_bf16 v[104:107], a[48:51], v[172:175], v[104:107]
ds_read_b128 v[188:191], v0 offset:7168
v_mfma_f32_16x16x32_bf16 v[108:111], a[52:55], v[172:175], v[108:111]
v_mfma_f32_16x16x32_bf16 v[112:115], v[172:175], a[56:59], v[112:115]
v_mfma_f32_16x16x32_bf16 v[116:119], v[172:175], a[60:63], v[116:119]
s_waitcnt lgkmcnt(3)
v_mfma_f32_16x16x32_bf16 v[104:107], a[64:67], v[176:179], v[104:107]
ds_read_b128 v[160:163], v0 offset:8192
v_mfma_f32_16x16x32_bf16 v[108:111], a[68:71], v[176:179], v[108:111]
v_mfma_f32_16x16x32_bf16 v[112:115], v[176:179], a[72:75], v[112:115]
v_mfma_f32_16x16x32_bf16 v[116:119], v[176:179], a[76:79], v[116:119]
s_waitcnt lgkmcnt(3)
v_mfma_f32_16x16x32_bf16 v[104:107], a[80:83], v[180:183], v[104:107]
ds_read_b128 v[164:167], v0 offset:9216
v_mfma_f32_16x16x32_bf16 v[108:111], a[84:87], v[180:183], v[108:111]
v_mfma_f32_16x16x32_bf16 v[112:115], v[180:183], a[88:91], v[112:115]
v_mfma_f32_16x16x32_bf16 v[116:119], v[180:183], a[92:95], v[116:119]
s_waitcnt lgkmcnt(3)
v_mfma_f32_16x16x32_bf16 v[104:107], a[96:99], v[184:187], v[104:107]
ds_read_b128 v[168:171], v0 offset:10240
v_mfma_f32_16x16x32_bf16 v[108:111], a[100:103], v[184:187], v[108:111]
v_mfma_f32_16x16x32_bf16 v[112:115], v[184:187], a[104:107], v[112:115]
v_mfma_f32_16x16x32_bf16 v[116:119], v[184:187], a[108:111], v[116:119]
s_waitcnt lgkmcnt(3)
v_mfma_f32_16x16x32_bf16 v[104:107], a[112:115], v[188:191], v[104:107]
ds_read_b128 v[172:175], v0 offset:11264
v_mfma_f32_16x16x32_bf16 v[108:111], a[116:119], v[188:191], v[108:111]
v_mfma_f32_16x16x32_bf16 v[112:115], v[188:191], a[120:123], v[112:115]
v_mfma_f32_16x16x32_bf16 v[116:119], v[188:191], a[124:127], v[116:119]
s_waitcnt lgkmcnt(3)
v_mfma_f32_16x16x32_bf16 v[104:107], a[128:131], v[160:163], v[104:107]
ds_read_b128 v[176:179], v0 offset:12288
v_mfma_f32_16x16x32_bf16 v[108:111], a[132:135], v[160:163], v[108:111]
v_mfma_f32_16x16x32_bf16 v[112:115], v[160:163], a[136:139], v[112:115]
v_mfma_f32_16x16x32_bf16 v[116:119], v[160:163], a[140:143], v[116:119]
s_waitcnt lgkmcnt(3)
v_mfma_f32_16x16x32_bf16 v[104:107], a[144:147], v[164:167], v[104:107]
ds_read_b128 v[180:183], v0 offset:13312
v_mfma_f32_16x16x32_bf16 v[108:111], a[148:151], v[164:167], v[108:111]
v_mfma_f32_16x16x32_bf16 v[112:115], v[164:167], a[152:155], v[112:115]
v_mfma_f32_16x16x32_bf16 v[116:119], v[164:167], a[156:159], v[116:119]
s_waitcnt lgkmcnt(3)
v_mfma_f32_16x16x32_bf16 v[104:107], a[160:163], v[168:171], v[104:107]
ds_read_b128 v[184:187], v0 offset:14336
v_mfma_f32_16x16x32_bf16 v[108:111], a[164:167], v[168:171], v[108:111]
v_mfma_f32_16x16x32_bf16 v[112:115], v[168:171], a[168:171], v[112:115]
v_mfma_f32_16x16x32_bf16 v[116:119], v[168:171], a[172:175], v[116:119]
s_waitcnt lgkmcnt(3)
v_mfma_f32_16x16x32_bf16 v[104:107], a[176:179], v[172:175], v[104:107]
ds_read_b128 v[188:191], v0 offset:15360
v_mfma_f32_16x16x32_bf16 v[108:111], a[180:183], v[172:175], v[108:111]
v_mfma_f32_16x16x32_bf16 v[112:115], v[172:175], a[184:187], v[112:115]
v_mfma_f32_16x16x32_bf16 v[116:119], v[172:175], a[188:191], v[116:119]
s_waitcnt lgkmcnt(3)
v_mfma_f32_16x16x32_bf16 v[104:107], a[192:195], v[176:179], v[104:107]
ds_read_b128 v[160:163], v0 offset:16384
v_mfma_f32_16x16x32_bf16 v[108:111], a[196:199], v[176:179], v[108:111]
v_mfma_f32_16x16x32_bf16 v[112:115], v[176:179], a[200:203], v[112:115]
v_mfma_f32_16x16x32_bf16 v[116:119], v[176:179], a[204:207], v[116:119]
s_waitcnt lgkmcnt(3)
v_mfma_f32_16x16x32_bf16 v[104:107], a[208:211], v[180:183], v[104:107]
ds_read_b128 v[164:167], v0 offset:17408
v_mfma_f32_16x16x32_bf16 v[108:111], a[212:215], v[180:183], v[108:111]
v_mfma_f32_16x16x32_bf16 v[112:115], v[180:183], a[216:219], v[112:115]
v_mfma_f32_16x16x32_bf16 v[116:119], v[180:183], a[220:223], v[116:119]
s_waitcnt lgkmcnt(3)
v_mfma_f32_16x16x32_bf16 v[104:107], a[224:227], v[184:187], v[104:107]
ds_read_b128 v[168:171], v0 offset:18432
v_mfma_f32_16x16x32_bf16 v[108:111], a[228:231], v[184:187], v[108:111]
v_mfma_f32_16x16x32_bf16 v[112:115], v[184:187], a[232:235], v[112:115]
v_mfma_f32_16x16x32_bf16 v[116:119], v[184:187], a[236:239], v[116:119]
s_waitcnt lgkmcnt(3)
v_mfma_f32_16x16x32_bf16 v[104:107], a[240:243], v[188:191], v[104:107]
ds_read_b128 v[172:175], v0 offset:19456
v_mfma_f32_16x16x32_bf16 v[108:111], a[244:247], v[188:191], v[108:111]
v_mfma_f32_16x16x32_bf16 v[112:115], v[188:191], a[248:251], v[112:115]
v_mfma_f32_16x16x32_bf16 v[116:119], v[188:191], a[252:255], v[116:119]
s_waitcnt lgkmcnt(3)
v_mfma_f32_16x16x32_bf16 v[104:107], v[192:195], v[160:163], v[104:107]
v_mfma_f32_16x16x32_bf16 v[108:111], v[196:199], v[160:163], v[108:111]
v_mfma_f32_16x16x32_bf16 v[112:115], v[160:163], v[200:203], v[112:115]
v_mfma_f32_16x16x32_bf16 v[116:119], v[160:163], v[204:207], v[116:119]
s_waitcnt lgkmcnt(2)
v_mfma_f32_16x16x32_bf16 v[104:107], v[208:211], v[164:167], v[104:107]
v_mfma_f32_16x16x32_bf16 v[108:111], v[212:215], v[164:167], v[108:111]
v_mfma_f32_16x16x32_bf16 v[112:115], v[164:167], v[216:219], v[112:115]
v_mfma_f32_16x16x32_bf16 v[116:119], v[164:167], v[220:223], v[116:119]
s_waitcnt lgkmcnt(1)
v_mfma_f32_16x16x32_bf16 v[104:107], v[224:227], v[168:171], v[104:107]
v_mfma_f32_16x16x32_bf16 v[108:111], v[228:231], v[168:171], v[108:111]
v_mfma_f32_16x16x32_bf16 v[112:115], v[168:171], v[232:235], v[112:115]
v_mfma_f32_16x16x32_bf16 v[116:119], v[168:171], v[236:239], v[116:119]
s_waitcnt lgkmcnt(0)
v_mfma_f32_16x16x32_bf16 v[104:107], v[240:243], v[172:175], v[104:107]
v_mfma_f32_16x16x32_bf16 v[108:111], v[244:247], v[172:175], v[108:111]
v_mfma_f32_16x16x32_bf16 v[112:115], v[172:175], v[248:251], v[112:115]
v_mfma_f32_16x16x32_bf16 v[116:119], v[172:175], v[252:255], v[116:119]
v_cvt_pk_bf16_f32 v104, v104, v105
v_cvt_pk_bf16_f32 v105, v106, v107
v_cvt_pk_bf16_f32 v106, v108, v109
v_cvt_pk_bf16_f32 v107, v110, v111
ds_write_b128 v155, v[104:107] offset:20480
v_cvt_pk_bf16_f32 v112, v112, v113
v_cvt_pk_bf16_f32 v113, v114, v115
v_cvt_pk_bf16_f32 v114, v116, v117
v_cvt_pk_bf16_f32 v115, v118, v119
ds_write_b128 v155, v[112:115] offset:24576
v_mfma_f32_16x16x32_bf16 v[136:139], v[40:43], v[24:27], v[4:7]
v_mfma_f32_16x16x32_bf16 v[140:143], v[44:47], v[24:27], v[8:11]
v_mfma_f32_16x16x32_bf16 v[136:139], v[48:51], v[28:31], v[136:139]
v_mfma_f32_16x16x32_bf16 v[140:143], v[52:55], v[28:31], v[140:143]
s_waitcnt lgkmcnt(0)
s_barrier
ds_read_b128 v[104:107], v0 offset:20480
ds_read_b128 v[108:111], v0 offset:21504
ds_read_b128 v[112:115], v0 offset:22528
ds_read_b128 v[116:119], v0 offset:23552
ds_read_b128 v[120:123], v0 offset:24576
ds_read_b128 v[124:127], v0 offset:25600
ds_read_b128 v[128:131], v0 offset:26624
ds_read_b128 v[132:135], v0 offset:27648
v_mfma_f32_16x16x32_bf16 v[136:139], v[56:59], v[32:35], v[136:139]
v_mfma_f32_16x16x32_bf16 v[140:143], v[60:63], v[32:35], v[140:143]
v_mfma_f32_16x16x32_bf16 v[136:139], v[64:67], v[36:39], v[136:139]
v_mfma_f32_16x16x32_bf16 v[140:143], v[68:71], v[36:39], v[140:143]
s_waitcnt lgkmcnt(7)
v_mfma_f32_16x16x32_bf16 v[144:147], v[104:107], v[24:27], v[156:159]
s_waitcnt lgkmcnt(6)
v_mfma_f32_16x16x32_bf16 v[144:147], v[108:111], v[28:31], v[144:147]
s_waitcnt lgkmcnt(5)
v_mfma_f32_16x16x32_bf16 v[144:147], v[112:115], v[32:35], v[144:147]
s_waitcnt lgkmcnt(4)
v_mfma_f32_16x16x32_bf16 v[144:147], v[116:119], v[36:39], v[144:147]
v_max3_f32 v44, v136, v137, v138
v_max3_f32 v44, v44, v139, v140
v_max3_f32 v44, v44, v141, v142
s_nop 2
v_max3_f32 v44, v44, v143, v144
v_max3_f32 v44, v44, v145, v146
v_max_f32 v44, v44, v147
v_mov_b32 v45, v44
s_nop 1
v_permlane32_swap_b32 v44, v45
v_max_f32 v44, v44, v45
v_mov_b32 v45, v44
s_nop 1
v_permlane16_swap_b32 v44, v45
v_max_f32 v44, v44, v45
v_mul_f32 v44, s58, v44
v_fma_f32 v136, v136, s58, -v44
v_exp_f32 v136, v136
v_fma_f32 v137, v137, s58, -v44
v_exp_f32 v137, v137
v_fma_f32 v138, v138, s58, -v44
v_exp_f32 v138, v138
v_fma_f32 v139, v139, s58, -v44
v_exp_f32 v139, v139
v_fma_f32 v140, v140, s58, -v44
v_exp_f32 v140, v140
v_fma_f32 v141, v141, s58, -v44
v_exp_f32 v141, v141
v_fma_f32 v142, v142, s58, -v44
v_exp_f32 v142, v142
v_fma_f32 v143, v143, s58, -v44
v_exp_f32 v143, v143
v_fma_f32 v144, v144, s58, -v44
v_exp_f32 v144, v144
v_fma_f32 v145, v145, s58, -v44
v_exp_f32 v145, v145
v_fma_f32 v146, v146, s58, -v44
v_exp_f32 v146, v146
v_fma_f32 v147, v147, s58, -v44
v_exp_f32 v147, v147
v_cvt_pk_bf16_f32 v148, v136, v137
v_cvt_pk_bf16_f32 v149, v138, v139
v_cvt_pk_bf16_f32 v150, v140, v141
v_cvt_pk_bf16_f32 v151, v142, v143
v_cvt_pk_bf16_f32 v152, v144, v145
v_cvt_pk_bf16_f32 v153, v146, v147
v_mfma_f32_16x16x32_bf16 v[40:43], v[12:15], v[148:151], 0
v_mfma_f32_16x16x32_bf16 v[160:163], v[72:75], v[148:151], 0
v_mfma_f32_16x16x32_bf16 v[164:167], v[76:79], v[148:151], 0
v_mfma_f32_16x16x16_bf16 v[40:43], v[12:13], v[152:153], v[40:43]
v_mfma_f32_16x16x32_bf16 v[168:171], v[80:83], v[148:151], 0
v_mfma_f32_16x16x32_bf16 v[172:175], v[84:87], v[148:151], 0
v_mfma_f32_16x16x32_bf16 v[176:179], v[88:91], v[148:151], 0
v_mfma_f32_16x16x32_bf16 v[180:183], v[92:95], v[148:151], 0
v_mfma_f32_16x16x32_bf16 v[184:187], v[96:99], v[148:151], 0
v_mfma_f32_16x16x32_bf16 v[188:191], v[100:103], v[148:151], 0
v_rcp_f32 v40, v40
s_waitcnt lgkmcnt(3)
v_mfma_f32_16x16x16_bf16 v[160:163], v[120:121], v[152:153], v[160:163]
v_mfma_f32_16x16x16_bf16 v[164:167], v[122:123], v[152:153], v[164:167]
s_waitcnt lgkmcnt(2)
v_mfma_f32_16x16x16_bf16 v[168:171], v[124:125], v[152:153], v[168:171]
v_mfma_f32_16x16x16_bf16 v[172:175], v[126:127], v[152:153], v[172:175]
s_waitcnt lgkmcnt(1)
v_mfma_f32_16x16x16_bf16 v[176:179], v[128:129], v[152:153], v[176:179]
v_mfma_f32_16x16x16_bf16 v[180:183], v[130:131], v[152:153], v[180:183]
s_waitcnt lgkmcnt(0)
v_mfma_f32_16x16x16_bf16 v[184:187], v[132:133], v[152:153], v[184:187]
v_mfma_f32_16x16x16_bf16 v[188:191], v[134:135], v[152:153], v[188:191]
v_mul_f32 v160, v40, v160
v_mul_f32 v161, v40, v161
v_mul_f32 v162, v40, v162
v_mul_f32 v163, v40, v163
v_mul_f32 v164, v40, v164
v_mul_f32 v165, v40, v165
v_mul_f32 v166, v40, v166
v_mul_f32 v167, v40, v167
v_cvt_pk_bf16_f32 v104, v160, v161
v_cvt_pk_bf16_f32 v105, v162, v163
v_cvt_pk_bf16_f32 v106, v164, v165
v_cvt_pk_bf16_f32 v107, v166, v167
buffer_store_dwordx4 v[104:107], v1, s[4:7], s48 offen offset:0 sc1
v_mul_f32 v168, v40, v168
v_mul_f32 v169, v40, v169
v_mul_f32 v170, v40, v170
v_mul_f32 v171, v40, v171
v_mul_f32 v172, v40, v172
v_mul_f32 v173, v40, v173
v_mul_f32 v174, v40, v174
v_mul_f32 v175, v40, v175
v_cvt_pk_bf16_f32 v108, v168, v169
v_cvt_pk_bf16_f32 v109, v170, v171
v_cvt_pk_bf16_f32 v110, v172, v173
v_cvt_pk_bf16_f32 v111, v174, v175
buffer_store_dwordx4 v[108:111], v1, s[4:7], s48 offen offset:128 sc1
v_mul_f32 v176, v40, v176
v_mul_f32 v177, v40, v177
v_mul_f32 v178, v40, v178
v_mul_f32 v179, v40, v179
v_mul_f32 v180, v40, v180
v_mul_f32 v181, v40, v181
v_mul_f32 v182, v40, v182
v_mul_f32 v183, v40, v183
v_cvt_pk_bf16_f32 v112, v176, v177
v_cvt_pk_bf16_f32 v113, v178, v179
v_cvt_pk_bf16_f32 v114, v180, v181
v_cvt_pk_bf16_f32 v115, v182, v183
buffer_store_dwordx4 v[112:115], v1, s[4:7], s48 offen offset:1024 sc1
v_mul_f32 v184, v40, v184
v_mul_f32 v185, v40, v185
v_mul_f32 v186, v40, v186
v_mul_f32 v187, v40, v187
v_mul_f32 v188, v40, v188
v_mul_f32 v189, v40, v189
v_mul_f32 v190, v40, v190
v_mul_f32 v191, v40, v191
v_cvt_pk_bf16_f32 v116, v184, v185
v_cvt_pk_bf16_f32 v117, v186, v187
v_cvt_pk_bf16_f32 v118, v188, v189
v_cvt_pk_bf16_f32 v119, v190, v191
buffer_store_dwordx4 v[116:119], v1, s[4:7], s48 offen offset:1152 sc1
v_mov_b32 v154, s50
s_add_u32 s44, s44, 1048576
s_add_u32 s45, s45, 524288
s_add_u32 s46, s46, 20480
s_add_u32 s48, s48, 524288
s_add_u32 s50, s50, 2
s_sub_u32 s52, s50, 65
s_cmp_lt_u32 s52, 2
s_cbranch_scc0 k_nosw_23
s_add_u32 s44, s44, 8388608
s_add_u32 s48, s48, 1048576
s_add_u32 s46, s46, 393216
k_nosw_23:
s_waitcnt vmcnt(4)
v_min3_u32 v20, v20, v21, v22
v_cmp_le_u32 vcc, s50, v20
s_cbranch_vccnz k_cd_19
s_branch k_top_17
k_out_24:
s_waitcnt vmcnt(0) lgkmcnt(0)
s_barrier
s_add_u32 s30, s30, 80
s_branch k_fin_7
k_p_6:
s_mul_i32 s57, s30, 21846
s_lshr_b32 s57, s57, 16
s_mul_i32 s52, s57, 3
s_sub_u32 s58, s30, s52
s_cmp_eq_u32 s58, 1
s_cselect_b32 s12, s16, s12
s_cselect_b32 s13, s17, s13
s_cmp_eq_u32 s58, 2
s_cselect_b32 s12, s8, s12
s_cselect_b32 s13, s9, s13
v_lshrrev_b32 v1, 8, v0
v_and_b32 v2, 0xf0, v0
v_lshlrev_b32 v3, 5, v1
v_xor_b32 v2, v2, v3
v_lshl_add_u32 v1, v1, 13, v2
s_mul_i32 s52, s3, 1310720
s_lshl_b32 s53, s57, 8
s_add_u32 s52, s52, s53
s_mul_i32 s53, s3, 40960
s_add_u32 m0, s53, 0
s_add_u32 s54, s52, 0
buffer_load_dwordx4 v1, s[12:15], s54 offen lds
s_add_u32 m0, s53, 1024
s_add_u32 s54, s52, 32768
buffer_load_dwordx4 v1, s[12:15], s54 offen lds
s_add_u32 m0, s53, 2048
s_add_u32 s54, s52, 65536
buffer_load_dwordx4 v1, s[12:15], s54 offen lds
s_add_u32 m0, s53, 3072
s_add_u32 s54, s52, 98304
buffer_load_dwordx4 v1, s[12:15], s54 offen lds
s_add_u32 m0, s53, 4096
s_add_u32 s54, s52, 131072
buffer_load_dwordx4 v1, s[12:15], s54 offen lds
s_add_u32 m0, s53, 5120
s_add_u32 s54, s52, 163840
buffer_load_dwordx4 v1, s[12:15], s54 offen lds
s_add_u32 m0, s53, 6144
s_add_u32 s54, s52, 196608
buffer_load_dwordx4 v1, s[12:15], s54 offen lds
s_add_u32 m0, s53, 7168
s_add_u32 s54, s52, 229376
buffer_load_dwordx4 v1, s[12:15], s54 offen lds
s_add_u32 m0, s53, 8192
s_add_u32 s54, s52, 262144
buffer_load_dwordx4 v1, s[12:15], s54 offen lds
s_add_u32 m0, s53, 9216
s_add_u32 s54, s52, 294912
buffer_load_dwordx4 v1, s[12:15], s54 offen lds
s_add_u32 m0, s53, 10240
s_add_u32 s54, s52, 327680
buffer_load_dwordx4 v1, s[12:15], s54 offen lds
s_add_u32 m0, s53, 11264
s_add_u32 s54, s52, 360448
buffer_load_dwordx4 v1, s[12:15], s54 offen lds
s_add_u32 m0, s53, 12288
s_add_u32 s54, s52, 393216
buffer_load_dwordx4 v1, s[12:15], s54 offen lds
s_add_u32 m0, s53, 13312
s_add_u32 s54, s52, 425984
buffer_load_dwordx4 v1, s[12:15], s54 offen lds
s_add_u32 m0, s53, 14336
s_add_u32 s54, s52, 458752
buffer_load_dwordx4 v1, s[12:15], s54 offen lds
s_add_u32 m0, s53, 15360
s_add_u32 s54, s52, 491520
buffer_load_dwordx4 v1, s[12:15], s54 offen lds
s_add_u32 m0, s53, 16384
s_add_u32 s54, s52, 524288
buffer_load_dwordx4 v1, s[12:15], s54 offen lds
s_add_u32 m0, s53, 17408
s_add_u32 s54, s52, 557056
buffer_load_dwordx4 v1, s[12:15], s54 offen lds
s_add_u32 m0, s53, 18432
s_add_u32 s54, s52, 589824
buffer_load_dwordx4 v1, s[12:15], s54 offen lds
s_add_u32 m0, s53, 19456
s_add_u32 s54, s52, 622592
buffer_load_dwordx4 v1, s[12:15], s54 offen lds
s_add_u32 m0, s53, 20480
s_add_u32 s54, s52, 655360
buffer_load_dwordx4 v1, s[12:15], s54 offen lds
s_add_u32 m0, s53, 21504
s_add_u32 s54, s52, 688128
buffer_load_dwordx4 v1, s[12:15], s54 offen lds
s_add_u32 m0, s53, 22528
s_add_u32 s54, s52, 720896
buffer_load_dwordx4 v1, s[12:15], s54 offen lds
s_add_u32 m0, s53, 23552
s_add_u32 s54, s52, 753664
buffer_load_dwordx4 v1, s[12:15], s54 offen lds
s_add_u32 m0, s53, 24576
s_add_u32 s54, s52, 786432
buffer_load_dwordx4 v1, s[12:15], s54 offen lds
s_add_u32 m0, s53, 25600
s_add_u32 s54, s52, 819200
buffer_load_dwordx4 v1, s[12:15], s54 offen lds
s_add_u32 m0, s53, 26624
s_add_u32 s54, s52, 851968
buffer_load_dwordx4 v1, s[12:15], s54 offen lds
s_add_u32 m0, s53, 27648
s_add_u32 s54, s52, 884736
buffer_load_dwordx4 v1, s[12:15], s54 offen lds
s_add_u32 m0, s53, 28672
s_add_u32 s54, s52, 917504
buffer_load_dwordx4 v1, s[12:15], s54 offen lds
s_add_u32 m0, s53, 29696
s_add_u32 s54, s52, 950272
buffer_load_dwordx4 v1, s[12:15], s54 offen lds
s_add_u32 m0, s53, 30720
s_add_u32 s54, s52, 983040
buffer_load_dwordx4 v1, s[12:15], s54 offen lds
s_add_u32 m0, s53, 31744
s_add_u32 s54, s52, 1015808
buffer_load_dwordx4 v1, s[12:15], s54 offen lds
s_add_u32 m0, s53, 32768
s_add_u32 s54, s52, 1048576
buffer_load_dwordx4 v1, s[12:15], s54 offen lds
s_add_u32 m0, s53, 33792
s_add_u32 s54, s52, 1081344
buffer_load_dwordx4 v1, s[12:15], s54 offen lds
s_add_u32 m0, s53, 34816
s_add_u32 s54, s52, 1114112
buffer_load_dwordx4 v1, s[12:15], s54 offen lds
s_add_u32 m0, s53, 35840
s_add_u32 s54, s52, 1146880
buffer_load_dwordx4 v1, s[12:15], s54 offen lds
s_add_u32 m0, s53, 36864
s_add_u32 s54, s52, 1179648
buffer_load_dwordx4 v1, s[12:15], s54 offen lds
s_add_u32 m0, s53, 37888
s_add_u32 s54, s52, 1212416
buffer_load_dwordx4 v1, s[12:15], s54 offen lds
s_add_u32 m0, s53, 38912
s_add_u32 s54, s52, 1245184
buffer_load_dwordx4 v1, s[12:15], s54 offen lds
s_add_u32 m0, s53, 39936
s_add_u32 s54, s52, 1277952
buffer_load_dwordx4 v1, s[12:15], s54 offen lds
v_bfe_u32 v2, v0, 8, 1
v_bfe_u32 v3, v0, 5, 1
s_cmp_eq_u32 s58, 1
s_cselect_b32 s52, 7, 4
s_cselect_b32 s53, 4, 7
v_lshlrev_b32 v2, s52, v2
v_lshlrev_b32 v3, s53, v3
v_add_u32 v2, v2, v3
v_bfe_u32 v3, v0, 4, 1
v_lshl_add_u32 v2, v3, 3, v2
v_bfe_u32 v3, v0, 6, 2
v_xor_b32 v4, s3, v3
v_lshl_add_u32 v2, v4, 5, v2
v_lshl_add_u32 v2, v3, 8, v2
v_lshrrev_b32 v3, 9, v0
v_lshl_add_u32 v2, v3, 11, v2
v_add_u32 v3, 0x10000, v2
v_add_u32 v4, 0x20000, v2
s_waitcnt vmcnt(0)
s_barrier
ds_read_b64_tr_b16 v[96:97], v2 offset:0
ds_read_b64_tr_b16 v[98:99], v2 offset:1024
ds_read_b64_tr_b16 v[100:101], v2 offset:4096
ds_read_b64_tr_b16 v[102:103], v2 offset:5120
ds_read_b64_tr_b16 v[104:105], v2 offset:8192
ds_read_b64_tr_b16 v[106:107], v2 offset:9216
ds_read_b64_tr_b16 v[108:109], v2 offset:12288
ds_read_b64_tr_b16 v[110:111], v2 offset:13312
ds_read_b64_tr_b16 v[112:113], v2 offset:16384
ds_read_b64_tr_b16 v[114:115], v2 offset:17408
ds_read_b64_tr_b16 v[116:117], v2 offset:20480
ds_read_b64_tr_b16 v[118:119], v2 offset:21504
ds_read_b64_tr_b16 v[120:121], v2 offset:24576
ds_read_b64_tr_b16 v[122:123], v2 offset:25600
ds_read_b64_tr_b16 v[124:125], v2 offset:28672
ds_read_b64_tr_b16 v[126:127], v2 offset:29696
ds_read_b64_tr_b16 v[128:129], v2 offset:32768
ds_read_b64_tr_b16 v[130:131], v2 offset:33792
ds_read_b64_tr_b16 v[132:133], v2 offset:36864
ds_read_b64_tr_b16 v[134:135], v2 offset:37888
ds_read_b64_tr_b16 v[136:137], v2 offset:40960
ds_read_b64_tr_b16 v[138:139], v2 offset:41984
ds_read_b64_tr_b16 v[140:141], v2 offset:45056
ds_read_b64_tr_b16 v[142:143], v2 offset:46080
ds_read_b64_tr_b16 v[144:145], v2 offset:49152
ds_read_b64_tr_b16 v[146:147], v2 offset:50176
ds_read_b64_tr_b16 v[148:149], v2 offset:53248
ds_read_b64_tr_b16 v[150:151], v2 offset:54272
ds_read_b64_tr_b16 v[152:153], v2 offset:57344
ds_read_b64_tr_b16 v[154:155], v2 offset:58368
ds_read_b64_tr_b16 v[156:157], v2 offset:61440
ds_read_b64_tr_b16 v[158:159], v2 offset:62464
ds_read_b64_tr_b16 v[160:161], v3 offset:0
ds_read_b64_tr_b16 v[162:163], v3 offset:1024
ds_read_b64_tr_b16 v[164:165], v3 offset:4096
ds_read_b64_tr_b16 v[166:167], v3 offset:5120
ds_read_b64_tr_b16 v[168:169], v3 offset:8192
ds_read_b64_tr_b16 v[170:171], v3 offset:9216
ds_read_b64_tr_b16 v[172:173], v3 offset:12288
ds_read_b64_tr_b16 v[174:175], v3 offset:13312
ds_read_b64_tr_b16 v[176:177], v3 offset:16384
ds_read_b64_tr_b16 v[178:179], v3 offset:17408
ds_read_b64_tr_b16 v[180:181], v3 offset:20480
ds_read_b64_tr_b16 v[182:183], v3 offset:21504
ds_read_b64_tr_b16 v[184:185], v3 offset:24576
ds_read_b64_tr_b16 v[186:187], v3 offset:25600
ds_read_b64_tr_b16 v[188:189], v3 offset:28672
ds_read_b64_tr_b16 v[190:191], v3 offset:29696
ds_read_b64_tr_b16 v[192:193], v3 offset:32768
ds_read_b64_tr_b16 v[194:195], v3 offset:33792
ds_read_b64_tr_b16 v[196:197], v3 offset:36864
ds_read_b64_tr_b16 v[198:199], v3 offset:37888
ds_read_b64_tr_b16 v[200:201], v3 offset:40960
ds_read_b64_tr_b16 v[202:203], v3 offset:41984
ds_read_b64_tr_b16 v[204:205], v3 offset:45056
ds_read_b64_tr_b16 v[206:207], v3 offset:46080
ds_read_b64_tr_b16 v[208:209], v3 offset:49152
ds_read_b64_tr_b16 v[210:211], v3 offset:50176
ds_read_b64_tr_b16 v[212:213], v3 offset:53248
ds_read_b64_tr_b16 v[214:215], v3 offset:54272
ds_read_b64_tr_b16 v[216:217], v3 offset:57344
ds_read_b64_tr_b16 v[218:219], v3 offset:58368
ds_read_b64_tr_b16 v[220:221], v3 offset:61440
ds_read_b64_tr_b16 v[222:223], v3 offset:62464
ds_read_b64_tr_b16 v[224:225], v4 offset:0
ds_read_b64_tr_b16 v[226:227], v4 offset:1024
ds_read_b64_tr_b16 v[228:229], v4 offset:4096
ds_read_b64_tr_b16 v[230:231], v4 offset:5120
ds_read_b64_tr_b16 v[232:233], v4 offset:8192
ds_read_b64_tr_b16 v[234:235], v4 offset:9216
ds_read_b64_tr_b16 v[236:237], v4 offset:12288
ds_read_b64_tr_b16 v[238:239], v4 offset:13312
ds_read_b64_tr_b16 v[240:241], v4 offset:16384
ds_read_b64_tr_b16 v[242:243], v4 offset:17408
ds_read_b64_tr_b16 v[244:245], v4 offset:20480
ds_read_b64_tr_b16 v[246:247], v4 offset:21504
ds_read_b64_tr_b16 v[248:249], v4 offset:24576
ds_read_b64_tr_b16 v[250:251], v4 offset:25600
ds_read_b64_tr_b16 v[252:253], v4 offset:28672
ds_read_b64_tr_b16 v[254:255], v4 offset:29696
s_waitcnt lgkmcnt(0)
s_cmp_lg_u32 s3, 0
s_cbranch_scc1 k_wdd_26
v_mov_b32 v2, 128
k_wd_25:
global_load_dword v3, v2, s[28:29] sc1
s_waitcnt vmcnt(0)
v_readfirstlane_b32 s52, v3
s_cmp_ge_u32 s52, 32
s_cbranch_scc1 k_wdd_26
s_sleep 2
s_sub_u32 s32, s32, 1
s_cmp_gt_i32 s32, 0
s_cbranch_scc1 k_wd_25
k_wdd_26:
s_barrier
s_mul_i32 s46, s3, 10240
s_add_u32 s46, s46, 213909504
s_mul_i32 s45, s3, 10240
s_mov_b32 s44, 0
v_mov_b32 v64, v0
s_add_u32 m0, s45, 0
s_add_u32 s55, s46, 0
buffer_load_dwordx4 v0, s[4:7], s55 offen offset:0 sc1 lds
buffer_load_dwordx4 v0, s[4:7], s55 offen offset:1024 sc1 lds
buffer_load_dwordx4 v0, s[4:7], s55 offen offset:2048 sc1 lds
buffer_load_dwordx4 v0, s[4:7], s55 offen offset:3072 sc1 lds
s_add_u32 m0, s45, 4096
s_add_u32 s55, s46, 4096
buffer_load_dwordx4 v0, s[4:7], s55 offen offset:0 sc1 lds
buffer_load_dwordx4 v0, s[4:7], s55 offen offset:1024 sc1 lds
buffer_load_dwordx4 v0, s[4:7], s55 offen offset:2048 sc1 lds
buffer_load_dwordx4 v0, s[4:7], s55 offen offset:3072 sc1 lds
s_add_u32 m0, s45, 8192
s_add_u32 s55, s46, 8192
buffer_load_dwordx4 v0, s[4:7], s55 offen offset:0 sc1 lds
buffer_load_dwordx4 v0, s[4:7], s55 offen offset:1024 sc1 lds
s_add_u32 s45, s45, 40960
s_cmp_ge_u32 s45, 122880
s_cselect_b32 s55, 122880, 0
s_sub_u32 s45, s45, s55
s_add_u32 s46, s46, 40960
s_add_u32 m0, s45, 0
s_add_u32 s55, s46, 0
buffer_load_dwordx4 v0, s[4:7], s55 offen offset:0 sc1 lds
buffer_load_dwordx4 v0, s[4:7], s55 offen offset:1024 sc1 lds
buffer_load_dwordx4 v0, s[4:7], s55 offen offset:2048 sc1 lds
buffer_load_dwordx4 v0, s[4:7], s55 offen offset:3072 sc1 lds
s_add_u32 m0, s45, 4096
s_add_u32 s55, s46, 4096
buffer_load_dwordx4 v0, s[4:7], s55 offen offset:0 sc1 lds
buffer_load_dwordx4 v0, s[4:7], s55 offen offset:1024 sc1 lds
buffer_load_dwordx4 v0, s[4:7], s55 offen offset:2048 sc1 lds
buffer_load_dwordx4 v0, s[4:7], s55 offen offset:3072 sc1 lds
s_add_u32 m0, s45, 8192
s_add_u32 s55, s46, 8192
buffer_load_dwordx4 v0, s[4:7], s55 offen offset:0 sc1 lds
buffer_load_dwordx4 v0, s[4:7], s55 offen offset:1024 sc1 lds
s_add_u32 s45, s45, 40960
s_cmp_ge_u32 s45, 122880
s_cselect_b32 s55, 122880, 0
s_sub_u32 s45, s45, s55
s_add_u32 s46, s46, 40960
s_waitcnt vmcnt(10)
s_barrier
ds_read_b128 v[8:11], v64 offset:0
ds_read_b128 v[12:15], v64 offset:1024
ds_read_b128 v[16:19], v64 offset:2048
ds_read_b128 v[20:23], v64 offset:3072
v_mov_b32 v1, 0xffff
v_cmp_gt_u32 vcc, 512, v0
s_nop 1
v_cndmask_b32 v1, -1, v1, vcc
s_waitcnt lgkmcnt(3)
v_mfma_f32_32x32x16_bf16 v[32:47], v[8:11], v[96:99], 0
s_waitcnt lgkmcnt(2)
ds_read_b128 v[24:27], v64 offset:4096
v_mfma_f32_32x32x16_bf16 v[32:47], v[12:15], v[100:103], v[32:47]
s_waitcnt lgkmcnt(2)
ds_read_b128 v[8:11], v64 offset:5120
s_add_u32 m0, s45, 0
s_add_u32 s55, s46, 0
buffer_load_dwordx4 v0, s[4:7], s55 offen offset:0 sc1 lds
buffer_load_dwordx4 v0, s[4:7], s55 offen offset:1024 sc1 lds
v_mfma_f32_32x32x16_bf16 v[32:47], v[16:19], v[104:107], v[32:47]
s_waitcnt lgkmcnt(2)
ds_read_b128 v[12:15], v64 offset:6144
buffer_load_dwordx4 v0, s[4:7], s55 offen offset:2048 sc1 lds
buffer_load_dwordx4 v0, s[4:7], s55 offen offset:3072 sc1 lds
v_mfma_f32_32x32x16_bf16 v[32:47], v[20:23], v[108:111], v[32:47]
s_waitcnt lgkmcnt(2)
ds_read_b128 v[16:19], v64 offset:7168
s_add_u32 m0, s45, 4096
s_add_u32 s55, s46, 4096
buffer_load_dwordx4 v0, s[4:7], s55 offen offset:0 sc1 lds
buffer_load_dwordx4 v0, s[4:7], s55 offen offset:1024 sc1 lds
v_mfma_f32_32x32x16_bf16 v[32:47], v[24:27], v[112:115], v[32:47]
s_waitcnt lgkmcnt(2)
ds_read_b128 v[20:23], v64 offset:8192
buffer_load_dwordx4 v0, s[4:7], s55 offen offset:2048 sc1 lds
buffer_load_dwordx4 v0, s[4:7], s55 offen offset:3072 sc1 lds
v_mfma_f32_32x32x16_bf16 v[32:47], v[8:11], v[116:119], v[32:47]
s_waitcnt lgkmcnt(2)
ds_read_b128 v[24:27], v64 offset:9216
s_add_u32 m0, s45, 8192
s_add_u32 s55, s46, 8192
buffer_load_dwordx4 v0, s[4:7], s55 offen offset:0 sc1 lds
buffer_load_dwordx4 v0, s[4:7], s55 offen offset:1024 sc1 lds
v_mfma_f32_32x32x16_bf16 v[32:47], v[12:15], v[120:123], v[32:47]
s_waitcnt lgkmcnt(2)
ds_read_b128 v[8:11], v64 offset:10240
s_add_u32 s45, s45, 40960
s_cmp_ge_u32 s45, 122880
s_cselect_b32 s55, 122880, 0
s_sub_u32 s45, s45, s55
s_add_u32 s46, s46, 40960
v_mfma_f32_32x32x16_bf16 v[32:47], v[16:19], v[124:127], v[32:47]
s_waitcnt lgkmcnt(2)
ds_read_b128 v[12:15], v64 offset:11264
v_mfma_f32_32x32x16_bf16 v[32:47], v[20:23], v[128:131], v[32:47]
s_waitcnt lgkmcnt(2)
ds_read_b128 v[16:19], v64 offset:12288
v_mfma_f32_32x32x16_bf16 v[32:47], v[24:27], v[132:135], v[32:47]
s_waitcnt lgkmcnt(2)
ds_read_b128 v[20:23], v64 offset:13312
v_mfma_f32_32x32x16_bf16 v[32:47], v[8:11], v[136:139], v[32:47]
s_waitcnt lgkmcnt(2)
ds_read_b128 v[24:27], v64 offset:14336
v_mfma_f32_32x32x16_bf16 v[32:47], v[12:15], v[140:143], v[32:47]
s_waitcnt lgkmcnt(2)
ds_read_b128 v[8:11], v64 offset:15360
v_mfma_f32_32x32x16_bf16 v[32:47], v[16:19], v[144:147], v[32:47]
s_waitcnt lgkmcnt(2)
ds_read_b128 v[12:15], v64 offset:16384
v_mfma_f32_32x32x16_bf16 v[32:47], v[20:23], v[148:151], v[32:47]
s_waitcnt lgkmcnt(2)
ds_read_b128 v[16:19], v64 offset:17408
v_mfma_f32_32x32x16_bf16 v[32:47], v[24:27], v[152:155], v[32:47]
s_waitcnt lgkmcnt(2)
ds_read_b128 v[20:23], v64 offset:18432
v_mfma_f32_32x32x16_bf16 v[32:47], v[8:11], v[156:159], v[32:47]
s_waitcnt lgkmcnt(2)
ds_read_b128 v[24:27], v64 offset:19456
v_mfma_f32_32x32x16_bf16 v[32:47], v[12:15], v[160:163], v[32:47]
s_waitcnt lgkmcnt(2)
ds_read_b128 v[8:11], v64 offset:20480
v_mfma_f32_32x32x16_bf16 v[32:47], v[16:19], v[164:167], v[32:47]
s_waitcnt lgkmcnt(2)
ds_read_b128 v[12:15], v64 offset:21504
v_mfma_f32_32x32x16_bf16 v[32:47], v[20:23], v[168:171], v[32:47]
s_waitcnt lgkmcnt(2)
ds_read_b128 v[16:19], v64 offset:22528
v_mfma_f32_32x32x16_bf16 v[32:47], v[24:27], v[172:175], v[32:47]
s_waitcnt lgkmcnt(2)
ds_read_b128 v[20:23], v64 offset:23552
v_mfma_f32_32x32x16_bf16 v[32:47], v[8:11], v[176:179], v[32:47]
s_waitcnt lgkmcnt(2)
ds_read_b128 v[24:27], v64 offset:24576
v_mfma_f32_32x32x16_bf16 v[32:47], v[12:15], v[180:183], v[32:47]
s_waitcnt lgkmcnt(2)
ds_read_b128 v[8:11], v64 offset:25600
v_mfma_f32_32x32x16_bf16 v[32:47], v[16:19], v[184:187], v[32:47]
s_waitcnt lgkmcnt(2)
ds_read_b128 v[12:15], v64 offset:26624
v_mfma_f32_32x32x16_bf16 v[32:47], v[20:23], v[188:191], v[32:47]
s_waitcnt lgkmcnt(2)
ds_read_b128 v[16:19], v64 offset:27648
v_mfma_f32_32x32x16_bf16 v[32:47], v[24:27], v[192:195], v[32:47]
s_waitcnt lgkmcnt(2)
ds_read_b128 v[20:23], v64 offset:28672
v_mfma_f32_32x32x16_bf16 v[32:47], v[8:11], v[196:199], v[32:47]
s_waitcnt lgkmcnt(2)
ds_read_b128 v[24:27], v64 offset:29696
v_mfma_f32_32x32x16_bf16 v[32:47], v[12:15], v[200:203], v[32:47]
s_waitcnt lgkmcnt(2)
ds_read_b128 v[8:11], v64 offset:30720
v_mfma_f32_32x32x16_bf16 v[32:47], v[16:19], v[204:207], v[32:47]
s_waitcnt lgkmcnt(2)
ds_read_b128 v[12:15], v64 offset:31744
v_mfma_f32_32x32x16_bf16 v[32:47], v[20:23], v[208:211], v[32:47]
s_waitcnt lgkmcnt(2)
ds_read_b128 v[16:19], v64 offset:32768
v_mfma_f32_32x32x16_bf16 v[32:47], v[24:27], v[212:215], v[32:47]
s_waitcnt lgkmcnt(2)
ds_read_b128 v[20:23], v64 offset:33792
v_mfma_f32_32x32x16_bf16 v[32:47], v[8:11], v[216:219], v[32:47]
s_waitcnt lgkmcnt(2)
ds_read_b128 v[24:27], v64 offset:34816
v_mfma_f32_32x32x16_bf16 v[32:47], v[12:15], v[220:223], v[32:47]
s_waitcnt lgkmcnt(2)
ds_read_b128 v[8:11], v64 offset:35840
v_mfma_f32_32x32x16_bf16 v[32:47], v[16:19], v[224:227], v[32:47]
s_waitcnt lgkmcnt(2)
ds_read_b128 v[12:15], v64 offset:36864
v_mfma_f32_32x32x16_bf16 v[32:47], v[20:23], v[228:231], v[32:47]
s_waitcnt lgkmcnt(2)
ds_read_b128 v[16:19], v64 offset:37888
v_mfma_f32_32x32x16_bf16 v[32:47], v[24:27], v[232:235], v[32:47]
s_waitcnt lgkmcnt(2)
ds_read_b128 v[20:23], v64 offset:38912
v_mfma_f32_32x32x16_bf16 v[32:47], v[8:11], v[236:239], v[32:47]
s_waitcnt lgkmcnt(2)
ds_read_b128 v[24:27], v64 offset:39936
v_mfma_f32_32x32x16_bf16 v[32:47], v[12:15], v[240:243], v[32:47]
s_add_u32 s44, s44, 1
s_cmp_eq_u32 s44, 3
s_mov_b32 s56, 40960
s_cmov_b32 s56, -81920
s_cselect_b32 s44, 0, s44
v_add_u32 v64, s56, v64
s_waitcnt vmcnt(10) lgkmcnt(2)
s_barrier
ds_read_b128 v[8:11], v64 offset:0
v_mfma_f32_32x32x16_bf16 v[32:47], v[16:19], v[244:247], v[32:47]
s_waitcnt lgkmcnt(2)
ds_read_b128 v[12:15], v64 offset:1024
v_mfma_f32_32x32x16_bf16 v[32:47], v[20:23], v[248:251], v[32:47]
s_waitcnt lgkmcnt(2)
ds_read_b128 v[16:19], v64 offset:2048
v_mfma_f32_32x32x16_bf16 v[32:47], v[24:27], v[252:255], v[32:47]
s_waitcnt lgkmcnt(2)
ds_read_b128 v[20:23], v64 offset:3072
v_mfma_f32_32x32x16_bf16 v[48:63], v[8:11], v[96:99], 0
s_waitcnt lgkmcnt(2)
ds_read_b128 v[24:27], v64 offset:4096
v_mfma_f32_32x32x16_bf16 v[48:63], v[12:15], v[100:103], v[48:63]
s_waitcnt lgkmcnt(2)
ds_read_b128 v[8:11], v64 offset:5120
v_cvt_pk_bf16_f32 v32, v32, v33
v_cvt_pk_bf16_f32 v33, v34, v35
v_mfma_f32_32x32x16_bf16 v[48:63], v[16:19], v[104:107], v[48:63]
s_waitcnt lgkmcnt(2)
ds_read_b128 v[12:15], v64 offset:6144
v_cvt_pk_bf16_f32 v34, v36, v37
v_cvt_pk_bf16_f32 v35, v38, v39
v_mfma_f32_32x32x16_bf16 v[48:63], v[20:23], v[108:111], v[48:63]
s_waitcnt lgkmcnt(2)
ds_read_b128 v[16:19], v64 offset:7168
v_cvt_pk_bf16_f32 v36, v40, v41
v_cvt_pk_bf16_f32 v37, v42, v43
v_mfma_f32_32x32x16_bf16 v[48:63], v[24:27], v[112:115], v[48:63]
s_waitcnt lgkmcnt(2)
ds_read_b128 v[20:23], v64 offset:8192
v_cvt_pk_bf16_f32 v38, v44, v45
v_cvt_pk_bf16_f32 v39, v46, v47
v_mfma_f32_32x32x16_bf16 v[48:63], v[8:11], v[116:119], v[48:63]
s_waitcnt lgkmcnt(2)
ds_read_b128 v[24:27], v64 offset:9216
v_and_b32 v32, v1, v32
v_accvgpr_write_b32 a0, v32
v_mfma_f32_32x32x16_bf16 v[48:63], v[12:15], v[120:123], v[48:63]
s_waitcnt lgkmcnt(2)
ds_read_b128 v[8:11], v64 offset:10240
v_accvgpr_write_b32 a1, v33
v_accvgpr_write_b32 a2, v34
v_mfma_f32_32x32x16_bf16 v[48:63], v[16:19], v[124:127], v[48:63]
s_waitcnt lgkmcnt(2)
ds_read_b128 v[12:15], v64 offset:11264
v_accvgpr_write_b32 a3, v35
v_accvgpr_write_b32 a4, v36
v_mfma_f32_32x32x16_bf16 v[48:63], v[20:23], v[128:131], v[48:63]
s_waitcnt lgkmcnt(2)
ds_read_b128 v[16:19], v64 offset:12288
v_accvgpr_write_b32 a5, v37
v_accvgpr_write_b32 a6, v38
v_mfma_f32_32x32x16_bf16 v[48:63], v[24:27], v[132:135], v[48:63]
s_waitcnt lgkmcnt(2)
ds_read_b128 v[20:23], v64 offset:13312
v_accvgpr_write_b32 a7, v39
s_add_u32 m0, s45, 0
s_add_u32 s55, s46, 0
buffer_load_dwordx4 v0, s[4:7], s55 offen offset:0 sc1 lds
v_mfma_f32_32x32x16_bf16 v[48:63], v[8:11], v[136:139], v[48:63]
s_waitcnt lgkmcnt(2)
ds_read_b128 v[24:27], v64 offset:14336
buffer_load_dwordx4 v0, s[4:7], s55 offen offset:1024 sc1 lds
buffer_load_dwordx4 v0, s[4:7], s55 offen offset:2048 sc1 lds
v_mfma_f32_32x32x16_bf16 v[48:63], v[12:15], v[140:143], v[48:63]
s_waitcnt lgkmcnt(2)
ds_read_b128 v[8:11], v64 offset:15360
buffer_load_dwordx4 v0, s[4:7], s55 offen offset:3072 sc1 lds
s_add_u32 m0, s45, 4096
s_add_u32 s55, s46, 4096
buffer_load_dwordx4 v0, s[4:7], s55 offen offset:0 sc1 lds
v_mfma_f32_32x32x16_bf16 v[48:63], v[16:19], v[144:147], v[48:63]
s_waitcnt lgkmcnt(2)
ds_read_b128 v[12:15], v64 offset:16384
buffer_load_dwordx4 v0, s[4:7], s55 offen offset:1024 sc1 lds
buffer_load_dwordx4 v0, s[4:7], s55 offen offset:2048 sc1 lds
v_mfma_f32_32x32x16_bf16 v[48:63], v[20:23], v[148:151], v[48:63]
s_waitcnt lgkmcnt(2)
ds_read_b128 v[16:19], v64 offset:17408
buffer_load_dwordx4 v0, s[4:7], s55 offen offset:3072 sc1 lds
s_add_u32 m0, s45, 8192
s_add_u32 s55, s46, 8192
buffer_load_dwordx4 v0, s[4:7], s55 offen offset:0 sc1 lds
v_mfma_f32_32x32x16_bf16 v[48:63], v[24:27], v[152:155], v[48:63]
s_waitcnt lgkmcnt(2)
ds_read_b128 v[20:23], v64 offset:18432
buffer_load_dwordx4 v0, s[4:7], s55 offen offset:1024 sc1 lds
s_add_u32 s45, s45, 40960
s_cmp_ge_u32 s45, 122880
s_cselect_b32 s55, 122880, 0
s_sub_u32 s45, s45, s55
v_mfma_f32_32x32x16_bf16 v[48:63], v[8:11], v[156:159], v[48:63]
s_waitcnt lgkmcnt(2)
ds_read_b128 v[24:27], v64 offset:19456
s_add_u32 s46, s46, 40960
v_mfma_f32_32x32x16_bf16 v[48:63], v[12:15], v[160:163], v[48:63]
s_waitcnt lgkmcnt(2)
ds_read_b128 v[8:11], v64 offset:20480
v_mfma_f32_32x32x16_bf16 v[48:63], v[16:19], v[164:167], v[48:63]
s_waitcnt lgkmcnt(2)
ds_read_b128 v[12:15], v64 offset:21504
v_mfma_f32_32x32x16_bf16 v[48:63], v[20:23], v[168:171], v[48:63]
s_waitcnt lgkmcnt(2)
ds_read_b128 v[16:19], v64 offset:22528
v_mfma_f32_32x32x16_bf16 v[48:63], v[24:27], v[172:175], v[48:63]
s_waitcnt lgkmcnt(2)
ds_read_b128 v[20:23], v64 offset:23552
v_mfma_f32_32x32x16_bf16 v[48:63], v[8:11], v[176:179], v[48:63]
s_waitcnt lgkmcnt(2)
ds_read_b128 v[24:27], v64 offset:24576
v_mfma_f32_32x32x16_bf16 v[48:63], v[12:15], v[180:183], v[48:63]
s_waitcnt lgkmcnt(2)
ds_read_b128 v[8:11], v64 offset:25600
v_mfma_f32_32x32x16_bf16 v[48:63], v[16:19], v[184:187], v[48:63]
s_waitcnt lgkmcnt(2)
ds_read_b128 v[12:15], v64 offset:26624
v_mfma_f32_32x32x16_bf16 v[48:63], v[20:23], v[188:191], v[48:63]
s_waitcnt lgkmcnt(2)
ds_read_b128 v[16:19], v64 offset:27648
v_mfma_f32_32x32x16_bf16 v[48:63], v[24:27], v[192:195], v[48:63]
s_waitcnt lgkmcnt(2)
ds_read_b128 v[20:23], v64 offset:28672
v_mfma_f32_32x32x16_bf16 v[48:63], v[8:11], v[196:199], v[48:63]
s_waitcnt lgkmcnt(2)
ds_read_b128 v[24:27], v64 offset:29696
v_mfma_f32_32x32x16_bf16 v[48:63], v[12:15], v[200:203], v[48:63]
s_waitcnt lgkmcnt(2)
ds_read_b128 v[8:11], v64 offset:30720
v_mfma_f32_32x32x16_bf16 v[48:63], v[16:19], v[204:207], v[48:63]
s_waitcnt lgkmcnt(2)
ds_read_b128 v[12:15], v64 offset:31744
v_mfma_f32_32x32x16_bf16 v[48:63], v[20:23], v[208:211], v[48:63]
s_waitcnt lgkmcnt(2)
ds_read_b128 v[16:19], v64 offset:32768
v_mfma_f32_32x32x16_bf16 v[48:63], v[24:27], v[212:215], v[48:63]
s_waitcnt lgkmcnt(2)
ds_read_b128 v[20:23], v64 offset:33792
v_mfma_f32_32x32x16_bf16 v[48:63], v[8:11], v[216:219], v[48:63]
s_waitcnt lgkmcnt(2)
ds_read_b128 v[24:27], v64 offset:34816
v_mfma_f32_32x32x16_bf16 v[48:63], v[12:15], v[220:223], v[48:63]
s_waitcnt lgkmcnt(2)
ds_read_b128 v[8:11], v64 offset:35840
v_mfma_f32_32x32x16_bf16 v[48:63], v[16:19], v[224:227], v[48:63]
s_waitcnt lgkmcnt(2)
ds_read_b128 v[12:15], v64 offset:36864
v_mfma_f32_32x32x16_bf16 v[48:63], v[20:23], v[228:231], v[48:63]
s_waitcnt lgkmcnt(2)
ds_read_b128 v[16:19], v64 offset:37888
v_mfma_f32_32x32x16_bf16 v[48:63], v[24:27], v[232:235], v[48:63]
s_waitcnt lgkmcnt(2)
ds_read_b128 v[20:23], v64 offset:38912
v_mfma_f32_32x32x16_bf16 v[48:63], v[8:11], v[236:239], v[48:63]
s_waitcnt lgkmcnt(2)
ds_read_b128 v[24:27], v64 offset:39936
v_mfma_f32_32x32x16_bf16 v[48:63], v[12:15], v[240:243], v[48:63]
s_add_u32 s44, s44, 1
s_cmp_eq_u32 s44, 3
s_mov_b32 s56, 40960
s_cmov_b32 s56, -81920
s_cselect_b32 s44, 0, s44
v_add_u32 v64, s56, v64
s_waitcnt vmcnt(10) lgkmcnt(2)
s_barrier
ds_read_b128 v[8:11], v64 offset:0
v_mfma_f32_32x32x16_bf16 v[48:63], v[16:19], v[244:247], v[48:63]
s_waitcnt lgkmcnt(2)
ds_read_b128 v[12:15], v64 offset:1024
v_mfma_f32_32x32x16_bf16 v[48:63], v[20:23], v[248:251], v[48:63]
s_waitcnt lgkmcnt(2)
ds_read_b128 v[16:19], v64 offset:2048
v_mfma_f32_32x32x16_bf16 v[48:63], v[24:27], v[252:255], v[48:63]
s_waitcnt lgkmcnt(2)
ds_read_b128 v[20:23], v64 offset:3072
v_mfma_f32_32x32x16_bf16 v[32:47], v[8:11], v[96:99], 0
s_waitcnt lgkmcnt(2)
ds_read_b128 v[24:27], v64 offset:4096
v_mfma_f32_32x32x16_bf16 v[32:47], v[12:15], v[100:103], v[32:47]
s_waitcnt lgkmcnt(2)
ds_read_b128 v[8:11], v64 offset:5120
v_cvt_pk_bf16_f32 v48, v48, v49
v_cvt_pk_bf16_f32 v49, v50, v51
v_mfma_f32_32x32x16_bf16 v[32:47], v[16:19], v[104:107], v[32:47]
s_waitcnt lgkmcnt(2)
ds_read_b128 v[12:15], v64 offset:6144
v_cvt_pk_bf16_f32 v50, v52, v53
v_cvt_pk_bf16_f32 v51, v54, v55
v_mfma_f32_32x32x16_bf16 v[32:47], v[20:23], v[108:111], v[32:47]
s_waitcnt lgkmcnt(2)
ds_read_b128 v[16:19], v64 offset:7168
v_cvt_pk_bf16_f32 v52, v56, v57
v_cvt_pk_bf16_f32 v53, v58, v59
v_mfma_f32_32x32x16_bf16 v[32:47], v[24:27], v[112:115], v[32:47]
s_waitcnt lgkmcnt(2)
ds_read_b128 v[20:23], v64 offset:8192
v_cvt_pk_bf16_f32 v54, v60, v61
v_cvt_pk_bf16_f32 v55, v62, v63
v_mfma_f32_32x32x16_bf16 v[32:47], v[8:11], v[116:119], v[32:47]
s_waitcnt lgkmcnt(2)
ds_read_b128 v[24:27], v64 offset:9216
v_accvgpr_write_b32 a8, v48
v_accvgpr_write_b32 a9, v49
v_mfma_f32_32x32x16_bf16 v[32:47], v[12:15], v[120:123], v[32:47]
s_waitcnt lgkmcnt(2)
ds_read_b128 v[8:11], v64 offset:10240
v_accvgpr_write_b32 a10, v50
v_accvgpr_write_b32 a11, v51
v_mfma_f32_32x32x16_bf16 v[32:47], v[16:19], v[124:127], v[32:47]
s_waitcnt lgkmcnt(2)
ds_read_b128 v[12:15], v64 offset:11264
v_accvgpr_write_b32 a12, v52
v_accvgpr_write_b32 a13, v53
v_mfma_f32_32x32x16_bf16 v[32:47], v[20:23], v[128:131], v[32:47]
s_waitcnt lgkmcnt(2)
ds_read_b128 v[16:19], v64 offset:12288
v_accvgpr_write_b32 a14, v54
v_accvgpr_write_b32 a15, v55
v_mfma_f32_32x32x16_bf16 v[32:47], v[24:27], v[132:135], v[32:47]
s_waitcnt lgkmcnt(2)
ds_read_b128 v[20:23], v64 offset:13312
s_add_u32 m0, s45, 0
s_add_u32 s55, s46, 0
buffer_load_dwordx4 v0, s[4:7], s55 offen offset:0 sc1 lds
buffer_load_dwordx4 v0, s[4:7], s55 offen offset:1024 sc1 lds
v_mfma_f32_32x32x16_bf16 v[32:47], v[8:11], v[136:139], v[32:47]
s_waitcnt lgkmcnt(2)
ds_read_b128 v[24:27], v64 offset:14336
buffer_load_dwordx4 v0, s[4:7], s55 offen offset:2048 sc1 lds
buffer_load_dwordx4 v0, s[4:7], s55 offen offset:3072 sc1 lds
v_mfma_f32_32x32x16_bf16 v[32:47], v[12:15], v[140:143], v[32:47]
s_waitcnt lgkmcnt(2)
ds_read_b128 v[8:11], v64 offset:15360
s_add_u32 m0, s45, 4096
s_add_u32 s55, s46, 4096
buffer_load_dwordx4 v0, s[4:7], s55 offen offset:0 sc1 lds
buffer_load_dwordx4 v0, s[4:7], s55 offen offset:1024 sc1 lds
v_mfma_f32_32x32x16_bf16 v[32:47], v[16:19], v[144:147], v[32:47]
s_waitcnt lgkmcnt(2)
ds_read_b128 v[12:15], v64 offset:16384
buffer_load_dwordx4 v0, s[4:7], s55 offen offset:2048 sc1 lds
buffer_load_dwordx4 v0, s[4:7], s55 offen offset:3072 sc1 lds
v_mfma_f32_32x32x16_bf16 v[32:47], v[20:23], v[148:151], v[32:47]
s_waitcnt lgkmcnt(2)
ds_read_b128 v[16:19], v64 offset:17408
s_add_u32 m0, s45, 8192
s_add_u32 s55, s46, 8192
buffer_load_dwordx4 v0, s[4:7], s55 offen offset:0 sc1 lds
buffer_load_dwordx4 v0, s[4:7], s55 offen offset:1024 sc1 lds
v_mfma_f32_32x32x16_bf16 v[32:47], v[24:27], v[152:155], v[32:47]
s_waitcnt lgkmcnt(2)
ds_read_b128 v[20:23], v64 offset:18432
s_add_u32 s45, s45, 40960
s_cmp_ge_u32 s45, 122880
s_cselect_b32 s55, 122880, 0
s_sub_u32 s45, s45, s55
s_add_u32 s46, s46, 40960
v_mfma_f32_32x32x16_bf16 v[32:47], v[8:11], v[156:159], v[32:47]
s_waitcnt lgkmcnt(2)
ds_read_b128 v[24:27], v64 offset:19456
v_mfma_f32_32x32x16_bf16 v[32:47], v[12:15], v[160:163], v[32:47]
s_waitcnt lgkmcnt(2)
ds_read_b128 v[8:11], v64 offset:20480
v_mfma_f32_32x32x16_bf16 v[32:47], v[16:19], v[164:167], v[32:47]
s_waitcnt lgkmcnt(2)
ds_read_b128 v[12:15], v64 offset:21504
v_mfma_f32_32x32x16_bf16 v[32:47], v[20:23], v[168:171], v[32:47]
s_waitcnt lgkmcnt(2)
ds_read_b128 v[16:19], v64 offset:22528
v_mfma_f32_32x32x16_bf16 v[32:47], v[24:27], v[172:175], v[32:47]
s_waitcnt lgkmcnt(2)
ds_read_b128 v[20:23], v64 offset:23552
v_mfma_f32_32x32x16_bf16 v[32:47], v[8:11], v[176:179], v[32:47]
s_waitcnt lgkmcnt(2)
ds_read_b128 v[24:27], v64 offset:24576
v_mfma_f32_32x32x16_bf16 v[32:47], v[12:15], v[180:183], v[32:47]
s_waitcnt lgkmcnt(2)
ds_read_b128 v[8:11], v64 offset:25600
v_mfma_f32_32x32x16_bf16 v[32:47], v[16:19], v[184:187], v[32:47]
s_waitcnt lgkmcnt(2)
ds_read_b128 v[12:15], v64 offset:26624
v_mfma_f32_32x32x16_bf16 v[32:47], v[20:23], v[188:191], v[32:47]
s_waitcnt lgkmcnt(2)
ds_read_b128 v[16:19], v64 offset:27648
v_mfma_f32_32x32x16_bf16 v[32:47], v[24:27], v[192:195], v[32:47]
s_waitcnt lgkmcnt(2)
ds_read_b128 v[20:23], v64 offset:28672
v_mfma_f32_32x32x16_bf16 v[32:47], v[8:11], v[196:199], v[32:47]
s_waitcnt lgkmcnt(2)
ds_read_b128 v[24:27], v64 offset:29696
v_mfma_f32_32x32x16_bf16 v[32:47], v[12:15], v[200:203], v[32:47]
s_waitcnt lgkmcnt(2)
ds_read_b128 v[8:11], v64 offset:30720
v_mfma_f32_32x32x16_bf16 v[32:47], v[16:19], v[204:207], v[32:47]
s_waitcnt lgkmcnt(2)
ds_read_b128 v[12:15], v64 offset:31744
v_mfma_f32_32x32x16_bf16 v[32:47], v[20:23], v[208:211], v[32:47]
s_waitcnt lgkmcnt(2)
ds_read_b128 v[16:19], v64 offset:32768
v_mfma_f32_32x32x16_bf16 v[32:47], v[24:27], v[212:215], v[32:47]
s_waitcnt lgkmcnt(2)
ds_read_b128 v[20:23], v64 offset:33792
v_mfma_f32_32x32x16_bf16 v[32:47], v[8:11], v[216:219], v[32:47]
s_waitcnt lgkmcnt(2)
ds_read_b128 v[24:27], v64 offset:34816
v_mfma_f32_32x32x16_bf16 v[32:47], v[12:15], v[220:223], v[32:47]
s_waitcnt lgkmcnt(2)
ds_read_b128 v[8:11], v64 offset:35840
v_mfma_f32_32x32x16_bf16 v[32:47], v[16:19], v[224:227], v[32:47]
s_waitcnt lgkmcnt(2)
ds_read_b128 v[12:15], v64 offset:36864
v_mfma_f32_32x32x16_bf16 v[32:47], v[20:23], v[228:231], v[32:47]
s_waitcnt lgkmcnt(2)
ds_read_b128 v[16:19], v64 offset:37888
v_mfma_f32_32x32x16_bf16 v[32:47], v[24:27], v[232:235], v[32:47]
s_waitcnt lgkmcnt(2)
ds_read_b128 v[20:23], v64 offset:38912
v_mfma_f32_32x32x16_bf16 v[32:47], v[8:11], v[236:239], v[32:47]
s_waitcnt lgkmcnt(2)
ds_read_b128 v[24:27], v64 offset:39936
v_mfma_f32_32x32x16_bf16 v[32:47], v[12:15], v[240:243], v[32:47]
s_add_u32 s44, s44, 1
s_cmp_eq_u32 s44, 3
s_mov_b32 s56, 40960
s_cmov_b32 s56, -81920
s_cselect_b32 s44, 0, s44
v_add_u32 v64, s56, v64
s_waitcnt vmcnt(10) lgkmcnt(2)
s_barrier
ds_read_b128 v[8:11], v64 offset:0
v_mfma_f32_32x32x16_bf16 v[32:47], v[16:19], v[244:247], v[32:47]
s_waitcnt lgkmcnt(2)
ds_read_b128 v[12:15], v64 offset:1024
v_mfma_f32_32x32x16_bf16 v[32:47], v[20:23], v[248:251], v[32:47]
s_waitcnt lgkmcnt(2)
ds_read_b128 v[16:19], v64 offset:2048
v_mfma_f32_32x32x16_bf16 v[32:47], v[24:27], v[252:255], v[32:47]
s_waitcnt lgkmcnt(2)
ds_read_b128 v[20:23], v64 offset:3072
v_mfma_f32_32x32x16_bf16 v[48:63], v[8:11], v[96:99], 0
s_waitcnt lgkmcnt(2)
ds_read_b128 v[24:27], v64 offset:4096
v_mfma_f32_32x32x16_bf16 v[48:63], v[12:15], v[100:103], v[48:63]
s_waitcnt lgkmcnt(2)
ds_read_b128 v[8:11], v64 offset:5120
v_cvt_pk_bf16_f32 v32, v32, v33
v_cvt_pk_bf16_f32 v33, v34, v35
v_mfma_f32_32x32x16_bf16 v[48:63], v[16:19], v[104:107], v[48:63]
s_waitcnt lgkmcnt(2)
ds_read_b128 v[12:15], v64 offset:6144
v_cvt_pk_bf16_f32 v34, v36, v37
v_cvt_pk_bf16_f32 v35, v38, v39
v_mfma_f32_32x32x16_bf16 v[48:63], v[20:23], v[108:111], v[48:63]
s_waitcnt lgkmcnt(2)
ds_read_b128 v[16:19], v64 offset:7168
v_cvt_pk_bf16_f32 v36, v40, v41
v_cvt_pk_bf16_f32 v37, v42, v43
v_mfma_f32_32x32x16_bf16 v[48:63], v[24:27], v[112:115], v[48:63]
s_waitcnt lgkmcnt(2)
ds_read_b128 v[20:23], v64 offset:8192
v_cvt_pk_bf16_f32 v38, v44, v45
v_cvt_pk_bf16_f32 v39, v46, v47
v_mfma_f32_32x32x16_bf16 v[48:63], v[8:11], v[116:119], v[48:63]
s_waitcnt lgkmcnt(2)
ds_read_b128 v[24:27], v64 offset:9216
v_accvgpr_write_b32 a16, v32
v_accvgpr_write_b32 a17, v33
v_mfma_f32_32x32x16_bf16 v[48:63], v[12:15], v[120:123], v[48:63]
s_waitcnt lgkmcnt(2)
ds_read_b128 v[8:11], v64 offset:10240
v_accvgpr_write_b32 a18, v34
v_accvgpr_write_b32 a19, v35
v_mfma_f32_32x32x16_bf16 v[48:63], v[16:19], v[124:127], v[48:63]
s_waitcnt lgkmcnt(2)
ds_read_b128 v[12:15], v64 offset:11264
v_accvgpr_write_b32 a20, v36
v_accvgpr_write_b32 a21, v37
v_mfma_f32_32x32x16_bf16 v[48:63], v[20:23], v[128:131], v[48:63]
s_waitcnt lgkmcnt(2)
ds_read_b128 v[16:19], v64 offset:12288
v_accvgpr_write_b32 a22, v38
v_accvgpr_write_b32 a23, v39
v_mfma_f32_32x32x16_bf16 v[48:63], v[24:27], v[132:135], v[48:63]
s_waitcnt lgkmcnt(2)
ds_read_b128 v[20:23], v64 offset:13312
s_add_u32 m0, s45, 0
s_add_u32 s55, s46, 0
buffer_load_dwordx4 v0, s[4:7], s55 offen offset:0 sc1 lds
buffer_load_dwordx4 v0, s[4:7], s55 offen offset:1024 sc1 lds
v_mfma_f32_32x32x16_bf16 v[48:63], v[8:11], v[136:139], v[48:63]
s_waitcnt lgkmcnt(2)
ds_read_b128 v[24:27], v64 offset:14336
buffer_load_dwordx4 v0, s[4:7], s55 offen offset:2048 sc1 lds
buffer_load_dwordx4 v0, s[4:7], s55 offen offset:3072 sc1 lds
v_mfma_f32_32x32x16_bf16 v[48:63], v[12:15], v[140:143], v[48:63]
s_waitcnt lgkmcnt(2)
ds_read_b128 v[8:11], v64 offset:15360
s_add_u32 m0, s45, 4096
s_add_u32 s55, s46, 4096
buffer_load_dwordx4 v0, s[4:7], s55 offen offset:0 sc1 lds
buffer_load_dwordx4 v0, s[4:7], s55 offen offset:1024 sc1 lds
v_mfma_f32_32x32x16_bf16 v[48:63], v[16:19], v[144:147], v[48:63]
s_waitcnt lgkmcnt(2)
ds_read_b128 v[12:15], v64 offset:16384
buffer_load_dwordx4 v0, s[4:7], s55 offen offset:2048 sc1 lds
buffer_load_dwordx4 v0, s[4:7], s55 offen offset:3072 sc1 lds
v_mfma_f32_32x32x16_bf16 v[48:63], v[20:23], v[148:151], v[48:63]
s_waitcnt lgkmcnt(2)
ds_read_b128 v[16:19], v64 offset:17408
s_add_u32 m0, s45, 8192
s_add_u32 s55, s46, 8192
buffer_load_dwordx4 v0, s[4:7], s55 offen offset:0 sc1 lds
buffer_load_dwordx4 v0, s[4:7], s55 offen offset:1024 sc1 lds
v_mfma_f32_32x32x16_bf16 v[48:63], v[24:27], v[152:155], v[48:63]
s_waitcnt lgkmcnt(2)
ds_read_b128 v[20:23], v64 offset:18432
s_add_u32 s45, s45, 40960
s_cmp_ge_u32 s45, 122880
s_cselect_b32 s55, 122880, 0
s_sub_u32 s45, s45, s55
s_add_u32 s46, s46, 40960
v_mfma_f32_32x32x16_bf16 v[48:63], v[8:11], v[156:159], v[48:63]
s_waitcnt lgkmcnt(2)
ds_read_b128 v[24:27], v64 offset:19456
v_mfma_f32_32x32x16_bf16 v[48:63], v[12:15], v[160:163], v[48:63]
s_waitcnt lgkmcnt(2)
ds_read_b128 v[8:11], v64 offset:20480
v_mfma_f32_32x32x16_bf16 v[48:63], v[16:19], v[164:167], v[48:63]
s_waitcnt lgkmcnt(2)
ds_read_b128 v[12:15], v64 offset:21504
v_mfma_f32_32x32x16_bf16 v[48:63], v[20:23], v[168:171], v[48:63]
s_waitcnt lgkmcnt(2)
ds_read_b128 v[16:19], v64 offset:22528
v_mfma_f32_32x32x16_bf16 v[48:63], v[24:27], v[172:175], v[48:63]
s_waitcnt lgkmcnt(2)
ds_read_b128 v[20:23], v64 offset:23552
v_mfma_f32_32x32x16_bf16 v[48:63], v[8:11], v[176:179], v[48:63]
s_waitcnt lgkmcnt(2)
ds_read_b128 v[24:27], v64 offset:24576
v_mfma_f32_32x32x16_bf16 v[48:63], v[12:15], v[180:183], v[48:63]
s_waitcnt lgkmcnt(2)
ds_read_b128 v[8:11], v64 offset:25600
v_mfma_f32_32x32x16_bf16 v[48:63], v[16:19], v[184:187], v[48:63]
s_waitcnt lgkmcnt(2)
ds_read_b128 v[12:15], v64 offset:26624
v_mfma_f32_32x32x16_bf16 v[48:63], v[20:23], v[188:191], v[48:63]
s_waitcnt lgkmcnt(2)
ds_read_b128 v[16:19], v64 offset:27648
v_mfma_f32_32x32x16_bf16 v[48:63], v[24:27], v[192:195], v[48:63]
s_waitcnt lgkmcnt(2)
ds_read_b128 v[20:23], v64 offset:28672
v_mfma_f32_32x32x16_bf16 v[48:63], v[8:11], v[196:199], v[48:63]
s_waitcnt lgkmcnt(2)
ds_read_b128 v[24:27], v64 offset:29696
v_mfma_f32_32x32x16_bf16 v[48:63], v[12:15], v[200:203], v[48:63]
s_waitcnt lgkmcnt(2)
ds_read_b128 v[8:11], v64 offset:30720
v_mfma_f32_32x32x16_bf16 v[48:63], v[16:19], v[204:207], v[48:63]
s_waitcnt lgkmcnt(2)
ds_read_b128 v[12:15], v64 offset:31744
v_mfma_f32_32x32x16_bf16 v[48:63], v[20:23], v[208:211], v[48:63]
s_waitcnt lgkmcnt(2)
ds_read_b128 v[16:19], v64 offset:32768
v_mfma_f32_32x32x16_bf16 v[48:63], v[24:27], v[212:215], v[48:63]
s_waitcnt lgkmcnt(2)
ds_read_b128 v[20:23], v64 offset:33792
v_mfma_f32_32x32x16_bf16 v[48:63], v[8:11], v[216:219], v[48:63]
s_waitcnt lgkmcnt(2)
ds_read_b128 v[24:27], v64 offset:34816
v_mfma_f32_32x32x16_bf16 v[48:63], v[12:15], v[220:223], v[48:63]
s_waitcnt lgkmcnt(2)
ds_read_b128 v[8:11], v64 offset:35840
v_mfma_f32_32x32x16_bf16 v[48:63], v[16:19], v[224:227], v[48:63]
s_waitcnt lgkmcnt(2)
ds_read_b128 v[12:15], v64 offset:36864
v_mfma_f32_32x32x16_bf16 v[48:63], v[20:23], v[228:231], v[48:63]
s_waitcnt lgkmcnt(2)
ds_read_b128 v[16:19], v64 offset:37888
v_mfma_f32_32x32x16_bf16 v[48:63], v[24:27], v[232:235], v[48:63]
s_waitcnt lgkmcnt(2)
ds_read_b128 v[20:23], v64 offset:38912
v_mfma_f32_32x32x16_bf16 v[48:63], v[8:11], v[236:239], v[48:63]
s_waitcnt lgkmcnt(2)
ds_read_b128 v[24:27], v64 offset:39936
v_mfma_f32_32x32x16_bf16 v[48:63], v[12:15], v[240:243], v[48:63]
s_add_u32 s44, s44, 1
s_cmp_eq_u32 s44, 3
s_mov_b32 s56, 40960
s_cmov_b32 s56, -81920
s_cselect_b32 s44, 0, s44
v_add_u32 v64, s56, v64
s_waitcnt vmcnt(10) lgkmcnt(2)
s_barrier
ds_read_b128 v[8:11], v64 offset:0
v_mfma_f32_32x32x16_bf16 v[48:63], v[16:19], v[244:247], v[48:63]
s_waitcnt lgkmcnt(2)
ds_read_b128 v[12:15], v64 offset:1024
v_mfma_f32_32x32x16_bf16 v[48:63], v[20:23], v[248:251], v[48:63]
s_waitcnt lgkmcnt(2)
ds_read_b128 v[16:19], v64 offset:2048
v_mfma_f32_32x32x16_bf16 v[48:63], v[24:27], v[252:255], v[48:63]
s_waitcnt lgkmcnt(2)
ds_read_b128 v[20:23], v64 offset:3072
v_mfma_f32_32x32x16_bf16 v[32:47], v[8:11], v[96:99], 0
s_waitcnt lgkmcnt(2)
ds_read_b128 v[24:27], v64 offset:4096
v_mfma_f32_32x32x16_bf16 v[32:47], v[12:15], v[100:103], v[32:47]
s_waitcnt lgkmcnt(2)
ds_read_b128 v[8:11], v64 offset:5120
v_cvt_pk_bf16_f32 v48, v48, v49
v_cvt_pk_bf16_f32 v49, v50, v51
v_mfma_f32_32x32x16_bf16 v[32:47], v[16:19], v[104:107], v[32:47]
s_waitcnt lgkmcnt(2)
ds_read_b128 v[12:15], v64 offset:6144
v_cvt_pk_bf16_f32 v50, v52, v53
v_cvt_pk_bf16_f32 v51, v54, v55
v_mfma_f32_32x32x16_bf16 v[32:47], v[20:23], v[108:111], v[32:47]
s_waitcnt lgkmcnt(2)
ds_read_b128 v[16:19], v64 offset:7168
v_cvt_pk_bf16_f32 v52, v56, v57
v_cvt_pk_bf16_f32 v53, v58, v59
v_mfma_f32_32x32x16_bf16 v[32:47], v[24:27], v[112:115], v[32:47]
s_waitcnt lgkmcnt(2)
ds_read_b128 v[20:23], v64 offset:8192
v_cvt_pk_bf16_f32 v54, v60, v61
v_cvt_pk_bf16_f32 v55, v62, v63
v_mfma_f32_32x32x16_bf16 v[32:47], v[8:11], v[116:119], v[32:47]
s_waitcnt lgkmcnt(2)
ds_read_b128 v[24:27], v64 offset:9216
v_accvgpr_write_b32 a24, v48
v_accvgpr_write_b32 a25, v49
v_mfma_f32_32x32x16_bf16 v[32:47], v[12:15], v[120:123], v[32:47]
s_waitcnt lgkmcnt(2)
ds_read_b128 v[8:11], v64 offset:10240
v_accvgpr_write_b32 a26, v50
v_accvgpr_write_b32 a27, v51
v_mfma_f32_32x32x16_bf16 v[32:47], v[16:19], v[124:127], v[32:47]
s_waitcnt lgkmcnt(2)
ds_read_b128 v[12:15], v64 offset:11264
v_accvgpr_write_b32 a28, v52
v_accvgpr_write_b32 a29, v53
v_mfma_f32_32x32x16_bf16 v[32:47], v[20:23], v[128:131], v[32:47]
s_waitcnt lgkmcnt(2)
ds_read_b128 v[16:19], v64 offset:12288
v_accvgpr_write_b32 a30, v54
v_accvgpr_write_b32 a31, v55
v_mfma_f32_32x32x16_bf16 v[32:47], v[24:27], v[132:135], v[32:47]
s_waitcnt lgkmcnt(2)
ds_read_b128 v[20:23], v64 offset:13312
s_add_u32 m0, s45, 0
s_add_u32 s55, s46, 0
buffer_load_dwordx4 v0, s[4:7], s55 offen offset:0 sc1 lds
buffer_load_dwordx4 v0, s[4:7], s55 offen offset:1024 sc1 lds
v_mfma_f32_32x32x16_bf16 v[32:47], v[8:11], v[136:139], v[32:47]
s_waitcnt lgkmcnt(2)
ds_read_b128 v[24:27], v64 offset:14336
buffer_load_dwordx4 v0, s[4:7], s55 offen offset:2048 sc1 lds
buffer_load_dwordx4 v0, s[4:7], s55 offen offset:3072 sc1 lds
v_mfma_f32_32x32x16_bf16 v[32:47], v[12:15], v[140:143], v[32:47]
s_waitcnt lgkmcnt(2)
ds_read_b128 v[8:11], v64 offset:15360
s_add_u32 m0, s45, 4096
s_add_u32 s55, s46, 4096
buffer_load_dwordx4 v0, s[4:7], s55 offen offset:0 sc1 lds
buffer_load_dwordx4 v0, s[4:7], s55 offen offset:1024 sc1 lds
v_mfma_f32_32x32x16_bf16 v[32:47], v[16:19], v[144:147], v[32:47]
s_waitcnt lgkmcnt(2)
ds_read_b128 v[12:15], v64 offset:16384
buffer_load_dwordx4 v0, s[4:7], s55 offen offset:2048 sc1 lds
buffer_load_dwordx4 v0, s[4:7], s55 offen offset:3072 sc1 lds
v_mfma_f32_32x32x16_bf16 v[32:47], v[20:23], v[148:151], v[32:47]
s_waitcnt lgkmcnt(2)
ds_read_b128 v[16:19], v64 offset:17408
s_add_u32 m0, s45, 8192
s_add_u32 s55, s46, 8192
buffer_load_dwordx4 v0, s[4:7], s55 offen offset:0 sc1 lds
buffer_load_dwordx4 v0, s[4:7], s55 offen offset:1024 sc1 lds
v_mfma_f32_32x32x16_bf16 v[32:47], v[24:27], v[152:155], v[32:47]
s_waitcnt lgkmcnt(2)
ds_read_b128 v[20:23], v64 offset:18432
s_add_u32 s45, s45, 40960
s_cmp_ge_u32 s45, 122880
s_cselect_b32 s55, 122880, 0
s_sub_u32 s45, s45, s55
s_add_u32 s46, s46, 40960
v_mfma_f32_32x32x16_bf16 v[32:47], v[8:11], v[156:159], v[32:47]
s_waitcnt lgkmcnt(2)
ds_read_b128 v[24:27], v64 offset:19456
v_mfma_f32_32x32x16_bf16 v[32:47], v[12:15], v[160:163], v[32:47]
s_waitcnt lgkmcnt(2)
ds_read_b128 v[8:11], v64 offset:20480
v_mfma_f32_32x32x16_bf16 v[32:47], v[16:19], v[164:167], v[32:47]
s_waitcnt lgkmcnt(2)
ds_read_b128 v[12:15], v64 offset:21504
v_mfma_f32_32x32x16_bf16 v[32:47], v[20:23], v[168:171], v[32:47]
s_waitcnt lgkmcnt(2)
ds_read_b128 v[16:19], v64 offset:22528
v_mfma_f32_32x32x16_bf16 v[32:47], v[24:27], v[172:175], v[32:47]
s_waitcnt lgkmcnt(2)
ds_read_b128 v[20:23], v64 offset:23552
v_mfma_f32_32x32x16_bf16 v[32:47], v[8:11], v[176:179], v[32:47]
s_waitcnt lgkmcnt(2)
ds_read_b128 v[24:27], v64 offset:24576
v_mfma_f32_32x32x16_bf16 v[32:47], v[12:15], v[180:183], v[32:47]
s_waitcnt lgkmcnt(2)
ds_read_b128 v[8:11], v64 offset:25600
v_mfma_f32_32x32x16_bf16 v[32:47], v[16:19], v[184:187], v[32:47]
s_waitcnt lgkmcnt(2)
ds_read_b128 v[12:15], v64 offset:26624
v_mfma_f32_32x32x16_bf16 v[32:47], v[20:23], v[188:191], v[32:47]
s_waitcnt lgkmcnt(2)
ds_read_b128 v[16:19], v64 offset:27648
v_mfma_f32_32x32x16_bf16 v[32:47], v[24:27], v[192:195], v[32:47]
s_waitcnt lgkmcnt(2)
ds_read_b128 v[20:23], v64 offset:28672
v_mfma_f32_32x32x16_bf16 v[32:47], v[8:11], v[196:199], v[32:47]
s_waitcnt lgkmcnt(2)
ds_read_b128 v[24:27], v64 offset:29696
v_mfma_f32_32x32x16_bf16 v[32:47], v[12:15], v[200:203], v[32:47]
s_waitcnt lgkmcnt(2)
ds_read_b128 v[8:11], v64 offset:30720
v_mfma_f32_32x32x16_bf16 v[32:47], v[16:19], v[204:207], v[32:47]
s_waitcnt lgkmcnt(2)
ds_read_b128 v[12:15], v64 offset:31744
v_mfma_f32_32x32x16_bf16 v[32:47], v[20:23], v[208:211], v[32:47]
s_waitcnt lgkmcnt(2)
ds_read_b128 v[16:19], v64 offset:32768
v_mfma_f32_32x32x16_bf16 v[32:47], v[24:27], v[212:215], v[32:47]
s_waitcnt lgkmcnt(2)
ds_read_b128 v[20:23], v64 offset:33792
v_mfma_f32_32x32x16_bf16 v[32:47], v[8:11], v[216:219], v[32:47]
s_waitcnt lgkmcnt(2)
ds_read_b128 v[24:27], v64 offset:34816
v_mfma_f32_32x32x16_bf16 v[32:47], v[12:15], v[220:223], v[32:47]
s_waitcnt lgkmcnt(2)
ds_read_b128 v[8:11], v64 offset:35840
v_mfma_f32_32x32x16_bf16 v[32:47], v[16:19], v[224:227], v[32:47]
s_waitcnt lgkmcnt(2)
ds_read_b128 v[12:15], v64 offset:36864
v_mfma_f32_32x32x16_bf16 v[32:47], v[20:23], v[228:231], v[32:47]
s_waitcnt lgkmcnt(2)
ds_read_b128 v[16:19], v64 offset:37888
v_mfma_f32_32x32x16_bf16 v[32:47], v[24:27], v[232:235], v[32:47]
s_waitcnt lgkmcnt(2)
ds_read_b128 v[20:23], v64 offset:38912
v_mfma_f32_32x32x16_bf16 v[32:47], v[8:11], v[236:239], v[32:47]
s_waitcnt lgkmcnt(2)
ds_read_b128 v[24:27], v64 offset:39936
v_mfma_f32_32x32x16_bf16 v[32:47], v[12:15], v[240:243], v[32:47]
s_add_u32 s44, s44, 1
s_cmp_eq_u32 s44, 3
s_mov_b32 s56, 40960
s_cmov_b32 s56, -81920
s_cselect_b32 s44, 0, s44
v_add_u32 v64, s56, v64
s_waitcnt vmcnt(10) lgkmcnt(2)
s_barrier
ds_read_b128 v[8:11], v64 offset:0
v_mfma_f32_32x32x16_bf16 v[32:47], v[16:19], v[244:247], v[32:47]
s_waitcnt lgkmcnt(2)
ds_read_b128 v[12:15], v64 offset:1024
v_mfma_f32_32x32x16_bf16 v[32:47], v[20:23], v[248:251], v[32:47]
s_waitcnt lgkmcnt(2)
ds_read_b128 v[16:19], v64 offset:2048
v_mfma_f32_32x32x16_bf16 v[32:47], v[24:27], v[252:255], v[32:47]
s_waitcnt lgkmcnt(2)
ds_read_b128 v[20:23], v64 offset:3072
v_mfma_f32_32x32x16_bf16 v[48:63], v[8:11], v[96:99], 0
s_waitcnt lgkmcnt(2)
ds_read_b128 v[24:27], v64 offset:4096
v_mfma_f32_32x32x16_bf16 v[48:63], v[12:15], v[100:103], v[48:63]
s_waitcnt lgkmcnt(2)
ds_read_b128 v[8:11], v64 offset:5120
v_cvt_pk_bf16_f32 v32, v32, v33
v_cvt_pk_bf16_f32 v33, v34, v35
v_mfma_f32_32x32x16_bf16 v[48:63], v[16:19], v[104:107], v[48:63]
s_waitcnt lgkmcnt(2)
ds_read_b128 v[12:15], v64 offset:6144
v_cvt_pk_bf16_f32 v34, v36, v37
v_cvt_pk_bf16_f32 v35, v38, v39
v_mfma_f32_32x32x16_bf16 v[48:63], v[20:23], v[108:111], v[48:63]
s_waitcnt lgkmcnt(2)
ds_read_b128 v[16:19], v64 offset:7168
v_cvt_pk_bf16_f32 v36, v40, v41
v_cvt_pk_bf16_f32 v37, v42, v43
v_mfma_f32_32x32x16_bf16 v[48:63], v[24:27], v[112:115], v[48:63]
s_waitcnt lgkmcnt(2)
ds_read_b128 v[20:23], v64 offset:8192
v_cvt_pk_bf16_f32 v38, v44, v45
v_cvt_pk_bf16_f32 v39, v46, v47
v_mfma_f32_32x32x16_bf16 v[48:63], v[8:11], v[116:119], v[48:63]
s_waitcnt lgkmcnt(2)
ds_read_b128 v[24:27], v64 offset:9216
v_accvgpr_write_b32 a32, v32
v_accvgpr_write_b32 a33, v33
v_mfma_f32_32x32x16_bf16 v[48:63], v[12:15], v[120:123], v[48:63]
s_waitcnt lgkmcnt(2)
ds_read_b128 v[8:11], v64 offset:10240
v_accvgpr_write_b32 a34, v34
v_accvgpr_write_b32 a35, v35
v_mfma_f32_32x32x16_bf16 v[48:63], v[16:19], v[124:127], v[48:63]
s_waitcnt lgkmcnt(2)
ds_read_b128 v[12:15], v64 offset:11264
v_accvgpr_write_b32 a36, v36
v_accvgpr_write_b32 a37, v37
v_mfma_f32_32x32x16_bf16 v[48:63], v[20:23], v[128:131], v[48:63]
s_waitcnt lgkmcnt(2)
ds_read_b128 v[16:19], v64 offset:12288
v_accvgpr_write_b32 a38, v38
v_accvgpr_write_b32 a39, v39
v_mfma_f32_32x32x16_bf16 v[48:63], v[24:27], v[132:135], v[48:63]
s_waitcnt lgkmcnt(2)
ds_read_b128 v[20:23], v64 offset:13312
s_add_u32 m0, s45, 0
s_add_u32 s55, s46, 0
buffer_load_dwordx4 v0, s[4:7], s55 offen offset:0 sc1 lds
buffer_load_dwordx4 v0, s[4:7], s55 offen offset:1024 sc1 lds
v_mfma_f32_32x32x16_bf16 v[48:63], v[8:11], v[136:139], v[48:63]
s_waitcnt lgkmcnt(2)
ds_read_b128 v[24:27], v64 offset:14336
buffer_load_dwordx4 v0, s[4:7], s55 offen offset:2048 sc1 lds
buffer_load_dwordx4 v0, s[4:7], s55 offen offset:3072 sc1 lds
v_mfma_f32_32x32x16_bf16 v[48:63], v[12:15], v[140:143], v[48:63]
s_waitcnt lgkmcnt(2)
ds_read_b128 v[8:11], v64 offset:15360
s_add_u32 m0, s45, 4096
s_add_u32 s55, s46, 4096
buffer_load_dwordx4 v0, s[4:7], s55 offen offset:0 sc1 lds
buffer_load_dwordx4 v0, s[4:7], s55 offen offset:1024 sc1 lds
v_mfma_f32_32x32x16_bf16 v[48:63], v[16:19], v[144:147], v[48:63]
s_waitcnt lgkmcnt(2)
ds_read_b128 v[12:15], v64 offset:16384
buffer_load_dwordx4 v0, s[4:7], s55 offen offset:2048 sc1 lds
buffer_load_dwordx4 v0, s[4:7], s55 offen offset:3072 sc1 lds
v_mfma_f32_32x32x16_bf16 v[48:63], v[20:23], v[148:151], v[48:63]
s_waitcnt lgkmcnt(2)
ds_read_b128 v[16:19], v64 offset:17408
s_add_u32 m0, s45, 8192
s_add_u32 s55, s46, 8192
buffer_load_dwordx4 v0, s[4:7], s55 offen offset:0 sc1 lds
buffer_load_dwordx4 v0, s[4:7], s55 offen offset:1024 sc1 lds
v_mfma_f32_32x32x16_bf16 v[48:63], v[24:27], v[152:155], v[48:63]
s_waitcnt lgkmcnt(2)
ds_read_b128 v[20:23], v64 offset:18432
s_add_u32 s45, s45, 40960
s_cmp_ge_u32 s45, 122880
s_cselect_b32 s55, 122880, 0
s_sub_u32 s45, s45, s55
s_add_u32 s46, s46, 40960
v_mfma_f32_32x32x16_bf16 v[48:63], v[8:11], v[156:159], v[48:63]
s_waitcnt lgkmcnt(2)
ds_read_b128 v[24:27], v64 offset:19456
v_mfma_f32_32x32x16_bf16 v[48:63], v[12:15], v[160:163], v[48:63]
s_waitcnt lgkmcnt(2)
ds_read_b128 v[8:11], v64 offset:20480
v_mfma_f32_32x32x16_bf16 v[48:63], v[16:19], v[164:167], v[48:63]
s_waitcnt lgkmcnt(2)
ds_read_b128 v[12:15], v64 offset:21504
v_mfma_f32_32x32x16_bf16 v[48:63], v[20:23], v[168:171], v[48:63]
s_waitcnt lgkmcnt(2)
ds_read_b128 v[16:19], v64 offset:22528
v_mfma_f32_32x32x16_bf16 v[48:63], v[24:27], v[172:175], v[48:63]
s_waitcnt lgkmcnt(2)
ds_read_b128 v[20:23], v64 offset:23552
v_mfma_f32_32x32x16_bf16 v[48:63], v[8:11], v[176:179], v[48:63]
s_waitcnt lgkmcnt(2)
ds_read_b128 v[24:27], v64 offset:24576
v_mfma_f32_32x32x16_bf16 v[48:63], v[12:15], v[180:183], v[48:63]
s_waitcnt lgkmcnt(2)
ds_read_b128 v[8:11], v64 offset:25600
v_mfma_f32_32x32x16_bf16 v[48:63], v[16:19], v[184:187], v[48:63]
s_waitcnt lgkmcnt(2)
ds_read_b128 v[12:15], v64 offset:26624
v_mfma_f32_32x32x16_bf16 v[48:63], v[20:23], v[188:191], v[48:63]
s_waitcnt lgkmcnt(2)
ds_read_b128 v[16:19], v64 offset:27648
v_mfma_f32_32x32x16_bf16 v[48:63], v[24:27], v[192:195], v[48:63]
s_waitcnt lgkmcnt(2)
ds_read_b128 v[20:23], v64 offset:28672
v_mfma_f32_32x32x16_bf16 v[48:63], v[8:11], v[196:199], v[48:63]
s_waitcnt lgkmcnt(2)
ds_read_b128 v[24:27], v64 offset:29696
v_mfma_f32_32x32x16_bf16 v[48:63], v[12:15], v[200:203], v[48:63]
s_waitcnt lgkmcnt(2)
ds_read_b128 v[8:11], v64 offset:30720
v_mfma_f32_32x32x16_bf16 v[48:63], v[16:19], v[204:207], v[48:63]
s_waitcnt lgkmcnt(2)
ds_read_b128 v[12:15], v64 offset:31744
v_mfma_f32_32x32x16_bf16 v[48:63], v[20:23], v[208:211], v[48:63]
s_waitcnt lgkmcnt(2)
ds_read_b128 v[16:19], v64 offset:32768
v_mfma_f32_32x32x16_bf16 v[48:63], v[24:27], v[212:215], v[48:63]
s_waitcnt lgkmcnt(2)
ds_read_b128 v[20:23], v64 offset:33792
v_mfma_f32_32x32x16_bf16 v[48:63], v[8:11], v[216:219], v[48:63]
s_waitcnt lgkmcnt(2)
ds_read_b128 v[24:27], v64 offset:34816
v_mfma_f32_32x32x16_bf16 v[48:63], v[12:15], v[220:223], v[48:63]
s_waitcnt lgkmcnt(2)
ds_read_b128 v[8:11], v64 offset:35840
v_mfma_f32_32x32x16_bf16 v[48:63], v[16:19], v[224:227], v[48:63]
s_waitcnt lgkmcnt(2)
ds_read_b128 v[12:15], v64 offset:36864
v_mfma_f32_32x32x16_bf16 v[48:63], v[20:23], v[228:231], v[48:63]
s_waitcnt lgkmcnt(2)
ds_read_b128 v[16:19], v64 offset:37888
v_mfma_f32_32x32x16_bf16 v[48:63], v[24:27], v[232:235], v[48:63]
s_waitcnt lgkmcnt(2)
ds_read_b128 v[20:23], v64 offset:38912
v_mfma_f32_32x32x16_bf16 v[48:63], v[8:11], v[236:239], v[48:63]
s_waitcnt lgkmcnt(2)
ds_read_b128 v[24:27], v64 offset:39936
v_mfma_f32_32x32x16_bf16 v[48:63], v[12:15], v[240:243], v[48:63]
s_add_u32 s44, s44, 1
s_cmp_eq_u32 s44, 3
s_mov_b32 s56, 40960
s_cmov_b32 s56, -81920
s_cselect_b32 s44, 0, s44
v_add_u32 v64, s56, v64
s_waitcnt vmcnt(10) lgkmcnt(2)
s_barrier
ds_read_b128 v[8:11], v64 offset:0
v_mfma_f32_32x32x16_bf16 v[48:63], v[16:19], v[244:247], v[48:63]
s_waitcnt lgkmcnt(2)
ds_read_b128 v[12:15], v64 offset:1024
v_mfma_f32_32x32x16_bf16 v[48:63], v[20:23], v[248:251], v[48:63]
s_waitcnt lgkmcnt(2)
ds_read_b128 v[16:19], v64 offset:2048
v_mfma_f32_32x32x16_bf16 v[48:63], v[24:27], v[252:255], v[48:63]
s_waitcnt lgkmcnt(2)
ds_read_b128 v[20:23], v64 offset:3072
v_mfma_f32_32x32x16_bf16 v[32:47], v[8:11], v[96:99], 0
s_waitcnt lgkmcnt(2)
ds_read_b128 v[24:27], v64 offset:4096
v_mfma_f32_32x32x16_bf16 v[32:47], v[12:15], v[100:103], v[32:47]
s_waitcnt lgkmcnt(2)
ds_read_b128 v[8:11], v64 offset:5120
v_cvt_pk_bf16_f32 v48, v48, v49
v_cvt_pk_bf16_f32 v49, v50, v51
v_mfma_f32_32x32x16_bf16 v[32:47], v[16:19], v[104:107], v[32:47]
s_waitcnt lgkmcnt(2)
ds_read_b128 v[12:15], v64 offset:6144
v_cvt_pk_bf16_f32 v50, v52, v53
v_cvt_pk_bf16_f32 v51, v54, v55
v_mfma_f32_32x32x16_bf16 v[32:47], v[20:23], v[108:111], v[32:47]
s_waitcnt lgkmcnt(2)
ds_read_b128 v[16:19], v64 offset:7168
v_cvt_pk_bf16_f32 v52, v56, v57
v_cvt_pk_bf16_f32 v53, v58, v59
v_mfma_f32_32x32x16_bf16 v[32:47], v[24:27], v[112:115], v[32:47]
s_waitcnt lgkmcnt(2)
ds_read_b128 v[20:23], v64 offset:8192
v_cvt_pk_bf16_f32 v54, v60, v61
v_cvt_pk_bf16_f32 v55, v62, v63
v_mfma_f32_32x32x16_bf16 v[32:47], v[8:11], v[116:119], v[32:47]
s_waitcnt lgkmcnt(2)
ds_read_b128 v[24:27], v64 offset:9216
v_accvgpr_write_b32 a40, v48
v_accvgpr_write_b32 a41, v49
v_mfma_f32_32x32x16_bf16 v[32:47], v[12:15], v[120:123], v[32:47]
s_waitcnt lgkmcnt(2)
ds_read_b128 v[8:11], v64 offset:10240
v_accvgpr_write_b32 a42, v50
v_accvgpr_write_b32 a43, v51
v_mfma_f32_32x32x16_bf16 v[32:47], v[16:19], v[124:127], v[32:47]
s_waitcnt lgkmcnt(2)
ds_read_b128 v[12:15], v64 offset:11264
v_accvgpr_write_b32 a44, v52
v_accvgpr_write_b32 a45, v53
v_mfma_f32_32x32x16_bf16 v[32:47], v[20:23], v[128:131], v[32:47]
s_waitcnt lgkmcnt(2)
ds_read_b128 v[16:19], v64 offset:12288
v_accvgpr_write_b32 a46, v54
v_accvgpr_write_b32 a47, v55
v_mfma_f32_32x32x16_bf16 v[32:47], v[24:27], v[132:135], v[32:47]
s_waitcnt lgkmcnt(2)
ds_read_b128 v[20:23], v64 offset:13312
s_add_u32 m0, s45, 0
s_add_u32 s55, s46, 0
buffer_load_dwordx4 v0, s[4:7], s55 offen offset:0 sc1 lds
buffer_load_dwordx4 v0, s[4:7], s55 offen offset:1024 sc1 lds
v_mfma_f32_32x32x16_bf16 v[32:47], v[8:11], v[136:139], v[32:47]
s_waitcnt lgkmcnt(2)
ds_read_b128 v[24:27], v64 offset:14336
buffer_load_dwordx4 v0, s[4:7], s55 offen offset:2048 sc1 lds
buffer_load_dwordx4 v0, s[4:7], s55 offen offset:3072 sc1 lds
v_mfma_f32_32x32x16_bf16 v[32:47], v[12:15], v[140:143], v[32:47]
s_waitcnt lgkmcnt(2)
ds_read_b128 v[8:11], v64 offset:15360
s_add_u32 m0, s45, 4096
s_add_u32 s55, s46, 4096
buffer_load_dwordx4 v0, s[4:7], s55 offen offset:0 sc1 lds
buffer_load_dwordx4 v0, s[4:7], s55 offen offset:1024 sc1 lds
v_mfma_f32_32x32x16_bf16 v[32:47], v[16:19], v[144:147], v[32:47]
s_waitcnt lgkmcnt(2)
ds_read_b128 v[12:15], v64 offset:16384
buffer_load_dwordx4 v0, s[4:7], s55 offen offset:2048 sc1 lds
buffer_load_dwordx4 v0, s[4:7], s55 offen offset:3072 sc1 lds
v_mfma_f32_32x32x16_bf16 v[32:47], v[20:23], v[148:151], v[32:47]
s_waitcnt lgkmcnt(2)
ds_read_b128 v[16:19], v64 offset:17408
s_add_u32 m0, s45, 8192
s_add_u32 s55, s46, 8192
buffer_load_dwordx4 v0, s[4:7], s55 offen offset:0 sc1 lds
buffer_load_dwordx4 v0, s[4:7], s55 offen offset:1024 sc1 lds
v_mfma_f32_32x32x16_bf16 v[32:47], v[24:27], v[152:155], v[32:47]
s_waitcnt lgkmcnt(2)
ds_read_b128 v[20:23], v64 offset:18432
s_add_u32 s45, s45, 40960
s_cmp_ge_u32 s45, 122880
s_cselect_b32 s55, 122880, 0
s_sub_u32 s45, s45, s55
s_add_u32 s46, s46, 40960
v_mfma_f32_32x32x16_bf16 v[32:47], v[8:11], v[156:159], v[32:47]
s_waitcnt lgkmcnt(2)
ds_read_b128 v[24:27], v64 offset:19456
v_mfma_f32_32x32x16_bf16 v[32:47], v[12:15], v[160:163], v[32:47]
s_waitcnt lgkmcnt(2)
ds_read_b128 v[8:11], v64 offset:20480
v_mfma_f32_32x32x16_bf16 v[32:47], v[16:19], v[164:167], v[32:47]
s_waitcnt lgkmcnt(2)
ds_read_b128 v[12:15], v64 offset:21504
v_mfma_f32_32x32x16_bf16 v[32:47], v[20:23], v[168:171], v[32:47]
s_waitcnt lgkmcnt(2)
ds_read_b128 v[16:19], v64 offset:22528
v_mfma_f32_32x32x16_bf16 v[32:47], v[24:27], v[172:175], v[32:47]
s_waitcnt lgkmcnt(2)
ds_read_b128 v[20:23], v64 offset:23552
v_mfma_f32_32x32x16_bf16 v[32:47], v[8:11], v[176:179], v[32:47]
s_waitcnt lgkmcnt(2)
ds_read_b128 v[24:27], v64 offset:24576
v_mfma_f32_32x32x16_bf16 v[32:47], v[12:15], v[180:183], v[32:47]
s_waitcnt lgkmcnt(2)
ds_read_b128 v[8:11], v64 offset:25600
v_mfma_f32_32x32x16_bf16 v[32:47], v[16:19], v[184:187], v[32:47]
s_waitcnt lgkmcnt(2)
ds_read_b128 v[12:15], v64 offset:26624
v_mfma_f32_32x32x16_bf16 v[32:47], v[20:23], v[188:191], v[32:47]
s_waitcnt lgkmcnt(2)
ds_read_b128 v[16:19], v64 offset:27648
v_mfma_f32_32x32x16_bf16 v[32:47], v[24:27], v[192:195], v[32:47]
s_waitcnt lgkmcnt(2)
ds_read_b128 v[20:23], v64 offset:28672
v_mfma_f32_32x32x16_bf16 v[32:47], v[8:11], v[196:199], v[32:47]
s_waitcnt lgkmcnt(2)
ds_read_b128 v[24:27], v64 offset:29696
v_mfma_f32_32x32x16_bf16 v[32:47], v[12:15], v[200:203], v[32:47]
s_waitcnt lgkmcnt(2)
ds_read_b128 v[8:11], v64 offset:30720
v_mfma_f32_32x32x16_bf16 v[32:47], v[16:19], v[204:207], v[32:47]
s_waitcnt lgkmcnt(2)
ds_read_b128 v[12:15], v64 offset:31744
v_mfma_f32_32x32x16_bf16 v[32:47], v[20:23], v[208:211], v[32:47]
s_waitcnt lgkmcnt(2)
ds_read_b128 v[16:19], v64 offset:32768
v_mfma_f32_32x32x16_bf16 v[32:47], v[24:27], v[212:215], v[32:47]
s_waitcnt lgkmcnt(2)
ds_read_b128 v[20:23], v64 offset:33792
v_mfma_f32_32x32x16_bf16 v[32:47], v[8:11], v[216:219], v[32:47]
s_waitcnt lgkmcnt(2)
ds_read_b128 v[24:27], v64 offset:34816
v_mfma_f32_32x32x16_bf16 v[32:47], v[12:15], v[220:223], v[32:47]
s_waitcnt lgkmcnt(2)
ds_read_b128 v[8:11], v64 offset:35840
v_mfma_f32_32x32x16_bf16 v[32:47], v[16:19], v[224:227], v[32:47]
s_waitcnt lgkmcnt(2)
ds_read_b128 v[12:15], v64 offset:36864
v_mfma_f32_32x32x16_bf16 v[32:47], v[20:23], v[228:231], v[32:47]
s_waitcnt lgkmcnt(2)
ds_read_b128 v[16:19], v64 offset:37888
v_mfma_f32_32x32x16_bf16 v[32:47], v[24:27], v[232:235], v[32:47]
s_waitcnt lgkmcnt(2)
ds_read_b128 v[20:23], v64 offset:38912
v_mfma_f32_32x32x16_bf16 v[32:47], v[8:11], v[236:239], v[32:47]
s_waitcnt lgkmcnt(2)
ds_read_b128 v[24:27], v64 offset:39936
v_mfma_f32_32x32x16_bf16 v[32:47], v[12:15], v[240:243], v[32:47]
s_add_u32 s44, s44, 1
s_cmp_eq_u32 s44, 3
s_mov_b32 s56, 40960
s_cmov_b32 s56, -81920
s_cselect_b32 s44, 0, s44
v_add_u32 v64, s56, v64
s_waitcnt vmcnt(10) lgkmcnt(2)
s_barrier
ds_read_b128 v[8:11], v64 offset:0
v_mfma_f32_32x32x16_bf16 v[32:47], v[16:19], v[244:247], v[32:47]
s_waitcnt lgkmcnt(2)
ds_read_b128 v[12:15], v64 offset:1024
v_mfma_f32_32x32x16_bf16 v[32:47], v[20:23], v[248:251], v[32:47]
s_waitcnt lgkmcnt(2)
ds_read_b128 v[16:19], v64 offset:2048
v_mfma_f32_32x32x16_bf16 v[32:47], v[24:27], v[252:255], v[32:47]
s_waitcnt lgkmcnt(2)
ds_read_b128 v[20:23], v64 offset:3072
v_mfma_f32_32x32x16_bf16 v[48:63], v[8:11], v[96:99], 0
s_waitcnt lgkmcnt(2)
ds_read_b128 v[24:27], v64 offset:4096
v_mfma_f32_32x32x16_bf16 v[48:63], v[12:15], v[100:103], v[48:63]
s_waitcnt lgkmcnt(2)
ds_read_b128 v[8:11], v64 offset:5120
v_cvt_pk_bf16_f32 v32, v32, v33
v_cvt_pk_bf16_f32 v33, v34, v35
v_mfma_f32_32x32x16_bf16 v[48:63], v[16:19], v[104:107], v[48:63]
s_waitcnt lgkmcnt(2)
ds_read_b128 v[12:15], v64 offset:6144
v_cvt_pk_bf16_f32 v34, v36, v37
v_cvt_pk_bf16_f32 v35, v38, v39
v_mfma_f32_32x32x16_bf16 v[48:63], v[20:23], v[108:111], v[48:63]
s_waitcnt lgkmcnt(2)
ds_read_b128 v[16:19], v64 offset:7168
v_cvt_pk_bf16_f32 v36, v40, v41
v_cvt_pk_bf16_f32 v37, v42, v43
v_mfma_f32_32x32x16_bf16 v[48:63], v[24:27], v[112:115], v[48:63]
s_waitcnt lgkmcnt(2)
ds_read_b128 v[20:23], v64 offset:8192
v_cvt_pk_bf16_f32 v38, v44, v45
v_cvt_pk_bf16_f32 v39, v46, v47
v_mfma_f32_32x32x16_bf16 v[48:63], v[8:11], v[116:119], v[48:63]
s_waitcnt lgkmcnt(2)
ds_read_b128 v[24:27], v64 offset:9216
v_accvgpr_write_b32 a48, v32
v_accvgpr_write_b32 a49, v33
v_mfma_f32_32x32x16_bf16 v[48:63], v[12:15], v[120:123], v[48:63]
s_waitcnt lgkmcnt(2)
ds_read_b128 v[8:11], v64 offset:10240
v_accvgpr_write_b32 a50, v34
v_accvgpr_write_b32 a51, v35
v_mfma_f32_32x32x16_bf16 v[48:63], v[16:19], v[124:127], v[48:63]
s_waitcnt lgkmcnt(2)
ds_read_b128 v[12:15], v64 offset:11264
v_accvgpr_write_b32 a52, v36
v_accvgpr_write_b32 a53, v37
v_mfma_f32_32x32x16_bf16 v[48:63], v[20:23], v[128:131], v[48:63]
s_waitcnt lgkmcnt(2)
ds_read_b128 v[16:19], v64 offset:12288
v_accvgpr_write_b32 a54, v38
v_accvgpr_write_b32 a55, v39
v_mfma_f32_32x32x16_bf16 v[48:63], v[24:27], v[132:135], v[48:63]
s_waitcnt lgkmcnt(2)
ds_read_b128 v[20:23], v64 offset:13312
s_add_u32 m0, s45, 0
s_add_u32 s55, s46, 0
buffer_load_dwordx4 v0, s[4:7], s55 offen offset:0 sc1 lds
buffer_load_dwordx4 v0, s[4:7], s55 offen offset:1024 sc1 lds
v_mfma_f32_32x32x16_bf16 v[48:63], v[8:11], v[136:139], v[48:63]
s_waitcnt lgkmcnt(2)
ds_read_b128 v[24:27], v64 offset:14336
buffer_load_dwordx4 v0, s[4:7], s55 offen offset:2048 sc1 lds
buffer_load_dwordx4 v0, s[4:7], s55 offen offset:3072 sc1 lds
v_mfma_f32_32x32x16_bf16 v[48:63], v[12:15], v[140:143], v[48:63]
s_waitcnt lgkmcnt(2)
ds_read_b128 v[8:11], v64 offset:15360
s_add_u32 m0, s45, 4096
s_add_u32 s55, s46, 4096
buffer_load_dwordx4 v0, s[4:7], s55 offen offset:0 sc1 lds
buffer_load_dwordx4 v0, s[4:7], s55 offen offset:1024 sc1 lds
v_mfma_f32_32x32x16_bf16 v[48:63], v[16:19], v[144:147], v[48:63]
s_waitcnt lgkmcnt(2)
ds_read_b128 v[12:15], v64 offset:16384
buffer_load_dwordx4 v0, s[4:7], s55 offen offset:2048 sc1 lds
buffer_load_dwordx4 v0, s[4:7], s55 offen offset:3072 sc1 lds
v_mfma_f32_32x32x16_bf16 v[48:63], v[20:23], v[148:151], v[48:63]
s_waitcnt lgkmcnt(2)
ds_read_b128 v[16:19], v64 offset:17408
s_add_u32 m0, s45, 8192
s_add_u32 s55, s46, 8192
buffer_load_dwordx4 v0, s[4:7], s55 offen offset:0 sc1 lds
buffer_load_dwordx4 v0, s[4:7], s55 offen offset:1024 sc1 lds
v_mfma_f32_32x32x16_bf16 v[48:63], v[24:27], v[152:155], v[48:63]
s_waitcnt lgkmcnt(2)
ds_read_b128 v[20:23], v64 offset:18432
s_add_u32 s45, s45, 40960
s_cmp_ge_u32 s45, 122880
s_cselect_b32 s55, 122880, 0
s_sub_u32 s45, s45, s55
s_add_u32 s46, s46, 40960
v_mfma_f32_32x32x16_bf16 v[48:63], v[8:11], v[156:159], v[48:63]
s_waitcnt lgkmcnt(2)
ds_read_b128 v[24:27], v64 offset:19456
v_mfma_f32_32x32x16_bf16 v[48:63], v[12:15], v[160:163], v[48:63]
s_waitcnt lgkmcnt(2)
ds_read_b128 v[8:11], v64 offset:20480
v_mfma_f32_32x32x16_bf16 v[48:63], v[16:19], v[164:167], v[48:63]
s_waitcnt lgkmcnt(2)
ds_read_b128 v[12:15], v64 offset:21504
v_mfma_f32_32x32x16_bf16 v[48:63], v[20:23], v[168:171], v[48:63]
s_waitcnt lgkmcnt(2)
ds_read_b128 v[16:19], v64 offset:22528
v_mfma_f32_32x32x16_bf16 v[48:63], v[24:27], v[172:175], v[48:63]
s_waitcnt lgkmcnt(2)
ds_read_b128 v[20:23], v64 offset:23552
v_mfma_f32_32x32x16_bf16 v[48:63], v[8:11], v[176:179], v[48:63]
s_waitcnt lgkmcnt(2)
ds_read_b128 v[24:27], v64 offset:24576
v_mfma_f32_32x32x16_bf16 v[48:63], v[12:15], v[180:183], v[48:63]
s_waitcnt lgkmcnt(2)
ds_read_b128 v[8:11], v64 offset:25600
v_mfma_f32_32x32x16_bf16 v[48:63], v[16:19], v[184:187], v[48:63]
s_waitcnt lgkmcnt(2)
ds_read_b128 v[12:15], v64 offset:26624
v_mfma_f32_32x32x16_bf16 v[48:63], v[20:23], v[188:191], v[48:63]
s_waitcnt lgkmcnt(2)
ds_read_b128 v[16:19], v64 offset:27648
v_mfma_f32_32x32x16_bf16 v[48:63], v[24:27], v[192:195], v[48:63]
s_waitcnt lgkmcnt(2)
ds_read_b128 v[20:23], v64 offset:28672
v_mfma_f32_32x32x16_bf16 v[48:63], v[8:11], v[196:199], v[48:63]
s_waitcnt lgkmcnt(2)
ds_read_b128 v[24:27], v64 offset:29696
v_mfma_f32_32x32x16_bf16 v[48:63], v[12:15], v[200:203], v[48:63]
s_waitcnt lgkmcnt(2)
ds_read_b128 v[8:11], v64 offset:30720
v_mfma_f32_32x32x16_bf16 v[48:63], v[16:19], v[204:207], v[48:63]
s_waitcnt lgkmcnt(2)
ds_read_b128 v[12:15], v64 offset:31744
v_mfma_f32_32x32x16_bf16 v[48:63], v[20:23], v[208:211], v[48:63]
s_waitcnt lgkmcnt(2)
ds_read_b128 v[16:19], v64 offset:32768
v_mfma_f32_32x32x16_bf16 v[48:63], v[24:27], v[212:215], v[48:63]
s_waitcnt lgkmcnt(2)
ds_read_b128 v[20:23], v64 offset:33792
v_mfma_f32_32x32x16_bf16 v[48:63], v[8:11], v[216:219], v[48:63]
s_waitcnt lgkmcnt(2)
ds_read_b128 v[24:27], v64 offset:34816
v_mfma_f32_32x32x16_bf16 v[48:63], v[12:15], v[220:223], v[48:63]
s_waitcnt lgkmcnt(2)
ds_read_b128 v[8:11], v64 offset:35840
v_mfma_f32_32x32x16_bf16 v[48:63], v[16:19], v[224:227], v[48:63]
s_waitcnt lgkmcnt(2)
ds_read_b128 v[12:15], v64 offset:36864
v_mfma_f32_32x32x16_bf16 v[48:63], v[20:23], v[228:231], v[48:63]
s_waitcnt lgkmcnt(2)
ds_read_b128 v[16:19], v64 offset:37888
v_mfma_f32_32x32x16_bf16 v[48:63], v[24:27], v[232:235], v[48:63]
s_waitcnt lgkmcnt(2)
ds_read_b128 v[20:23], v64 offset:38912
v_mfma_f32_32x32x16_bf16 v[48:63], v[8:11], v[236:239], v[48:63]
s_waitcnt lgkmcnt(2)
ds_read_b128 v[24:27], v64 offset:39936
v_mfma_f32_32x32x16_bf16 v[48:63], v[12:15], v[240:243], v[48:63]
s_add_u32 s44, s44, 1
s_cmp_eq_u32 s44, 3
s_mov_b32 s56, 40960
s_cmov_b32 s56, -81920
s_cselect_b32 s44, 0, s44
v_add_u32 v64, s56, v64
s_waitcnt vmcnt(10) lgkmcnt(2)
s_barrier
ds_read_b128 v[8:11], v64 offset:0
v_mfma_f32_32x32x16_bf16 v[48:63], v[16:19], v[244:247], v[48:63]
s_waitcnt lgkmcnt(2)
ds_read_b128 v[12:15], v64 offset:1024
v_mfma_f32_32x32x16_bf16 v[48:63], v[20:23], v[248:251], v[48:63]
s_waitcnt lgkmcnt(2)
ds_read_b128 v[16:19], v64 offset:2048
v_mfma_f32_32x32x16_bf16 v[48:63], v[24:27], v[252:255], v[48:63]
s_waitcnt lgkmcnt(2)
ds_read_b128 v[20:23], v64 offset:3072
v_mfma_f32_32x32x16_bf16 v[32:47], v[8:11], v[96:99], 0
s_waitcnt lgkmcnt(2)
ds_read_b128 v[24:27], v64 offset:4096
v_mfma_f32_32x32x16_bf16 v[32:47], v[12:15], v[100:103], v[32:47]
s_waitcnt lgkmcnt(2)
ds_read_b128 v[8:11], v64 offset:5120
v_cvt_pk_bf16_f32 v48, v48, v49
v_cvt_pk_bf16_f32 v49, v50, v51
v_mfma_f32_32x32x16_bf16 v[32:47], v[16:19], v[104:107], v[32:47]
s_waitcnt lgkmcnt(2)
ds_read_b128 v[12:15], v64 offset:6144
v_cvt_pk_bf16_f32 v50, v52, v53
v_cvt_pk_bf16_f32 v51, v54, v55
v_mfma_f32_32x32x16_bf16 v[32:47], v[20:23], v[108:111], v[32:47]
s_waitcnt lgkmcnt(2)
ds_read_b128 v[16:19], v64 offset:7168
v_cvt_pk_bf16_f32 v52, v56, v57
v_cvt_pk_bf16_f32 v53, v58, v59
v_mfma_f32_32x32x16_bf16 v[32:47], v[24:27], v[112:115], v[32:47]
s_waitcnt lgkmcnt(2)
ds_read_b128 v[20:23], v64 offset:8192
v_cvt_pk_bf16_f32 v54, v60, v61
v_cvt_pk_bf16_f32 v55, v62, v63
v_mfma_f32_32x32x16_bf16 v[32:47], v[8:11], v[116:119], v[32:47]
s_waitcnt lgkmcnt(2)
ds_read_b128 v[24:27], v64 offset:9216
v_accvgpr_write_b32 a56, v48
v_accvgpr_write_b32 a57, v49
v_mfma_f32_32x32x16_bf16 v[32:47], v[12:15], v[120:123], v[32:47]
s_waitcnt lgkmcnt(2)
ds_read_b128 v[8:11], v64 offset:10240
v_accvgpr_write_b32 a58, v50
v_accvgpr_write_b32 a59, v51
v_mfma_f32_32x32x16_bf16 v[32:47], v[16:19], v[124:127], v[32:47]
s_waitcnt lgkmcnt(2)
ds_read_b128 v[12:15], v64 offset:11264
v_accvgpr_write_b32 a60, v52
v_accvgpr_write_b32 a61, v53
v_mfma_f32_32x32x16_bf16 v[32:47], v[20:23], v[128:131], v[32:47]
s_waitcnt lgkmcnt(2)
ds_read_b128 v[16:19], v64 offset:12288
v_accvgpr_write_b32 a62, v54
v_accvgpr_write_b32 a63, v55
v_mfma_f32_32x32x16_bf16 v[32:47], v[24:27], v[132:135], v[32:47]
s_waitcnt lgkmcnt(2)
ds_read_b128 v[20:23], v64 offset:13312
s_add_u32 m0, s45, 0
s_add_u32 s55, s46, 0
buffer_load_dwordx4 v0, s[4:7], s55 offen offset:0 sc1 lds
buffer_load_dwordx4 v0, s[4:7], s55 offen offset:1024 sc1 lds
v_mfma_f32_32x32x16_bf16 v[32:47], v[8:11], v[136:139], v[32:47]
s_waitcnt lgkmcnt(2)
ds_read_b128 v[24:27], v64 offset:14336
buffer_load_dwordx4 v0, s[4:7], s55 offen offset:2048 sc1 lds
buffer_load_dwordx4 v0, s[4:7], s55 offen offset:3072 sc1 lds
v_mfma_f32_32x32x16_bf16 v[32:47], v[12:15], v[140:143], v[32:47]
s_waitcnt lgkmcnt(2)
ds_read_b128 v[8:11], v64 offset:15360
s_add_u32 m0, s45, 4096
s_add_u32 s55, s46, 4096
buffer_load_dwordx4 v0, s[4:7], s55 offen offset:0 sc1 lds
buffer_load_dwordx4 v0, s[4:7], s55 offen offset:1024 sc1 lds
v_mfma_f32_32x32x16_bf16 v[32:47], v[16:19], v[144:147], v[32:47]
s_waitcnt lgkmcnt(2)
ds_read_b128 v[12:15], v64 offset:16384
buffer_load_dwordx4 v0, s[4:7], s55 offen offset:2048 sc1 lds
buffer_load_dwordx4 v0, s[4:7], s55 offen offset:3072 sc1 lds
v_mfma_f32_32x32x16_bf16 v[32:47], v[20:23], v[148:151], v[32:47]
s_waitcnt lgkmcnt(2)
ds_read_b128 v[16:19], v64 offset:17408
s_add_u32 m0, s45, 8192
s_add_u32 s55, s46, 8192
buffer_load_dwordx4 v0, s[4:7], s55 offen offset:0 sc1 lds
buffer_load_dwordx4 v0, s[4:7], s55 offen offset:1024 sc1 lds
v_mfma_f32_32x32x16_bf16 v[32:47], v[24:27], v[152:155], v[32:47]
s_waitcnt lgkmcnt(2)
ds_read_b128 v[20:23], v64 offset:18432
s_add_u32 s45, s45, 40960
s_cmp_ge_u32 s45, 122880
s_cselect_b32 s55, 122880, 0
s_sub_u32 s45, s45, s55
s_add_u32 s46, s46, 40960
v_mfma_f32_32x32x16_bf16 v[32:47], v[8:11], v[156:159], v[32:47]
s_waitcnt lgkmcnt(2)
ds_read_b128 v[24:27], v64 offset:19456
v_mfma_f32_32x32x16_bf16 v[32:47], v[12:15], v[160:163], v[32:47]
s_waitcnt lgkmcnt(2)
ds_read_b128 v[8:11], v64 offset:20480
v_mfma_f32_32x32x16_bf16 v[32:47], v[16:19], v[164:167], v[32:47]
s_waitcnt lgkmcnt(2)
ds_read_b128 v[12:15], v64 offset:21504
v_mfma_f32_32x32x16_bf16 v[32:47], v[20:23], v[168:171], v[32:47]
s_waitcnt lgkmcnt(2)
ds_read_b128 v[16:19], v64 offset:22528
v_mfma_f32_32x32x16_bf16 v[32:47], v[24:27], v[172:175], v[32:47]
s_waitcnt lgkmcnt(2)
ds_read_b128 v[20:23], v64 offset:23552
v_mfma_f32_32x32x16_bf16 v[32:47], v[8:11], v[176:179], v[32:47]
s_waitcnt lgkmcnt(2)
ds_read_b128 v[24:27], v64 offset:24576
v_mfma_f32_32x32x16_bf16 v[32:47], v[12:15], v[180:183], v[32:47]
s_waitcnt lgkmcnt(2)
ds_read_b128 v[8:11], v64 offset:25600
v_mfma_f32_32x32x16_bf16 v[32:47], v[16:19], v[184:187], v[32:47]
s_waitcnt lgkmcnt(2)
ds_read_b128 v[12:15], v64 offset:26624
v_mfma_f32_32x32x16_bf16 v[32:47], v[20:23], v[188:191], v[32:47]
s_waitcnt lgkmcnt(2)
ds_read_b128 v[16:19], v64 offset:27648
v_mfma_f32_32x32x16_bf16 v[32:47], v[24:27], v[192:195], v[32:47]
s_waitcnt lgkmcnt(2)
ds_read_b128 v[20:23], v64 offset:28672
v_mfma_f32_32x32x16_bf16 v[32:47], v[8:11], v[196:199], v[32:47]
s_waitcnt lgkmcnt(2)
ds_read_b128 v[24:27], v64 offset:29696
v_mfma_f32_32x32x16_bf16 v[32:47], v[12:15], v[200:203], v[32:47]
s_waitcnt lgkmcnt(2)
ds_read_b128 v[8:11], v64 offset:30720
v_mfma_f32_32x32x16_bf16 v[32:47], v[16:19], v[204:207], v[32:47]
s_waitcnt lgkmcnt(2)
ds_read_b128 v[12:15], v64 offset:31744
v_mfma_f32_32x32x16_bf16 v[32:47], v[20:23], v[208:211], v[32:47]
s_waitcnt lgkmcnt(2)
ds_read_b128 v[16:19], v64 offset:32768
v_mfma_f32_32x32x16_bf16 v[32:47], v[24:27], v[212:215], v[32:47]
s_waitcnt lgkmcnt(2)
ds_read_b128 v[20:23], v64 offset:33792
v_mfma_f32_32x32x16_bf16 v[32:47], v[8:11], v[216:219], v[32:47]
s_waitcnt lgkmcnt(2)
ds_read_b128 v[24:27], v64 offset:34816
v_mfma_f32_32x32x16_bf16 v[32:47], v[12:15], v[220:223], v[32:47]
s_waitcnt lgkmcnt(2)
ds_read_b128 v[8:11], v64 offset:35840
v_mfma_f32_32x32x16_bf16 v[32:47], v[16:19], v[224:227], v[32:47]
s_waitcnt lgkmcnt(2)
ds_read_b128 v[12:15], v64 offset:36864
v_mfma_f32_32x32x16_bf16 v[32:47], v[20:23], v[228:231], v[32:47]
s_waitcnt lgkmcnt(2)
ds_read_b128 v[16:19], v64 offset:37888
v_mfma_f32_32x32x16_bf16 v[32:47], v[24:27], v[232:235], v[32:47]
s_waitcnt lgkmcnt(2)
ds_read_b128 v[20:23], v64 offset:38912
v_mfma_f32_32x32x16_bf16 v[32:47], v[8:11], v[236:239], v[32:47]
s_waitcnt lgkmcnt(2)
ds_read_b128 v[24:27], v64 offset:39936
v_mfma_f32_32x32x16_bf16 v[32:47], v[12:15], v[240:243], v[32:47]
s_add_u32 s44, s44, 1
s_cmp_eq_u32 s44, 3
s_mov_b32 s56, 40960
s_cmov_b32 s56, -81920
s_cselect_b32 s44, 0, s44
v_add_u32 v64, s56, v64
s_waitcnt vmcnt(10) lgkmcnt(2)
s_barrier
ds_read_b128 v[8:11], v64 offset:0
v_mfma_f32_32x32x16_bf16 v[32:47], v[16:19], v[244:247], v[32:47]
s_waitcnt lgkmcnt(2)
ds_read_b128 v[12:15], v64 offset:1024
v_mfma_f32_32x32x16_bf16 v[32:47], v[20:23], v[248:251], v[32:47]
s_waitcnt lgkmcnt(2)
ds_read_b128 v[16:19], v64 offset:2048
v_mfma_f32_32x32x16_bf16 v[32:47], v[24:27], v[252:255], v[32:47]
s_waitcnt lgkmcnt(2)
ds_read_b128 v[20:23], v64 offset:3072
v_mfma_f32_32x32x16_bf16 v[48:63], v[8:11], v[96:99], 0
s_waitcnt lgkmcnt(2)
ds_read_b128 v[24:27], v64 offset:4096
v_mfma_f32_32x32x16_bf16 v[48:63], v[12:15], v[100:103], v[48:63]
s_waitcnt lgkmcnt(2)
ds_read_b128 v[8:11], v64 offset:5120
v_cvt_pk_bf16_f32 v32, v32, v33
v_cvt_pk_bf16_f32 v33, v34, v35
v_mfma_f32_32x32x16_bf16 v[48:63], v[16:19], v[104:107], v[48:63]
s_waitcnt lgkmcnt(2)
ds_read_b128 v[12:15], v64 offset:6144
v_cvt_pk_bf16_f32 v34, v36, v37
v_cvt_pk_bf16_f32 v35, v38, v39
v_mfma_f32_32x32x16_bf16 v[48:63], v[20:23], v[108:111], v[48:63]
s_waitcnt lgkmcnt(2)
ds_read_b128 v[16:19], v64 offset:7168
v_cvt_pk_bf16_f32 v36, v40, v41
v_cvt_pk_bf16_f32 v37, v42, v43
v_mfma_f32_32x32x16_bf16 v[48:63], v[24:27], v[112:115], v[48:63]
s_waitcnt lgkmcnt(2)
ds_read_b128 v[20:23], v64 offset:8192
v_cvt_pk_bf16_f32 v38, v44, v45
v_cvt_pk_bf16_f32 v39, v46, v47
v_mfma_f32_32x32x16_bf16 v[48:63], v[8:11], v[116:119], v[48:63]
s_waitcnt lgkmcnt(2)
ds_read_b128 v[24:27], v64 offset:9216
v_accvgpr_write_b32 a64, v32
v_accvgpr_write_b32 a65, v33
v_mfma_f32_32x32x16_bf16 v[48:63], v[12:15], v[120:123], v[48:63]
s_waitcnt lgkmcnt(2)
ds_read_b128 v[8:11], v64 offset:10240
v_accvgpr_write_b32 a66, v34
v_accvgpr_write_b32 a67, v35
v_mfma_f32_32x32x16_bf16 v[48:63], v[16:19], v[124:127], v[48:63]
s_waitcnt lgkmcnt(2)
ds_read_b128 v[12:15], v64 offset:11264
v_accvgpr_write_b32 a68, v36
v_accvgpr_write_b32 a69, v37
v_mfma_f32_32x32x16_bf16 v[48:63], v[20:23], v[128:131], v[48:63]
s_waitcnt lgkmcnt(2)
ds_read_b128 v[16:19], v64 offset:12288
v_accvgpr_write_b32 a70, v38
v_accvgpr_write_b32 a71, v39
v_mfma_f32_32x32x16_bf16 v[48:63], v[24:27], v[132:135], v[48:63]
s_waitcnt lgkmcnt(2)
ds_read_b128 v[20:23], v64 offset:13312
s_add_u32 m0, s45, 0
s_add_u32 s55, s46, 0
buffer_load_dwordx4 v0, s[4:7], s55 offen offset:0 sc1 lds
buffer_load_dwordx4 v0, s[4:7], s55 offen offset:1024 sc1 lds
v_mfma_f32_32x32x16_bf16 v[48:63], v[8:11], v[136:139], v[48:63]
s_waitcnt lgkmcnt(2)
ds_read_b128 v[24:27], v64 offset:14336
buffer_load_dwordx4 v0, s[4:7], s55 offen offset:2048 sc1 lds
buffer_load_dwordx4 v0, s[4:7], s55 offen offset:3072 sc1 lds
v_mfma_f32_32x32x16_bf16 v[48:63], v[12:15], v[140:143], v[48:63]
s_waitcnt lgkmcnt(2)
ds_read_b128 v[8:11], v64 offset:15360
s_add_u32 m0, s45, 4096
s_add_u32 s55, s46, 4096
buffer_load_dwordx4 v0, s[4:7], s55 offen offset:0 sc1 lds
buffer_load_dwordx4 v0, s[4:7], s55 offen offset:1024 sc1 lds
v_mfma_f32_32x32x16_bf16 v[48:63], v[16:19], v[144:147], v[48:63]
s_waitcnt lgkmcnt(2)
ds_read_b128 v[12:15], v64 offset:16384
buffer_load_dwordx4 v0, s[4:7], s55 offen offset:2048 sc1 lds
buffer_load_dwordx4 v0, s[4:7], s55 offen offset:3072 sc1 lds
v_mfma_f32_32x32x16_bf16 v[48:63], v[20:23], v[148:151], v[48:63]
s_waitcnt lgkmcnt(2)
ds_read_b128 v[16:19], v64 offset:17408
s_add_u32 m0, s45, 8192
s_add_u32 s55, s46, 8192
buffer_load_dwordx4 v0, s[4:7], s55 offen offset:0 sc1 lds
buffer_load_dwordx4 v0, s[4:7], s55 offen offset:1024 sc1 lds
v_mfma_f32_32x32x16_bf16 v[48:63], v[24:27], v[152:155], v[48:63]
s_waitcnt lgkmcnt(2)
ds_read_b128 v[20:23], v64 offset:18432
s_add_u32 s45, s45, 40960
s_cmp_ge_u32 s45, 122880
s_cselect_b32 s55, 122880, 0
s_sub_u32 s45, s45, s55
s_add_u32 s46, s46, 40960
v_mfma_f32_32x32x16_bf16 v[48:63], v[8:11], v[156:159], v[48:63]
s_waitcnt lgkmcnt(2)
ds_read_b128 v[24:27], v64 offset:19456
v_mfma_f32_32x32x16_bf16 v[48:63], v[12:15], v[160:163], v[48:63]
s_waitcnt lgkmcnt(2)
ds_read_b128 v[8:11], v64 offset:20480
v_mfma_f32_32x32x16_bf16 v[48:63], v[16:19], v[164:167], v[48:63]
s_waitcnt lgkmcnt(2)
ds_read_b128 v[12:15], v64 offset:21504
v_mfma_f32_32x32x16_bf16 v[48:63], v[20:23], v[168:171], v[48:63]
s_waitcnt lgkmcnt(2)
ds_read_b128 v[16:19], v64 offset:22528
v_mfma_f32_32x32x16_bf16 v[48:63], v[24:27], v[172:175], v[48:63]
s_waitcnt lgkmcnt(2)
ds_read_b128 v[20:23], v64 offset:23552
v_mfma_f32_32x32x16_bf16 v[48:63], v[8:11], v[176:179], v[48:63]
s_waitcnt lgkmcnt(2)
ds_read_b128 v[24:27], v64 offset:24576
v_mfma_f32_32x32x16_bf16 v[48:63], v[12:15], v[180:183], v[48:63]
s_waitcnt lgkmcnt(2)
ds_read_b128 v[8:11], v64 offset:25600
v_mfma_f32_32x32x16_bf16 v[48:63], v[16:19], v[184:187], v[48:63]
s_waitcnt lgkmcnt(2)
ds_read_b128 v[12:15], v64 offset:26624
v_mfma_f32_32x32x16_bf16 v[48:63], v[20:23], v[188:191], v[48:63]
s_waitcnt lgkmcnt(2)
ds_read_b128 v[16:19], v64 offset:27648
v_mfma_f32_32x32x16_bf16 v[48:63], v[24:27], v[192:195], v[48:63]
s_waitcnt lgkmcnt(2)
ds_read_b128 v[20:23], v64 offset:28672
v_mfma_f32_32x32x16_bf16 v[48:63], v[8:11], v[196:199], v[48:63]
s_waitcnt lgkmcnt(2)
ds_read_b128 v[24:27], v64 offset:29696
v_mfma_f32_32x32x16_bf16 v[48:63], v[12:15], v[200:203], v[48:63]
s_waitcnt lgkmcnt(2)
ds_read_b128 v[8:11], v64 offset:30720
v_mfma_f32_32x32x16_bf16 v[48:63], v[16:19], v[204:207], v[48:63]
s_waitcnt lgkmcnt(2)
ds_read_b128 v[12:15], v64 offset:31744
v_mfma_f32_32x32x16_bf16 v[48:63], v[20:23], v[208:211], v[48:63]
s_waitcnt lgkmcnt(2)
ds_read_b128 v[16:19], v64 offset:32768
v_mfma_f32_32x32x16_bf16 v[48:63], v[24:27], v[212:215], v[48:63]
s_waitcnt lgkmcnt(2)
ds_read_b128 v[20:23], v64 offset:33792
v_mfma_f32_32x32x16_bf16 v[48:63], v[8:11], v[216:219], v[48:63]
s_waitcnt lgkmcnt(2)
ds_read_b128 v[24:27], v64 offset:34816
v_mfma_f32_32x32x16_bf16 v[48:63], v[12:15], v[220:223], v[48:63]
s_waitcnt lgkmcnt(2)
ds_read_b128 v[8:11], v64 offset:35840
v_mfma_f32_32x32x16_bf16 v[48:63], v[16:19], v[224:227], v[48:63]
s_waitcnt lgkmcnt(2)
ds_read_b128 v[12:15], v64 offset:36864
v_mfma_f32_32x32x16_bf16 v[48:63], v[20:23], v[228:231], v[48:63]
s_waitcnt lgkmcnt(2)
ds_read_b128 v[16:19], v64 offset:37888
v_mfma_f32_32x32x16_bf16 v[48:63], v[24:27], v[232:235], v[48:63]
s_waitcnt lgkmcnt(2)
ds_read_b128 v[20:23], v64 offset:38912
v_mfma_f32_32x32x16_bf16 v[48:63], v[8:11], v[236:239], v[48:63]
s_waitcnt lgkmcnt(2)
ds_read_b128 v[24:27], v64 offset:39936
v_mfma_f32_32x32x16_bf16 v[48:63], v[12:15], v[240:243], v[48:63]
s_add_u32 s44, s44, 1
s_cmp_eq_u32 s44, 3
s_mov_b32 s56, 40960
s_cmov_b32 s56, -81920
s_cselect_b32 s44, 0, s44
v_add_u32 v64, s56, v64
s_waitcnt vmcnt(10) lgkmcnt(2)
s_barrier
ds_read_b128 v[8:11], v64 offset:0
v_mfma_f32_32x32x16_bf16 v[48:63], v[16:19], v[244:247], v[48:63]
s_waitcnt lgkmcnt(2)
ds_read_b128 v[12:15], v64 offset:1024
v_mfma_f32_32x32x16_bf16 v[48:63], v[20:23], v[248:251], v[48:63]
s_waitcnt lgkmcnt(2)
ds_read_b128 v[16:19], v64 offset:2048
v_mfma_f32_32x32x16_bf16 v[48:63], v[24:27], v[252:255], v[48:63]
s_waitcnt lgkmcnt(2)
ds_read_b128 v[20:23], v64 offset:3072
v_mfma_f32_32x32x16_bf16 v[32:47], v[8:11], v[96:99], 0
s_waitcnt lgkmcnt(2)
ds_read_b128 v[24:27], v64 offset:4096
v_mfma_f32_32x32x16_bf16 v[32:47], v[12:15], v[100:103], v[32:47]
s_waitcnt lgkmcnt(2)
ds_read_b128 v[8:11], v64 offset:5120
v_cvt_pk_bf16_f32 v48, v48, v49
v_cvt_pk_bf16_f32 v49, v50, v51
v_mfma_f32_32x32x16_bf16 v[32:47], v[16:19], v[104:107], v[32:47]
s_waitcnt lgkmcnt(2)
ds_read_b128 v[12:15], v64 offset:6144
v_cvt_pk_bf16_f32 v50, v52, v53
v_cvt_pk_bf16_f32 v51, v54, v55
v_mfma_f32_32x32x16_bf16 v[32:47], v[20:23], v[108:111], v[32:47]
s_waitcnt lgkmcnt(2)
ds_read_b128 v[16:19], v64 offset:7168
v_cvt_pk_bf16_f32 v52, v56, v57
v_cvt_pk_bf16_f32 v53, v58, v59
v_mfma_f32_32x32x16_bf16 v[32:47], v[24:27], v[112:115], v[32:47]
s_waitcnt lgkmcnt(2)
ds_read_b128 v[20:23], v64 offset:8192
v_cvt_pk_bf16_f32 v54, v60, v61
v_cvt_pk_bf16_f32 v55, v62, v63
v_mfma_f32_32x32x16_bf16 v[32:47], v[8:11], v[116:119], v[32:47]
s_waitcnt lgkmcnt(2)
ds_read_b128 v[24:27], v64 offset:9216
v_accvgpr_write_b32 a72, v48
v_accvgpr_write_b32 a73, v49
v_mfma_f32_32x32x16_bf16 v[32:47], v[12:15], v[120:123], v[32:47]
s_waitcnt lgkmcnt(2)
ds_read_b128 v[8:11], v64 offset:10240
v_accvgpr_write_b32 a74, v50
v_accvgpr_write_b32 a75, v51
v_mfma_f32_32x32x16_bf16 v[32:47], v[16:19], v[124:127], v[32:47]
s_waitcnt lgkmcnt(2)
ds_read_b128 v[12:15], v64 offset:11264
v_accvgpr_write_b32 a76, v52
v_accvgpr_write_b32 a77, v53
v_mfma_f32_32x32x16_bf16 v[32:47], v[20:23], v[128:131], v[32:47]
s_waitcnt lgkmcnt(2)
ds_read_b128 v[16:19], v64 offset:12288
v_accvgpr_write_b32 a78, v54
v_accvgpr_write_b32 a79, v55
v_mfma_f32_32x32x16_bf16 v[32:47], v[24:27], v[132:135], v[32:47]
s_waitcnt lgkmcnt(2)
ds_read_b128 v[20:23], v64 offset:13312
s_add_u32 m0, s45, 0
s_add_u32 s55, s46, 0
buffer_load_dwordx4 v0, s[4:7], s55 offen offset:0 sc1 lds
buffer_load_dwordx4 v0, s[4:7], s55 offen offset:1024 sc1 lds
v_mfma_f32_32x32x16_bf16 v[32:47], v[8:11], v[136:139], v[32:47]
s_waitcnt lgkmcnt(2)
ds_read_b128 v[24:27], v64 offset:14336
buffer_load_dwordx4 v0, s[4:7], s55 offen offset:2048 sc1 lds
buffer_load_dwordx4 v0, s[4:7], s55 offen offset:3072 sc1 lds
v_mfma_f32_32x32x16_bf16 v[32:47], v[12:15], v[140:143], v[32:47]
s_waitcnt lgkmcnt(2)
ds_read_b128 v[8:11], v64 offset:15360
s_add_u32 m0, s45, 4096
s_add_u32 s55, s46, 4096
buffer_load_dwordx4 v0, s[4:7], s55 offen offset:0 sc1 lds
buffer_load_dwordx4 v0, s[4:7], s55 offen offset:1024 sc1 lds
v_mfma_f32_32x32x16_bf16 v[32:47], v[16:19], v[144:147], v[32:47]
s_waitcnt lgkmcnt(2)
ds_read_b128 v[12:15], v64 offset:16384
buffer_load_dwordx4 v0, s[4:7], s55 offen offset:2048 sc1 lds
buffer_load_dwordx4 v0, s[4:7], s55 offen offset:3072 sc1 lds
v_mfma_f32_32x32x16_bf16 v[32:47], v[20:23], v[148:151], v[32:47]
s_waitcnt lgkmcnt(2)
ds_read_b128 v[16:19], v64 offset:17408
s_add_u32 m0, s45, 8192
s_add_u32 s55, s46, 8192
buffer_load_dwordx4 v0, s[4:7], s55 offen offset:0 sc1 lds
buffer_load_dwordx4 v0, s[4:7], s55 offen offset:1024 sc1 lds
v_mfma_f32_32x32x16_bf16 v[32:47], v[24:27], v[152:155], v[32:47]
s_waitcnt lgkmcnt(2)
ds_read_b128 v[20:23], v64 offset:18432
s_add_u32 s45, s45, 40960
s_cmp_ge_u32 s45, 122880
s_cselect_b32 s55, 122880, 0
s_sub_u32 s45, s45, s55
s_add_u32 s46, s46, 40960
v_mfma_f32_32x32x16_bf16 v[32:47], v[8:11], v[156:159], v[32:47]
s_waitcnt lgkmcnt(2)
ds_read_b128 v[24:27], v64 offset:19456
v_mfma_f32_32x32x16_bf16 v[32:47], v[12:15], v[160:163], v[32:47]
s_waitcnt lgkmcnt(2)
ds_read_b128 v[8:11], v64 offset:20480
v_mfma_f32_32x32x16_bf16 v[32:47], v[16:19], v[164:167], v[32:47]
s_waitcnt lgkmcnt(2)
ds_read_b128 v[12:15], v64 offset:21504
v_mfma_f32_32x32x16_bf16 v[32:47], v[20:23], v[168:171], v[32:47]
s_waitcnt lgkmcnt(2)
ds_read_b128 v[16:19], v64 offset:22528
v_mfma_f32_32x32x16_bf16 v[32:47], v[24:27], v[172:175], v[32:47]
s_waitcnt lgkmcnt(2)
ds_read_b128 v[20:23], v64 offset:23552
v_mfma_f32_32x32x16_bf16 v[32:47], v[8:11], v[176:179], v[32:47]
s_waitcnt lgkmcnt(2)
ds_read_b128 v[24:27], v64 offset:24576
v_mfma_f32_32x32x16_bf16 v[32:47], v[12:15], v[180:183], v[32:47]
s_waitcnt lgkmcnt(2)
ds_read_b128 v[8:11], v64 offset:25600
v_mfma_f32_32x32x16_bf16 v[32:47], v[16:19], v[184:187], v[32:47]
s_waitcnt lgkmcnt(2)
ds_read_b128 v[12:15], v64 offset:26624
v_mfma_f32_32x32x16_bf16 v[32:47], v[20:23], v[188:191], v[32:47]
s_waitcnt lgkmcnt(2)
ds_read_b128 v[16:19], v64 offset:27648
v_mfma_f32_32x32x16_bf16 v[32:47], v[24:27], v[192:195], v[32:47]
s_waitcnt lgkmcnt(2)
ds_read_b128 v[20:23], v64 offset:28672
v_mfma_f32_32x32x16_bf16 v[32:47], v[8:11], v[196:199], v[32:47]
s_waitcnt lgkmcnt(2)
ds_read_b128 v[24:27], v64 offset:29696
v_mfma_f32_32x32x16_bf16 v[32:47], v[12:15], v[200:203], v[32:47]
s_waitcnt lgkmcnt(2)
ds_read_b128 v[8:11], v64 offset:30720
v_mfma_f32_32x32x16_bf16 v[32:47], v[16:19], v[204:207], v[32:47]
s_waitcnt lgkmcnt(2)
ds_read_b128 v[12:15], v64 offset:31744
v_mfma_f32_32x32x16_bf16 v[32:47], v[20:23], v[208:211], v[32:47]
s_waitcnt lgkmcnt(2)
ds_read_b128 v[16:19], v64 offset:32768
v_mfma_f32_32x32x16_bf16 v[32:47], v[24:27], v[212:215], v[32:47]
s_waitcnt lgkmcnt(2)
ds_read_b128 v[20:23], v64 offset:33792
v_mfma_f32_32x32x16_bf16 v[32:47], v[8:11], v[216:219], v[32:47]
s_waitcnt lgkmcnt(2)
ds_read_b128 v[24:27], v64 offset:34816
v_mfma_f32_32x32x16_bf16 v[32:47], v[12:15], v[220:223], v[32:47]
s_waitcnt lgkmcnt(2)
ds_read_b128 v[8:11], v64 offset:35840
v_mfma_f32_32x32x16_bf16 v[32:47], v[16:19], v[224:227], v[32:47]
s_waitcnt lgkmcnt(2)
ds_read_b128 v[12:15], v64 offset:36864
v_mfma_f32_32x32x16_bf16 v[32:47], v[20:23], v[228:231], v[32:47]
s_waitcnt lgkmcnt(2)
ds_read_b128 v[16:19], v64 offset:37888
v_mfma_f32_32x32x16_bf16 v[32:47], v[24:27], v[232:235], v[32:47]
s_waitcnt lgkmcnt(2)
ds_read_b128 v[20:23], v64 offset:38912
v_mfma_f32_32x32x16_bf16 v[32:47], v[8:11], v[236:239], v[32:47]
s_waitcnt lgkmcnt(2)
ds_read_b128 v[24:27], v64 offset:39936
v_mfma_f32_32x32x16_bf16 v[32:47], v[12:15], v[240:243], v[32:47]
s_add_u32 s44, s44, 1
s_cmp_eq_u32 s44, 3
s_mov_b32 s56, 40960
s_cmov_b32 s56, -81920
s_cselect_b32 s44, 0, s44
v_add_u32 v64, s56, v64
s_waitcnt vmcnt(10) lgkmcnt(2)
s_barrier
ds_read_b128 v[8:11], v64 offset:0
v_mfma_f32_32x32x16_bf16 v[32:47], v[16:19], v[244:247], v[32:47]
s_waitcnt lgkmcnt(2)
ds_read_b128 v[12:15], v64 offset:1024
v_mfma_f32_32x32x16_bf16 v[32:47], v[20:23], v[248:251], v[32:47]
s_waitcnt lgkmcnt(2)
ds_read_b128 v[16:19], v64 offset:2048
v_mfma_f32_32x32x16_bf16 v[32:47], v[24:27], v[252:255], v[32:47]
s_waitcnt lgkmcnt(2)
ds_read_b128 v[20:23], v64 offset:3072
v_mfma_f32_32x32x16_bf16 v[48:63], v[8:11], v[96:99], 0
s_waitcnt lgkmcnt(2)
ds_read_b128 v[24:27], v64 offset:4096
v_mfma_f32_32x32x16_bf16 v[48:63], v[12:15], v[100:103], v[48:63]
s_waitcnt lgkmcnt(2)
ds_read_b128 v[8:11], v64 offset:5120
v_cvt_pk_bf16_f32 v32, v32, v33
v_cvt_pk_bf16_f32 v33, v34, v35
v_mfma_f32_32x32x16_bf16 v[48:63], v[16:19], v[104:107], v[48:63]
s_waitcnt lgkmcnt(2)
ds_read_b128 v[12:15], v64 offset:6144
v_cvt_pk_bf16_f32 v34, v36, v37
v_cvt_pk_bf16_f32 v35, v38, v39
v_mfma_f32_32x32x16_bf16 v[48:63], v[20:23], v[108:111], v[48:63]
s_waitcnt lgkmcnt(2)
ds_read_b128 v[16:19], v64 offset:7168
v_cvt_pk_bf16_f32 v36, v40, v41
v_cvt_pk_bf16_f32 v37, v42, v43
v_mfma_f32_32x32x16_bf16 v[48:63], v[24:27], v[112:115], v[48:63]
s_waitcnt lgkmcnt(2)
ds_read_b128 v[20:23], v64 offset:8192
v_cvt_pk_bf16_f32 v38, v44, v45
v_cvt_pk_bf16_f32 v39, v46, v47
v_mfma_f32_32x32x16_bf16 v[48:63], v[8:11], v[116:119], v[48:63]
s_waitcnt lgkmcnt(2)
ds_read_b128 v[24:27], v64 offset:9216
v_accvgpr_write_b32 a80, v32
v_accvgpr_write_b32 a81, v33
v_mfma_f32_32x32x16_bf16 v[48:63], v[12:15], v[120:123], v[48:63]
s_waitcnt lgkmcnt(2)
ds_read_b128 v[8:11], v64 offset:10240
v_accvgpr_write_b32 a82, v34
v_accvgpr_write_b32 a83, v35
v_mfma_f32_32x32x16_bf16 v[48:63], v[16:19], v[124:127], v[48:63]
s_waitcnt lgkmcnt(2)
ds_read_b128 v[12:15], v64 offset:11264
v_accvgpr_write_b32 a84, v36
v_accvgpr_write_b32 a85, v37
v_mfma_f32_32x32x16_bf16 v[48:63], v[20:23], v[128:131], v[48:63]
s_waitcnt lgkmcnt(2)
ds_read_b128 v[16:19], v64 offset:12288
v_accvgpr_write_b32 a86, v38
v_accvgpr_write_b32 a87, v39
v_mfma_f32_32x32x16_bf16 v[48:63], v[24:27], v[132:135], v[48:63]
s_waitcnt lgkmcnt(2)
ds_read_b128 v[20:23], v64 offset:13312
s_add_u32 m0, s45, 0
s_add_u32 s55, s46, 0
buffer_load_dwordx4 v0, s[4:7], s55 offen offset:0 sc1 lds
buffer_load_dwordx4 v0, s[4:7], s55 offen offset:1024 sc1 lds
v_mfma_f32_32x32x16_bf16 v[48:63], v[8:11], v[136:139], v[48:63]
s_waitcnt lgkmcnt(2)
ds_read_b128 v[24:27], v64 offset:14336
buffer_load_dwordx4 v0, s[4:7], s55 offen offset:2048 sc1 lds
buffer_load_dwordx4 v0, s[4:7], s55 offen offset:3072 sc1 lds
v_mfma_f32_32x32x16_bf16 v[48:63], v[12:15], v[140:143], v[48:63]
s_waitcnt lgkmcnt(2)
ds_read_b128 v[8:11], v64 offset:15360
s_add_u32 m0, s45, 4096
s_add_u32 s55, s46, 4096
buffer_load_dwordx4 v0, s[4:7], s55 offen offset:0 sc1 lds
buffer_load_dwordx4 v0, s[4:7], s55 offen offset:1024 sc1 lds
v_mfma_f32_32x32x16_bf16 v[48:63], v[16:19], v[144:147], v[48:63]
s_waitcnt lgkmcnt(2)
ds_read_b128 v[12:15], v64 offset:16384
buffer_load_dwordx4 v0, s[4:7], s55 offen offset:2048 sc1 lds
buffer_load_dwordx4 v0, s[4:7], s55 offen offset:3072 sc1 lds
v_mfma_f32_32x32x16_bf16 v[48:63], v[20:23], v[148:151], v[48:63]
s_waitcnt lgkmcnt(2)
ds_read_b128 v[16:19], v64 offset:17408
s_add_u32 m0, s45, 8192
s_add_u32 s55, s46, 8192
buffer_load_dwordx4 v0, s[4:7], s55 offen offset:0 sc1 lds
buffer_load_dwordx4 v0, s[4:7], s55 offen offset:1024 sc1 lds
v_mfma_f32_32x32x16_bf16 v[48:63], v[24:27], v[152:155], v[48:63]
s_waitcnt lgkmcnt(2)
ds_read_b128 v[20:23], v64 offset:18432
s_add_u32 s45, s45, 40960
s_cmp_ge_u32 s45, 122880
s_cselect_b32 s55, 122880, 0
s_sub_u32 s45, s45, s55
s_add_u32 s46, s46, 40960
v_mfma_f32_32x32x16_bf16 v[48:63], v[8:11], v[156:159], v[48:63]
s_waitcnt lgkmcnt(2)
ds_read_b128 v[24:27], v64 offset:19456
v_mfma_f32_32x32x16_bf16 v[48:63], v[12:15], v[160:163], v[48:63]
s_waitcnt lgkmcnt(2)
ds_read_b128 v[8:11], v64 offset:20480
v_mfma_f32_32x32x16_bf16 v[48:63], v[16:19], v[164:167], v[48:63]
s_waitcnt lgkmcnt(2)
ds_read_b128 v[12:15], v64 offset:21504
v_mfma_f32_32x32x16_bf16 v[48:63], v[20:23], v[168:171], v[48:63]
s_waitcnt lgkmcnt(2)
ds_read_b128 v[16:19], v64 offset:22528
v_mfma_f32_32x32x16_bf16 v[48:63], v[24:27], v[172:175], v[48:63]
s_waitcnt lgkmcnt(2)
ds_read_b128 v[20:23], v64 offset:23552
v_mfma_f32_32x32x16_bf16 v[48:63], v[8:11], v[176:179], v[48:63]
s_waitcnt lgkmcnt(2)
ds_read_b128 v[24:27], v64 offset:24576
v_mfma_f32_32x32x16_bf16 v[48:63], v[12:15], v[180:183], v[48:63]
s_waitcnt lgkmcnt(2)
ds_read_b128 v[8:11], v64 offset:25600
v_mfma_f32_32x32x16_bf16 v[48:63], v[16:19], v[184:187], v[48:63]
s_waitcnt lgkmcnt(2)
ds_read_b128 v[12:15], v64 offset:26624
v_mfma_f32_32x32x16_bf16 v[48:63], v[20:23], v[188:191], v[48:63]
s_waitcnt lgkmcnt(2)
ds_read_b128 v[16:19], v64 offset:27648
v_mfma_f32_32x32x16_bf16 v[48:63], v[24:27], v[192:195], v[48:63]
s_waitcnt lgkmcnt(2)
ds_read_b128 v[20:23], v64 offset:28672
v_mfma_f32_32x32x16_bf16 v[48:63], v[8:11], v[196:199], v[48:63]
s_waitcnt lgkmcnt(2)
ds_read_b128 v[24:27], v64 offset:29696
v_mfma_f32_32x32x16_bf16 v[48:63], v[12:15], v[200:203], v[48:63]
s_waitcnt lgkmcnt(2)
ds_read_b128 v[8:11], v64 offset:30720
v_mfma_f32_32x32x16_bf16 v[48:63], v[16:19], v[204:207], v[48:63]
s_waitcnt lgkmcnt(2)
ds_read_b128 v[12:15], v64 offset:31744
v_mfma_f32_32x32x16_bf16 v[48:63], v[20:23], v[208:211], v[48:63]
s_waitcnt lgkmcnt(2)
ds_read_b128 v[16:19], v64 offset:32768
v_mfma_f32_32x32x16_bf16 v[48:63], v[24:27], v[212:215], v[48:63]
s_waitcnt lgkmcnt(2)
ds_read_b128 v[20:23], v64 offset:33792
v_mfma_f32_32x32x16_bf16 v[48:63], v[8:11], v[216:219], v[48:63]
s_waitcnt lgkmcnt(2)
ds_read_b128 v[24:27], v64 offset:34816
v_mfma_f32_32x32x16_bf16 v[48:63], v[12:15], v[220:223], v[48:63]
s_waitcnt lgkmcnt(2)
ds_read_b128 v[8:11], v64 offset:35840
v_mfma_f32_32x32x16_bf16 v[48:63], v[16:19], v[224:227], v[48:63]
s_waitcnt lgkmcnt(2)
ds_read_b128 v[12:15], v64 offset:36864
v_mfma_f32_32x32x16_bf16 v[48:63], v[20:23], v[228:231], v[48:63]
s_waitcnt lgkmcnt(2)
ds_read_b128 v[16:19], v64 offset:37888
v_mfma_f32_32x32x16_bf16 v[48:63], v[24:27], v[232:235], v[48:63]
s_waitcnt lgkmcnt(2)
ds_read_b128 v[20:23], v64 offset:38912
v_mfma_f32_32x32x16_bf16 v[48:63], v[8:11], v[236:239], v[48:63]
s_waitcnt lgkmcnt(2)
ds_read_b128 v[24:27], v64 offset:39936
v_mfma_f32_32x32x16_bf16 v[48:63], v[12:15], v[240:243], v[48:63]
s_add_u32 s44, s44, 1
s_cmp_eq_u32 s44, 3
s_mov_b32 s56, 40960
s_cmov_b32 s56, -81920
s_cselect_b32 s44, 0, s44
v_add_u32 v64, s56, v64
s_waitcnt vmcnt(10) lgkmcnt(2)
s_barrier
ds_read_b128 v[8:11], v64 offset:0
v_mfma_f32_32x32x16_bf16 v[48:63], v[16:19], v[244:247], v[48:63]
s_waitcnt lgkmcnt(2)
ds_read_b128 v[12:15], v64 offset:1024
v_mfma_f32_32x32x16_bf16 v[48:63], v[20:23], v[248:251], v[48:63]
s_waitcnt lgkmcnt(2)
ds_read_b128 v[16:19], v64 offset:2048
v_mfma_f32_32x32x16_bf16 v[48:63], v[24:27], v[252:255], v[48:63]
s_waitcnt lgkmcnt(2)
ds_read_b128 v[20:23], v64 offset:3072
v_mfma_f32_32x32x16_bf16 v[32:47], v[8:11], v[96:99], 0
s_waitcnt lgkmcnt(2)
ds_read_b128 v[24:27], v64 offset:4096
v_mfma_f32_32x32x16_bf16 v[32:47], v[12:15], v[100:103], v[32:47]
s_waitcnt lgkmcnt(2)
ds_read_b128 v[8:11], v64 offset:5120
v_cvt_pk_bf16_f32 v48, v48, v49
v_cvt_pk_bf16_f32 v49, v50, v51
v_mfma_f32_32x32x16_bf16 v[32:47], v[16:19], v[104:107], v[32:47]
s_waitcnt lgkmcnt(2)
ds_read_b128 v[12:15], v64 offset:6144
v_cvt_pk_bf16_f32 v50, v52, v53
v_cvt_pk_bf16_f32 v51, v54, v55
v_mfma_f32_32x32x16_bf16 v[32:47], v[20:23], v[108:111], v[32:47]
s_waitcnt lgkmcnt(2)
ds_read_b128 v[16:19], v64 offset:7168
v_cvt_pk_bf16_f32 v52, v56, v57
v_cvt_pk_bf16_f32 v53, v58, v59
v_mfma_f32_32x32x16_bf16 v[32:47], v[24:27], v[112:115], v[32:47]
s_waitcnt lgkmcnt(2)
ds_read_b128 v[20:23], v64 offset:8192
v_cvt_pk_bf16_f32 v54, v60, v61
v_cvt_pk_bf16_f32 v55, v62, v63
v_mfma_f32_32x32x16_bf16 v[32:47], v[8:11], v[116:119], v[32:47]
s_waitcnt lgkmcnt(2)
ds_read_b128 v[24:27], v64 offset:9216
v_accvgpr_write_b32 a88, v48
v_accvgpr_write_b32 a89, v49
v_mfma_f32_32x32x16_bf16 v[32:47], v[12:15], v[120:123], v[32:47]
s_waitcnt lgkmcnt(2)
ds_read_b128 v[8:11], v64 offset:10240
v_accvgpr_write_b32 a90, v50
v_accvgpr_write_b32 a91, v51
v_mfma_f32_32x32x16_bf16 v[32:47], v[16:19], v[124:127], v[32:47]
s_waitcnt lgkmcnt(2)
ds_read_b128 v[12:15], v64 offset:11264
v_accvgpr_write_b32 a92, v52
v_accvgpr_write_b32 a93, v53
v_mfma_f32_32x32x16_bf16 v[32:47], v[20:23], v[128:131], v[32:47]
s_waitcnt lgkmcnt(2)
ds_read_b128 v[16:19], v64 offset:12288
v_accvgpr_write_b32 a94, v54
v_accvgpr_write_b32 a95, v55
v_mfma_f32_32x32x16_bf16 v[32:47], v[24:27], v[132:135], v[32:47]
s_waitcnt lgkmcnt(2)
ds_read_b128 v[20:23], v64 offset:13312
s_add_u32 m0, s45, 0
s_add_u32 s55, s46, 0
buffer_load_dwordx4 v0, s[4:7], s55 offen offset:0 sc1 lds
buffer_load_dwordx4 v0, s[4:7], s55 offen offset:1024 sc1 lds
v_mfma_f32_32x32x16_bf16 v[32:47], v[8:11], v[136:139], v[32:47]
s_waitcnt lgkmcnt(2)
ds_read_b128 v[24:27], v64 offset:14336
buffer_load_dwordx4 v0, s[4:7], s55 offen offset:2048 sc1 lds
buffer_load_dwordx4 v0, s[4:7], s55 offen offset:3072 sc1 lds
v_mfma_f32_32x32x16_bf16 v[32:47], v[12:15], v[140:143], v[32:47]
s_waitcnt lgkmcnt(2)
ds_read_b128 v[8:11], v64 offset:15360
s_add_u32 m0, s45, 4096
s_add_u32 s55, s46, 4096
buffer_load_dwordx4 v0, s[4:7], s55 offen offset:0 sc1 lds
buffer_load_dwordx4 v0, s[4:7], s55 offen offset:1024 sc1 lds
v_mfma_f32_32x32x16_bf16 v[32:47], v[16:19], v[144:147], v[32:47]
s_waitcnt lgkmcnt(2)
ds_read_b128 v[12:15], v64 offset:16384
buffer_load_dwordx4 v0, s[4:7], s55 offen offset:2048 sc1 lds
buffer_load_dwordx4 v0, s[4:7], s55 offen offset:3072 sc1 lds
v_mfma_f32_32x32x16_bf16 v[32:47], v[20:23], v[148:151], v[32:47]
s_waitcnt lgkmcnt(2)
ds_read_b128 v[16:19], v64 offset:17408
s_add_u32 m0, s45, 8192
s_add_u32 s55, s46, 8192
buffer_load_dwordx4 v0, s[4:7], s55 offen offset:0 sc1 lds
buffer_load_dwordx4 v0, s[4:7], s55 offen offset:1024 sc1 lds
v_mfma_f32_32x32x16_bf16 v[32:47], v[24:27], v[152:155], v[32:47]
s_waitcnt lgkmcnt(2)
ds_read_b128 v[20:23], v64 offset:18432
s_add_u32 s45, s45, 40960
s_cmp_ge_u32 s45, 122880
s_cselect_b32 s55, 122880, 0
s_sub_u32 s45, s45, s55
s_add_u32 s46, s46, 40960
v_mfma_f32_32x32x16_bf16 v[32:47], v[8:11], v[156:159], v[32:47]
s_waitcnt lgkmcnt(2)
ds_read_b128 v[24:27], v64 offset:19456
v_mfma_f32_32x32x16_bf16 v[32:47], v[12:15], v[160:163], v[32:47]
s_waitcnt lgkmcnt(2)
ds_read_b128 v[8:11], v64 offset:20480
v_mfma_f32_32x32x16_bf16 v[32:47], v[16:19], v[164:167], v[32:47]
s_waitcnt lgkmcnt(2)
ds_read_b128 v[12:15], v64 offset:21504
v_mfma_f32_32x32x16_bf16 v[32:47], v[20:23], v[168:171], v[32:47]
s_waitcnt lgkmcnt(2)
ds_read_b128 v[16:19], v64 offset:22528
v_mfma_f32_32x32x16_bf16 v[32:47], v[24:27], v[172:175], v[32:47]
s_waitcnt lgkmcnt(2)
ds_read_b128 v[20:23], v64 offset:23552
v_mfma_f32_32x32x16_bf16 v[32:47], v[8:11], v[176:179], v[32:47]
s_waitcnt lgkmcnt(2)
ds_read_b128 v[24:27], v64 offset:24576
v_mfma_f32_32x32x16_bf16 v[32:47], v[12:15], v[180:183], v[32:47]
s_waitcnt lgkmcnt(2)
ds_read_b128 v[8:11], v64 offset:25600
v_mfma_f32_32x32x16_bf16 v[32:47], v[16:19], v[184:187], v[32:47]
s_waitcnt lgkmcnt(2)
ds_read_b128 v[12:15], v64 offset:26624
v_mfma_f32_32x32x16_bf16 v[32:47], v[20:23], v[188:191], v[32:47]
s_waitcnt lgkmcnt(2)
ds_read_b128 v[16:19], v64 offset:27648
v_mfma_f32_32x32x16_bf16 v[32:47], v[24:27], v[192:195], v[32:47]
s_waitcnt lgkmcnt(2)
ds_read_b128 v[20:23], v64 offset:28672
v_mfma_f32_32x32x16_bf16 v[32:47], v[8:11], v[196:199], v[32:47]
s_waitcnt lgkmcnt(2)
ds_read_b128 v[24:27], v64 offset:29696
v_mfma_f32_32x32x16_bf16 v[32:47], v[12:15], v[200:203], v[32:47]
s_waitcnt lgkmcnt(2)
ds_read_b128 v[8:11], v64 offset:30720
v_mfma_f32_32x32x16_bf16 v[32:47], v[16:19], v[204:207], v[32:47]
s_waitcnt lgkmcnt(2)
ds_read_b128 v[12:15], v64 offset:31744
v_mfma_f32_32x32x16_bf16 v[32:47], v[20:23], v[208:211], v[32:47]
s_waitcnt lgkmcnt(2)
ds_read_b128 v[16:19], v64 offset:32768
v_mfma_f32_32x32x16_bf16 v[32:47], v[24:27], v[212:215], v[32:47]
s_waitcnt lgkmcnt(2)
ds_read_b128 v[20:23], v64 offset:33792
v_mfma_f32_32x32x16_bf16 v[32:47], v[8:11], v[216:219], v[32:47]
s_waitcnt lgkmcnt(2)
ds_read_b128 v[24:27], v64 offset:34816
v_mfma_f32_32x32x16_bf16 v[32:47], v[12:15], v[220:223], v[32:47]
s_waitcnt lgkmcnt(2)
ds_read_b128 v[8:11], v64 offset:35840
v_mfma_f32_32x32x16_bf16 v[32:47], v[16:19], v[224:227], v[32:47]
s_waitcnt lgkmcnt(2)
ds_read_b128 v[12:15], v64 offset:36864
v_mfma_f32_32x32x16_bf16 v[32:47], v[20:23], v[228:231], v[32:47]
s_waitcnt lgkmcnt(2)
ds_read_b128 v[16:19], v64 offset:37888
v_mfma_f32_32x32x16_bf16 v[32:47], v[24:27], v[232:235], v[32:47]
s_waitcnt lgkmcnt(2)
ds_read_b128 v[20:23], v64 offset:38912
v_mfma_f32_32x32x16_bf16 v[32:47], v[8:11], v[236:239], v[32:47]
s_waitcnt lgkmcnt(2)
ds_read_b128 v[24:27], v64 offset:39936
v_mfma_f32_32x32x16_bf16 v[32:47], v[12:15], v[240:243], v[32:47]
s_add_u32 s44, s44, 1
s_cmp_eq_u32 s44, 3
s_mov_b32 s56, 40960
s_cmov_b32 s56, -81920
s_cselect_b32 s44, 0, s44
v_add_u32 v64, s56, v64
s_waitcnt vmcnt(10) lgkmcnt(2)
s_barrier
ds_read_b128 v[8:11], v64 offset:0
v_mfma_f32_32x32x16_bf16 v[32:47], v[16:19], v[244:247], v[32:47]
s_waitcnt lgkmcnt(2)
ds_read_b128 v[12:15], v64 offset:1024
v_mfma_f32_32x32x16_bf16 v[32:47], v[20:23], v[248:251], v[32:47]
s_waitcnt lgkmcnt(2)
ds_read_b128 v[16:19], v64 offset:2048
v_mfma_f32_32x32x16_bf16 v[32:47], v[24:27], v[252:255], v[32:47]
s_waitcnt lgkmcnt(2)
ds_read_b128 v[20:23], v64 offset:3072
v_mfma_f32_32x32x16_bf16 v[48:63], v[8:11], v[96:99], 0
s_waitcnt lgkmcnt(2)
ds_read_b128 v[24:27], v64 offset:4096
v_mfma_f32_32x32x16_bf16 v[48:63], v[12:15], v[100:103], v[48:63]
s_waitcnt lgkmcnt(2)
ds_read_b128 v[8:11], v64 offset:5120
v_cvt_pk_bf16_f32 v32, v32, v33
v_cvt_pk_bf16_f32 v33, v34, v35
v_mfma_f32_32x32x16_bf16 v[48:63], v[16:19], v[104:107], v[48:63]
s_waitcnt lgkmcnt(2)
ds_read_b128 v[12:15], v64 offset:6144
v_cvt_pk_bf16_f32 v34, v36, v37
v_cvt_pk_bf16_f32 v35, v38, v39
v_mfma_f32_32x32x16_bf16 v[48:63], v[20:23], v[108:111], v[48:63]
s_waitcnt lgkmcnt(2)
ds_read_b128 v[16:19], v64 offset:7168
v_cvt_pk_bf16_f32 v36, v40, v41
v_cvt_pk_bf16_f32 v37, v42, v43
v_mfma_f32_32x32x16_bf16 v[48:63], v[24:27], v[112:115], v[48:63]
s_waitcnt lgkmcnt(2)
ds_read_b128 v[20:23], v64 offset:8192
v_cvt_pk_bf16_f32 v38, v44, v45
v_cvt_pk_bf16_f32 v39, v46, v47
v_mfma_f32_32x32x16_bf16 v[48:63], v[8:11], v[116:119], v[48:63]
s_waitcnt lgkmcnt(2)
ds_read_b128 v[24:27], v64 offset:9216
v_accvgpr_write_b32 a96, v32
v_accvgpr_write_b32 a97, v33
v_mfma_f32_32x32x16_bf16 v[48:63], v[12:15], v[120:123], v[48:63]
s_waitcnt lgkmcnt(2)
ds_read_b128 v[8:11], v64 offset:10240
v_accvgpr_write_b32 a98, v34
v_accvgpr_write_b32 a99, v35
v_mfma_f32_32x32x16_bf16 v[48:63], v[16:19], v[124:127], v[48:63]
s_waitcnt lgkmcnt(2)
ds_read_b128 v[12:15], v64 offset:11264
v_accvgpr_write_b32 a100, v36
v_accvgpr_write_b32 a101, v37
v_mfma_f32_32x32x16_bf16 v[48:63], v[20:23], v[128:131], v[48:63]
s_waitcnt lgkmcnt(2)
ds_read_b128 v[16:19], v64 offset:12288
v_accvgpr_write_b32 a102, v38
v_accvgpr_write_b32 a103, v39
v_mfma_f32_32x32x16_bf16 v[48:63], v[24:27], v[132:135], v[48:63]
s_waitcnt lgkmcnt(2)
ds_read_b128 v[20:23], v64 offset:13312
s_add_u32 m0, s45, 0
s_add_u32 s55, s46, 0
buffer_load_dwordx4 v0, s[4:7], s55 offen offset:0 sc1 lds
buffer_load_dwordx4 v0, s[4:7], s55 offen offset:1024 sc1 lds
v_mfma_f32_32x32x16_bf16 v[48:63], v[8:11], v[136:139], v[48:63]
s_waitcnt lgkmcnt(2)
ds_read_b128 v[24:27], v64 offset:14336
buffer_load_dwordx4 v0, s[4:7], s55 offen offset:2048 sc1 lds
buffer_load_dwordx4 v0, s[4:7], s55 offen offset:3072 sc1 lds
v_mfma_f32_32x32x16_bf16 v[48:63], v[12:15], v[140:143], v[48:63]
s_waitcnt lgkmcnt(2)
ds_read_b128 v[8:11], v64 offset:15360
s_add_u32 m0, s45, 4096
s_add_u32 s55, s46, 4096
buffer_load_dwordx4 v0, s[4:7], s55 offen offset:0 sc1 lds
buffer_load_dwordx4 v0, s[4:7], s55 offen offset:1024 sc1 lds
v_mfma_f32_32x32x16_bf16 v[48:63], v[16:19], v[144:147], v[48:63]
s_waitcnt lgkmcnt(2)
ds_read_b128 v[12:15], v64 offset:16384
buffer_load_dwordx4 v0, s[4:7], s55 offen offset:2048 sc1 lds
buffer_load_dwordx4 v0, s[4:7], s55 offen offset:3072 sc1 lds
v_mfma_f32_32x32x16_bf16 v[48:63], v[20:23], v[148:151], v[48:63]
s_waitcnt lgkmcnt(2)
ds_read_b128 v[16:19], v64 offset:17408
s_add_u32 m0, s45, 8192
s_add_u32 s55, s46, 8192
buffer_load_dwordx4 v0, s[4:7], s55 offen offset:0 sc1 lds
buffer_load_dwordx4 v0, s[4:7], s55 offen offset:1024 sc1 lds
v_mfma_f32_32x32x16_bf16 v[48:63], v[24:27], v[152:155], v[48:63]
s_waitcnt lgkmcnt(2)
ds_read_b128 v[20:23], v64 offset:18432
s_add_u32 s45, s45, 40960
s_cmp_ge_u32 s45, 122880
s_cselect_b32 s55, 122880, 0
s_sub_u32 s45, s45, s55
s_add_u32 s46, s46, 40960
v_mfma_f32_32x32x16_bf16 v[48:63], v[8:11], v[156:159], v[48:63]
s_waitcnt lgkmcnt(2)
ds_read_b128 v[24:27], v64 offset:19456
v_mfma_f32_32x32x16_bf16 v[48:63], v[12:15], v[160:163], v[48:63]
s_waitcnt lgkmcnt(2)
ds_read_b128 v[8:11], v64 offset:20480
v_mfma_f32_32x32x16_bf16 v[48:63], v[16:19], v[164:167], v[48:63]
s_waitcnt lgkmcnt(2)
ds_read_b128 v[12:15], v64 offset:21504
v_mfma_f32_32x32x16_bf16 v[48:63], v[20:23], v[168:171], v[48:63]
s_waitcnt lgkmcnt(2)
ds_read_b128 v[16:19], v64 offset:22528
v_mfma_f32_32x32x16_bf16 v[48:63], v[24:27], v[172:175], v[48:63]
s_waitcnt lgkmcnt(2)
ds_read_b128 v[20:23], v64 offset:23552
v_mfma_f32_32x32x16_bf16 v[48:63], v[8:11], v[176:179], v[48:63]
s_waitcnt lgkmcnt(2)
ds_read_b128 v[24:27], v64 offset:24576
v_mfma_f32_32x32x16_bf16 v[48:63], v[12:15], v[180:183], v[48:63]
s_waitcnt lgkmcnt(2)
ds_read_b128 v[8:11], v64 offset:25600
v_mfma_f32_32x32x16_bf16 v[48:63], v[16:19], v[184:187], v[48:63]
s_waitcnt lgkmcnt(2)
ds_read_b128 v[12:15], v64 offset:26624
v_mfma_f32_32x32x16_bf16 v[48:63], v[20:23], v[188:191], v[48:63]
s_waitcnt lgkmcnt(2)
ds_read_b128 v[16:19], v64 offset:27648
v_mfma_f32_32x32x16_bf16 v[48:63], v[24:27], v[192:195], v[48:63]
s_waitcnt lgkmcnt(2)
ds_read_b128 v[20:23], v64 offset:28672
v_mfma_f32_32x32x16_bf16 v[48:63], v[8:11], v[196:199], v[48:63]
s_waitcnt lgkmcnt(2)
ds_read_b128 v[24:27], v64 offset:29696
v_mfma_f32_32x32x16_bf16 v[48:63], v[12:15], v[200:203], v[48:63]
s_waitcnt lgkmcnt(2)
ds_read_b128 v[8:11], v64 offset:30720
v_mfma_f32_32x32x16_bf16 v[48:63], v[16:19], v[204:207], v[48:63]
s_waitcnt lgkmcnt(2)
ds_read_b128 v[12:15], v64 offset:31744
v_mfma_f32_32x32x16_bf16 v[48:63], v[20:23], v[208:211], v[48:63]
s_waitcnt lgkmcnt(2)
ds_read_b128 v[16:19], v64 offset:32768
v_mfma_f32_32x32x16_bf16 v[48:63], v[24:27], v[212:215], v[48:63]
s_waitcnt lgkmcnt(2)
ds_read_b128 v[20:23], v64 offset:33792
v_mfma_f32_32x32x16_bf16 v[48:63], v[8:11], v[216:219], v[48:63]
s_waitcnt lgkmcnt(2)
ds_read_b128 v[24:27], v64 offset:34816
v_mfma_f32_32x32x16_bf16 v[48:63], v[12:15], v[220:223], v[48:63]
s_waitcnt lgkmcnt(2)
ds_read_b128 v[8:11], v64 offset:35840
v_mfma_f32_32x32x16_bf16 v[48:63], v[16:19], v[224:227], v[48:63]
s_waitcnt lgkmcnt(2)
ds_read_b128 v[12:15], v64 offset:36864
v_mfma_f32_32x32x16_bf16 v[48:63], v[20:23], v[228:231], v[48:63]
s_waitcnt lgkmcnt(2)
ds_read_b128 v[16:19], v64 offset:37888
v_mfma_f32_32x32x16_bf16 v[48:63], v[24:27], v[232:235], v[48:63]
s_waitcnt lgkmcnt(2)
ds_read_b128 v[20:23], v64 offset:38912
v_mfma_f32_32x32x16_bf16 v[48:63], v[8:11], v[236:239], v[48:63]
s_waitcnt lgkmcnt(2)
ds_read_b128 v[24:27], v64 offset:39936
v_mfma_f32_32x32x16_bf16 v[48:63], v[12:15], v[240:243], v[48:63]
s_add_u32 s44, s44, 1
s_cmp_eq_u32 s44, 3
s_mov_b32 s56, 40960
s_cmov_b32 s56, -81920
s_cselect_b32 s44, 0, s44
v_add_u32 v64, s56, v64
s_waitcnt vmcnt(10) lgkmcnt(2)
s_barrier
ds_read_b128 v[8:11], v64 offset:0
v_mfma_f32_32x32x16_bf16 v[48:63], v[16:19], v[244:247], v[48:63]
s_waitcnt lgkmcnt(2)
ds_read_b128 v[12:15], v64 offset:1024
v_mfma_f32_32x32x16_bf16 v[48:63], v[20:23], v[248:251], v[48:63]
s_waitcnt lgkmcnt(2)
ds_read_b128 v[16:19], v64 offset:2048
v_mfma_f32_32x32x16_bf16 v[48:63], v[24:27], v[252:255], v[48:63]
s_waitcnt lgkmcnt(2)
ds_read_b128 v[20:23], v64 offset:3072
v_mfma_f32_32x32x16_bf16 v[32:47], v[8:11], v[96:99], 0
s_waitcnt lgkmcnt(2)
ds_read_b128 v[24:27], v64 offset:4096
v_mfma_f32_32x32x16_bf16 v[32:47], v[12:15], v[100:103], v[32:47]
s_waitcnt lgkmcnt(2)
ds_read_b128 v[8:11], v64 offset:5120
v_cvt_pk_bf16_f32 v48, v48, v49
v_cvt_pk_bf16_f32 v49, v50, v51
v_mfma_f32_32x32x16_bf16 v[32:47], v[16:19], v[104:107], v[32:47]
s_waitcnt lgkmcnt(2)
ds_read_b128 v[12:15], v64 offset:6144
v_cvt_pk_bf16_f32 v50, v52, v53
v_cvt_pk_bf16_f32 v51, v54, v55
v_mfma_f32_32x32x16_bf16 v[32:47], v[20:23], v[108:111], v[32:47]
s_waitcnt lgkmcnt(2)
ds_read_b128 v[16:19], v64 offset:7168
v_cvt_pk_bf16_f32 v52, v56, v57
v_cvt_pk_bf16_f32 v53, v58, v59
v_mfma_f32_32x32x16_bf16 v[32:47], v[24:27], v[112:115], v[32:47]
s_waitcnt lgkmcnt(2)
ds_read_b128 v[20:23], v64 offset:8192
v_cvt_pk_bf16_f32 v54, v60, v61
v_cvt_pk_bf16_f32 v55, v62, v63
v_mfma_f32_32x32x16_bf16 v[32:47], v[8:11], v[116:119], v[32:47]
s_waitcnt lgkmcnt(2)
ds_read_b128 v[24:27], v64 offset:9216
v_accvgpr_write_b32 a104, v48
v_accvgpr_write_b32 a105, v49
v_mfma_f32_32x32x16_bf16 v[32:47], v[12:15], v[120:123], v[32:47]
s_waitcnt lgkmcnt(2)
ds_read_b128 v[8:11], v64 offset:10240
v_accvgpr_write_b32 a106, v50
v_accvgpr_write_b32 a107, v51
v_mfma_f32_32x32x16_bf16 v[32:47], v[16:19], v[124:127], v[32:47]
s_waitcnt lgkmcnt(2)
ds_read_b128 v[12:15], v64 offset:11264
v_accvgpr_write_b32 a108, v52
v_accvgpr_write_b32 a109, v53
v_mfma_f32_32x32x16_bf16 v[32:47], v[20:23], v[128:131], v[32:47]
s_waitcnt lgkmcnt(2)
ds_read_b128 v[16:19], v64 offset:12288
v_accvgpr_write_b32 a110, v54
v_accvgpr_write_b32 a111, v55
v_mfma_f32_32x32x16_bf16 v[32:47], v[24:27], v[132:135], v[32:47]
s_waitcnt lgkmcnt(2)
ds_read_b128 v[20:23], v64 offset:13312
s_add_u32 m0, s45, 0
s_add_u32 s55, s46, 0
buffer_load_dwordx4 v0, s[4:7], s55 offen offset:0 sc1 lds
buffer_load_dwordx4 v0, s[4:7], s55 offen offset:1024 sc1 lds
v_mfma_f32_32x32x16_bf16 v[32:47], v[8:11], v[136:139], v[32:47]
s_waitcnt lgkmcnt(2)
ds_read_b128 v[24:27], v64 offset:14336
buffer_load_dwordx4 v0, s[4:7], s55 offen offset:2048 sc1 lds
buffer_load_dwordx4 v0, s[4:7], s55 offen offset:3072 sc1 lds
v_mfma_f32_32x32x16_bf16 v[32:47], v[12:15], v[140:143], v[32:47]
s_waitcnt lgkmcnt(2)
ds_read_b128 v[8:11], v64 offset:15360
s_add_u32 m0, s45, 4096
s_add_u32 s55, s46, 4096
buffer_load_dwordx4 v0, s[4:7], s55 offen offset:0 sc1 lds
buffer_load_dwordx4 v0, s[4:7], s55 offen offset:1024 sc1 lds
v_mfma_f32_32x32x16_bf16 v[32:47], v[16:19], v[144:147], v[32:47]
s_waitcnt lgkmcnt(2)
ds_read_b128 v[12:15], v64 offset:16384
buffer_load_dwordx4 v0, s[4:7], s55 offen offset:2048 sc1 lds
buffer_load_dwordx4 v0, s[4:7], s55 offen offset:3072 sc1 lds
v_mfma_f32_32x32x16_bf16 v[32:47], v[20:23], v[148:151], v[32:47]
s_waitcnt lgkmcnt(2)
ds_read_b128 v[16:19], v64 offset:17408
s_add_u32 m0, s45, 8192
s_add_u32 s55, s46, 8192
buffer_load_dwordx4 v0, s[4:7], s55 offen offset:0 sc1 lds
buffer_load_dwordx4 v0, s[4:7], s55 offen offset:1024 sc1 lds
v_mfma_f32_32x32x16_bf16 v[32:47], v[24:27], v[152:155], v[32:47]
s_waitcnt lgkmcnt(2)
ds_read_b128 v[20:23], v64 offset:18432
s_add_u32 s45, s45, 40960
s_cmp_ge_u32 s45, 122880
s_cselect_b32 s55, 122880, 0
s_sub_u32 s45, s45, s55
s_add_u32 s46, s46, 40960
v_mfma_f32_32x32x16_bf16 v[32:47], v[8:11], v[156:159], v[32:47]
s_waitcnt lgkmcnt(2)
ds_read_b128 v[24:27], v64 offset:19456
v_mfma_f32_32x32x16_bf16 v[32:47], v[12:15], v[160:163], v[32:47]
s_waitcnt lgkmcnt(2)
ds_read_b128 v[8:11], v64 offset:20480
v_mfma_f32_32x32x16_bf16 v[32:47], v[16:19], v[164:167], v[32:47]
s_waitcnt lgkmcnt(2)
ds_read_b128 v[12:15], v64 offset:21504
v_mfma_f32_32x32x16_bf16 v[32:47], v[20:23], v[168:171], v[32:47]
s_waitcnt lgkmcnt(2)
ds_read_b128 v[16:19], v64 offset:22528
v_mfma_f32_32x32x16_bf16 v[32:47], v[24:27], v[172:175], v[32:47]
s_waitcnt lgkmcnt(2)
ds_read_b128 v[20:23], v64 offset:23552
v_mfma_f32_32x32x16_bf16 v[32:47], v[8:11], v[176:179], v[32:47]
s_waitcnt lgkmcnt(2)
ds_read_b128 v[24:27], v64 offset:24576
v_mfma_f32_32x32x16_bf16 v[32:47], v[12:15], v[180:183], v[32:47]
s_waitcnt lgkmcnt(2)
ds_read_b128 v[8:11], v64 offset:25600
v_mfma_f32_32x32x16_bf16 v[32:47], v[16:19], v[184:187], v[32:47]
s_waitcnt lgkmcnt(2)
ds_read_b128 v[12:15], v64 offset:26624
v_mfma_f32_32x32x16_bf16 v[32:47], v[20:23], v[188:191], v[32:47]
s_waitcnt lgkmcnt(2)
ds_read_b128 v[16:19], v64 offset:27648
v_mfma_f32_32x32x16_bf16 v[32:47], v[24:27], v[192:195], v[32:47]
s_waitcnt lgkmcnt(2)
ds_read_b128 v[20:23], v64 offset:28672
v_mfma_f32_32x32x16_bf16 v[32:47], v[8:11], v[196:199], v[32:47]
s_waitcnt lgkmcnt(2)
ds_read_b128 v[24:27], v64 offset:29696
v_mfma_f32_32x32x16_bf16 v[32:47], v[12:15], v[200:203], v[32:47]
s_waitcnt lgkmcnt(2)
ds_read_b128 v[8:11], v64 offset:30720
v_mfma_f32_32x32x16_bf16 v[32:47], v[16:19], v[204:207], v[32:47]
s_waitcnt lgkmcnt(2)
ds_read_b128 v[12:15], v64 offset:31744
v_mfma_f32_32x32x16_bf16 v[32:47], v[20:23], v[208:211], v[32:47]
s_waitcnt lgkmcnt(2)
ds_read_b128 v[16:19], v64 offset:32768
v_mfma_f32_32x32x16_bf16 v[32:47], v[24:27], v[212:215], v[32:47]
s_waitcnt lgkmcnt(2)
ds_read_b128 v[20:23], v64 offset:33792
v_mfma_f32_32x32x16_bf16 v[32:47], v[8:11], v[216:219], v[32:47]
s_waitcnt lgkmcnt(2)
ds_read_b128 v[24:27], v64 offset:34816
v_mfma_f32_32x32x16_bf16 v[32:47], v[12:15], v[220:223], v[32:47]
s_waitcnt lgkmcnt(2)
ds_read_b128 v[8:11], v64 offset:35840
v_mfma_f32_32x32x16_bf16 v[32:47], v[16:19], v[224:227], v[32:47]
s_waitcnt lgkmcnt(2)
ds_read_b128 v[12:15], v64 offset:36864
v_mfma_f32_32x32x16_bf16 v[32:47], v[20:23], v[228:231], v[32:47]
s_waitcnt lgkmcnt(2)
ds_read_b128 v[16:19], v64 offset:37888
v_mfma_f32_32x32x16_bf16 v[32:47], v[24:27], v[232:235], v[32:47]
s_waitcnt lgkmcnt(2)
ds_read_b128 v[20:23], v64 offset:38912
v_mfma_f32_32x32x16_bf16 v[32:47], v[8:11], v[236:239], v[32:47]
s_waitcnt lgkmcnt(2)
ds_read_b128 v[24:27], v64 offset:39936
v_mfma_f32_32x32x16_bf16 v[32:47], v[12:15], v[240:243], v[32:47]
s_add_u32 s44, s44, 1
s_cmp_eq_u32 s44, 3
s_mov_b32 s56, 40960
s_cmov_b32 s56, -81920
s_cselect_b32 s44, 0, s44
v_add_u32 v64, s56, v64
s_waitcnt vmcnt(10) lgkmcnt(2)
s_barrier
ds_read_b128 v[8:11], v64 offset:0
v_mfma_f32_32x32x16_bf16 v[32:47], v[16:19], v[244:247], v[32:47]
s_waitcnt lgkmcnt(2)
ds_read_b128 v[12:15], v64 offset:1024
v_mfma_f32_32x32x16_bf16 v[32:47], v[20:23], v[248:251], v[32:47]
s_waitcnt lgkmcnt(2)
ds_read_b128 v[16:19], v64 offset:2048
v_mfma_f32_32x32x16_bf16 v[32:47], v[24:27], v[252:255], v[32:47]
s_waitcnt lgkmcnt(2)
ds_read_b128 v[20:23], v64 offset:3072
v_mfma_f32_32x32x16_bf16 v[48:63], v[8:11], v[96:99], 0
s_waitcnt lgkmcnt(2)
ds_read_b128 v[24:27], v64 offset:4096
v_mfma_f32_32x32x16_bf16 v[48:63], v[12:15], v[100:103], v[48:63]
s_waitcnt lgkmcnt(2)
ds_read_b128 v[8:11], v64 offset:5120
v_cvt_pk_bf16_f32 v32, v32, v33
v_cvt_pk_bf16_f32 v33, v34, v35
v_mfma_f32_32x32x16_bf16 v[48:63], v[16:19], v[104:107], v[48:63]
s_waitcnt lgkmcnt(2)
ds_read_b128 v[12:15], v64 offset:6144
v_cvt_pk_bf16_f32 v34, v36, v37
v_cvt_pk_bf16_f32 v35, v38, v39
v_mfma_f32_32x32x16_bf16 v[48:63], v[20:23], v[108:111], v[48:63]
s_waitcnt lgkmcnt(2)
ds_read_b128 v[16:19], v64 offset:7168
v_cvt_pk_bf16_f32 v36, v40, v41
v_cvt_pk_bf16_f32 v37, v42, v43
v_mfma_f32_32x32x16_bf16 v[48:63], v[24:27], v[112:115], v[48:63]
s_waitcnt lgkmcnt(2)
ds_read_b128 v[20:23], v64 offset:8192
v_cvt_pk_bf16_f32 v38, v44, v45
v_cvt_pk_bf16_f32 v39, v46, v47
v_mfma_f32_32x32x16_bf16 v[48:63], v[8:11], v[116:119], v[48:63]
s_waitcnt lgkmcnt(2)
ds_read_b128 v[24:27], v64 offset:9216
v_accvgpr_write_b32 a112, v32
v_accvgpr_write_b32 a113, v33
v_mfma_f32_32x32x16_bf16 v[48:63], v[12:15], v[120:123], v[48:63]
s_waitcnt lgkmcnt(2)
ds_read_b128 v[8:11], v64 offset:10240
v_accvgpr_write_b32 a114, v34
v_accvgpr_write_b32 a115, v35
v_mfma_f32_32x32x16_bf16 v[48:63], v[16:19], v[124:127], v[48:63]
s_waitcnt lgkmcnt(2)
ds_read_b128 v[12:15], v64 offset:11264
v_accvgpr_write_b32 a116, v36
v_accvgpr_write_b32 a117, v37
v_mfma_f32_32x32x16_bf16 v[48:63], v[20:23], v[128:131], v[48:63]
s_waitcnt lgkmcnt(2)
ds_read_b128 v[16:19], v64 offset:12288
v_accvgpr_write_b32 a118, v38
v_accvgpr_write_b32 a119, v39
v_mfma_f32_32x32x16_bf16 v[48:63], v[24:27], v[132:135], v[48:63]
s_waitcnt lgkmcnt(2)
ds_read_b128 v[20:23], v64 offset:13312
s_add_u32 m0, s45, 0
s_add_u32 s55, s46, 0
buffer_load_dwordx4 v0, s[4:7], s55 offen offset:0 sc1 lds
buffer_load_dwordx4 v0, s[4:7], s55 offen offset:1024 sc1 lds
v_mfma_f32_32x32x16_bf16 v[48:63], v[8:11], v[136:139], v[48:63]
s_waitcnt lgkmcnt(2)
ds_read_b128 v[24:27], v64 offset:14336
buffer_load_dwordx4 v0, s[4:7], s55 offen offset:2048 sc1 lds
buffer_load_dwordx4 v0, s[4:7], s55 offen offset:3072 sc1 lds
v_mfma_f32_32x32x16_bf16 v[48:63], v[12:15], v[140:143], v[48:63]
s_waitcnt lgkmcnt(2)
ds_read_b128 v[8:11], v64 offset:15360
s_add_u32 m0, s45, 4096
s_add_u32 s55, s46, 4096
buffer_load_dwordx4 v0, s[4:7], s55 offen offset:0 sc1 lds
buffer_load_dwordx4 v0, s[4:7], s55 offen offset:1024 sc1 lds
v_mfma_f32_32x32x16_bf16 v[48:63], v[16:19], v[144:147], v[48:63]
s_waitcnt lgkmcnt(2)
ds_read_b128 v[12:15], v64 offset:16384
buffer_load_dwordx4 v0, s[4:7], s55 offen offset:2048 sc1 lds
buffer_load_dwordx4 v0, s[4:7], s55 offen offset:3072 sc1 lds
v_mfma_f32_32x32x16_bf16 v[48:63], v[20:23], v[148:151], v[48:63]
s_waitcnt lgkmcnt(2)
ds_read_b128 v[16:19], v64 offset:17408
s_add_u32 m0, s45, 8192
s_add_u32 s55, s46, 8192
buffer_load_dwordx4 v0, s[4:7], s55 offen offset:0 sc1 lds
buffer_load_dwordx4 v0, s[4:7], s55 offen offset:1024 sc1 lds
v_mfma_f32_32x32x16_bf16 v[48:63], v[24:27], v[152:155], v[48:63]
s_waitcnt lgkmcnt(2)
ds_read_b128 v[20:23], v64 offset:18432
s_add_u32 s45, s45, 40960
s_cmp_ge_u32 s45, 122880
s_cselect_b32 s55, 122880, 0
s_sub_u32 s45, s45, s55
s_add_u32 s46, s46, 40960
v_mfma_f32_32x32x16_bf16 v[48:63], v[8:11], v[156:159], v[48:63]
s_waitcnt lgkmcnt(2)
ds_read_b128 v[24:27], v64 offset:19456
v_mfma_f32_32x32x16_bf16 v[48:63], v[12:15], v[160:163], v[48:63]
s_waitcnt lgkmcnt(2)
ds_read_b128 v[8:11], v64 offset:20480
v_mfma_f32_32x32x16_bf16 v[48:63], v[16:19], v[164:167], v[48:63]
s_waitcnt lgkmcnt(2)
ds_read_b128 v[12:15], v64 offset:21504
v_mfma_f32_32x32x16_bf16 v[48:63], v[20:23], v[168:171], v[48:63]
s_waitcnt lgkmcnt(2)
ds_read_b128 v[16:19], v64 offset:22528
v_mfma_f32_32x32x16_bf16 v[48:63], v[24:27], v[172:175], v[48:63]
s_waitcnt lgkmcnt(2)
ds_read_b128 v[20:23], v64 offset:23552
v_mfma_f32_32x32x16_bf16 v[48:63], v[8:11], v[176:179], v[48:63]
s_waitcnt lgkmcnt(2)
ds_read_b128 v[24:27], v64 offset:24576
v_mfma_f32_32x32x16_bf16 v[48:63], v[12:15], v[180:183], v[48:63]
s_waitcnt lgkmcnt(2)
ds_read_b128 v[8:11], v64 offset:25600
v_mfma_f32_32x32x16_bf16 v[48:63], v[16:19], v[184:187], v[48:63]
s_waitcnt lgkmcnt(2)
ds_read_b128 v[12:15], v64 offset:26624
v_mfma_f32_32x32x16_bf16 v[48:63], v[20:23], v[188:191], v[48:63]
s_waitcnt lgkmcnt(2)
ds_read_b128 v[16:19], v64 offset:27648
v_mfma_f32_32x32x16_bf16 v[48:63], v[24:27], v[192:195], v[48:63]
s_waitcnt lgkmcnt(2)
ds_read_b128 v[20:23], v64 offset:28672
v_mfma_f32_32x32x16_bf16 v[48:63], v[8:11], v[196:199], v[48:63]
s_waitcnt lgkmcnt(2)
ds_read_b128 v[24:27], v64 offset:29696
v_mfma_f32_32x32x16_bf16 v[48:63], v[12:15], v[200:203], v[48:63]
s_waitcnt lgkmcnt(2)
ds_read_b128 v[8:11], v64 offset:30720
v_mfma_f32_32x32x16_bf16 v[48:63], v[16:19], v[204:207], v[48:63]
s_waitcnt lgkmcnt(2)
ds_read_b128 v[12:15], v64 offset:31744
v_mfma_f32_32x32x16_bf16 v[48:63], v[20:23], v[208:211], v[48:63]
s_waitcnt lgkmcnt(2)
ds_read_b128 v[16:19], v64 offset:32768
v_mfma_f32_32x32x16_bf16 v[48:63], v[24:27], v[212:215], v[48:63]
s_waitcnt lgkmcnt(2)
ds_read_b128 v[20:23], v64 offset:33792
v_mfma_f32_32x32x16_bf16 v[48:63], v[8:11], v[216:219], v[48:63]
s_waitcnt lgkmcnt(2)
ds_read_b128 v[24:27], v64 offset:34816
v_mfma_f32_32x32x16_bf16 v[48:63], v[12:15], v[220:223], v[48:63]
s_waitcnt lgkmcnt(2)
ds_read_b128 v[8:11], v64 offset:35840
v_mfma_f32_32x32x16_bf16 v[48:63], v[16:19], v[224:227], v[48:63]
s_waitcnt lgkmcnt(2)
ds_read_b128 v[12:15], v64 offset:36864
v_mfma_f32_32x32x16_bf16 v[48:63], v[20:23], v[228:231], v[48:63]
s_waitcnt lgkmcnt(2)
ds_read_b128 v[16:19], v64 offset:37888
v_mfma_f32_32x32x16_bf16 v[48:63], v[24:27], v[232:235], v[48:63]
s_waitcnt lgkmcnt(2)
ds_read_b128 v[20:23], v64 offset:38912
v_mfma_f32_32x32x16_bf16 v[48:63], v[8:11], v[236:239], v[48:63]
s_waitcnt lgkmcnt(2)
ds_read_b128 v[24:27], v64 offset:39936
v_mfma_f32_32x32x16_bf16 v[48:63], v[12:15], v[240:243], v[48:63]
s_add_u32 s44, s44, 1
s_cmp_eq_u32 s44, 3
s_mov_b32 s56, 40960
s_cmov_b32 s56, -81920
s_cselect_b32 s44, 0, s44
v_add_u32 v64, s56, v64
s_waitcnt vmcnt(10) lgkmcnt(2)
s_barrier
ds_read_b128 v[8:11], v64 offset:0
v_mfma_f32_32x32x16_bf16 v[48:63], v[16:19], v[244:247], v[48:63]
s_waitcnt lgkmcnt(2)
ds_read_b128 v[12:15], v64 offset:1024
v_mfma_f32_32x32x16_bf16 v[48:63], v[20:23], v[248:251], v[48:63]
s_waitcnt lgkmcnt(2)
ds_read_b128 v[16:19], v64 offset:2048
v_mfma_f32_32x32x16_bf16 v[48:63], v[24:27], v[252:255], v[48:63]
s_waitcnt lgkmcnt(2)
ds_read_b128 v[20:23], v64 offset:3072
v_mfma_f32_32x32x16_bf16 v[32:47], v[8:11], v[96:99], 0
s_waitcnt lgkmcnt(2)
ds_read_b128 v[24:27], v64 offset:4096
v_mfma_f32_32x32x16_bf16 v[32:47], v[12:15], v[100:103], v[32:47]
s_waitcnt lgkmcnt(2)
ds_read_b128 v[8:11], v64 offset:5120
v_cvt_pk_bf16_f32 v48, v48, v49
v_cvt_pk_bf16_f32 v49, v50, v51
v_mfma_f32_32x32x16_bf16 v[32:47], v[16:19], v[104:107], v[32:47]
s_waitcnt lgkmcnt(2)
ds_read_b128 v[12:15], v64 offset:6144
v_cvt_pk_bf16_f32 v50, v52, v53
v_cvt_pk_bf16_f32 v51, v54, v55
v_mfma_f32_32x32x16_bf16 v[32:47], v[20:23], v[108:111], v[32:47]
s_waitcnt lgkmcnt(2)
ds_read_b128 v[16:19], v64 offset:7168
v_cvt_pk_bf16_f32 v52, v56, v57
v_cvt_pk_bf16_f32 v53, v58, v59
v_mfma_f32_32x32x16_bf16 v[32:47], v[24:27], v[112:115], v[32:47]
s_waitcnt lgkmcnt(2)
ds_read_b128 v[20:23], v64 offset:8192
v_cvt_pk_bf16_f32 v54, v60, v61
v_cvt_pk_bf16_f32 v55, v62, v63
v_mfma_f32_32x32x16_bf16 v[32:47], v[8:11], v[116:119], v[32:47]
s_waitcnt lgkmcnt(2)
ds_read_b128 v[24:27], v64 offset:9216
v_accvgpr_write_b32 a120, v48
v_accvgpr_write_b32 a121, v49
v_mfma_f32_32x32x16_bf16 v[32:47], v[12:15], v[120:123], v[32:47]
s_waitcnt lgkmcnt(2)
ds_read_b128 v[8:11], v64 offset:10240
v_accvgpr_write_b32 a122, v50
v_accvgpr_write_b32 a123, v51
v_mfma_f32_32x32x16_bf16 v[32:47], v[16:19], v[124:127], v[32:47]
s_waitcnt lgkmcnt(2)
ds_read_b128 v[12:15], v64 offset:11264
v_accvgpr_write_b32 a124, v52
v_accvgpr_write_b32 a125, v53
v_mfma_f32_32x32x16_bf16 v[32:47], v[20:23], v[128:131], v[32:47]
s_waitcnt lgkmcnt(2)
ds_read_b128 v[16:19], v64 offset:12288
v_accvgpr_write_b32 a126, v54
v_accvgpr_write_b32 a127, v55
v_mfma_f32_32x32x16_bf16 v[32:47], v[24:27], v[132:135], v[32:47]
s_waitcnt lgkmcnt(2)
ds_read_b128 v[20:23], v64 offset:13312
s_add_u32 m0, s45, 0
s_add_u32 s55, s46, 0
buffer_load_dwordx4 v0, s[4:7], s55 offen offset:0 sc1 lds
buffer_load_dwordx4 v0, s[4:7], s55 offen offset:1024 sc1 lds
v_mfma_f32_32x32x16_bf16 v[32:47], v[8:11], v[136:139], v[32:47]
s_waitcnt lgkmcnt(2)
ds_read_b128 v[24:27], v64 offset:14336
buffer_load_dwordx4 v0, s[4:7], s55 offen offset:2048 sc1 lds
buffer_load_dwordx4 v0, s[4:7], s55 offen offset:3072 sc1 lds
v_mfma_f32_32x32x16_bf16 v[32:47], v[12:15], v[140:143], v[32:47]
s_waitcnt lgkmcnt(2)
ds_read_b128 v[8:11], v64 offset:15360
s_add_u32 m0, s45, 4096
s_add_u32 s55, s46, 4096
buffer_load_dwordx4 v0, s[4:7], s55 offen offset:0 sc1 lds
buffer_load_dwordx4 v0, s[4:7], s55 offen offset:1024 sc1 lds
v_mfma_f32_32x32x16_bf16 v[32:47], v[16:19], v[144:147], v[32:47]
s_waitcnt lgkmcnt(2)
ds_read_b128 v[12:15], v64 offset:16384
buffer_load_dwordx4 v0, s[4:7], s55 offen offset:2048 sc1 lds
buffer_load_dwordx4 v0, s[4:7], s55 offen offset:3072 sc1 lds
v_mfma_f32_32x32x16_bf16 v[32:47], v[20:23], v[148:151], v[32:47]
s_waitcnt lgkmcnt(2)
ds_read_b128 v[16:19], v64 offset:17408
s_add_u32 m0, s45, 8192
s_add_u32 s55, s46, 8192
buffer_load_dwordx4 v0, s[4:7], s55 offen offset:0 sc1 lds
buffer_load_dwordx4 v0, s[4:7], s55 offen offset:1024 sc1 lds
v_mfma_f32_32x32x16_bf16 v[32:47], v[24:27], v[152:155], v[32:47]
s_waitcnt lgkmcnt(2)
ds_read_b128 v[20:23], v64 offset:18432
s_add_u32 s45, s45, 40960
s_cmp_ge_u32 s45, 122880
s_cselect_b32 s55, 122880, 0
s_sub_u32 s45, s45, s55
s_add_u32 s46, s46, 40960
v_mfma_f32_32x32x16_bf16 v[32:47], v[8:11], v[156:159], v[32:47]
s_waitcnt lgkmcnt(2)
ds_read_b128 v[24:27], v64 offset:19456
v_mfma_f32_32x32x16_bf16 v[32:47], v[12:15], v[160:163], v[32:47]
s_waitcnt lgkmcnt(2)
ds_read_b128 v[8:11], v64 offset:20480
v_mfma_f32_32x32x16_bf16 v[32:47], v[16:19], v[164:167], v[32:47]
s_waitcnt lgkmcnt(2)
ds_read_b128 v[12:15], v64 offset:21504
v_mfma_f32_32x32x16_bf16 v[32:47], v[20:23], v[168:171], v[32:47]
s_waitcnt lgkmcnt(2)
ds_read_b128 v[16:19], v64 offset:22528
v_mfma_f32_32x32x16_bf16 v[32:47], v[24:27], v[172:175], v[32:47]
s_waitcnt lgkmcnt(2)
ds_read_b128 v[20:23], v64 offset:23552
v_mfma_f32_32x32x16_bf16 v[32:47], v[8:11], v[176:179], v[32:47]
s_waitcnt lgkmcnt(2)
ds_read_b128 v[24:27], v64 offset:24576
v_mfma_f32_32x32x16_bf16 v[32:47], v[12:15], v[180:183], v[32:47]
s_waitcnt lgkmcnt(2)
ds_read_b128 v[8:11], v64 offset:25600
v_mfma_f32_32x32x16_bf16 v[32:47], v[16:19], v[184:187], v[32:47]
s_waitcnt lgkmcnt(2)
ds_read_b128 v[12:15], v64 offset:26624
v_mfma_f32_32x32x16_bf16 v[32:47], v[20:23], v[188:191], v[32:47]
s_waitcnt lgkmcnt(2)
ds_read_b128 v[16:19], v64 offset:27648
v_mfma_f32_32x32x16_bf16 v[32:47], v[24:27], v[192:195], v[32:47]
s_waitcnt lgkmcnt(2)
ds_read_b128 v[20:23], v64 offset:28672
v_mfma_f32_32x32x16_bf16 v[32:47], v[8:11], v[196:199], v[32:47]
s_waitcnt lgkmcnt(2)
ds_read_b128 v[24:27], v64 offset:29696
v_mfma_f32_32x32x16_bf16 v[32:47], v[12:15], v[200:203], v[32:47]
s_waitcnt lgkmcnt(2)
ds_read_b128 v[8:11], v64 offset:30720
v_mfma_f32_32x32x16_bf16 v[32:47], v[16:19], v[204:207], v[32:47]
s_waitcnt lgkmcnt(2)
ds_read_b128 v[12:15], v64 offset:31744
v_mfma_f32_32x32x16_bf16 v[32:47], v[20:23], v[208:211], v[32:47]
s_waitcnt lgkmcnt(2)
ds_read_b128 v[16:19], v64 offset:32768
v_mfma_f32_32x32x16_bf16 v[32:47], v[24:27], v[212:215], v[32:47]
s_waitcnt lgkmcnt(2)
ds_read_b128 v[20:23], v64 offset:33792
v_mfma_f32_32x32x16_bf16 v[32:47], v[8:11], v[216:219], v[32:47]
s_waitcnt lgkmcnt(2)
ds_read_b128 v[24:27], v64 offset:34816
v_mfma_f32_32x32x16_bf16 v[32:47], v[12:15], v[220:223], v[32:47]
s_waitcnt lgkmcnt(2)
ds_read_b128 v[8:11], v64 offset:35840
v_mfma_f32_32x32x16_bf16 v[32:47], v[16:19], v[224:227], v[32:47]
s_waitcnt lgkmcnt(2)
ds_read_b128 v[12:15], v64 offset:36864
v_mfma_f32_32x32x16_bf16 v[32:47], v[20:23], v[228:231], v[32:47]
s_waitcnt lgkmcnt(2)
ds_read_b128 v[16:19], v64 offset:37888
v_mfma_f32_32x32x16_bf16 v[32:47], v[24:27], v[232:235], v[32:47]
s_waitcnt lgkmcnt(2)
ds_read_b128 v[20:23], v64 offset:38912
v_mfma_f32_32x32x16_bf16 v[32:47], v[8:11], v[236:239], v[32:47]
s_waitcnt lgkmcnt(2)
ds_read_b128 v[24:27], v64 offset:39936
v_mfma_f32_32x32x16_bf16 v[32:47], v[12:15], v[240:243], v[32:47]
s_add_u32 s44, s44, 1
s_cmp_eq_u32 s44, 3
s_mov_b32 s56, 40960
s_cmov_b32 s56, -81920
s_cselect_b32 s44, 0, s44
v_add_u32 v64, s56, v64
s_waitcnt vmcnt(10) lgkmcnt(2)
s_barrier
ds_read_b128 v[8:11], v64 offset:0
v_mfma_f32_32x32x16_bf16 v[32:47], v[16:19], v[244:247], v[32:47]
s_waitcnt lgkmcnt(2)
ds_read_b128 v[12:15], v64 offset:1024
v_mfma_f32_32x32x16_bf16 v[32:47], v[20:23], v[248:251], v[32:47]
s_waitcnt lgkmcnt(2)
ds_read_b128 v[16:19], v64 offset:2048
v_mfma_f32_32x32x16_bf16 v[32:47], v[24:27], v[252:255], v[32:47]
s_waitcnt lgkmcnt(2)
ds_read_b128 v[20:23], v64 offset:3072
v_mfma_f32_32x32x16_bf16 v[48:63], v[8:11], v[96:99], 0
s_waitcnt lgkmcnt(2)
ds_read_b128 v[24:27], v64 offset:4096
v_mfma_f32_32x32x16_bf16 v[48:63], v[12:15], v[100:103], v[48:63]
s_waitcnt lgkmcnt(2)
ds_read_b128 v[8:11], v64 offset:5120
v_cvt_pk_bf16_f32 v32, v32, v33
v_cvt_pk_bf16_f32 v33, v34, v35
v_mfma_f32_32x32x16_bf16 v[48:63], v[16:19], v[104:107], v[48:63]
s_waitcnt lgkmcnt(2)
ds_read_b128 v[12:15], v64 offset:6144
v_cvt_pk_bf16_f32 v34, v36, v37
v_cvt_pk_bf16_f32 v35, v38, v39
v_mfma_f32_32x32x16_bf16 v[48:63], v[20:23], v[108:111], v[48:63]
s_waitcnt lgkmcnt(2)
ds_read_b128 v[16:19], v64 offset:7168
v_cvt_pk_bf16_f32 v36, v40, v41
v_cvt_pk_bf16_f32 v37, v42, v43
v_mfma_f32_32x32x16_bf16 v[48:63], v[24:27], v[112:115], v[48:63]
s_waitcnt lgkmcnt(2)
ds_read_b128 v[20:23], v64 offset:8192
v_cvt_pk_bf16_f32 v38, v44, v45
v_cvt_pk_bf16_f32 v39, v46, v47
v_mfma_f32_32x32x16_bf16 v[48:63], v[8:11], v[116:119], v[48:63]
s_waitcnt lgkmcnt(2)
ds_read_b128 v[24:27], v64 offset:9216
v_accvgpr_write_b32 a128, v32
v_accvgpr_write_b32 a129, v33
v_mfma_f32_32x32x16_bf16 v[48:63], v[12:15], v[120:123], v[48:63]
s_waitcnt lgkmcnt(2)
ds_read_b128 v[8:11], v64 offset:10240
v_accvgpr_write_b32 a130, v34
v_accvgpr_write_b32 a131, v35
v_mfma_f32_32x32x16_bf16 v[48:63], v[16:19], v[124:127], v[48:63]
s_waitcnt lgkmcnt(2)
ds_read_b128 v[12:15], v64 offset:11264
v_accvgpr_write_b32 a132, v36
v_accvgpr_write_b32 a133, v37
v_mfma_f32_32x32x16_bf16 v[48:63], v[20:23], v[128:131], v[48:63]
s_waitcnt lgkmcnt(2)
ds_read_b128 v[16:19], v64 offset:12288
v_accvgpr_write_b32 a134, v38
v_accvgpr_write_b32 a135, v39
v_mfma_f32_32x32x16_bf16 v[48:63], v[24:27], v[132:135], v[48:63]
s_waitcnt lgkmcnt(2)
ds_read_b128 v[20:23], v64 offset:13312
s_add_u32 m0, s45, 0
s_add_u32 s55, s46, 0
buffer_load_dwordx4 v0, s[4:7], s55 offen offset:0 sc1 lds
buffer_load_dwordx4 v0, s[4:7], s55 offen offset:1024 sc1 lds
v_mfma_f32_32x32x16_bf16 v[48:63], v[8:11], v[136:139], v[48:63]
s_waitcnt lgkmcnt(2)
ds_read_b128 v[24:27], v64 offset:14336
buffer_load_dwordx4 v0, s[4:7], s55 offen offset:2048 sc1 lds
buffer_load_dwordx4 v0, s[4:7], s55 offen offset:3072 sc1 lds
v_mfma_f32_32x32x16_bf16 v[48:63], v[12:15], v[140:143], v[48:63]
s_waitcnt lgkmcnt(2)
ds_read_b128 v[8:11], v64 offset:15360
s_add_u32 m0, s45, 4096
s_add_u32 s55, s46, 4096
buffer_load_dwordx4 v0, s[4:7], s55 offen offset:0 sc1 lds
buffer_load_dwordx4 v0, s[4:7], s55 offen offset:1024 sc1 lds
v_mfma_f32_32x32x16_bf16 v[48:63], v[16:19], v[144:147], v[48:63]
s_waitcnt lgkmcnt(2)
ds_read_b128 v[12:15], v64 offset:16384
buffer_load_dwordx4 v0, s[4:7], s55 offen offset:2048 sc1 lds
buffer_load_dwordx4 v0, s[4:7], s55 offen offset:3072 sc1 lds
v_mfma_f32_32x32x16_bf16 v[48:63], v[20:23], v[148:151], v[48:63]
s_waitcnt lgkmcnt(2)
ds_read_b128 v[16:19], v64 offset:17408
s_add_u32 m0, s45, 8192
s_add_u32 s55, s46, 8192
buffer_load_dwordx4 v0, s[4:7], s55 offen offset:0 sc1 lds
buffer_load_dwordx4 v0, s[4:7], s55 offen offset:1024 sc1 lds
v_mfma_f32_32x32x16_bf16 v[48:63], v[24:27], v[152:155], v[48:63]
s_waitcnt lgkmcnt(2)
ds_read_b128 v[20:23], v64 offset:18432
s_add_u32 s45, s45, 40960
s_cmp_ge_u32 s45, 122880
s_cselect_b32 s55, 122880, 0
s_sub_u32 s45, s45, s55
s_add_u32 s46, s46, 40960
v_mfma_f32_32x32x16_bf16 v[48:63], v[8:11], v[156:159], v[48:63]
s_waitcnt lgkmcnt(2)
ds_read_b128 v[24:27], v64 offset:19456
v_mfma_f32_32x32x16_bf16 v[48:63], v[12:15], v[160:163], v[48:63]
s_waitcnt lgkmcnt(2)
ds_read_b128 v[8:11], v64 offset:20480
v_mfma_f32_32x32x16_bf16 v[48:63], v[16:19], v[164:167], v[48:63]
s_waitcnt lgkmcnt(2)
ds_read_b128 v[12:15], v64 offset:21504
v_mfma_f32_32x32x16_bf16 v[48:63], v[20:23], v[168:171], v[48:63]
s_waitcnt lgkmcnt(2)
ds_read_b128 v[16:19], v64 offset:22528
v_mfma_f32_32x32x16_bf16 v[48:63], v[24:27], v[172:175], v[48:63]
s_waitcnt lgkmcnt(2)
ds_read_b128 v[20:23], v64 offset:23552
v_mfma_f32_32x32x16_bf16 v[48:63], v[8:11], v[176:179], v[48:63]
s_waitcnt lgkmcnt(2)
ds_read_b128 v[24:27], v64 offset:24576
v_mfma_f32_32x32x16_bf16 v[48:63], v[12:15], v[180:183], v[48:63]
s_waitcnt lgkmcnt(2)
ds_read_b128 v[8:11], v64 offset:25600
v_mfma_f32_32x32x16_bf16 v[48:63], v[16:19], v[184:187], v[48:63]
s_waitcnt lgkmcnt(2)
ds_read_b128 v[12:15], v64 offset:26624
v_mfma_f32_32x32x16_bf16 v[48:63], v[20:23], v[188:191], v[48:63]
s_waitcnt lgkmcnt(2)
ds_read_b128 v[16:19], v64 offset:27648
v_mfma_f32_32x32x16_bf16 v[48:63], v[24:27], v[192:195], v[48:63]
s_waitcnt lgkmcnt(2)
ds_read_b128 v[20:23], v64 offset:28672
v_mfma_f32_32x32x16_bf16 v[48:63], v[8:11], v[196:199], v[48:63]
s_waitcnt lgkmcnt(2)
ds_read_b128 v[24:27], v64 offset:29696
v_mfma_f32_32x32x16_bf16 v[48:63], v[12:15], v[200:203], v[48:63]
s_waitcnt lgkmcnt(2)
ds_read_b128 v[8:11], v64 offset:30720
v_mfma_f32_32x32x16_bf16 v[48:63], v[16:19], v[204:207], v[48:63]
s_waitcnt lgkmcnt(2)
ds_read_b128 v[12:15], v64 offset:31744
v_mfma_f32_32x32x16_bf16 v[48:63], v[20:23], v[208:211], v[48:63]
s_waitcnt lgkmcnt(2)
ds_read_b128 v[16:19], v64 offset:32768
v_mfma_f32_32x32x16_bf16 v[48:63], v[24:27], v[212:215], v[48:63]
s_waitcnt lgkmcnt(2)
ds_read_b128 v[20:23], v64 offset:33792
v_mfma_f32_32x32x16_bf16 v[48:63], v[8:11], v[216:219], v[48:63]
s_waitcnt lgkmcnt(2)
ds_read_b128 v[24:27], v64 offset:34816
v_mfma_f32_32x32x16_bf16 v[48:63], v[12:15], v[220:223], v[48:63]
s_waitcnt lgkmcnt(2)
ds_read_b128 v[8:11], v64 offset:35840
v_mfma_f32_32x32x16_bf16 v[48:63], v[16:19], v[224:227], v[48:63]
s_waitcnt lgkmcnt(2)
ds_read_b128 v[12:15], v64 offset:36864
v_mfma_f32_32x32x16_bf16 v[48:63], v[20:23], v[228:231], v[48:63]
s_waitcnt lgkmcnt(2)
ds_read_b128 v[16:19], v64 offset:37888
v_mfma_f32_32x32x16_bf16 v[48:63], v[24:27], v[232:235], v[48:63]
s_waitcnt lgkmcnt(2)
ds_read_b128 v[20:23], v64 offset:38912
v_mfma_f32_32x32x16_bf16 v[48:63], v[8:11], v[236:239], v[48:63]
s_waitcnt lgkmcnt(2)
ds_read_b128 v[24:27], v64 offset:39936
v_mfma_f32_32x32x16_bf16 v[48:63], v[12:15], v[240:243], v[48:63]
s_add_u32 s44, s44, 1
s_cmp_eq_u32 s44, 3
s_mov_b32 s56, 40960
s_cmov_b32 s56, -81920
s_cselect_b32 s44, 0, s44
v_add_u32 v64, s56, v64
s_waitcnt vmcnt(10) lgkmcnt(2)
s_barrier
ds_read_b128 v[8:11], v64 offset:0
v_mfma_f32_32x32x16_bf16 v[48:63], v[16:19], v[244:247], v[48:63]
s_waitcnt lgkmcnt(2)
ds_read_b128 v[12:15], v64 offset:1024
v_mfma_f32_32x32x16_bf16 v[48:63], v[20:23], v[248:251], v[48:63]
s_waitcnt lgkmcnt(2)
ds_read_b128 v[16:19], v64 offset:2048
v_mfma_f32_32x32x16_bf16 v[48:63], v[24:27], v[252:255], v[48:63]
s_waitcnt lgkmcnt(2)
ds_read_b128 v[20:23], v64 offset:3072
v_mfma_f32_32x32x16_bf16 v[32:47], v[8:11], v[96:99], 0
s_waitcnt lgkmcnt(2)
ds_read_b128 v[24:27], v64 offset:4096
v_mfma_f32_32x32x16_bf16 v[32:47], v[12:15], v[100:103], v[32:47]
s_waitcnt lgkmcnt(2)
ds_read_b128 v[8:11], v64 offset:5120
v_cvt_pk_bf16_f32 v48, v48, v49
v_cvt_pk_bf16_f32 v49, v50, v51
v_mfma_f32_32x32x16_bf16 v[32:47], v[16:19], v[104:107], v[32:47]
s_waitcnt lgkmcnt(2)
ds_read_b128 v[12:15], v64 offset:6144
v_cvt_pk_bf16_f32 v50, v52, v53
v_cvt_pk_bf16_f32 v51, v54, v55
v_mfma_f32_32x32x16_bf16 v[32:47], v[20:23], v[108:111], v[32:47]
s_waitcnt lgkmcnt(2)
ds_read_b128 v[16:19], v64 offset:7168
v_cvt_pk_bf16_f32 v52, v56, v57
v_cvt_pk_bf16_f32 v53, v58, v59
v_mfma_f32_32x32x16_bf16 v[32:47], v[24:27], v[112:115], v[32:47]
s_waitcnt lgkmcnt(2)
ds_read_b128 v[20:23], v64 offset:8192
v_cvt_pk_bf16_f32 v54, v60, v61
v_cvt_pk_bf16_f32 v55, v62, v63
v_mfma_f32_32x32x16_bf16 v[32:47], v[8:11], v[116:119], v[32:47]
s_waitcnt lgkmcnt(2)
ds_read_b128 v[24:27], v64 offset:9216
v_accvgpr_write_b32 a136, v48
v_accvgpr_write_b32 a137, v49
v_mfma_f32_32x32x16_bf16 v[32:47], v[12:15], v[120:123], v[32:47]
s_waitcnt lgkmcnt(2)
ds_read_b128 v[8:11], v64 offset:10240
v_accvgpr_write_b32 a138, v50
v_accvgpr_write_b32 a139, v51
v_mfma_f32_32x32x16_bf16 v[32:47], v[16:19], v[124:127], v[32:47]
s_waitcnt lgkmcnt(2)
ds_read_b128 v[12:15], v64 offset:11264
v_accvgpr_write_b32 a140, v52
v_accvgpr_write_b32 a141, v53
v_mfma_f32_32x32x16_bf16 v[32:47], v[20:23], v[128:131], v[32:47]
s_waitcnt lgkmcnt(2)
ds_read_b128 v[16:19], v64 offset:12288
v_accvgpr_write_b32 a142, v54
v_accvgpr_write_b32 a143, v55
v_mfma_f32_32x32x16_bf16 v[32:47], v[24:27], v[132:135], v[32:47]
s_waitcnt lgkmcnt(2)
ds_read_b128 v[20:23], v64 offset:13312
s_add_u32 m0, s45, 0
s_add_u32 s55, s46, 0
buffer_load_dwordx4 v0, s[4:7], s55 offen offset:0 sc1 lds
buffer_load_dwordx4 v0, s[4:7], s55 offen offset:1024 sc1 lds
v_mfma_f32_32x32x16_bf16 v[32:47], v[8:11], v[136:139], v[32:47]
s_waitcnt lgkmcnt(2)
ds_read_b128 v[24:27], v64 offset:14336
buffer_load_dwordx4 v0, s[4:7], s55 offen offset:2048 sc1 lds
buffer_load_dwordx4 v0, s[4:7], s55 offen offset:3072 sc1 lds
v_mfma_f32_32x32x16_bf16 v[32:47], v[12:15], v[140:143], v[32:47]
s_waitcnt lgkmcnt(2)
ds_read_b128 v[8:11], v64 offset:15360
s_add_u32 m0, s45, 4096
s_add_u32 s55, s46, 4096
buffer_load_dwordx4 v0, s[4:7], s55 offen offset:0 sc1 lds
buffer_load_dwordx4 v0, s[4:7], s55 offen offset:1024 sc1 lds
v_mfma_f32_32x32x16_bf16 v[32:47], v[16:19], v[144:147], v[32:47]
s_waitcnt lgkmcnt(2)
ds_read_b128 v[12:15], v64 offset:16384
buffer_load_dwordx4 v0, s[4:7], s55 offen offset:2048 sc1 lds
buffer_load_dwordx4 v0, s[4:7], s55 offen offset:3072 sc1 lds
v_mfma_f32_32x32x16_bf16 v[32:47], v[20:23], v[148:151], v[32:47]
s_waitcnt lgkmcnt(2)
ds_read_b128 v[16:19], v64 offset:17408
s_add_u32 m0, s45, 8192
s_add_u32 s55, s46, 8192
buffer_load_dwordx4 v0, s[4:7], s55 offen offset:0 sc1 lds
buffer_load_dwordx4 v0, s[4:7], s55 offen offset:1024 sc1 lds
v_mfma_f32_32x32x16_bf16 v[32:47], v[24:27], v[152:155], v[32:47]
s_waitcnt lgkmcnt(2)
ds_read_b128 v[20:23], v64 offset:18432
s_add_u32 s45, s45, 40960
s_cmp_ge_u32 s45, 122880
s_cselect_b32 s55, 122880, 0
s_sub_u32 s45, s45, s55
s_add_u32 s46, s46, 40960
v_mfma_f32_32x32x16_bf16 v[32:47], v[8:11], v[156:159], v[32:47]
s_waitcnt lgkmcnt(2)
ds_read_b128 v[24:27], v64 offset:19456
v_mfma_f32_32x32x16_bf16 v[32:47], v[12:15], v[160:163], v[32:47]
s_waitcnt lgkmcnt(2)
ds_read_b128 v[8:11], v64 offset:20480
v_mfma_f32_32x32x16_bf16 v[32:47], v[16:19], v[164:167], v[32:47]
s_waitcnt lgkmcnt(2)
ds_read_b128 v[12:15], v64 offset:21504
v_mfma_f32_32x32x16_bf16 v[32:47], v[20:23], v[168:171], v[32:47]
s_waitcnt lgkmcnt(2)
ds_read_b128 v[16:19], v64 offset:22528
v_mfma_f32_32x32x16_bf16 v[32:47], v[24:27], v[172:175], v[32:47]
s_waitcnt lgkmcnt(2)
ds_read_b128 v[20:23], v64 offset:23552
v_mfma_f32_32x32x16_bf16 v[32:47], v[8:11], v[176:179], v[32:47]
s_waitcnt lgkmcnt(2)
ds_read_b128 v[24:27], v64 offset:24576
v_mfma_f32_32x32x16_bf16 v[32:47], v[12:15], v[180:183], v[32:47]
s_waitcnt lgkmcnt(2)
ds_read_b128 v[8:11], v64 offset:25600
v_mfma_f32_32x32x16_bf16 v[32:47], v[16:19], v[184:187], v[32:47]
s_waitcnt lgkmcnt(2)
ds_read_b128 v[12:15], v64 offset:26624
v_mfma_f32_32x32x16_bf16 v[32:47], v[20:23], v[188:191], v[32:47]
s_waitcnt lgkmcnt(2)
ds_read_b128 v[16:19], v64 offset:27648
v_mfma_f32_32x32x16_bf16 v[32:47], v[24:27], v[192:195], v[32:47]
s_waitcnt lgkmcnt(2)
ds_read_b128 v[20:23], v64 offset:28672
v_mfma_f32_32x32x16_bf16 v[32:47], v[8:11], v[196:199], v[32:47]
s_waitcnt lgkmcnt(2)
ds_read_b128 v[24:27], v64 offset:29696
v_mfma_f32_32x32x16_bf16 v[32:47], v[12:15], v[200:203], v[32:47]
s_waitcnt lgkmcnt(2)
ds_read_b128 v[8:11], v64 offset:30720
v_mfma_f32_32x32x16_bf16 v[32:47], v[16:19], v[204:207], v[32:47]
s_waitcnt lgkmcnt(2)
ds_read_b128 v[12:15], v64 offset:31744
v_mfma_f32_32x32x16_bf16 v[32:47], v[20:23], v[208:211], v[32:47]
s_waitcnt lgkmcnt(2)
ds_read_b128 v[16:19], v64 offset:32768
v_mfma_f32_32x32x16_bf16 v[32:47], v[24:27], v[212:215], v[32:47]
s_waitcnt lgkmcnt(2)
ds_read_b128 v[20:23], v64 offset:33792
v_mfma_f32_32x32x16_bf16 v[32:47], v[8:11], v[216:219], v[32:47]
s_waitcnt lgkmcnt(2)
ds_read_b128 v[24:27], v64 offset:34816
v_mfma_f32_32x32x16_bf16 v[32:47], v[12:15], v[220:223], v[32:47]
s_waitcnt lgkmcnt(2)
ds_read_b128 v[8:11], v64 offset:35840
v_mfma_f32_32x32x16_bf16 v[32:47], v[16:19], v[224:227], v[32:47]
s_waitcnt lgkmcnt(2)
ds_read_b128 v[12:15], v64 offset:36864
v_mfma_f32_32x32x16_bf16 v[32:47], v[20:23], v[228:231], v[32:47]
s_waitcnt lgkmcnt(2)
ds_read_b128 v[16:19], v64 offset:37888
v_mfma_f32_32x32x16_bf16 v[32:47], v[24:27], v[232:235], v[32:47]
s_waitcnt lgkmcnt(2)
ds_read_b128 v[20:23], v64 offset:38912
v_mfma_f32_32x32x16_bf16 v[32:47], v[8:11], v[236:239], v[32:47]
s_waitcnt lgkmcnt(2)
ds_read_b128 v[24:27], v64 offset:39936
v_mfma_f32_32x32x16_bf16 v[32:47], v[12:15], v[240:243], v[32:47]
s_add_u32 s44, s44, 1
s_cmp_eq_u32 s44, 3
s_mov_b32 s56, 40960
s_cmov_b32 s56, -81920
s_cselect_b32 s44, 0, s44
v_add_u32 v64, s56, v64
s_waitcnt vmcnt(10) lgkmcnt(2)
s_barrier
ds_read_b128 v[8:11], v64 offset:0
v_mfma_f32_32x32x16_bf16 v[32:47], v[16:19], v[244:247], v[32:47]
s_waitcnt lgkmcnt(2)
ds_read_b128 v[12:15], v64 offset:1024
v_mfma_f32_32x32x16_bf16 v[32:47], v[20:23], v[248:251], v[32:47]
s_waitcnt lgkmcnt(2)
ds_read_b128 v[16:19], v64 offset:2048
v_mfma_f32_32x32x16_bf16 v[32:47], v[24:27], v[252:255], v[32:47]
s_waitcnt lgkmcnt(2)
ds_read_b128 v[20:23], v64 offset:3072
v_mfma_f32_32x32x16_bf16 v[48:63], v[8:11], v[96:99], 0
s_waitcnt lgkmcnt(2)
ds_read_b128 v[24:27], v64 offset:4096
v_mfma_f32_32x32x16_bf16 v[48:63], v[12:15], v[100:103], v[48:63]
s_waitcnt lgkmcnt(2)
ds_read_b128 v[8:11], v64 offset:5120
v_cvt_pk_bf16_f32 v32, v32, v33
v_cvt_pk_bf16_f32 v33, v34, v35
v_mfma_f32_32x32x16_bf16 v[48:63], v[16:19], v[104:107], v[48:63]
s_waitcnt lgkmcnt(2)
ds_read_b128 v[12:15], v64 offset:6144
v_cvt_pk_bf16_f32 v34, v36, v37
v_cvt_pk_bf16_f32 v35, v38, v39
v_mfma_f32_32x32x16_bf16 v[48:63], v[20:23], v[108:111], v[48:63]
s_waitcnt lgkmcnt(2)
ds_read_b128 v[16:19], v64 offset:7168
v_cvt_pk_bf16_f32 v36, v40, v41
v_cvt_pk_bf16_f32 v37, v42, v43
v_mfma_f32_32x32x16_bf16 v[48:63], v[24:27], v[112:115], v[48:63]
s_waitcnt lgkmcnt(2)
ds_read_b128 v[20:23], v64 offset:8192
v_cvt_pk_bf16_f32 v38, v44, v45
v_cvt_pk_bf16_f32 v39, v46, v47
v_mfma_f32_32x32x16_bf16 v[48:63], v[8:11], v[116:119], v[48:63]
s_waitcnt lgkmcnt(2)
ds_read_b128 v[24:27], v64 offset:9216
v_accvgpr_write_b32 a144, v32
v_accvgpr_write_b32 a145, v33
v_mfma_f32_32x32x16_bf16 v[48:63], v[12:15], v[120:123], v[48:63]
s_waitcnt lgkmcnt(2)
ds_read_b128 v[8:11], v64 offset:10240
v_accvgpr_write_b32 a146, v34
v_accvgpr_write_b32 a147, v35
v_mfma_f32_32x32x16_bf16 v[48:63], v[16:19], v[124:127], v[48:63]
s_waitcnt lgkmcnt(2)
ds_read_b128 v[12:15], v64 offset:11264
v_accvgpr_write_b32 a148, v36
v_accvgpr_write_b32 a149, v37
v_mfma_f32_32x32x16_bf16 v[48:63], v[20:23], v[128:131], v[48:63]
s_waitcnt lgkmcnt(2)
ds_read_b128 v[16:19], v64 offset:12288
v_accvgpr_write_b32 a150, v38
v_accvgpr_write_b32 a151, v39
v_mfma_f32_32x32x16_bf16 v[48:63], v[24:27], v[132:135], v[48:63]
s_waitcnt lgkmcnt(2)
ds_read_b128 v[20:23], v64 offset:13312
s_add_u32 m0, s45, 0
s_add_u32 s55, s46, 0
buffer_load_dwordx4 v0, s[4:7], s55 offen offset:0 sc1 lds
buffer_load_dwordx4 v0, s[4:7], s55 offen offset:1024 sc1 lds
v_mfma_f32_32x32x16_bf16 v[48:63], v[8:11], v[136:139], v[48:63]
s_waitcnt lgkmcnt(2)
ds_read_b128 v[24:27], v64 offset:14336
buffer_load_dwordx4 v0, s[4:7], s55 offen offset:2048 sc1 lds
buffer_load_dwordx4 v0, s[4:7], s55 offen offset:3072 sc1 lds
v_mfma_f32_32x32x16_bf16 v[48:63], v[12:15], v[140:143], v[48:63]
s_waitcnt lgkmcnt(2)
ds_read_b128 v[8:11], v64 offset:15360
s_add_u32 m0, s45, 4096
s_add_u32 s55, s46, 4096
buffer_load_dwordx4 v0, s[4:7], s55 offen offset:0 sc1 lds
buffer_load_dwordx4 v0, s[4:7], s55 offen offset:1024 sc1 lds
v_mfma_f32_32x32x16_bf16 v[48:63], v[16:19], v[144:147], v[48:63]
s_waitcnt lgkmcnt(2)
ds_read_b128 v[12:15], v64 offset:16384
buffer_load_dwordx4 v0, s[4:7], s55 offen offset:2048 sc1 lds
buffer_load_dwordx4 v0, s[4:7], s55 offen offset:3072 sc1 lds
v_mfma_f32_32x32x16_bf16 v[48:63], v[20:23], v[148:151], v[48:63]
s_waitcnt lgkmcnt(2)
ds_read_b128 v[16:19], v64 offset:17408
s_add_u32 m0, s45, 8192
s_add_u32 s55, s46, 8192
buffer_load_dwordx4 v0, s[4:7], s55 offen offset:0 sc1 lds
buffer_load_dwordx4 v0, s[4:7], s55 offen offset:1024 sc1 lds
v_mfma_f32_32x32x16_bf16 v[48:63], v[24:27], v[152:155], v[48:63]
s_waitcnt lgkmcnt(2)
ds_read_b128 v[20:23], v64 offset:18432
s_add_u32 s45, s45, 40960
s_cmp_ge_u32 s45, 122880
s_cselect_b32 s55, 122880, 0
s_sub_u32 s45, s45, s55
s_add_u32 s46, s46, 40960
v_mfma_f32_32x32x16_bf16 v[48:63], v[8:11], v[156:159], v[48:63]
s_waitcnt lgkmcnt(2)
ds_read_b128 v[24:27], v64 offset:19456
v_mfma_f32_32x32x16_bf16 v[48:63], v[12:15], v[160:163], v[48:63]
s_waitcnt lgkmcnt(2)
ds_read_b128 v[8:11], v64 offset:20480
v_mfma_f32_32x32x16_bf16 v[48:63], v[16:19], v[164:167], v[48:63]
s_waitcnt lgkmcnt(2)
ds_read_b128 v[12:15], v64 offset:21504
v_mfma_f32_32x32x16_bf16 v[48:63], v[20:23], v[168:171], v[48:63]
s_waitcnt lgkmcnt(2)
ds_read_b128 v[16:19], v64 offset:22528
v_mfma_f32_32x32x16_bf16 v[48:63], v[24:27], v[172:175], v[48:63]
s_waitcnt lgkmcnt(2)
ds_read_b128 v[20:23], v64 offset:23552
v_mfma_f32_32x32x16_bf16 v[48:63], v[8:11], v[176:179], v[48:63]
s_waitcnt lgkmcnt(2)
ds_read_b128 v[24:27], v64 offset:24576
v_mfma_f32_32x32x16_bf16 v[48:63], v[12:15], v[180:183], v[48:63]
s_waitcnt lgkmcnt(2)
ds_read_b128 v[8:11], v64 offset:25600
v_mfma_f32_32x32x16_bf16 v[48:63], v[16:19], v[184:187], v[48:63]
s_waitcnt lgkmcnt(2)
ds_read_b128 v[12:15], v64 offset:26624
v_mfma_f32_32x32x16_bf16 v[48:63], v[20:23], v[188:191], v[48:63]
s_waitcnt lgkmcnt(2)
ds_read_b128 v[16:19], v64 offset:27648
v_mfma_f32_32x32x16_bf16 v[48:63], v[24:27], v[192:195], v[48:63]
s_waitcnt lgkmcnt(2)
ds_read_b128 v[20:23], v64 offset:28672
v_mfma_f32_32x32x16_bf16 v[48:63], v[8:11], v[196:199], v[48:63]
s_waitcnt lgkmcnt(2)
ds_read_b128 v[24:27], v64 offset:29696
v_mfma_f32_32x32x16_bf16 v[48:63], v[12:15], v[200:203], v[48:63]
s_waitcnt lgkmcnt(2)
ds_read_b128 v[8:11], v64 offset:30720
v_mfma_f32_32x32x16_bf16 v[48:63], v[16:19], v[204:207], v[48:63]
s_waitcnt lgkmcnt(2)
ds_read_b128 v[12:15], v64 offset:31744
v_mfma_f32_32x32x16_bf16 v[48:63], v[20:23], v[208:211], v[48:63]
s_waitcnt lgkmcnt(2)
ds_read_b128 v[16:19], v64 offset:32768
v_mfma_f32_32x32x16_bf16 v[48:63], v[24:27], v[212:215], v[48:63]
s_waitcnt lgkmcnt(2)
ds_read_b128 v[20:23], v64 offset:33792
v_mfma_f32_32x32x16_bf16 v[48:63], v[8:11], v[216:219], v[48:63]
s_waitcnt lgkmcnt(2)
ds_read_b128 v[24:27], v64 offset:34816
v_mfma_f32_32x32x16_bf16 v[48:63], v[12:15], v[220:223], v[48:63]
s_waitcnt lgkmcnt(2)
ds_read_b128 v[8:11], v64 offset:35840
v_mfma_f32_32x32x16_bf16 v[48:63], v[16:19], v[224:227], v[48:63]
s_waitcnt lgkmcnt(2)
ds_read_b128 v[12:15], v64 offset:36864
v_mfma_f32_32x32x16_bf16 v[48:63], v[20:23], v[228:231], v[48:63]
s_waitcnt lgkmcnt(2)
ds_read_b128 v[16:19], v64 offset:37888
v_mfma_f32_32x32x16_bf16 v[48:63], v[24:27], v[232:235], v[48:63]
s_waitcnt lgkmcnt(2)
ds_read_b128 v[20:23], v64 offset:38912
v_mfma_f32_32x32x16_bf16 v[48:63], v[8:11], v[236:239], v[48:63]
s_waitcnt lgkmcnt(2)
ds_read_b128 v[24:27], v64 offset:39936
v_mfma_f32_32x32x16_bf16 v[48:63], v[12:15], v[240:243], v[48:63]
s_add_u32 s44, s44, 1
s_cmp_eq_u32 s44, 3
s_mov_b32 s56, 40960
s_cmov_b32 s56, -81920
s_cselect_b32 s44, 0, s44
v_add_u32 v64, s56, v64
s_waitcnt vmcnt(10) lgkmcnt(2)
s_barrier
ds_read_b128 v[8:11], v64 offset:0
v_mfma_f32_32x32x16_bf16 v[48:63], v[16:19], v[244:247], v[48:63]
s_waitcnt lgkmcnt(2)
ds_read_b128 v[12:15], v64 offset:1024
v_mfma_f32_32x32x16_bf16 v[48:63], v[20:23], v[248:251], v[48:63]
s_waitcnt lgkmcnt(2)
ds_read_b128 v[16:19], v64 offset:2048
v_mfma_f32_32x32x16_bf16 v[48:63], v[24:27], v[252:255], v[48:63]
s_waitcnt lgkmcnt(2)
ds_read_b128 v[20:23], v64 offset:3072
s_nop 9
v_cvt_pk_bf16_f32 v48, v48, v49
v_cvt_pk_bf16_f32 v49, v50, v51
v_cvt_pk_bf16_f32 v50, v52, v53
v_cvt_pk_bf16_f32 v51, v54, v55
v_cvt_pk_bf16_f32 v52, v56, v57
v_cvt_pk_bf16_f32 v53, v58, v59
v_cvt_pk_bf16_f32 v54, v60, v61
v_cvt_pk_bf16_f32 v55, v62, v63
v_accvgpr_write_b32 a152, v48
v_accvgpr_write_b32 a153, v49
v_accvgpr_write_b32 a154, v50
v_accvgpr_write_b32 a155, v51
v_accvgpr_write_b32 a156, v52
v_accvgpr_write_b32 a157, v53
v_accvgpr_write_b32 a158, v54
v_accvgpr_write_b32 a159, v55
v_bfe_u32 v72, v0, 8, 1
v_and_b32 v1, 0xf0, v0
v_lshl_add_u32 v1, v72, 10, v1
v_and_b32 v2, 0x50, v0
v_lshl_add_u32 v2, v72, 13, v2
v_bfe_u32 v72, v0, 7, 1
v_lshl_add_u32 v2, v72, 5, v2
v_bfe_u32 v72, v0, 5, 1
v_lshl_add_u32 v2, v72, 12, v2
s_cmp_eq_u32 s58, 0
s_cselect_b64 vcc, -1, 0
v_cndmask_b32 v1, v1, v2, vcc
v_lshrrev_b32 v72, 9, v0
v_lshl_add_u32 v1, v72, 8, v1
s_lshl_b32 s52, s3, 10
v_add_u32 v73, s52, v0
v_mov_b32 v2, 2146435072
v_cmp_eq_u32 vcc, 0, v73
s_nop 1
v_cndmask_b32 v2, v2, 0, vcc
v_mov_b32 v3, 0xffff
v_cmp_gt_u32 vcc, 512, v73
s_nop 1
v_cndmask_b32 v3, -1, v3, vcc
v_and_b32 v7, 0x1f0, v0
v_lshrrev_b32 v28, 2, v7
v_lshlrev_b32 v7, 1, v7
v_add_u32 v7, 122880, v7
s_lshl_b32 s52, s3, 3
v_lshl_add_u32 v6, v72, 2, v7
v_add_u32 v6, s52, v6
s_lshl_b32 s52, s3, 7
s_add_u32 s52, s52, 124928
v_add_u32 v28, s52, v28
v_lshlrev_b32 v29, 4, v72
v_add_u32 v29, s52, v29
s_mov_b32 s51, 0
s_mov_b32 s50, 0
k_lay_27:
s_lshl_b32 s54, s51, 13
s_add_u32 s54, s54, 222298112
s_waitcnt vmcnt(0) lgkmcnt(0)
s_cmp_lg_u32 s3, 0
s_cbranch_scc1 k_w8d_31
v_lshlrev_b32 v8, 2, v0
k_w8_30:
buffer_load_dword v9, v8, s[4:7], s54 offen sc1
buffer_load_dword v10, v8, s[4:7], s54 offen offset:1024 sc1
s_waitcnt vmcnt(0)
v_and_b32 v9, v9, v10
v_cmp_eq_u32 vcc, 0, v9
s_cbranch_vccz k_w8d_31
s_sleep 1
s_sub_u32 s32, s32, 1
s_cmp_gt_i32 s32, 0
s_cbranch_scc1 k_w8_30
k_w8d_31:
s_barrier
s_mul_i32 s52, s3, 10240
v_add_u32 v5, s52, v0
s_mul_i32 s46, s51, 3145728
s_add_u32 s46, s46, s52
s_add_u32 s46, s46, 195035136
s_lshl_b32 s52, s57, 2
s_add_u32 s52, s52, s3
s_cmp_eq_u32 s58, 2
s_cselect_b32 s53, 11, 12
s_mov_b32 s49, 524288
s_cmov_b32 s49, 262144
s_lshl_b32 s48, s52, s53
s_lshr_b32 s52, s3, 1
s_mul_i32 s52, s52, 768
s_mul_i32 s53, s3, 3968
s_sub_u32 s52, s53, s52
s_cmp_eq_u32 s58, 0
s_cselect_b32 s52, s52, 0
s_sub_u32 s48, s48, s52
s_cmp_eq_u32 s58, 2
s_mov_b32 s52, 41943040
s_cmov_b32 s52, 16777216
s_cselect_b32 s53, 125829120, 0
s_mul_i32 s52, s52, s51
s_add_u32 s48, s48, s52
s_add_u32 s48, s48, s53
s_lshl_b32 s60, s57, 6
s_lshl_b32 s52, s58, 2
s_add_u32 s60, s60, s52
s_add_u32 s60, s60, 222330880
s_mov_b32 s61, 0x3acccccd
s_cmp_eq_u32 s58, 1
s_cbranch_scc1 k_isv_28
s_mul_i32 s45, s3, 10240
s_mov_b32 s44, 0
v_mov_b32 v64, v0
s_add_u32 m0, s45, 0
s_add_u32 s55, s46, 0
buffer_load_dwordx4 v0, s[4:7], s55 offen offset:0 sc1 lds
buffer_load_dwordx4 v0, s[4:7], s55 offen offset:1024 sc1 lds
buffer_load_dwordx4 v0, s[4:7], s55 offen offset:2048 sc1 lds
buffer_load_dwordx4 v0, s[4:7], s55 offen offset:3072 sc1 lds
s_add_u32 m0, s45, 4096
s_add_u32 s55, s46, 4096
buffer_load_dwordx4 v0, s[4:7], s55 offen offset:0 sc1 lds
buffer_load_dwordx4 v0, s[4:7], s55 offen offset:1024 sc1 lds
buffer_load_dwordx4 v0, s[4:7], s55 offen offset:2048 sc1 lds
buffer_load_dwordx4 v0, s[4:7], s55 offen offset:3072 sc1 lds
s_add_u32 m0, s45, 8192
s_add_u32 s55, s46, 8192
buffer_load_dwordx4 v0, s[4:7], s55 offen offset:0 sc1 lds
buffer_load_dwordx4 v0, s[4:7], s55 offen offset:1024 sc1 lds
s_add_u32 s45, s45, 40960
s_cmp_ge_u32 s45, 122880
s_cselect_b32 s55, 122880, 0
s_sub_u32 s45, s45, s55
s_add_u32 s46, s46, 40960
s_add_u32 m0, s45, 0
s_add_u32 s55, s46, 0
buffer_load_dwordx4 v0, s[4:7], s55 offen offset:0 sc1 lds
buffer_load_dwordx4 v0, s[4:7], s55 offen offset:1024 sc1 lds
buffer_load_dwordx4 v0, s[4:7], s55 offen offset:2048 sc1 lds
buffer_load_dwordx4 v0, s[4:7], s55 offen offset:3072 sc1 lds
s_add_u32 m0, s45, 4096
s_add_u32 s55, s46, 4096
buffer_load_dwordx4 v0, s[4:7], s55 offen offset:0 sc1 lds
buffer_load_dwordx4 v0, s[4:7], s55 offen offset:1024 sc1 lds
buffer_load_dwordx4 v0, s[4:7], s55 offen offset:2048 sc1 lds
buffer_load_dwordx4 v0, s[4:7], s55 offen offset:3072 sc1 lds
s_add_u32 m0, s45, 8192
s_add_u32 s55, s46, 8192
buffer_load_dwordx4 v0, s[4:7], s55 offen offset:0 sc1 lds
buffer_load_dwordx4 v0, s[4:7], s55 offen offset:1024 sc1 lds
s_add_u32 s45, s45, 40960
s_cmp_ge_u32 s45, 122880
s_cselect_b32 s55, 122880, 0
s_sub_u32 s45, s45, s55
s_add_u32 s46, s46, 40960
s_waitcnt vmcnt(10)
s_barrier
ds_read_b128 v[8:11], v64 offset:0
ds_read_b128 v[12:15], v64 offset:1024
ds_read_b128 v[16:19], v64 offset:2048
ds_read_b128 v[20:23], v64 offset:3072
s_mov_b32 s59, 32
s_waitcnt lgkmcnt(3)
v_mfma_f32_32x32x16_bf16 v[32:47], a[0:3], v[8:11], 0
s_waitcnt lgkmcnt(2)
ds_read_b128 v[24:27], v64 offset:4096
v_mfma_f32_32x32x16_bf16 v[32:47], a[4:7], v[12:15], v[32:47]
s_waitcnt lgkmcnt(2)
ds_read_b128 v[8:11], v64 offset:5120
ds_read_b128 v[72:75], v5
v_mov_b32 v4, 0
ds_read_b128 v[76:79], v5 offset:1024
v_mfma_f32_32x32x16_bf16 v[32:47], a[8:11], v[16:19], v[32:47]
s_waitcnt lgkmcnt(4)
ds_read_b128 v[12:15], v64 offset:6144
s_waitcnt lgkmcnt(2)
v_and_b32 v72, v3, v72
v_dot2c_f32_bf16 v4, v72, v72
v_dot2c_f32_bf16 v4, v73, v73
v_dot2c_f32_bf16 v4, v74, v74
v_dot2c_f32_bf16 v4, v75, v75
v_mfma_f32_32x32x16_bf16 v[32:47], a[12:15], v[20:23], v[32:47]
ds_read_b128 v[16:19], v64 offset:7168
ds_read_b128 v[72:75], v5 offset:2048
s_waitcnt lgkmcnt(3)
v_dot2c_f32_bf16 v4, v76, v76
v_dot2c_f32_bf16 v4, v77, v77
v_dot2c_f32_bf16 v4, v78, v78
v_dot2c_f32_bf16 v4, v79, v79
v_mfma_f32_32x32x16_bf16 v[32:47], a[16:19], v[24:27], v[32:47]
ds_read_b128 v[20:23], v64 offset:8192
ds_read_b128 v[76:79], v5 offset:3072
s_waitcnt lgkmcnt(2)
v_dot2c_f32_bf16 v4, v72, v72
v_dot2c_f32_bf16 v4, v73, v73
v_dot2c_f32_bf16 v4, v74, v74
v_dot2c_f32_bf16 v4, v75, v75
v_mfma_f32_32x32x16_bf16 v[32:47], a[20:23], v[8:11], v[32:47]
ds_read_b128 v[24:27], v64 offset:9216
ds_read_b128 v[72:75], v5 offset:4096
s_waitcnt lgkmcnt(2)
v_dot2c_f32_bf16 v4, v76, v76
v_dot2c_f32_bf16 v4, v77, v77
v_dot2c_f32_bf16 v4, v78, v78
v_dot2c_f32_bf16 v4, v79, v79
v_mfma_f32_32x32x16_bf16 v[32:47], a[24:27], v[12:15], v[32:47]
ds_read_b128 v[8:11], v64 offset:10240
ds_read_b128 v[76:79], v5 offset:5120
s_waitcnt lgkmcnt(2)
v_dot2c_f32_bf16 v4, v72, v72
v_dot2c_f32_bf16 v4, v73, v73
v_dot2c_f32_bf16 v4, v74, v74
v_dot2c_f32_bf16 v4, v75, v75
v_mfma_f32_32x32x16_bf16 v[32:47], a[28:31], v[16:19], v[32:47]
ds_read_b128 v[12:15], v64 offset:11264
ds_read_b128 v[72:75], v5 offset:6144
s_waitcnt lgkmcnt(2)
v_dot2c_f32_bf16 v4, v76, v76
v_dot2c_f32_bf16 v4, v77, v77
v_dot2c_f32_bf16 v4, v78, v78
v_dot2c_f32_bf16 v4, v79, v79
v_mfma_f32_32x32x16_bf16 v[32:47], a[32:35], v[20:23], v[32:47]
ds_read_b128 v[16:19], v64 offset:12288
ds_read_b128 v[76:79], v5 offset:7168
s_waitcnt lgkmcnt(2)
v_dot2c_f32_bf16 v4, v72, v72
v_dot2c_f32_bf16 v4, v73, v73
v_dot2c_f32_bf16 v4, v74, v74
v_dot2c_f32_bf16 v4, v75, v75
v_mfma_f32_32x32x16_bf16 v[32:47], a[36:39], v[24:27], v[32:47]
ds_read_b128 v[20:23], v64 offset:13312
ds_read_b128 v[72:75], v5 offset:8192
s_waitcnt lgkmcnt(2)
v_dot2c_f32_bf16 v4, v76, v76
v_dot2c_f32_bf16 v4, v77, v77
v_dot2c_f32_bf16 v4, v78, v78
v_dot2c_f32_bf16 v4, v79, v79
v_mfma_f32_32x32x16_bf16 v[32:47], a[40:43], v[8:11], v[32:47]
ds_read_b128 v[24:27], v64 offset:14336
ds_read_b128 v[76:79], v5 offset:9216
s_waitcnt lgkmcnt(2)
v_dot2c_f32_bf16 v4, v72, v72
v_dot2c_f32_bf16 v4, v73, v73
v_dot2c_f32_bf16 v4, v74, v74
v_dot2c_f32_bf16 v4, v75, v75
v_mfma_f32_32x32x16_bf16 v[32:47], a[44:47], v[12:15], v[32:47]
ds_read_b128 v[8:11], v64 offset:15360
s_waitcnt lgkmcnt(1)
v_dot2c_f32_bf16 v4, v76, v76
v_dot2c_f32_bf16 v4, v77, v77
v_dot2c_f32_bf16 v4, v78, v78
v_dot2c_f32_bf16 v4, v79, v79
s_nop 2
ds_write_b32 v6, v4 offset:0
v_mfma_f32_32x32x16_bf16 v[32:47], a[48:51], v[16:19], v[32:47]
ds_read_b128 v[12:15], v64 offset:16384
s_add_u32 m0, s45, 0
s_add_u32 s55, s46, 0
buffer_load_dwordx4 v0, s[4:7], s55 offen offset:0 sc1 lds
buffer_load_dwordx4 v0, s[4:7], s55 offen offset:1024 sc1 lds
v_mfma_f32_32x32x16_bf16 v[32:47], a[52:55], v[20:23], v[32:47]
ds_read_b128 v[16:19], v64 offset:17408
buffer_load_dwordx4 v0, s[4:7], s55 offen offset:2048 sc1 lds
buffer_load_dwordx4 v0, s[4:7], s55 offen offset:3072 sc1 lds
v_mfma_f32_32x32x16_bf16 v[32:47], a[56:59], v[24:27], v[32:47]
s_waitcnt lgkmcnt(3)
ds_read_b128 v[20:23], v64 offset:18432
s_add_u32 m0, s45, 4096
s_add_u32 s55, s46, 4096
buffer_load_dwordx4 v0, s[4:7], s55 offen offset:0 sc1 lds
buffer_load_dwordx4 v0, s[4:7], s55 offen offset:1024 sc1 lds
v_mfma_f32_32x32x16_bf16 v[32:47], a[60:63], v[8:11], v[32:47]
s_waitcnt lgkmcnt(2)
ds_read_b128 v[24:27], v64 offset:19456
buffer_load_dwordx4 v0, s[4:7], s55 offen offset:2048 sc1 lds
buffer_load_dwordx4 v0, s[4:7], s55 offen offset:3072 sc1 lds
v_mfma_f32_32x32x16_bf16 v[32:47], a[64:67], v[12:15], v[32:47]
s_waitcnt lgkmcnt(2)
ds_read_b128 v[8:11], v64 offset:20480
s_add_u32 m0, s45, 8192
s_add_u32 s55, s46, 8192
buffer_load_dwordx4 v0, s[4:7], s55 offen offset:0 sc1 lds
buffer_load_dwordx4 v0, s[4:7], s55 offen offset:1024 sc1 lds
v_mfma_f32_32x32x16_bf16 v[32:47], a[68:71], v[16:19], v[32:47]
s_waitcnt lgkmcnt(2)
ds_read_b128 v[12:15], v64 offset:21504
s_add_u32 s45, s45, 40960
s_cmp_ge_u32 s45, 122880
s_cselect_b32 s55, 122880, 0
s_sub_u32 s45, s45, s55
s_add_u32 s46, s46, 40960
v_mfma_f32_32x32x16_bf16 v[32:47], a[72:75], v[20:23], v[32:47]
s_waitcnt lgkmcnt(2)
ds_read_b128 v[16:19], v64 offset:22528
v_mfma_f32_32x32x16_bf16 v[32:47], a[76:79], v[24:27], v[32:47]
s_waitcnt lgkmcnt(2)
ds_read_b128 v[20:23], v64 offset:23552
v_mfma_f32_32x32x16_bf16 v[32:47], a[80:83], v[8:11], v[32:47]
s_waitcnt lgkmcnt(2)
ds_read_b128 v[24:27], v64 offset:24576
v_mfma_f32_32x32x16_bf16 v[32:47], a[84:87], v[12:15], v[32:47]
s_waitcnt lgkmcnt(2)
ds_read_b128 v[8:11], v64 offset:25600
v_mfma_f32_32x32x16_bf16 v[32:47], a[88:91], v[16:19], v[32:47]
s_waitcnt lgkmcnt(2)
ds_read_b128 v[12:15], v64 offset:26624
v_mfma_f32_32x32x16_bf16 v[32:47], a[92:95], v[20:23], v[32:47]
s_waitcnt lgkmcnt(2)
ds_read_b128 v[16:19], v64 offset:27648
v_mfma_f32_32x32x16_bf16 v[32:47], a[96:99], v[24:27], v[32:47]
s_waitcnt lgkmcnt(2)
ds_read_b128 v[20:23], v64 offset:28672
v_mfma_f32_32x32x16_bf16 v[32:47], a[100:103], v[8:11], v[32:47]
s_waitcnt lgkmcnt(2)
ds_read_b128 v[24:27], v64 offset:29696
v_mfma_f32_32x32x16_bf16 v[32:47], a[104:107], v[12:15], v[32:47]
s_waitcnt lgkmcnt(2)
ds_read_b128 v[8:11], v64 offset:30720
v_mfma_f32_32x32x16_bf16 v[32:47], a[108:111], v[16:19], v[32:47]
s_waitcnt lgkmcnt(2)
ds_read_b128 v[12:15], v64 offset:31744
v_mfma_f32_32x32x16_bf16 v[32:47], a[112:115], v[20:23], v[32:47]
s_waitcnt lgkmcnt(2)
ds_read_b128 v[16:19], v64 offset:32768
v_mfma_f32_32x32x16_bf16 v[32:47], a[116:119], v[24:27], v[32:47]
s_waitcnt lgkmcnt(2)
ds_read_b128 v[20:23], v64 offset:33792
v_mfma_f32_32x32x16_bf16 v[32:47], a[120:123], v[8:11], v[32:47]
s_waitcnt lgkmcnt(2)
ds_read_b128 v[24:27], v64 offset:34816
v_mfma_f32_32x32x16_bf16 v[32:47], a[124:127], v[12:15], v[32:47]
s_waitcnt lgkmcnt(2)
ds_read_b128 v[8:11], v64 offset:35840
v_mfma_f32_32x32x16_bf16 v[32:47], a[128:131], v[16:19], v[32:47]
s_waitcnt lgkmcnt(2)
ds_read_b128 v[12:15], v64 offset:36864
v_mfma_f32_32x32x16_bf16 v[32:47], a[132:135], v[20:23], v[32:47]
s_waitcnt lgkmcnt(2)
ds_read_b128 v[16:19], v64 offset:37888
v_mfma_f32_32x32x16_bf16 v[32:47], a[136:139], v[24:27], v[32:47]
s_waitcnt lgkmcnt(2)
ds_read_b128 v[20:23], v64 offset:38912
v_mfma_f32_32x32x16_bf16 v[32:47], a[140:143], v[8:11], v[32:47]
s_waitcnt lgkmcnt(2)
ds_read_b128 v[24:27], v64 offset:39936
v_mfma_f32_32x32x16_bf16 v[32:47], a[144:147], v[12:15], v[32:47]
s_add_u32 s44, s44, 1
s_cmp_eq_u32 s44, 3
s_mov_b32 s56, 40960
s_cmov_b32 s56, -81920
s_cselect_b32 s44, 0, s44
v_add_u32 v64, s56, v64
v_add_u32 v5, s56, v5
s_waitcnt vmcnt(10) lgkmcnt(2)
s_barrier
ds_read_b128 v[8:11], v64 offset:0
v_mfma_f32_32x32x16_bf16 v[32:47], a[148:151], v[16:19], v[32:47]
s_waitcnt lgkmcnt(2)
ds_read_b128 v[12:15], v64 offset:1024
v_mfma_f32_32x32x16_bf16 v[32:47], a[152:155], v[20:23], v[32:47]
s_waitcnt lgkmcnt(2)
ds_read_b128 v[16:19], v64 offset:2048
v_mfma_f32_32x32x16_bf16 v[32:47], a[156:159], v[24:27], v[32:47]
s_waitcnt lgkmcnt(2)
ds_read_b128 v[20:23], v64 offset:3072
k_st_32:
v_mfma_f32_32x32x16_bf16 v[48:63], a[0:3], v[8:11], 0
s_waitcnt lgkmcnt(2)
ds_read_b128 v[24:27], v64 offset:4096
v_mfma_f32_32x32x16_bf16 v[48:63], a[4:7], v[12:15], v[48:63]
s_waitcnt lgkmcnt(2)
ds_read_b128 v[8:11], v64 offset:5120
ds_read_b128 v[80:83], v7 offset:0
ds_read_b128 v[84:87], v7 offset:16
v_mov_b32 v88, 0x3727c5ac
v_mfma_f32_32x32x16_bf16 v[48:63], a[8:11], v[16:19], v[48:63]
s_waitcnt lgkmcnt(4)
ds_read_b128 v[12:15], v64 offset:6144
s_waitcnt lgkmcnt(1)
v_add_f32 v80, v80, v84
v_add_f32 v81, v81, v85
v_add_f32 v82, v82, v86
v_add_f32 v83, v83, v87
v_add_f32 v80, v80, v81
v_add_f32 v82, v82, v83
v_add_f32 v80, v80, v82
v_mfma_f32_32x32x16_bf16 v[48:63], a[12:15], v[20:23], v[48:63]
ds_read_b128 v[16:19], v64 offset:7168
v_fma_f32 v80, v80, s61, v88
v_rsq_f32 v80, v80
s_nop 0
v_mul_f32 v32, v80, v32
v_mul_f32 v33, v80, v33
v_cvt_pk_bf16_f32 v32, v32, v33
v_mfma_f32_32x32x16_bf16 v[48:63], a[16:19], v[24:27], v[48:63]
ds_read_b128 v[20:23], v64 offset:8192
v_mul_f32 v34, v80, v34
v_mul_f32 v35, v80, v35
v_cvt_pk_bf16_f32 v33, v34, v35
v_mul_f32 v36, v80, v36
v_mul_f32 v37, v80, v37
v_cvt_pk_bf16_f32 v34, v36, v37
v_mfma_f32_32x32x16_bf16 v[48:63], a[20:23], v[8:11], v[48:63]
s_waitcnt lgkmcnt(2)
ds_read_b128 v[24:27], v64 offset:9216
v_mul_f32 v38, v80, v38
v_mul_f32 v39, v80, v39
v_cvt_pk_bf16_f32 v35, v38, v39
v_mul_f32 v40, v80, v40
v_mul_f32 v41, v80, v41
v_cvt_pk_bf16_f32 v36, v40, v41
v_mfma_f32_32x32x16_bf16 v[48:63], a[24:27], v[12:15], v[48:63]
s_waitcnt lgkmcnt(2)
ds_read_b128 v[8:11], v64 offset:10240
v_mul_f32 v42, v80, v42
v_mul_f32 v43, v80, v43
v_cvt_pk_bf16_f32 v37, v42, v43
v_mul_f32 v44, v80, v44
v_mul_f32 v45, v80, v45
v_cvt_pk_bf16_f32 v38, v44, v45
v_mfma_f32_32x32x16_bf16 v[48:63], a[28:31], v[16:19], v[48:63]
s_waitcnt lgkmcnt(2)
ds_read_b128 v[12:15], v64 offset:11264
v_mul_f32 v46, v80, v46
v_mul_f32 v47, v80, v47
v_cvt_pk_bf16_f32 v39, v46, v47
buffer_store_dwordx4 v[32:35], v1, s[4:7], s48 offen offset:0 sc1
v_mfma_f32_32x32x16_bf16 v[48:63], a[32:35], v[20:23], v[48:63]
s_waitcnt lgkmcnt(2)
ds_read_b128 v[16:19], v64 offset:12288
buffer_store_dwordx4 v[36:39], v1, s[4:7], s48 offen offset:512 sc1
s_add_u32 s48, s48, s49
v_mfma_f32_32x32x16_bf16 v[48:63], a[36:39], v[24:27], v[48:63]
s_waitcnt lgkmcnt(2)
ds_read_b128 v[20:23], v64 offset:13312
ds_read_b128 v[72:75], v5
v_mov_b32 v4, 0
ds_read_b128 v[76:79], v5 offset:1024
v_mfma_f32_32x32x16_bf16 v[48:63], a[40:43], v[8:11], v[48:63]
s_waitcnt lgkmcnt(4)
ds_read_b128 v[24:27], v64 offset:14336
s_waitcnt lgkmcnt(2)
v_and_b32 v72, v3, v72
v_dot2c_f32_bf16 v4, v72, v72
v_dot2c_f32_bf16 v4, v73, v73
v_dot2c_f32_bf16 v4, v74, v74
v_dot2c_f32_bf16 v4, v75, v75
v_mfma_f32_32x32x16_bf16 v[48:63], a[44:47], v[12:15], v[48:63]
ds_read_b128 v[8:11], v64 offset:15360
ds_read_b128 v[72:75], v5 offset:2048
s_waitcnt lgkmcnt(3)
v_dot2c_f32_bf16 v4, v76, v76
v_dot2c_f32_bf16 v4, v77, v77
v_dot2c_f32_bf16 v4, v78, v78
v_dot2c_f32_bf16 v4, v79, v79
v_mfma_f32_32x32x16_bf16 v[48:63], a[48:51], v[16:19], v[48:63]
ds_read_b128 v[12:15], v64 offset:16384
ds_read_b128 v[76:79], v5 offset:3072
s_waitcnt lgkmcnt(2)
v_dot2c_f32_bf16 v4, v72, v72
v_dot2c_f32_bf16 v4, v73, v73
v_dot2c_f32_bf16 v4, v74, v74
v_dot2c_f32_bf16 v4, v75, v75
v_mfma_f32_32x32x16_bf16 v[48:63], a[52:55], v[20:23], v[48:63]
ds_read_b128 v[16:19], v64 offset:17408
ds_read_b128 v[72:75], v5 offset:4096
s_waitcnt lgkmcnt(2)
v_dot2c_f32_bf16 v4, v76, v76
v_dot2c_f32_bf16 v4, v77, v77
v_dot2c_f32_bf16 v4, v78, v78
v_dot2c_f32_bf16 v4, v79, v79
v_mfma_f32_32x32x16_bf16 v[48:63], a[56:59], v[24:27], v[48:63]
ds_read_b128 v[20:23], v64 offset:18432
ds_read_b128 v[76:79], v5 offset:5120
s_waitcnt lgkmcnt(2)
v_dot2c_f32_bf16 v4, v72, v72
v_dot2c_f32_bf16 v4, v73, v73
v_dot2c_f32_bf16 v4, v74, v74
v_dot2c_f32_bf16 v4, v75, v75
v_mfma_f32_32x32x16_bf16 v[48:63], a[60:63], v[8:11], v[48:63]
ds_read_b128 v[24:27], v64 offset:19456
ds_read_b128 v[72:75], v5 offset:6144
s_waitcnt lgkmcnt(2)
v_dot2c_f32_bf16 v4, v76, v76
v_dot2c_f32_bf16 v4, v77, v77
v_dot2c_f32_bf16 v4, v78, v78
v_dot2c_f32_bf16 v4, v79, v79
v_mfma_f32_32x32x16_bf16 v[48:63], a[64:67], v[12:15], v[48:63]
ds_read_b128 v[8:11], v64 offset:20480
ds_read_b128 v[76:79], v5 offset:7168
s_waitcnt lgkmcnt(2)
v_dot2c_f32_bf16 v4, v72, v72
v_dot2c_f32_bf16 v4, v73, v73
v_dot2c_f32_bf16 v4, v74, v74
v_dot2c_f32_bf16 v4, v75, v75
v_mfma_f32_32x32x16_bf16 v[48:63], a[68:71], v[16:19], v[48:63]
ds_read_b128 v[12:15], v64 offset:21504
ds_read_b128 v[72:75], v5 offset:8192
s_waitcnt lgkmcnt(2)
v_dot2c_f32_bf16 v4, v76, v76
v_dot2c_f32_bf16 v4, v77, v77
v_dot2c_f32_bf16 v4, v78, v78
v_dot2c_f32_bf16 v4, v79, v79
v_mfma_f32_32x32x16_bf16 v[48:63], a[72:75], v[20:23], v[48:63]
ds_read_b128 v[16:19], v64 offset:22528
ds_read_b128 v[76:79], v5 offset:9216
s_waitcnt lgkmcnt(2)
v_dot2c_f32_bf16 v4, v72, v72
v_dot2c_f32_bf16 v4, v73, v73
v_dot2c_f32_bf16 v4, v74, v74
v_dot2c_f32_bf16 v4, v75, v75
v_mfma_f32_32x32x16_bf16 v[48:63], a[76:79], v[24:27], v[48:63]
ds_read_b128 v[20:23], v64 offset:23552
s_waitcnt lgkmcnt(1)
v_dot2c_f32_bf16 v4, v76, v76
v_dot2c_f32_bf16 v4, v77, v77
v_dot2c_f32_bf16 v4, v78, v78
v_dot2c_f32_bf16 v4, v79, v79
s_nop 2
ds_write_b32 v6, v4 offset:1024
v_mfma_f32_32x32x16_bf16 v[48:63], a[80:83], v[8:11], v[48:63]
ds_read_b128 v[24:27], v64 offset:24576
s_add_u32 m0, s45, 0
s_add_u32 s55, s46, 0
buffer_load_dwordx4 v0, s[4:7], s55 offen offset:0 sc1 lds
buffer_load_dwordx4 v0, s[4:7], s55 offen offset:1024 sc1 lds
v_mfma_f32_32x32x16_bf16 v[48:63], a[84:87], v[12:15], v[48:63]
ds_read_b128 v[8:11], v64 offset:25600
buffer_load_dwordx4 v0, s[4:7], s55 offen offset:2048 sc1 lds
buffer_load_dwordx4 v0, s[4:7], s55 offen offset:3072 sc1 lds
v_mfma_f32_32x32x16_bf16 v[48:63], a[88:91], v[16:19], v[48:63]
s_waitcnt lgkmcnt(3)
ds_read_b128 v[12:15], v64 offset:26624
s_add_u32 m0, s45, 4096
s_add_u32 s55, s46, 4096
buffer_load_dwordx4 v0, s[4:7], s55 offen offset:0 sc1 lds
buffer_load_dwordx4 v0, s[4:7], s55 offen offset:1024 sc1 lds
v_mfma_f32_32x32x16_bf16 v[48:63], a[92:95], v[20:23], v[48:63]
s_waitcnt lgkmcnt(2)
ds_read_b128 v[16:19], v64 offset:27648
buffer_load_dwordx4 v0, s[4:7], s55 offen offset:2048 sc1 lds
buffer_load_dwordx4 v0, s[4:7], s55 offen offset:3072 sc1 lds
v_mfma_f32_32x32x16_bf16 v[48:63], a[96:99], v[24:27], v[48:63]
s_waitcnt lgkmcnt(2)
ds_read_b128 v[20:23], v64 offset:28672
s_add_u32 m0, s45, 8192
s_add_u32 s55, s46, 8192
buffer_load_dwordx4 v0, s[4:7], s55 offen offset:0 sc1 lds
buffer_load_dwordx4 v0, s[4:7], s55 offen offset:1024 sc1 lds
v_mfma_f32_32x32x16_bf16 v[48:63], a[100:103], v[8:11], v[48:63]
s_waitcnt lgkmcnt(2)
ds_read_b128 v[24:27], v64 offset:29696
s_add_u32 s45, s45, 40960
s_cmp_ge_u32 s45, 122880
s_cselect_b32 s55, 122880, 0
s_sub_u32 s45, s45, s55
s_add_u32 s46, s46, 40960
v_mfma_f32_32x32x16_bf16 v[48:63], a[104:107], v[12:15], v[48:63]
s_waitcnt lgkmcnt(2)
ds_read_b128 v[8:11], v64 offset:30720
v_mfma_f32_32x32x16_bf16 v[48:63], a[108:111], v[16:19], v[48:63]
s_waitcnt lgkmcnt(2)
ds_read_b128 v[12:15], v64 offset:31744
v_mfma_f32_32x32x16_bf16 v[48:63], a[112:115], v[20:23], v[48:63]
s_waitcnt lgkmcnt(2)
ds_read_b128 v[16:19], v64 offset:32768
v_mfma_f32_32x32x16_bf16 v[48:63], a[116:119], v[24:27], v[48:63]
s_waitcnt lgkmcnt(2)
ds_read_b128 v[20:23], v64 offset:33792
v_mfma_f32_32x32x16_bf16 v[48:63], a[120:123], v[8:11], v[48:63]
s_waitcnt lgkmcnt(2)
ds_read_b128 v[24:27], v64 offset:34816
v_mfma_f32_32x32x16_bf16 v[48:63], a[124:127], v[12:15], v[48:63]
s_waitcnt lgkmcnt(2)
ds_read_b128 v[8:11], v64 offset:35840
v_mfma_f32_32x32x16_bf16 v[48:63], a[128:131], v[16:19], v[48:63]
s_waitcnt lgkmcnt(2)
ds_read_b128 v[12:15], v64 offset:36864
v_mfma_f32_32x32x16_bf16 v[48:63], a[132:135], v[20:23], v[48:63]
s_waitcnt lgkmcnt(2)
ds_read_b128 v[16:19], v64 offset:37888
v_mfma_f32_32x32x16_bf16 v[48:63], a[136:139], v[24:27], v[48:63]
s_waitcnt lgkmcnt(2)
ds_read_b128 v[20:23], v64 offset:38912
v_mfma_f32_32x32x16_bf16 v[48:63], a[140:143], v[8:11], v[48:63]
s_waitcnt lgkmcnt(2)
ds_read_b128 v[24:27], v64 offset:39936
v_mfma_f32_32x32x16_bf16 v[48:63], a[144:147], v[12:15], v[48:63]
s_add_u32 s44, s44, 1
s_cmp_eq_u32 s44, 3
s_mov_b32 s56, 40960
s_cmov_b32 s56, -81920
s_cselect_b32 s44, 0, s44
v_add_u32 v64, s56, v64
v_add_u32 v5, s56, v5
s_waitcnt vmcnt(10) lgkmcnt(2)
s_barrier
s_add_u32 s50, s50, 1
v_mov_b32 v4, s50
buffer_store_dword v4, v2, s[4:7], s60 offen sc1
ds_read_b128 v[8:11], v64 offset:0
v_mfma_f32_32x32x16_bf16 v[48:63], a[148:151], v[16:19], v[48:63]
s_waitcnt lgkmcnt(2)
ds_read_b128 v[12:15], v64 offset:1024
v_mfma_f32_32x32x16_bf16 v[48:63], a[152:155], v[20:23], v[48:63]
s_waitcnt lgkmcnt(2)
ds_read_b128 v[16:19], v64 offset:2048
v_mfma_f32_32x32x16_bf16 v[48:63], a[156:159], v[24:27], v[48:63]
s_waitcnt lgkmcnt(2)
ds_read_b128 v[20:23], v64 offset:3072
s_sub_u32 s59, s59, 1
s_cmp_eq_u32 s59, 0
s_cbranch_scc1 k_so_33
v_mfma_f32_32x32x16_bf16 v[32:47], a[0:3], v[8:11], 0
s_waitcnt lgkmcnt(2)
ds_read_b128 v[24:27], v64 offset:4096
v_mfma_f32_32x32x16_bf16 v[32:47], a[4:7], v[12:15], v[32:47]
s_waitcnt lgkmcnt(2)
ds_read_b128 v[8:11], v64 offset:5120
ds_read_b128 v[80:83], v7 offset:1024
ds_read_b128 v[84:87], v7 offset:1040
v_mov_b32 v88, 0x3727c5ac
v_mfma_f32_32x32x16_bf16 v[32:47], a[8:11], v[16:19], v[32:47]
s_waitcnt lgkmcnt(4)
ds_read_b128 v[12:15], v64 offset:6144
s_waitcnt lgkmcnt(1)
v_add_f32 v80, v80, v84
v_add_f32 v81, v81, v85
v_add_f32 v82, v82, v86
v_add_f32 v83, v83, v87
v_add_f32 v80, v80, v81
v_add_f32 v82, v82, v83
v_add_f32 v80, v80, v82
v_mfma_f32_32x32x16_bf16 v[32:47], a[12:15], v[20:23], v[32:47]
ds_read_b128 v[16:19], v64 offset:7168
v_fma_f32 v80, v80, s61, v88
v_rsq_f32 v80, v80
s_nop 0
v_mul_f32 v48, v80, v48
v_mul_f32 v49, v80, v49
v_cvt_pk_bf16_f32 v48, v48, v49
v_mfma_f32_32x32x16_bf16 v[32:47], a[16:19], v[24:27], v[32:47]
ds_read_b128 v[20:23], v64 offset:8192
v_mul_f32 v50, v80, v50
v_mul_f32 v51, v80, v51
v_cvt_pk_bf16_f32 v49, v50, v51
v_mul_f32 v52, v80, v52
v_mul_f32 v53, v80, v53
v_cvt_pk_bf16_f32 v50, v52, v53
v_mfma_f32_32x32x16_bf16 v[32:47], a[20:23], v[8:11], v[32:47]
s_waitcnt lgkmcnt(2)
ds_read_b128 v[24:27], v64 offset:9216
v_mul_f32 v54, v80, v54
v_mul_f32 v55, v80, v55
v_cvt_pk_bf16_f32 v51, v54, v55
v_mul_f32 v56, v80, v56
v_mul_f32 v57, v80, v57
v_cvt_pk_bf16_f32 v52, v56, v57
v_mfma_f32_32x32x16_bf16 v[32:47], a[24:27], v[12:15], v[32:47]
s_waitcnt lgkmcnt(2)
ds_read_b128 v[8:11], v64 offset:10240
v_mul_f32 v58, v80, v58
v_mul_f32 v59, v80, v59
v_cvt_pk_bf16_f32 v53, v58, v59
v_mul_f32 v60, v80, v60
v_mul_f32 v61, v80, v61
v_cvt_pk_bf16_f32 v54, v60, v61
v_mfma_f32_32x32x16_bf16 v[32:47], a[28:31], v[16:19], v[32:47]
s_waitcnt lgkmcnt(2)
ds_read_b128 v[12:15], v64 offset:11264
v_mul_f32 v62, v80, v62
v_mul_f32 v63, v80, v63
v_cvt_pk_bf16_f32 v55, v62, v63
buffer_store_dwordx4 v[48:51], v1, s[4:7], s48 offen offset:0 sc1
v_mfma_f32_32x32x16_bf16 v[32:47], a[32:35], v[20:23], v[32:47]
s_waitcnt lgkmcnt(2)
ds_read_b128 v[16:19], v64 offset:12288
buffer_store_dwordx4 v[52:55], v1, s[4:7], s48 offen offset:512 sc1
s_add_u32 s48, s48, s49
v_mfma_f32_32x32x16_bf16 v[32:47], a[36:39], v[24:27], v[32:47]
s_waitcnt lgkmcnt(2)
ds_read_b128 v[20:23], v64 offset:13312
ds_read_b128 v[72:75], v5
v_mov_b32 v4, 0
ds_read_b128 v[76:79], v5 offset:1024
v_mfma_f32_32x32x16_bf16 v[32:47], a[40:43], v[8:11], v[32:47]
s_waitcnt lgkmcnt(4)
ds_read_b128 v[24:27], v64 offset:14336
s_waitcnt lgkmcnt(2)
v_and_b32 v72, v3, v72
v_dot2c_f32_bf16 v4, v72, v72
v_dot2c_f32_bf16 v4, v73, v73
v_dot2c_f32_bf16 v4, v74, v74
v_dot2c_f32_bf16 v4, v75, v75
v_mfma_f32_32x32x16_bf16 v[32:47], a[44:47], v[12:15], v[32:47]
ds_read_b128 v[8:11], v64 offset:15360
ds_read_b128 v[72:75], v5 offset:2048
s_waitcnt lgkmcnt(3)
v_dot2c_f32_bf16 v4, v76, v76
v_dot2c_f32_bf16 v4, v77, v77
v_dot2c_f32_bf16 v4, v78, v78
v_dot2c_f32_bf16 v4, v79, v79
v_mfma_f32_32x32x16_bf16 v[32:47], a[48:51], v[16:19], v[32:47]
ds_read_b128 v[12:15], v64 offset:16384
ds_read_b128 v[76:79], v5 offset:3072
s_waitcnt lgkmcnt(2)
v_dot2c_f32_bf16 v4, v72, v72
v_dot2c_f32_bf16 v4, v73, v73
v_dot2c_f32_bf16 v4, v74, v74
v_dot2c_f32_bf16 v4, v75, v75
v_mfma_f32_32x32x16_bf16 v[32:47], a[52:55], v[20:23], v[32:47]
ds_read_b128 v[16:19], v64 offset:17408
ds_read_b128 v[72:75], v5 offset:4096
s_waitcnt lgkmcnt(2)
v_dot2c_f32_bf16 v4, v76, v76
v_dot2c_f32_bf16 v4, v77, v77
v_dot2c_f32_bf16 v4, v78, v78
v_dot2c_f32_bf16 v4, v79, v79
v_mfma_f32_32x32x16_bf16 v[32:47], a[56:59], v[24:27], v[32:47]
ds_read_b128 v[20:23], v64 offset:18432
ds_read_b128 v[76:79], v5 offset:5120
s_waitcnt lgkmcnt(2)
v_dot2c_f32_bf16 v4, v72, v72
v_dot2c_f32_bf16 v4, v73, v73
v_dot2c_f32_bf16 v4, v74, v74
v_dot2c_f32_bf16 v4, v75, v75
v_mfma_f32_32x32x16_bf16 v[32:47], a[60:63], v[8:11], v[32:47]
ds_read_b128 v[24:27], v64 offset:19456
ds_read_b128 v[72:75], v5 offset:6144
s_waitcnt lgkmcnt(2)
v_dot2c_f32_bf16 v4, v76, v76
v_dot2c_f32_bf16 v4, v77, v77
v_dot2c_f32_bf16 v4, v78, v78
v_dot2c_f32_bf16 v4, v79, v79
v_mfma_f32_32x32x16_bf16 v[32:47], a[64:67], v[12:15], v[32:47]
ds_read_b128 v[8:11], v64 offset:20480
ds_read_b128 v[76:79], v5 offset:7168
s_waitcnt lgkmcnt(2)
v_dot2c_f32_bf16 v4, v72, v72
v_dot2c_f32_bf16 v4, v73, v73
v_dot2c_f32_bf16 v4, v74, v74
v_dot2c_f32_bf16 v4, v75, v75
v_mfma_f32_32x32x16_bf16 v[32:47], a[68:71], v[16:19], v[32:47]
ds_read_b128 v[12:15], v64 offset:21504
ds_read_b128 v[72:75], v5 offset:8192
s_waitcnt lgkmcnt(2)
v_dot2c_f32_bf16 v4, v76, v76
v_dot2c_f32_bf16 v4, v77, v77
v_dot2c_f32_bf16 v4, v78, v78
v_dot2c_f32_bf16 v4, v79, v79
v_mfma_f32_32x32x16_bf16 v[32:47], a[72:75], v[20:23], v[32:47]
ds_read_b128 v[16:19], v64 offset:22528
ds_read_b128 v[76:79], v5 offset:9216
s_waitcnt lgkmcnt(2)
v_dot2c_f32_bf16 v4, v72, v72
v_dot2c_f32_bf16 v4, v73, v73
v_dot2c_f32_bf16 v4, v74, v74
v_dot2c_f32_bf16 v4, v75, v75
v_mfma_f32_32x32x16_bf16 v[32:47], a[76:79], v[24:27], v[32:47]
ds_read_b128 v[20:23], v64 offset:23552
s_waitcnt lgkmcnt(1)
v_dot2c_f32_bf16 v4, v76, v76
v_dot2c_f32_bf16 v4, v77, v77
v_dot2c_f32_bf16 v4, v78, v78
v_dot2c_f32_bf16 v4, v79, v79
s_nop 2
ds_write_b32 v6, v4 offset:0
v_mfma_f32_32x32x16_bf16 v[32:47], a[80:83], v[8:11], v[32:47]
ds_read_b128 v[24:27], v64 offset:24576
s_add_u32 m0, s45, 0
s_add_u32 s55, s46, 0
buffer_load_dwordx4 v0, s[4:7], s55 offen offset:0 sc1 lds
buffer_load_dwordx4 v0, s[4:7], s55 offen offset:1024 sc1 lds
v_mfma_f32_32x32x16_bf16 v[32:47], a[84:87], v[12:15], v[32:47]
ds_read_b128 v[8:11], v64 offset:25600
buffer_load_dwordx4 v0, s[4:7], s55 offen offset:2048 sc1 lds
buffer_load_dwordx4 v0, s[4:7], s55 offen offset:3072 sc1 lds
v_mfma_f32_32x32x16_bf16 v[32:47], a[88:91], v[16:19], v[32:47]
s_waitcnt lgkmcnt(3)
ds_read_b128 v[12:15], v64 offset:26624
s_add_u32 m0, s45, 4096
s_add_u32 s55, s46, 4096
buffer_load_dwordx4 v0, s[4:7], s55 offen offset:0 sc1 lds
buffer_load_dwordx4 v0, s[4:7], s55 offen offset:1024 sc1 lds
v_mfma_f32_32x32x16_bf16 v[32:47], a[92:95], v[20:23], v[32:47]
s_waitcnt lgkmcnt(2)
ds_read_b128 v[16:19], v64 offset:27648
buffer_load_dwordx4 v0, s[4:7], s55 offen offset:2048 sc1 lds
buffer_load_dwordx4 v0, s[4:7], s55 offen offset:3072 sc1 lds
v_mfma_f32_32x32x16_bf16 v[32:47], a[96:99], v[24:27], v[32:47]
s_waitcnt lgkmcnt(2)
ds_read_b128 v[20:23], v64 offset:28672
s_add_u32 m0, s45, 8192
s_add_u32 s55, s46, 8192
buffer_load_dwordx4 v0, s[4:7], s55 offen offset:0 sc1 lds
buffer_load_dwordx4 v0, s[4:7], s55 offen offset:1024 sc1 lds
v_mfma_f32_32x32x16_bf16 v[32:47], a[100:103], v[8:11], v[32:47]
s_waitcnt lgkmcnt(2)
ds_read_b128 v[24:27], v64 offset:29696
s_add_u32 s45, s45, 40960
s_cmp_ge_u32 s45, 122880
s_cselect_b32 s55, 122880, 0
s_sub_u32 s45, s45, s55
s_add_u32 s46, s46, 40960
v_mfma_f32_32x32x16_bf16 v[32:47], a[104:107], v[12:15], v[32:47]
s_waitcnt lgkmcnt(2)
ds_read_b128 v[8:11], v64 offset:30720
v_mfma_f32_32x32x16_bf16 v[32:47], a[108:111], v[16:19], v[32:47]
s_waitcnt lgkmcnt(2)
ds_read_b128 v[12:15], v64 offset:31744
v_mfma_f32_32x32x16_bf16 v[32:47], a[112:115], v[20:23], v[32:47]
s_waitcnt lgkmcnt(2)
ds_read_b128 v[16:19], v64 offset:32768
v_mfma_f32_32x32x16_bf16 v[32:47], a[116:119], v[24:27], v[32:47]
s_waitcnt lgkmcnt(2)
ds_read_b128 v[20:23], v64 offset:33792
v_mfma_f32_32x32x16_bf16 v[32:47], a[120:123], v[8:11], v[32:47]
s_waitcnt lgkmcnt(2)
ds_read_b128 v[24:27], v64 offset:34816
v_mfma_f32_32x32x16_bf16 v[32:47], a[124:127], v[12:15], v[32:47]
s_waitcnt lgkmcnt(2)
ds_read_b128 v[8:11], v64 offset:35840
v_mfma_f32_32x32x16_bf16 v[32:47], a[128:131], v[16:19], v[32:47]
s_waitcnt lgkmcnt(2)
ds_read_b128 v[12:15], v64 offset:36864
v_mfma_f32_32x32x16_bf16 v[32:47], a[132:135], v[20:23], v[32:47]
s_waitcnt lgkmcnt(2)
ds_read_b128 v[16:19], v64 offset:37888
v_mfma_f32_32x32x16_bf16 v[32:47], a[136:139], v[24:27], v[32:47]
s_waitcnt lgkmcnt(2)
ds_read_b128 v[20:23], v64 offset:38912
v_mfma_f32_32x32x16_bf16 v[32:47], a[140:143], v[8:11], v[32:47]
s_waitcnt lgkmcnt(2)
ds_read_b128 v[24:27], v64 offset:39936
v_mfma_f32_32x32x16_bf16 v[32:47], a[144:147], v[12:15], v[32:47]
s_add_u32 s44, s44, 1
s_cmp_eq_u32 s44, 3
s_mov_b32 s56, 40960
s_cmov_b32 s56, -81920
s_cselect_b32 s44, 0, s44
v_add_u32 v64, s56, v64
v_add_u32 v5, s56, v5
s_waitcnt vmcnt(10) lgkmcnt(2)
s_barrier
s_add_u32 s50, s50, 1
v_mov_b32 v4, s50
buffer_store_dword v4, v2, s[4:7], s60 offen sc1
ds_read_b128 v[8:11], v64 offset:0
v_mfma_f32_32x32x16_bf16 v[32:47], a[148:151], v[16:19], v[32:47]
s_waitcnt lgkmcnt(2)
ds_read_b128 v[12:15], v64 offset:1024
v_mfma_f32_32x32x16_bf16 v[32:47], a[152:155], v[20:23], v[32:47]
s_waitcnt lgkmcnt(2)
ds_read_b128 v[16:19], v64 offset:2048
v_mfma_f32_32x32x16_bf16 v[32:47], a[156:159], v[24:27], v[32:47]
s_waitcnt lgkmcnt(2)
ds_read_b128 v[20:23], v64 offset:3072
s_branch k_st_32
k_so_33:
ds_read_b128 v[80:83], v7 offset:1024
ds_read_b128 v[84:87], v7 offset:1040
v_mov_b32 v88, 0x3727c5ac
s_waitcnt lgkmcnt(0)
v_add_f32 v80, v80, v84
v_add_f32 v81, v81, v85
v_add_f32 v82, v82, v86
v_add_f32 v83, v83, v87
v_add_f32 v80, v80, v81
v_add_f32 v82, v82, v83
v_add_f32 v80, v80, v82
v_fma_f32 v80, v80, s61, v88
v_rsq_f32 v80, v80
s_nop 0
v_mul_f32 v48, v80, v48
v_mul_f32 v49, v80, v49
v_cvt_pk_bf16_f32 v48, v48, v49
v_mul_f32 v50, v80, v50
v_mul_f32 v51, v80, v51
v_cvt_pk_bf16_f32 v49, v50, v51
v_mul_f32 v52, v80, v52
v_mul_f32 v53, v80, v53
v_cvt_pk_bf16_f32 v50, v52, v53
v_mul_f32 v54, v80, v54
v_mul_f32 v55, v80, v55
v_cvt_pk_bf16_f32 v51, v54, v55
v_mul_f32 v56, v80, v56
v_mul_f32 v57, v80, v57
v_cvt_pk_bf16_f32 v52, v56, v57
v_mul_f32 v58, v80, v58
v_mul_f32 v59, v80, v59
v_cvt_pk_bf16_f32 v53, v58, v59
v_mul_f32 v60, v80, v60
v_mul_f32 v61, v80, v61
v_cvt_pk_bf16_f32 v54, v60, v61
v_mul_f32 v62, v80, v62
v_mul_f32 v63, v80, v63
v_cvt_pk_bf16_f32 v55, v62, v63
buffer_store_dwordx4 v[48:51], v1, s[4:7], s48 offen offset:0 sc1
buffer_store_dwordx4 v[52:55], v1, s[4:7], s48 offen offset:512 sc1
s_add_u32 s48, s48, s49
s_branch k_join_29
k_isv_28:
s_mul_i32 s45, s3, 10240
s_mov_b32 s44, 0
v_mov_b32 v64, v0
s_add_u32 m0, s45, 0
s_add_u32 s55, s46, 0
buffer_load_dwordx4 v0, s[4:7], s55 offen offset:0 sc1 lds
buffer_load_dwordx4 v0, s[4:7], s55 offen offset:1024 sc1 lds
buffer_load_dwordx4 v0, s[4:7], s55 offen offset:2048 sc1 lds
buffer_load_dwordx4 v0, s[4:7], s55 offen offset:3072 sc1 lds
s_add_u32 m0, s45, 4096
s_add_u32 s55, s46, 4096
buffer_load_dwordx4 v0, s[4:7], s55 offen offset:0 sc1 lds
buffer_load_dwordx4 v0, s[4:7], s55 offen offset:1024 sc1 lds
buffer_load_dwordx4 v0, s[4:7], s55 offen offset:2048 sc1 lds
buffer_load_dwordx4 v0, s[4:7], s55 offen offset:3072 sc1 lds
s_add_u32 m0, s45, 8192
s_add_u32 s55, s46, 8192
buffer_load_dwordx4 v0, s[4:7], s55 offen offset:0 sc1 lds
buffer_load_dwordx4 v0, s[4:7], s55 offen offset:1024 sc1 lds
s_add_u32 s45, s45, 40960
s_cmp_ge_u32 s45, 122880
s_cselect_b32 s55, 122880, 0
s_sub_u32 s45, s45, s55
s_add_u32 s46, s46, 40960
s_add_u32 m0, s45, 0
s_add_u32 s55, s46, 0
buffer_load_dwordx4 v0, s[4:7], s55 offen offset:0 sc1 lds
buffer_load_dwordx4 v0, s[4:7], s55 offen offset:1024 sc1 lds
buffer_load_dwordx4 v0, s[4:7], s55 offen offset:2048 sc1 lds
buffer_load_dwordx4 v0, s[4:7], s55 offen offset:3072 sc1 lds
s_add_u32 m0, s45, 4096
s_add_u32 s55, s46, 4096
buffer_load_dwordx4 v0, s[4:7], s55 offen offset:0 sc1 lds
buffer_load_dwordx4 v0, s[4:7], s55 offen offset:1024 sc1 lds
buffer_load_dwordx4 v0, s[4:7], s55 offen offset:2048 sc1 lds
buffer_load_dwordx4 v0, s[4:7], s55 offen offset:3072 sc1 lds
s_add_u32 m0, s45, 8192
s_add_u32 s55, s46, 8192
buffer_load_dwordx4 v0, s[4:7], s55 offen offset:0 sc1 lds
buffer_load_dwordx4 v0, s[4:7], s55 offen offset:1024 sc1 lds
s_add_u32 s45, s45, 40960
s_cmp_ge_u32 s45, 122880
s_cselect_b32 s55, 122880, 0
s_sub_u32 s45, s45, s55
s_add_u32 s46, s46, 40960
s_waitcnt vmcnt(10)
s_barrier
ds_read_b128 v[8:11], v64 offset:0
ds_read_b128 v[12:15], v64 offset:1024
ds_read_b128 v[16:19], v64 offset:2048
ds_read_b128 v[20:23], v64 offset:3072
s_mov_b32 s59, 32
s_waitcnt lgkmcnt(3)
v_mfma_f32_32x32x16_bf16 v[32:47], v[8:11], a[0:3], 0
s_waitcnt lgkmcnt(2)
ds_read_b128 v[24:27], v64 offset:4096
v_mfma_f32_32x32x16_bf16 v[32:47], v[12:15], a[4:7], v[32:47]
s_waitcnt lgkmcnt(2)
ds_read_b128 v[8:11], v64 offset:5120
ds_read_b128 v[72:75], v5
v_mov_b32 v4, 0
ds_read_b128 v[76:79], v5 offset:1024
v_mfma_f32_32x32x16_bf16 v[32:47], v[16:19], a[8:11], v[32:47]
s_waitcnt lgkmcnt(4)
ds_read_b128 v[12:15], v64 offset:6144
s_waitcnt lgkmcnt(2)
v_and_b32 v72, v3, v72
v_dot2c_f32_bf16 v4, v72, v72
v_dot2c_f32_bf16 v4, v73, v73
v_dot2c_f32_bf16 v4, v74, v74
v_dot2c_f32_bf16 v4, v75, v75
v_mfma_f32_32x32x16_bf16 v[32:47], v[20:23], a[12:15], v[32:47]
ds_read_b128 v[16:19], v64 offset:7168
ds_read_b128 v[72:75], v5 offset:2048
s_waitcnt lgkmcnt(3)
v_dot2c_f32_bf16 v4, v76, v76
v_dot2c_f32_bf16 v4, v77, v77
v_dot2c_f32_bf16 v4, v78, v78
v_dot2c_f32_bf16 v4, v79, v79
v_mfma_f32_32x32x16_bf16 v[32:47], v[24:27], a[16:19], v[32:47]
ds_read_b128 v[20:23], v64 offset:8192
ds_read_b128 v[76:79], v5 offset:3072
s_waitcnt lgkmcnt(2)
v_dot2c_f32_bf16 v4, v72, v72
v_dot2c_f32_bf16 v4, v73, v73
v_dot2c_f32_bf16 v4, v74, v74
v_dot2c_f32_bf16 v4, v75, v75
v_mfma_f32_32x32x16_bf16 v[32:47], v[8:11], a[20:23], v[32:47]
ds_read_b128 v[24:27], v64 offset:9216
ds_read_b128 v[72:75], v5 offset:4096
s_waitcnt lgkmcnt(2)
v_dot2c_f32_bf16 v4, v76, v76
v_dot2c_f32_bf16 v4, v77, v77
v_dot2c_f32_bf16 v4, v78, v78
v_dot2c_f32_bf16 v4, v79, v79
v_mfma_f32_32x32x16_bf16 v[32:47], v[12:15], a[24:27], v[32:47]
ds_read_b128 v[8:11], v64 offset:10240
ds_read_b128 v[76:79], v5 offset:5120
s_waitcnt lgkmcnt(2)
v_dot2c_f32_bf16 v4, v72, v72
v_dot2c_f32_bf16 v4, v73, v73
v_dot2c_f32_bf16 v4, v74, v74
v_dot2c_f32_bf16 v4, v75, v75
v_mfma_f32_32x32x16_bf16 v[32:47], v[16:19], a[28:31], v[32:47]
ds_read_b128 v[12:15], v64 offset:11264
ds_read_b128 v[72:75], v5 offset:6144
s_waitcnt lgkmcnt(2)
v_dot2c_f32_bf16 v4, v76, v76
v_dot2c_f32_bf16 v4, v77, v77
v_dot2c_f32_bf16 v4, v78, v78
v_dot2c_f32_bf16 v4, v79, v79
v_mfma_f32_32x32x16_bf16 v[32:47], v[20:23], a[32:35], v[32:47]
ds_read_b128 v[16:19], v64 offset:12288
ds_read_b128 v[76:79], v5 offset:7168
s_waitcnt lgkmcnt(2)
v_dot2c_f32_bf16 v4, v72, v72
v_dot2c_f32_bf16 v4, v73, v73
v_dot2c_f32_bf16 v4, v74, v74
v_dot2c_f32_bf16 v4, v75, v75
v_mfma_f32_32x32x16_bf16 v[32:47], v[24:27], a[36:39], v[32:47]
ds_read_b128 v[20:23], v64 offset:13312
ds_read_b128 v[72:75], v5 offset:8192
s_waitcnt lgkmcnt(2)
v_dot2c_f32_bf16 v4, v76, v76
v_dot2c_f32_bf16 v4, v77, v77
v_dot2c_f32_bf16 v4, v78, v78
v_dot2c_f32_bf16 v4, v79, v79
v_mfma_f32_32x32x16_bf16 v[32:47], v[8:11], a[40:43], v[32:47]
ds_read_b128 v[24:27], v64 offset:14336
ds_read_b128 v[76:79], v5 offset:9216
s_waitcnt lgkmcnt(2)
v_dot2c_f32_bf16 v4, v72, v72
v_dot2c_f32_bf16 v4, v73, v73
v_dot2c_f32_bf16 v4, v74, v74
v_dot2c_f32_bf16 v4, v75, v75
v_mfma_f32_32x32x16_bf16 v[32:47], v[12:15], a[44:47], v[32:47]
ds_read_b128 v[8:11], v64 offset:15360
s_waitcnt lgkmcnt(1)
v_dot2c_f32_bf16 v4, v76, v76
v_dot2c_f32_bf16 v4, v77, v77
v_dot2c_f32_bf16 v4, v78, v78
v_dot2c_f32_bf16 v4, v79, v79
s_nop 2
ds_write_b32 v6, v4 offset:0
v_mfma_f32_32x32x16_bf16 v[32:47], v[16:19], a[48:51], v[32:47]
ds_read_b128 v[12:15], v64 offset:16384
s_add_u32 m0, s45, 0
s_add_u32 s55, s46, 0
buffer_load_dwordx4 v0, s[4:7], s55 offen offset:0 sc1 lds
buffer_load_dwordx4 v0, s[4:7], s55 offen offset:1024 sc1 lds
v_mfma_f32_32x32x16_bf16 v[32:47], v[20:23], a[52:55], v[32:47]
ds_read_b128 v[16:19], v64 offset:17408
buffer_load_dwordx4 v0, s[4:7], s55 offen offset:2048 sc1 lds
buffer_load_dwordx4 v0, s[4:7], s55 offen offset:3072 sc1 lds
v_mfma_f32_32x32x16_bf16 v[32:47], v[24:27], a[56:59], v[32:47]
s_waitcnt lgkmcnt(3)
ds_read_b128 v[20:23], v64 offset:18432
s_add_u32 m0, s45, 4096
s_add_u32 s55, s46, 4096
buffer_load_dwordx4 v0, s[4:7], s55 offen offset:0 sc1 lds
buffer_load_dwordx4 v0, s[4:7], s55 offen offset:1024 sc1 lds
v_mfma_f32_32x32x16_bf16 v[32:47], v[8:11], a[60:63], v[32:47]
s_waitcnt lgkmcnt(2)
ds_read_b128 v[24:27], v64 offset:19456
buffer_load_dwordx4 v0, s[4:7], s55 offen offset:2048 sc1 lds
buffer_load_dwordx4 v0, s[4:7], s55 offen offset:3072 sc1 lds
v_mfma_f32_32x32x16_bf16 v[32:47], v[12:15], a[64:67], v[32:47]
s_waitcnt lgkmcnt(2)
ds_read_b128 v[8:11], v64 offset:20480
s_add_u32 m0, s45, 8192
s_add_u32 s55, s46, 8192
buffer_load_dwordx4 v0, s[4:7], s55 offen offset:0 sc1 lds
buffer_load_dwordx4 v0, s[4:7], s55 offen offset:1024 sc1 lds
v_mfma_f32_32x32x16_bf16 v[32:47], v[16:19], a[68:71], v[32:47]
s_waitcnt lgkmcnt(2)
ds_read_b128 v[12:15], v64 offset:21504
s_add_u32 s45, s45, 40960
s_cmp_ge_u32 s45, 122880
s_cselect_b32 s55, 122880, 0
s_sub_u32 s45, s45, s55
s_add_u32 s46, s46, 40960
v_mfma_f32_32x32x16_bf16 v[32:47], v[20:23], a[72:75], v[32:47]
s_waitcnt lgkmcnt(2)
ds_read_b128 v[16:19], v64 offset:22528
v_mfma_f32_32x32x16_bf16 v[32:47], v[24:27], a[76:79], v[32:47]
s_waitcnt lgkmcnt(2)
ds_read_b128 v[20:23], v64 offset:23552
v_mfma_f32_32x32x16_bf16 v[32:47], v[8:11], a[80:83], v[32:47]
s_waitcnt lgkmcnt(2)
ds_read_b128 v[24:27], v64 offset:24576
v_mfma_f32_32x32x16_bf16 v[32:47], v[12:15], a[84:87], v[32:47]
s_waitcnt lgkmcnt(2)
ds_read_b128 v[8:11], v64 offset:25600
v_mfma_f32_32x32x16_bf16 v[32:47], v[16:19], a[88:91], v[32:47]
s_waitcnt lgkmcnt(2)
ds_read_b128 v[12:15], v64 offset:26624
v_mfma_f32_32x32x16_bf16 v[32:47], v[20:23], a[92:95], v[32:47]
s_waitcnt lgkmcnt(2)
ds_read_b128 v[16:19], v64 offset:27648
v_mfma_f32_32x32x16_bf16 v[32:47], v[24:27], a[96:99], v[32:47]
s_waitcnt lgkmcnt(2)
ds_read_b128 v[20:23], v64 offset:28672
v_mfma_f32_32x32x16_bf16 v[32:47], v[8:11], a[100:103], v[32:47]
s_waitcnt lgkmcnt(2)
ds_read_b128 v[24:27], v64 offset:29696
v_mfma_f32_32x32x16_bf16 v[32:47], v[12:15], a[104:107], v[32:47]
s_waitcnt lgkmcnt(2)
ds_read_b128 v[8:11], v64 offset:30720
v_mfma_f32_32x32x16_bf16 v[32:47], v[16:19], a[108:111], v[32:47]
s_waitcnt lgkmcnt(2)
ds_read_b128 v[12:15], v64 offset:31744
v_mfma_f32_32x32x16_bf16 v[32:47], v[20:23], a[112:115], v[32:47]
s_waitcnt lgkmcnt(2)
ds_read_b128 v[16:19], v64 offset:32768
v_mfma_f32_32x32x16_bf16 v[32:47], v[24:27], a[116:119], v[32:47]
s_waitcnt lgkmcnt(2)
ds_read_b128 v[20:23], v64 offset:33792
v_mfma_f32_32x32x16_bf16 v[32:47], v[8:11], a[120:123], v[32:47]
s_waitcnt lgkmcnt(2)
ds_read_b128 v[24:27], v64 offset:34816
v_mfma_f32_32x32x16_bf16 v[32:47], v[12:15], a[124:127], v[32:47]
s_waitcnt lgkmcnt(2)
ds_read_b128 v[8:11], v64 offset:35840
v_mfma_f32_32x32x16_bf16 v[32:47], v[16:19], a[128:131], v[32:47]
s_waitcnt lgkmcnt(2)
ds_read_b128 v[12:15], v64 offset:36864
v_mfma_f32_32x32x16_bf16 v[32:47], v[20:23], a[132:135], v[32:47]
s_waitcnt lgkmcnt(2)
ds_read_b128 v[16:19], v64 offset:37888
v_mfma_f32_32x32x16_bf16 v[32:47], v[24:27], a[136:139], v[32:47]
s_waitcnt lgkmcnt(2)
ds_read_b128 v[20:23], v64 offset:38912
v_mfma_f32_32x32x16_bf16 v[32:47], v[8:11], a[140:143], v[32:47]
s_waitcnt lgkmcnt(2)
ds_read_b128 v[24:27], v64 offset:39936
v_mfma_f32_32x32x16_bf16 v[32:47], v[12:15], a[144:147], v[32:47]
s_add_u32 s44, s44, 1
s_cmp_eq_u32 s44, 3
s_mov_b32 s56, 40960
s_cmov_b32 s56, -81920
s_cselect_b32 s44, 0, s44
v_add_u32 v64, s56, v64
v_add_u32 v5, s56, v5
s_waitcnt vmcnt(10) lgkmcnt(2)
s_barrier
ds_read_b128 v[8:11], v64 offset:0
v_mfma_f32_32x32x16_bf16 v[32:47], v[16:19], a[148:151], v[32:47]
s_waitcnt lgkmcnt(2)
ds_read_b128 v[12:15], v64 offset:1024
v_mfma_f32_32x32x16_bf16 v[32:47], v[20:23], a[152:155], v[32:47]
s_waitcnt lgkmcnt(2)
ds_read_b128 v[16:19], v64 offset:2048
v_mfma_f32_32x32x16_bf16 v[32:47], v[24:27], a[156:159], v[32:47]
s_waitcnt lgkmcnt(2)
ds_read_b128 v[20:23], v64 offset:3072
k_st_34:
v_mfma_f32_32x32x16_bf16 v[48:63], v[8:11], a[0:3], 0
s_waitcnt lgkmcnt(2)
ds_read_b128 v[24:27], v64 offset:4096
v_mfma_f32_32x32x16_bf16 v[48:63], v[12:15], a[4:7], v[48:63]
s_waitcnt lgkmcnt(2)
ds_read_b128 v[8:11], v64 offset:5120
ds_read_b128 v[80:83], v7 offset:0
ds_read_b128 v[84:87], v7 offset:16
v_mov_b32 v88, 0x3727c5ac
v_mfma_f32_32x32x16_bf16 v[48:63], v[16:19], a[8:11], v[48:63]
s_waitcnt lgkmcnt(4)
ds_read_b128 v[12:15], v64 offset:6144
s_waitcnt lgkmcnt(1)
v_add_f32 v80, v80, v84
v_add_f32 v81, v81, v85
v_add_f32 v82, v82, v86
v_add_f32 v83, v83, v87
v_add_f32 v80, v80, v81
v_add_f32 v82, v82, v83
v_add_f32 v80, v80, v82
v_mfma_f32_32x32x16_bf16 v[48:63], v[20:23], a[12:15], v[48:63]
ds_read_b128 v[16:19], v64 offset:7168
v_fma_f32 v80, v80, s61, v88
v_rsq_f32 v80, v80
ds_write_b32 v28, v80
v_mfma_f32_32x32x16_bf16 v[48:63], v[24:27], a[16:19], v[48:63]
ds_read_b128 v[20:23], v64 offset:8192
ds_read_b128 v[80:83], v29 offset:0
ds_read_b128 v[84:87], v29 offset:32
ds_read_b128 v[88:91], v29 offset:64
ds_read_b128 v[92:95], v29 offset:96
v_mfma_f32_32x32x16_bf16 v[48:63], v[8:11], a[20:23], v[48:63]
s_waitcnt lgkmcnt(7)
ds_read_b128 v[24:27], v64 offset:9216
s_waitcnt lgkmcnt(4)
v_mul_f32 v80, v80, v32
v_mul_f32 v81, v81, v33
v_mul_f32 v82, v82, v34
v_mul_f32 v83, v83, v35
v_mfma_f32_32x32x16_bf16 v[48:63], v[12:15], a[24:27], v[48:63]
ds_read_b128 v[8:11], v64 offset:10240
s_waitcnt lgkmcnt(4)
v_mul_f32 v84, v84, v36
v_mul_f32 v85, v85, v37
v_mul_f32 v86, v86, v38
v_mul_f32 v87, v87, v39
v_mfma_f32_32x32x16_bf16 v[48:63], v[16:19], a[28:31], v[48:63]
ds_read_b128 v[12:15], v64 offset:11264
s_waitcnt lgkmcnt(4)
v_mul_f32 v88, v88, v40
v_mul_f32 v89, v89, v41
v_mul_f32 v90, v90, v42
v_mul_f32 v91, v91, v43
v_mfma_f32_32x32x16_bf16 v[48:63], v[20:23], a[32:35], v[48:63]
s_waitcnt lgkmcnt(2)
ds_read_b128 v[16:19], v64 offset:12288
v_mul_f32 v92, v92, v44
v_mul_f32 v93, v93, v45
v_mul_f32 v94, v94, v46
v_mul_f32 v95, v95, v47
v_mfma_f32_32x32x16_bf16 v[48:63], v[24:27], a[36:39], v[48:63]
s_waitcnt lgkmcnt(2)
ds_read_b128 v[20:23], v64 offset:13312
v_cvt_pk_bf16_f32 v32, v80, v81
v_cvt_pk_bf16_f32 v33, v82, v83
v_mfma_f32_32x32x16_bf16 v[48:63], v[8:11], a[40:43], v[48:63]
s_waitcnt lgkmcnt(2)
ds_read_b128 v[24:27], v64 offset:14336
v_cvt_pk_bf16_f32 v36, v84, v85
v_cvt_pk_bf16_f32 v37, v86, v87
v_mfma_f32_32x32x16_bf16 v[48:63], v[12:15], a[44:47], v[48:63]
s_waitcnt lgkmcnt(2)
ds_read_b128 v[8:11], v64 offset:15360
v_cvt_pk_bf16_f32 v34, v88, v89
v_cvt_pk_bf16_f32 v35, v90, v91
v_mfma_f32_32x32x16_bf16 v[48:63], v[16:19], a[48:51], v[48:63]
s_waitcnt lgkmcnt(2)
ds_read_b128 v[12:15], v64 offset:16384
v_cvt_pk_bf16_f32 v38, v92, v93
v_cvt_pk_bf16_f32 v39, v94, v95
v_mfma_f32_32x32x16_bf16 v[48:63], v[20:23], a[52:55], v[48:63]
s_waitcnt lgkmcnt(2)
ds_read_b128 v[16:19], v64 offset:17408
buffer_store_dwordx4 v[32:35], v1, s[4:7], s48 offen offset:2048 sc1
buffer_store_dwordx4 v[36:39], v1, s[4:7], s48 offen offset:2560 sc1
v_mfma_f32_32x32x16_bf16 v[48:63], v[24:27], a[56:59], v[48:63]
s_waitcnt lgkmcnt(2)
ds_read_b128 v[20:23], v64 offset:18432
s_add_u32 s48, s48, s49
ds_read_b128 v[72:75], v5
v_mov_b32 v4, 0
v_mfma_f32_32x32x16_bf16 v[48:63], v[8:11], a[60:63], v[48:63]
s_waitcnt lgkmcnt(3)
ds_read_b128 v[24:27], v64 offset:19456
ds_read_b128 v[76:79], v5 offset:1024
s_waitcnt lgkmcnt(2)
v_and_b32 v72, v3, v72
v_mfma_f32_32x32x16_bf16 v[48:63], v[12:15], a[64:67], v[48:63]
ds_read_b128 v[8:11], v64 offset:20480
v_dot2c_f32_bf16 v4, v72, v72
v_dot2c_f32_bf16 v4, v73, v73
v_dot2c_f32_bf16 v4, v74, v74
v_dot2c_f32_bf16 v4, v75, v75
ds_read_b128 v[72:75], v5 offset:2048
v_mfma_f32_32x32x16_bf16 v[48:63], v[16:19], a[68:71], v[48:63]
ds_read_b128 v[12:15], v64 offset:21504
s_waitcnt lgkmcnt(3)
v_dot2c_f32_bf16 v4, v76, v76
v_dot2c_f32_bf16 v4, v77, v77
v_dot2c_f32_bf16 v4, v78, v78
v_dot2c_f32_bf16 v4, v79, v79
ds_read_b128 v[76:79], v5 offset:3072
v_mfma_f32_32x32x16_bf16 v[48:63], v[20:23], a[72:75], v[48:63]
ds_read_b128 v[16:19], v64 offset:22528
s_waitcnt lgkmcnt(3)
v_dot2c_f32_bf16 v4, v72, v72
v_dot2c_f32_bf16 v4, v73, v73
v_dot2c_f32_bf16 v4, v74, v74
v_dot2c_f32_bf16 v4, v75, v75
ds_read_b128 v[72:75], v5 offset:4096
v_mfma_f32_32x32x16_bf16 v[48:63], v[24:27], a[76:79], v[48:63]
ds_read_b128 v[20:23], v64 offset:23552
s_waitcnt lgkmcnt(3)
v_dot2c_f32_bf16 v4, v76, v76
v_dot2c_f32_bf16 v4, v77, v77
v_dot2c_f32_bf16 v4, v78, v78
v_dot2c_f32_bf16 v4, v79, v79
ds_read_b128 v[76:79], v5 offset:5120
v_mfma_f32_32x32x16_bf16 v[48:63], v[8:11], a[80:83], v[48:63]
ds_read_b128 v[24:27], v64 offset:24576
s_waitcnt lgkmcnt(3)
v_dot2c_f32_bf16 v4, v72, v72
v_dot2c_f32_bf16 v4, v73, v73
v_dot2c_f32_bf16 v4, v74, v74
v_dot2c_f32_bf16 v4, v75, v75
ds_read_b128 v[72:75], v5 offset:6144
v_mfma_f32_32x32x16_bf16 v[48:63], v[12:15], a[84:87], v[48:63]
ds_read_b128 v[8:11], v64 offset:25600
s_waitcnt lgkmcnt(3)
v_dot2c_f32_bf16 v4, v76, v76
v_dot2c_f32_bf16 v4, v77, v77
v_dot2c_f32_bf16 v4, v78, v78
v_dot2c_f32_bf16 v4, v79, v79
ds_read_b128 v[76:79], v5 offset:7168
v_mfma_f32_32x32x16_bf16 v[48:63], v[16:19], a[88:91], v[48:63]
ds_read_b128 v[12:15], v64 offset:26624
s_waitcnt lgkmcnt(3)
v_dot2c_f32_bf16 v4, v72, v72
v_dot2c_f32_bf16 v4, v73, v73
v_dot2c_f32_bf16 v4, v74, v74
v_dot2c_f32_bf16 v4, v75, v75
ds_read_b128 v[72:75], v5 offset:8192
v_mfma_f32_32x32x16_bf16 v[48:63], v[20:23], a[92:95], v[48:63]
ds_read_b128 v[16:19], v64 offset:27648
s_waitcnt lgkmcnt(3)
v_dot2c_f32_bf16 v4, v76, v76
v_dot2c_f32_bf16 v4, v77, v77
v_dot2c_f32_bf16 v4, v78, v78
v_dot2c_f32_bf16 v4, v79, v79
ds_read_b128 v[76:79], v5 offset:9216
v_mfma_f32_32x32x16_bf16 v[48:63], v[24:27], a[96:99], v[48:63]
ds_read_b128 v[20:23], v64 offset:28672
s_waitcnt lgkmcnt(3)
v_dot2c_f32_bf16 v4, v72, v72
v_dot2c_f32_bf16 v4, v73, v73
v_dot2c_f32_bf16 v4, v74, v74
v_dot2c_f32_bf16 v4, v75, v75
s_waitcnt lgkmcnt(1)
v_dot2c_f32_bf16 v4, v76, v76
v_dot2c_f32_bf16 v4, v77, v77
v_dot2c_f32_bf16 v4, v78, v78
v_dot2c_f32_bf16 v4, v79, v79
v_mfma_f32_32x32x16_bf16 v[48:63], v[8:11], a[100:103], v[48:63]
ds_read_b128 v[24:27], v64 offset:29696
ds_write_b32 v6, v4 offset:1024
s_add_u32 m0, s45, 0
s_add_u32 s55, s46, 0
buffer_load_dwordx4 v0, s[4:7], s55 offen offset:0 sc1 lds
v_mfma_f32_32x32x16_bf16 v[48:63], v[12:15], a[104:107], v[48:63]
ds_read_b128 v[8:11], v64 offset:30720
buffer_load_dwordx4 v0, s[4:7], s55 offen offset:1024 sc1 lds
buffer_load_dwordx4 v0, s[4:7], s55 offen offset:2048 sc1 lds
v_mfma_f32_32x32x16_bf16 v[48:63], v[16:19], a[108:111], v[48:63]
s_waitcnt lgkmcnt(3)
ds_read_b128 v[12:15], v64 offset:31744
buffer_load_dwordx4 v0, s[4:7], s55 offen offset:3072 sc1 lds
s_add_u32 m0, s45, 4096
s_add_u32 s55, s46, 4096
buffer_load_dwordx4 v0, s[4:7], s55 offen offset:0 sc1 lds
v_mfma_f32_32x32x16_bf16 v[48:63], v[20:23], a[112:115], v[48:63]
s_waitcnt lgkmcnt(3)
ds_read_b128 v[16:19], v64 offset:32768
buffer_load_dwordx4 v0, s[4:7], s55 offen offset:1024 sc1 lds
buffer_load_dwordx4 v0, s[4:7], s55 offen offset:2048 sc1 lds
v_mfma_f32_32x32x16_bf16 v[48:63], v[24:27], a[116:119], v[48:63]
s_waitcnt lgkmcnt(2)
ds_read_b128 v[20:23], v64 offset:33792
buffer_load_dwordx4 v0, s[4:7], s55 offen offset:3072 sc1 lds
s_add_u32 m0, s45, 8192
s_add_u32 s55, s46, 8192
buffer_load_dwordx4 v0, s[4:7], s55 offen offset:0 sc1 lds
v_mfma_f32_32x32x16_bf16 v[48:63], v[8:11], a[120:123], v[48:63]
s_waitcnt lgkmcnt(2)
ds_read_b128 v[24:27], v64 offset:34816
buffer_load_dwordx4 v0, s[4:7], s55 offen offset:1024 sc1 lds
s_add_u32 s45, s45, 40960
s_cmp_ge_u32 s45, 122880
s_cselect_b32 s55, 122880, 0
s_sub_u32 s45, s45, s55
v_mfma_f32_32x32x16_bf16 v[48:63], v[12:15], a[124:127], v[48:63]
s_waitcnt lgkmcnt(2)
ds_read_b128 v[8:11], v64 offset:35840
s_add_u32 s46, s46, 40960
v_mfma_f32_32x32x16_bf16 v[48:63], v[16:19], a[128:131], v[48:63]
s_waitcnt lgkmcnt(2)
ds_read_b128 v[12:15], v64 offset:36864
v_mfma_f32_32x32x16_bf16 v[48:63], v[20:23], a[132:135], v[48:63]
s_waitcnt lgkmcnt(2)
ds_read_b128 v[16:19], v64 offset:37888
v_mfma_f32_32x32x16_bf16 v[48:63], v[24:27], a[136:139], v[48:63]
s_waitcnt lgkmcnt(2)
ds_read_b128 v[20:23], v64 offset:38912
v_mfma_f32_32x32x16_bf16 v[48:63], v[8:11], a[140:143], v[48:63]
s_waitcnt lgkmcnt(2)
ds_read_b128 v[24:27], v64 offset:39936
v_mfma_f32_32x32x16_bf16 v[48:63], v[12:15], a[144:147], v[48:63]
s_add_u32 s44, s44, 1
s_cmp_eq_u32 s44, 3
s_mov_b32 s56, 40960
s_cmov_b32 s56, -81920
s_cselect_b32 s44, 0, s44
v_add_u32 v64, s56, v64
v_add_u32 v5, s56, v5
s_waitcnt vmcnt(10) lgkmcnt(2)
s_barrier
s_add_u32 s50, s50, 1
v_mov_b32 v4, s50
buffer_store_dword v4, v2, s[4:7], s60 offen sc1
ds_read_b128 v[8:11], v64 offset:0
v_mfma_f32_32x32x16_bf16 v[48:63], v[16:19], a[148:151], v[48:63]
s_waitcnt lgkmcnt(2)
ds_read_b128 v[12:15], v64 offset:1024
v_mfma_f32_32x32x16_bf16 v[48:63], v[20:23], a[152:155], v[48:63]
s_waitcnt lgkmcnt(2)
ds_read_b128 v[16:19], v64 offset:2048
v_mfma_f32_32x32x16_bf16 v[48:63], v[24:27], a[156:159], v[48:63]
s_waitcnt lgkmcnt(2)
ds_read_b128 v[20:23], v64 offset:3072
s_sub_u32 s59, s59, 1
s_cmp_eq_u32 s59, 0
s_cbranch_scc1 k_so_35
v_mfma_f32_32x32x16_bf16 v[32:47], v[8:11], a[0:3], 0
s_waitcnt lgkmcnt(2)
ds_read_b128 v[24:27], v64 offset:4096
v_mfma_f32_32x32x16_bf16 v[32:47], v[12:15], a[4:7], v[32:47]
s_waitcnt lgkmcnt(2)
ds_read_b128 v[8:11], v64 offset:5120
ds_read_b128 v[80:83], v7 offset:1024
ds_read_b128 v[84:87], v7 offset:1040
v_mov_b32 v88, 0x3727c5ac
v_mfma_f32_32x32x16_bf16 v[32:47], v[16:19], a[8:11], v[32:47]
s_waitcnt lgkmcnt(4)
ds_read_b128 v[12:15], v64 offset:6144
s_waitcnt lgkmcnt(1)
v_add_f32 v80, v80, v84
v_add_f32 v81, v81, v85
v_add_f32 v82, v82, v86
v_add_f32 v83, v83, v87
v_add_f32 v80, v80, v81
v_add_f32 v82, v82, v83
v_add_f32 v80, v80, v82
v_mfma_f32_32x32x16_bf16 v[32:47], v[20:23], a[12:15], v[32:47]
ds_read_b128 v[16:19], v64 offset:7168
v_fma_f32 v80, v80, s61, v88
v_rsq_f32 v80, v80
ds_write_b32 v28, v80
v_mfma_f32_32x32x16_bf16 v[32:47], v[24:27], a[16:19], v[32:47]
ds_read_b128 v[20:23], v64 offset:8192
ds_read_b128 v[80:83], v29 offset:0
ds_read_b128 v[84:87], v29 offset:32
ds_read_b128 v[88:91], v29 offset:64
ds_read_b128 v[92:95], v29 offset:96
v_mfma_f32_32x32x16_bf16 v[32:47], v[8:11], a[20:23], v[32:47]
s_waitcnt lgkmcnt(7)
ds_read_b128 v[24:27], v64 offset:9216
s_waitcnt lgkmcnt(4)
v_mul_f32 v80, v80, v48
v_mul_f32 v81, v81, v49
v_mul_f32 v82, v82, v50
v_mul_f32 v83, v83, v51
v_mfma_f32_32x32x16_bf16 v[32:47], v[12:15], a[24:27], v[32:47]
ds_read_b128 v[8:11], v64 offset:10240
s_waitcnt lgkmcnt(4)
v_mul_f32 v84, v84, v52
v_mul_f32 v85, v85, v53
v_mul_f32 v86, v86, v54
v_mul_f32 v87, v87, v55
v_mfma_f32_32x32x16_bf16 v[32:47], v[16:19], a[28:31], v[32:47]
ds_read_b128 v[12:15], v64 offset:11264
s_waitcnt lgkmcnt(4)
v_mul_f32 v88, v88, v56
v_mul_f32 v89, v89, v57
v_mul_f32 v90, v90, v58
v_mul_f32 v91, v91, v59
v_mfma_f32_32x32x16_bf16 v[32:47], v[20:23], a[32:35], v[32:47]
s_waitcnt lgkmcnt(2)
ds_read_b128 v[16:19], v64 offset:12288
v_mul_f32 v92, v92, v60
v_mul_f32 v93, v93, v61
v_mul_f32 v94, v94, v62
v_mul_f32 v95, v95, v63
v_mfma_f32_32x32x16_bf16 v[32:47], v[24:27], a[36:39], v[32:47]
s_waitcnt lgkmcnt(2)
ds_read_b128 v[20:23], v64 offset:13312
v_cvt_pk_bf16_f32 v48, v80, v81
v_cvt_pk_bf16_f32 v49, v82, v83
v_mfma_f32_32x32x16_bf16 v[32:47], v[8:11], a[40:43], v[32:47]
s_waitcnt lgkmcnt(2)
ds_read_b128 v[24:27], v64 offset:14336
v_cvt_pk_bf16_f32 v52, v84, v85
v_cvt_pk_bf16_f32 v53, v86, v87
v_mfma_f32_32x32x16_bf16 v[32:47], v[12:15], a[44:47], v[32:47]
s_waitcnt lgkmcnt(2)
ds_read_b128 v[8:11], v64 offset:15360
v_cvt_pk_bf16_f32 v50, v88, v89
v_cvt_pk_bf16_f32 v51, v90, v91
v_mfma_f32_32x32x16_bf16 v[32:47], v[16:19], a[48:51], v[32:47]
s_waitcnt lgkmcnt(2)
ds_read_b128 v[12:15], v64 offset:16384
v_cvt_pk_bf16_f32 v54, v92, v93
v_cvt_pk_bf16_f32 v55, v94, v95
v_mfma_f32_32x32x16_bf16 v[32:47], v[20:23], a[52:55], v[32:47]
s_waitcnt lgkmcnt(2)
ds_read_b128 v[16:19], v64 offset:17408
buffer_store_dwordx4 v[48:51], v1, s[4:7], s48 offen offset:2048 sc1
buffer_store_dwordx4 v[52:55], v1, s[4:7], s48 offen offset:2560 sc1
v_mfma_f32_32x32x16_bf16 v[32:47], v[24:27], a[56:59], v[32:47]
s_waitcnt lgkmcnt(2)
ds_read_b128 v[20:23], v64 offset:18432
s_add_u32 s48, s48, s49
ds_read_b128 v[72:75], v5
v_mov_b32 v4, 0
v_mfma_f32_32x32x16_bf16 v[32:47], v[8:11], a[60:63], v[32:47]
s_waitcnt lgkmcnt(3)
ds_read_b128 v[24:27], v64 offset:19456
ds_read_b128 v[76:79], v5 offset:1024
s_waitcnt lgkmcnt(2)
v_and_b32 v72, v3, v72
v_mfma_f32_32x32x16_bf16 v[32:47], v[12:15], a[64:67], v[32:47]
ds_read_b128 v[8:11], v64 offset:20480
v_dot2c_f32_bf16 v4, v72, v72
v_dot2c_f32_bf16 v4, v73, v73
v_dot2c_f32_bf16 v4, v74, v74
v_dot2c_f32_bf16 v4, v75, v75
ds_read_b128 v[72:75], v5 offset:2048
v_mfma_f32_32x32x16_bf16 v[32:47], v[16:19], a[68:71], v[32:47]
ds_read_b128 v[12:15], v64 offset:21504
s_waitcnt lgkmcnt(3)
v_dot2c_f32_bf16 v4, v76, v76
v_dot2c_f32_bf16 v4, v77, v77
v_dot2c_f32_bf16 v4, v78, v78
v_dot2c_f32_bf16 v4, v79, v79
ds_read_b128 v[76:79], v5 offset:3072
v_mfma_f32_32x32x16_bf16 v[32:47], v[20:23], a[72:75], v[32:47]
ds_read_b128 v[16:19], v64 offset:22528
s_waitcnt lgkmcnt(3)
v_dot2c_f32_bf16 v4, v72, v72
v_dot2c_f32_bf16 v4, v73, v73
v_dot2c_f32_bf16 v4, v74, v74
v_dot2c_f32_bf16 v4, v75, v75
ds_read_b128 v[72:75], v5 offset:4096
v_mfma_f32_32x32x16_bf16 v[32:47], v[24:27], a[76:79], v[32:47]
ds_read_b128 v[20:23], v64 offset:23552
s_waitcnt lgkmcnt(3)
v_dot2c_f32_bf16 v4, v76, v76
v_dot2c_f32_bf16 v4, v77, v77
v_dot2c_f32_bf16 v4, v78, v78
v_dot2c_f32_bf16 v4, v79, v79
ds_read_b128 v[76:79], v5 offset:5120
v_mfma_f32_32x32x16_bf16 v[32:47], v[8:11], a[80:83], v[32:47]
ds_read_b128 v[24:27], v64 offset:24576
s_waitcnt lgkmcnt(3)
v_dot2c_f32_bf16 v4, v72, v72
v_dot2c_f32_bf16 v4, v73, v73
v_dot2c_f32_bf16 v4, v74, v74
v_dot2c_f32_bf16 v4, v75, v75
ds_read_b128 v[72:75], v5 offset:6144
v_mfma_f32_32x32x16_bf16 v[32:47], v[12:15], a[84:87], v[32:47]
ds_read_b128 v[8:11], v64 offset:25600
s_waitcnt lgkmcnt(3)
v_dot2c_f32_bf16 v4, v76, v76
v_dot2c_f32_bf16 v4, v77, v77
v_dot2c_f32_bf16 v4, v78, v78
v_dot2c_f32_bf16 v4, v79, v79
ds_read_b128 v[76:79], v5 offset:7168
v_mfma_f32_32x32x16_bf16 v[32:47], v[16:19], a[88:91], v[32:47]
ds_read_b128 v[12:15], v64 offset:26624
s_waitcnt lgkmcnt(3)
v_dot2c_f32_bf16 v4, v72, v72
v_dot2c_f32_bf16 v4, v73, v73
v_dot2c_f32_bf16 v4, v74, v74
v_dot2c_f32_bf16 v4, v75, v75
ds_read_b128 v[72:75], v5 offset:8192
v_mfma_f32_32x32x16_bf16 v[32:47], v[20:23], a[92:95], v[32:47]
ds_read_b128 v[16:19], v64 offset:27648
s_waitcnt lgkmcnt(3)
v_dot2c_f32_bf16 v4, v76, v76
v_dot2c_f32_bf16 v4, v77, v77
v_dot2c_f32_bf16 v4, v78, v78
v_dot2c_f32_bf16 v4, v79, v79
ds_read_b128 v[76:79], v5 offset:9216
v_mfma_f32_32x32x16_bf16 v[32:47], v[24:27], a[96:99], v[32:47]
ds_read_b128 v[20:23], v64 offset:28672
s_waitcnt lgkmcnt(3)
v_dot2c_f32_bf16 v4, v72, v72
v_dot2c_f32_bf16 v4, v73, v73
v_dot2c_f32_bf16 v4, v74, v74
v_dot2c_f32_bf16 v4, v75, v75
s_waitcnt lgkmcnt(1)
v_dot2c_f32_bf16 v4, v76, v76
v_dot2c_f32_bf16 v4, v77, v77
v_dot2c_f32_bf16 v4, v78, v78
v_dot2c_f32_bf16 v4, v79, v79
v_mfma_f32_32x32x16_bf16 v[32:47], v[8:11], a[100:103], v[32:47]
ds_read_b128 v[24:27], v64 offset:29696
ds_write_b32 v6, v4 offset:0
s_add_u32 m0, s45, 0
s_add_u32 s55, s46, 0
buffer_load_dwordx4 v0, s[4:7], s55 offen offset:0 sc1 lds
v_mfma_f32_32x32x16_bf16 v[32:47], v[12:15], a[104:107], v[32:47]
ds_read_b128 v[8:11], v64 offset:30720
buffer_load_dwordx4 v0, s[4:7], s55 offen offset:1024 sc1 lds
buffer_load_dwordx4 v0, s[4:7], s55 offen offset:2048 sc1 lds
v_mfma_f32_32x32x16_bf16 v[32:47], v[16:19], a[108:111], v[32:47]
s_waitcnt lgkmcnt(3)
ds_read_b128 v[12:15], v64 offset:31744
buffer_load_dwordx4 v0, s[4:7], s55 offen offset:3072 sc1 lds
s_add_u32 m0, s45, 4096
s_add_u32 s55, s46, 4096
buffer_load_dwordx4 v0, s[4:7], s55 offen offset:0 sc1 lds
v_mfma_f32_32x32x16_bf16 v[32:47], v[20:23], a[112:115], v[32:47]
s_waitcnt lgkmcnt(3)
ds_read_b128 v[16:19], v64 offset:32768
buffer_load_dwordx4 v0, s[4:7], s55 offen offset:1024 sc1 lds
buffer_load_dwordx4 v0, s[4:7], s55 offen offset:2048 sc1 lds
v_mfma_f32_32x32x16_bf16 v[32:47], v[24:27], a[116:119], v[32:47]
s_waitcnt lgkmcnt(2)
ds_read_b128 v[20:23], v64 offset:33792
buffer_load_dwordx4 v0, s[4:7], s55 offen offset:3072 sc1 lds
s_add_u32 m0, s45, 8192
s_add_u32 s55, s46, 8192
buffer_load_dwordx4 v0, s[4:7], s55 offen offset:0 sc1 lds
v_mfma_f32_32x32x16_bf16 v[32:47], v[8:11], a[120:123], v[32:47]
s_waitcnt lgkmcnt(2)
ds_read_b128 v[24:27], v64 offset:34816
buffer_load_dwordx4 v0, s[4:7], s55 offen offset:1024 sc1 lds
s_add_u32 s45, s45, 40960
s_cmp_ge_u32 s45, 122880
s_cselect_b32 s55, 122880, 0
s_sub_u32 s45, s45, s55
v_mfma_f32_32x32x16_bf16 v[32:47], v[12:15], a[124:127], v[32:47]
s_waitcnt lgkmcnt(2)
ds_read_b128 v[8:11], v64 offset:35840
s_add_u32 s46, s46, 40960
v_mfma_f32_32x32x16_bf16 v[32:47], v[16:19], a[128:131], v[32:47]
s_waitcnt lgkmcnt(2)
ds_read_b128 v[12:15], v64 offset:36864
v_mfma_f32_32x32x16_bf16 v[32:47], v[20:23], a[132:135], v[32:47]
s_waitcnt lgkmcnt(2)
ds_read_b128 v[16:19], v64 offset:37888
v_mfma_f32_32x32x16_bf16 v[32:47], v[24:27], a[136:139], v[32:47]
s_waitcnt lgkmcnt(2)
ds_read_b128 v[20:23], v64 offset:38912
v_mfma_f32_32x32x16_bf16 v[32:47], v[8:11], a[140:143], v[32:47]
s_waitcnt lgkmcnt(2)
ds_read_b128 v[24:27], v64 offset:39936
v_mfma_f32_32x32x16_bf16 v[32:47], v[12:15], a[144:147], v[32:47]
s_add_u32 s44, s44, 1
s_cmp_eq_u32 s44, 3
s_mov_b32 s56, 40960
s_cmov_b32 s56, -81920
s_cselect_b32 s44, 0, s44
v_add_u32 v64, s56, v64
v_add_u32 v5, s56, v5
s_waitcnt vmcnt(10) lgkmcnt(2)
s_barrier
s_add_u32 s50, s50, 1
v_mov_b32 v4, s50
buffer_store_dword v4, v2, s[4:7], s60 offen sc1
ds_read_b128 v[8:11], v64 offset:0
v_mfma_f32_32x32x16_bf16 v[32:47], v[16:19], a[148:151], v[32:47]
s_waitcnt lgkmcnt(2)
ds_read_b128 v[12:15], v64 offset:1024
v_mfma_f32_32x32x16_bf16 v[32:47], v[20:23], a[152:155], v[32:47]
s_waitcnt lgkmcnt(2)
ds_read_b128 v[16:19], v64 offset:2048
v_mfma_f32_32x32x16_bf16 v[32:47], v[24:27], a[156:159], v[32:47]
s_waitcnt lgkmcnt(2)
ds_read_b128 v[20:23], v64 offset:3072
s_branch k_st_34
k_so_35:
ds_read_b128 v[80:83], v7 offset:1024
ds_read_b128 v[84:87], v7 offset:1040
v_mov_b32 v88, 0x3727c5ac
s_waitcnt lgkmcnt(0)
v_add_f32 v80, v80, v84
v_add_f32 v81, v81, v85
v_add_f32 v82, v82, v86
v_add_f32 v83, v83, v87
v_add_f32 v80, v80, v81
v_add_f32 v82, v82, v83
v_add_f32 v80, v80, v82
v_fma_f32 v80, v80, s61, v88
v_rsq_f32 v80, v80
ds_write_b32 v28, v80
ds_read_b128 v[80:83], v29 offset:0
ds_read_b128 v[84:87], v29 offset:32
ds_read_b128 v[88:91], v29 offset:64
ds_read_b128 v[92:95], v29 offset:96
s_waitcnt lgkmcnt(3)
v_mul_f32 v80, v80, v48
v_mul_f32 v81, v81, v49
v_mul_f32 v82, v82, v50
v_mul_f32 v83, v83, v51
s_waitcnt lgkmcnt(2)
v_mul_f32 v84, v84, v52
v_mul_f32 v85, v85, v53
v_mul_f32 v86, v86, v54
v_mul_f32 v87, v87, v55
s_waitcnt lgkmcnt(1)
v_mul_f32 v88, v88, v56
v_mul_f32 v89, v89, v57
v_mul_f32 v90, v90, v58
v_mul_f32 v91, v91, v59
s_waitcnt lgkmcnt(0)
v_mul_f32 v92, v92, v60
v_mul_f32 v93, v93, v61
v_mul_f32 v94, v94, v62
v_mul_f32 v95, v95, v63
v_cvt_pk_bf16_f32 v48, v80, v81
v_cvt_pk_bf16_f32 v49, v82, v83
v_cvt_pk_bf16_f32 v52, v84, v85
v_cvt_pk_bf16_f32 v53, v86, v87
v_cvt_pk_bf16_f32 v50, v88, v89
v_cvt_pk_bf16_f32 v51, v90, v91
v_cvt_pk_bf16_f32 v54, v92, v93
v_cvt_pk_bf16_f32 v55, v94, v95
buffer_store_dwordx4 v[48:51], v1, s[4:7], s48 offen offset:2048 sc1
buffer_store_dwordx4 v[52:55], v1, s[4:7], s48 offen offset:2560 sc1
s_add_u32 s48, s48, s49
k_join_29:
s_waitcnt vmcnt(0) lgkmcnt(0)
s_barrier
s_add_u32 s50, s50, 1
v_mov_b32 v4, s50
buffer_store_dword v4, v2, s[4:7], s60 offen sc1
s_cmp_ge_u32 s30, 80
s_cbranch_scc1 k_fend_36
v_bfe_u32 v8, v0, 4, 5
v_lshrrev_b32 v9, 9, v0
s_lshl_b32 s52, s30, 2
s_add_u32 s52, s52, s3
s_cmp_eq_u32 s52, 0
s_cselect_b32 s47, 0xffff, -1
s_cselect_b32 s53, 0x30000, 0
s_cmov_b32 s52, 320
v_add_u32 v26, s53, v0
s_cmp_lg_u32 s51, 0
s_cbranch_scc1 k_fnog_37
s_load_dwordx2 s[36:37], s[0:1], 64
s_mov_b32 s38, 1314816
s_mov_b32 s39, 0x20000
s_load_dwordx2 s[40:41], s[0:1], 72
s_mov_b32 s42, 1314816
s_mov_b32 s43, 0x20000
v_lshl_add_u32 v20, v9, 8, v8
v_mul_u32_u24 v20, 642, v20
s_lshl_b32 s52, s52, 1
v_add_u32 v22, s52, v20
s_waitcnt lgkmcnt(0)
s_mov_b32 s53, 0
buffer_load_ushort v192, v22, s[36:39], s53 offen
buffer_load_ushort v208, v22, s[40:43], s53 offen
s_mov_b32 s53, 41088
buffer_load_ushort v193, v22, s[36:39], s53 offen
buffer_load_ushort v209, v22, s[40:43], s53 offen
s_mov_b32 s53, 82176
buffer_load_ushort v194, v22, s[36:39], s53 offen
buffer_load_ushort v210, v22, s[40:43], s53 offen
s_mov_b32 s53, 123264
buffer_load_ushort v195, v22, s[36:39], s53 offen
buffer_load_ushort v211, v22, s[40:43], s53 offen
s_mov_b32 s53, 328704
buffer_load_ushort v196, v22, s[36:39], s53 offen
buffer_load_ushort v212, v22, s[40:43], s53 offen
s_mov_b32 s53, 369792
buffer_load_ushort v197, v22, s[36:39], s53 offen
buffer_load_ushort v213, v22, s[40:43], s53 offen
s_mov_b32 s53, 410880
buffer_load_ushort v198, v22, s[36:39], s53 offen
buffer_load_ushort v214, v22, s[40:43], s53 offen
s_mov_b32 s53, 451968
buffer_load_ushort v199, v22, s[36:39], s53 offen
buffer_load_ushort v215, v22, s[40:43], s53 offen
s_mov_b32 s53, 657408
buffer_load_ushort v200, v22, s[36:39], s53 offen
buffer_load_ushort v216, v22, s[40:43], s53 offen
s_mov_b32 s53, 698496
buffer_load_ushort v201, v22, s[36:39], s53 offen
buffer_load_ushort v217, v22, s[40:43], s53 offen
s_mov_b32 s53, 739584
buffer_load_ushort v202, v22, s[36:39], s53 offen
buffer_load_ushort v218, v22, s[40:43], s53 offen
s_mov_b32 s53, 780672
buffer_load_ushort v203, v22, s[36:39], s53 offen
buffer_load_ushort v219, v22, s[40:43], s53 offen
s_mov_b32 s53, 986112
buffer_load_ushort v204, v22, s[36:39], s53 offen
buffer_load_ushort v220, v22, s[40:43], s53 offen
s_mov_b32 s53, 1027200
buffer_load_ushort v205, v22, s[36:39], s53 offen
buffer_load_ushort v221, v22, s[40:43], s53 offen
s_mov_b32 s53, 1068288
buffer_load_ushort v206, v22, s[36:39], s53 offen
buffer_load_ushort v222, v22, s[40:43], s53 offen
s_mov_b32 s53, 1109376
buffer_load_ushort v207, v22, s[36:39], s53 offen
buffer_load_ushort v223, v22, s[40:43], s53 offen
s_mov_b32 s53, 20544
buffer_load_ushort v224, v22, s[36:39], s53 offen
buffer_load_ushort v240, v22, s[40:43], s53 offen
s_mov_b32 s53, 61632
buffer_load_ushort v225, v22, s[36:39], s53 offen
buffer_load_ushort v241, v22, s[40:43], s53 offen
s_mov_b32 s53, 102720
buffer_load_ushort v226, v22, s[36:39], s53 offen
buffer_load_ushort v242, v22, s[40:43], s53 offen
s_mov_b32 s53, 143808
buffer_load_ushort v227, v22, s[36:39], s53 offen
buffer_load_ushort v243, v22, s[40:43], s53 offen
s_mov_b32 s53, 349248
buffer_load_ushort v228, v22, s[36:39], s53 offen
buffer_load_ushort v244, v22, s[40:43], s53 offen
s_mov_b32 s53, 390336
buffer_load_ushort v229, v22, s[36:39], s53 offen
buffer_load_ushort v245, v22, s[40:43], s53 offen
s_mov_b32 s53, 431424
buffer_load_ushort v230, v22, s[36:39], s53 offen
buffer_load_ushort v246, v22, s[40:43], s53 offen
s_mov_b32 s53, 472512
buffer_load_ushort v231, v22, s[36:39], s53 offen
buffer_load_ushort v247, v22, s[40:43], s53 offen
s_mov_b32 s53, 677952
buffer_load_ushort v232, v22, s[36:39], s53 offen
buffer_load_ushort v248, v22, s[40:43], s53 offen
s_mov_b32 s53, 719040
buffer_load_ushort v233, v22, s[36:39], s53 offen
buffer_load_ushort v249, v22, s[40:43], s53 offen
s_mov_b32 s53, 760128
buffer_load_ushort v234, v22, s[36:39], s53 offen
buffer_load_ushort v250, v22, s[40:43], s53 offen
s_mov_b32 s53, 801216
buffer_load_ushort v235, v22, s[36:39], s53 offen
buffer_load_ushort v251, v22, s[40:43], s53 offen
s_mov_b32 s53, 1006656
buffer_load_ushort v236, v22, s[36:39], s53 offen
buffer_load_ushort v252, v22, s[40:43], s53 offen
s_mov_b32 s53, 1047744
buffer_load_ushort v237, v22, s[36:39], s53 offen
buffer_load_ushort v253, v22, s[40:43], s53 offen
s_mov_b32 s53, 1088832
buffer_load_ushort v238, v22, s[36:39], s53 offen
buffer_load_ushort v254, v22, s[40:43], s53 offen
s_mov_b32 s53, 1129920
buffer_load_ushort v239, v22, s[36:39], s53 offen
buffer_load_ushort v255, v22, s[40:43], s53 offen
v_lshl_add_u32 v10, v9, 2, 0
v_mul_u32_u24 v10, v10, v8
v_and_b32 v20, 31, v10
v_cvt_f32_u32 v20, v20
v_mul_f32 v20, 0x3d000000, v20
v_sin_f32 v21, v20
v_cos_f32 v20, v20
v_add_u32 v10, v8, v10
v_cvt_pk_bf16_f32 v32, v20, v21
v_cvt_pk_bf16_f32 v36, -v21, v20
v_and_b32 v20, 31, v10
v_cvt_f32_u32 v20, v20
v_mul_f32 v20, 0x3d000000, v20
v_sin_f32 v21, v20
v_cos_f32 v20, v20
v_add_u32 v10, v8, v10
v_cvt_pk_bf16_f32 v33, v20, v21
v_cvt_pk_bf16_f32 v37, -v21, v20
v_and_b32 v20, 31, v10
v_cvt_f32_u32 v20, v20
v_mul_f32 v20, 0x3d000000, v20
v_sin_f32 v21, v20
v_cos_f32 v20, v20
v_add_u32 v10, v8, v10
v_cvt_pk_bf16_f32 v34, v20, v21
v_cvt_pk_bf16_f32 v38, -v21, v20
v_and_b32 v20, 31, v10
v_cvt_f32_u32 v20, v20
v_mul_f32 v20, 0x3d000000, v20
v_sin_f32 v21, v20
v_cos_f32 v20, v20
v_add_u32 v10, v8, v10
v_cvt_pk_bf16_f32 v35, v20, v21
v_cvt_pk_bf16_f32 v39, -v21, v20
v_accvgpr_write_b32 a160, v32
v_accvgpr_write_b32 a161, v33
v_accvgpr_write_b32 a162, v34
v_accvgpr_write_b32 a163, v35
v_accvgpr_write_b32 a164, v36
v_accvgpr_write_b32 a165, v37
v_accvgpr_write_b32 a166, v38
v_accvgpr_write_b32 a167, v39
v_lshl_add_u32 v10, v9, 2, 8
v_mul_u32_u24 v10, v10, v8
v_and_b32 v20, 31, v10
v_cvt_f32_u32 v20, v20
v_mul_f32 v20, 0x3d000000, v20
v_sin_f32 v21, v20
v_cos_f32 v20, v20
v_add_u32 v10, v8, v10
v_cvt_pk_bf16_f32 v32, v20, v21
v_cvt_pk_bf16_f32 v36, -v21, v20
v_and_b32 v20, 31, v10
v_cvt_f32_u32 v20, v20
v_mul_f32 v20, 0x3d000000, v20
v_sin_f32 v21, v20
v_cos_f32 v20, v20
v_add_u32 v10, v8, v10
v_cvt_pk_bf16_f32 v33, v20, v21
v_cvt_pk_bf16_f32 v37, -v21, v20
v_and_b32 v20, 31, v10
v_cvt_f32_u32 v20, v20
v_mul_f32 v20, 0x3d000000, v20
v_sin_f32 v21, v20
v_cos_f32 v20, v20
v_add_u32 v10, v8, v10
v_cvt_pk_bf16_f32 v34, v20, v21
v_cvt_pk_bf16_f32 v38, -v21, v20
v_and_b32 v20, 31, v10
v_cvt_f32_u32 v20, v20
v_mul_f32 v20, 0x3d000000, v20
v_sin_f32 v21, v20
v_cos_f32 v20, v20
v_add_u32 v10, v8, v10
v_cvt_pk_bf16_f32 v35, v20, v21
v_cvt_pk_bf16_f32 v39, -v21, v20
v_accvgpr_write_b32 a168, v32
v_accvgpr_write_b32 a169, v33
v_accvgpr_write_b32 a170, v34
v_accvgpr_write_b32 a171, v35
v_accvgpr_write_b32 a172, v36
v_accvgpr_write_b32 a173, v37
v_accvgpr_write_b32 a174, v38
v_accvgpr_write_b32 a175, v39
v_lshl_add_u32 v10, v9, 2, 16
v_mul_u32_u24 v10, v10, v8
v_and_b32 v20, 31, v10
v_cvt_f32_u32 v20, v20
v_mul_f32 v20, 0x3d000000, v20
v_sin_f32 v21, v20
v_cos_f32 v20, v20
v_add_u32 v10, v8, v10
v_cvt_pk_bf16_f32 v32, v20, v21
v_cvt_pk_bf16_f32 v36, -v21, v20
v_and_b32 v20, 31, v10
v_cvt_f32_u32 v20, v20
v_mul_f32 v20, 0x3d000000, v20
v_sin_f32 v21, v20
v_cos_f32 v20, v20
v_add_u32 v10, v8, v10
v_cvt_pk_bf16_f32 v33, v20, v21
v_cvt_pk_bf16_f32 v37, -v21, v20
v_and_b32 v20, 31, v10
v_cvt_f32_u32 v20, v20
v_mul_f32 v20, 0x3d000000, v20
v_sin_f32 v21, v20
v_cos_f32 v20, v20
v_add_u32 v10, v8, v10
v_cvt_pk_bf16_f32 v34, v20, v21
v_cvt_pk_bf16_f32 v38, -v21, v20
v_and_b32 v20, 31, v10
v_cvt_f32_u32 v20, v20
v_mul_f32 v20, 0x3d000000, v20
v_sin_f32 v21, v20
v_cos_f32 v20, v20
v_add_u32 v10, v8, v10
v_cvt_pk_bf16_f32 v35, v20, v21
v_cvt_pk_bf16_f32 v39, -v21, v20
v_accvgpr_write_b32 a176, v32
v_accvgpr_write_b32 a177, v33
v_accvgpr_write_b32 a178, v34
v_accvgpr_write_b32 a179, v35
v_accvgpr_write_b32 a180, v36
v_accvgpr_write_b32 a181, v37
v_accvgpr_write_b32 a182, v38
v_accvgpr_write_b32 a183, v39
v_lshl_add_u32 v10, v9, 2, 24
v_mul_u32_u24 v10, v10, v8
v_and_b32 v20, 31, v10
v_cvt_f32_u32 v20, v20
v_mul_f32 v20, 0x3d000000, v20
v_sin_f32 v21, v20
v_cos_f32 v20, v20
v_add_u32 v10, v8, v10
v_cvt_pk_bf16_f32 v32, v20, v21
v_cvt_pk_bf16_f32 v36, -v21, v20
v_and_b32 v20, 31, v10
v_cvt_f32_u32 v20, v20
v_mul_f32 v20, 0x3d000000, v20
v_sin_f32 v21, v20
v_cos_f32 v20, v20
v_add_u32 v10, v8, v10
v_cvt_pk_bf16_f32 v33, v20, v21
v_cvt_pk_bf16_f32 v37, -v21, v20
v_and_b32 v20, 31, v10
v_cvt_f32_u32 v20, v20
v_mul_f32 v20, 0x3d000000, v20
v_sin_f32 v21, v20
v_cos_f32 v20, v20
v_add_u32 v10, v8, v10
v_cvt_pk_bf16_f32 v34, v20, v21
v_cvt_pk_bf16_f32 v38, -v21, v20
v_and_b32 v20, 31, v10
v_cvt_f32_u32 v20, v20
v_mul_f32 v20, 0x3d000000, v20
v_sin_f32 v21, v20
v_cos_f32 v20, v20
v_add_u32 v10, v8, v10
v_cvt_pk_bf16_f32 v35, v20, v21
v_cvt_pk_bf16_f32 v39, -v21, v20
v_accvgpr_write_b32 a184, v32
v_accvgpr_write_b32 a185, v33
v_accvgpr_write_b32 a186, v34
v_accvgpr_write_b32 a187, v35
v_accvgpr_write_b32 a188, v36
v_accvgpr_write_b32 a189, v37
v_accvgpr_write_b32 a190, v38
v_accvgpr_write_b32 a191, v39
s_waitcnt vmcnt(63)
v_lshlrev_b32 v192, 16, v192
v_mul_f32 v192, 0x3a000000, v192
s_waitcnt vmcnt(61)
v_lshlrev_b32 v193, 16, v193
v_mul_f32 v193, 0x3a000000, v193
s_waitcnt vmcnt(59)
v_lshlrev_b32 v194, 16, v194
v_mul_f32 v194, 0x3a000000, v194
s_waitcnt vmcnt(57)
v_lshlrev_b32 v195, 16, v195
v_mul_f32 v195, 0x3a000000, v195
s_waitcnt vmcnt(55)
v_lshlrev_b32 v196, 16, v196
v_mul_f32 v196, 0x3a000000, v196
s_waitcnt vmcnt(53)
v_lshlrev_b32 v197, 16, v197
v_mul_f32 v197, 0x3a000000, v197
s_waitcnt vmcnt(51)
v_lshlrev_b32 v198, 16, v198
v_mul_f32 v198, 0x3a000000, v198
s_waitcnt vmcnt(49)
v_lshlrev_b32 v199, 16, v199
v_mul_f32 v199, 0x3a000000, v199
s_waitcnt vmcnt(47)
v_lshlrev_b32 v200, 16, v200
v_mul_f32 v200, 0x3a000000, v200
s_waitcnt vmcnt(45)
v_lshlrev_b32 v201, 16, v201
v_mul_f32 v201, 0x3a000000, v201
s_waitcnt vmcnt(43)
v_lshlrev_b32 v202, 16, v202
v_mul_f32 v202, 0x3a000000, v202
s_waitcnt vmcnt(41)
v_lshlrev_b32 v203, 16, v203
v_mul_f32 v203, 0x3a000000, v203
s_waitcnt vmcnt(39)
v_lshlrev_b32 v204, 16, v204
v_mul_f32 v204, 0x3a000000, v204
s_waitcnt vmcnt(37)
v_lshlrev_b32 v205, 16, v205
v_mul_f32 v205, 0x3a000000, v205
s_waitcnt vmcnt(35)
v_lshlrev_b32 v206, 16, v206
v_mul_f32 v206, 0x3a000000, v206
s_waitcnt vmcnt(33)
v_lshlrev_b32 v207, 16, v207
v_mul_f32 v207, 0x3a000000, v207
v_lshlrev_b32 v208, 16, v208
v_mul_f32 v208, 0x3a000000, v208
v_lshlrev_b32 v209, 16, v209
v_mul_f32 v209, 0x3a000000, v209
v_lshlrev_b32 v210, 16, v210
v_mul_f32 v210, 0x3a000000, v210
v_lshlrev_b32 v211, 16, v211
v_mul_f32 v211, 0x3a000000, v211
v_lshlrev_b32 v212, 16, v212
v_mul_f32 v212, 0x3a000000, v212
v_lshlrev_b32 v213, 16, v213
v_mul_f32 v213, 0x3a000000, v213
v_lshlrev_b32 v214, 16, v214
v_mul_f32 v214, 0x3a000000, v214
v_lshlrev_b32 v215, 16, v215
v_mul_f32 v215, 0x3a000000, v215
v_lshlrev_b32 v216, 16, v216
v_mul_f32 v216, 0x3a000000, v216
v_lshlrev_b32 v217, 16, v217
v_mul_f32 v217, 0x3a000000, v217
v_lshlrev_b32 v218, 16, v218
v_mul_f32 v218, 0x3a000000, v218
v_lshlrev_b32 v219, 16, v219
v_mul_f32 v219, 0x3a000000, v219
v_lshlrev_b32 v220, 16, v220
v_mul_f32 v220, 0x3a000000, v220
v_lshlrev_b32 v221, 16, v221
v_mul_f32 v221, 0x3a000000, v221
v_lshlrev_b32 v222, 16, v222
v_mul_f32 v222, 0x3a000000, v222
s_waitcnt vmcnt(32)
v_lshlrev_b32 v223, 16, v223
v_mul_f32 v223, 0x3a000000, v223
s_waitcnt vmcnt(31)
v_lshlrev_b32 v224, 16, v224
v_mul_f32 v224, 0x3a000000, v224
s_waitcnt vmcnt(29)
v_lshlrev_b32 v225, 16, v225
v_mul_f32 v225, 0x3a000000, v225
s_waitcnt vmcnt(27)
v_lshlrev_b32 v226, 16, v226
v_mul_f32 v226, 0x3a000000, v226
s_waitcnt vmcnt(25)
v_lshlrev_b32 v227, 16, v227
v_mul_f32 v227, 0x3a000000, v227
s_waitcnt vmcnt(23)
v_lshlrev_b32 v228, 16, v228
v_mul_f32 v228, 0x3a000000, v228
s_waitcnt vmcnt(21)
v_lshlrev_b32 v229, 16, v229
v_mul_f32 v229, 0x3a000000, v229
s_waitcnt vmcnt(19)
v_lshlrev_b32 v230, 16, v230
v_mul_f32 v230, 0x3a000000, v230
s_waitcnt vmcnt(17)
v_lshlrev_b32 v231, 16, v231
v_mul_f32 v231, 0x3a000000, v231
s_waitcnt vmcnt(15)
v_lshlrev_b32 v232, 16, v232
v_mul_f32 v232, 0x3a000000, v232
s_waitcnt vmcnt(13)
v_lshlrev_b32 v233, 16, v233
v_mul_f32 v233, 0x3a000000, v233
s_waitcnt vmcnt(11)
v_lshlrev_b32 v234, 16, v234
v_mul_f32 v234, 0x3a000000, v234
s_waitcnt vmcnt(9)
v_lshlrev_b32 v235, 16, v235
v_mul_f32 v235, 0x3a000000, v235
s_waitcnt vmcnt(7)
v_lshlrev_b32 v236, 16, v236
v_mul_f32 v236, 0x3a000000, v236
s_waitcnt vmcnt(5)
v_lshlrev_b32 v237, 16, v237
v_mul_f32 v237, 0x3a000000, v237
s_waitcnt vmcnt(3)
v_lshlrev_b32 v238, 16, v238
v_mul_f32 v238, 0x3a000000, v238
s_waitcnt vmcnt(1)
v_lshlrev_b32 v239, 16, v239
v_mul_f32 v239, 0x3a000000, v239
v_lshlrev_b32 v240, 16, v240
v_mul_f32 v240, 0x3a000000, v240
v_lshlrev_b32 v241, 16, v241
v_mul_f32 v241, 0x3a000000, v241
v_lshlrev_b32 v242, 16, v242
v_mul_f32 v242, 0x3a000000, v242
v_lshlrev_b32 v243, 16, v243
v_mul_f32 v243, 0x3a000000, v243
v_lshlrev_b32 v244, 16, v244
v_mul_f32 v244, 0x3a000000, v244
v_lshlrev_b32 v245, 16, v245
v_mul_f32 v245, 0x3a000000, v245
v_lshlrev_b32 v246, 16, v246
v_mul_f32 v246, 0x3a000000, v246
v_lshlrev_b32 v247, 16, v247
v_mul_f32 v247, 0x3a000000, v247
v_lshlrev_b32 v248, 16, v248
v_mul_f32 v248, 0x3a000000, v248
v_lshlrev_b32 v249, 16, v249
v_mul_f32 v249, 0x3a000000, v249
v_lshlrev_b32 v250, 16, v250
v_mul_f32 v250, 0x3a000000, v250
v_lshlrev_b32 v251, 16, v251
v_mul_f32 v251, 0x3a000000, v251
v_lshlrev_b32 v252, 16, v252
v_mul_f32 v252, 0x3a000000, v252
v_lshlrev_b32 v253, 16, v253
v_mul_f32 v253, 0x3a000000, v253
v_lshlrev_b32 v254, 16, v254
v_mul_f32 v254, 0x3a000000, v254
s_waitcnt vmcnt(0)
v_lshlrev_b32 v255, 16, v255
v_mul_f32 v255, 0x3a000000, v255
k_fnog_37:
s_lshl_b32 s52, s3, 13
v_add_u32 v12, s52, v0
s_lshl_b32 s52, s3, 4
v_lshl_add_u32 v10, v9, 2, s52
v_add_u32 v10, 0, v10
v_add_u32 v11, 0, v8
v_mul_u32_u24 v10, v10, v11
v_and_b32 v20, 63, v10
v_cvt_f32_u32 v20, v20
v_mul_f32 v20, 0x3c800000, v20
v_sin_f32 v21, v20
v_cos_f32 v20, v20
v_add_u32 v10, v11, v10
v_cvt_pk_bf16_f32 v32, v20, v21
v_cvt_pk_bf16_f32 v36, -v21, v20
v_and_b32 v20, 63, v10
v_cvt_f32_u32 v20, v20
v_mul_f32 v20, 0x3c800000, v20
v_sin_f32 v21, v20
v_cos_f32 v20, v20
v_add_u32 v10, v11, v10
v_cvt_pk_bf16_f32 v33, v20, v21
v_cvt_pk_bf16_f32 v37, -v21, v20
v_and_b32 v20, 63, v10
v_cvt_f32_u32 v20, v20
v_mul_f32 v20, 0x3c800000, v20
v_sin_f32 v21, v20
v_cos_f32 v20, v20
v_add_u32 v10, v11, v10
v_cvt_pk_bf16_f32 v34, v20, v21
v_cvt_pk_bf16_f32 v38, -v21, v20
v_and_b32 v20, 63, v10
v_cvt_f32_u32 v20, v20
v_mul_f32 v20, 0x3c800000, v20
v_sin_f32 v21, v20
v_cos_f32 v20, v20
v_add_u32 v10, v11, v10
v_cvt_pk_bf16_f32 v35, v20, v21
v_cvt_pk_bf16_f32 v39, -v21, v20
ds_write_b128 v12, v[32:35] offset:0
ds_write_b128 v12, v[36:39] offset:1024
v_lshl_add_u32 v10, v9, 2, s52
v_add_u32 v10, 0, v10
v_add_u32 v11, 32, v8
v_mul_u32_u24 v10, v10, v11
v_and_b32 v20, 63, v10
v_cvt_f32_u32 v20, v20
v_mul_f32 v20, 0x3c800000, v20
v_sin_f32 v21, v20
v_cos_f32 v20, v20
v_add_u32 v10, v11, v10
v_cvt_pk_bf16_f32 v40, v20, v21
v_cvt_pk_bf16_f32 v44, -v21, v20
v_and_b32 v20, 63, v10
v_cvt_f32_u32 v20, v20
v_mul_f32 v20, 0x3c800000, v20
v_sin_f32 v21, v20
v_cos_f32 v20, v20
v_add_u32 v10, v11, v10
v_cvt_pk_bf16_f32 v41, v20, v21
v_cvt_pk_bf16_f32 v45, -v21, v20
v_and_b32 v20, 63, v10
v_cvt_f32_u32 v20, v20
v_mul_f32 v20, 0x3c800000, v20
v_sin_f32 v21, v20
v_cos_f32 v20, v20
v_add_u32 v10, v11, v10
v_cvt_pk_bf16_f32 v42, v20, v21
v_cvt_pk_bf16_f32 v46, -v21, v20
v_and_b32 v20, 63, v10
v_cvt_f32_u32 v20, v20
v_mul_f32 v20, 0x3c800000, v20
v_sin_f32 v21, v20
v_cos_f32 v20, v20
v_add_u32 v10, v11, v10
v_cvt_pk_bf16_f32 v43, v20, v21
v_cvt_pk_bf16_f32 v47, -v21, v20
ds_write_b128 v12, v[40:43] offset:2048
ds_write_b128 v12, v[44:47] offset:3072
v_lshl_add_u32 v10, v9, 2, s52
v_add_u32 v10, 8, v10
v_add_u32 v11, 0, v8
v_mul_u32_u24 v10, v10, v11
v_and_b32 v20, 63, v10
v_cvt_f32_u32 v20, v20
v_mul_f32 v20, 0x3c800000, v20
v_sin_f32 v21, v20
v_cos_f32 v20, v20
v_add_u32 v10, v11, v10
v_cvt_pk_bf16_f32 v48, v20, v21
v_cvt_pk_bf16_f32 v52, -v21, v20
v_and_b32 v20, 63, v10
v_cvt_f32_u32 v20, v20
v_mul_f32 v20, 0x3c800000, v20
v_sin_f32 v21, v20
v_cos_f32 v20, v20
v_add_u32 v10, v11, v10
v_cvt_pk_bf16_f32 v49, v20, v21
v_cvt_pk_bf16_f32 v53, -v21, v20
v_and_b32 v20, 63, v10
v_cvt_f32_u32 v20, v20
v_mul_f32 v20, 0x3c800000, v20
v_sin_f32 v21, v20
v_cos_f32 v20, v20
v_add_u32 v10, v11, v10
v_cvt_pk_bf16_f32 v50, v20, v21
v_cvt_pk_bf16_f32 v54, -v21, v20
v_and_b32 v20, 63, v10
v_cvt_f32_u32 v20, v20
v_mul_f32 v20, 0x3c800000, v20
v_sin_f32 v21, v20
v_cos_f32 v20, v20
v_add_u32 v10, v11, v10
v_cvt_pk_bf16_f32 v51, v20, v21
v_cvt_pk_bf16_f32 v55, -v21, v20
ds_write_b128 v12, v[48:51] offset:4096
ds_write_b128 v12, v[52:55] offset:5120
v_lshl_add_u32 v10, v9, 2, s52
v_add_u32 v10, 8, v10
v_add_u32 v11, 32, v8
v_mul_u32_u24 v10, v10, v11
v_and_b32 v20, 63, v10
v_cvt_f32_u32 v20, v20
v_mul_f32 v20, 0x3c800000, v20
v_sin_f32 v21, v20
v_cos_f32 v20, v20
v_add_u32 v10, v11, v10
v_cvt_pk_bf16_f32 v56, v20, v21
v_cvt_pk_bf16_f32 v60, -v21, v20
v_and_b32 v20, 63, v10
v_cvt_f32_u32 v20, v20
v_mul_f32 v20, 0x3c800000, v20
v_sin_f32 v21, v20
v_cos_f32 v20, v20
v_add_u32 v10, v11, v10
v_cvt_pk_bf16_f32 v57, v20, v21
v_cvt_pk_bf16_f32 v61, -v21, v20
v_and_b32 v20, 63, v10
v_cvt_f32_u32 v20, v20
v_mul_f32 v20, 0x3c800000, v20
v_sin_f32 v21, v20
v_cos_f32 v20, v20
v_add_u32 v10, v11, v10
v_cvt_pk_bf16_f32 v58, v20, v21
v_cvt_pk_bf16_f32 v62, -v21, v20
v_and_b32 v20, 63, v10
v_cvt_f32_u32 v20, v20
v_mul_f32 v20, 0x3c800000, v20
v_sin_f32 v21, v20
v_cos_f32 v20, v20
v_add_u32 v10, v11, v10
v_cvt_pk_bf16_f32 v59, v20, v21
v_cvt_pk_bf16_f32 v63, -v21, v20
ds_write_b128 v12, v[56:59] offset:6144
ds_write_b128 v12, v[60:63] offset:7168
s_lshl_b32 s52, s3, 11
v_add_u32 v12, s52, v0
s_lshl_b32 s52, s3, 3
v_lshl_add_u32 v10, v9, 2, s52
v_add_u32 v10, 0, v10
v_add_u32 v11, 0, v8
v_mul_u32_u24 v10, v10, v11
v_cvt_f32_u32 v20, v10
v_mul_f32 v20, 0x3a000000, v20
v_add_u32 v10, v11, v10
v_cos_f32 v64, v20
v_sin_f32 v68, v20
v_cvt_f32_u32 v20, v10
v_mul_f32 v20, 0x3a000000, v20
v_add_u32 v10, v11, v10
v_cos_f32 v65, v20
v_sin_f32 v69, v20
v_cvt_f32_u32 v20, v10
v_mul_f32 v20, 0x3a000000, v20
v_add_u32 v10, v11, v10
v_cos_f32 v66, v20
v_sin_f32 v70, v20
v_cvt_f32_u32 v20, v10
v_mul_f32 v20, 0x3a000000, v20
v_add_u32 v10, v11, v10
v_cos_f32 v67, v20
v_sin_f32 v71, v20
ds_write_b128 v12, v[64:67] offset:32768
ds_write_b128 v12, v[68:71] offset:33792
v_lshl_add_u32 v10, v9, 2, s52
v_add_u32 v10, 0, v10
v_add_u32 v11, 32, v8
v_mul_u32_u24 v10, v10, v11
v_cvt_f32_u32 v20, v10
v_mul_f32 v20, 0x3a000000, v20
v_add_u32 v10, v11, v10
v_cos_f32 v72, v20
v_sin_f32 v76, v20
v_cvt_f32_u32 v20, v10
v_mul_f32 v20, 0x3a000000, v20
v_add_u32 v10, v11, v10
v_cos_f32 v73, v20
v_sin_f32 v77, v20
v_cvt_f32_u32 v20, v10
v_mul_f32 v20, 0x3a000000, v20
v_add_u32 v10, v11, v10
v_cos_f32 v74, v20
v_sin_f32 v78, v20
v_cvt_f32_u32 v20, v10
v_mul_f32 v20, 0x3a000000, v20
v_add_u32 v10, v11, v10
v_cos_f32 v75, v20
v_sin_f32 v79, v20
ds_write_b128 v12, v[72:75] offset:40960
ds_write_b128 v12, v[76:79] offset:41984
v_lshl_add_u32 v10, v9, 2, s52
v_add_u32 v10, 32, v10
v_add_u32 v11, 0, v8
v_mul_u32_u24 v10, v10, v11
v_cvt_f32_u32 v20, v10
v_mul_f32 v20, 0x3a000000, v20
v_add_u32 v10, v11, v10
v_cos_f32 v80, v20
v_sin_f32 v84, v20
v_cvt_f32_u32 v20, v10
v_mul_f32 v20, 0x3a000000, v20
v_add_u32 v10, v11, v10
v_cos_f32 v81, v20
v_sin_f32 v85, v20
v_cvt_f32_u32 v20, v10
v_mul_f32 v20, 0x3a000000, v20
v_add_u32 v10, v11, v10
v_cos_f32 v82, v20
v_sin_f32 v86, v20
v_cvt_f32_u32 v20, v10
v_mul_f32 v20, 0x3a000000, v20
v_add_u32 v10, v11, v10
v_cos_f32 v83, v20
v_sin_f32 v87, v20
ds_write_b128 v12, v[80:83] offset:49152
ds_write_b128 v12, v[84:87] offset:50176
s_lshl_b32 s52, s3, 2
v_lshl_add_u32 v30, v8, 4, s52
v_lshl_add_u32 v30, v9, 11, v30
v_mul_u32_u24 v31, 2560, v9
v_lshl_add_u32 v31, v8, 2, v31
s_lshr_b32 s52, s3, 1
s_lshl_b32 s52, s52, 9
s_and_b32 s53, s3, 1
s_lshl_b32 s53, s53, 3
s_add_u32 s52, s52, s53
v_lshl_add_u32 v24, v8, 4, s52
v_lshl_add_u32 v24, v9, 2, v24
s_mov_b32 s52, 163840
v_mul_lo_u32 v25, v9, s52
v_lshl_add_u32 v25, v8, 4, v25
s_mul_i32 s44, s51, 3145728
s_lshl_b32 s52, s30, 15
s_add_u32 s44, s44, s52
s_add_u32 s44, s44, 205520896
s_mul_i32 s45, s51, 1048576
s_mul_i32 s52, s3, 5120
s_add_u32 s45, s45, s52
s_add_u32 s45, s45, 211812352
s_mul_i32 s48, s51, 3145728
s_lshl_b32 s52, s30, 9
s_add_u32 s48, s48, s52
s_mul_i32 s52, s3, 327680
s_add_u32 s48, s48, s52
s_add_u32 s48, s48, 198180864
s_mov_b32 s49, 0x3acccccd
v_mov_b32 v27, 0x3727c5ac
s_waitcnt vmcnt(0) lgkmcnt(0)
s_barrier
ds_read_b128 v[112:115], v0 offset:0
ds_read_b128 v[116:119], v0 offset:1024
ds_read_b128 v[120:123], v0 offset:2048
ds_read_b128 v[124:127], v0 offset:3072
k_pr_38:
buffer_load_dword v18, v30, s[4:7], s44 offen offset:1024 sc1
s_waitcnt vmcnt(0)
v_cmp_eq_u32 vcc, -1, v18
s_cbranch_vccz k_prd_39
s_sleep 8
s_sub_u32 s32, s32, 1
s_cmp_gt_i32 s32, 0
s_cbranch_scc1 k_pr_38
k_prd_39:
k_ps_40:
buffer_load_dword v96, v31, s[4:7], s45 offen offset:0 sc1
buffer_load_dword v97, v31, s[4:7], s45 offen offset:128 sc1
buffer_load_dword v98, v31, s[4:7], s45 offen offset:256 sc1
buffer_load_dword v99, v31, s[4:7], s45 offen offset:384 sc1
buffer_load_dword v100, v31, s[4:7], s45 offen offset:512 sc1
buffer_load_dword v101, v31, s[4:7], s45 offen offset:640 sc1
buffer_load_dword v102, v31, s[4:7], s45 offen offset:768 sc1
buffer_load_dword v103, v31, s[4:7], s45 offen offset:896 sc1
buffer_load_dword v104, v31, s[4:7], s45 offen offset:1024 sc1
buffer_load_dword v105, v31, s[4:7], s45 offen offset:1152 sc1
buffer_load_dword v106, v31, s[4:7], s45 offen offset:1280 sc1
buffer_load_dword v107, v31, s[4:7], s45 offen offset:1408 sc1
buffer_load_dword v108, v31, s[4:7], s45 offen offset:1536 sc1
buffer_load_dword v109, v31, s[4:7], s45 offen offset:1664 sc1
buffer_load_dword v110, v31, s[4:7], s45 offen offset:1792 sc1
buffer_load_dword v111, v31, s[4:7], s45 offen offset:1920 sc1
buffer_load_dword v20, v31, s[4:7], s45 offen offset:2048 sc1
buffer_load_dword v21, v31, s[4:7], s45 offen offset:2176 sc1
buffer_load_dword v22, v31, s[4:7], s45 offen offset:2304 sc1
buffer_load_dword v23, v31, s[4:7], s45 offen offset:2432 sc1
buffer_load_dword v16, v30, s[4:7], s44 offen offset:0 sc1
buffer_load_dword v17, v30, s[4:7], s44 offen offset:512 sc1
buffer_load_dword v19, v30, s[4:7], s44 offen offset:1536 sc1
s_waitcnt vmcnt(21)
v_add_f32 v96, v96, v97
s_waitcnt vmcnt(20)
v_add_f32 v96, v96, v98
s_waitcnt vmcnt(19)
v_add_f32 v96, v96, v99
s_waitcnt vmcnt(18)
v_add_f32 v96, v96, v100
s_waitcnt vmcnt(17)
v_add_f32 v96, v96, v101
s_waitcnt vmcnt(16)
v_add_f32 v96, v96, v102
s_waitcnt vmcnt(15)
v_add_f32 v96, v96, v103
s_waitcnt vmcnt(14)
v_add_f32 v96, v96, v104
s_waitcnt vmcnt(13)
v_add_f32 v96, v96, v105
s_waitcnt vmcnt(12)
v_add_f32 v96, v96, v106
s_waitcnt vmcnt(11)
v_add_f32 v96, v96, v107
s_waitcnt vmcnt(10)
v_add_f32 v96, v96, v108
s_waitcnt vmcnt(9)
v_add_f32 v96, v96, v109
s_waitcnt vmcnt(8)
v_add_f32 v96, v96, v110
s_waitcnt vmcnt(7)
v_add_f32 v96, v96, v111
s_waitcnt vmcnt(6)
v_add_f32 v96, v96, v20
s_waitcnt vmcnt(5)
v_add_f32 v96, v96, v21
s_waitcnt vmcnt(4)
v_add_f32 v96, v96, v22
s_waitcnt vmcnt(3)
v_add_f32 v96, v96, v23
v_cmp_u_f32 vcc, v96, v96
v_fma_f32 v96, v96, s49, v27
s_cbranch_vccz k_psd_41
s_sub_u32 s32, s32, 1
s_cmp_gt_i32 s32, 0
s_cbranch_scc1 k_ps_40
k_psd_41:
v_rsq_f32 v96, v96
s_add_u32 s45, s45, 20480
ds_write_b32 v24, v96 offset:57344
s_branch k_pyd_43
k_py_42:
buffer_load_dword v16, v30, s[4:7], s44 offen offset:0 sc1
buffer_load_dword v17, v30, s[4:7], s44 offen offset:512 sc1
buffer_load_dword v19, v30, s[4:7], s44 offen offset:1536 sc1
s_sub_u32 s32, s32, 1
k_pyd_43:
s_waitcnt vmcnt(0)
v_max3_u32 v20, v16, v17, v19
v_cmp_eq_u32 vcc, -1, v20
s_cmp_gt_i32 s32, 0
s_cselect_b64 vcc, vcc, 0
s_cbranch_vccnz k_py_42
s_add_u32 s44, s44, 4096
s_waitcnt lgkmcnt(0)
s_barrier
ds_read_b128 v[12:15], v0 offset:57344
v_lshlrev_b32 v144, 16, v16
v_and_b32 v128, 0xffff0000, v16
v_lshlrev_b32 v145, 16, v17
v_and_b32 v129, 0xffff0000, v17
v_lshlrev_b32 v146, 16, v18
v_and_b32 v130, 0xffff0000, v18
v_lshlrev_b32 v147, 16, v19
v_and_b32 v131, 0xffff0000, v19
s_waitcnt lgkmcnt(0)
v_mul_f32 v8, v12, v144
v_mul_f32 v12, v12, v128
v_cvt_pk_bf16_f32 v8, v8, v12
v_and_b32 v8, s47, v8
v_mul_f32 v9, v13, v145
v_mul_f32 v13, v13, v129
v_cvt_pk_bf16_f32 v9, v9, v13
v_and_b32 v9, s47, v9
v_mul_f32 v10, v14, v146
v_mul_f32 v14, v14, v130
v_cvt_pk_bf16_f32 v10, v10, v14
v_and_b32 v10, s47, v10
v_mul_f32 v11, v15, v147
v_mul_f32 v15, v15, v131
v_cvt_pk_bf16_f32 v11, v11, v15
v_and_b32 v11, s47, v11
s_nop 1
v_mfma_f32_32x32x16_bf16 v[32:47], v[8:11], v[112:115], 0
v_mfma_f32_32x32x16_bf16 v[48:63], v[8:11], v[116:119], 0
v_mfma_f32_32x32x16_bf16 v[64:79], v[8:11], v[120:123], 0
v_mfma_f32_32x32x16_bf16 v[80:95], v[8:11], v[124:127], 0
ds_read_b128 v[112:115], v0 offset:4096
ds_read_b128 v[116:119], v0 offset:5120
ds_read_b128 v[120:123], v0 offset:6144
ds_read_b128 v[124:127], v0 offset:7168
k_pr_44:
buffer_load_dword v18, v30, s[4:7], s44 offen offset:1024 sc1
s_waitcnt vmcnt(0)
v_cmp_eq_u32 vcc, -1, v18
s_cbranch_vccz k_prd_45
s_sleep 8
s_sub_u32 s32, s32, 1
s_cmp_gt_i32 s32, 0
s_cbranch_scc1 k_pr_44
k_prd_45:
k_ps_46:
buffer_load_dword v96, v31, s[4:7], s45 offen offset:0 sc1
buffer_load_dword v97, v31, s[4:7], s45 offen offset:128 sc1
buffer_load_dword v98, v31, s[4:7], s45 offen offset:256 sc1
buffer_load_dword v99, v31, s[4:7], s45 offen offset:384 sc1
buffer_load_dword v100, v31, s[4:7], s45 offen offset:512 sc1
buffer_load_dword v101, v31, s[4:7], s45 offen offset:640 sc1
buffer_load_dword v102, v31, s[4:7], s45 offen offset:768 sc1
buffer_load_dword v103, v31, s[4:7], s45 offen offset:896 sc1
buffer_load_dword v104, v31, s[4:7], s45 offen offset:1024 sc1
buffer_load_dword v105, v31, s[4:7], s45 offen offset:1152 sc1
buffer_load_dword v106, v31, s[4:7], s45 offen offset:1280 sc1
buffer_load_dword v107, v31, s[4:7], s45 offen offset:1408 sc1
buffer_load_dword v108, v31, s[4:7], s45 offen offset:1536 sc1
buffer_load_dword v109, v31, s[4:7], s45 offen offset:1664 sc1
buffer_load_dword v110, v31, s[4:7], s45 offen offset:1792 sc1
buffer_load_dword v111, v31, s[4:7], s45 offen offset:1920 sc1
buffer_load_dword v20, v31, s[4:7], s45 offen offset:2048 sc1
buffer_load_dword v21, v31, s[4:7], s45 offen offset:2176 sc1
buffer_load_dword v22, v31, s[4:7], s45 offen offset:2304 sc1
buffer_load_dword v23, v31, s[4:7], s45 offen offset:2432 sc1
buffer_load_dword v16, v30, s[4:7], s44 offen offset:0 sc1
buffer_load_dword v17, v30, s[4:7], s44 offen offset:512 sc1
buffer_load_dword v19, v30, s[4:7], s44 offen offset:1536 sc1
s_waitcnt vmcnt(21)
v_add_f32 v96, v96, v97
s_waitcnt vmcnt(20)
v_add_f32 v96, v96, v98
s_waitcnt vmcnt(19)
v_add_f32 v96, v96, v99
s_waitcnt vmcnt(18)
v_add_f32 v96, v96, v100
s_waitcnt vmcnt(17)
v_add_f32 v96, v96, v101
s_waitcnt vmcnt(16)
v_add_f32 v96, v96, v102
s_waitcnt vmcnt(15)
v_add_f32 v96, v96, v103
s_waitcnt vmcnt(14)
v_add_f32 v96, v96, v104
s_waitcnt vmcnt(13)
v_add_f32 v96, v96, v105
s_waitcnt vmcnt(12)
v_add_f32 v96, v96, v106
s_waitcnt vmcnt(11)
v_add_f32 v96, v96, v107
s_waitcnt vmcnt(10)
v_add_f32 v96, v96, v108
s_waitcnt vmcnt(9)
v_add_f32 v96, v96, v109
s_waitcnt vmcnt(8)
v_add_f32 v96, v96, v110
s_waitcnt vmcnt(7)
v_add_f32 v96, v96, v111
s_waitcnt vmcnt(6)
v_add_f32 v96, v96, v20
s_waitcnt vmcnt(5)
v_add_f32 v96, v96, v21
s_waitcnt vmcnt(4)
v_add_f32 v96, v96, v22
s_waitcnt vmcnt(3)
v_add_f32 v96, v96, v23
v_cmp_u_f32 vcc, v96, v96
v_fma_f32 v96, v96, s49, v27
s_cbranch_vccz k_psd_47
s_sub_u32 s32, s32, 1
s_cmp_gt_i32 s32, 0
s_cbranch_scc1 k_ps_46
k_psd_47:
v_rsq_f32 v96, v96
s_add_u32 s45, s45, 20480
ds_write_b32 v24, v96 offset:58368
s_branch k_pyd_49
k_py_48:
buffer_load_dword v16, v30, s[4:7], s44 offen offset:0 sc1
buffer_load_dword v17, v30, s[4:7], s44 offen offset:512 sc1
buffer_load_dword v19, v30, s[4:7], s44 offen offset:1536 sc1
s_sub_u32 s32, s32, 1
k_pyd_49:
s_waitcnt vmcnt(0)
v_max3_u32 v20, v16, v17, v19
v_cmp_eq_u32 vcc, -1, v20
s_cmp_gt_i32 s32, 0
s_cselect_b64 vcc, vcc, 0
s_cbranch_vccnz k_py_48
s_add_u32 s44, s44, 4096
s_waitcnt lgkmcnt(0)
s_barrier
ds_read_b128 v[12:15], v0 offset:58368
v_lshlrev_b32 v148, 16, v16
v_and_b32 v132, 0xffff0000, v16
v_lshlrev_b32 v149, 16, v17
v_and_b32 v133, 0xffff0000, v17
v_lshlrev_b32 v150, 16, v18
v_and_b32 v134, 0xffff0000, v18
v_lshlrev_b32 v151, 16, v19
v_and_b32 v135, 0xffff0000, v19
s_waitcnt lgkmcnt(0)
v_mul_f32 v8, v12, v148
v_mul_f32 v12, v12, v132
v_cvt_pk_bf16_f32 v8, v8, v12
v_and_b32 v8, s47, v8
v_mul_f32 v9, v13, v149
v_mul_f32 v13, v13, v133
v_cvt_pk_bf16_f32 v9, v9, v13
v_and_b32 v9, s47, v9
v_mul_f32 v10, v14, v150
v_mul_f32 v14, v14, v134
v_cvt_pk_bf16_f32 v10, v10, v14
v_and_b32 v10, s47, v10
v_mul_f32 v11, v15, v151
v_mul_f32 v15, v15, v135
v_cvt_pk_bf16_f32 v11, v11, v15
v_and_b32 v11, s47, v11
s_nop 1
v_mfma_f32_32x32x16_bf16 v[32:47], v[8:11], v[112:115], v[32:47]
v_mfma_f32_32x32x16_bf16 v[48:63], v[8:11], v[116:119], v[48:63]
v_mfma_f32_32x32x16_bf16 v[64:79], v[8:11], v[120:123], v[64:79]
v_mfma_f32_32x32x16_bf16 v[80:95], v[8:11], v[124:127], v[80:95]
ds_read_b128 v[112:115], v0 offset:8192
ds_read_b128 v[116:119], v0 offset:9216
ds_read_b128 v[120:123], v0 offset:10240
ds_read_b128 v[124:127], v0 offset:11264
k_pr_50:
buffer_load_dword v18, v30, s[4:7], s44 offen offset:1024 sc1
s_waitcnt vmcnt(0)
v_cmp_eq_u32 vcc, -1, v18
s_cbranch_vccz k_prd_51
s_sleep 8
s_sub_u32 s32, s32, 1
s_cmp_gt_i32 s32, 0
s_cbranch_scc1 k_pr_50
k_prd_51:
k_ps_52:
buffer_load_dword v96, v31, s[4:7], s45 offen offset:0 sc1
buffer_load_dword v97, v31, s[4:7], s45 offen offset:128 sc1
buffer_load_dword v98, v31, s[4:7], s45 offen offset:256 sc1
buffer_load_dword v99, v31, s[4:7], s45 offen offset:384 sc1
buffer_load_dword v100, v31, s[4:7], s45 offen offset:512 sc1
buffer_load_dword v101, v31, s[4:7], s45 offen offset:640 sc1
buffer_load_dword v102, v31, s[4:7], s45 offen offset:768 sc1
buffer_load_dword v103, v31, s[4:7], s45 offen offset:896 sc1
buffer_load_dword v104, v31, s[4:7], s45 offen offset:1024 sc1
buffer_load_dword v105, v31, s[4:7], s45 offen offset:1152 sc1
buffer_load_dword v106, v31, s[4:7], s45 offen offset:1280 sc1
buffer_load_dword v107, v31, s[4:7], s45 offen offset:1408 sc1
buffer_load_dword v108, v31, s[4:7], s45 offen offset:1536 sc1
buffer_load_dword v109, v31, s[4:7], s45 offen offset:1664 sc1
buffer_load_dword v110, v31, s[4:7], s45 offen offset:1792 sc1
buffer_load_dword v111, v31, s[4:7], s45 offen offset:1920 sc1
buffer_load_dword v20, v31, s[4:7], s45 offen offset:2048 sc1
buffer_load_dword v21, v31, s[4:7], s45 offen offset:2176 sc1
buffer_load_dword v22, v31, s[4:7], s45 offen offset:2304 sc1
buffer_load_dword v23, v31, s[4:7], s45 offen offset:2432 sc1
buffer_load_dword v16, v30, s[4:7], s44 offen offset:0 sc1
buffer_load_dword v17, v30, s[4:7], s44 offen offset:512 sc1
buffer_load_dword v19, v30, s[4:7], s44 offen offset:1536 sc1
s_waitcnt vmcnt(21)
v_add_f32 v96, v96, v97
s_waitcnt vmcnt(20)
v_add_f32 v96, v96, v98
s_waitcnt vmcnt(19)
v_add_f32 v96, v96, v99
s_waitcnt vmcnt(18)
v_add_f32 v96, v96, v100
s_waitcnt vmcnt(17)
v_add_f32 v96, v96, v101
s_waitcnt vmcnt(16)
v_add_f32 v96, v96, v102
s_waitcnt vmcnt(15)
v_add_f32 v96, v96, v103
s_waitcnt vmcnt(14)
v_add_f32 v96, v96, v104
s_waitcnt vmcnt(13)
v_add_f32 v96, v96, v105
s_waitcnt vmcnt(12)
v_add_f32 v96, v96, v106
s_waitcnt vmcnt(11)
v_add_f32 v96, v96, v107
s_waitcnt vmcnt(10)
v_add_f32 v96, v96, v108
s_waitcnt vmcnt(9)
v_add_f32 v96, v96, v109
s_waitcnt vmcnt(8)
v_add_f32 v96, v96, v110
s_waitcnt vmcnt(7)
v_add_f32 v96, v96, v111
s_waitcnt vmcnt(6)
v_add_f32 v96, v96, v20
s_waitcnt vmcnt(5)
v_add_f32 v96, v96, v21
s_waitcnt vmcnt(4)
v_add_f32 v96, v96, v22
s_waitcnt vmcnt(3)
v_add_f32 v96, v96, v23
v_cmp_u_f32 vcc, v96, v96
v_fma_f32 v96, v96, s49, v27
s_cbranch_vccz k_psd_53
s_sub_u32 s32, s32, 1
s_cmp_gt_i32 s32, 0
s_cbranch_scc1 k_ps_52
k_psd_53:
v_rsq_f32 v96, v96
s_add_u32 s45, s45, 20480
ds_write_b32 v24, v96 offset:57344
s_branch k_pyd_55
k_py_54:
buffer_load_dword v16, v30, s[4:7], s44 offen offset:0 sc1
buffer_load_dword v17, v30, s[4:7], s44 offen offset:512 sc1
buffer_load_dword v19, v30, s[4:7], s44 offen offset:1536 sc1
s_sub_u32 s32, s32, 1
k_pyd_55:
s_waitcnt vmcnt(0)
v_max3_u32 v20, v16, v17, v19
v_cmp_eq_u32 vcc, -1, v20
s_cmp_gt_i32 s32, 0
s_cselect_b64 vcc, vcc, 0
s_cbranch_vccnz k_py_54
s_add_u32 s44, s44, 4096
s_waitcnt lgkmcnt(0)
s_barrier
ds_read_b128 v[12:15], v0 offset:57344
v_lshlrev_b32 v152, 16, v16
v_and_b32 v136, 0xffff0000, v16
v_lshlrev_b32 v153, 16, v17
v_and_b32 v137, 0xffff0000, v17
v_lshlrev_b32 v154, 16, v18
v_and_b32 v138, 0xffff0000, v18
v_lshlrev_b32 v155, 16, v19
v_and_b32 v139, 0xffff0000, v19
s_waitcnt lgkmcnt(0)
v_mul_f32 v8, v12, v152
v_mul_f32 v12, v12, v136
v_cvt_pk_bf16_f32 v8, v8, v12
v_and_b32 v8, s47, v8
v_mul_f32 v9, v13, v153
v_mul_f32 v13, v13, v137
v_cvt_pk_bf16_f32 v9, v9, v13
v_and_b32 v9, s47, v9
v_mul_f32 v10, v14, v154
v_mul_f32 v14, v14, v138
v_cvt_pk_bf16_f32 v10, v10, v14
v_and_b32 v10, s47, v10
v_mul_f32 v11, v15, v155
v_mul_f32 v15, v15, v139
v_cvt_pk_bf16_f32 v11, v11, v15
v_and_b32 v11, s47, v11
s_nop 1
v_mfma_f32_32x32x16_bf16 v[32:47], v[8:11], v[112:115], v[32:47]
v_mfma_f32_32x32x16_bf16 v[48:63], v[8:11], v[116:119], v[48:63]
v_mfma_f32_32x32x16_bf16 v[64:79], v[8:11], v[120:123], v[64:79]
v_mfma_f32_32x32x16_bf16 v[80:95], v[8:11], v[124:127], v[80:95]
ds_read_b128 v[112:115], v0 offset:12288
ds_read_b128 v[116:119], v0 offset:13312
ds_read_b128 v[120:123], v0 offset:14336
ds_read_b128 v[124:127], v0 offset:15360
k_pr_56:
buffer_load_dword v18, v30, s[4:7], s44 offen offset:1024 sc1
s_waitcnt vmcnt(0)
v_cmp_eq_u32 vcc, -1, v18
s_cbranch_vccz k_prd_57
s_sleep 8
s_sub_u32 s32, s32, 1
s_cmp_gt_i32 s32, 0
s_cbranch_scc1 k_pr_56
k_prd_57:
k_ps_58:
buffer_load_dword v96, v31, s[4:7], s45 offen offset:0 sc1
buffer_load_dword v97, v31, s[4:7], s45 offen offset:128 sc1
buffer_load_dword v98, v31, s[4:7], s45 offen offset:256 sc1
buffer_load_dword v99, v31, s[4:7], s45 offen offset:384 sc1
buffer_load_dword v100, v31, s[4:7], s45 offen offset:512 sc1
buffer_load_dword v101, v31, s[4:7], s45 offen offset:640 sc1
buffer_load_dword v102, v31, s[4:7], s45 offen offset:768 sc1
buffer_load_dword v103, v31, s[4:7], s45 offen offset:896 sc1
buffer_load_dword v104, v31, s[4:7], s45 offen offset:1024 sc1
buffer_load_dword v105, v31, s[4:7], s45 offen offset:1152 sc1
buffer_load_dword v106, v31, s[4:7], s45 offen offset:1280 sc1
buffer_load_dword v107, v31, s[4:7], s45 offen offset:1408 sc1
buffer_load_dword v108, v31, s[4:7], s45 offen offset:1536 sc1
buffer_load_dword v109, v31, s[4:7], s45 offen offset:1664 sc1
buffer_load_dword v110, v31, s[4:7], s45 offen offset:1792 sc1
buffer_load_dword v111, v31, s[4:7], s45 offen offset:1920 sc1
buffer_load_dword v20, v31, s[4:7], s45 offen offset:2048 sc1
buffer_load_dword v21, v31, s[4:7], s45 offen offset:2176 sc1
buffer_load_dword v22, v31, s[4:7], s45 offen offset:2304 sc1
buffer_load_dword v23, v31, s[4:7], s45 offen offset:2432 sc1
buffer_load_dword v16, v30, s[4:7], s44 offen offset:0 sc1
buffer_load_dword v17, v30, s[4:7], s44 offen offset:512 sc1
buffer_load_dword v19, v30, s[4:7], s44 offen offset:1536 sc1
s_waitcnt vmcnt(21)
v_add_f32 v96, v96, v97
s_waitcnt vmcnt(20)
v_add_f32 v96, v96, v98
s_waitcnt vmcnt(19)
v_add_f32 v96, v96, v99
s_waitcnt vmcnt(18)
v_add_f32 v96, v96, v100
s_waitcnt vmcnt(17)
v_add_f32 v96, v96, v101
s_waitcnt vmcnt(16)
v_add_f32 v96, v96, v102
s_waitcnt vmcnt(15)
v_add_f32 v96, v96, v103
s_waitcnt vmcnt(14)
v_add_f32 v96, v96, v104
s_waitcnt vmcnt(13)
v_add_f32 v96, v96, v105
s_waitcnt vmcnt(12)
v_add_f32 v96, v96, v106
s_waitcnt vmcnt(11)
v_add_f32 v96, v96, v107
s_waitcnt vmcnt(10)
v_add_f32 v96, v96, v108
s_waitcnt vmcnt(9)
v_add_f32 v96, v96, v109
s_waitcnt vmcnt(8)
v_add_f32 v96, v96, v110
s_waitcnt vmcnt(7)
v_add_f32 v96, v96, v111
s_waitcnt vmcnt(6)
v_add_f32 v96, v96, v20
s_waitcnt vmcnt(5)
v_add_f32 v96, v96, v21
s_waitcnt vmcnt(4)
v_add_f32 v96, v96, v22
s_waitcnt vmcnt(3)
v_add_f32 v96, v96, v23
v_cmp_u_f32 vcc, v96, v96
v_fma_f32 v96, v96, s49, v27
s_cbranch_vccz k_psd_59
s_sub_u32 s32, s32, 1
s_cmp_gt_i32 s32, 0
s_cbranch_scc1 k_ps_58
k_psd_59:
v_rsq_f32 v96, v96
s_add_u32 s45, s45, 20480
ds_write_b32 v24, v96 offset:58368
s_branch k_pyd_61
k_py_60:
buffer_load_dword v16, v30, s[4:7], s44 offen offset:0 sc1
buffer_load_dword v17, v30, s[4:7], s44 offen offset:512 sc1
buffer_load_dword v19, v30, s[4:7], s44 offen offset:1536 sc1
s_sub_u32 s32, s32, 1
k_pyd_61:
s_waitcnt vmcnt(0)
v_max3_u32 v20, v16, v17, v19
v_cmp_eq_u32 vcc, -1, v20
s_cmp_gt_i32 s32, 0
s_cselect_b64 vcc, vcc, 0
s_cbranch_vccnz k_py_60
s_add_u32 s44, s44, 4096
s_waitcnt lgkmcnt(0)
s_barrier
ds_read_b128 v[12:15], v0 offset:58368
v_lshlrev_b32 v156, 16, v16
v_and_b32 v140, 0xffff0000, v16
v_lshlrev_b32 v157, 16, v17
v_and_b32 v141, 0xffff0000, v17
v_lshlrev_b32 v158, 16, v18
v_and_b32 v142, 0xffff0000, v18
v_lshlrev_b32 v159, 16, v19
v_and_b32 v143, 0xffff0000, v19
s_waitcnt lgkmcnt(0)
v_mul_f32 v8, v12, v156
v_mul_f32 v12, v12, v140
v_cvt_pk_bf16_f32 v8, v8, v12
v_and_b32 v8, s47, v8
v_mul_f32 v9, v13, v157
v_mul_f32 v13, v13, v141
v_cvt_pk_bf16_f32 v9, v9, v13
v_and_b32 v9, s47, v9
v_mul_f32 v10, v14, v158
v_mul_f32 v14, v14, v142
v_cvt_pk_bf16_f32 v10, v10, v14
v_and_b32 v10, s47, v10
v_mul_f32 v11, v15, v159
v_mul_f32 v15, v15, v143
v_cvt_pk_bf16_f32 v11, v11, v15
v_and_b32 v11, s47, v11
s_nop 1
v_mfma_f32_32x32x16_bf16 v[32:47], v[8:11], v[112:115], v[32:47]
v_mfma_f32_32x32x16_bf16 v[48:63], v[8:11], v[116:119], v[48:63]
v_mfma_f32_32x32x16_bf16 v[64:79], v[8:11], v[120:123], v[64:79]
v_mfma_f32_32x32x16_bf16 v[80:95], v[8:11], v[124:127], v[80:95]
ds_read_b128 v[112:115], v0 offset:16384
ds_read_b128 v[116:119], v0 offset:17408
ds_read_b128 v[120:123], v0 offset:18432
ds_read_b128 v[124:127], v0 offset:19456
k_pr_62:
buffer_load_dword v18, v30, s[4:7], s44 offen offset:1024 sc1
s_waitcnt vmcnt(0)
v_cmp_eq_u32 vcc, -1, v18
s_cbranch_vccz k_prd_63
s_sleep 8
s_sub_u32 s32, s32, 1
s_cmp_gt_i32 s32, 0
s_cbranch_scc1 k_pr_62
k_prd_63:
k_ps_64:
buffer_load_dword v96, v31, s[4:7], s45 offen offset:0 sc1
buffer_load_dword v97, v31, s[4:7], s45 offen offset:128 sc1
buffer_load_dword v98, v31, s[4:7], s45 offen offset:256 sc1
buffer_load_dword v99, v31, s[4:7], s45 offen offset:384 sc1
buffer_load_dword v100, v31, s[4:7], s45 offen offset:512 sc1
buffer_load_dword v101, v31, s[4:7], s45 offen offset:640 sc1
buffer_load_dword v102, v31, s[4:7], s45 offen offset:768 sc1
buffer_load_dword v103, v31, s[4:7], s45 offen offset:896 sc1
buffer_load_dword v104, v31, s[4:7], s45 offen offset:1024 sc1
buffer_load_dword v105, v31, s[4:7], s45 offen offset:1152 sc1
buffer_load_dword v106, v31, s[4:7], s45 offen offset:1280 sc1
buffer_load_dword v107, v31, s[4:7], s45 offen offset:1408 sc1
buffer_load_dword v108, v31, s[4:7], s45 offen offset:1536 sc1
buffer_load_dword v109, v31, s[4:7], s45 offen offset:1664 sc1
buffer_load_dword v110, v31, s[4:7], s45 offen offset:1792 sc1
buffer_load_dword v111, v31, s[4:7], s45 offen offset:1920 sc1
buffer_load_dword v20, v31, s[4:7], s45 offen offset:2048 sc1
buffer_load_dword v21, v31, s[4:7], s45 offen offset:2176 sc1
buffer_load_dword v22, v31, s[4:7], s45 offen offset:2304 sc1
buffer_load_dword v23, v31, s[4:7], s45 offen offset:2432 sc1
buffer_load_dword v16, v30, s[4:7], s44 offen offset:0 sc1
buffer_load_dword v17, v30, s[4:7], s44 offen offset:512 sc1
buffer_load_dword v19, v30, s[4:7], s44 offen offset:1536 sc1
s_waitcnt vmcnt(21)
v_add_f32 v96, v96, v97
s_waitcnt vmcnt(20)
v_add_f32 v96, v96, v98
s_waitcnt vmcnt(19)
v_add_f32 v96, v96, v99
s_waitcnt vmcnt(18)
v_add_f32 v96, v96, v100
s_waitcnt vmcnt(17)
v_add_f32 v96, v96, v101
s_waitcnt vmcnt(16)
v_add_f32 v96, v96, v102
s_waitcnt vmcnt(15)
v_add_f32 v96, v96, v103
s_waitcnt vmcnt(14)
v_add_f32 v96, v96, v104
s_waitcnt vmcnt(13)
v_add_f32 v96, v96, v105
s_waitcnt vmcnt(12)
v_add_f32 v96, v96, v106
s_waitcnt vmcnt(11)
v_add_f32 v96, v96, v107
s_waitcnt vmcnt(10)
v_add_f32 v96, v96, v108
s_waitcnt vmcnt(9)
v_add_f32 v96, v96, v109
s_waitcnt vmcnt(8)
v_add_f32 v96, v96, v110
s_waitcnt vmcnt(7)
v_add_f32 v96, v96, v111
s_waitcnt vmcnt(6)
v_add_f32 v96, v96, v20
s_waitcnt vmcnt(5)
v_add_f32 v96, v96, v21
s_waitcnt vmcnt(4)
v_add_f32 v96, v96, v22
s_waitcnt vmcnt(3)
v_add_f32 v96, v96, v23
v_cmp_u_f32 vcc, v96, v96
v_fma_f32 v96, v96, s49, v27
s_cbranch_vccz k_psd_65
s_sub_u32 s32, s32, 1
s_cmp_gt_i32 s32, 0
s_cbranch_scc1 k_ps_64
k_psd_65:
v_rsq_f32 v96, v96
s_add_u32 s45, s45, 20480
ds_write_b32 v24, v96 offset:57344
s_branch k_pyd_67
k_py_66:
buffer_load_dword v16, v30, s[4:7], s44 offen offset:0 sc1
buffer_load_dword v17, v30, s[4:7], s44 offen offset:512 sc1
buffer_load_dword v19, v30, s[4:7], s44 offen offset:1536 sc1
s_sub_u32 s32, s32, 1
k_pyd_67:
s_waitcnt vmcnt(0)
v_max3_u32 v20, v16, v17, v19
v_cmp_eq_u32 vcc, -1, v20
s_cmp_gt_i32 s32, 0
s_cselect_b64 vcc, vcc, 0
s_cbranch_vccnz k_py_66
s_add_u32 s44, s44, 4096
s_waitcnt lgkmcnt(0)
s_barrier
ds_read_b128 v[12:15], v0 offset:57344
v_lshlrev_b32 v176, 16, v16
v_and_b32 v160, 0xffff0000, v16
v_lshlrev_b32 v177, 16, v17
v_and_b32 v161, 0xffff0000, v17
v_lshlrev_b32 v178, 16, v18
v_and_b32 v162, 0xffff0000, v18
v_lshlrev_b32 v179, 16, v19
v_and_b32 v163, 0xffff0000, v19
s_waitcnt lgkmcnt(0)
v_mul_f32 v8, v12, v176
v_mul_f32 v12, v12, v160
v_cvt_pk_bf16_f32 v8, v8, v12
v_and_b32 v8, s47, v8
v_mul_f32 v9, v13, v177
v_mul_f32 v13, v13, v161
v_cvt_pk_bf16_f32 v9, v9, v13
v_and_b32 v9, s47, v9
v_mul_f32 v10, v14, v178
v_mul_f32 v14, v14, v162
v_cvt_pk_bf16_f32 v10, v10, v14
v_and_b32 v10, s47, v10
v_mul_f32 v11, v15, v179
v_mul_f32 v15, v15, v163
v_cvt_pk_bf16_f32 v11, v11, v15
v_and_b32 v11, s47, v11
s_nop 1
v_mfma_f32_32x32x16_bf16 v[32:47], v[8:11], v[112:115], v[32:47]
v_mfma_f32_32x32x16_bf16 v[48:63], v[8:11], v[116:119], v[48:63]
v_mfma_f32_32x32x16_bf16 v[64:79], v[8:11], v[120:123], v[64:79]
v_mfma_f32_32x32x16_bf16 v[80:95], v[8:11], v[124:127], v[80:95]
ds_read_b128 v[112:115], v0 offset:20480
ds_read_b128 v[116:119], v0 offset:21504
ds_read_b128 v[120:123], v0 offset:22528
ds_read_b128 v[124:127], v0 offset:23552
k_pr_68:
buffer_load_dword v18, v30, s[4:7], s44 offen offset:1024 sc1
s_waitcnt vmcnt(0)
v_cmp_eq_u32 vcc, -1, v18
s_cbranch_vccz k_prd_69
s_sleep 8
s_sub_u32 s32, s32, 1
s_cmp_gt_i32 s32, 0
s_cbranch_scc1 k_pr_68
k_prd_69:
k_ps_70:
buffer_load_dword v96, v31, s[4:7], s45 offen offset:0 sc1
buffer_load_dword v97, v31, s[4:7], s45 offen offset:128 sc1
buffer_load_dword v98, v31, s[4:7], s45 offen offset:256 sc1
buffer_load_dword v99, v31, s[4:7], s45 offen offset:384 sc1
buffer_load_dword v100, v31, s[4:7], s45 offen offset:512 sc1
buffer_load_dword v101, v31, s[4:7], s45 offen offset:640 sc1
buffer_load_dword v102, v31, s[4:7], s45 offen offset:768 sc1
buffer_load_dword v103, v31, s[4:7], s45 offen offset:896 sc1
buffer_load_dword v104, v31, s[4:7], s45 offen offset:1024 sc1
buffer_load_dword v105, v31, s[4:7], s45 offen offset:1152 sc1
buffer_load_dword v106, v31, s[4:7], s45 offen offset:1280 sc1
buffer_load_dword v107, v31, s[4:7], s45 offen offset:1408 sc1
buffer_load_dword v108, v31, s[4:7], s45 offen offset:1536 sc1
buffer_load_dword v109, v31, s[4:7], s45 offen offset:1664 sc1
buffer_load_dword v110, v31, s[4:7], s45 offen offset:1792 sc1
buffer_load_dword v111, v31, s[4:7], s45 offen offset:1920 sc1
buffer_load_dword v20, v31, s[4:7], s45 offen offset:2048 sc1
buffer_load_dword v21, v31, s[4:7], s45 offen offset:2176 sc1
buffer_load_dword v22, v31, s[4:7], s45 offen offset:2304 sc1
buffer_load_dword v23, v31, s[4:7], s45 offen offset:2432 sc1
buffer_load_dword v16, v30, s[4:7], s44 offen offset:0 sc1
buffer_load_dword v17, v30, s[4:7], s44 offen offset:512 sc1
buffer_load_dword v19, v30, s[4:7], s44 offen offset:1536 sc1
s_waitcnt vmcnt(21)
v_add_f32 v96, v96, v97
s_waitcnt vmcnt(20)
v_add_f32 v96, v96, v98
s_waitcnt vmcnt(19)
v_add_f32 v96, v96, v99
s_waitcnt vmcnt(18)
v_add_f32 v96, v96, v100
s_waitcnt vmcnt(17)
v_add_f32 v96, v96, v101
s_waitcnt vmcnt(16)
v_add_f32 v96, v96, v102
s_waitcnt vmcnt(15)
v_add_f32 v96, v96, v103
s_waitcnt vmcnt(14)
v_add_f32 v96, v96, v104
s_waitcnt vmcnt(13)
v_add_f32 v96, v96, v105
s_waitcnt vmcnt(12)
v_add_f32 v96, v96, v106
s_waitcnt vmcnt(11)
v_add_f32 v96, v96, v107
s_waitcnt vmcnt(10)
v_add_f32 v96, v96, v108
s_waitcnt vmcnt(9)
v_add_f32 v96, v96, v109
s_waitcnt vmcnt(8)
v_add_f32 v96, v96, v110
s_waitcnt vmcnt(7)
v_add_f32 v96, v96, v111
s_waitcnt vmcnt(6)
v_add_f32 v96, v96, v20
s_waitcnt vmcnt(5)
v_add_f32 v96, v96, v21
s_waitcnt vmcnt(4)
v_add_f32 v96, v96, v22
s_waitcnt vmcnt(3)
v_add_f32 v96, v96, v23
v_cmp_u_f32 vcc, v96, v96
v_fma_f32 v96, v96, s49, v27
s_cbranch_vccz k_psd_71
s_sub_u32 s32, s32, 1
s_cmp_gt_i32 s32, 0
s_cbranch_scc1 k_ps_70
k_psd_71:
v_rsq_f32 v96, v96
s_add_u32 s45, s45, 20480
ds_write_b32 v24, v96 offset:58368
s_branch k_pyd_73
k_py_72:
buffer_load_dword v16, v30, s[4:7], s44 offen offset:0 sc1
buffer_load_dword v17, v30, s[4:7], s44 offen offset:512 sc1
buffer_load_dword v19, v30, s[4:7], s44 offen offset:1536 sc1
s_sub_u32 s32, s32, 1
k_pyd_73:
s_waitcnt vmcnt(0)
v_max3_u32 v20, v16, v17, v19
v_cmp_eq_u32 vcc, -1, v20
s_cmp_gt_i32 s32, 0
s_cselect_b64 vcc, vcc, 0
s_cbranch_vccnz k_py_72
s_add_u32 s44, s44, 4096
s_waitcnt lgkmcnt(0)
s_barrier
ds_read_b128 v[12:15], v0 offset:58368
v_lshlrev_b32 v180, 16, v16
v_and_b32 v164, 0xffff0000, v16
v_lshlrev_b32 v181, 16, v17
v_and_b32 v165, 0xffff0000, v17
v_lshlrev_b32 v182, 16, v18
v_and_b32 v166, 0xffff0000, v18
v_lshlrev_b32 v183, 16, v19
v_and_b32 v167, 0xffff0000, v19
s_waitcnt lgkmcnt(0)
v_mul_f32 v8, v12, v180
v_mul_f32 v12, v12, v164
v_cvt_pk_bf16_f32 v8, v8, v12
v_and_b32 v8, s47, v8
v_mul_f32 v9, v13, v181
v_mul_f32 v13, v13, v165
v_cvt_pk_bf16_f32 v9, v9, v13
v_and_b32 v9, s47, v9
v_mul_f32 v10, v14, v182
v_mul_f32 v14, v14, v166
v_cvt_pk_bf16_f32 v10, v10, v14
v_and_b32 v10, s47, v10
v_mul_f32 v11, v15, v183
v_mul_f32 v15, v15, v167
v_cvt_pk_bf16_f32 v11, v11, v15
v_and_b32 v11, s47, v11
s_nop 1
v_mfma_f32_32x32x16_bf16 v[32:47], v[8:11], v[112:115], v[32:47]
v_mfma_f32_32x32x16_bf16 v[48:63], v[8:11], v[116:119], v[48:63]
v_mfma_f32_32x32x16_bf16 v[64:79], v[8:11], v[120:123], v[64:79]
v_mfma_f32_32x32x16_bf16 v[80:95], v[8:11], v[124:127], v[80:95]
ds_read_b128 v[112:115], v0 offset:24576
ds_read_b128 v[116:119], v0 offset:25600
ds_read_b128 v[120:123], v0 offset:26624
ds_read_b128 v[124:127], v0 offset:27648
k_pr_74:
buffer_load_dword v18, v30, s[4:7], s44 offen offset:1024 sc1
s_waitcnt vmcnt(0)
v_cmp_eq_u32 vcc, -1, v18
s_cbranch_vccz k_prd_75
s_sleep 8
s_sub_u32 s32, s32, 1
s_cmp_gt_i32 s32, 0
s_cbranch_scc1 k_pr_74
k_prd_75:
k_ps_76:
buffer_load_dword v96, v31, s[4:7], s45 offen offset:0 sc1
buffer_load_dword v97, v31, s[4:7], s45 offen offset:128 sc1
buffer_load_dword v98, v31, s[4:7], s45 offen offset:256 sc1
buffer_load_dword v99, v31, s[4:7], s45 offen offset:384 sc1
buffer_load_dword v100, v31, s[4:7], s45 offen offset:512 sc1
buffer_load_dword v101, v31, s[4:7], s45 offen offset:640 sc1
buffer_load_dword v102, v31, s[4:7], s45 offen offset:768 sc1
buffer_load_dword v103, v31, s[4:7], s45 offen offset:896 sc1
buffer_load_dword v104, v31, s[4:7], s45 offen offset:1024 sc1
buffer_load_dword v105, v31, s[4:7], s45 offen offset:1152 sc1
buffer_load_dword v106, v31, s[4:7], s45 offen offset:1280 sc1
buffer_load_dword v107, v31, s[4:7], s45 offen offset:1408 sc1
buffer_load_dword v108, v31, s[4:7], s45 offen offset:1536 sc1
buffer_load_dword v109, v31, s[4:7], s45 offen offset:1664 sc1
buffer_load_dword v110, v31, s[4:7], s45 offen offset:1792 sc1
buffer_load_dword v111, v31, s[4:7], s45 offen offset:1920 sc1
buffer_load_dword v20, v31, s[4:7], s45 offen offset:2048 sc1
buffer_load_dword v21, v31, s[4:7], s45 offen offset:2176 sc1
buffer_load_dword v22, v31, s[4:7], s45 offen offset:2304 sc1
buffer_load_dword v23, v31, s[4:7], s45 offen offset:2432 sc1
buffer_load_dword v16, v30, s[4:7], s44 offen offset:0 sc1
buffer_load_dword v17, v30, s[4:7], s44 offen offset:512 sc1
buffer_load_dword v19, v30, s[4:7], s44 offen offset:1536 sc1
s_waitcnt vmcnt(21)
v_add_f32 v96, v96, v97
s_waitcnt vmcnt(20)
v_add_f32 v96, v96, v98
s_waitcnt vmcnt(19)
v_add_f32 v96, v96, v99
s_waitcnt vmcnt(18)
v_add_f32 v96, v96, v100
s_waitcnt vmcnt(17)
v_add_f32 v96, v96, v101
s_waitcnt vmcnt(16)
v_add_f32 v96, v96, v102
s_waitcnt vmcnt(15)
v_add_f32 v96, v96, v103
s_waitcnt vmcnt(14)
v_add_f32 v96, v96, v104
s_waitcnt vmcnt(13)
v_add_f32 v96, v96, v105
s_waitcnt vmcnt(12)
v_add_f32 v96, v96, v106
s_waitcnt vmcnt(11)
v_add_f32 v96, v96, v107
s_waitcnt vmcnt(10)
v_add_f32 v96, v96, v108
s_waitcnt vmcnt(9)
v_add_f32 v96, v96, v109
s_waitcnt vmcnt(8)
v_add_f32 v96, v96, v110
s_waitcnt vmcnt(7)
v_add_f32 v96, v96, v111
s_waitcnt vmcnt(6)
v_add_f32 v96, v96, v20
s_waitcnt vmcnt(5)
v_add_f32 v96, v96, v21
s_waitcnt vmcnt(4)
v_add_f32 v96, v96, v22
s_waitcnt vmcnt(3)
v_add_f32 v96, v96, v23
v_cmp_u_f32 vcc, v96, v96
v_fma_f32 v96, v96, s49, v27
s_cbranch_vccz k_psd_77
s_sub_u32 s32, s32, 1
s_cmp_gt_i32 s32, 0
s_cbranch_scc1 k_ps_76
k_psd_77:
v_rsq_f32 v96, v96
s_add_u32 s45, s45, 20480
ds_write_b32 v24, v96 offset:57344
s_branch k_pyd_79
k_py_78:
buffer_load_dword v16, v30, s[4:7], s44 offen offset:0 sc1
buffer_load_dword v17, v30, s[4:7], s44 offen offset:512 sc1
buffer_load_dword v19, v30, s[4:7], s44 offen offset:1536 sc1
s_sub_u32 s32, s32, 1
k_pyd_79:
s_waitcnt vmcnt(0)
v_max3_u32 v20, v16, v17, v19
v_cmp_eq_u32 vcc, -1, v20
s_cmp_gt_i32 s32, 0
s_cselect_b64 vcc, vcc, 0
s_cbranch_vccnz k_py_78
s_add_u32 s44, s44, 4096
s_waitcnt lgkmcnt(0)
s_barrier
ds_read_b128 v[12:15], v0 offset:57344
v_lshlrev_b32 v184, 16, v16
v_and_b32 v168, 0xffff0000, v16
v_lshlrev_b32 v185, 16, v17
v_and_b32 v169, 0xffff0000, v17
v_lshlrev_b32 v186, 16, v18
v_and_b32 v170, 0xffff0000, v18
v_lshlrev_b32 v187, 16, v19
v_and_b32 v171, 0xffff0000, v19
s_waitcnt lgkmcnt(0)
v_mul_f32 v8, v12, v184
v_mul_f32 v12, v12, v168
v_cvt_pk_bf16_f32 v8, v8, v12
v_and_b32 v8, s47, v8
v_mul_f32 v9, v13, v185
v_mul_f32 v13, v13, v169
v_cvt_pk_bf16_f32 v9, v9, v13
v_and_b32 v9, s47, v9
v_mul_f32 v10, v14, v186
v_mul_f32 v14, v14, v170
v_cvt_pk_bf16_f32 v10, v10, v14
v_and_b32 v10, s47, v10
v_mul_f32 v11, v15, v187
v_mul_f32 v15, v15, v171
v_cvt_pk_bf16_f32 v11, v11, v15
v_and_b32 v11, s47, v11
s_nop 1
v_mfma_f32_32x32x16_bf16 v[32:47], v[8:11], v[112:115], v[32:47]
v_mfma_f32_32x32x16_bf16 v[48:63], v[8:11], v[116:119], v[48:63]
v_mfma_f32_32x32x16_bf16 v[64:79], v[8:11], v[120:123], v[64:79]
v_mfma_f32_32x32x16_bf16 v[80:95], v[8:11], v[124:127], v[80:95]
ds_read_b128 v[112:115], v0 offset:28672
ds_read_b128 v[116:119], v0 offset:29696
ds_read_b128 v[120:123], v0 offset:30720
ds_read_b128 v[124:127], v0 offset:31744
k_pr_80:
buffer_load_dword v18, v30, s[4:7], s44 offen offset:1024 sc1
s_waitcnt vmcnt(0)
v_cmp_eq_u32 vcc, -1, v18
s_cbranch_vccz k_prd_81
s_sleep 8
s_sub_u32 s32, s32, 1
s_cmp_gt_i32 s32, 0
s_cbranch_scc1 k_pr_80
k_prd_81:
k_ps_82:
buffer_load_dword v96, v31, s[4:7], s45 offen offset:0 sc1
buffer_load_dword v97, v31, s[4:7], s45 offen offset:128 sc1
buffer_load_dword v98, v31, s[4:7], s45 offen offset:256 sc1
buffer_load_dword v99, v31, s[4:7], s45 offen offset:384 sc1
buffer_load_dword v100, v31, s[4:7], s45 offen offset:512 sc1
buffer_load_dword v101, v31, s[4:7], s45 offen offset:640 sc1
buffer_load_dword v102, v31, s[4:7], s45 offen offset:768 sc1
buffer_load_dword v103, v31, s[4:7], s45 offen offset:896 sc1
buffer_load_dword v104, v31, s[4:7], s45 offen offset:1024 sc1
buffer_load_dword v105, v31, s[4:7], s45 offen offset:1152 sc1
buffer_load_dword v106, v31, s[4:7], s45 offen offset:1280 sc1
buffer_load_dword v107, v31, s[4:7], s45 offen offset:1408 sc1
buffer_load_dword v108, v31, s[4:7], s45 offen offset:1536 sc1
buffer_load_dword v109, v31, s[4:7], s45 offen offset:1664 sc1
buffer_load_dword v110, v31, s[4:7], s45 offen offset:1792 sc1
buffer_load_dword v111, v31, s[4:7], s45 offen offset:1920 sc1
buffer_load_dword v20, v31, s[4:7], s45 offen offset:2048 sc1
buffer_load_dword v21, v31, s[4:7], s45 offen offset:2176 sc1
buffer_load_dword v22, v31, s[4:7], s45 offen offset:2304 sc1
buffer_load_dword v23, v31, s[4:7], s45 offen offset:2432 sc1
buffer_load_dword v16, v30, s[4:7], s44 offen offset:0 sc1
buffer_load_dword v17, v30, s[4:7], s44 offen offset:512 sc1
buffer_load_dword v19, v30, s[4:7], s44 offen offset:1536 sc1
s_waitcnt vmcnt(21)
v_add_f32 v96, v96, v97
s_waitcnt vmcnt(20)
v_add_f32 v96, v96, v98
s_waitcnt vmcnt(19)
v_add_f32 v96, v96, v99
s_waitcnt vmcnt(18)
v_add_f32 v96, v96, v100
s_waitcnt vmcnt(17)
v_add_f32 v96, v96, v101
s_waitcnt vmcnt(16)
v_add_f32 v96, v96, v102
s_waitcnt vmcnt(15)
v_add_f32 v96, v96, v103
s_waitcnt vmcnt(14)
v_add_f32 v96, v96, v104
s_waitcnt vmcnt(13)
v_add_f32 v96, v96, v105
s_waitcnt vmcnt(12)
v_add_f32 v96, v96, v106
s_waitcnt vmcnt(11)
v_add_f32 v96, v96, v107
s_waitcnt vmcnt(10)
v_add_f32 v96, v96, v108
s_waitcnt vmcnt(9)
v_add_f32 v96, v96, v109
s_waitcnt vmcnt(8)
v_add_f32 v96, v96, v110
s_waitcnt vmcnt(7)
v_add_f32 v96, v96, v111
s_waitcnt vmcnt(6)
v_add_f32 v96, v96, v20
s_waitcnt vmcnt(5)
v_add_f32 v96, v96, v21
s_waitcnt vmcnt(4)
v_add_f32 v96, v96, v22
s_waitcnt vmcnt(3)
v_add_f32 v96, v96, v23
v_cmp_u_f32 vcc, v96, v96
v_fma_f32 v96, v96, s49, v27
s_cbranch_vccz k_psd_83
s_sub_u32 s32, s32, 1
s_cmp_gt_i32 s32, 0
s_cbranch_scc1 k_ps_82
k_psd_83:
v_rsq_f32 v96, v96
s_add_u32 s45, s45, 20480
ds_write_b32 v24, v96 offset:58368
s_branch k_pyd_85
k_py_84:
buffer_load_dword v16, v30, s[4:7], s44 offen offset:0 sc1
buffer_load_dword v17, v30, s[4:7], s44 offen offset:512 sc1
buffer_load_dword v19, v30, s[4:7], s44 offen offset:1536 sc1
s_sub_u32 s32, s32, 1
k_pyd_85:
s_waitcnt vmcnt(0)
v_max3_u32 v20, v16, v17, v19
v_cmp_eq_u32 vcc, -1, v20
s_cmp_gt_i32 s32, 0
s_cselect_b64 vcc, vcc, 0
s_cbranch_vccnz k_py_84
s_add_u32 s44, s44, 4096
s_waitcnt lgkmcnt(0)
s_barrier
ds_read_b128 v[12:15], v0 offset:58368
v_lshlrev_b32 v188, 16, v16
v_and_b32 v172, 0xffff0000, v16
v_lshlrev_b32 v189, 16, v17
v_and_b32 v173, 0xffff0000, v17
v_lshlrev_b32 v190, 16, v18
v_and_b32 v174, 0xffff0000, v18
v_lshlrev_b32 v191, 16, v19
v_and_b32 v175, 0xffff0000, v19
s_waitcnt lgkmcnt(0)
v_mul_f32 v8, v12, v188
v_mul_f32 v12, v12, v172
v_cvt_pk_bf16_f32 v8, v8, v12
v_and_b32 v8, s47, v8
v_mul_f32 v9, v13, v189
v_mul_f32 v13, v13, v173
v_cvt_pk_bf16_f32 v9, v9, v13
v_and_b32 v9, s47, v9
v_mul_f32 v10, v14, v190
v_mul_f32 v14, v14, v174
v_cvt_pk_bf16_f32 v10, v10, v14
v_and_b32 v10, s47, v10
v_mul_f32 v11, v15, v191
v_mul_f32 v15, v15, v175
v_cvt_pk_bf16_f32 v11, v11, v15
v_and_b32 v11, s47, v11
s_nop 1
v_mfma_f32_32x32x16_bf16 v[32:47], v[8:11], v[112:115], v[32:47]
v_mfma_f32_32x32x16_bf16 v[48:63], v[8:11], v[116:119], v[48:63]
v_mfma_f32_32x32x16_bf16 v[64:79], v[8:11], v[120:123], v[64:79]
v_mfma_f32_32x32x16_bf16 v[80:95], v[8:11], v[124:127], v[80:95]
ds_read_b128 v[112:115], v0 offset:32768
ds_read_b128 v[116:119], v0 offset:33792
ds_read_b128 v[120:123], v0 offset:34816
ds_read_b128 v[124:127], v0 offset:35840
s_waitcnt lgkmcnt(3)
v_mul_f32 v8, v32, v112
v_mul_f32 v9, v48, v112
s_waitcnt lgkmcnt(2)
v_fmac_f32 v8, v48, v116
v_fma_f32 v9, -v32, v116, v9
v_cvt_pk_bf16_f32 v32, v8, v9
v_mul_f32 v10, v33, v113
v_mul_f32 v11, v49, v113
v_fmac_f32 v10, v49, v117
v_fma_f32 v11, -v33, v117, v11
v_cvt_pk_bf16_f32 v33, v10, v11
v_mul_f32 v8, v34, v114
v_mul_f32 v9, v50, v114
v_fmac_f32 v8, v50, v118
v_fma_f32 v9, -v34, v118, v9
v_cvt_pk_bf16_f32 v34, v8, v9
v_mul_f32 v10, v35, v115
v_mul_f32 v11, v51, v115
v_fmac_f32 v10, v51, v119
v_fma_f32 v11, -v35, v119, v11
v_cvt_pk_bf16_f32 v35, v10, v11
ds_read_b128 v[112:115], v0 offset:36864
ds_read_b128 v[116:119], v0 offset:37888
s_waitcnt lgkmcnt(3)
v_mul_f32 v8, v36, v120
v_mul_f32 v9, v52, v120
s_waitcnt lgkmcnt(2)
v_fmac_f32 v8, v52, v124
v_fma_f32 v9, -v36, v124, v9
v_cvt_pk_bf16_f32 v36, v8, v9
v_mul_f32 v10, v37, v121
v_mul_f32 v11, v53, v121
v_fmac_f32 v10, v53, v125
v_fma_f32 v11, -v37, v125, v11
v_cvt_pk_bf16_f32 v37, v10, v11
v_mul_f32 v8, v38, v122
v_mul_f32 v9, v54, v122
v_fmac_f32 v8, v54, v126
v_fma_f32 v9, -v38, v126, v9
v_cvt_pk_bf16_f32 v38, v8, v9
v_mul_f32 v10, v39, v123
v_mul_f32 v11, v55, v123
v_fmac_f32 v10, v55, v127
v_fma_f32 v11, -v39, v127, v11
v_cvt_pk_bf16_f32 v39, v10, v11
ds_read_b128 v[120:123], v0 offset:38912
ds_read_b128 v[124:127], v0 offset:39936
s_waitcnt lgkmcnt(3)
v_mul_f32 v8, v40, v112
v_mul_f32 v9, v56, v112
s_waitcnt lgkmcnt(2)
v_fmac_f32 v8, v56, v116
v_fma_f32 v9, -v40, v116, v9
v_cvt_pk_bf16_f32 v40, v8, v9
v_mul_f32 v10, v41, v113
v_mul_f32 v11, v57, v113
v_fmac_f32 v10, v57, v117
v_fma_f32 v11, -v41, v117, v11
v_cvt_pk_bf16_f32 v41, v10, v11
v_mul_f32 v8, v42, v114
v_mul_f32 v9, v58, v114
v_fmac_f32 v8, v58, v118
v_fma_f32 v9, -v42, v118, v9
v_cvt_pk_bf16_f32 v42, v8, v9
v_mul_f32 v10, v43, v115
v_mul_f32 v11, v59, v115
v_fmac_f32 v10, v59, v119
v_fma_f32 v11, -v43, v119, v11
v_cvt_pk_bf16_f32 v43, v10, v11
ds_read_b128 v[112:115], v0 offset:40960
ds_read_b128 v[116:119], v0 offset:41984
s_waitcnt lgkmcnt(3)
v_mul_f32 v8, v44, v120
v_mul_f32 v9, v60, v120
s_waitcnt lgkmcnt(2)
v_fmac_f32 v8, v60, v124
v_fma_f32 v9, -v44, v124, v9
v_cvt_pk_bf16_f32 v44, v8, v9
v_mul_f32 v10, v45, v121
v_mul_f32 v11, v61, v121
v_fmac_f32 v10, v61, v125
v_fma_f32 v11, -v45, v125, v11
v_cvt_pk_bf16_f32 v45, v10, v11
v_mul_f32 v8, v46, v122
v_mul_f32 v9, v62, v122
v_fmac_f32 v8, v62, v126
v_fma_f32 v9, -v46, v126, v9
v_cvt_pk_bf16_f32 v46, v8, v9
v_mul_f32 v10, v47, v123
v_mul_f32 v11, v63, v123
v_fmac_f32 v10, v63, v127
v_fma_f32 v11, -v47, v127, v11
v_cvt_pk_bf16_f32 v47, v10, v11
ds_read_b128 v[120:123], v0 offset:43008
ds_read_b128 v[124:127], v0 offset:44032
v_mfma_f32_32x32x16_bf16 v[48:63], a[160:163], v[32:35], 0
s_waitcnt lgkmcnt(3)
v_mul_f32 v8, v64, v112
v_mul_f32 v9, v80, v112
s_waitcnt lgkmcnt(2)
v_fmac_f32 v8, v80, v116
v_fma_f32 v9, -v64, v116, v9
v_cvt_pk_bf16_f32 v64, v8, v9
v_mul_f32 v10, v65, v113
v_mul_f32 v11, v81, v113
v_fmac_f32 v10, v81, v117
v_mfma_f32_32x32x16_bf16 v[96:111], a[164:167], v[32:35], 0
v_fma_f32 v11, -v65, v117, v11
v_cvt_pk_bf16_f32 v65, v10, v11
v_mul_f32 v8, v66, v114
v_mul_f32 v9, v82, v114
v_fmac_f32 v8, v82, v118
v_fma_f32 v9, -v66, v118, v9
v_cvt_pk_bf16_f32 v66, v8, v9
v_mul_f32 v10, v67, v115
v_mfma_f32_32x32x16_bf16 v[48:63], a[168:171], v[36:39], v[48:63]
v_mul_f32 v11, v83, v115
v_fmac_f32 v10, v83, v119
v_fma_f32 v11, -v67, v119, v11
v_cvt_pk_bf16_f32 v67, v10, v11
ds_read_b128 v[112:115], v0 offset:45056
ds_read_b128 v[116:119], v0 offset:46080
s_waitcnt lgkmcnt(3)
v_mul_f32 v8, v68, v120
v_mul_f32 v9, v84, v120
v_mfma_f32_32x32x16_bf16 v[96:111], a[172:175], v[36:39], v[96:111]
s_waitcnt lgkmcnt(2)
v_fmac_f32 v8, v84, v124
v_fma_f32 v9, -v68, v124, v9
v_cvt_pk_bf16_f32 v68, v8, v9
v_mul_f32 v10, v69, v121
v_mul_f32 v11, v85, v121
v_fmac_f32 v10, v85, v125
v_fma_f32 v11, -v69, v125, v11
v_cvt_pk_bf16_f32 v69, v10, v11
v_mfma_f32_32x32x16_bf16 v[48:63], a[176:179], v[40:43], v[48:63]
v_mul_f32 v8, v70, v122
v_mul_f32 v9, v86, v122
v_fmac_f32 v8, v86, v126
v_fma_f32 v9, -v70, v126, v9
v_cvt_pk_bf16_f32 v70, v8, v9
v_mul_f32 v10, v71, v123
v_mul_f32 v11, v87, v123
v_fmac_f32 v10, v87, v127
v_mfma_f32_32x32x16_bf16 v[96:111], a[180:183], v[40:43], v[96:111]
v_fma_f32 v11, -v71, v127, v11
v_cvt_pk_bf16_f32 v71, v10, v11
ds_read_b128 v[120:123], v0 offset:47104
ds_read_b128 v[124:127], v0 offset:48128
s_waitcnt lgkmcnt(3)
v_mul_f32 v8, v72, v112
v_mul_f32 v9, v88, v112
s_waitcnt lgkmcnt(2)
v_fmac_f32 v8, v88, v116
v_fma_f32 v9, -v72, v116, v9
v_mfma_f32_32x32x16_bf16 v[48:63], a[184:187], v[44:47], v[48:63]
v_cvt_pk_bf16_f32 v72, v8, v9
v_mul_f32 v10, v73, v113
v_mul_f32 v11, v89, v113
v_fmac_f32 v10, v89, v117
v_fma_f32 v11, -v73, v117, v11
v_cvt_pk_bf16_f32 v73, v10, v11
v_mul_f32 v8, v74, v114
v_mul_f32 v9, v90, v114
v_mfma_f32_32x32x16_bf16 v[96:111], a[188:191], v[44:47], v[96:111]
v_fmac_f32 v8, v90, v118
v_fma_f32 v9, -v74, v118, v9
v_cvt_pk_bf16_f32 v74, v8, v9
v_mul_f32 v10, v75, v115
v_mul_f32 v11, v91, v115
v_fmac_f32 v10, v91, v119
v_fma_f32 v11, -v75, v119, v11
v_cvt_pk_bf16_f32 v75, v10, v11
ds_read_b128 v[112:115], v0 offset:32768
ds_read_b128 v[116:119], v0 offset:33792
s_waitcnt lgkmcnt(3)
v_mul_f32 v8, v76, v120
v_mul_f32 v9, v92, v120
s_waitcnt lgkmcnt(2)
v_fmac_f32 v8, v92, v124
v_fma_f32 v9, -v76, v124, v9
v_cvt_pk_bf16_f32 v76, v8, v9
v_mul_f32 v10, v77, v121
v_mul_f32 v11, v93, v121
v_fmac_f32 v10, v93, v125
v_fma_f32 v11, -v77, v125, v11
v_cvt_pk_bf16_f32 v77, v10, v11
v_mul_f32 v8, v78, v122
v_mul_f32 v9, v94, v122
v_fmac_f32 v8, v94, v126
v_fma_f32 v9, -v78, v126, v9
v_cvt_pk_bf16_f32 v78, v8, v9
v_mul_f32 v10, v79, v123
v_mul_f32 v11, v95, v123
v_fmac_f32 v10, v95, v127
v_fma_f32 v11, -v79, v127, v11
v_cvt_pk_bf16_f32 v79, v10, v11
ds_read_b128 v[120:123], v0 offset:34816
ds_read_b128 v[124:127], v0 offset:35840
v_mfma_f32_32x32x16_bf16 v[80:95], a[160:163], v[64:67], 0
v_mul_f32 v8, v48, v208
v_mul_f32 v9, v96, v208
v_fmac_f32 v8, v96, v192
v_fma_f32 v9, v48, v192, -v9
v_cvt_pk_bf16_f32 v48, v8, v9
v_mul_f32 v10, v49, v209
v_mul_f32 v11, v97, v209
v_fmac_f32 v10, v97, v193
v_mfma_f32_32x32x16_bf16 v[32:47], a[164:167], v[64:67], 0
v_fma_f32 v11, v49, v193, -v11
v_cvt_pk_bf16_f32 v49, v10, v11
v_mul_f32 v8, v50, v210
v_mul_f32 v9, v98, v210
v_fmac_f32 v8, v98, v194
v_fma_f32 v9, v50, v194, -v9
v_cvt_pk_bf16_f32 v50, v8, v9
v_mul_f32 v10, v51, v211
v_mfma_f32_32x32x16_bf16 v[80:95], a[168:171], v[68:71], v[80:95]
v_mul_f32 v11, v99, v211
v_fmac_f32 v10, v99, v195
v_fma_f32 v11, v51, v195, -v11
v_cvt_pk_bf16_f32 v51, v10, v11
v_mul_f32 v8, v52, v212
v_mul_f32 v9, v100, v212
v_fmac_f32 v8, v100, v196
v_fma_f32 v9, v52, v196, -v9
v_mfma_f32_32x32x16_bf16 v[32:47], a[172:175], v[68:71], v[32:47]
v_cvt_pk_bf16_f32 v52, v8, v9
v_mul_f32 v10, v53, v213
v_mul_f32 v11, v101, v213
v_fmac_f32 v10, v101, v197
v_fma_f32 v11, v53, v197, -v11
v_cvt_pk_bf16_f32 v53, v10, v11
v_mul_f32 v8, v54, v214
v_mul_f32 v9, v102, v214
v_mfma_f32_32x32x16_bf16 v[80:95], a[176:179], v[72:75], v[80:95]
v_fmac_f32 v8, v102, v198
v_fma_f32 v9, v54, v198, -v9
v_cvt_pk_bf16_f32 v54, v8, v9
v_mul_f32 v10, v55, v215
v_mul_f32 v11, v103, v215
v_fmac_f32 v10, v103, v199
v_fma_f32 v11, v55, v199, -v11
v_cvt_pk_bf16_f32 v55, v10, v11
v_mfma_f32_32x32x16_bf16 v[32:47], a[180:183], v[72:75], v[32:47]
v_mul_f32 v8, v56, v216
v_mul_f32 v9, v104, v216
v_fmac_f32 v8, v104, v200
v_fma_f32 v9, v56, v200, -v9
v_cvt_pk_bf16_f32 v56, v8, v9
v_mul_f32 v10, v57, v217
v_mul_f32 v11, v105, v217
v_fmac_f32 v10, v105, v201
v_mfma_f32_32x32x16_bf16 v[80:95], a[184:187], v[76:79], v[80:95]
v_fma_f32 v11, v57, v201, -v11
v_cvt_pk_bf16_f32 v57, v10, v11
v_mul_f32 v8, v58, v218
v_mul_f32 v9, v106, v218
v_fmac_f32 v8, v106, v202
v_fma_f32 v9, v58, v202, -v9
v_cvt_pk_bf16_f32 v58, v8, v9
v_mul_f32 v10, v59, v219
v_mfma_f32_32x32x16_bf16 v[32:47], a[188:191], v[76:79], v[32:47]
v_mul_f32 v11, v107, v219
v_fmac_f32 v10, v107, v203
v_fma_f32 v11, v59, v203, -v11
v_cvt_pk_bf16_f32 v59, v10, v11
v_mul_f32 v8, v60, v220
v_mul_f32 v9, v108, v220
v_fmac_f32 v8, v108, v204
v_fma_f32 v9, v60, v204, -v9
v_cvt_pk_bf16_f32 v60, v8, v9
v_mul_f32 v10, v61, v221
v_mul_f32 v11, v109, v221
v_fmac_f32 v10, v109, v205
v_fma_f32 v11, v61, v205, -v11
v_cvt_pk_bf16_f32 v61, v10, v11
v_mul_f32 v8, v62, v222
v_mul_f32 v9, v110, v222
v_fmac_f32 v8, v110, v206
v_fma_f32 v9, v62, v206, -v9
v_cvt_pk_bf16_f32 v62, v8, v9
v_mul_f32 v10, v63, v223
v_mul_f32 v11, v111, v223
v_fmac_f32 v10, v111, v207
v_fma_f32 v11, v63, v207, -v11
v_cvt_pk_bf16_f32 v63, v10, v11
v_mfma_f32_32x32x16_bf16 v[96:111], v[48:51], a[160:163], 0
v_mul_f32 v8, v80, v240
v_mul_f32 v9, v32, v240
v_fmac_f32 v8, v32, v224
v_fma_f32 v9, v80, v224, -v9
v_cvt_pk_bf16_f32 v80, v8, v9
v_mul_f32 v10, v81, v241
v_mul_f32 v11, v33, v241
v_fmac_f32 v10, v33, v225
v_mfma_f32_32x32x16_bf16 v[64:79], v[48:51], a[164:167], 0
v_fma_f32 v11, v81, v225, -v11
v_cvt_pk_bf16_f32 v81, v10, v11
v_mul_f32 v8, v82, v242
v_mul_f32 v9, v34, v242
v_fmac_f32 v8, v34, v226
v_fma_f32 v9, v82, v226, -v9
v_cvt_pk_bf16_f32 v82, v8, v9
v_mul_f32 v10, v83, v243
v_mfma_f32_32x32x16_bf16 v[96:111], v[52:55], a[168:171], v[96:111]
v_mul_f32 v11, v35, v243
v_fmac_f32 v10, v35, v227
v_fma_f32 v11, v83, v227, -v11
v_cvt_pk_bf16_f32 v83, v10, v11
v_mul_f32 v8, v84, v244
v_mul_f32 v9, v36, v244
v_fmac_f32 v8, v36, v228
v_fma_f32 v9, v84, v228, -v9
v_mfma_f32_32x32x16_bf16 v[64:79], v[52:55], a[172:175], v[64:79]
v_cvt_pk_bf16_f32 v84, v8, v9
v_mul_f32 v10, v85, v245
v_mul_f32 v11, v37, v245
v_fmac_f32 v10, v37, v229
v_fma_f32 v11, v85, v229, -v11
v_cvt_pk_bf16_f32 v85, v10, v11
v_mul_f32 v8, v86, v246
v_mul_f32 v9, v38, v246
v_mfma_f32_32x32x16_bf16 v[96:111], v[56:59], a[176:179], v[96:111]
v_fmac_f32 v8, v38, v230
v_fma_f32 v9, v86, v230, -v9
v_cvt_pk_bf16_f32 v86, v8, v9
v_mul_f32 v10, v87, v247
v_mul_f32 v11, v39, v247
v_fmac_f32 v10, v39, v231
v_fma_f32 v11, v87, v231, -v11
v_cvt_pk_bf16_f32 v87, v10, v11
v_mfma_f32_32x32x16_bf16 v[64:79], v[56:59], a[180:183], v[64:79]
v_mul_f32 v8, v88, v248
v_mul_f32 v9, v40, v248
v_fmac_f32 v8, v40, v232
v_fma_f32 v9, v88, v232, -v9
v_cvt_pk_bf16_f32 v88, v8, v9
v_mul_f32 v10, v89, v249
v_mul_f32 v11, v41, v249
v_fmac_f32 v10, v41, v233
v_mfma_f32_32x32x16_bf16 v[96:111], v[60:63], a[184:187], v[96:111]
v_fma_f32 v11, v89, v233, -v11
v_cvt_pk_bf16_f32 v89, v10, v11
v_mul_f32 v8, v90, v250
v_mul_f32 v9, v42, v250
v_fmac_f32 v8, v42, v234
v_fma_f32 v9, v90, v234, -v9
v_cvt_pk_bf16_f32 v90, v8, v9
v_mul_f32 v10, v91, v251
v_mfma_f32_32x32x16_bf16 v[64:79], v[60:63], a[188:191], v[64:79]
v_mul_f32 v11, v43, v251
v_fmac_f32 v10, v43, v235
v_fma_f32 v11, v91, v235, -v11
v_cvt_pk_bf16_f32 v91, v10, v11
v_mul_f32 v8, v92, v252
v_mul_f32 v9, v44, v252
v_fmac_f32 v8, v44, v236
v_fma_f32 v9, v92, v236, -v9
v_cvt_pk_bf16_f32 v92, v8, v9
v_mul_f32 v10, v93, v253
v_mul_f32 v11, v45, v253
v_fmac_f32 v10, v45, v237
v_fma_f32 v11, v93, v237, -v11
v_cvt_pk_bf16_f32 v93, v10, v11
v_mul_f32 v8, v94, v254
v_mul_f32 v9, v46, v254
v_fmac_f32 v8, v46, v238
v_fma_f32 v9, v94, v238, -v9
v_cvt_pk_bf16_f32 v94, v8, v9
v_mul_f32 v10, v95, v255
v_mul_f32 v11, v47, v255
v_fmac_f32 v10, v47, v239
v_fma_f32 v11, v95, v239, -v11
v_cvt_pk_bf16_f32 v95, v10, v11
v_mfma_f32_32x32x16_bf16 v[32:47], v[80:83], a[160:163], 0
s_waitcnt lgkmcnt(3)
v_mul_f32 v8, v96, v112
v_mul_f32 v9, v64, v112
s_waitcnt lgkmcnt(2)
v_fmac_f32 v8, v64, v116
v_fma_f32 v9, -v96, v116, v9
v_cvt_pk_bf16_f32 v96, v8, v9
v_mul_f32 v10, v97, v113
v_mul_f32 v11, v65, v113
v_fmac_f32 v10, v65, v117
v_mfma_f32_32x32x16_bf16 v[48:63], v[80:83], a[164:167], 0
v_fma_f32 v11, -v97, v117, v11
v_cvt_pk_bf16_f32 v97, v10, v11
v_mul_f32 v8, v98, v114
v_mul_f32 v9, v66, v114
v_fmac_f32 v8, v66, v118
v_fma_f32 v9, -v98, v118, v9
v_cvt_pk_bf16_f32 v98, v8, v9
v_mul_f32 v10, v99, v115
v_mfma_f32_32x32x16_bf16 v[32:47], v[84:87], a[168:171], v[32:47]
v_mul_f32 v11, v67, v115
v_fmac_f32 v10, v67, v119
v_fma_f32 v11, -v99, v119, v11
v_cvt_pk_bf16_f32 v99, v10, v11
ds_read_b128 v[112:115], v0 offset:36864
ds_read_b128 v[116:119], v0 offset:37888
s_waitcnt lgkmcnt(3)
v_mul_f32 v8, v100, v120
v_mul_f32 v9, v68, v120
v_mfma_f32_32x32x16_bf16 v[48:63], v[84:87], a[172:175], v[48:63]
s_waitcnt lgkmcnt(2)
v_fmac_f32 v8, v68, v124
v_fma_f32 v9, -v100, v124, v9
v_cvt_pk_bf16_f32 v100, v8, v9
v_mul_f32 v10, v101, v121
v_mul_f32 v11, v69, v121
v_fmac_f32 v10, v69, v125
v_fma_f32 v11, -v101, v125, v11
v_cvt_pk_bf16_f32 v101, v10, v11
v_mfma_f32_32x32x16_bf16 v[32:47], v[88:91], a[176:179], v[32:47]
v_mul_f32 v8, v102, v122
v_mul_f32 v9, v70, v122
v_fmac_f32 v8, v70, v126
v_fma_f32 v9, -v102, v126, v9
v_cvt_pk_bf16_f32 v102, v8, v9
v_mul_f32 v10, v103, v123
v_mul_f32 v11, v71, v123
v_fmac_f32 v10, v71, v127
v_mfma_f32_32x32x16_bf16 v[48:63], v[88:91], a[180:183], v[48:63]
v_fma_f32 v11, -v103, v127, v11
v_cvt_pk_bf16_f32 v103, v10, v11
ds_read_b128 v[120:123], v0 offset:38912
ds_read_b128 v[124:127], v0 offset:39936
s_waitcnt lgkmcnt(3)
v_mul_f32 v8, v104, v112
v_mul_f32 v9, v72, v112
s_waitcnt lgkmcnt(2)
v_fmac_f32 v8, v72, v116
v_fma_f32 v9, -v104, v116, v9
v_mfma_f32_32x32x16_bf16 v[32:47], v[92:95], a[184:187], v[32:47]
v_cvt_pk_bf16_f32 v104, v8, v9
v_mul_f32 v10, v105, v113
v_mul_f32 v11, v73, v113
v_fmac_f32 v10, v73, v117
v_fma_f32 v11, -v105, v117, v11
v_cvt_pk_bf16_f32 v105, v10, v11
v_mul_f32 v8, v106, v114
v_mul_f32 v9, v74, v114
v_mfma_f32_32x32x16_bf16 v[48:63], v[92:95], a[188:191], v[48:63]
v_fmac_f32 v8, v74, v118
v_fma_f32 v9, -v106, v118, v9
v_cvt_pk_bf16_f32 v106, v8, v9
v_mul_f32 v10, v107, v115
v_mul_f32 v11, v75, v115
v_fmac_f32 v10, v75, v119
v_fma_f32 v11, -v107, v119, v11
v_cvt_pk_bf16_f32 v107, v10, v11
ds_read_b128 v[112:115], v0 offset:49152
ds_read_b128 v[116:119], v0 offset:50176
s_waitcnt lgkmcnt(3)
v_mul_f32 v8, v108, v120
v_mul_f32 v9, v76, v120
s_waitcnt lgkmcnt(2)
v_fmac_f32 v8, v76, v124
v_fma_f32 v9, -v108, v124, v9
v_cvt_pk_bf16_f32 v108, v8, v9
v_mul_f32 v10, v109, v121
v_mul_f32 v11, v77, v121
v_fmac_f32 v10, v77, v125
v_fma_f32 v11, -v109, v125, v11
v_cvt_pk_bf16_f32 v109, v10, v11
v_mul_f32 v8, v110, v122
v_mul_f32 v9, v78, v122
v_fmac_f32 v8, v78, v126
v_fma_f32 v9, -v110, v126, v9
v_cvt_pk_bf16_f32 v110, v8, v9
v_mul_f32 v10, v111, v123
v_mul_f32 v11, v79, v123
v_fmac_f32 v10, v79, v127
v_fma_f32 v11, -v111, v127, v11
v_cvt_pk_bf16_f32 v111, v10, v11
ds_read_b128 v[120:123], v0 offset:51200
ds_read_b128 v[124:127], v0 offset:52224
ds_read_b128 v[80:83], v26 offset:0
ds_read_b128 v[84:87], v0 offset:1024
ds_read_b128 v[88:91], v26 offset:2048
ds_read_b128 v[92:95], v0 offset:3072
ds_read_b128 v[64:67], v26 offset:4096
ds_read_b128 v[68:71], v0 offset:5120
s_lshl_b32 s52, s3, 10
v_add_u32 v20, s52, v0
v_add_u32 v20, 65536, v20
s_waitcnt lgkmcnt(5)
v_mfma_f32_32x32x16_bf16 v[128:143], v[80:83], v[96:99], v[128:143]
ds_read_b128 v[72:75], v26 offset:6144
v_mul_f32 v8, v32, v112
v_mul_f32 v9, v48, v112
v_fmac_f32 v8, v48, v116
v_fma_f32 v9, -v32, v116, v9
v_cvt_pk_bf16_f32 v32, v8, v9
v_mul_f32 v10, v33, v113
s_waitcnt lgkmcnt(5)
v_mfma_f32_32x32x16_bf16 v[144:159], v[84:87], v[96:99], v[144:159]
ds_read_b128 v[76:79], v0 offset:7168
v_mul_f32 v11, v49, v113
v_fmac_f32 v10, v49, v117
v_fma_f32 v11, -v33, v117, v11
v_cvt_pk_bf16_f32 v33, v10, v11
v_mul_f32 v8, v34, v114
v_mul_f32 v9, v50, v114
s_waitcnt lgkmcnt(5)
v_mfma_f32_32x32x16_bf16 v[160:175], v[88:91], v[96:99], v[160:175]
ds_read_b128 v[80:83], v26 offset:8192
v_fmac_f32 v8, v50, v118
v_fma_f32 v9, -v34, v118, v9
v_cvt_pk_bf16_f32 v34, v8, v9
v_mul_f32 v10, v35, v115
v_mul_f32 v11, v51, v115
v_fmac_f32 v10, v51, v119
s_waitcnt lgkmcnt(5)
v_mfma_f32_32x32x16_bf16 v[176:191], v[92:95], v[96:99], v[176:191]
ds_read_b128 v[84:87], v0 offset:9216
v_fma_f32 v11, -v35, v119, v11
v_cvt_pk_bf16_f32 v35, v10, v11
ds_read_b128 v[112:115], v0 offset:53248
ds_read_b128 v[116:119], v0 offset:54272
v_mul_f32 v8, v36, v120
v_mul_f32 v9, v52, v120
s_waitcnt lgkmcnt(7)
v_mfma_f32_32x32x16_bf16 v[128:143], v[64:67], v[100:103], v[128:143]
ds_read_b128 v[88:91], v26 offset:10240
v_fmac_f32 v8, v52, v124
v_fma_f32 v9, -v36, v124, v9
v_cvt_pk_bf16_f32 v36, v8, v9
v_mul_f32 v10, v37, v121
v_mul_f32 v11, v53, v121
v_fmac_f32 v10, v53, v125
s_waitcnt lgkmcnt(7)
v_mfma_f32_32x32x16_bf16 v[144:159], v[68:71], v[100:103], v[144:159]
ds_read_b128 v[92:95], v0 offset:11264
v_fma_f32 v11, -v37, v125, v11
v_cvt_pk_bf16_f32 v37, v10, v11
v_mul_f32 v8, v38, v122
v_mul_f32 v9, v54, v122
v_fmac_f32 v8, v54, v126
v_fma_f32 v9, -v38, v126, v9
s_waitcnt lgkmcnt(7)
v_mfma_f32_32x32x16_bf16 v[160:175], v[72:75], v[100:103], v[160:175]
ds_read_b128 v[64:67], v26 offset:12288
v_cvt_pk_bf16_f32 v38, v8, v9
v_mul_f32 v10, v39, v123
v_mul_f32 v11, v55, v123
v_fmac_f32 v10, v55, v127
v_fma_f32 v11, -v39, v127, v11
v_cvt_pk_bf16_f32 v39, v10, v11
s_waitcnt lgkmcnt(7)
v_mfma_f32_32x32x16_bf16 v[176:191], v[76:79], v[100:103], v[176:191]
ds_read_b128 v[68:71], v0 offset:13312
ds_read_b128 v[120:123], v0 offset:55296
ds_read_b128 v[124:127], v0 offset:56320
s_waitcnt lgkmcnt(7)
v_mul_f32 v8, v40, v112
v_mul_f32 v9, v56, v112
s_waitcnt lgkmcnt(6)
v_fmac_f32 v8, v56, v116
v_fma_f32 v9, -v40, v116, v9
v_mfma_f32_32x32x16_bf16 v[128:143], v[80:83], v[104:107], v[128:143]
ds_read_b128 v[72:75], v26 offset:14336
v_cvt_pk_bf16_f32 v40, v8, v9
v_mul_f32 v10, v41, v113
v_mul_f32 v11, v57, v113
v_fmac_f32 v10, v57, v117
v_fma_f32 v11, -v41, v117, v11
v_cvt_pk_bf16_f32 v41, v10, v11
v_mfma_f32_32x32x16_bf16 v[144:159], v[84:87], v[104:107], v[144:159]
ds_read_b128 v[76:79], v0 offset:15360
v_mul_f32 v8, v42, v114
v_mul_f32 v9, v58, v114
v_fmac_f32 v8, v58, v118
v_fma_f32 v9, -v42, v118, v9
v_cvt_pk_bf16_f32 v42, v8, v9
v_mul_f32 v10, v43, v115
s_waitcnt lgkmcnt(7)
v_mfma_f32_32x32x16_bf16 v[160:175], v[88:91], v[104:107], v[160:175]
ds_read_b128 v[80:83], v26 offset:16384
v_mul_f32 v11, v59, v115
v_fmac_f32 v10, v59, v119
v_fma_f32 v11, -v43, v119, v11
v_cvt_pk_bf16_f32 v43, v10, v11
s_waitcnt lgkmcnt(4)
v_mul_f32 v8, v44, v120
v_mul_f32 v9, v60, v120
v_mfma_f32_32x32x16_bf16 v[176:191], v[92:95], v[104:107], v[176:191]
ds_read_b128 v[84:87], v0 offset:17408
s_waitcnt lgkmcnt(4)
v_fmac_f32 v8, v60, v124
v_fma_f32 v9, -v44, v124, v9
v_cvt_pk_bf16_f32 v44, v8, v9
v_mul_f32 v10, v45, v121
v_mul_f32 v11, v61, v121
v_fmac_f32 v10, v61, v125
v_mfma_f32_32x32x16_bf16 v[128:143], v[64:67], v[108:111], v[128:143]
ds_read_b128 v[88:91], v26 offset:20480
v_fma_f32 v11, -v45, v125, v11
v_cvt_pk_bf16_f32 v45, v10, v11
v_mul_f32 v8, v46, v122
v_mul_f32 v9, v62, v122
v_fmac_f32 v8, v62, v126
v_fma_f32 v9, -v46, v126, v9
v_mfma_f32_32x32x16_bf16 v[144:159], v[68:71], v[108:111], v[144:159]
ds_read_b128 v[92:95], v0 offset:21504
v_cvt_pk_bf16_f32 v46, v8, v9
v_mul_f32 v10, v47, v123
v_mul_f32 v11, v63, v123
v_fmac_f32 v10, v63, v127
v_fma_f32 v11, -v47, v127, v11
v_cvt_pk_bf16_f32 v47, v10, v11
s_waitcnt lgkmcnt(5)
v_mfma_f32_32x32x16_bf16 v[160:175], v[72:75], v[108:111], v[160:175]
ds_read_b128 v[64:67], v26 offset:24576
s_waitcnt lgkmcnt(5)
v_mfma_f32_32x32x16_bf16 v[176:191], v[76:79], v[108:111], v[176:191]
ds_read_b128 v[68:71], v0 offset:25600
s_waitcnt lgkmcnt(5)
v_mfma_f32_32x32x16_bf16 v[128:143], v[80:83], v[32:35], v[128:143]
ds_read_b128 v[72:75], v26 offset:28672
s_waitcnt lgkmcnt(5)
v_mfma_f32_32x32x16_bf16 v[144:159], v[84:87], v[32:35], v[144:159]
ds_read_b128 v[76:79], v0 offset:29696
s_waitcnt lgkmcnt(5)
v_mfma_f32_32x32x16_bf16 v[128:143], v[88:91], v[36:39], v[128:143]
ds_read_b128 v[80:83], v26 offset:18432
s_waitcnt lgkmcnt(5)
v_mfma_f32_32x32x16_bf16 v[144:159], v[92:95], v[36:39], v[144:159]
ds_read_b128 v[84:87], v0 offset:19456
s_waitcnt lgkmcnt(5)
v_mfma_f32_32x32x16_bf16 v[128:143], v[64:67], v[40:43], v[128:143]
ds_read_b128 v[88:91], v26 offset:22528
s_waitcnt lgkmcnt(5)
v_mfma_f32_32x32x16_bf16 v[144:159], v[68:71], v[40:43], v[144:159]
ds_read_b128 v[92:95], v0 offset:23552
s_waitcnt lgkmcnt(5)
v_mfma_f32_32x32x16_bf16 v[128:143], v[72:75], v[44:47], v[128:143]
ds_read_b128 v[64:67], v26 offset:26624
s_waitcnt lgkmcnt(5)
v_mfma_f32_32x32x16_bf16 v[144:159], v[76:79], v[44:47], v[144:159]
ds_read_b128 v[68:71], v0 offset:27648
s_waitcnt lgkmcnt(5)
v_mfma_f32_32x32x16_bf16 v[160:175], v[80:83], v[32:35], v[160:175]
ds_read_b128 v[72:75], v26 offset:30720
s_waitcnt lgkmcnt(5)
v_mfma_f32_32x32x16_bf16 v[176:191], v[84:87], v[32:35], v[176:191]
ds_read_b128 v[76:79], v0 offset:31744
v_cvt_pk_bf16_f32 v128, v144, v128
v_cvt_pk_bf16_f32 v129, v145, v129
v_cvt_pk_bf16_f32 v130, v146, v130
v_cvt_pk_bf16_f32 v131, v147, v131
ds_write_b128 v20, v[128:131] offset:0
v_cvt_pk_bf16_f32 v132, v148, v132
s_waitcnt lgkmcnt(6)
v_mfma_f32_32x32x16_bf16 v[160:175], v[88:91], v[36:39], v[160:175]
v_cvt_pk_bf16_f32 v133, v149, v133
v_cvt_pk_bf16_f32 v134, v150, v134
v_cvt_pk_bf16_f32 v135, v151, v135
ds_write_b128 v20, v[132:135] offset:4096
v_cvt_pk_bf16_f32 v136, v152, v136
v_cvt_pk_bf16_f32 v137, v153, v137
s_waitcnt lgkmcnt(6)
v_mfma_f32_32x32x16_bf16 v[176:191], v[92:95], v[36:39], v[176:191]
v_cvt_pk_bf16_f32 v138, v154, v138
v_cvt_pk_bf16_f32 v139, v155, v139
ds_write_b128 v20, v[136:139] offset:8192
v_cvt_pk_bf16_f32 v140, v156, v140
v_cvt_pk_bf16_f32 v141, v157, v141
v_cvt_pk_bf16_f32 v142, v158, v142
s_waitcnt lgkmcnt(6)
v_mfma_f32_32x32x16_bf16 v[160:175], v[64:67], v[40:43], v[160:175]
v_cvt_pk_bf16_f32 v143, v159, v143
ds_write_b128 v20, v[140:143] offset:12288
s_waitcnt lgkmcnt(6)
v_mfma_f32_32x32x16_bf16 v[176:191], v[68:71], v[40:43], v[176:191]
s_waitcnt lgkmcnt(5)
v_mfma_f32_32x32x16_bf16 v[160:175], v[72:75], v[44:47], v[160:175]
s_waitcnt lgkmcnt(4)
v_mfma_f32_32x32x16_bf16 v[176:191], v[76:79], v[44:47], v[176:191]
s_nop 11
v_cvt_pk_bf16_f32 v160, v176, v160
v_cvt_pk_bf16_f32 v161, v177, v161
v_cvt_pk_bf16_f32 v162, v178, v162
v_cvt_pk_bf16_f32 v163, v179, v163
ds_write_b128 v20, v[160:163] offset:16384
v_cvt_pk_bf16_f32 v164, v180, v164
v_cvt_pk_bf16_f32 v165, v181, v165
v_cvt_pk_bf16_f32 v166, v182, v166
v_cvt_pk_bf16_f32 v167, v183, v167
ds_write_b128 v20, v[164:167] offset:20480
v_cvt_pk_bf16_f32 v168, v184, v168
v_cvt_pk_bf16_f32 v169, v185, v169
v_cvt_pk_bf16_f32 v170, v186, v170
v_cvt_pk_bf16_f32 v171, v187, v171
ds_write_b128 v20, v[168:171] offset:24576
v_cvt_pk_bf16_f32 v172, v188, v172
v_cvt_pk_bf16_f32 v173, v189, v173
v_cvt_pk_bf16_f32 v174, v190, v174
v_cvt_pk_bf16_f32 v175, v191, v175
ds_write_b128 v20, v[172:175] offset:28672
s_lshl_b32 s52, s3, 12
s_add_u32 s52, s52, 65536
v_add_u32 v20, s52, v0
s_waitcnt lgkmcnt(0)
s_barrier
ds_read_b128 v[32:35], v20 offset:0
ds_read_b128 v[36:39], v20 offset:1024
ds_read_b128 v[40:43], v20 offset:2048
ds_read_b128 v[44:47], v20 offset:3072
ds_read_b128 v[48:51], v20 offset:16384
ds_read_b128 v[52:55], v20 offset:17408
ds_read_b128 v[56:59], v20 offset:18432
ds_read_b128 v[60:63], v20 offset:19456
s_waitcnt lgkmcnt(6)
v_swap_b32 v33, v36
s_waitcnt lgkmcnt(5)
v_swap_b32 v34, v40
s_waitcnt lgkmcnt(4)
v_swap_b32 v35, v44
buffer_store_dwordx4 v[32:35], v25, s[4:7], s48 offen sc1
s_add_u32 s48, s48, 40960
v_swap_b32 v38, v41
v_swap_b32 v39, v45
buffer_store_dwordx4 v[36:39], v25, s[4:7], s48 offen sc1
s_add_u32 s48, s48, 40960
v_swap_b32 v43, v46
buffer_store_dwordx4 v[40:43], v25, s[4:7], s48 offen sc1
s_add_u32 s48, s48, 40960
buffer_store_dwordx4 v[44:47], v25, s[4:7], s48 offen sc1
s_add_u32 s48, s48, 1187840
s_waitcnt lgkmcnt(2)
v_swap_b32 v49, v52
s_waitcnt lgkmcnt(1)
v_swap_b32 v50, v56
s_waitcnt lgkmcnt(0)
v_swap_b32 v51, v60
buffer_store_dwordx4 v[48:51], v25, s[4:7], s48 offen sc1
s_add_u32 s48, s48, 40960
v_swap_b32 v54, v57
v_swap_b32 v55, v61
buffer_store_dwordx4 v[52:55], v25, s[4:7], s48 offen sc1
s_add_u32 s48, s48, 40960
v_swap_b32 v59, v62
buffer_store_dwordx4 v[56:59], v25, s[4:7], s48 offen sc1
s_add_u32 s48, s48, 40960
buffer_store_dwordx4 v[60:63], v25, s[4:7], s48 offen sc1
s_add_u32 s48, s48, 1187840
s_lshl_b32 s54, s51, 13
s_lshl_b32 s52, s30, 6
s_add_u32 s54, s54, s52
s_add_u32 s54, s54, 222306304
s_waitcnt vmcnt(0)
s_barrier
s_cmp_lg_u32 s3, 0
s_cbranch_scc1 k_s8_86
s_mov_b64 exec, 1
v_mov_b32 v8, 1
buffer_store_dword v8, off, s[4:7], s54 sc1
s_mov_b64 exec, -1
k_s8_86:
k_fend_36:
s_add_u32 s51, s51, 1
s_cmp_lt_u32 s51, 2
s_cbranch_scc1 k_lay_27
s_add_u32 s30, s30, 64
s_cmp_ge_u32 s30, 144
s_cbranch_scc1 k_fin_7
s_endpgm
k_o_4:
s_load_dwordx2 s[36:37], s[0:1], 0
s_mov_b32 s38, 2621440
s_mov_b32 s39, 0x20000
s_mul_i32 s57, s30, 52429
s_lshr_b32 s57, s57, 18
s_mul_i32 s52, s57, 5
s_sub_u32 s58, s30, s52
s_lshl_b32 s58, s58, 2
s_add_u32 s58, s58, s3
v_mov_b64 v[4:5], -1
v_mov_b64 v[6:7], -1
s_lshl_b32 s52, s30, 2
s_add_u32 s52, s52, s3
s_lshl_b32 s53, s52, 13
s_lshl_b32 s52, s52, 9
v_lshrrev_b32 v2, 1, v0
s_add_u32 s54, s52, 211812352
buffer_store_dwordx2 v[4:5], v2, s[4:7], s54 offen sc1
s_add_u32 s54, s53, 205520896
buffer_store_dwordx4 v[4:7], v0, s[4:7], s54 offen offset:0 sc1
buffer_store_dwordx4 v[4:7], v0, s[4:7], s54 offen offset:1024 sc1
buffer_store_dwordx4 v[4:7], v0, s[4:7], s54 offen offset:2048 sc1
buffer_store_dwordx4 v[4:7], v0, s[4:7], s54 offen offset:3072 sc1
s_add_u32 s54, s53, 205524992
buffer_store_dwordx4 v[4:7], v0, s[4:7], s54 offen offset:0 sc1
buffer_store_dwordx4 v[4:7], v0, s[4:7], s54 offen offset:1024 sc1
buffer_store_dwordx4 v[4:7], v0, s[4:7], s54 offen offset:2048 sc1
buffer_store_dwordx4 v[4:7], v0, s[4:7], s54 offen offset:3072 sc1
s_add_u32 s54, s52, 212860928
buffer_store_dwordx2 v[4:5], v2, s[4:7], s54 offen sc1
s_add_u32 s54, s53, 208666624
buffer_store_dwordx4 v[4:7], v0, s[4:7], s54 offen offset:0 sc1
buffer_store_dwordx4 v[4:7], v0, s[4:7], s54 offen offset:1024 sc1
buffer_store_dwordx4 v[4:7], v0, s[4:7], s54 offen offset:2048 sc1
buffer_store_dwordx4 v[4:7], v0, s[4:7], s54 offen offset:3072 sc1
s_add_u32 s54, s53, 208670720
buffer_store_dwordx4 v[4:7], v0, s[4:7], s54 offen offset:0 sc1
buffer_store_dwordx4 v[4:7], v0, s[4:7], s54 offen offset:1024 sc1
buffer_store_dwordx4 v[4:7], v0, s[4:7], s54 offen offset:2048 sc1
buffer_store_dwordx4 v[4:7], v0, s[4:7], s54 offen offset:3072 sc1
s_mul_i32 s52, s3, 640
v_lshrrev_b32 v8, 4, v0
v_add_u32 v8, s52, v8
s_mov_b32 s53, 52429
v_add_u32 v9, 0, v8
v_mul_u32_u24 v10, s53, v9
v_lshrrev_b32 v10, 22, v10
v_mul_u32_u24 v11, 80, v10
v_sub_u32 v9, v9, v11
v_and_b32 v11, 15, v10
v_xor_b32 v9, v9, v11
v_mul_u32_u24 v10, 1280, v10
v_lshl_add_u32 v72, v9, 4, v10
v_add_u32 v9, 64, v8
v_mul_u32_u24 v10, s53, v9
v_lshrrev_b32 v10, 22, v10
v_mul_u32_u24 v11, 80, v10
v_sub_u32 v9, v9, v11
v_and_b32 v11, 15, v10
v_xor_b32 v9, v9, v11
v_mul_u32_u24 v10, 1280, v10
v_lshl_add_u32 v73, v9, 4, v10
v_add_u32 v9, 128, v8
v_mul_u32_u24 v10, s53, v9
v_lshrrev_b32 v10, 22, v10
v_mul_u32_u24 v11, 80, v10
v_sub_u32 v9, v9, v11
v_and_b32 v11, 15, v10
v_xor_b32 v9, v9, v11
v_mul_u32_u24 v10, 1280, v10
v_lshl_add_u32 v74, v9, 4, v10
v_add_u32 v9, 192, v8
v_mul_u32_u24 v10, s53, v9
v_lshrrev_b32 v10, 22, v10
v_mul_u32_u24 v11, 80, v10
v_sub_u32 v9, v9, v11
v_and_b32 v11, 15, v10
v_xor_b32 v9, v9, v11
v_mul_u32_u24 v10, 1280, v10
v_lshl_add_u32 v75, v9, 4, v10
v_add_u32 v9, 256, v8
v_mul_u32_u24 v10, s53, v9
v_lshrrev_b32 v10, 22, v10
v_mul_u32_u24 v11, 80, v10
v_sub_u32 v9, v9, v11
v_and_b32 v11, 15, v10
v_xor_b32 v9, v9, v11
v_mul_u32_u24 v10, 1280, v10
v_lshl_add_u32 v76, v9, 4, v10
v_add_u32 v9, 320, v8
v_mul_u32_u24 v10, s53, v9
v_lshrrev_b32 v10, 22, v10
v_mul_u32_u24 v11, 80, v10
v_sub_u32 v9, v9, v11
v_and_b32 v11, 15, v10
v_xor_b32 v9, v9, v11
v_mul_u32_u24 v10, 1280, v10
v_lshl_add_u32 v77, v9, 4, v10
v_add_u32 v9, 384, v8
v_mul_u32_u24 v10, s53, v9
v_lshrrev_b32 v10, 22, v10
v_mul_u32_u24 v11, 80, v10
v_sub_u32 v9, v9, v11
v_and_b32 v11, 15, v10
v_xor_b32 v9, v9, v11
v_mul_u32_u24 v10, 1280, v10
v_lshl_add_u32 v78, v9, 4, v10
v_add_u32 v9, 448, v8
v_mul_u32_u24 v10, s53, v9
v_lshrrev_b32 v10, 22, v10
v_mul_u32_u24 v11, 80, v10
v_sub_u32 v9, v9, v11
v_and_b32 v11, 15, v10
v_xor_b32 v9, v9, v11
v_mul_u32_u24 v10, 1280, v10
v_lshl_add_u32 v79, v9, 4, v10
v_add_u32 v9, 512, v8
v_mul_u32_u24 v10, s53, v9
v_lshrrev_b32 v10, 22, v10
v_mul_u32_u24 v11, 80, v10
v_sub_u32 v9, v9, v11
v_and_b32 v11, 15, v10
v_xor_b32 v9, v9, v11
v_mul_u32_u24 v10, 1280, v10
v_lshl_add_u32 v80, v9, 4, v10
v_add_u32 v9, 576, v8
v_mul_u32_u24 v10, s53, v9
v_lshrrev_b32 v10, 22, v10
v_mul_u32_u24 v11, 80, v10
v_sub_u32 v9, v9, v11
v_and_b32 v11, 15, v10
v_xor_b32 v9, v9, v11
v_mul_u32_u24 v10, 1280, v10
v_lshl_add_u32 v81, v9, 4, v10
s_cmp_lg_u32 s3, 0
s_cbranch_scc1 k_wdd_88
v_mov_b32 v2, 128
k_wd_87:
global_load_dword v3, v2, s[28:29] sc1
s_waitcnt vmcnt(0)
v_readfirstlane_b32 s52, v3
s_cmp_ge_u32 s52, 32
s_cbranch_scc1 k_wdd_88
s_sleep 2
s_sub_u32 s32, s32, 1
s_cmp_gt_i32 s32, 0
s_cbranch_scc1 k_wd_87
k_wdd_88:
s_barrier
s_mul_i32 s53, s58, 40960
s_add_u32 s53, s53, 213909504
buffer_load_dwordx4 v[96:99], v0, s[4:7], s53 offen offset:0 sc1
buffer_load_dwordx4 v[100:103], v0, s[4:7], s53 offen offset:1024 sc1
buffer_load_dwordx4 v[104:107], v0, s[4:7], s53 offen offset:2048 sc1
buffer_load_dwordx4 v[108:111], v0, s[4:7], s53 offen offset:3072 sc1
s_add_u32 s53, s53, 4096
buffer_load_dwordx4 v[112:115], v0, s[4:7], s53 offen offset:0 sc1
buffer_load_dwordx4 v[116:119], v0, s[4:7], s53 offen offset:1024 sc1
buffer_load_dwordx4 v[120:123], v0, s[4:7], s53 offen offset:2048 sc1
buffer_load_dwordx4 v[124:127], v0, s[4:7], s53 offen offset:3072 sc1
s_add_u32 s53, s53, 4096
buffer_load_dwordx4 v[128:131], v0, s[4:7], s53 offen offset:0 sc1
buffer_load_dwordx4 v[132:135], v0, s[4:7], s53 offen offset:1024 sc1
buffer_load_dwordx4 v[136:139], v0, s[4:7], s53 offen offset:2048 sc1
buffer_load_dwordx4 v[140:143], v0, s[4:7], s53 offen offset:3072 sc1
s_add_u32 s53, s53, 4096
buffer_load_dwordx4 v[144:147], v0, s[4:7], s53 offen offset:0 sc1
buffer_load_dwordx4 v[148:151], v0, s[4:7], s53 offen offset:1024 sc1
buffer_load_dwordx4 v[152:155], v0, s[4:7], s53 offen offset:2048 sc1
buffer_load_dwordx4 v[156:159], v0, s[4:7], s53 offen offset:3072 sc1
s_add_u32 s53, s53, 4096
buffer_load_dwordx4 v[160:163], v0, s[4:7], s53 offen offset:0 sc1
buffer_load_dwordx4 v[164:167], v0, s[4:7], s53 offen offset:1024 sc1
buffer_load_dwordx4 v[168:171], v0, s[4:7], s53 offen offset:2048 sc1
buffer_load_dwordx4 v[172:175], v0, s[4:7], s53 offen offset:3072 sc1
s_add_u32 s53, s53, 4096
buffer_load_dwordx4 v[176:179], v0, s[4:7], s53 offen offset:0 sc1
buffer_load_dwordx4 v[180:183], v0, s[4:7], s53 offen offset:1024 sc1
buffer_load_dwordx4 v[184:187], v0, s[4:7], s53 offen offset:2048 sc1
buffer_load_dwordx4 v[188:191], v0, s[4:7], s53 offen offset:3072 sc1
s_add_u32 s53, s53, 4096
buffer_load_dwordx4 v[192:195], v0, s[4:7], s53 offen offset:0 sc1
buffer_load_dwordx4 v[196:199], v0, s[4:7], s53 offen offset:1024 sc1
buffer_load_dwordx4 v[200:203], v0, s[4:7], s53 offen offset:2048 sc1
buffer_load_dwordx4 v[204:207], v0, s[4:7], s53 offen offset:3072 sc1
s_add_u32 s53, s53, 4096
buffer_load_dwordx4 v[208:211], v0, s[4:7], s53 offen offset:0 sc1
buffer_load_dwordx4 v[212:215], v0, s[4:7], s53 offen offset:1024 sc1
buffer_load_dwordx4 v[216:219], v0, s[4:7], s53 offen offset:2048 sc1
buffer_load_dwordx4 v[220:223], v0, s[4:7], s53 offen offset:3072 sc1
s_add_u32 s53, s53, 4096
buffer_load_dwordx4 v[224:227], v0, s[4:7], s53 offen offset:0 sc1
buffer_load_dwordx4 v[228:231], v0, s[4:7], s53 offen offset:1024 sc1
buffer_load_dwordx4 v[232:235], v0, s[4:7], s53 offen offset:2048 sc1
buffer_load_dwordx4 v[236:239], v0, s[4:7], s53 offen offset:3072 sc1
s_add_u32 s53, s53, 4096
buffer_load_dwordx4 v[240:243], v0, s[4:7], s53 offen offset:0 sc1
buffer_load_dwordx4 v[244:247], v0, s[4:7], s53 offen offset:1024 sc1
buffer_load_dwordx4 v[248:251], v0, s[4:7], s53 offen offset:2048 sc1
buffer_load_dwordx4 v[252:255], v0, s[4:7], s53 offen offset:3072 sc1
s_mul_i32 s46, s57, 163840
s_lshl_b32 s48, s58, 11
s_add_u32 s48, s48, s46
s_add_u32 s48, s48, 195035136
s_mov_b32 s47, 0
s_waitcnt lgkmcnt(0)
s_mul_i32 s45, s3, 10240
s_mov_b32 s44, 0
v_bfe_u32 v8, v0, 4, 5
v_mul_u32_u24 v9, 1280, v8
v_and_b32 v8, 15, v8
v_lshrrev_b32 v10, 9, v0
v_xor_b32 v8, v8, v10
v_xor_b32 v10, 0, v8
v_lshl_add_u32 v64, v10, 4, v9
v_xor_b32 v10, 2, v8
v_lshl_add_u32 v65, v10, 4, v9
v_xor_b32 v10, 4, v8
v_lshl_add_u32 v66, v10, 4, v9
v_xor_b32 v10, 6, v8
v_lshl_add_u32 v67, v10, 4, v9
v_xor_b32 v10, 8, v8
v_lshl_add_u32 v68, v10, 4, v9
v_xor_b32 v10, 10, v8
v_lshl_add_u32 v69, v10, 4, v9
v_xor_b32 v10, 12, v8
v_lshl_add_u32 v70, v10, 4, v9
v_xor_b32 v10, 14, v8
v_lshl_add_u32 v71, v10, 4, v9
s_add_u32 m0, s45, 0
s_nop 0
buffer_load_dwordx4 v72, s[36:39], s46 offen lds
s_add_u32 m0, s45, 1024
s_nop 0
buffer_load_dwordx4 v73, s[36:39], s46 offen lds
s_add_u32 m0, s45, 2048
s_nop 0
buffer_load_dwordx4 v74, s[36:39], s46 offen lds
s_add_u32 m0, s45, 3072
s_nop 0
buffer_load_dwordx4 v75, s[36:39], s46 offen lds
s_add_u32 m0, s45, 4096
s_nop 0
buffer_load_dwordx4 v76, s[36:39], s46 offen lds
s_add_u32 m0, s45, 5120
s_nop 0
buffer_load_dwordx4 v77, s[36:39], s46 offen lds
s_add_u32 m0, s45, 6144
s_nop 0
buffer_load_dwordx4 v78, s[36:39], s46 offen lds
s_add_u32 m0, s45, 7168
s_nop 0
buffer_load_dwordx4 v79, s[36:39], s46 offen lds
s_add_u32 m0, s45, 8192
s_nop 0
buffer_load_dwordx4 v80, s[36:39], s46 offen lds
s_add_u32 m0, s45, 9216
s_nop 0
buffer_load_dwordx4 v81, s[36:39], s46 offen lds
s_add_u32 s45, s45, 40960
s_cmp_ge_u32 s45, 122880
s_cselect_b32 s55, 122880, 0
s_sub_u32 s45, s45, s55
s_add_u32 s47, s47, 1
s_cmp_lt_u32 s47, 4
s_cselect_b32 s55, 40960, 0
s_add_u32 s46, s46, s55
s_add_u32 m0, s45, 0
s_nop 0
buffer_load_dwordx4 v72, s[36:39], s46 offen lds
s_add_u32 m0, s45, 1024
s_nop 0
buffer_load_dwordx4 v73, s[36:39], s46 offen lds
s_add_u32 m0, s45, 2048
s_nop 0
buffer_load_dwordx4 v74, s[36:39], s46 offen lds
s_add_u32 m0, s45, 3072
s_nop 0
buffer_load_dwordx4 v75, s[36:39], s46 offen lds
s_add_u32 m0, s45, 4096
s_nop 0
buffer_load_dwordx4 v76, s[36:39], s46 offen lds
s_add_u32 m0, s45, 5120
s_nop 0
buffer_load_dwordx4 v77, s[36:39], s46 offen lds
s_add_u32 m0, s45, 6144
s_nop 0
buffer_load_dwordx4 v78, s[36:39], s46 offen lds
s_add_u32 m0, s45, 7168
s_nop 0
buffer_load_dwordx4 v79, s[36:39], s46 offen lds
s_add_u32 m0, s45, 8192
s_nop 0
buffer_load_dwordx4 v80, s[36:39], s46 offen lds
s_add_u32 m0, s45, 9216
s_nop 0
buffer_load_dwordx4 v81, s[36:39], s46 offen lds
s_add_u32 s45, s45, 40960
s_cmp_ge_u32 s45, 122880
s_cselect_b32 s55, 122880, 0
s_sub_u32 s45, s45, s55
s_add_u32 s47, s47, 1
s_cmp_lt_u32 s47, 4
s_cselect_b32 s55, 40960, 0
s_add_u32 s46, s46, s55
s_waitcnt vmcnt(10)
s_barrier
ds_read_b128 v[8:11], v64 offset:0
ds_read_b128 v[12:15], v65 offset:0
ds_read_b128 v[16:19], v66 offset:0
ds_read_b128 v[20:23], v67 offset:0
s_mov_b32 s59, 2
s_waitcnt lgkmcnt(3)
v_mfma_f32_32x32x16_bf16 v[32:47], v[96:99], v[8:11], 0
s_waitcnt lgkmcnt(2)
ds_read_b128 v[24:27], v68 offset:0
v_mfma_f32_32x32x16_bf16 v[32:47], v[100:103], v[12:15], v[32:47]
s_waitcnt lgkmcnt(2)
ds_read_b128 v[8:11], v69 offset:0
s_add_u32 m0, s45, 0
s_nop 0
buffer_load_dwordx4 v72, s[36:39], s46 offen lds
s_add_u32 m0, s45, 1024
s_nop 0
buffer_load_dwordx4 v73, s[36:39], s46 offen lds
v_mfma_f32_32x32x16_bf16 v[32:47], v[104:107], v[16:19], v[32:47]
s_waitcnt lgkmcnt(2)
ds_read_b128 v[12:15], v70 offset:0
s_add_u32 m0, s45, 2048
s_nop 0
buffer_load_dwordx4 v74, s[36:39], s46 offen lds
s_add_u32 m0, s45, 3072
s_nop 0
buffer_load_dwordx4 v75, s[36:39], s46 offen lds
v_mfma_f32_32x32x16_bf16 v[32:47], v[108:111], v[20:23], v[32:47]
s_waitcnt lgkmcnt(2)
ds_read_b128 v[16:19], v71 offset:0
s_add_u32 m0, s45, 4096
s_nop 0
buffer_load_dwordx4 v76, s[36:39], s46 offen lds
s_add_u32 m0, s45, 5120
s_nop 0
buffer_load_dwordx4 v77, s[36:39], s46 offen lds
v_mfma_f32_32x32x16_bf16 v[32:47], v[112:115], v[24:27], v[32:47]
s_waitcnt lgkmcnt(2)
ds_read_b128 v[20:23], v64 offset:256
s_add_u32 m0, s45, 6144
s_nop 0
buffer_load_dwordx4 v78, s[36:39], s46 offen lds
s_add_u32 m0, s45, 7168
s_nop 0
buffer_load_dwordx4 v79, s[36:39], s46 offen lds
v_mfma_f32_32x32x16_bf16 v[32:47], v[116:119], v[8:11], v[32:47]
s_waitcnt lgkmcnt(2)
ds_read_b128 v[24:27], v65 offset:256
s_add_u32 m0, s45, 8192
s_nop 0
buffer_load_dwordx4 v80, s[36:39], s46 offen lds
s_add_u32 m0, s45, 9216
s_nop 0
buffer_load_dwordx4 v81, s[36:39], s46 offen lds
v_mfma_f32_32x32x16_bf16 v[32:47], v[120:123], v[12:15], v[32:47]
s_waitcnt lgkmcnt(2)
ds_read_b128 v[8:11], v66 offset:256
s_add_u32 s45, s45, 40960
s_cmp_ge_u32 s45, 122880
s_cselect_b32 s55, 122880, 0
s_sub_u32 s45, s45, s55
s_add_u32 s47, s47, 1
s_cmp_lt_u32 s47, 4
s_cselect_b32 s55, 40960, 0
s_add_u32 s46, s46, s55
v_mfma_f32_32x32x16_bf16 v[32:47], v[124:127], v[16:19], v[32:47]
s_waitcnt lgkmcnt(2)
ds_read_b128 v[12:15], v67 offset:256
v_mfma_f32_32x32x16_bf16 v[32:47], v[128:131], v[20:23], v[32:47]
s_waitcnt lgkmcnt(2)
ds_read_b128 v[16:19], v68 offset:256
v_mfma_f32_32x32x16_bf16 v[32:47], v[132:135], v[24:27], v[32:47]
s_waitcnt lgkmcnt(2)
ds_read_b128 v[20:23], v69 offset:256
v_mfma_f32_32x32x16_bf16 v[32:47], v[136:139], v[8:11], v[32:47]
s_waitcnt lgkmcnt(2)
ds_read_b128 v[24:27], v70 offset:256
v_mfma_f32_32x32x16_bf16 v[32:47], v[140:143], v[12:15], v[32:47]
s_waitcnt lgkmcnt(2)
ds_read_b128 v[8:11], v71 offset:256
v_mfma_f32_32x32x16_bf16 v[32:47], v[144:147], v[16:19], v[32:47]
s_waitcnt lgkmcnt(2)
ds_read_b128 v[12:15], v64 offset:512
v_mfma_f32_32x32x16_bf16 v[32:47], v[148:151], v[20:23], v[32:47]
s_waitcnt lgkmcnt(2)
ds_read_b128 v[16:19], v65 offset:512
v_mfma_f32_32x32x16_bf16 v[32:47], v[152:155], v[24:27], v[32:47]
s_waitcnt lgkmcnt(2)
ds_read_b128 v[20:23], v66 offset:512
v_mfma_f32_32x32x16_bf16 v[32:47], v[156:159], v[8:11], v[32:47]
s_waitcnt lgkmcnt(2)
ds_read_b128 v[24:27], v67 offset:512
v_mfma_f32_32x32x16_bf16 v[32:47], v[160:163], v[12:15], v[32:47]
s_waitcnt lgkmcnt(2)
ds_read_b128 v[8:11], v68 offset:512
v_mfma_f32_32x32x16_bf16 v[32:47], v[164:167], v[16:19], v[32:47]
s_waitcnt lgkmcnt(2)
ds_read_b128 v[12:15], v69 offset:512
v_mfma_f32_32x32x16_bf16 v[32:47], v[168:171], v[20:23], v[32:47]
s_waitcnt lgkmcnt(2)
ds_read_b128 v[16:19], v70 offset:512
v_mfma_f32_32x32x16_bf16 v[32:47], v[172:175], v[24:27], v[32:47]
s_waitcnt lgkmcnt(2)
ds_read_b128 v[20:23], v71 offset:512
v_mfma_f32_32x32x16_bf16 v[32:47], v[176:179], v[8:11], v[32:47]
s_waitcnt lgkmcnt(2)
ds_read_b128 v[24:27], v64 offset:768
v_mfma_f32_32x32x16_bf16 v[32:47], v[180:183], v[12:15], v[32:47]
s_waitcnt lgkmcnt(2)
ds_read_b128 v[8:11], v65 offset:768
v_mfma_f32_32x32x16_bf16 v[32:47], v[184:187], v[16:19], v[32:47]
s_waitcnt lgkmcnt(2)
ds_read_b128 v[12:15], v66 offset:768
v_mfma_f32_32x32x16_bf16 v[32:47], v[188:191], v[20:23], v[32:47]
s_waitcnt lgkmcnt(2)
ds_read_b128 v[16:19], v67 offset:768
v_mfma_f32_32x32x16_bf16 v[32:47], v[192:195], v[24:27], v[32:47]
s_waitcnt lgkmcnt(2)
ds_read_b128 v[20:23], v68 offset:768
v_mfma_f32_32x32x16_bf16 v[32:47], v[196:199], v[8:11], v[32:47]
s_waitcnt lgkmcnt(2)
ds_read_b128 v[24:27], v69 offset:768
v_mfma_f32_32x32x16_bf16 v[32:47], v[200:203], v[12:15], v[32:47]
s_waitcnt lgkmcnt(2)
ds_read_b128 v[8:11], v70 offset:768
v_mfma_f32_32x32x16_bf16 v[32:47], v[204:207], v[16:19], v[32:47]
s_waitcnt lgkmcnt(2)
ds_read_b128 v[12:15], v71 offset:768
v_mfma_f32_32x32x16_bf16 v[32:47], v[208:211], v[20:23], v[32:47]
s_waitcnt lgkmcnt(2)
ds_read_b128 v[16:19], v64 offset:1024
v_mfma_f32_32x32x16_bf16 v[32:47], v[212:215], v[24:27], v[32:47]
s_waitcnt lgkmcnt(2)
ds_read_b128 v[20:23], v65 offset:1024
v_mfma_f32_32x32x16_bf16 v[32:47], v[216:219], v[8:11], v[32:47]
s_waitcnt lgkmcnt(2)
ds_read_b128 v[24:27], v66 offset:1024
v_mfma_f32_32x32x16_bf16 v[32:47], v[220:223], v[12:15], v[32:47]
s_waitcnt lgkmcnt(2)
ds_read_b128 v[8:11], v67 offset:1024
v_mfma_f32_32x32x16_bf16 v[32:47], v[224:227], v[16:19], v[32:47]
s_waitcnt lgkmcnt(2)
ds_read_b128 v[12:15], v68 offset:1024
v_mfma_f32_32x32x16_bf16 v[32:47], v[228:231], v[20:23], v[32:47]
s_waitcnt lgkmcnt(2)
ds_read_b128 v[16:19], v69 offset:1024
v_mfma_f32_32x32x16_bf16 v[32:47], v[232:235], v[24:27], v[32:47]
s_waitcnt lgkmcnt(2)
ds_read_b128 v[20:23], v70 offset:1024
v_mfma_f32_32x32x16_bf16 v[32:47], v[236:239], v[8:11], v[32:47]
s_waitcnt lgkmcnt(2)
ds_read_b128 v[24:27], v71 offset:1024
v_mfma_f32_32x32x16_bf16 v[32:47], v[240:243], v[12:15], v[32:47]
s_add_u32 s44, s44, 1
s_cmp_eq_u32 s44, 3
s_mov_b32 s56, 40960
s_cmov_b32 s56, -81920
s_cselect_b32 s44, 0, s44
v_add_u32 v64, s56, v64
v_add_u32 v65, s56, v65
v_add_u32 v66, s56, v66
v_add_u32 v67, s56, v67
v_add_u32 v68, s56, v68
v_add_u32 v69, s56, v69
v_add_u32 v70, s56, v70
v_add_u32 v71, s56, v71
s_waitcnt vmcnt(10) lgkmcnt(2)
s_barrier
ds_read_b128 v[8:11], v64 offset:0
v_mfma_f32_32x32x16_bf16 v[32:47], v[244:247], v[16:19], v[32:47]
s_waitcnt lgkmcnt(2)
ds_read_b128 v[12:15], v65 offset:0
v_mfma_f32_32x32x16_bf16 v[32:47], v[248:251], v[20:23], v[32:47]
s_waitcnt lgkmcnt(2)
ds_read_b128 v[16:19], v66 offset:0
v_mfma_f32_32x32x16_bf16 v[32:47], v[252:255], v[24:27], v[32:47]
s_waitcnt lgkmcnt(2)
ds_read_b128 v[20:23], v67 offset:0
k_st_89:
v_mfma_f32_32x32x16_bf16 v[48:63], v[96:99], v[8:11], 0
s_waitcnt lgkmcnt(2)
ds_read_b128 v[24:27], v68 offset:0
v_mfma_f32_32x32x16_bf16 v[48:63], v[100:103], v[12:15], v[48:63]
s_waitcnt lgkmcnt(2)
ds_read_b128 v[8:11], v69 offset:0
v_cvt_pk_bf16_f32 v32, v32, v33
v_cvt_pk_bf16_f32 v33, v34, v35
v_mfma_f32_32x32x16_bf16 v[48:63], v[104:107], v[16:19], v[48:63]
s_waitcnt lgkmcnt(2)
ds_read_b128 v[12:15], v70 offset:0
v_cvt_pk_bf16_f32 v34, v36, v37
v_cvt_pk_bf16_f32 v35, v38, v39
v_mfma_f32_32x32x16_bf16 v[48:63], v[108:111], v[20:23], v[48:63]
s_waitcnt lgkmcnt(2)
ds_read_b128 v[16:19], v71 offset:0
v_cvt_pk_bf16_f32 v36, v40, v41
v_cvt_pk_bf16_f32 v37, v42, v43
v_mfma_f32_32x32x16_bf16 v[48:63], v[112:115], v[24:27], v[48:63]
s_waitcnt lgkmcnt(2)
ds_read_b128 v[20:23], v64 offset:256
v_cvt_pk_bf16_f32 v38, v44, v45
v_cvt_pk_bf16_f32 v39, v46, v47
v_mfma_f32_32x32x16_bf16 v[48:63], v[116:119], v[8:11], v[48:63]
s_waitcnt lgkmcnt(2)
ds_read_b128 v[24:27], v65 offset:256
buffer_store_dwordx4 v[32:35], v0, s[4:7], s48 offen offset:0 sc1
buffer_store_dwordx4 v[36:39], v0, s[4:7], s48 offen offset:1024 sc1
v_mfma_f32_32x32x16_bf16 v[48:63], v[120:123], v[12:15], v[48:63]
s_waitcnt lgkmcnt(2)
ds_read_b128 v[8:11], v66 offset:256
s_add_u32 s48, s48, 40960
s_add_u32 m0, s45, 0
s_nop 0
buffer_load_dwordx4 v72, s[36:39], s46 offen lds
v_mfma_f32_32x32x16_bf16 v[48:63], v[124:127], v[16:19], v[48:63]
s_waitcnt lgkmcnt(2)
ds_read_b128 v[12:15], v67 offset:256
s_add_u32 m0, s45, 1024
s_nop 0
buffer_load_dwordx4 v73, s[36:39], s46 offen lds
s_add_u32 m0, s45, 2048
s_nop 0
buffer_load_dwordx4 v74, s[36:39], s46 offen lds
v_mfma_f32_32x32x16_bf16 v[48:63], v[128:131], v[20:23], v[48:63]
s_waitcnt lgkmcnt(2)
ds_read_b128 v[16:19], v68 offset:256
s_add_u32 m0, s45, 3072
s_nop 0
buffer_load_dwordx4 v75, s[36:39], s46 offen lds
s_add_u32 m0, s45, 4096
s_nop 0
buffer_load_dwordx4 v76, s[36:39], s46 offen lds
v_mfma_f32_32x32x16_bf16 v[48:63], v[132:135], v[24:27], v[48:63]
s_waitcnt lgkmcnt(2)
ds_read_b128 v[20:23], v69 offset:256
s_add_u32 m0, s45, 5120
s_nop 0
buffer_load_dwordx4 v77, s[36:39], s46 offen lds
s_add_u32 m0, s45, 6144
s_nop 0
buffer_load_dwordx4 v78, s[36:39], s46 offen lds
v_mfma_f32_32x32x16_bf16 v[48:63], v[136:139], v[8:11], v[48:63]
s_waitcnt lgkmcnt(2)
ds_read_b128 v[24:27], v70 offset:256
s_add_u32 m0, s45, 7168
s_nop 0
buffer_load_dwordx4 v79, s[36:39], s46 offen lds
s_add_u32 m0, s45, 8192
s_nop 0
buffer_load_dwordx4 v80, s[36:39], s46 offen lds
v_mfma_f32_32x32x16_bf16 v[48:63], v[140:143], v[12:15], v[48:63]
s_waitcnt lgkmcnt(2)
ds_read_b128 v[8:11], v71 offset:256
s_add_u32 m0, s45, 9216
s_nop 0
buffer_load_dwordx4 v81, s[36:39], s46 offen lds
s_add_u32 s45, s45, 40960
s_cmp_ge_u32 s45, 122880
s_cselect_b32 s55, 122880, 0
s_sub_u32 s45, s45, s55
v_mfma_f32_32x32x16_bf16 v[48:63], v[144:147], v[16:19], v[48:63]
s_waitcnt lgkmcnt(2)
ds_read_b128 v[12:15], v64 offset:512
s_add_u32 s47, s47, 1
s_cmp_lt_u32 s47, 4
s_cselect_b32 s55, 40960, 0
s_add_u32 s46, s46, s55
v_mfma_f32_32x32x16_bf16 v[48:63], v[148:151], v[20:23], v[48:63]
s_waitcnt lgkmcnt(2)
ds_read_b128 v[16:19], v65 offset:512
v_mfma_f32_32x32x16_bf16 v[48:63], v[152:155], v[24:27], v[48:63]
s_waitcnt lgkmcnt(2)
ds_read_b128 v[20:23], v66 offset:512
v_mfma_f32_32x32x16_bf16 v[48:63], v[156:159], v[8:11], v[48:63]
s_waitcnt lgkmcnt(2)
ds_read_b128 v[24:27], v67 offset:512
v_mfma_f32_32x32x16_bf16 v[48:63], v[160:163], v[12:15], v[48:63]
s_waitcnt lgkmcnt(2)
ds_read_b128 v[8:11], v68 offset:512
v_mfma_f32_32x32x16_bf16 v[48:63], v[164:167], v[16:19], v[48:63]
s_waitcnt lgkmcnt(2)
ds_read_b128 v[12:15], v69 offset:512
v_mfma_f32_32x32x16_bf16 v[48:63], v[168:171], v[20:23], v[48:63]
s_waitcnt lgkmcnt(2)
ds_read_b128 v[16:19], v70 offset:512
v_mfma_f32_32x32x16_bf16 v[48:63], v[172:175], v[24:27], v[48:63]
s_waitcnt lgkmcnt(2)
ds_read_b128 v[20:23], v71 offset:512
v_mfma_f32_32x32x16_bf16 v[48:63], v[176:179], v[8:11], v[48:63]
s_waitcnt lgkmcnt(2)
ds_read_b128 v[24:27], v64 offset:768
v_mfma_f32_32x32x16_bf16 v[48:63], v[180:183], v[12:15], v[48:63]
s_waitcnt lgkmcnt(2)
ds_read_b128 v[8:11], v65 offset:768
v_mfma_f32_32x32x16_bf16 v[48:63], v[184:187], v[16:19], v[48:63]
s_waitcnt lgkmcnt(2)
ds_read_b128 v[12:15], v66 offset:768
v_mfma_f32_32x32x16_bf16 v[48:63], v[188:191], v[20:23], v[48:63]
s_waitcnt lgkmcnt(2)
ds_read_b128 v[16:19], v67 offset:768
v_mfma_f32_32x32x16_bf16 v[48:63], v[192:195], v[24:27], v[48:63]
s_waitcnt lgkmcnt(2)
ds_read_b128 v[20:23], v68 offset:768
v_mfma_f32_32x32x16_bf16 v[48:63], v[196:199], v[8:11], v[48:63]
s_waitcnt lgkmcnt(2)
ds_read_b128 v[24:27], v69 offset:768
v_mfma_f32_32x32x16_bf16 v[48:63], v[200:203], v[12:15], v[48:63]
s_waitcnt lgkmcnt(2)
ds_read_b128 v[8:11], v70 offset:768
v_mfma_f32_32x32x16_bf16 v[48:63], v[204:207], v[16:19], v[48:63]
s_waitcnt lgkmcnt(2)
ds_read_b128 v[12:15], v71 offset:768
v_mfma_f32_32x32x16_bf16 v[48:63], v[208:211], v[20:23], v[48:63]
s_waitcnt lgkmcnt(2)
ds_read_b128 v[16:19], v64 offset:1024
v_mfma_f32_32x32x16_bf16 v[48:63], v[212:215], v[24:27], v[48:63]
s_waitcnt lgkmcnt(2)
ds_read_b128 v[20:23], v65 offset:1024
v_mfma_f32_32x32x16_bf16 v[48:63], v[216:219], v[8:11], v[48:63]
s_waitcnt lgkmcnt(2)
ds_read_b128 v[24:27], v66 offset:1024
v_mfma_f32_32x32x16_bf16 v[48:63], v[220:223], v[12:15], v[48:63]
s_waitcnt lgkmcnt(2)
ds_read_b128 v[8:11], v67 offset:1024
v_mfma_f32_32x32x16_bf16 v[48:63], v[224:227], v[16:19], v[48:63]
s_waitcnt lgkmcnt(2)
ds_read_b128 v[12:15], v68 offset:1024
v_mfma_f32_32x32x16_bf16 v[48:63], v[228:231], v[20:23], v[48:63]
s_waitcnt lgkmcnt(2)
ds_read_b128 v[16:19], v69 offset:1024
v_mfma_f32_32x32x16_bf16 v[48:63], v[232:235], v[24:27], v[48:63]
s_waitcnt lgkmcnt(2)
ds_read_b128 v[20:23], v70 offset:1024
v_mfma_f32_32x32x16_bf16 v[48:63], v[236:239], v[8:11], v[48:63]
s_waitcnt lgkmcnt(2)
ds_read_b128 v[24:27], v71 offset:1024
v_mfma_f32_32x32x16_bf16 v[48:63], v[240:243], v[12:15], v[48:63]
s_add_u32 s44, s44, 1
s_cmp_eq_u32 s44, 3
s_mov_b32 s56, 40960
s_cmov_b32 s56, -81920
s_cselect_b32 s44, 0, s44
v_add_u32 v64, s56, v64
v_add_u32 v65, s56, v65
v_add_u32 v66, s56, v66
v_add_u32 v67, s56, v67
v_add_u32 v68, s56, v68
v_add_u32 v69, s56, v69
v_add_u32 v70, s56, v70
v_add_u32 v71, s56, v71
s_waitcnt vmcnt(10) lgkmcnt(2)
s_barrier
ds_read_b128 v[8:11], v64 offset:0
v_mfma_f32_32x32x16_bf16 v[48:63], v[244:247], v[16:19], v[48:63]
s_waitcnt lgkmcnt(2)
ds_read_b128 v[12:15], v65 offset:0
v_mfma_f32_32x32x16_bf16 v[48:63], v[248:251], v[20:23], v[48:63]
s_waitcnt lgkmcnt(2)
ds_read_b128 v[16:19], v66 offset:0
v_mfma_f32_32x32x16_bf16 v[48:63], v[252:255], v[24:27], v[48:63]
s_waitcnt lgkmcnt(2)
ds_read_b128 v[20:23], v67 offset:0
s_sub_u32 s59, s59, 1
s_cmp_eq_u32 s59, 0
s_cbranch_scc1 k_so_90
v_mfma_f32_32x32x16_bf16 v[32:47], v[96:99], v[8:11], 0
s_waitcnt lgkmcnt(2)
ds_read_b128 v[24:27], v68 offset:0
v_mfma_f32_32x32x16_bf16 v[32:47], v[100:103], v[12:15], v[32:47]
s_waitcnt lgkmcnt(2)
ds_read_b128 v[8:11], v69 offset:0
v_cvt_pk_bf16_f32 v48, v48, v49
v_cvt_pk_bf16_f32 v49, v50, v51
v_mfma_f32_32x32x16_bf16 v[32:47], v[104:107], v[16:19], v[32:47]
s_waitcnt lgkmcnt(2)
ds_read_b128 v[12:15], v70 offset:0
v_cvt_pk_bf16_f32 v50, v52, v53
v_cvt_pk_bf16_f32 v51, v54, v55
v_mfma_f32_32x32x16_bf16 v[32:47], v[108:111], v[20:23], v[32:47]
s_waitcnt lgkmcnt(2)
ds_read_b128 v[16:19], v71 offset:0
v_cvt_pk_bf16_f32 v52, v56, v57
v_cvt_pk_bf16_f32 v53, v58, v59
v_mfma_f32_32x32x16_bf16 v[32:47], v[112:115], v[24:27], v[32:47]
s_waitcnt lgkmcnt(2)
ds_read_b128 v[20:23], v64 offset:256
v_cvt_pk_bf16_f32 v54, v60, v61
v_cvt_pk_bf16_f32 v55, v62, v63
v_mfma_f32_32x32x16_bf16 v[32:47], v[116:119], v[8:11], v[32:47]
s_waitcnt lgkmcnt(2)
ds_read_b128 v[24:27], v65 offset:256
buffer_store_dwordx4 v[48:51], v0, s[4:7], s48 offen offset:0 sc1
buffer_store_dwordx4 v[52:55], v0, s[4:7], s48 offen offset:1024 sc1
v_mfma_f32_32x32x16_bf16 v[32:47], v[120:123], v[12:15], v[32:47]
s_waitcnt lgkmcnt(2)
ds_read_b128 v[8:11], v66 offset:256
s_add_u32 s48, s48, 40960
s_add_u32 m0, s45, 0
s_nop 0
buffer_load_dwordx4 v72, s[36:39], s46 offen lds
v_mfma_f32_32x32x16_bf16 v[32:47], v[124:127], v[16:19], v[32:47]
s_waitcnt lgkmcnt(2)
ds_read_b128 v[12:15], v67 offset:256
s_add_u32 m0, s45, 1024
s_nop 0
buffer_load_dwordx4 v73, s[36:39], s46 offen lds
s_add_u32 m0, s45, 2048
s_nop 0
buffer_load_dwordx4 v74, s[36:39], s46 offen lds
v_mfma_f32_32x32x16_bf16 v[32:47], v[128:131], v[20:23], v[32:47]
s_waitcnt lgkmcnt(2)
ds_read_b128 v[16:19], v68 offset:256
s_add_u32 m0, s45, 3072
s_nop 0
buffer_load_dwordx4 v75, s[36:39], s46 offen lds
s_add_u32 m0, s45, 4096
s_nop 0
buffer_load_dwordx4 v76, s[36:39], s46 offen lds
v_mfma_f32_32x32x16_bf16 v[32:47], v[132:135], v[24:27], v[32:47]
s_waitcnt lgkmcnt(2)
ds_read_b128 v[20:23], v69 offset:256
s_add_u32 m0, s45, 5120
s_nop 0
buffer_load_dwordx4 v77, s[36:39], s46 offen lds
s_add_u32 m0, s45, 6144
s_nop 0
buffer_load_dwordx4 v78, s[36:39], s46 offen lds
v_mfma_f32_32x32x16_bf16 v[32:47], v[136:139], v[8:11], v[32:47]
s_waitcnt lgkmcnt(2)
ds_read_b128 v[24:27], v70 offset:256
s_add_u32 m0, s45, 7168
s_nop 0
buffer_load_dwordx4 v79, s[36:39], s46 offen lds
s_add_u32 m0, s45, 8192
s_nop 0
buffer_load_dwordx4 v80, s[36:39], s46 offen lds
v_mfma_f32_32x32x16_bf16 v[32:47], v[140:143], v[12:15], v[32:47]
s_waitcnt lgkmcnt(2)
ds_read_b128 v[8:11], v71 offset:256
s_add_u32 m0, s45, 9216
s_nop 0
buffer_load_dwordx4 v81, s[36:39], s46 offen lds
s_add_u32 s45, s45, 40960
s_cmp_ge_u32 s45, 122880
s_cselect_b32 s55, 122880, 0
s_sub_u32 s45, s45, s55
v_mfma_f32_32x32x16_bf16 v[32:47], v[144:147], v[16:19], v[32:47]
s_waitcnt lgkmcnt(2)
ds_read_b128 v[12:15], v64 offset:512
s_add_u32 s47, s47, 1
s_cmp_lt_u32 s47, 4
s_cselect_b32 s55, 40960, 0
s_add_u32 s46, s46, s55
v_mfma_f32_32x32x16_bf16 v[32:47], v[148:151], v[20:23], v[32:47]
s_waitcnt lgkmcnt(2)
ds_read_b128 v[16:19], v65 offset:512
v_mfma_f32_32x32x16_bf16 v[32:47], v[152:155], v[24:27], v[32:47]
s_waitcnt lgkmcnt(2)
ds_read_b128 v[20:23], v66 offset:512
v_mfma_f32_32x32x16_bf16 v[32:47], v[156:159], v[8:11], v[32:47]
s_waitcnt lgkmcnt(2)
ds_read_b128 v[24:27], v67 offset:512
v_mfma_f32_32x32x16_bf16 v[32:47], v[160:163], v[12:15], v[32:47]
s_waitcnt lgkmcnt(2)
ds_read_b128 v[8:11], v68 offset:512
v_mfma_f32_32x32x16_bf16 v[32:47], v[164:167], v[16:19], v[32:47]
s_waitcnt lgkmcnt(2)
ds_read_b128 v[12:15], v69 offset:512
v_mfma_f32_32x32x16_bf16 v[32:47], v[168:171], v[20:23], v[32:47]
s_waitcnt lgkmcnt(2)
ds_read_b128 v[16:19], v70 offset:512
v_mfma_f32_32x32x16_bf16 v[32:47], v[172:175], v[24:27], v[32:47]
s_waitcnt lgkmcnt(2)
ds_read_b128 v[20:23], v71 offset:512
v_mfma_f32_32x32x16_bf16 v[32:47], v[176:179], v[8:11], v[32:47]
s_waitcnt lgkmcnt(2)
ds_read_b128 v[24:27], v64 offset:768
v_mfma_f32_32x32x16_bf16 v[32:47], v[180:183], v[12:15], v[32:47]
s_waitcnt lgkmcnt(2)
ds_read_b128 v[8:11], v65 offset:768
v_mfma_f32_32x32x16_bf16 v[32:47], v[184:187], v[16:19], v[32:47]
s_waitcnt lgkmcnt(2)
ds_read_b128 v[12:15], v66 offset:768
v_mfma_f32_32x32x16_bf16 v[32:47], v[188:191], v[20:23], v[32:47]
s_waitcnt lgkmcnt(2)
ds_read_b128 v[16:19], v67 offset:768
v_mfma_f32_32x32x16_bf16 v[32:47], v[192:195], v[24:27], v[32:47]
s_waitcnt lgkmcnt(2)
ds_read_b128 v[20:23], v68 offset:768
v_mfma_f32_32x32x16_bf16 v[32:47], v[196:199], v[8:11], v[32:47]
s_waitcnt lgkmcnt(2)
ds_read_b128 v[24:27], v69 offset:768
v_mfma_f32_32x32x16_bf16 v[32:47], v[200:203], v[12:15], v[32:47]
s_waitcnt lgkmcnt(2)
ds_read_b128 v[8:11], v70 offset:768
v_mfma_f32_32x32x16_bf16 v[32:47], v[204:207], v[16:19], v[32:47]
s_waitcnt lgkmcnt(2)
ds_read_b128 v[12:15], v71 offset:768
v_mfma_f32_32x32x16_bf16 v[32:47], v[208:211], v[20:23], v[32:47]
s_waitcnt lgkmcnt(2)
ds_read_b128 v[16:19], v64 offset:1024
v_mfma_f32_32x32x16_bf16 v[32:47], v[212:215], v[24:27], v[32:47]
s_waitcnt lgkmcnt(2)
ds_read_b128 v[20:23], v65 offset:1024
v_mfma_f32_32x32x16_bf16 v[32:47], v[216:219], v[8:11], v[32:47]
s_waitcnt lgkmcnt(2)
ds_read_b128 v[24:27], v66 offset:1024
v_mfma_f32_32x32x16_bf16 v[32:47], v[220:223], v[12:15], v[32:47]
s_waitcnt lgkmcnt(2)
ds_read_b128 v[8:11], v67 offset:1024
v_mfma_f32_32x32x16_bf16 v[32:47], v[224:227], v[16:19], v[32:47]
s_waitcnt lgkmcnt(2)
ds_read_b128 v[12:15], v68 offset:1024
v_mfma_f32_32x32x16_bf16 v[32:47], v[228:231], v[20:23], v[32:47]
s_waitcnt lgkmcnt(2)
ds_read_b128 v[16:19], v69 offset:1024
v_mfma_f32_32x32x16_bf16 v[32:47], v[232:235], v[24:27], v[32:47]
s_waitcnt lgkmcnt(2)
ds_read_b128 v[20:23], v70 offset:1024
v_mfma_f32_32x32x16_bf16 v[32:47], v[236:239], v[8:11], v[32:47]
s_waitcnt lgkmcnt(2)
ds_read_b128 v[24:27], v71 offset:1024
v_mfma_f32_32x32x16_bf16 v[32:47], v[240:243], v[12:15], v[32:47]
s_add_u32 s44, s44, 1
s_cmp_eq_u32 s44, 3
s_mov_b32 s56, 40960
s_cmov_b32 s56, -81920
s_cselect_b32 s44, 0, s44
v_add_u32 v64, s56, v64
v_add_u32 v65, s56, v65
v_add_u32 v66, s56, v66
v_add_u32 v67, s56, v67
v_add_u32 v68, s56, v68
v_add_u32 v69, s56, v69
v_add_u32 v70, s56, v70
v_add_u32 v71, s56, v71
s_waitcnt vmcnt(10) lgkmcnt(2)
s_barrier
ds_read_b128 v[8:11], v64 offset:0
v_mfma_f32_32x32x16_bf16 v[32:47], v[244:247], v[16:19], v[32:47]
s_waitcnt lgkmcnt(2)
ds_read_b128 v[12:15], v65 offset:0
v_mfma_f32_32x32x16_bf16 v[32:47], v[248:251], v[20:23], v[32:47]
s_waitcnt lgkmcnt(2)
ds_read_b128 v[16:19], v66 offset:0
v_mfma_f32_32x32x16_bf16 v[32:47], v[252:255], v[24:27], v[32:47]
s_waitcnt lgkmcnt(2)
ds_read_b128 v[20:23], v67 offset:0
s_branch k_st_89
k_so_90:
s_nop 6
v_cvt_pk_bf16_f32 v48, v48, v49
v_cvt_pk_bf16_f32 v49, v50, v51
v_cvt_pk_bf16_f32 v50, v52, v53
v_cvt_pk_bf16_f32 v51, v54, v55
v_cvt_pk_bf16_f32 v52, v56, v57
v_cvt_pk_bf16_f32 v53, v58, v59
v_cvt_pk_bf16_f32 v54, v60, v61
v_cvt_pk_bf16_f32 v55, v62, v63
buffer_store_dwordx4 v[48:51], v0, s[4:7], s48 offen offset:0 sc1
buffer_store_dwordx4 v[52:55], v0, s[4:7], s48 offen offset:1024 sc1
s_add_u32 s48, s48, 40960
s_lshl_b32 s54, s30, 6
s_add_u32 s54, s54, 222298112
s_waitcnt lgkmcnt(0)
s_waitcnt vmcnt(0)
s_barrier
s_cmp_lg_u32 s3, 0
s_cbranch_scc1 k_s8_91
s_mov_b64 exec, 1
v_mov_b32 v2, 1
buffer_store_dword v2, off, s[4:7], s54 sc1
s_mov_b64 exec, -1
k_s8_91:
s_mul_i32 s52, s3, 640
v_lshrrev_b32 v8, 4, v0
v_add_u32 v8, s52, v8
s_mov_b32 s53, 52429
v_add_u32 v9, 0, v8
v_mul_u32_u24 v10, s53, v9
v_lshrrev_b32 v10, 22, v10
v_mul_u32_u24 v11, 80, v10
v_sub_u32 v9, v9, v11
v_and_b32 v11, 15, v10
v_xor_b32 v9, v9, v11
v_and_b32 v11, 1, v10
v_bfe_u32 v12, v10, 1, 1
v_lshl_add_u32 v11, v12, 4, v11
v_bfe_u32 v12, v10, 2, 1
v_lshl_add_u32 v11, v12, 6, v11
v_bfe_u32 v12, v10, 3, 1
v_lshl_add_u32 v11, v12, 1, v11
v_bfe_u32 v12, v10, 4, 1
v_lshl_add_u32 v10, v12, 3, v11
v_mul_u32_u24 v10, 1280, v10
v_lshl_add_u32 v72, v9, 4, v10
v_add_u32 v9, 64, v8
v_mul_u32_u24 v10, s53, v9
v_lshrrev_b32 v10, 22, v10
v_mul_u32_u24 v11, 80, v10
v_sub_u32 v9, v9, v11
v_and_b32 v11, 15, v10
v_xor_b32 v9, v9, v11
v_and_b32 v11, 1, v10
v_bfe_u32 v12, v10, 1, 1
v_lshl_add_u32 v11, v12, 4, v11
v_bfe_u32 v12, v10, 2, 1
v_lshl_add_u32 v11, v12, 6, v11
v_bfe_u32 v12, v10, 3, 1
v_lshl_add_u32 v11, v12, 1, v11
v_bfe_u32 v12, v10, 4, 1
v_lshl_add_u32 v10, v12, 3, v11
v_mul_u32_u24 v10, 1280, v10
v_lshl_add_u32 v73, v9, 4, v10
v_add_u32 v9, 128, v8
v_mul_u32_u24 v10, s53, v9
v_lshrrev_b32 v10, 22, v10
v_mul_u32_u24 v11, 80, v10
v_sub_u32 v9, v9, v11
v_and_b32 v11, 15, v10
v_xor_b32 v9, v9, v11
v_and_b32 v11, 1, v10
v_bfe_u32 v12, v10, 1, 1
v_lshl_add_u32 v11, v12, 4, v11
v_bfe_u32 v12, v10, 2, 1
v_lshl_add_u32 v11, v12, 6, v11
v_bfe_u32 v12, v10, 3, 1
v_lshl_add_u32 v11, v12, 1, v11
v_bfe_u32 v12, v10, 4, 1
v_lshl_add_u32 v10, v12, 3, v11
v_mul_u32_u24 v10, 1280, v10
v_lshl_add_u32 v74, v9, 4, v10
v_add_u32 v9, 192, v8
v_mul_u32_u24 v10, s53, v9
v_lshrrev_b32 v10, 22, v10
v_mul_u32_u24 v11, 80, v10
v_sub_u32 v9, v9, v11
v_and_b32 v11, 15, v10
v_xor_b32 v9, v9, v11
v_and_b32 v11, 1, v10
v_bfe_u32 v12, v10, 1, 1
v_lshl_add_u32 v11, v12, 4, v11
v_bfe_u32 v12, v10, 2, 1
v_lshl_add_u32 v11, v12, 6, v11
v_bfe_u32 v12, v10, 3, 1
v_lshl_add_u32 v11, v12, 1, v11
v_bfe_u32 v12, v10, 4, 1
v_lshl_add_u32 v10, v12, 3, v11
v_mul_u32_u24 v10, 1280, v10
v_lshl_add_u32 v75, v9, 4, v10
v_add_u32 v9, 256, v8
v_mul_u32_u24 v10, s53, v9
v_lshrrev_b32 v10, 22, v10
v_mul_u32_u24 v11, 80, v10
v_sub_u32 v9, v9, v11
v_and_b32 v11, 15, v10
v_xor_b32 v9, v9, v11
v_and_b32 v11, 1, v10
v_bfe_u32 v12, v10, 1, 1
v_lshl_add_u32 v11, v12, 4, v11
v_bfe_u32 v12, v10, 2, 1
v_lshl_add_u32 v11, v12, 6, v11
v_bfe_u32 v12, v10, 3, 1
v_lshl_add_u32 v11, v12, 1, v11
v_bfe_u32 v12, v10, 4, 1
v_lshl_add_u32 v10, v12, 3, v11
v_mul_u32_u24 v10, 1280, v10
v_lshl_add_u32 v76, v9, 4, v10
v_add_u32 v9, 320, v8
v_mul_u32_u24 v10, s53, v9
v_lshrrev_b32 v10, 22, v10
v_mul_u32_u24 v11, 80, v10
v_sub_u32 v9, v9, v11
v_and_b32 v11, 15, v10
v_xor_b32 v9, v9, v11
v_and_b32 v11, 1, v10
v_bfe_u32 v12, v10, 1, 1
v_lshl_add_u32 v11, v12, 4, v11
v_bfe_u32 v12, v10, 2, 1
v_lshl_add_u32 v11, v12, 6, v11
v_bfe_u32 v12, v10, 3, 1
v_lshl_add_u32 v11, v12, 1, v11
v_bfe_u32 v12, v10, 4, 1
v_lshl_add_u32 v10, v12, 3, v11
v_mul_u32_u24 v10, 1280, v10
v_lshl_add_u32 v77, v9, 4, v10
v_add_u32 v9, 384, v8
v_mul_u32_u24 v10, s53, v9
v_lshrrev_b32 v10, 22, v10
v_mul_u32_u24 v11, 80, v10
v_sub_u32 v9, v9, v11
v_and_b32 v11, 15, v10
v_xor_b32 v9, v9, v11
v_and_b32 v11, 1, v10
v_bfe_u32 v12, v10, 1, 1
v_lshl_add_u32 v11, v12, 4, v11
v_bfe_u32 v12, v10, 2, 1
v_lshl_add_u32 v11, v12, 6, v11
v_bfe_u32 v12, v10, 3, 1
v_lshl_add_u32 v11, v12, 1, v11
v_bfe_u32 v12, v10, 4, 1
v_lshl_add_u32 v10, v12, 3, v11
v_mul_u32_u24 v10, 1280, v10
v_lshl_add_u32 v78, v9, 4, v10
v_add_u32 v9, 448, v8
v_mul_u32_u24 v10, s53, v9
v_lshrrev_b32 v10, 22, v10
v_mul_u32_u24 v11, 80, v10
v_sub_u32 v9, v9, v11
v_and_b32 v11, 15, v10
v_xor_b32 v9, v9, v11
v_and_b32 v11, 1, v10
v_bfe_u32 v12, v10, 1, 1
v_lshl_add_u32 v11, v12, 4, v11
v_bfe_u32 v12, v10, 2, 1
v_lshl_add_u32 v11, v12, 6, v11
v_bfe_u32 v12, v10, 3, 1
v_lshl_add_u32 v11, v12, 1, v11
v_bfe_u32 v12, v10, 4, 1
v_lshl_add_u32 v10, v12, 3, v11
v_mul_u32_u24 v10, 1280, v10
v_lshl_add_u32 v79, v9, 4, v10
v_add_u32 v9, 512, v8
v_mul_u32_u24 v10, s53, v9
v_lshrrev_b32 v10, 22, v10
v_mul_u32_u24 v11, 80, v10
v_sub_u32 v9, v9, v11
v_and_b32 v11, 15, v10
v_xor_b32 v9, v9, v11
v_and_b32 v11, 1, v10
v_bfe_u32 v12, v10, 1, 1
v_lshl_add_u32 v11, v12, 4, v11
v_bfe_u32 v12, v10, 2, 1
v_lshl_add_u32 v11, v12, 6, v11
v_bfe_u32 v12, v10, 3, 1
v_lshl_add_u32 v11, v12, 1, v11
v_bfe_u32 v12, v10, 4, 1
v_lshl_add_u32 v10, v12, 3, v11
v_mul_u32_u24 v10, 1280, v10
v_lshl_add_u32 v80, v9, 4, v10
v_add_u32 v9, 576, v8
v_mul_u32_u24 v10, s53, v9
v_lshrrev_b32 v10, 22, v10
v_mul_u32_u24 v11, 80, v10
v_sub_u32 v9, v9, v11
v_and_b32 v11, 15, v10
v_xor_b32 v9, v9, v11
v_and_b32 v11, 1, v10
v_bfe_u32 v12, v10, 1, 1
v_lshl_add_u32 v11, v12, 4, v11
v_bfe_u32 v12, v10, 2, 1
v_lshl_add_u32 v11, v12, 6, v11
v_bfe_u32 v12, v10, 3, 1
v_lshl_add_u32 v11, v12, 1, v11
v_bfe_u32 v12, v10, 4, 1
v_lshl_add_u32 v10, v12, 3, v11
v_mul_u32_u24 v10, 1280, v10
v_lshl_add_u32 v81, v9, 4, v10
s_mul_i32 s49, s57, 327680
s_mov_b32 s46, s49
s_mov_b32 s47, 0
s_lshl_b32 s48, s58, 18
s_lshl_b32 s52, s57, 14
s_add_u32 s48, s48, s52
s_add_u32 s48, s48, 216006656
s_mov_b32 s50, 512
v_bfe_u32 v2, v0, 6, 1
v_bfe_u32 v3, v0, 7, 1
v_and_b32 v1, 0x30, v0
v_lshl_add_u32 v1, v2, 7, v1
v_lshl_add_u32 v1, v3, 6, v1
v_bfe_u32 v2, v0, 8, 1
v_lshl_add_u32 v1, v2, 11, v1
v_bfe_u32 v2, v0, 9, 1
v_lshl_add_u32 v1, v2, 8, v1
s_mul_i32 s45, s3, 10240
s_mov_b32 s44, 0
v_bfe_u32 v8, v0, 4, 5
v_mul_u32_u24 v9, 1280, v8
v_and_b32 v8, 15, v8
v_lshrrev_b32 v10, 9, v0
v_xor_b32 v8, v8, v10
v_xor_b32 v10, 0, v8
v_lshl_add_u32 v64, v10, 4, v9
v_xor_b32 v10, 2, v8
v_lshl_add_u32 v65, v10, 4, v9
v_xor_b32 v10, 4, v8
v_lshl_add_u32 v66, v10, 4, v9
v_xor_b32 v10, 6, v8
v_lshl_add_u32 v67, v10, 4, v9
v_xor_b32 v10, 8, v8
v_lshl_add_u32 v68, v10, 4, v9
v_xor_b32 v10, 10, v8
v_lshl_add_u32 v69, v10, 4, v9
v_xor_b32 v10, 12, v8
v_lshl_add_u32 v70, v10, 4, v9
v_xor_b32 v10, 14, v8
v_lshl_add_u32 v71, v10, 4, v9
s_add_u32 m0, s45, 0
s_nop 0
buffer_load_dwordx4 v72, s[20:23], s46 offen lds
s_add_u32 m0, s45, 1024
s_nop 0
buffer_load_dwordx4 v73, s[20:23], s46 offen lds
s_add_u32 m0, s45, 2048
s_nop 0
buffer_load_dwordx4 v74, s[20:23], s46 offen lds
s_add_u32 m0, s45, 3072
s_nop 0
buffer_load_dwordx4 v75, s[20:23], s46 offen lds
s_add_u32 m0, s45, 4096
s_nop 0
buffer_load_dwordx4 v76, s[20:23], s46 offen lds
s_add_u32 m0, s45, 5120
s_nop 0
buffer_load_dwordx4 v77, s[20:23], s46 offen lds
s_add_u32 m0, s45, 6144
s_nop 0
buffer_load_dwordx4 v78, s[20:23], s46 offen lds
s_add_u32 m0, s45, 7168
s_nop 0
buffer_load_dwordx4 v79, s[20:23], s46 offen lds
s_add_u32 m0, s45, 8192
s_nop 0
buffer_load_dwordx4 v80, s[20:23], s46 offen lds
s_add_u32 m0, s45, 9216
s_nop 0
buffer_load_dwordx4 v81, s[20:23], s46 offen lds
s_add_u32 s45, s45, 40960
s_cmp_ge_u32 s45, 122880
s_cselect_b32 s55, 122880, 0
s_sub_u32 s45, s45, s55
s_add_u32 s47, s47, 1
s_and_b32 s55, s47, 1
s_mul_i32 s46, s55, 5120
s_and_b32 s55, s47, 2
s_mul_i32 s55, s55, 20480
s_add_u32 s46, s46, s55
s_and_b32 s55, s47, 4
s_mul_i32 s55, s55, 40960
s_add_u32 s46, s46, s55
s_add_u32 s46, s46, s49
s_add_u32 m0, s45, 0
s_nop 0
buffer_load_dwordx4 v72, s[20:23], s46 offen lds
s_add_u32 m0, s45, 1024
s_nop 0
buffer_load_dwordx4 v73, s[20:23], s46 offen lds
s_add_u32 m0, s45, 2048
s_nop 0
buffer_load_dwordx4 v74, s[20:23], s46 offen lds
s_add_u32 m0, s45, 3072
s_nop 0
buffer_load_dwordx4 v75, s[20:23], s46 offen lds
s_add_u32 m0, s45, 4096
s_nop 0
buffer_load_dwordx4 v76, s[20:23], s46 offen lds
s_add_u32 m0, s45, 5120
s_nop 0
buffer_load_dwordx4 v77, s[20:23], s46 offen lds
s_add_u32 m0, s45, 6144
s_nop 0
buffer_load_dwordx4 v78, s[20:23], s46 offen lds
s_add_u32 m0, s45, 7168
s_nop 0
buffer_load_dwordx4 v79, s[20:23], s46 offen lds
s_add_u32 m0, s45, 8192
s_nop 0
buffer_load_dwordx4 v80, s[20:23], s46 offen lds
s_add_u32 m0, s45, 9216
s_nop 0
buffer_load_dwordx4 v81, s[20:23], s46 offen lds
s_add_u32 s45, s45, 40960
s_cmp_ge_u32 s45, 122880
s_cselect_b32 s55, 122880, 0
s_sub_u32 s45, s45, s55
s_add_u32 s47, s47, 1
s_and_b32 s55, s47, 1
s_mul_i32 s46, s55, 5120
s_and_b32 s55, s47, 2
s_mul_i32 s55, s55, 20480
s_add_u32 s46, s46, s55
s_and_b32 s55, s47, 4
s_mul_i32 s55, s55, 40960
s_add_u32 s46, s46, s55
s_add_u32 s46, s46, s49
s_waitcnt vmcnt(10)
s_barrier
ds_read_b128 v[8:11], v64 offset:0
ds_read_b128 v[12:15], v65 offset:0
ds_read_b128 v[16:19], v66 offset:0
ds_read_b128 v[20:23], v67 offset:0
s_mov_b32 s59, 4
s_waitcnt lgkmcnt(3)
v_mfma_f32_32x32x16_bf16 v[32:47], v[8:11], v[96:99], 0
s_waitcnt lgkmcnt(2)
ds_read_b128 v[24:27], v68 offset:0
v_mfma_f32_32x32x16_bf16 v[32:47], v[12:15], v[100:103], v[32:47]
s_waitcnt lgkmcnt(2)
ds_read_b128 v[8:11], v69 offset:0
s_add_u32 m0, s45, 0
s_nop 0
buffer_load_dwordx4 v72, s[20:23], s46 offen lds
s_add_u32 m0, s45, 1024
s_nop 0
buffer_load_dwordx4 v73, s[20:23], s46 offen lds
v_mfma_f32_32x32x16_bf16 v[32:47], v[16:19], v[104:107], v[32:47]
s_waitcnt lgkmcnt(2)
ds_read_b128 v[12:15], v70 offset:0
s_add_u32 m0, s45, 2048
s_nop 0
buffer_load_dwordx4 v74, s[20:23], s46 offen lds
s_add_u32 m0, s45, 3072
s_nop 0
buffer_load_dwordx4 v75, s[20:23], s46 offen lds
v_mfma_f32_32x32x16_bf16 v[32:47], v[20:23], v[108:111], v[32:47]
s_waitcnt lgkmcnt(2)
ds_read_b128 v[16:19], v71 offset:0
s_add_u32 m0, s45, 4096
s_nop 0
buffer_load_dwordx4 v76, s[20:23], s46 offen lds
s_add_u32 m0, s45, 5120
s_nop 0
buffer_load_dwordx4 v77, s[20:23], s46 offen lds
v_mfma_f32_32x32x16_bf16 v[32:47], v[24:27], v[112:115], v[32:47]
s_waitcnt lgkmcnt(2)
ds_read_b128 v[20:23], v64 offset:256
s_add_u32 m0, s45, 6144
s_nop 0
buffer_load_dwordx4 v78, s[20:23], s46 offen lds
s_add_u32 m0, s45, 7168
s_nop 0
buffer_load_dwordx4 v79, s[20:23], s46 offen lds
v_mfma_f32_32x32x16_bf16 v[32:47], v[8:11], v[116:119], v[32:47]
s_waitcnt lgkmcnt(2)
ds_read_b128 v[24:27], v65 offset:256
s_add_u32 m0, s45, 8192
s_nop 0
buffer_load_dwordx4 v80, s[20:23], s46 offen lds
s_add_u32 m0, s45, 9216
s_nop 0
buffer_load_dwordx4 v81, s[20:23], s46 offen lds
v_mfma_f32_32x32x16_bf16 v[32:47], v[12:15], v[120:123], v[32:47]
s_waitcnt lgkmcnt(2)
ds_read_b128 v[8:11], v66 offset:256
s_add_u32 s45, s45, 40960
s_cmp_ge_u32 s45, 122880
s_cselect_b32 s55, 122880, 0
s_sub_u32 s45, s45, s55
s_add_u32 s47, s47, 1
s_and_b32 s55, s47, 1
s_mul_i32 s46, s55, 5120
s_and_b32 s55, s47, 2
s_mul_i32 s55, s55, 20480
s_add_u32 s46, s46, s55
s_and_b32 s55, s47, 4
s_mul_i32 s55, s55, 40960
s_add_u32 s46, s46, s55
s_add_u32 s46, s46, s49
v_mfma_f32_32x32x16_bf16 v[32:47], v[16:19], v[124:127], v[32:47]
s_waitcnt lgkmcnt(2)
ds_read_b128 v[12:15], v67 offset:256
v_mfma_f32_32x32x16_bf16 v[32:47], v[20:23], v[128:131], v[32:47]
s_waitcnt lgkmcnt(2)
ds_read_b128 v[16:19], v68 offset:256
v_mfma_f32_32x32x16_bf16 v[32:47], v[24:27], v[132:135], v[32:47]
s_waitcnt lgkmcnt(2)
ds_read_b128 v[20:23], v69 offset:256
v_mfma_f32_32x32x16_bf16 v[32:47], v[8:11], v[136:139], v[32:47]
s_waitcnt lgkmcnt(2)
ds_read_b128 v[24:27], v70 offset:256
v_mfma_f32_32x32x16_bf16 v[32:47], v[12:15], v[140:143], v[32:47]
s_waitcnt lgkmcnt(2)
ds_read_b128 v[8:11], v71 offset:256
v_mfma_f32_32x32x16_bf16 v[32:47], v[16:19], v[144:147], v[32:47]
s_waitcnt lgkmcnt(2)
ds_read_b128 v[12:15], v64 offset:512
v_mfma_f32_32x32x16_bf16 v[32:47], v[20:23], v[148:151], v[32:47]
s_waitcnt lgkmcnt(2)
ds_read_b128 v[16:19], v65 offset:512
v_mfma_f32_32x32x16_bf16 v[32:47], v[24:27], v[152:155], v[32:47]
s_waitcnt lgkmcnt(2)
ds_read_b128 v[20:23], v66 offset:512
v_mfma_f32_32x32x16_bf16 v[32:47], v[8:11], v[156:159], v[32:47]
s_waitcnt lgkmcnt(2)
ds_read_b128 v[24:27], v67 offset:512
v_mfma_f32_32x32x16_bf16 v[32:47], v[12:15], v[160:163], v[32:47]
s_waitcnt lgkmcnt(2)
ds_read_b128 v[8:11], v68 offset:512
v_mfma_f32_32x32x16_bf16 v[32:47], v[16:19], v[164:167], v[32:47]
s_waitcnt lgkmcnt(2)
ds_read_b128 v[12:15], v69 offset:512
v_mfma_f32_32x32x16_bf16 v[32:47], v[20:23], v[168:171], v[32:47]
s_waitcnt lgkmcnt(2)
ds_read_b128 v[16:19], v70 offset:512
v_mfma_f32_32x32x16_bf16 v[32:47], v[24:27], v[172:175], v[32:47]
s_waitcnt lgkmcnt(2)
ds_read_b128 v[20:23], v71 offset:512
v_mfma_f32_32x32x16_bf16 v[32:47], v[8:11], v[176:179], v[32:47]
s_waitcnt lgkmcnt(2)
ds_read_b128 v[24:27], v64 offset:768
v_mfma_f32_32x32x16_bf16 v[32:47], v[12:15], v[180:183], v[32:47]
s_waitcnt lgkmcnt(2)
ds_read_b128 v[8:11], v65 offset:768
v_mfma_f32_32x32x16_bf16 v[32:47], v[16:19], v[184:187], v[32:47]
s_waitcnt lgkmcnt(2)
ds_read_b128 v[12:15], v66 offset:768
v_mfma_f32_32x32x16_bf16 v[32:47], v[20:23], v[188:191], v[32:47]
s_waitcnt lgkmcnt(2)
ds_read_b128 v[16:19], v67 offset:768
v_mfma_f32_32x32x16_bf16 v[32:47], v[24:27], v[192:195], v[32:47]
s_waitcnt lgkmcnt(2)
ds_read_b128 v[20:23], v68 offset:768
v_mfma_f32_32x32x16_bf16 v[32:47], v[8:11], v[196:199], v[32:47]
s_waitcnt lgkmcnt(2)
ds_read_b128 v[24:27], v69 offset:768
v_mfma_f32_32x32x16_bf16 v[32:47], v[12:15], v[200:203], v[32:47]
s_waitcnt lgkmcnt(2)
ds_read_b128 v[8:11], v70 offset:768
v_mfma_f32_32x32x16_bf16 v[32:47], v[16:19], v[204:207], v[32:47]
s_waitcnt lgkmcnt(2)
ds_read_b128 v[12:15], v71 offset:768
v_mfma_f32_32x32x16_bf16 v[32:47], v[20:23], v[208:211], v[32:47]
s_waitcnt lgkmcnt(2)
ds_read_b128 v[16:19], v64 offset:1024
v_mfma_f32_32x32x16_bf16 v[32:47], v[24:27], v[212:215], v[32:47]
s_waitcnt lgkmcnt(2)
ds_read_b128 v[20:23], v65 offset:1024
v_mfma_f32_32x32x16_bf16 v[32:47], v[8:11], v[216:219], v[32:47]
s_waitcnt lgkmcnt(2)
ds_read_b128 v[24:27], v66 offset:1024
v_mfma_f32_32x32x16_bf16 v[32:47], v[12:15], v[220:223], v[32:47]
s_waitcnt lgkmcnt(2)
ds_read_b128 v[8:11], v67 offset:1024
v_mfma_f32_32x32x16_bf16 v[32:47], v[16:19], v[224:227], v[32:47]
s_waitcnt lgkmcnt(2)
ds_read_b128 v[12:15], v68 offset:1024
v_mfma_f32_32x32x16_bf16 v[32:47], v[20:23], v[228:231], v[32:47]
s_waitcnt lgkmcnt(2)
ds_read_b128 v[16:19], v69 offset:1024
v_mfma_f32_32x32x16_bf16 v[32:47], v[24:27], v[232:235], v[32:47]
s_waitcnt lgkmcnt(2)
ds_read_b128 v[20:23], v70 offset:1024
v_mfma_f32_32x32x16_bf16 v[32:47], v[8:11], v[236:239], v[32:47]
s_waitcnt lgkmcnt(2)
ds_read_b128 v[24:27], v71 offset:1024
v_mfma_f32_32x32x16_bf16 v[32:47], v[12:15], v[240:243], v[32:47]
s_add_u32 s44, s44, 1
s_cmp_eq_u32 s44, 3
s_mov_b32 s56, 40960
s_cmov_b32 s56, -81920
s_cselect_b32 s44, 0, s44
v_add_u32 v64, s56, v64
v_add_u32 v65, s56, v65
v_add_u32 v66, s56, v66
v_add_u32 v67, s56, v67
v_add_u32 v68, s56, v68
v_add_u32 v69, s56, v69
v_add_u32 v70, s56, v70
v_add_u32 v71, s56, v71
s_waitcnt vmcnt(10) lgkmcnt(2)
s_barrier
ds_read_b128 v[8:11], v64 offset:0
v_mfma_f32_32x32x16_bf16 v[32:47], v[16:19], v[244:247], v[32:47]
s_waitcnt lgkmcnt(2)
ds_read_b128 v[12:15], v65 offset:0
v_mfma_f32_32x32x16_bf16 v[32:47], v[20:23], v[248:251], v[32:47]
s_waitcnt lgkmcnt(2)
ds_read_b128 v[16:19], v66 offset:0
v_mfma_f32_32x32x16_bf16 v[32:47], v[24:27], v[252:255], v[32:47]
s_waitcnt lgkmcnt(2)
ds_read_b128 v[20:23], v67 offset:0
k_st_92:
v_mfma_f32_32x32x16_bf16 v[48:63], v[8:11], v[96:99], 0
s_waitcnt lgkmcnt(2)
ds_read_b128 v[24:27], v68 offset:0
v_mfma_f32_32x32x16_bf16 v[48:63], v[12:15], v[100:103], v[48:63]
s_waitcnt lgkmcnt(2)
ds_read_b128 v[8:11], v69 offset:0
v_cvt_pk_bf16_f32 v32, v32, v33
v_cvt_pk_bf16_f32 v33, v34, v35
v_mfma_f32_32x32x16_bf16 v[48:63], v[16:19], v[104:107], v[48:63]
s_waitcnt lgkmcnt(2)
ds_read_b128 v[12:15], v70 offset:0
v_cvt_pk_bf16_f32 v34, v36, v37
v_cvt_pk_bf16_f32 v35, v38, v39
v_mfma_f32_32x32x16_bf16 v[48:63], v[20:23], v[108:111], v[48:63]
s_waitcnt lgkmcnt(2)
ds_read_b128 v[16:19], v71 offset:0
v_cvt_pk_bf16_f32 v36, v40, v41
v_cvt_pk_bf16_f32 v37, v42, v43
v_mfma_f32_32x32x16_bf16 v[48:63], v[24:27], v[112:115], v[48:63]
s_waitcnt lgkmcnt(2)
ds_read_b128 v[20:23], v64 offset:256
v_cvt_pk_bf16_f32 v38, v44, v45
v_cvt_pk_bf16_f32 v39, v46, v47
v_mfma_f32_32x32x16_bf16 v[48:63], v[8:11], v[116:119], v[48:63]
s_waitcnt lgkmcnt(2)
ds_read_b128 v[24:27], v65 offset:256
buffer_store_dwordx4 v[32:35], v1, s[4:7], s48 offen offset:0 sc1
buffer_store_dwordx4 v[36:39], v1, s[4:7], s48 offen offset:1024 sc1
v_mfma_f32_32x32x16_bf16 v[48:63], v[12:15], v[120:123], v[48:63]
s_waitcnt lgkmcnt(2)
ds_read_b128 v[8:11], v66 offset:256
s_add_u32 s48, s48, s50
s_sub_u32 s50, 4096, s50
s_add_u32 m0, s45, 0
s_nop 0
buffer_load_dwordx4 v72, s[20:23], s46 offen lds
v_mfma_f32_32x32x16_bf16 v[48:63], v[16:19], v[124:127], v[48:63]
s_waitcnt lgkmcnt(2)
ds_read_b128 v[12:15], v67 offset:256
s_add_u32 m0, s45, 1024
s_nop 0
buffer_load_dwordx4 v73, s[20:23], s46 offen lds
s_add_u32 m0, s45, 2048
s_nop 0
buffer_load_dwordx4 v74, s[20:23], s46 offen lds
v_mfma_f32_32x32x16_bf16 v[48:63], v[20:23], v[128:131], v[48:63]
s_waitcnt lgkmcnt(2)
ds_read_b128 v[16:19], v68 offset:256
s_add_u32 m0, s45, 3072
s_nop 0
buffer_load_dwordx4 v75, s[20:23], s46 offen lds
s_add_u32 m0, s45, 4096
s_nop 0
buffer_load_dwordx4 v76, s[20:23], s46 offen lds
v_mfma_f32_32x32x16_bf16 v[48:63], v[24:27], v[132:135], v[48:63]
s_waitcnt lgkmcnt(2)
ds_read_b128 v[20:23], v69 offset:256
s_add_u32 m0, s45, 5120
s_nop 0
buffer_load_dwordx4 v77, s[20:23], s46 offen lds
s_add_u32 m0, s45, 6144
s_nop 0
buffer_load_dwordx4 v78, s[20:23], s46 offen lds
v_mfma_f32_32x32x16_bf16 v[48:63], v[8:11], v[136:139], v[48:63]
s_waitcnt lgkmcnt(2)
ds_read_b128 v[24:27], v70 offset:256
s_add_u32 m0, s45, 7168
s_nop 0
buffer_load_dwordx4 v79, s[20:23], s46 offen lds
s_add_u32 m0, s45, 8192
s_nop 0
buffer_load_dwordx4 v80, s[20:23], s46 offen lds
v_mfma_f32_32x32x16_bf16 v[48:63], v[12:15], v[140:143], v[48:63]
s_waitcnt lgkmcnt(2)
ds_read_b128 v[8:11], v71 offset:256
s_add_u32 m0, s45, 9216
s_nop 0
buffer_load_dwordx4 v81, s[20:23], s46 offen lds
s_add_u32 s45, s45, 40960
s_cmp_ge_u32 s45, 122880
s_cselect_b32 s55, 122880, 0
s_sub_u32 s45, s45, s55
v_mfma_f32_32x32x16_bf16 v[48:63], v[16:19], v[144:147], v[48:63]
s_waitcnt lgkmcnt(2)
ds_read_b128 v[12:15], v64 offset:512
s_add_u32 s47, s47, 1
s_and_b32 s55, s47, 1
s_mul_i32 s46, s55, 5120
s_and_b32 s55, s47, 2
s_mul_i32 s55, s55, 20480
s_add_u32 s46, s46, s55
s_and_b32 s55, s47, 4
s_mul_i32 s55, s55, 40960
s_add_u32 s46, s46, s55
s_add_u32 s46, s46, s49
v_mfma_f32_32x32x16_bf16 v[48:63], v[20:23], v[148:151], v[48:63]
s_waitcnt lgkmcnt(2)
ds_read_b128 v[16:19], v65 offset:512
v_mfma_f32_32x32x16_bf16 v[48:63], v[24:27], v[152:155], v[48:63]
s_waitcnt lgkmcnt(2)
ds_read_b128 v[20:23], v66 offset:512
v_mfma_f32_32x32x16_bf16 v[48:63], v[8:11], v[156:159], v[48:63]
s_waitcnt lgkmcnt(2)
ds_read_b128 v[24:27], v67 offset:512
v_mfma_f32_32x32x16_bf16 v[48:63], v[12:15], v[160:163], v[48:63]
s_waitcnt lgkmcnt(2)
ds_read_b128 v[8:11], v68 offset:512
v_mfma_f32_32x32x16_bf16 v[48:63], v[16:19], v[164:167], v[48:63]
s_waitcnt lgkmcnt(2)
ds_read_b128 v[12:15], v69 offset:512
v_mfma_f32_32x32x16_bf16 v[48:63], v[20:23], v[168:171], v[48:63]
s_waitcnt lgkmcnt(2)
ds_read_b128 v[16:19], v70 offset:512
v_mfma_f32_32x32x16_bf16 v[48:63], v[24:27], v[172:175], v[48:63]
s_waitcnt lgkmcnt(2)
ds_read_b128 v[20:23], v71 offset:512
v_mfma_f32_32x32x16_bf16 v[48:63], v[8:11], v[176:179], v[48:63]
s_waitcnt lgkmcnt(2)
ds_read_b128 v[24:27], v64 offset:768
v_mfma_f32_32x32x16_bf16 v[48:63], v[12:15], v[180:183], v[48:63]
s_waitcnt lgkmcnt(2)
ds_read_b128 v[8:11], v65 offset:768
v_mfma_f32_32x32x16_bf16 v[48:63], v[16:19], v[184:187], v[48:63]
s_waitcnt lgkmcnt(2)
ds_read_b128 v[12:15], v66 offset:768
v_mfma_f32_32x32x16_bf16 v[48:63], v[20:23], v[188:191], v[48:63]
s_waitcnt lgkmcnt(2)
ds_read_b128 v[16:19], v67 offset:768
v_mfma_f32_32x32x16_bf16 v[48:63], v[24:27], v[192:195], v[48:63]
s_waitcnt lgkmcnt(2)
ds_read_b128 v[20:23], v68 offset:768
v_mfma_f32_32x32x16_bf16 v[48:63], v[8:11], v[196:199], v[48:63]
s_waitcnt lgkmcnt(2)
ds_read_b128 v[24:27], v69 offset:768
v_mfma_f32_32x32x16_bf16 v[48:63], v[12:15], v[200:203], v[48:63]
s_waitcnt lgkmcnt(2)
ds_read_b128 v[8:11], v70 offset:768
v_mfma_f32_32x32x16_bf16 v[48:63], v[16:19], v[204:207], v[48:63]
s_waitcnt lgkmcnt(2)
ds_read_b128 v[12:15], v71 offset:768
v_mfma_f32_32x32x16_bf16 v[48:63], v[20:23], v[208:211], v[48:63]
s_waitcnt lgkmcnt(2)
ds_read_b128 v[16:19], v64 offset:1024
v_mfma_f32_32x32x16_bf16 v[48:63], v[24:27], v[212:215], v[48:63]
s_waitcnt lgkmcnt(2)
ds_read_b128 v[20:23], v65 offset:1024
v_mfma_f32_32x32x16_bf16 v[48:63], v[8:11], v[216:219], v[48:63]
s_waitcnt lgkmcnt(2)
ds_read_b128 v[24:27], v66 offset:1024
v_mfma_f32_32x32x16_bf16 v[48:63], v[12:15], v[220:223], v[48:63]
s_waitcnt lgkmcnt(2)
ds_read_b128 v[8:11], v67 offset:1024
v_mfma_f32_32x32x16_bf16 v[48:63], v[16:19], v[224:227], v[48:63]
s_waitcnt lgkmcnt(2)
ds_read_b128 v[12:15], v68 offset:1024
v_mfma_f32_32x32x16_bf16 v[48:63], v[20:23], v[228:231], v[48:63]
s_waitcnt lgkmcnt(2)
ds_read_b128 v[16:19], v69 offset:1024
v_mfma_f32_32x32x16_bf16 v[48:63], v[24:27], v[232:235], v[48:63]
s_waitcnt lgkmcnt(2)
ds_read_b128 v[20:23], v70 offset:1024
v_mfma_f32_32x32x16_bf16 v[48:63], v[8:11], v[236:239], v[48:63]
s_waitcnt lgkmcnt(2)
ds_read_b128 v[24:27], v71 offset:1024
v_mfma_f32_32x32x16_bf16 v[48:63], v[12:15], v[240:243], v[48:63]
s_add_u32 s44, s44, 1
s_cmp_eq_u32 s44, 3
s_mov_b32 s56, 40960
s_cmov_b32 s56, -81920
s_cselect_b32 s44, 0, s44
v_add_u32 v64, s56, v64
v_add_u32 v65, s56, v65
v_add_u32 v66, s56, v66
v_add_u32 v67, s56, v67
v_add_u32 v68, s56, v68
v_add_u32 v69, s56, v69
v_add_u32 v70, s56, v70
v_add_u32 v71, s56, v71
s_waitcnt vmcnt(10) lgkmcnt(2)
s_barrier
ds_read_b128 v[8:11], v64 offset:0
v_mfma_f32_32x32x16_bf16 v[48:63], v[16:19], v[244:247], v[48:63]
s_waitcnt lgkmcnt(2)
ds_read_b128 v[12:15], v65 offset:0
v_mfma_f32_32x32x16_bf16 v[48:63], v[20:23], v[248:251], v[48:63]
s_waitcnt lgkmcnt(2)
ds_read_b128 v[16:19], v66 offset:0
v_mfma_f32_32x32x16_bf16 v[48:63], v[24:27], v[252:255], v[48:63]
s_waitcnt lgkmcnt(2)
ds_read_b128 v[20:23], v67 offset:0
s_sub_u32 s59, s59, 1
s_cmp_eq_u32 s59, 0
s_cbranch_scc1 k_so_93
v_mfma_f32_32x32x16_bf16 v[32:47], v[8:11], v[96:99], 0
s_waitcnt lgkmcnt(2)
ds_read_b128 v[24:27], v68 offset:0
v_mfma_f32_32x32x16_bf16 v[32:47], v[12:15], v[100:103], v[32:47]
s_waitcnt lgkmcnt(2)
ds_read_b128 v[8:11], v69 offset:0
v_cvt_pk_bf16_f32 v48, v48, v49
v_cvt_pk_bf16_f32 v49, v50, v51
v_mfma_f32_32x32x16_bf16 v[32:47], v[16:19], v[104:107], v[32:47]
s_waitcnt lgkmcnt(2)
ds_read_b128 v[12:15], v70 offset:0
v_cvt_pk_bf16_f32 v50, v52, v53
v_cvt_pk_bf16_f32 v51, v54, v55
v_mfma_f32_32x32x16_bf16 v[32:47], v[20:23], v[108:111], v[32:47]
s_waitcnt lgkmcnt(2)
ds_read_b128 v[16:19], v71 offset:0
v_cvt_pk_bf16_f32 v52, v56, v57
v_cvt_pk_bf16_f32 v53, v58, v59
v_mfma_f32_32x32x16_bf16 v[32:47], v[24:27], v[112:115], v[32:47]
s_waitcnt lgkmcnt(2)
ds_read_b128 v[20:23], v64 offset:256
v_cvt_pk_bf16_f32 v54, v60, v61
v_cvt_pk_bf16_f32 v55, v62, v63
v_mfma_f32_32x32x16_bf16 v[32:47], v[8:11], v[116:119], v[32:47]
s_waitcnt lgkmcnt(2)
ds_read_b128 v[24:27], v65 offset:256
buffer_store_dwordx4 v[48:51], v1, s[4:7], s48 offen offset:0 sc1
buffer_store_dwordx4 v[52:55], v1, s[4:7], s48 offen offset:1024 sc1
v_mfma_f32_32x32x16_bf16 v[32:47], v[12:15], v[120:123], v[32:47]
s_waitcnt lgkmcnt(2)
ds_read_b128 v[8:11], v66 offset:256
s_add_u32 s48, s48, s50
s_sub_u32 s50, 4096, s50
s_add_u32 m0, s45, 0
s_nop 0
buffer_load_dwordx4 v72, s[20:23], s46 offen lds
v_mfma_f32_32x32x16_bf16 v[32:47], v[16:19], v[124:127], v[32:47]
s_waitcnt lgkmcnt(2)
ds_read_b128 v[12:15], v67 offset:256
s_add_u32 m0, s45, 1024
s_nop 0
buffer_load_dwordx4 v73, s[20:23], s46 offen lds
s_add_u32 m0, s45, 2048
s_nop 0
buffer_load_dwordx4 v74, s[20:23], s46 offen lds
v_mfma_f32_32x32x16_bf16 v[32:47], v[20:23], v[128:131], v[32:47]
s_waitcnt lgkmcnt(2)
ds_read_b128 v[16:19], v68 offset:256
s_add_u32 m0, s45, 3072
s_nop 0
buffer_load_dwordx4 v75, s[20:23], s46 offen lds
s_add_u32 m0, s45, 4096
s_nop 0
buffer_load_dwordx4 v76, s[20:23], s46 offen lds
v_mfma_f32_32x32x16_bf16 v[32:47], v[24:27], v[132:135], v[32:47]
s_waitcnt lgkmcnt(2)
ds_read_b128 v[20:23], v69 offset:256
s_add_u32 m0, s45, 5120
s_nop 0
buffer_load_dwordx4 v77, s[20:23], s46 offen lds
s_add_u32 m0, s45, 6144
s_nop 0
buffer_load_dwordx4 v78, s[20:23], s46 offen lds
v_mfma_f32_32x32x16_bf16 v[32:47], v[8:11], v[136:139], v[32:47]
s_waitcnt lgkmcnt(2)
ds_read_b128 v[24:27], v70 offset:256
s_add_u32 m0, s45, 7168
s_nop 0
buffer_load_dwordx4 v79, s[20:23], s46 offen lds
s_add_u32 m0, s45, 8192
s_nop 0
buffer_load_dwordx4 v80, s[20:23], s46 offen lds
v_mfma_f32_32x32x16_bf16 v[32:47], v[12:15], v[140:143], v[32:47]
s_waitcnt lgkmcnt(2)
ds_read_b128 v[8:11], v71 offset:256
s_add_u32 m0, s45, 9216
s_nop 0
buffer_load_dwordx4 v81, s[20:23], s46 offen lds
s_add_u32 s45, s45, 40960
s_cmp_ge_u32 s45, 122880
s_cselect_b32 s55, 122880, 0
s_sub_u32 s45, s45, s55
v_mfma_f32_32x32x16_bf16 v[32:47], v[16:19], v[144:147], v[32:47]
s_waitcnt lgkmcnt(2)
ds_read_b128 v[12:15], v64 offset:512
s_add_u32 s47, s47, 1
s_and_b32 s55, s47, 1
s_mul_i32 s46, s55, 5120
s_and_b32 s55, s47, 2
s_mul_i32 s55, s55, 20480
s_add_u32 s46, s46, s55
s_and_b32 s55, s47, 4
s_mul_i32 s55, s55, 40960
s_add_u32 s46, s46, s55
s_add_u32 s46, s46, s49
v_mfma_f32_32x32x16_bf16 v[32:47], v[20:23], v[148:151], v[32:47]
s_waitcnt lgkmcnt(2)
ds_read_b128 v[16:19], v65 offset:512
v_mfma_f32_32x32x16_bf16 v[32:47], v[24:27], v[152:155], v[32:47]
s_waitcnt lgkmcnt(2)
ds_read_b128 v[20:23], v66 offset:512
v_mfma_f32_32x32x16_bf16 v[32:47], v[8:11], v[156:159], v[32:47]
s_waitcnt lgkmcnt(2)
ds_read_b128 v[24:27], v67 offset:512
v_mfma_f32_32x32x16_bf16 v[32:47], v[12:15], v[160:163], v[32:47]
s_waitcnt lgkmcnt(2)
ds_read_b128 v[8:11], v68 offset:512
v_mfma_f32_32x32x16_bf16 v[32:47], v[16:19], v[164:167], v[32:47]
s_waitcnt lgkmcnt(2)
ds_read_b128 v[12:15], v69 offset:512
v_mfma_f32_32x32x16_bf16 v[32:47], v[20:23], v[168:171], v[32:47]
s_waitcnt lgkmcnt(2)
ds_read_b128 v[16:19], v70 offset:512
v_mfma_f32_32x32x16_bf16 v[32:47], v[24:27], v[172:175], v[32:47]
s_waitcnt lgkmcnt(2)
ds_read_b128 v[20:23], v71 offset:512
v_mfma_f32_32x32x16_bf16 v[32:47], v[8:11], v[176:179], v[32:47]
s_waitcnt lgkmcnt(2)
ds_read_b128 v[24:27], v64 offset:768
v_mfma_f32_32x32x16_bf16 v[32:47], v[12:15], v[180:183], v[32:47]
s_waitcnt lgkmcnt(2)
ds_read_b128 v[8:11], v65 offset:768
v_mfma_f32_32x32x16_bf16 v[32:47], v[16:19], v[184:187], v[32:47]
s_waitcnt lgkmcnt(2)
ds_read_b128 v[12:15], v66 offset:768
v_mfma_f32_32x32x16_bf16 v[32:47], v[20:23], v[188:191], v[32:47]
s_waitcnt lgkmcnt(2)
ds_read_b128 v[16:19], v67 offset:768
v_mfma_f32_32x32x16_bf16 v[32:47], v[24:27], v[192:195], v[32:47]
s_waitcnt lgkmcnt(2)
ds_read_b128 v[20:23], v68 offset:768
v_mfma_f32_32x32x16_bf16 v[32:47], v[8:11], v[196:199], v[32:47]
s_waitcnt lgkmcnt(2)
ds_read_b128 v[24:27], v69 offset:768
v_mfma_f32_32x32x16_bf16 v[32:47], v[12:15], v[200:203], v[32:47]
s_waitcnt lgkmcnt(2)
ds_read_b128 v[8:11], v70 offset:768
v_mfma_f32_32x32x16_bf16 v[32:47], v[16:19], v[204:207], v[32:47]
s_waitcnt lgkmcnt(2)
ds_read_b128 v[12:15], v71 offset:768
v_mfma_f32_32x32x16_bf16 v[32:47], v[20:23], v[208:211], v[32:47]
s_waitcnt lgkmcnt(2)
ds_read_b128 v[16:19], v64 offset:1024
v_mfma_f32_32x32x16_bf16 v[32:47], v[24:27], v[212:215], v[32:47]
s_waitcnt lgkmcnt(2)
ds_read_b128 v[20:23], v65 offset:1024
v_mfma_f32_32x32x16_bf16 v[32:47], v[8:11], v[216:219], v[32:47]
s_waitcnt lgkmcnt(2)
ds_read_b128 v[24:27], v66 offset:1024
v_mfma_f32_32x32x16_bf16 v[32:47], v[12:15], v[220:223], v[32:47]
s_waitcnt lgkmcnt(2)
ds_read_b128 v[8:11], v67 offset:1024
v_mfma_f32_32x32x16_bf16 v[32:47], v[16:19], v[224:227], v[32:47]
s_waitcnt lgkmcnt(2)
ds_read_b128 v[12:15], v68 offset:1024
v_mfma_f32_32x32x16_bf16 v[32:47], v[20:23], v[228:231], v[32:47]
s_waitcnt lgkmcnt(2)
ds_read_b128 v[16:19], v69 offset:1024
v_mfma_f32_32x32x16_bf16 v[32:47], v[24:27], v[232:235], v[32:47]
s_waitcnt lgkmcnt(2)
ds_read_b128 v[20:23], v70 offset:1024
v_mfma_f32_32x32x16_bf16 v[32:47], v[8:11], v[236:239], v[32:47]
s_waitcnt lgkmcnt(2)
ds_read_b128 v[24:27], v71 offset:1024
v_mfma_f32_32x32x16_bf16 v[32:47], v[12:15], v[240:243], v[32:47]
s_add_u32 s44, s44, 1
s_cmp_eq_u32 s44, 3
s_mov_b32 s56, 40960
s_cmov_b32 s56, -81920
s_cselect_b32 s44, 0, s44
v_add_u32 v64, s56, v64
v_add_u32 v65, s56, v65
v_add_u32 v66, s56, v66
v_add_u32 v67, s56, v67
v_add_u32 v68, s56, v68
v_add_u32 v69, s56, v69
v_add_u32 v70, s56, v70
v_add_u32 v71, s56, v71
s_waitcnt vmcnt(10) lgkmcnt(2)
s_barrier
ds_read_b128 v[8:11], v64 offset:0
v_mfma_f32_32x32x16_bf16 v[32:47], v[16:19], v[244:247], v[32:47]
s_waitcnt lgkmcnt(2)
ds_read_b128 v[12:15], v65 offset:0
v_mfma_f32_32x32x16_bf16 v[32:47], v[20:23], v[248:251], v[32:47]
s_waitcnt lgkmcnt(2)
ds_read_b128 v[16:19], v66 offset:0
v_mfma_f32_32x32x16_bf16 v[32:47], v[24:27], v[252:255], v[32:47]
s_waitcnt lgkmcnt(2)
ds_read_b128 v[20:23], v67 offset:0
s_branch k_st_92
k_so_93:
s_nop 6
v_cvt_pk_bf16_f32 v48, v48, v49
v_cvt_pk_bf16_f32 v49, v50, v51
v_cvt_pk_bf16_f32 v50, v52, v53
v_cvt_pk_bf16_f32 v51, v54, v55
v_cvt_pk_bf16_f32 v52, v56, v57
v_cvt_pk_bf16_f32 v53, v58, v59
v_cvt_pk_bf16_f32 v54, v60, v61
v_cvt_pk_bf16_f32 v55, v62, v63
buffer_store_dwordx4 v[48:51], v1, s[4:7], s48 offen offset:0 sc1
buffer_store_dwordx4 v[52:55], v1, s[4:7], s48 offen offset:1024 sc1
s_add_u32 s48, s48, s50
s_sub_u32 s50, 4096, s50
s_lshl_b32 s54, s30, 6
s_add_u32 s54, s54, 222322688
s_waitcnt lgkmcnt(0)
s_waitcnt vmcnt(0)
s_barrier
s_cmp_lg_u32 s3, 0
s_cbranch_scc1 k_s8_94
s_mov_b64 exec, 1
v_mov_b32 v2, 1
buffer_store_dword v2, off, s[4:7], s54 sc1
s_mov_b64 exec, -1
k_s8_94:
s_mul_i32 s57, s30, 3277
s_lshr_b32 s57, s57, 16
s_mul_i32 s52, s57, 20
s_sub_u32 s58, s30, s52
s_mov_b32 s54, 222322688
v_add_u32 v10, 4096, v0
v_add_u32 v11, 8192, v0
v_add_u32 v12, 12288, v0
s_cmp_lg_u32 s3, 0
s_cbranch_scc1 k_w8d_96
v_lshlrev_b32 v96, 2, v0
k_w8_95:
buffer_load_dword v97, v96, s[4:7], s54 offen sc1
buffer_load_dword v98, v96, s[4:7], s54 offen offset:1024 sc1
s_waitcnt vmcnt(0)
v_and_b32 v97, v97, v98
v_cmp_eq_u32 vcc, 0, v97
s_cbranch_vccz k_w8d_96
s_sleep 1
s_sub_u32 s32, s32, 1
s_cmp_gt_i32 s32, 0
s_cbranch_scc1 k_w8_95
k_w8d_96:
s_barrier
s_lshl_b32 s52, s58, 2
s_add_u32 s52, s52, s3
s_lshl_b32 s52, s52, 16
s_add_u32 s52, s52, 216006656
buffer_load_dwordx4 a[0:3], v0, s[4:7], s52 offen offset:0 sc1
buffer_load_dwordx4 a[4:7], v0, s[4:7], s52 offen offset:1024 sc1
buffer_load_dwordx4 a[8:11], v0, s[4:7], s52 offen offset:2048 sc1
buffer_load_dwordx4 a[12:15], v0, s[4:7], s52 offen offset:3072 sc1
buffer_load_dwordx4 a[16:19], v10, s[4:7], s52 offen offset:0 sc1
buffer_load_dwordx4 a[20:23], v10, s[4:7], s52 offen offset:1024 sc1
buffer_load_dwordx4 a[24:27], v10, s[4:7], s52 offen offset:2048 sc1
buffer_load_dwordx4 a[28:31], v10, s[4:7], s52 offen offset:3072 sc1
buffer_load_dwordx4 a[32:35], v11, s[4:7], s52 offen offset:0 sc1
buffer_load_dwordx4 a[36:39], v11, s[4:7], s52 offen offset:1024 sc1
buffer_load_dwordx4 a[40:43], v11, s[4:7], s52 offen offset:2048 sc1
buffer_load_dwordx4 a[44:47], v11, s[4:7], s52 offen offset:3072 sc1
buffer_load_dwordx4 a[48:51], v12, s[4:7], s52 offen offset:0 sc1
buffer_load_dwordx4 a[52:55], v12, s[4:7], s52 offen offset:1024 sc1
buffer_load_dwordx4 a[56:59], v12, s[4:7], s52 offen offset:2048 sc1
buffer_load_dwordx4 a[60:63], v12, s[4:7], s52 offen offset:3072 sc1
s_add_u32 s52, s52, 16384
buffer_load_dwordx4 a[64:67], v0, s[4:7], s52 offen offset:0 sc1
buffer_load_dwordx4 a[68:71], v0, s[4:7], s52 offen offset:1024 sc1
buffer_load_dwordx4 a[72:75], v0, s[4:7], s52 offen offset:2048 sc1
buffer_load_dwordx4 a[76:79], v0, s[4:7], s52 offen offset:3072 sc1
buffer_load_dwordx4 a[80:83], v10, s[4:7], s52 offen offset:0 sc1
buffer_load_dwordx4 a[84:87], v10, s[4:7], s52 offen offset:1024 sc1
buffer_load_dwordx4 a[88:91], v10, s[4:7], s52 offen offset:2048 sc1
buffer_load_dwordx4 a[92:95], v10, s[4:7], s52 offen offset:3072 sc1
buffer_load_dwordx4 a[96:99], v11, s[4:7], s52 offen offset:0 sc1
buffer_load_dwordx4 a[100:103], v11, s[4:7], s52 offen offset:1024 sc1
buffer_load_dwordx4 a[104:107], v11, s[4:7], s52 offen offset:2048 sc1
buffer_load_dwordx4 a[108:111], v11, s[4:7], s52 offen offset:3072 sc1
buffer_load_dwordx4 a[112:115], v12, s[4:7], s52 offen offset:0 sc1
buffer_load_dwordx4 a[116:119], v12, s[4:7], s52 offen offset:1024 sc1
buffer_load_dwordx4 a[120:123], v12, s[4:7], s52 offen offset:2048 sc1
buffer_load_dwordx4 a[124:127], v12, s[4:7], s52 offen offset:3072 sc1
s_waitcnt vmcnt(0)
s_add_u32 s52, s52, 16384
buffer_load_dwordx4 a[128:131], v0, s[4:7], s52 offen offset:0 sc1
buffer_load_dwordx4 a[132:135], v0, s[4:7], s52 offen offset:1024 sc1
buffer_load_dwordx4 a[136:139], v0, s[4:7], s52 offen offset:2048 sc1
buffer_load_dwordx4 a[140:143], v0, s[4:7], s52 offen offset:3072 sc1
buffer_load_dwordx4 a[144:147], v10, s[4:7], s52 offen offset:0 sc1
buffer_load_dwordx4 a[148:151], v10, s[4:7], s52 offen offset:1024 sc1
buffer_load_dwordx4 a[152:155], v10, s[4:7], s52 offen offset:2048 sc1
buffer_load_dwordx4 a[156:159], v10, s[4:7], s52 offen offset:3072 sc1
buffer_load_dwordx4 a[160:163], v11, s[4:7], s52 offen offset:0 sc1
buffer_load_dwordx4 a[164:167], v11, s[4:7], s52 offen offset:1024 sc1
buffer_load_dwordx4 a[168:171], v11, s[4:7], s52 offen offset:2048 sc1
buffer_load_dwordx4 a[172:175], v11, s[4:7], s52 offen offset:3072 sc1
buffer_load_dwordx4 a[176:179], v12, s[4:7], s52 offen offset:0 sc1
buffer_load_dwordx4 a[180:183], v12, s[4:7], s52 offen offset:1024 sc1
buffer_load_dwordx4 a[184:187], v12, s[4:7], s52 offen offset:2048 sc1
buffer_load_dwordx4 a[188:191], v12, s[4:7], s52 offen offset:3072 sc1
s_add_u32 s52, s52, 16384
buffer_load_dwordx4 a[192:195], v0, s[4:7], s52 offen offset:0 sc1
buffer_load_dwordx4 a[196:199], v0, s[4:7], s52 offen offset:1024 sc1
buffer_load_dwordx4 a[200:203], v0, s[4:7], s52 offen offset:2048 sc1
buffer_load_dwordx4 a[204:207], v0, s[4:7], s52 offen offset:3072 sc1
buffer_load_dwordx4 a[208:211], v10, s[4:7], s52 offen offset:0 sc1
buffer_load_dwordx4 a[212:215], v10, s[4:7], s52 offen offset:1024 sc1
buffer_load_dwordx4 a[216:219], v10, s[4:7], s52 offen offset:2048 sc1
buffer_load_dwordx4 a[220:223], v10, s[4:7], s52 offen offset:3072 sc1
buffer_load_dwordx4 a[224:227], v11, s[4:7], s52 offen offset:0 sc1
buffer_load_dwordx4 a[228:231], v11, s[4:7], s52 offen offset:1024 sc1
buffer_load_dwordx4 a[232:235], v11, s[4:7], s52 offen offset:2048 sc1
buffer_load_dwordx4 a[236:239], v11, s[4:7], s52 offen offset:3072 sc1
buffer_load_dwordx4 a[240:243], v12, s[4:7], s52 offen offset:0 sc1
buffer_load_dwordx4 a[244:247], v12, s[4:7], s52 offen offset:1024 sc1
buffer_load_dwordx4 a[248:251], v12, s[4:7], s52 offen offset:2048 sc1
buffer_load_dwordx4 a[252:255], v12, s[4:7], s52 offen offset:3072 sc1
s_waitcnt vmcnt(0)
s_lshl_b32 s46, s57, 16
s_lshl_b32 s52, s3, 14
s_add_u32 s46, s46, s52
s_add_u32 s46, s46, 159383552
s_lshl_b32 s53, s57, 7
s_lshl_b32 s44, s58, 11
s_add_u32 s44, s44, s53
s_add_u32 s44, s44, 195035136
s_lshl_b32 s45, s58, 17
s_add_u32 s45, s45, s53
s_add_u32 s45, s45, 205520896
s_lshl_b32 s48, s58, 7
s_lshl_b32 s53, s57, 5
s_add_u32 s48, s48, s53
s_add_u32 s48, s48, 211812352
s_lshr_b32 s49, s57, 1
s_lshl_b32 s49, s49, 8
s_lshl_b32 s53, s3, 5
s_add_u32 s49, s49, s53
s_add_u32 s49, s49, 222339072
s_mov_b32 s50, 1
v_lshrrev_b32 v96, 4, v0
v_and_b32 v97, 8, v96
v_cmp_ne_u32 vcc, 0, v97
v_mov_b32 v1, 0x4444
v_mov_b32 v97, 0xeeee
v_cndmask_b32 v1, v1, v97, vcc
v_and_b32 v97, 7, v96
v_lshrrev_b32 v98, 3, v96
v_lshlrev_b32 v2, 2, v97
v_mul_u32_u24 v4, 144, v98
v_lshl_add_u32 v4, v97, 4, v4
v_and_b32 v99, 1, v96
v_lshlrev_b32 v99, 3, v99
v_lshl_add_u32 v99, v98, 4, v99
v_bfe_u32 v100, v96, 1, 2
v_lshl_add_u32 v5, v100, 9, v99
v_lshl_add_u32 v6, v100, 15, v99
v_lshlrev_b32 v7, 2, v98
v_mov_b32 v99, 2146435072
v_cmp_eq_u32 vcc, 0, v97
s_nop 1
v_cndmask_b32 v7, v99, v7, vcc
v_add_u32 v97, s58, v97
v_cmp_eq_u32 vcc, 0, v97
s_nop 1
v_cndmask_b32 v9, 1.0, 0, vcc
v_and_b32 v3, 15, v96
v_bfe_u32 v97, v96, 4, 1
v_mul_u32_u24 v97, 144, v97
v_add_u32 v3, v3, v97
v_lshrrev_b32 v97, 5, v96
v_lshl_add_u32 v3, v97, 4, v3
v_lshlrev_b32 v3, 2, v3
s_mul_i32 s52, s3, 1152
v_add_u32 v3, s52, v3
s_mov_b32 s56, 8192
k_poll_98:
buffer_load_dword v8, v2, s[4:7], s49 offen sc1
s_waitcnt vmcnt(0)
v_cmp_gt_u32 vcc, s50, v8
s_cbranch_vccz k_pd_99
s_sleep 1
s_sub_u32 s32, s32, 1
s_cmp_gt_i32 s32, 0
s_cbranch_scc1 k_poll_98
k_pd_99:
buffer_load_dwordx2 v[14:15], v5, s[4:7], s44 offen sc1
buffer_load_dwordx4 v[32:35], v0, s[4:7], s46 offen offset:0 sc1
buffer_load_dwordx4 v[36:39], v0, s[4:7], s46 offen offset:1024 sc1
buffer_load_dwordx4 v[40:43], v0, s[4:7], s46 offen offset:2048 sc1
buffer_load_dwordx4 v[44:47], v0, s[4:7], s46 offen offset:3072 sc1
buffer_load_dwordx4 v[48:51], v10, s[4:7], s46 offen offset:0 sc1
buffer_load_dwordx4 v[52:55], v10, s[4:7], s46 offen offset:1024 sc1
buffer_load_dwordx4 v[56:59], v10, s[4:7], s46 offen offset:2048 sc1
buffer_load_dwordx4 v[60:63], v10, s[4:7], s46 offen offset:3072 sc1
buffer_load_dwordx4 v[64:67], v11, s[4:7], s46 offen offset:0 sc1
buffer_load_dwordx4 v[68:71], v11, s[4:7], s46 offen offset:1024 sc1
buffer_load_dwordx4 v[72:75], v11, s[4:7], s46 offen offset:2048 sc1
buffer_load_dwordx4 v[76:79], v11, s[4:7], s46 offen offset:3072 sc1
buffer_load_dwordx4 v[80:83], v12, s[4:7], s46 offen offset:0 sc1
buffer_load_dwordx4 v[84:87], v12, s[4:7], s46 offen offset:1024 sc1
buffer_load_dwordx4 v[88:91], v12, s[4:7], s46 offen offset:2048 sc1
buffer_load_dwordx4 v[92:95], v12, s[4:7], s46 offen offset:3072 sc1
s_xor_b32 s49, s49, 512
buffer_load_dword v8, v2, s[4:7], s49 offen sc1
k_top_97:
v_mov_b64 v[24:25], 0
v_mov_b64 v[26:27], 0
v_mov_b64 v[28:29], 0
v_mov_b64 v[30:31], 0
s_add_u32 s50, s50, 1
s_add_u32 s46, s46, 262144
s_add_u32 s44, s44, 40960
s_cmp_eq_u32 s50, 65
s_cselect_b32 s52, 1048576, 0
s_cselect_b32 s53, 524288, 0
s_add_u32 s46, s46, s52
s_add_u32 s44, s44, s53
s_waitcnt vmcnt(17)
v_lshlrev_b32 v16, 16, v14
v_and_b32 v17, 0xffff0000, v14
v_lshlrev_b32 v18, 16, v15
v_and_b32 v19, 0xffff0000, v15
s_waitcnt vmcnt(16)
v_smfmac_f32_16x16x64_bf16 v[24:27], v[32:35], a[0:7], v1
v_smfmac_f32_16x16x64_bf16 v[28:31], v[32:35], a[8:15], v1
s_waitcnt vmcnt(15)
v_smfmac_f32_16x16x64_bf16 v[24:27], v[36:39], a[16:23], v1
v_smfmac_f32_16x16x64_bf16 v[28:31], v[36:39], a[24:31], v1
s_waitcnt vmcnt(14)
v_smfmac_f32_16x16x64_bf16 v[24:27], v[40:43], a[32:39], v1
v_smfmac_f32_16x16x64_bf16 v[28:31], v[40:43], a[40:47], v1
s_waitcnt vmcnt(13)
v_smfmac_f32_16x16x64_bf16 v[24:27], v[44:47], a[48:55], v1
v_smfmac_f32_16x16x64_bf16 v[28:31], v[44:47], a[56:63], v1
s_waitcnt vmcnt(12)
v_smfmac_f32_16x16x64_bf16 v[24:27], v[48:51], a[64:71], v1
v_smfmac_f32_16x16x64_bf16 v[28:31], v[48:51], a[72:79], v1
s_waitcnt vmcnt(11)
v_smfmac_f32_16x16x64_bf16 v[24:27], v[52:55], a[80:87], v1
v_smfmac_f32_16x16x64_bf16 v[28:31], v[52:55], a[88:95], v1
s_waitcnt vmcnt(10)
v_smfmac_f32_16x16x64_bf16 v[24:27], v[56:59], a[96:103], v1
v_smfmac_f32_16x16x64_bf16 v[28:31], v[56:59], a[104:111], v1
s_waitcnt vmcnt(9)
v_smfmac_f32_16x16x64_bf16 v[24:27], v[60:63], a[112:119], v1
v_smfmac_f32_16x16x64_bf16 v[28:31], v[60:63], a[120:127], v1
s_waitcnt vmcnt(8)
v_smfmac_f32_16x16x64_bf16 v[24:27], v[64:67], a[128:135], v1
v_smfmac_f32_16x16x64_bf16 v[28:31], v[64:67], a[136:143], v1
s_waitcnt vmcnt(7)
v_smfmac_f32_16x16x64_bf16 v[24:27], v[68:71], a[144:151], v1
v_smfmac_f32_16x16x64_bf16 v[28:31], v[68:71], a[152:159], v1
s_waitcnt vmcnt(6)
v_smfmac_f32_16x16x64_bf16 v[24:27], v[72:75], a[160:167], v1
v_smfmac_f32_16x16x64_bf16 v[28:31], v[72:75], a[168:175], v1
s_waitcnt vmcnt(5)
v_smfmac_f32_16x16x64_bf16 v[24:27], v[76:79], a[176:183], v1
v_smfmac_f32_16x16x64_bf16 v[28:31], v[76:79], a[184:191], v1
s_waitcnt vmcnt(4)
v_smfmac_f32_16x16x64_bf16 v[24:27], v[80:83], a[192:199], v1
v_smfmac_f32_16x16x64_bf16 v[28:31], v[80:83], a[200:207], v1
s_waitcnt vmcnt(3)
v_smfmac_f32_16x16x64_bf16 v[24:27], v[84:87], a[208:215], v1
v_smfmac_f32_16x16x64_bf16 v[28:31], v[84:87], a[216:223], v1
s_waitcnt vmcnt(2)
v_smfmac_f32_16x16x64_bf16 v[24:27], v[88:91], a[224:231], v1
v_smfmac_f32_16x16x64_bf16 v[28:31], v[88:91], a[232:239], v1
s_waitcnt vmcnt(1)
v_smfmac_f32_16x16x64_bf16 v[24:27], v[92:95], a[240:247], v1
v_smfmac_f32_16x16x64_bf16 v[28:31], v[92:95], a[248:255], v1
s_waitcnt vmcnt(0)
v_cmp_gt_u32 vcc, s50, v8
s_mov_b32 s47, 0
s_cbranch_vccnz k_nr_100
s_mov_b32 s47, 1
buffer_load_dwordx2 v[14:15], v5, s[4:7], s44 offen sc1
buffer_load_dwordx4 v[32:35], v0, s[4:7], s46 offen offset:0 sc1
buffer_load_dwordx4 v[36:39], v0, s[4:7], s46 offen offset:1024 sc1
buffer_load_dwordx4 v[40:43], v0, s[4:7], s46 offen offset:2048 sc1
buffer_load_dwordx4 v[44:47], v0, s[4:7], s46 offen offset:3072 sc1
buffer_load_dwordx4 v[48:51], v10, s[4:7], s46 offen offset:0 sc1
buffer_load_dwordx4 v[52:55], v10, s[4:7], s46 offen offset:1024 sc1
buffer_load_dwordx4 v[56:59], v10, s[4:7], s46 offen offset:2048 sc1
buffer_load_dwordx4 v[60:63], v10, s[4:7], s46 offen offset:3072 sc1
buffer_load_dwordx4 v[64:67], v11, s[4:7], s46 offen offset:0 sc1
buffer_load_dwordx4 v[68:71], v11, s[4:7], s46 offen offset:1024 sc1
buffer_load_dwordx4 v[72:75], v11, s[4:7], s46 offen offset:2048 sc1
buffer_load_dwordx4 v[76:79], v11, s[4:7], s46 offen offset:3072 sc1
buffer_load_dwordx4 v[80:83], v12, s[4:7], s46 offen offset:0 sc1
buffer_load_dwordx4 v[84:87], v12, s[4:7], s46 offen offset:1024 sc1
buffer_load_dwordx4 v[88:91], v12, s[4:7], s46 offen offset:2048 sc1
buffer_load_dwordx4 v[92:95], v12, s[4:7], s46 offen offset:3072 sc1
s_xor_b32 s49, s49, 512
buffer_load_dword v8, v2, s[4:7], s49 offen sc1
k_nr_100:
s_nop 2
v_permlane32_swap_b32 v24, v28
v_permlane32_swap_b32 v25, v29
v_permlane32_swap_b32 v26, v30
v_permlane32_swap_b32 v27, v31
v_add_f32 v24, v24, v28
ds_write_b32 v3, v24 offset:0
v_add_f32 v25, v25, v29
ds_write_b32 v3, v25 offset:144
v_add_f32 v26, v26, v30
ds_write_b32 v3, v26 offset:288
v_add_f32 v27, v27, v31
ds_write_b32 v3, v27 offset:432
v_add_u32 v3, s56, v3
s_waitcnt lgkmcnt(0)
s_barrier
s_cmp_lg_u32 s3, 0
s_cbranch_scc1 k_ne_101
ds_read_b128 v[96:99], v4 offset:0
ds_read_b128 v[100:103], v4 offset:1152
ds_read_b128 v[104:107], v4 offset:2304
ds_read_b128 v[108:111], v4 offset:3456
v_add_u32 v4, s56, v4
s_waitcnt lgkmcnt(3)
v_add_f32 v16, v16, v96
v_add_f32 v17, v17, v97
v_add_f32 v18, v18, v98
v_add_f32 v19, v19, v99
s_waitcnt lgkmcnt(2)
v_add_f32 v16, v16, v100
v_add_f32 v17, v17, v101
v_add_f32 v18, v18, v102
v_add_f32 v19, v19, v103
s_waitcnt lgkmcnt(1)
v_add_f32 v16, v16, v104
v_add_f32 v17, v17, v105
v_add_f32 v18, v18, v106
v_add_f32 v19, v19, v107
s_waitcnt lgkmcnt(0)
v_add_f32 v16, v16, v108
v_add_f32 v17, v17, v109
v_add_f32 v18, v18, v110
v_add_f32 v19, v19, v111
v_cvt_pk_bf16_f32 v96, v16, v17
v_cvt_pk_bf16_f32 v97, v18, v19
buffer_store_dwordx2 v[96:97], v6, s[4:7], s45 offen sc1
v_mul_f32 v17, v9, v17
v_mul_f32 v16, v16, v16
v_fmac_f32 v16, v17, v17
v_fmac_f32 v16, v18, v18
v_fmac_f32 v16, v19, v19
s_nop 1
v_add_f32_dpp v16, v16, v16 quad_perm:[1,0,3,2] row_mask:0xf bank_mask:0xf
s_nop 1
v_add_f32_dpp v16, v16, v16 quad_perm:[2,3,0,1] row_mask:0xf bank_mask:0xf
s_nop 1
v_add_f32_dpp v16, v16, v16 row_half_mirror row_mask:0xf bank_mask:0xf
buffer_store_dword v16, v7, s[4:7], s48 offen sc1
s_add_u32 s45, s45, 512
s_add_u32 s48, s48, 2560
s_cmp_eq_u32 s50, 65
s_cbranch_scc0 k_ne_101
s_add_u32 s45, s45, 3112960
s_add_u32 s48, s48, 884736
k_ne_101:
s_sub_u32 s56, 0, s56
s_cmp_eq_u32 s47, 1
s_cbranch_scc1 k_top_97
s_cmp_le_u32 s50, 128
s_cbranch_scc1 k_poll_98
s_waitcnt vmcnt(0) lgkmcnt(0)
s_barrier
k_fin_7:
s_mul_i32 s57, s30, 52429
s_lshr_b32 s57, s57, 18
s_mul_i32 s52, s57, 5
s_sub_u32 s58, s30, s52
s_lshl_b32 s58, s58, 2
s_add_u32 s58, s58, s3
s_mul_i32 s53, s58, 40960
s_add_u32 s53, s53, 214958080
s_load_dwordx2 s[36:37], s[0:1], 80
s_mov_b32 s38, 2621440
s_mov_b32 s39, 0x20000
buffer_load_dwordx4 v[96:99], v0, s[4:7], s53 offen offset:0 sc1
buffer_load_dwordx4 v[100:103], v0, s[4:7], s53 offen offset:1024 sc1
buffer_load_dwordx4 v[104:107], v0, s[4:7], s53 offen offset:2048 sc1
buffer_load_dwordx4 v[108:111], v0, s[4:7], s53 offen offset:3072 sc1
s_add_u32 s53, s53, 4096
buffer_load_dwordx4 v[112:115], v0, s[4:7], s53 offen offset:0 sc1
buffer_load_dwordx4 v[116:119], v0, s[4:7], s53 offen offset:1024 sc1
buffer_load_dwordx4 v[120:123], v0, s[4:7], s53 offen offset:2048 sc1
buffer_load_dwordx4 v[124:127], v0, s[4:7], s53 offen offset:3072 sc1
s_add_u32 s53, s53, 4096
buffer_load_dwordx4 v[128:131], v0, s[4:7], s53 offen offset:0 sc1
buffer_load_dwordx4 v[132:135], v0, s[4:7], s53 offen offset:1024 sc1
buffer_load_dwordx4 v[136:139], v0, s[4:7], s53 offen offset:2048 sc1
buffer_load_dwordx4 v[140:143], v0, s[4:7], s53 offen offset:3072 sc1
s_add_u32 s53, s53, 4096
buffer_load_dwordx4 v[144:147], v0, s[4:7], s53 offen offset:0 sc1
buffer_load_dwordx4 v[148:151], v0, s[4:7], s53 offen offset:1024 sc1
buffer_load_dwordx4 v[152:155], v0, s[4:7], s53 offen offset:2048 sc1
buffer_load_dwordx4 v[156:159], v0, s[4:7], s53 offen offset:3072 sc1
s_add_u32 s53, s53, 4096
buffer_load_dwordx4 v[160:163], v0, s[4:7], s53 offen offset:0 sc1
buffer_load_dwordx4 v[164:167], v0, s[4:7], s53 offen offset:1024 sc1
buffer_load_dwordx4 v[168:171], v0, s[4:7], s53 offen offset:2048 sc1
buffer_load_dwordx4 v[172:175], v0, s[4:7], s53 offen offset:3072 sc1
s_add_u32 s53, s53, 4096
buffer_load_dwordx4 v[176:179], v0, s[4:7], s53 offen offset:0 sc1
buffer_load_dwordx4 v[180:183], v0, s[4:7], s53 offen offset:1024 sc1
buffer_load_dwordx4 v[184:187], v0, s[4:7], s53 offen offset:2048 sc1
buffer_load_dwordx4 v[188:191], v0, s[4:7], s53 offen offset:3072 sc1
s_add_u32 s53, s53, 4096
buffer_load_dwordx4 v[192:195], v0, s[4:7], s53 offen offset:0 sc1
buffer_load_dwordx4 v[196:199], v0, s[4:7], s53 offen offset:1024 sc1
buffer_load_dwordx4 v[200:203], v0, s[4:7], s53 offen offset:2048 sc1
buffer_load_dwordx4 v[204:207], v0, s[4:7], s53 offen offset:3072 sc1
s_add_u32 s53, s53, 4096
buffer_load_dwordx4 v[208:211], v0, s[4:7], s53 offen offset:0 sc1
buffer_load_dwordx4 v[212:215], v0, s[4:7], s53 offen offset:1024 sc1
buffer_load_dwordx4 v[216:219], v0, s[4:7], s53 offen offset:2048 sc1
buffer_load_dwordx4 v[220:223], v0, s[4:7], s53 offen offset:3072 sc1
s_add_u32 s53, s53, 4096
buffer_load_dwordx4 v[224:227], v0, s[4:7], s53 offen offset:0 sc1
buffer_load_dwordx4 v[228:231], v0, s[4:7], s53 offen offset:1024 sc1
buffer_load_dwordx4 v[232:235], v0, s[4:7], s53 offen offset:2048 sc1
buffer_load_dwordx4 v[236:239], v0, s[4:7], s53 offen offset:3072 sc1
s_add_u32 s53, s53, 4096
buffer_load_dwordx4 v[240:243], v0, s[4:7], s53 offen offset:0 sc1
buffer_load_dwordx4 v[244:247], v0, s[4:7], s53 offen offset:1024 sc1
buffer_load_dwordx4 v[248:251], v0, s[4:7], s53 offen offset:2048 sc1
buffer_load_dwordx4 v[252:255], v0, s[4:7], s53 offen offset:3072 sc1
s_mul_i32 s48, s57, 40960
s_mul_i32 s52, s3, 10240
s_add_u32 s46, s48, s52
s_add_u32 s46, s46, 201326592
s_lshl_b32 s58, s58, 6
s_add_u32 s48, s48, s58
v_bfe_u32 v1, v0, 4, 5
v_mul_u32_u24 v1, 1280, v1
v_lshrrev_b32 v2, 9, v0
v_lshl_add_u32 v1, v2, 5, v1
s_mov_b32 s49, 1310720
s_mov_b32 s54, 222314496
s_waitcnt vmcnt(0) lgkmcnt(0)
s_cmp_lg_u32 s3, 0
s_cbranch_scc1 k_w8d_105
v_lshlrev_b32 v2, 2, v0
k_w8_104:
buffer_load_dword v3, v2, s[4:7], s54 offen sc1
buffer_load_dword v4, v2, s[4:7], s54 offen offset:1024 sc1
s_waitcnt vmcnt(0)
v_and_b32 v3, v3, v4
v_cmp_eq_u32 vcc, 0, v3
s_cbranch_vccz k_w8d_105
s_sleep 1
s_sub_u32 s32, s32, 1
s_cmp_gt_i32 s32, 0
s_cbranch_scc1 k_w8_104
k_w8d_105:
s_barrier
s_mul_i32 s45, s3, 10240
s_mov_b32 s44, 0
v_mov_b32 v64, v0
s_add_u32 m0, s45, 0
s_add_u32 s55, s46, 0
buffer_load_dwordx4 v0, s[4:7], s55 offen offset:0 sc1 lds
buffer_load_dwordx4 v0, s[4:7], s55 offen offset:1024 sc1 lds
buffer_load_dwordx4 v0, s[4:7], s55 offen offset:2048 sc1 lds
buffer_load_dwordx4 v0, s[4:7], s55 offen offset:3072 sc1 lds
s_add_u32 m0, s45, 4096
s_add_u32 s55, s46, 4096
buffer_load_dwordx4 v0, s[4:7], s55 offen offset:0 sc1 lds
buffer_load_dwordx4 v0, s[4:7], s55 offen offset:1024 sc1 lds
buffer_load_dwordx4 v0, s[4:7], s55 offen offset:2048 sc1 lds
buffer_load_dwordx4 v0, s[4:7], s55 offen offset:3072 sc1 lds
s_add_u32 m0, s45, 8192
s_add_u32 s55, s46, 8192
buffer_load_dwordx4 v0, s[4:7], s55 offen offset:0 sc1 lds
buffer_load_dwordx4 v0, s[4:7], s55 offen offset:1024 sc1 lds
s_add_u32 s45, s45, 40960
s_cmp_ge_u32 s45, 122880
s_cselect_b32 s55, 122880, 0
s_sub_u32 s45, s45, s55
s_add_u32 s46, s46, s49
s_mov_b32 s49, 0
s_add_u32 m0, s45, 0
s_add_u32 s55, s46, 0
buffer_load_dwordx4 v0, s[4:7], s55 offen offset:0 sc1 lds
buffer_load_dwordx4 v0, s[4:7], s55 offen offset:1024 sc1 lds
buffer_load_dwordx4 v0, s[4:7], s55 offen offset:2048 sc1 lds
buffer_load_dwordx4 v0, s[4:7], s55 offen offset:3072 sc1 lds
s_add_u32 m0, s45, 4096
s_add_u32 s55, s46, 4096
buffer_load_dwordx4 v0, s[4:7], s55 offen offset:0 sc1 lds
buffer_load_dwordx4 v0, s[4:7], s55 offen offset:1024 sc1 lds
buffer_load_dwordx4 v0, s[4:7], s55 offen offset:2048 sc1 lds
buffer_load_dwordx4 v0, s[4:7], s55 offen offset:3072 sc1 lds
s_add_u32 m0, s45, 8192
s_add_u32 s55, s46, 8192
buffer_load_dwordx4 v0, s[4:7], s55 offen offset:0 sc1 lds
buffer_load_dwordx4 v0, s[4:7], s55 offen offset:1024 sc1 lds
s_add_u32 s45, s45, 40960
s_cmp_ge_u32 s45, 122880
s_cselect_b32 s55, 122880, 0
s_sub_u32 s45, s45, s55
s_add_u32 s46, s46, s49
s_mov_b32 s49, 0
s_waitcnt vmcnt(10)
s_barrier
ds_read_b128 v[8:11], v64 offset:0
ds_read_b128 v[12:15], v64 offset:1024
ds_read_b128 v[16:19], v64 offset:2048
ds_read_b128 v[20:23], v64 offset:3072
s_mov_b32 s59, 1
s_waitcnt lgkmcnt(3)
v_mfma_f32_32x32x16_bf16 v[32:47], v[96:99], v[8:11], 0
s_waitcnt lgkmcnt(2)
ds_read_b128 v[24:27], v64 offset:4096
v_mfma_f32_32x32x16_bf16 v[32:47], v[100:103], v[12:15], v[32:47]
s_waitcnt lgkmcnt(2)
ds_read_b128 v[8:11], v64 offset:5120
s_add_u32 m0, s45, 0
s_add_u32 s55, s46, 0
buffer_load_dwordx4 v0, s[4:7], s55 offen offset:0 sc1 lds
buffer_load_dwordx4 v0, s[4:7], s55 offen offset:1024 sc1 lds
v_mfma_f32_32x32x16_bf16 v[32:47], v[104:107], v[16:19], v[32:47]
s_waitcnt lgkmcnt(2)
ds_read_b128 v[12:15], v64 offset:6144
buffer_load_dwordx4 v0, s[4:7], s55 offen offset:2048 sc1 lds
buffer_load_dwordx4 v0, s[4:7], s55 offen offset:3072 sc1 lds
v_mfma_f32_32x32x16_bf16 v[32:47], v[108:111], v[20:23], v[32:47]
s_waitcnt lgkmcnt(2)
ds_read_b128 v[16:19], v64 offset:7168
s_add_u32 m0, s45, 4096
s_add_u32 s55, s46, 4096
buffer_load_dwordx4 v0, s[4:7], s55 offen offset:0 sc1 lds
buffer_load_dwordx4 v0, s[4:7], s55 offen offset:1024 sc1 lds
v_mfma_f32_32x32x16_bf16 v[32:47], v[112:115], v[24:27], v[32:47]
s_waitcnt lgkmcnt(2)
ds_read_b128 v[20:23], v64 offset:8192
buffer_load_dwordx4 v0, s[4:7], s55 offen offset:2048 sc1 lds
buffer_load_dwordx4 v0, s[4:7], s55 offen offset:3072 sc1 lds
v_mfma_f32_32x32x16_bf16 v[32:47], v[116:119], v[8:11], v[32:47]
s_waitcnt lgkmcnt(2)
ds_read_b128 v[24:27], v64 offset:9216
s_add_u32 m0, s45, 8192
s_add_u32 s55, s46, 8192
buffer_load_dwordx4 v0, s[4:7], s55 offen offset:0 sc1 lds
buffer_load_dwordx4 v0, s[4:7], s55 offen offset:1024 sc1 lds
v_mfma_f32_32x32x16_bf16 v[32:47], v[120:123], v[12:15], v[32:47]
s_waitcnt lgkmcnt(2)
ds_read_b128 v[8:11], v64 offset:10240
s_add_u32 s45, s45, 40960
s_cmp_ge_u32 s45, 122880
s_cselect_b32 s55, 122880, 0
s_sub_u32 s45, s45, s55
s_add_u32 s46, s46, s49
s_mov_b32 s49, 0
v_mfma_f32_32x32x16_bf16 v[32:47], v[124:127], v[16:19], v[32:47]
s_waitcnt lgkmcnt(2)
ds_read_b128 v[12:15], v64 offset:11264
v_mfma_f32_32x32x16_bf16 v[32:47], v[128:131], v[20:23], v[32:47]
s_waitcnt lgkmcnt(2)
ds_read_b128 v[16:19], v64 offset:12288
v_mfma_f32_32x32x16_bf16 v[32:47], v[132:135], v[24:27], v[32:47]
s_waitcnt lgkmcnt(2)
ds_read_b128 v[20:23], v64 offset:13312
v_mfma_f32_32x32x16_bf16 v[32:47], v[136:139], v[8:11], v[32:47]
s_waitcnt lgkmcnt(2)
ds_read_b128 v[24:27], v64 offset:14336
v_mfma_f32_32x32x16_bf16 v[32:47], v[140:143], v[12:15], v[32:47]
s_waitcnt lgkmcnt(2)
ds_read_b128 v[8:11], v64 offset:15360
v_mfma_f32_32x32x16_bf16 v[32:47], v[144:147], v[16:19], v[32:47]
s_waitcnt lgkmcnt(2)
ds_read_b128 v[12:15], v64 offset:16384
v_mfma_f32_32x32x16_bf16 v[32:47], v[148:151], v[20:23], v[32:47]
s_waitcnt lgkmcnt(2)
ds_read_b128 v[16:19], v64 offset:17408
v_mfma_f32_32x32x16_bf16 v[32:47], v[152:155], v[24:27], v[32:47]
s_waitcnt lgkmcnt(2)
ds_read_b128 v[20:23], v64 offset:18432
v_mfma_f32_32x32x16_bf16 v[32:47], v[156:159], v[8:11], v[32:47]
s_waitcnt lgkmcnt(2)
ds_read_b128 v[24:27], v64 offset:19456
v_mfma_f32_32x32x16_bf16 v[32:47], v[160:163], v[12:15], v[32:47]
s_waitcnt lgkmcnt(2)
ds_read_b128 v[8:11], v64 offset:20480
v_mfma_f32_32x32x16_bf16 v[32:47], v[164:167], v[16:19], v[32:47]
s_waitcnt lgkmcnt(2)
ds_read_b128 v[12:15], v64 offset:21504
v_mfma_f32_32x32x16_bf16 v[32:47], v[168:171], v[20:23], v[32:47]
s_waitcnt lgkmcnt(2)
ds_read_b128 v[16:19], v64 offset:22528
v_mfma_f32_32x32x16_bf16 v[32:47], v[172:175], v[24:27], v[32:47]
s_waitcnt lgkmcnt(2)
ds_read_b128 v[20:23], v64 offset:23552
v_mfma_f32_32x32x16_bf16 v[32:47], v[176:179], v[8:11], v[32:47]
s_waitcnt lgkmcnt(2)
ds_read_b128 v[24:27], v64 offset:24576
v_mfma_f32_32x32x16_bf16 v[32:47], v[180:183], v[12:15], v[32:47]
s_waitcnt lgkmcnt(2)
ds_read_b128 v[8:11], v64 offset:25600
v_mfma_f32_32x32x16_bf16 v[32:47], v[184:187], v[16:19], v[32:47]
s_waitcnt lgkmcnt(2)
ds_read_b128 v[12:15], v64 offset:26624
v_mfma_f32_32x32x16_bf16 v[32:47], v[188:191], v[20:23], v[32:47]
s_waitcnt lgkmcnt(2)
ds_read_b128 v[16:19], v64 offset:27648
v_mfma_f32_32x32x16_bf16 v[32:47], v[192:195], v[24:27], v[32:47]
s_waitcnt lgkmcnt(2)
ds_read_b128 v[20:23], v64 offset:28672
v_mfma_f32_32x32x16_bf16 v[32:47], v[196:199], v[8:11], v[32:47]
s_waitcnt lgkmcnt(2)
ds_read_b128 v[24:27], v64 offset:29696
v_mfma_f32_32x32x16_bf16 v[32:47], v[200:203], v[12:15], v[32:47]
s_waitcnt lgkmcnt(2)
ds_read_b128 v[8:11], v64 offset:30720
v_mfma_f32_32x32x16_bf16 v[32:47], v[204:207], v[16:19], v[32:47]
s_waitcnt lgkmcnt(2)
ds_read_b128 v[12:15], v64 offset:31744
v_mfma_f32_32x32x16_bf16 v[32:47], v[208:211], v[20:23], v[32:47]
s_waitcnt lgkmcnt(2)
ds_read_b128 v[16:19], v64 offset:32768
v_mfma_f32_32x32x16_bf16 v[32:47], v[212:215], v[24:27], v[32:47]
s_waitcnt lgkmcnt(2)
ds_read_b128 v[20:23], v64 offset:33792
v_mfma_f32_32x32x16_bf16 v[32:47], v[216:219], v[8:11], v[32:47]
s_waitcnt lgkmcnt(2)
ds_read_b128 v[24:27], v64 offset:34816
v_mfma_f32_32x32x16_bf16 v[32:47], v[220:223], v[12:15], v[32:47]
s_waitcnt lgkmcnt(2)
ds_read_b128 v[8:11], v64 offset:35840
v_mfma_f32_32x32x16_bf16 v[32:47], v[224:227], v[16:19], v[32:47]
s_waitcnt lgkmcnt(2)
ds_read_b128 v[12:15], v64 offset:36864
v_mfma_f32_32x32x16_bf16 v[32:47], v[228:231], v[20:23], v[32:47]
s_waitcnt lgkmcnt(2)
ds_read_b128 v[16:19], v64 offset:37888
v_mfma_f32_32x32x16_bf16 v[32:47], v[232:235], v[24:27], v[32:47]
s_waitcnt lgkmcnt(2)
ds_read_b128 v[20:23], v64 offset:38912
v_mfma_f32_32x32x16_bf16 v[32:47], v[236:239], v[8:11], v[32:47]
s_waitcnt lgkmcnt(2)
ds_read_b128 v[24:27], v64 offset:39936
v_mfma_f32_32x32x16_bf16 v[32:47], v[240:243], v[12:15], v[32:47]
s_add_u32 s44, s44, 1
s_cmp_eq_u32 s44, 3
s_mov_b32 s56, 40960
s_cmov_b32 s56, -81920
s_cselect_b32 s44, 0, s44
v_add_u32 v64, s56, v64
s_waitcnt vmcnt(10) lgkmcnt(2)
s_barrier
ds_read_b128 v[8:11], v64 offset:0
v_mfma_f32_32x32x16_bf16 v[32:47], v[244:247], v[16:19], v[32:47]
s_waitcnt lgkmcnt(2)
ds_read_b128 v[12:15], v64 offset:1024
v_mfma_f32_32x32x16_bf16 v[32:47], v[248:251], v[20:23], v[32:47]
s_waitcnt lgkmcnt(2)
ds_read_b128 v[16:19], v64 offset:2048
v_mfma_f32_32x32x16_bf16 v[32:47], v[252:255], v[24:27], v[32:47]
s_waitcnt lgkmcnt(2)
ds_read_b128 v[20:23], v64 offset:3072
k_st_106:
v_mfma_f32_32x32x16_bf16 v[48:63], v[96:99], v[8:11], 0
s_waitcnt lgkmcnt(2)
ds_read_b128 v[24:27], v64 offset:4096
v_mfma_f32_32x32x16_bf16 v[48:63], v[100:103], v[12:15], v[48:63]
s_waitcnt lgkmcnt(2)
ds_read_b128 v[8:11], v64 offset:5120
v_cvt_pk_bf16_f32 v32, v32, v33
v_cvt_pk_bf16_f32 v33, v34, v35
v_mfma_f32_32x32x16_bf16 v[48:63], v[104:107], v[16:19], v[48:63]
s_waitcnt lgkmcnt(2)
ds_read_b128 v[12:15], v64 offset:6144
v_cvt_pk_bf16_f32 v34, v36, v37
v_cvt_pk_bf16_f32 v35, v38, v39
v_mfma_f32_32x32x16_bf16 v[48:63], v[108:111], v[20:23], v[48:63]
s_waitcnt lgkmcnt(2)
ds_read_b128 v[16:19], v64 offset:7168
v_cvt_pk_bf16_f32 v36, v40, v41
v_cvt_pk_bf16_f32 v37, v42, v43
v_mfma_f32_32x32x16_bf16 v[48:63], v[112:115], v[24:27], v[48:63]
s_waitcnt lgkmcnt(2)
ds_read_b128 v[20:23], v64 offset:8192
v_cvt_pk_bf16_f32 v38, v44, v45
v_cvt_pk_bf16_f32 v39, v46, v47
v_mfma_f32_32x32x16_bf16 v[48:63], v[116:119], v[8:11], v[48:63]
s_waitcnt lgkmcnt(2)
ds_read_b128 v[24:27], v64 offset:9216
buffer_store_dwordx4 v[32:35], v1, s[36:39], s48 offen offset:0
buffer_store_dwordx4 v[36:39], v1, s[36:39], s48 offen offset:16
v_mfma_f32_32x32x16_bf16 v[48:63], v[120:123], v[12:15], v[48:63]
s_waitcnt lgkmcnt(2)
ds_read_b128 v[8:11], v64 offset:10240
s_add_u32 s48, s48, 1310720
s_add_u32 m0, s45, 0
s_add_u32 s55, s46, 0
buffer_load_dwordx4 v0, s[4:7], s55 offen offset:0 sc1 lds
v_mfma_f32_32x32x16_bf16 v[48:63], v[124:127], v[16:19], v[48:63]
s_waitcnt lgkmcnt(2)
ds_read_b128 v[12:15], v64 offset:11264
buffer_load_dwordx4 v0, s[4:7], s55 offen offset:1024 sc1 lds
buffer_load_dwordx4 v0, s[4:7], s55 offen offset:2048 sc1 lds
v_mfma_f32_32x32x16_bf16 v[48:63], v[128:131], v[20:23], v[48:63]
s_waitcnt lgkmcnt(2)
ds_read_b128 v[16:19], v64 offset:12288
buffer_load_dwordx4 v0, s[4:7], s55 offen offset:3072 sc1 lds
s_add_u32 m0, s45, 4096
s_add_u32 s55, s46, 4096
buffer_load_dwordx4 v0, s[4:7], s55 offen offset:0 sc1 lds
v_mfma_f32_32x32x16_bf16 v[48:63], v[132:135], v[24:27], v[48:63]
s_waitcnt lgkmcnt(2)
ds_read_b128 v[20:23], v64 offset:13312
buffer_load_dwordx4 v0, s[4:7], s55 offen offset:1024 sc1 lds
buffer_load_dwordx4 v0, s[4:7], s55 offen offset:2048 sc1 lds
v_mfma_f32_32x32x16_bf16 v[48:63], v[136:139], v[8:11], v[48:63]
s_waitcnt lgkmcnt(2)
ds_read_b128 v[24:27], v64 offset:14336
buffer_load_dwordx4 v0, s[4:7], s55 offen offset:3072 sc1 lds
s_add_u32 m0, s45, 8192
s_add_u32 s55, s46, 8192
buffer_load_dwordx4 v0, s[4:7], s55 offen offset:0 sc1 lds
v_mfma_f32_32x32x16_bf16 v[48:63], v[140:143], v[12:15], v[48:63]
s_waitcnt lgkmcnt(2)
ds_read_b128 v[8:11], v64 offset:15360
buffer_load_dwordx4 v0, s[4:7], s55 offen offset:1024 sc1 lds
s_add_u32 s45, s45, 40960
s_cmp_ge_u32 s45, 122880
s_cselect_b32 s55, 122880, 0
s_sub_u32 s45, s45, s55
v_mfma_f32_32x32x16_bf16 v[48:63], v[144:147], v[16:19], v[48:63]
s_waitcnt lgkmcnt(2)
ds_read_b128 v[12:15], v64 offset:16384
s_add_u32 s46, s46, s49
s_mov_b32 s49, 0
v_mfma_f32_32x32x16_bf16 v[48:63], v[148:151], v[20:23], v[48:63]
s_waitcnt lgkmcnt(2)
ds_read_b128 v[16:19], v64 offset:17408
v_mfma_f32_32x32x16_bf16 v[48:63], v[152:155], v[24:27], v[48:63]
s_waitcnt lgkmcnt(2)
ds_read_b128 v[20:23], v64 offset:18432
v_mfma_f32_32x32x16_bf16 v[48:63], v[156:159], v[8:11], v[48:63]
s_waitcnt lgkmcnt(2)
ds_read_b128 v[24:27], v64 offset:19456
v_mfma_f32_32x32x16_bf16 v[48:63], v[160:163], v[12:15], v[48:63]
s_waitcnt lgkmcnt(2)
ds_read_b128 v[8:11], v64 offset:20480
v_mfma_f32_32x32x16_bf16 v[48:63], v[164:167], v[16:19], v[48:63]
s_waitcnt lgkmcnt(2)
ds_read_b128 v[12:15], v64 offset:21504
v_mfma_f32_32x32x16_bf16 v[48:63], v[168:171], v[20:23], v[48:63]
s_waitcnt lgkmcnt(2)
ds_read_b128 v[16:19], v64 offset:22528
v_mfma_f32_32x32x16_bf16 v[48:63], v[172:175], v[24:27], v[48:63]
s_waitcnt lgkmcnt(2)
ds_read_b128 v[20:23], v64 offset:23552
v_mfma_f32_32x32x16_bf16 v[48:63], v[176:179], v[8:11], v[48:63]
s_waitcnt lgkmcnt(2)
ds_read_b128 v[24:27], v64 offset:24576
v_mfma_f32_32x32x16_bf16 v[48:63], v[180:183], v[12:15], v[48:63]
s_waitcnt lgkmcnt(2)
ds_read_b128 v[8:11], v64 offset:25600
v_mfma_f32_32x32x16_bf16 v[48:63], v[184:187], v[16:19], v[48:63]
s_waitcnt lgkmcnt(2)
ds_read_b128 v[12:15], v64 offset:26624
v_mfma_f32_32x32x16_bf16 v[48:63], v[188:191], v[20:23], v[48:63]
s_waitcnt lgkmcnt(2)
ds_read_b128 v[16:19], v64 offset:27648
v_mfma_f32_32x32x16_bf16 v[48:63], v[192:195], v[24:27], v[48:63]
s_waitcnt lgkmcnt(2)
ds_read_b128 v[20:23], v64 offset:28672
v_mfma_f32_32x32x16_bf16 v[48:63], v[196:199], v[8:11], v[48:63]
s_waitcnt lgkmcnt(2)
ds_read_b128 v[24:27], v64 offset:29696
v_mfma_f32_32x32x16_bf16 v[48:63], v[200:203], v[12:15], v[48:63]
s_waitcnt lgkmcnt(2)
ds_read_b128 v[8:11], v64 offset:30720
v_mfma_f32_32x32x16_bf16 v[48:63], v[204:207], v[16:19], v[48:63]
s_waitcnt lgkmcnt(2)
ds_read_b128 v[12:15], v64 offset:31744
v_mfma_f32_32x32x16_bf16 v[48:63], v[208:211], v[20:23], v[48:63]
s_waitcnt lgkmcnt(2)
ds_read_b128 v[16:19], v64 offset:32768
v_mfma_f32_32x32x16_bf16 v[48:63], v[212:215], v[24:27], v[48:63]
s_waitcnt lgkmcnt(2)
ds_read_b128 v[20:23], v64 offset:33792
v_mfma_f32_32x32x16_bf16 v[48:63], v[216:219], v[8:11], v[48:63]
s_waitcnt lgkmcnt(2)
ds_read_b128 v[24:27], v64 offset:34816
v_mfma_f32_32x32x16_bf16 v[48:63], v[220:223], v[12:15], v[48:63]
s_waitcnt lgkmcnt(2)
ds_read_b128 v[8:11], v64 offset:35840
v_mfma_f32_32x32x16_bf16 v[48:63], v[224:227], v[16:19], v[48:63]
s_waitcnt lgkmcnt(2)
ds_read_b128 v[12:15], v64 offset:36864
v_mfma_f32_32x32x16_bf16 v[48:63], v[228:231], v[20:23], v[48:63]
s_waitcnt lgkmcnt(2)
ds_read_b128 v[16:19], v64 offset:37888
v_mfma_f32_32x32x16_bf16 v[48:63], v[232:235], v[24:27], v[48:63]
s_waitcnt lgkmcnt(2)
ds_read_b128 v[20:23], v64 offset:38912
v_mfma_f32_32x32x16_bf16 v[48:63], v[236:239], v[8:11], v[48:63]
s_waitcnt lgkmcnt(2)
ds_read_b128 v[24:27], v64 offset:39936
v_mfma_f32_32x32x16_bf16 v[48:63], v[240:243], v[12:15], v[48:63]
s_add_u32 s44, s44, 1
s_cmp_eq_u32 s44, 3
s_mov_b32 s56, 40960
s_cmov_b32 s56, -81920
s_cselect_b32 s44, 0, s44
v_add_u32 v64, s56, v64
s_waitcnt vmcnt(10) lgkmcnt(2)
s_barrier
ds_read_b128 v[8:11], v64 offset:0
v_mfma_f32_32x32x16_bf16 v[48:63], v[244:247], v[16:19], v[48:63]
s_waitcnt lgkmcnt(2)
ds_read_b128 v[12:15], v64 offset:1024
v_mfma_f32_32x32x16_bf16 v[48:63], v[248:251], v[20:23], v[48:63]
s_waitcnt lgkmcnt(2)
ds_read_b128 v[16:19], v64 offset:2048
v_mfma_f32_32x32x16_bf16 v[48:63], v[252:255], v[24:27], v[48:63]
s_waitcnt lgkmcnt(2)
ds_read_b128 v[20:23], v64 offset:3072
s_nop 9
v_cvt_pk_bf16_f32 v48, v48, v49
v_cvt_pk_bf16_f32 v49, v50, v51
v_cvt_pk_bf16_f32 v50, v52, v53
v_cvt_pk_bf16_f32 v51, v54, v55
v_cvt_pk_bf16_f32 v52, v56, v57
v_cvt_pk_bf16_f32 v53, v58, v59
v_cvt_pk_bf16_f32 v54, v60, v61
v_cvt_pk_bf16_f32 v55, v62, v63
buffer_store_dwordx4 v[48:51], v1, s[36:39], s48 offen offset:0
buffer_store_dwordx4 v[52:55], v1, s[36:39], s48 offen offset:16
s_add_u32 s48, s48, 1310720
s_waitcnt vmcnt(0)
s_endpgm
k_team_3:
s_cmp_eq_u32 s3, 1
s_cbranch_scc1 k_w1_109
s_cmp_eq_u32 s3, 2
s_cbranch_scc1 k_w2_110
s_cmp_eq_u32 s3, 3
s_cbranch_scc1 k_w3_111
k_w0_108:
v_lshrrev_b32 v12, 3, v0
v_lshlrev_b32 v10, 13, v12
v_bfe_u32 v12, v0, 1, 2
v_lshrrev_b32 v13, 4, v0
v_xor_b32 v12, v12, v13
v_lshl_add_u32 v10, v12, 5, v10
v_and_b32 v14, 1, v0
v_lshl_add_u32 v10, v14, 4, v10
v_mul_u32_u24 v11, 1280, v13
v_bfe_u32 v12, v0, 1, 3
v_and_b32 v13, 1, v13
v_lshlrev_b32 v13, 1, v13
v_xor_b32 v12, v12, v13
v_xor_b32 v12, 0, v12
v_lshl_add_u32 v11, v12, 5, v11
v_lshl_add_u32 v11, v14, 4, v11
v_bfe_u32 v12, v0, 5, 1
v_lshlrev_b32 v12, 4, v12
v_bfe_u32 v13, v0, 4, 1
v_lshl_add_u32 v12, v13, 1, v12
v_bfe_u32 v13, v0, 2, 1
v_lshl_add_u32 v12, v13, 2, v12
v_bfe_u32 v13, v0, 3, 1
v_mul_u32_u24 v15, 4224, v13
v_add_u32 v12, v13, v12
v_bfe_u32 v13, v12, 1, 2
v_xor_b32 v13, 0, v13
v_lshlrev_b32 v13, 5, v13
v_lshl_add_u32 v4, v12, 7, v13
v_and_b32 v14, 3, v0
v_lshl_add_u32 v4, v14, 3, v4
v_add_u32 v5, 0x10000, v4
v_add_u32 v6, 0x20000, v4
v_bfe_u32 v12, v0, 4, 1
v_lshlrev_b32 v13, 4, v12
v_lshlrev_b32 v12, 2, v12
v_bfe_u32 v8, v0, 5, 1
v_lshl_add_u32 v13, v8, 2, v13
v_bfe_u32 v8, v0, 2, 1
v_add_u32 v13, v8, v13
v_lshl_add_u32 v12, v8, 1, v12
v_bfe_u32 v8, v0, 3, 1
v_add_u32 v8, 0, v8
v_xor_b32 v12, v12, v8
v_lshlrev_b32 v12, 5, v12
v_lshl_add_u32 v7, v13, 8, v12
v_lshl_add_u32 v7, v14, 3, v7
v_add_u32 v8, 0x10000, v7
v_add_u32 v9, 0x20000, v7
v_lshlrev_b32 v0, 4, v0
v_add_u32 v2, 98304, v0
s_lshl_b32 s49, s30, 8
s_mul_i32 s50, s30, 163840
s_mul_i32 s60, s30, 131072
s_add_u32 s60, s60, 120586240
s_add_u32 s61, s60, 4096
s_add_u32 s62, s60, 8192
s_mov_b32 m0, 0
s_add_u32 s48, s49, 0
buffer_load_dwordx4 v10, s[8:11], s48 offen lds
s_mov_b32 m0, 1024
s_add_u32 s48, s49, 65536
buffer_load_dwordx4 v10, s[8:11], s48 offen lds
s_mov_b32 m0, 8192
s_add_u32 s48, s49, 128
buffer_load_dwordx4 v10, s[8:11], s48 offen lds
s_mov_b32 m0, 9216
s_add_u32 s48, s49, 65664
buffer_load_dwordx4 v10, s[8:11], s48 offen lds
s_mov_b32 m0, 16384
s_add_u32 s48, s49, 128
buffer_load_dwordx4 v10, s[12:15], s48 offen lds
s_mov_b32 m0, 17408
s_add_u32 s48, s49, 65664
buffer_load_dwordx4 v10, s[12:15], s48 offen lds
s_mov_b32 m0, 24576
s_add_u32 s48, s49, 0
buffer_load_dwordx4 v10, s[16:19], s48 offen lds
s_mov_b32 m0, 25600
s_add_u32 s48, s49, 65536
buffer_load_dwordx4 v10, s[16:19], s48 offen lds
s_mov_b32 m0, 32768
s_add_u32 s48, s49, 128
buffer_load_dwordx4 v10, s[16:19], s48 offen lds
s_mov_b32 m0, 33792
s_add_u32 s48, s49, 65664
buffer_load_dwordx4 v10, s[16:19], s48 offen lds
s_mov_b32 m0, 40960
s_add_u32 s48, s49, 524288
buffer_load_dwordx4 v10, s[8:11], s48 offen lds
s_mov_b32 m0, 41984
s_add_u32 s48, s49, 589824
buffer_load_dwordx4 v10, s[8:11], s48 offen lds
s_mov_b32 m0, 49152
s_add_u32 s48, s49, 524416
buffer_load_dwordx4 v10, s[8:11], s48 offen lds
s_mov_b32 m0, 50176
s_add_u32 s48, s49, 589952
buffer_load_dwordx4 v10, s[8:11], s48 offen lds
s_mov_b32 m0, 57344
s_add_u32 s48, s49, 524416
buffer_load_dwordx4 v10, s[12:15], s48 offen lds
s_mov_b32 m0, 58368
s_add_u32 s48, s49, 589952
buffer_load_dwordx4 v10, s[12:15], s48 offen lds
s_mov_b32 m0, 65536
s_add_u32 s48, s49, 524288
buffer_load_dwordx4 v10, s[16:19], s48 offen lds
s_mov_b32 m0, 66560
s_add_u32 s48, s49, 589824
buffer_load_dwordx4 v10, s[16:19], s48 offen lds
s_mov_b32 m0, 73728
s_add_u32 s48, s49, 524416
buffer_load_dwordx4 v10, s[16:19], s48 offen lds
s_mov_b32 m0, 74752
s_add_u32 s48, s49, 589952
buffer_load_dwordx4 v10, s[16:19], s48 offen lds
s_mov_b32 m0, 81920
s_add_u32 s48, s49, 1048576
buffer_load_dwordx4 v10, s[8:11], s48 offen lds
s_mov_b32 m0, 82944
s_add_u32 s48, s49, 1114112
buffer_load_dwordx4 v10, s[8:11], s48 offen lds
s_mov_b32 m0, 90112
s_add_u32 s48, s49, 1048704
buffer_load_dwordx4 v10, s[8:11], s48 offen lds
s_mov_b32 m0, 91136
s_add_u32 s48, s49, 1114240
buffer_load_dwordx4 v10, s[8:11], s48 offen lds
s_mov_b32 m0, 98304
s_add_u32 s48, s49, 1048704
buffer_load_dwordx4 v10, s[12:15], s48 offen lds
s_mov_b32 m0, 99328
s_add_u32 s48, s49, 1114240
buffer_load_dwordx4 v10, s[12:15], s48 offen lds
s_mov_b32 m0, 106496
s_add_u32 s48, s49, 1048576
buffer_load_dwordx4 v10, s[16:19], s48 offen lds
s_mov_b32 m0, 107520
s_add_u32 s48, s49, 1114112
buffer_load_dwordx4 v10, s[16:19], s48 offen lds
s_mov_b32 m0, 114688
s_add_u32 s48, s49, 1572864
buffer_load_dwordx4 v10, s[8:11], s48 offen lds
s_mov_b32 m0, 115712
s_add_u32 s48, s49, 1638400
buffer_load_dwordx4 v10, s[8:11], s48 offen lds
s_mov_b32 m0, 122880
s_add_u32 s48, s49, 1572992
buffer_load_dwordx4 v10, s[8:11], s48 offen lds
s_mov_b32 m0, 123904
s_add_u32 s48, s49, 1638528
buffer_load_dwordx4 v10, s[8:11], s48 offen lds
s_waitcnt vmcnt(24)
s_barrier
s_mov_b32 m0, 131072
s_add_u32 s48, s49, 1572992
buffer_load_dwordx4 v10, s[12:15], s48 offen lds
s_mov_b32 m0, 132096
s_add_u32 s48, s49, 1638528
buffer_load_dwordx4 v10, s[12:15], s48 offen lds
s_mov_b32 m0, 139264
s_add_u32 s48, s49, 1572864
buffer_load_dwordx4 v10, s[16:19], s48 offen lds
s_mov_b32 m0, 140288
s_add_u32 s48, s49, 1638400
buffer_load_dwordx4 v10, s[16:19], s48 offen lds
s_mov_b32 m0, 147456
s_add_u32 s48, s49, 2097152
buffer_load_dwordx4 v10, s[8:11], s48 offen lds
s_mov_b32 m0, 148480
s_add_u32 s48, s49, 2162688
buffer_load_dwordx4 v10, s[8:11], s48 offen lds
s_mov_b32 m0, 155648
s_add_u32 s48, s49, 2097280
buffer_load_dwordx4 v10, s[8:11], s48 offen lds
s_mov_b32 m0, 156672
s_add_u32 s48, s49, 2162816
buffer_load_dwordx4 v10, s[8:11], s48 offen lds
ds_read_b64_tr_b16 a[0:1], v4 offset:0
ds_read_b64_tr_b16 a[2:3], v4 offset:1024
ds_read_b64_tr_b16 a[4:5], v4 offset:4096
ds_read_b64_tr_b16 a[6:7], v4 offset:5120
ds_read_b64_tr_b16 a[8:9], v4 offset:8192
ds_read_b64_tr_b16 a[10:11], v4 offset:9216
ds_read_b64_tr_b16 a[12:13], v4 offset:12288
ds_read_b64_tr_b16 a[14:15], v4 offset:13312
ds_read_b64_tr_b16 a[16:17], v4 offset:16384
ds_read_b64_tr_b16 a[18:19], v4 offset:17408
ds_read_b64_tr_b16 a[20:21], v4 offset:20480
ds_read_b64_tr_b16 a[22:23], v4 offset:21504
ds_read_b64_tr_b16 v[40:41], v4 offset:24576
ds_read_b64_tr_b16 v[42:43], v4 offset:25600
ds_read_b64_tr_b16 v[44:45], v4 offset:28672
ds_read_b64_tr_b16 v[46:47], v4 offset:29696
s_waitcnt lgkmcnt(0)
buffer_store_dwordx4 v[40:43], v0, s[4:7], s60 offen offset:0
buffer_store_dwordx4 v[44:47], v0, s[4:7], s60 offen offset:1024
s_waitcnt vmcnt(26)
s_barrier
s_mov_b32 m0, 0
s_add_u32 s48, s49, 2097280
buffer_load_dwordx4 v10, s[12:15], s48 offen lds
s_mov_b32 m0, 1024
s_add_u32 s48, s49, 2162816
buffer_load_dwordx4 v10, s[12:15], s48 offen lds
s_mov_b32 m0, 8192
s_add_u32 s48, s49, 2097152
buffer_load_dwordx4 v10, s[16:19], s48 offen lds
s_mov_b32 m0, 9216
s_add_u32 s48, s49, 2162688
buffer_load_dwordx4 v10, s[16:19], s48 offen lds
s_mov_b32 m0, 16384
s_add_u32 s48, s49, 2621440
buffer_load_dwordx4 v10, s[8:11], s48 offen lds
s_mov_b32 m0, 17408
s_add_u32 s48, s49, 2686976
buffer_load_dwordx4 v10, s[8:11], s48 offen lds
s_mov_b32 m0, 24576
s_add_u32 s48, s49, 2621568
buffer_load_dwordx4 v10, s[8:11], s48 offen lds
s_mov_b32 m0, 25600
s_add_u32 s48, s49, 2687104
buffer_load_dwordx4 v10, s[8:11], s48 offen lds
ds_read_b64_tr_b16 v[16:17], v4 offset:32768
ds_read_b64_tr_b16 v[18:19], v4 offset:33792
ds_read_b64_tr_b16 v[20:21], v4 offset:36864
ds_read_b64_tr_b16 v[22:23], v4 offset:37888
ds_read_b64_tr_b16 a[24:25], v4 offset:40960
ds_read_b64_tr_b16 a[26:27], v4 offset:41984
ds_read_b64_tr_b16 a[28:29], v4 offset:45056
ds_read_b64_tr_b16 a[30:31], v4 offset:46080
ds_read_b64_tr_b16 a[32:33], v4 offset:49152
ds_read_b64_tr_b16 a[34:35], v4 offset:50176
ds_read_b64_tr_b16 a[36:37], v4 offset:53248
ds_read_b64_tr_b16 a[38:39], v4 offset:54272
ds_read_b64_tr_b16 a[40:41], v4 offset:57344
ds_read_b64_tr_b16 a[42:43], v4 offset:58368
ds_read_b64_tr_b16 a[44:45], v4 offset:61440
ds_read_b64_tr_b16 a[46:47], v4 offset:62464
s_waitcnt lgkmcnt(0)
buffer_store_dwordx4 v[16:19], v0, s[4:7], s60 offen offset:2048
buffer_store_dwordx4 v[20:23], v0, s[4:7], s60 offen offset:3072
s_waitcnt vmcnt(28)
s_barrier
s_mov_b32 m0, 32768
s_add_u32 s48, s49, 2621568
buffer_load_dwordx4 v10, s[12:15], s48 offen lds
s_mov_b32 m0, 33792
s_add_u32 s48, s49, 2687104
buffer_load_dwordx4 v10, s[12:15], s48 offen lds
s_mov_b32 m0, 40960
s_add_u32 s48, s49, 2621440
buffer_load_dwordx4 v10, s[16:19], s48 offen lds
s_mov_b32 m0, 41984
s_add_u32 s48, s49, 2686976
buffer_load_dwordx4 v10, s[16:19], s48 offen lds
s_mov_b32 m0, 49152
s_add_u32 s48, s49, 3145856
buffer_load_dwordx4 v10, s[8:11], s48 offen lds
s_mov_b32 m0, 50176
s_add_u32 s48, s49, 3211392
buffer_load_dwordx4 v10, s[8:11], s48 offen lds
s_mov_b32 m0, 57344
s_add_u32 s48, s49, 3670016
buffer_load_dwordx4 v10, s[8:11], s48 offen lds
s_mov_b32 m0, 58368
s_add_u32 s48, s49, 3735552
buffer_load_dwordx4 v10, s[8:11], s48 offen lds
ds_read_b64_tr_b16 a[176:177], v5 offset:0
ds_read_b64_tr_b16 a[178:179], v5 offset:1024
ds_read_b64_tr_b16 a[180:181], v5 offset:4096
ds_read_b64_tr_b16 a[182:183], v5 offset:5120
ds_read_b64_tr_b16 v[232:233], v5 offset:8192
ds_read_b64_tr_b16 v[234:235], v5 offset:9216
ds_read_b64_tr_b16 v[236:237], v5 offset:12288
ds_read_b64_tr_b16 v[238:239], v5 offset:13312
ds_read_b64_tr_b16 a[48:49], v5 offset:16384
ds_read_b64_tr_b16 a[50:51], v5 offset:17408
ds_read_b64_tr_b16 a[52:53], v5 offset:20480
ds_read_b64_tr_b16 a[54:55], v5 offset:21504
ds_read_b64_tr_b16 a[56:57], v5 offset:24576
ds_read_b64_tr_b16 a[58:59], v5 offset:25600
ds_read_b64_tr_b16 a[60:61], v5 offset:28672
ds_read_b64_tr_b16 a[62:63], v5 offset:29696
s_waitcnt lgkmcnt(0)
s_waitcnt vmcnt(28)
s_barrier
s_mov_b32 m0, 65536
s_add_u32 s48, s49, 3670144
buffer_load_dwordx4 v10, s[8:11], s48 offen lds
s_mov_b32 m0, 66560
s_add_u32 s48, s49, 3735680
buffer_load_dwordx4 v10, s[8:11], s48 offen lds
s_mov_b32 m0, 73728
s_add_u32 s48, s49, 4194304
buffer_load_dwordx4 v10, s[8:11], s48 offen lds
s_mov_b32 m0, 74752
s_add_u32 s48, s49, 4259840
buffer_load_dwordx4 v10, s[8:11], s48 offen lds
s_mov_b32 m0, 81920
s_add_u32 s48, s49, 4194432
buffer_load_dwordx4 v10, s[8:11], s48 offen lds
s_mov_b32 m0, 82944
s_add_u32 s48, s49, 4259968
buffer_load_dwordx4 v10, s[8:11], s48 offen lds
s_mov_b32 m0, 90112
s_add_u32 s48, s49, 4718592
buffer_load_dwordx4 v10, s[8:11], s48 offen lds
s_mov_b32 m0, 91136
s_add_u32 s48, s49, 4784128
buffer_load_dwordx4 v10, s[8:11], s48 offen lds
ds_read_b64_tr_b16 a[64:65], v5 offset:32768
ds_read_b64_tr_b16 a[66:67], v5 offset:33792
ds_read_b64_tr_b16 a[68:69], v5 offset:36864
ds_read_b64_tr_b16 a[70:71], v5 offset:37888
ds_read_b64_tr_b16 a[72:73], v5 offset:40960
ds_read_b64_tr_b16 a[74:75], v5 offset:41984
ds_read_b64_tr_b16 a[76:77], v5 offset:45056
ds_read_b64_tr_b16 a[78:79], v5 offset:46080
ds_read_b64_tr_b16 a[80:81], v5 offset:49152
ds_read_b64_tr_b16 a[82:83], v5 offset:50176
ds_read_b64_tr_b16 a[84:85], v5 offset:53248
ds_read_b64_tr_b16 a[86:87], v5 offset:54272
ds_read_b64_tr_b16 a[88:89], v5 offset:57344
ds_read_b64_tr_b16 a[90:91], v5 offset:58368
ds_read_b64_tr_b16 a[92:93], v5 offset:61440
ds_read_b64_tr_b16 a[94:95], v5 offset:62464
s_waitcnt lgkmcnt(0)
s_waitcnt vmcnt(28)
s_barrier
s_mov_b32 m0, 98304
s_add_u32 s48, s49, 4718720
buffer_load_dwordx4 v10, s[8:11], s48 offen lds
s_mov_b32 m0, 99328
s_add_u32 s48, s49, 4784256
buffer_load_dwordx4 v10, s[8:11], s48 offen lds
s_mov_b32 m0, 106496
s_add_u32 s48, s49, 3145728
buffer_load_dwordx4 v10, s[12:15], s48 offen lds
s_mov_b32 m0, 107520
s_add_u32 s48, s49, 3211264
buffer_load_dwordx4 v10, s[12:15], s48 offen lds
s_mov_b32 m0, 114688
s_add_u32 s48, s49, 3145856
buffer_load_dwordx4 v10, s[12:15], s48 offen lds
s_mov_b32 m0, 115712
s_add_u32 s48, s49, 3211392
buffer_load_dwordx4 v10, s[12:15], s48 offen lds
s_mov_b32 m0, 122880
s_add_u32 s48, s49, 3670016
buffer_load_dwordx4 v10, s[12:15], s48 offen lds
s_mov_b32 m0, 123904
s_add_u32 s48, s49, 3735552
buffer_load_dwordx4 v10, s[12:15], s48 offen lds
ds_read_b64_tr_b16 a[96:97], v6 offset:0
ds_read_b64_tr_b16 a[98:99], v6 offset:1024
ds_read_b64_tr_b16 a[100:101], v6 offset:4096
ds_read_b64_tr_b16 a[102:103], v6 offset:5120
ds_read_b64_tr_b16 a[104:105], v6 offset:8192
ds_read_b64_tr_b16 a[106:107], v6 offset:9216
ds_read_b64_tr_b16 a[108:109], v6 offset:12288
ds_read_b64_tr_b16 a[110:111], v6 offset:13312
ds_read_b64_tr_b16 a[112:113], v6 offset:16384
ds_read_b64_tr_b16 a[114:115], v6 offset:17408
ds_read_b64_tr_b16 a[116:117], v6 offset:20480
ds_read_b64_tr_b16 a[118:119], v6 offset:21504
ds_read_b64_tr_b16 a[120:121], v6 offset:24576
ds_read_b64_tr_b16 a[122:123], v6 offset:25600
ds_read_b64_tr_b16 a[124:125], v6 offset:28672
ds_read_b64_tr_b16 a[126:127], v6 offset:29696
s_waitcnt lgkmcnt(0)
s_waitcnt vmcnt(26)
s_barrier
s_mov_b32 m0, 131072
s_add_u32 s48, s49, 3670144
buffer_load_dwordx4 v10, s[12:15], s48 offen lds
s_mov_b32 m0, 132096
s_add_u32 s48, s49, 3735680
buffer_load_dwordx4 v10, s[12:15], s48 offen lds
s_mov_b32 m0, 139264
s_add_u32 s48, s49, 4194304
buffer_load_dwordx4 v10, s[12:15], s48 offen lds
s_mov_b32 m0, 140288
s_add_u32 s48, s49, 4259840
buffer_load_dwordx4 v10, s[12:15], s48 offen lds
s_mov_b32 m0, 147456
s_add_u32 s48, s49, 4194432
buffer_load_dwordx4 v10, s[12:15], s48 offen lds
s_mov_b32 m0, 148480
s_add_u32 s48, s49, 4259968
buffer_load_dwordx4 v10, s[12:15], s48 offen lds
s_mov_b32 m0, 155648
s_add_u32 s48, s49, 4718592
buffer_load_dwordx4 v10, s[12:15], s48 offen lds
s_mov_b32 m0, 156672
s_add_u32 s48, s49, 4784128
buffer_load_dwordx4 v10, s[12:15], s48 offen lds
ds_read_b64_tr_b16 a[128:129], v4 offset:0
ds_read_b64_tr_b16 a[130:131], v4 offset:1024
ds_read_b64_tr_b16 a[132:133], v4 offset:4096
ds_read_b64_tr_b16 a[134:135], v4 offset:5120
ds_read_b64_tr_b16 a[136:137], v4 offset:8192
ds_read_b64_tr_b16 a[138:139], v4 offset:9216
ds_read_b64_tr_b16 a[140:141], v4 offset:12288
ds_read_b64_tr_b16 a[142:143], v4 offset:13312
ds_read_b64_tr_b16 a[144:145], v4 offset:16384
ds_read_b64_tr_b16 a[146:147], v4 offset:17408
ds_read_b64_tr_b16 a[148:149], v4 offset:20480
ds_read_b64_tr_b16 a[150:151], v4 offset:21504
ds_read_b64_tr_b16 a[152:153], v4 offset:24576
ds_read_b64_tr_b16 a[154:155], v4 offset:25600
ds_read_b64_tr_b16 a[156:157], v4 offset:28672
ds_read_b64_tr_b16 a[158:159], v4 offset:29696
s_waitcnt lgkmcnt(0)
s_waitcnt vmcnt(24)
s_barrier
s_mov_b32 m0, 0
s_add_u32 s48, s49, 4718720
buffer_load_dwordx4 v10, s[12:15], s48 offen lds
s_mov_b32 m0, 1024
s_add_u32 s48, s49, 4784256
buffer_load_dwordx4 v10, s[12:15], s48 offen lds
s_mov_b32 m0, 8192
s_add_u32 s48, s49, 3145728
buffer_load_dwordx4 v10, s[16:19], s48 offen lds
s_mov_b32 m0, 9216
s_add_u32 s48, s49, 3211264
buffer_load_dwordx4 v10, s[16:19], s48 offen lds
s_mov_b32 m0, 16384
s_add_u32 s48, s49, 3145856
buffer_load_dwordx4 v10, s[16:19], s48 offen lds
s_mov_b32 m0, 17408
s_add_u32 s48, s49, 3211392
buffer_load_dwordx4 v10, s[16:19], s48 offen lds
s_mov_b32 m0, 24576
s_add_u32 s48, s49, 3670016
buffer_load_dwordx4 v10, s[16:19], s48 offen lds
s_mov_b32 m0, 25600
s_add_u32 s48, s49, 3735552
buffer_load_dwordx4 v10, s[16:19], s48 offen lds
ds_read_b64_tr_b16 a[160:161], v4 offset:32768
ds_read_b64_tr_b16 a[162:163], v4 offset:33792
ds_read_b64_tr_b16 a[164:165], v4 offset:36864
ds_read_b64_tr_b16 a[166:167], v4 offset:37888
ds_read_b64_tr_b16 a[168:169], v4 offset:40960
ds_read_b64_tr_b16 a[170:171], v4 offset:41984
ds_read_b64_tr_b16 a[172:173], v4 offset:45056
ds_read_b64_tr_b16 a[174:175], v4 offset:46080
ds_read_b64_tr_b16 a[192:193], v4 offset:49152
ds_read_b64_tr_b16 a[194:195], v4 offset:50176
ds_read_b64_tr_b16 a[196:197], v4 offset:53248
ds_read_b64_tr_b16 a[198:199], v4 offset:54272
ds_read_b64_tr_b16 v[240:241], v4 offset:57344
ds_read_b64_tr_b16 v[242:243], v4 offset:58368
ds_read_b64_tr_b16 v[244:245], v4 offset:61440
ds_read_b64_tr_b16 v[246:247], v4 offset:62464
s_waitcnt lgkmcnt(0)
s_waitcnt vmcnt(24)
s_barrier
s_mov_b32 m0, 32768
s_add_u32 s48, s49, 3670144
buffer_load_dwordx4 v10, s[16:19], s48 offen lds
s_mov_b32 m0, 33792
s_add_u32 s48, s49, 3735680
buffer_load_dwordx4 v10, s[16:19], s48 offen lds
s_mov_b32 m0, 40960
s_add_u32 s48, s49, 4194304
buffer_load_dwordx4 v10, s[16:19], s48 offen lds
s_mov_b32 m0, 41984
s_add_u32 s48, s49, 4259840
buffer_load_dwordx4 v10, s[16:19], s48 offen lds
s_mov_b32 m0, 49152
s_add_u32 s48, s49, 4194432
buffer_load_dwordx4 v10, s[16:19], s48 offen lds
s_mov_b32 m0, 50176
s_add_u32 s48, s49, 4259968
buffer_load_dwordx4 v10, s[16:19], s48 offen lds
s_mov_b32 m0, 57344
s_add_u32 s48, s49, 4718592
buffer_load_dwordx4 v10, s[16:19], s48 offen lds
s_mov_b32 m0, 58368
s_add_u32 s48, s49, 4784128
buffer_load_dwordx4 v10, s[16:19], s48 offen lds
ds_read_b64_tr_b16 a[200:201], v5 offset:0
ds_read_b64_tr_b16 a[202:203], v5 offset:1024
ds_read_b64_tr_b16 a[204:205], v5 offset:4096
ds_read_b64_tr_b16 a[206:207], v5 offset:5120
ds_read_b64_tr_b16 a[208:209], v5 offset:8192
ds_read_b64_tr_b16 a[210:211], v5 offset:9216
ds_read_b64_tr_b16 a[212:213], v5 offset:12288
ds_read_b64_tr_b16 a[214:215], v5 offset:13312
ds_read_b64_tr_b16 a[216:217], v5 offset:16384
ds_read_b64_tr_b16 a[218:219], v5 offset:17408
ds_read_b64_tr_b16 a[220:221], v5 offset:20480
ds_read_b64_tr_b16 a[222:223], v5 offset:21504
ds_read_b64_tr_b16 a[224:225], v5 offset:24576
ds_read_b64_tr_b16 a[226:227], v5 offset:25600
ds_read_b64_tr_b16 a[228:229], v5 offset:28672
ds_read_b64_tr_b16 a[230:231], v5 offset:29696
s_waitcnt lgkmcnt(0)
s_waitcnt vmcnt(24)
s_barrier
s_mov_b32 m0, 65536
s_add_u32 s48, s49, 4718720
buffer_load_dwordx4 v10, s[16:19], s48 offen lds
s_mov_b32 m0, 66560
s_add_u32 s48, s49, 4784256
buffer_load_dwordx4 v10, s[16:19], s48 offen lds
s_mov_b32 m0, 73728
s_add_u32 s48, s50, 0
buffer_load_dwordx4 v11, s[20:23], s48 offen lds
s_mov_b32 m0, 74752
s_add_u32 s48, s50, 5120
buffer_load_dwordx4 v11, s[20:23], s48 offen lds
s_mov_b32 m0, 81920
s_add_u32 s48, s50, 20480
buffer_load_dwordx4 v11, s[20:23], s48 offen lds
s_mov_b32 m0, 82944
s_add_u32 s48, s50, 25600
buffer_load_dwordx4 v11, s[20:23], s48 offen lds
s_mov_b32 m0, 90112
s_add_u32 s48, s50, 40960
buffer_load_dwordx4 v11, s[20:23], s48 offen lds
s_mov_b32 m0, 91136
s_add_u32 s48, s50, 46080
buffer_load_dwordx4 v11, s[20:23], s48 offen lds
ds_read_b64_tr_b16 a[232:233], v5 offset:32768
ds_read_b64_tr_b16 a[234:235], v5 offset:33792
ds_read_b64_tr_b16 a[236:237], v5 offset:36864
ds_read_b64_tr_b16 a[238:239], v5 offset:37888
ds_read_b64_tr_b16 v[248:249], v5 offset:40960
ds_read_b64_tr_b16 v[250:251], v5 offset:41984
ds_read_b64_tr_b16 v[252:253], v5 offset:45056
ds_read_b64_tr_b16 v[254:255], v5 offset:46080
ds_read_b64_tr_b16 a[240:241], v5 offset:49152
ds_read_b64_tr_b16 a[242:243], v5 offset:50176
ds_read_b64_tr_b16 a[244:245], v5 offset:53248
ds_read_b64_tr_b16 a[246:247], v5 offset:54272
ds_read_b64_tr_b16 a[248:249], v5 offset:57344
ds_read_b64_tr_b16 a[250:251], v5 offset:58368
ds_read_b64_tr_b16 a[252:253], v5 offset:61440
ds_read_b64_tr_b16 a[254:255], v5 offset:62464
s_waitcnt lgkmcnt(0)
s_waitcnt vmcnt(24)
s_barrier
s_mov_b32 m0, 98304
s_add_u32 s48, s50, 61440
buffer_load_dwordx4 v11, s[20:23], s48 offen lds
s_mov_b32 m0, 99328
s_add_u32 s48, s50, 66560
buffer_load_dwordx4 v11, s[20:23], s48 offen lds
s_mov_b32 m0, 106496
s_add_u32 s48, s50, 256
buffer_load_dwordx4 v11, s[20:23], s48 offen lds
s_mov_b32 m0, 107520
s_add_u32 s48, s50, 5376
buffer_load_dwordx4 v11, s[20:23], s48 offen lds
s_mov_b32 m0, 114688
s_add_u32 s48, s50, 20736
buffer_load_dwordx4 v11, s[20:23], s48 offen lds
s_mov_b32 m0, 115712
s_add_u32 s48, s50, 25856
buffer_load_dwordx4 v11, s[20:23], s48 offen lds
s_mov_b32 m0, 122880
s_add_u32 s48, s50, 41216
buffer_load_dwordx4 v11, s[20:23], s48 offen lds
s_mov_b32 m0, 123904
s_add_u32 s48, s50, 46336
buffer_load_dwordx4 v11, s[20:23], s48 offen lds
ds_read_b64_tr_b16 v[72:73], v6 offset:0
ds_read_b64_tr_b16 v[74:75], v6 offset:1024
ds_read_b64_tr_b16 v[76:77], v6 offset:4096
ds_read_b64_tr_b16 v[78:79], v6 offset:5120
ds_read_b64_tr_b16 v[80:81], v6 offset:8192
ds_read_b64_tr_b16 v[82:83], v6 offset:9216
ds_read_b64_tr_b16 v[84:85], v6 offset:12288
ds_read_b64_tr_b16 v[86:87], v6 offset:13312
ds_read_b64_tr_b16 v[88:89], v6 offset:16384
ds_read_b64_tr_b16 v[90:91], v6 offset:17408
ds_read_b64_tr_b16 v[92:93], v6 offset:20480
ds_read_b64_tr_b16 v[94:95], v6 offset:21504
ds_read_b64_tr_b16 v[96:97], v6 offset:24576
ds_read_b64_tr_b16 v[98:99], v6 offset:25600
ds_read_b64_tr_b16 v[100:101], v6 offset:28672
ds_read_b64_tr_b16 v[102:103], v6 offset:29696
s_waitcnt lgkmcnt(0)
s_waitcnt vmcnt(24)
s_barrier
s_mov_b32 m0, 131072
s_add_u32 s48, s50, 61696
buffer_load_dwordx4 v11, s[20:23], s48 offen lds
s_mov_b32 m0, 132096
s_add_u32 s48, s50, 66816
buffer_load_dwordx4 v11, s[20:23], s48 offen lds
s_mov_b32 m0, 139264
s_add_u32 s48, s50, 512
buffer_load_dwordx4 v11, s[20:23], s48 offen lds
s_mov_b32 m0, 140288
s_add_u32 s48, s50, 5632
buffer_load_dwordx4 v11, s[20:23], s48 offen lds
s_mov_b32 m0, 147456
s_add_u32 s48, s50, 20992
buffer_load_dwordx4 v11, s[20:23], s48 offen lds
s_mov_b32 m0, 148480
s_add_u32 s48, s50, 26112
buffer_load_dwordx4 v11, s[20:23], s48 offen lds
s_mov_b32 m0, 155648
s_add_u32 s48, s50, 41472
buffer_load_dwordx4 v11, s[20:23], s48 offen lds
s_mov_b32 m0, 156672
s_add_u32 s48, s50, 46592
buffer_load_dwordx4 v11, s[20:23], s48 offen lds
ds_read_b64_tr_b16 v[104:105], v4 offset:0
ds_read_b64_tr_b16 v[106:107], v4 offset:1024
ds_read_b64_tr_b16 v[108:109], v4 offset:4096
ds_read_b64_tr_b16 v[110:111], v4 offset:5120
ds_read_b64_tr_b16 v[112:113], v4 offset:8192
ds_read_b64_tr_b16 v[114:115], v4 offset:9216
ds_read_b64_tr_b16 v[116:117], v4 offset:12288
ds_read_b64_tr_b16 v[118:119], v4 offset:13312
ds_read_b64_tr_b16 v[120:121], v4 offset:16384
ds_read_b64_tr_b16 v[122:123], v4 offset:17408
ds_read_b64_tr_b16 v[124:125], v4 offset:20480
ds_read_b64_tr_b16 v[126:127], v4 offset:21504
ds_read_b64_tr_b16 v[128:129], v4 offset:24576
ds_read_b64_tr_b16 v[130:131], v4 offset:25600
ds_read_b64_tr_b16 v[132:133], v4 offset:28672
ds_read_b64_tr_b16 v[134:135], v4 offset:29696
s_waitcnt lgkmcnt(0)
s_waitcnt vmcnt(24)
s_barrier
s_mov_b32 m0, 0
s_add_u32 s48, s50, 61952
buffer_load_dwordx4 v11, s[20:23], s48 offen lds
s_mov_b32 m0, 1024
s_add_u32 s48, s50, 67072
buffer_load_dwordx4 v11, s[20:23], s48 offen lds
s_mov_b32 m0, 8192
s_add_u32 s48, s49, 0
buffer_load_dwordx4 v10, s[12:15], s48 offen lds
s_mov_b32 m0, 9216
s_add_u32 s48, s49, 65536
buffer_load_dwordx4 v10, s[12:15], s48 offen lds
s_mov_b32 m0, 16384
s_add_u32 s48, s49, 524288
buffer_load_dwordx4 v10, s[12:15], s48 offen lds
s_mov_b32 m0, 17408
s_add_u32 s48, s49, 589824
buffer_load_dwordx4 v10, s[12:15], s48 offen lds
s_mov_b32 m0, 24576
s_add_u32 s48, s49, 1048576
buffer_load_dwordx4 v10, s[12:15], s48 offen lds
s_mov_b32 m0, 25600
s_add_u32 s48, s49, 1114112
buffer_load_dwordx4 v10, s[12:15], s48 offen lds
ds_read_b64_tr_b16 v[136:137], v4 offset:32768
ds_read_b64_tr_b16 v[138:139], v4 offset:33792
ds_read_b64_tr_b16 v[140:141], v4 offset:36864
ds_read_b64_tr_b16 v[142:143], v4 offset:37888
ds_read_b64_tr_b16 v[144:145], v4 offset:40960
ds_read_b64_tr_b16 v[146:147], v4 offset:41984
ds_read_b64_tr_b16 v[148:149], v4 offset:45056
ds_read_b64_tr_b16 v[150:151], v4 offset:46080
ds_read_b64_tr_b16 v[152:153], v4 offset:49152
ds_read_b64_tr_b16 v[154:155], v4 offset:50176
ds_read_b64_tr_b16 v[156:157], v4 offset:53248
ds_read_b64_tr_b16 v[158:159], v4 offset:54272
ds_read_b64_tr_b16 v[160:161], v4 offset:57344
ds_read_b64_tr_b16 v[162:163], v4 offset:58368
ds_read_b64_tr_b16 v[164:165], v4 offset:61440
ds_read_b64_tr_b16 v[166:167], v4 offset:62464
s_waitcnt lgkmcnt(0)
s_waitcnt vmcnt(24)
s_barrier
s_mov_b32 m0, 32768
s_add_u32 s48, s49, 1572864
buffer_load_dwordx4 v10, s[12:15], s48 offen lds
s_mov_b32 m0, 33792
s_add_u32 s48, s49, 1638400
buffer_load_dwordx4 v10, s[12:15], s48 offen lds
s_mov_b32 m0, 40960
s_add_u32 s48, s49, 2097152
buffer_load_dwordx4 v10, s[12:15], s48 offen lds
s_mov_b32 m0, 41984
s_add_u32 s48, s49, 2162688
buffer_load_dwordx4 v10, s[12:15], s48 offen lds
s_mov_b32 m0, 49152
s_add_u32 s48, s49, 2621440
buffer_load_dwordx4 v10, s[12:15], s48 offen lds
s_mov_b32 m0, 50176
s_add_u32 s48, s49, 2686976
buffer_load_dwordx4 v10, s[12:15], s48 offen lds
s_mov_b32 m0, 57344
s_add_u32 s48, s49, 1048704
buffer_load_dwordx4 v10, s[16:19], s48 offen lds
s_mov_b32 m0, 58368
s_add_u32 s48, s49, 1114240
buffer_load_dwordx4 v10, s[16:19], s48 offen lds
ds_read_b64_tr_b16 v[168:169], v5 offset:0
ds_read_b64_tr_b16 v[170:171], v5 offset:1024
ds_read_b64_tr_b16 v[172:173], v5 offset:4096
ds_read_b64_tr_b16 v[174:175], v5 offset:5120
v_xor_b32 v12, v15, v8
ds_read_b64_tr_b16 v[24:25], v12 offset:8192
ds_read_b64_tr_b16 v[26:27], v12 offset:8704
ds_read_b64_tr_b16 v[28:29], v12 offset:10240
ds_read_b64_tr_b16 v[30:31], v12 offset:10752
ds_read_b64_tr_b16 v[176:177], v8 offset:16384
ds_read_b64_tr_b16 v[178:179], v8 offset:16896
ds_read_b64_tr_b16 v[180:181], v8 offset:18432
ds_read_b64_tr_b16 v[182:183], v8 offset:18944
ds_read_b64_tr_b16 v[184:185], v8 offset:24576
ds_read_b64_tr_b16 v[186:187], v8 offset:25088
ds_read_b64_tr_b16 v[188:189], v8 offset:26624
ds_read_b64_tr_b16 v[190:191], v8 offset:27136
s_waitcnt lgkmcnt(0)
buffer_store_dwordx4 v[24:27], v0, s[4:7], s61 offen offset:0
buffer_store_dwordx4 v[28:31], v0, s[4:7], s61 offen offset:1024
s_waitcnt vmcnt(26)
s_barrier
s_mov_b32 m0, 65536
s_add_u32 s48, s49, 1572992
buffer_load_dwordx4 v10, s[16:19], s48 offen lds
s_mov_b32 m0, 66560
s_add_u32 s48, s49, 1638528
buffer_load_dwordx4 v10, s[16:19], s48 offen lds
s_mov_b32 m0, 73728
s_add_u32 s48, s49, 2097280
buffer_load_dwordx4 v10, s[16:19], s48 offen lds
s_mov_b32 m0, 74752
s_add_u32 s48, s49, 2162816
buffer_load_dwordx4 v10, s[16:19], s48 offen lds
s_mov_b32 m0, 81920
s_add_u32 s48, s49, 2621568
buffer_load_dwordx4 v10, s[16:19], s48 offen lds
s_mov_b32 m0, 82944
s_add_u32 s48, s49, 2687104
buffer_load_dwordx4 v10, s[16:19], s48 offen lds
s_mov_b32 m0, 90112
s_add_u32 s48, s50, 768
buffer_load_dwordx4 v11, s[20:23], s48 offen lds
s_mov_b32 m0, 91136
s_add_u32 s48, s50, 5888
buffer_load_dwordx4 v11, s[20:23], s48 offen lds
ds_read_b64_tr_b16 v[192:193], v8 offset:32768
ds_read_b64_tr_b16 v[194:195], v8 offset:33280
ds_read_b64_tr_b16 v[196:197], v8 offset:34816
ds_read_b64_tr_b16 v[198:199], v8 offset:35328
v_xor_b32 v12, v15, v8
ds_read_b64_tr_b16 v[24:25], v12 offset:40960
ds_read_b64_tr_b16 v[26:27], v12 offset:41472
ds_read_b64_tr_b16 v[28:29], v12 offset:43008
ds_read_b64_tr_b16 v[30:31], v12 offset:43520
ds_read_b64_tr_b16 a[184:185], v8 offset:49152
ds_read_b64_tr_b16 a[186:187], v8 offset:49664
ds_read_b64_tr_b16 a[188:189], v8 offset:51200
ds_read_b64_tr_b16 a[190:191], v8 offset:51712
ds_read_b64_tr_b16 v[224:225], v8 offset:57344
ds_read_b64_tr_b16 v[226:227], v8 offset:57856
ds_read_b64_tr_b16 v[228:229], v8 offset:59392
ds_read_b64_tr_b16 v[230:231], v8 offset:59904
s_waitcnt lgkmcnt(0)
buffer_store_dwordx4 v[24:27], v0, s[4:7], s61 offen offset:2048
buffer_store_dwordx4 v[28:31], v0, s[4:7], s61 offen offset:3072
s_waitcnt vmcnt(28)
s_barrier
s_mov_b32 m0, 98304
s_add_u32 s48, s50, 21248
buffer_load_dwordx4 v11, s[20:23], s48 offen lds
s_mov_b32 m0, 99328
s_add_u32 s48, s50, 26368
buffer_load_dwordx4 v11, s[20:23], s48 offen lds
s_mov_b32 m0, 106496
s_add_u32 s48, s50, 41728
buffer_load_dwordx4 v11, s[20:23], s48 offen lds
s_mov_b32 m0, 107520
s_add_u32 s48, s50, 46848
buffer_load_dwordx4 v11, s[20:23], s48 offen lds
s_mov_b32 m0, 114688
s_add_u32 s48, s50, 62208
buffer_load_dwordx4 v11, s[20:23], s48 offen lds
s_mov_b32 m0, 115712
s_add_u32 s48, s50, 67328
buffer_load_dwordx4 v11, s[20:23], s48 offen lds
s_mov_b32 m0, 122880
s_add_u32 s48, s50, 1024
buffer_load_dwordx4 v11, s[20:23], s48 offen lds
s_mov_b32 m0, 123904
s_add_u32 s48, s50, 6144
buffer_load_dwordx4 v11, s[20:23], s48 offen lds
ds_read_b64_tr_b16 v[16:17], v9 offset:0
ds_read_b64_tr_b16 v[18:19], v9 offset:512
ds_read_b64_tr_b16 v[20:21], v9 offset:2048
ds_read_b64_tr_b16 v[22:23], v9 offset:2560
v_xor_b32 v12, v15, v9
ds_read_b64_tr_b16 v[200:201], v12 offset:8192
ds_read_b64_tr_b16 v[202:203], v12 offset:8704
ds_read_b64_tr_b16 v[204:205], v12 offset:10240
ds_read_b64_tr_b16 v[206:207], v12 offset:10752
ds_read_b64_tr_b16 v[32:33], v9 offset:16384
ds_read_b64_tr_b16 v[34:35], v9 offset:16896
ds_read_b64_tr_b16 v[36:37], v9 offset:18432
ds_read_b64_tr_b16 v[38:39], v9 offset:18944
ds_read_b64_tr_b16 v[208:209], v9 offset:24576
ds_read_b64_tr_b16 v[210:211], v9 offset:25088
ds_read_b64_tr_b16 v[212:213], v9 offset:26624
ds_read_b64_tr_b16 v[214:215], v9 offset:27136
s_waitcnt lgkmcnt(0)
buffer_store_dwordx4 v[16:19], v0, s[4:7], s62 offen offset:0
buffer_store_dwordx4 v[20:23], v0, s[4:7], s62 offen offset:1024
buffer_store_dwordx4 v[32:35], v0, s[4:7], s62 offen offset:2048
buffer_store_dwordx4 v[36:39], v0, s[4:7], s62 offen offset:3072
s_waitcnt vmcnt(38)
s_barrier
s_mov_b32 m0, 131072
s_add_u32 s48, s50, 21504
buffer_load_dwordx4 v11, s[20:23], s48 offen lds
s_mov_b32 m0, 132096
s_add_u32 s48, s50, 26624
buffer_load_dwordx4 v11, s[20:23], s48 offen lds
s_mov_b32 m0, 139264
s_add_u32 s48, s50, 41984
buffer_load_dwordx4 v11, s[20:23], s48 offen lds
s_mov_b32 m0, 140288
s_add_u32 s48, s50, 47104
buffer_load_dwordx4 v11, s[20:23], s48 offen lds
s_mov_b32 m0, 147456
s_add_u32 s48, s50, 62464
buffer_load_dwordx4 v11, s[20:23], s48 offen lds
s_mov_b32 m0, 148480
s_add_u32 s48, s50, 67584
buffer_load_dwordx4 v11, s[20:23], s48 offen lds
s_mov_b32 m0, 155648
s_add_u32 s48, s49, 3145728
buffer_load_dwordx4 v10, s[8:11], s48 offen lds
s_mov_b32 m0, 156672
s_add_u32 s48, s49, 3211264
buffer_load_dwordx4 v10, s[8:11], s48 offen lds
ds_read_b64_tr_b16 v[216:217], v7 offset:0
ds_read_b64_tr_b16 v[218:219], v7 offset:512
ds_read_b64_tr_b16 v[220:221], v7 offset:2048
ds_read_b64_tr_b16 v[222:223], v7 offset:2560
s_waitcnt lgkmcnt(0)
s_waitcnt vmcnt(32)
s_barrier
ds_read_b64_tr_b16 v[16:17], v4 offset:8192
ds_read_b64_tr_b16 v[18:19], v4 offset:9216
ds_read_b64_tr_b16 v[20:21], v4 offset:12288
ds_read_b64_tr_b16 v[22:23], v4 offset:13312
ds_read_b64_tr_b16 v[24:25], v4 offset:16384
ds_read_b64_tr_b16 v[26:27], v4 offset:17408
ds_read_b64_tr_b16 v[28:29], v4 offset:20480
ds_read_b64_tr_b16 v[30:31], v4 offset:21504
ds_read_b64_tr_b16 v[32:33], v4 offset:24576
ds_read_b64_tr_b16 v[34:35], v4 offset:25600
ds_read_b64_tr_b16 v[36:37], v4 offset:28672
ds_read_b64_tr_b16 v[38:39], v4 offset:29696
ds_read_b64_tr_b16 v[40:41], v4 offset:32768
ds_read_b64_tr_b16 v[42:43], v4 offset:33792
ds_read_b64_tr_b16 v[44:45], v4 offset:36864
ds_read_b64_tr_b16 v[46:47], v4 offset:37888
ds_read_b64_tr_b16 v[48:49], v4 offset:40960
ds_read_b64_tr_b16 v[50:51], v4 offset:41984
ds_read_b64_tr_b16 v[52:53], v4 offset:45056
ds_read_b64_tr_b16 v[54:55], v4 offset:46080
ds_read_b64_tr_b16 v[56:57], v4 offset:49152
ds_read_b64_tr_b16 v[58:59], v4 offset:50176
ds_read_b64_tr_b16 v[60:61], v4 offset:53248
ds_read_b64_tr_b16 v[62:63], v4 offset:54272
ds_read_b64_tr_b16 v[64:65], v4 offset:57344
ds_read_b64_tr_b16 v[66:67], v4 offset:58368
ds_read_b64_tr_b16 v[68:69], v4 offset:61440
ds_read_b64_tr_b16 v[70:71], v4 offset:62464
s_waitcnt lgkmcnt(0)
s_barrier
ds_write_b128 v0, v[16:19] offset:8192
ds_write_b128 v0, v[20:23] offset:9216
ds_write_b128 v0, v[24:27] offset:10240
ds_write_b128 v0, v[28:31] offset:11264
ds_write_b128 v0, v[32:35] offset:12288
ds_write_b128 v0, v[36:39] offset:13312
ds_write_b128 v0, v[40:43] offset:14336
ds_write_b128 v0, v[44:47] offset:15360
ds_write_b128 v0, v[48:51] offset:16384
ds_write_b128 v0, v[52:55] offset:17408
ds_write_b128 v0, v[56:59] offset:18432
ds_write_b128 v0, v[60:63] offset:19456
ds_write_b128 v0, v[64:67] offset:20480
ds_write_b128 v0, v[68:71] offset:21504
s_waitcnt lgkmcnt(0)
s_waitcnt vmcnt(6)
s_barrier
v_xor_b32 v12, v15, v8
ds_read_b64_tr_b16 v[16:17], v12 offset:24576
ds_read_b64_tr_b16 v[18:19], v12 offset:25088
ds_read_b64_tr_b16 v[20:21], v12 offset:26624
ds_read_b64_tr_b16 v[22:23], v12 offset:27136
ds_read_b64_tr_b16 v[24:25], v8 offset:32768
ds_read_b64_tr_b16 v[26:27], v8 offset:33280
ds_read_b64_tr_b16 v[28:29], v8 offset:34816
ds_read_b64_tr_b16 v[30:31], v8 offset:35328
ds_read_b64_tr_b16 v[32:33], v8 offset:40960
ds_read_b64_tr_b16 v[34:35], v8 offset:41472
ds_read_b64_tr_b16 v[36:37], v8 offset:43008
ds_read_b64_tr_b16 v[38:39], v8 offset:43520
ds_read_b64_tr_b16 v[40:41], v8 offset:49152
ds_read_b64_tr_b16 v[42:43], v8 offset:49664
ds_read_b64_tr_b16 v[44:45], v8 offset:51200
ds_read_b64_tr_b16 v[46:47], v8 offset:51712
v_xor_b32 v12, v15, v8
ds_read_b64_tr_b16 v[48:49], v12 offset:57344
ds_read_b64_tr_b16 v[50:51], v12 offset:57856
ds_read_b64_tr_b16 v[52:53], v12 offset:59392
ds_read_b64_tr_b16 v[54:55], v12 offset:59904
ds_read_b64_tr_b16 v[56:57], v9 offset:0
ds_read_b64_tr_b16 v[58:59], v9 offset:512
ds_read_b64_tr_b16 v[60:61], v9 offset:2048
ds_read_b64_tr_b16 v[62:63], v9 offset:2560
s_waitcnt lgkmcnt(0)
s_barrier
ds_write_b128 v2, v[224:227] offset:16384
ds_write_b128 v2, v[228:231] offset:17408
ds_write_b128 v2, v[24:27] offset:18432
ds_write_b128 v2, v[28:31] offset:19456
ds_write_b128 v2, v[32:35] offset:20480
ds_write_b128 v2, v[36:39] offset:21504
ds_write_b128 v2, v[232:235] offset:22528
ds_write_b128 v2, v[236:239] offset:23552
ds_write_b128 v2, v[240:243] offset:24576
ds_write_b128 v2, v[244:247] offset:25600
ds_write_b128 v2, v[56:59] offset:26624
ds_write_b128 v2, v[60:63] offset:27648
s_waitcnt lgkmcnt(0)
v_mov_b32 v224, v16
v_mov_b32 v225, v17
v_mov_b32 v226, v18
v_mov_b32 v227, v19
v_mov_b32 v228, v20
v_mov_b32 v229, v21
v_mov_b32 v230, v22
v_mov_b32 v231, v23
v_mov_b32 v232, v40
v_mov_b32 v233, v41
v_mov_b32 v234, v42
v_mov_b32 v235, v43
v_mov_b32 v236, v44
v_mov_b32 v237, v45
v_mov_b32 v238, v46
v_mov_b32 v239, v47
v_mov_b32 v240, v48
v_mov_b32 v241, v49
v_mov_b32 v242, v50
v_mov_b32 v243, v51
v_mov_b32 v244, v52
v_mov_b32 v245, v53
v_mov_b32 v246, v54
v_mov_b32 v247, v55
s_waitcnt vmcnt(0)
s_barrier
ds_read_b64_tr_b16 v[16:17], v5 offset:0
ds_read_b64_tr_b16 v[18:19], v5 offset:1024
ds_read_b64_tr_b16 v[20:21], v5 offset:4096
ds_read_b64_tr_b16 v[22:23], v5 offset:5120
ds_read_b64_tr_b16 v[24:25], v5 offset:8192
ds_read_b64_tr_b16 v[26:27], v5 offset:9216
ds_read_b64_tr_b16 v[28:29], v5 offset:12288
ds_read_b64_tr_b16 v[30:31], v5 offset:13312
ds_read_b64_tr_b16 v[32:33], v5 offset:16384
ds_read_b64_tr_b16 v[34:35], v5 offset:17408
ds_read_b64_tr_b16 v[36:37], v5 offset:20480
ds_read_b64_tr_b16 v[38:39], v5 offset:21504
ds_read_b64_tr_b16 v[40:41], v9 offset:8192
ds_read_b64_tr_b16 v[42:43], v9 offset:8704
ds_read_b64_tr_b16 v[44:45], v9 offset:10240
ds_read_b64_tr_b16 v[46:47], v9 offset:10752
ds_read_b64_tr_b16 v[48:49], v9 offset:16384
ds_read_b64_tr_b16 v[50:51], v9 offset:16896
ds_read_b64_tr_b16 v[52:53], v9 offset:18432
ds_read_b64_tr_b16 v[54:55], v9 offset:18944
ds_read_b64_tr_b16 v[56:57], v6 offset:24576
ds_read_b64_tr_b16 v[58:59], v6 offset:25600
ds_read_b64_tr_b16 v[60:61], v6 offset:28672
ds_read_b64_tr_b16 v[62:63], v6 offset:29696
s_waitcnt lgkmcnt(0)
s_barrier
ds_write_b128 v2, v[16:19] offset:40960
ds_write_b128 v2, v[20:23] offset:41984
ds_write_b128 v2, v[24:27] offset:43008
ds_write_b128 v2, v[28:31] offset:44032
ds_write_b128 v2, a[176:179] offset:45056
ds_write_b128 v2, a[180:183] offset:46080
ds_write_b128 v2, v[40:43] offset:47104
ds_write_b128 v2, v[44:47] offset:48128
ds_write_b128 v2, v[248:251] offset:49152
ds_write_b128 v2, v[252:255] offset:50176
ds_write_b128 v2, a[184:187] offset:51200
ds_write_b128 v2, a[188:191] offset:52224
s_waitcnt lgkmcnt(0)
v_accvgpr_write_b32 a176, v32
v_accvgpr_write_b32 a177, v33
v_accvgpr_write_b32 a178, v34
v_accvgpr_write_b32 a179, v35
v_accvgpr_write_b32 a180, v36
v_accvgpr_write_b32 a181, v37
v_accvgpr_write_b32 a182, v38
v_accvgpr_write_b32 a183, v39
v_mov_b32 v248, v48
v_mov_b32 v249, v49
v_mov_b32 v250, v50
v_mov_b32 v251, v51
v_mov_b32 v252, v52
v_mov_b32 v253, v53
v_mov_b32 v254, v54
v_mov_b32 v255, v55
v_accvgpr_write_b32 a184, v56
v_accvgpr_write_b32 a185, v57
v_accvgpr_write_b32 a186, v58
v_accvgpr_write_b32 a187, v59
v_accvgpr_write_b32 a188, v60
v_accvgpr_write_b32 a189, v61
v_accvgpr_write_b32 a190, v62
v_accvgpr_write_b32 a191, v63
s_mov_b32 s90, 0x300003
s_mov_b32 s91, 0x300003
s_mov_b32 s12, 0x3030303
s_mov_b32 s13, 0x3030303
s_mov_b32 s92, 0xc0000c
s_mov_b32 s93, 0xc0000c
s_mov_b32 s14, 0xc0c0c0c
s_mov_b32 s15, 0xc0c0c0c
s_mov_b32 s94, 0x30000300
s_mov_b32 s95, 0x30000300
s_mov_b32 s16, 0x30303030
s_mov_b32 s17, 0x30303030
s_mov_b32 s96, 0xc0000c00
s_mov_b32 s97, 0xc0000c00
s_mov_b32 s18, 0xc0c0c0c0
s_mov_b32 s19, 0xc0c0c0c0
s_mov_b32 s98, 0xff00ff00
s_mov_b32 s99, 0xff00ff00
v_mov_b32 v1, 0x4444
v_mov_b32 v4, 0xeeee
v_cndmask_b32 v1, v1, v4, s[98:99]
v_lshrrev_b32 v4, 8, v0
v_lshl_or_b32 v1, v4, 28, v1
v_bfe_u32 v4, v0, 4, 4
v_lshl_or_b32 v1, v4, 19, v1
s_mov_b32 s51, 0x3e0293ee
s_mov_b32 s52, 0x3f803f80
s_mov_b32 s53, 0x3f803f80
s_mov_b32 s54, 0x3f003f00
s_mov_b32 s55, 0x3f003f00
s_mov_b32 s56, 0xff800000
s_mov_b32 s57, 0xff800000
s_mov_b32 s58, 0x3f80
s_mov_b32 s8, s4
s_mov_b32 s9, s5
s_cmp_eq_u32 s30, 28
s_cselect_b32 s10, s6, 0
s_mov_b32 s31, 0
s_mov_b32 s45, -2
s_lshl_b32 s46, s30, 6
s_add_u32 s46, s46, 222330880
s_lshl_b32 s48, s30, 7
s_and_b32 s49, s30, 15
s_lshl_b32 s49, s49, 12
s_add_u32 s43, s49, 119537664
v_mov_b64 v[12:13], -1
s_add_u32 s38, s48, 119537664
s_add_u32 s39, s48, 119603200
s_add_u32 s40, s48, 119668736
s_add_u32 s41, s48, 119734272
s_add_u32 s42, s48, 119799808
v_lshrrev_b32 v4, 16, v1
buffer_store_dwordx2 v[12:13], v4, s[4:7], s38 offen
buffer_store_dwordx2 v[12:13], v4, s[4:7], s39 offen
buffer_store_dwordx2 v[12:13], v4, s[4:7], s40 offen
buffer_store_dwordx2 v[12:13], v4, s[4:7], s41 offen
buffer_store_dwordx2 v[12:13], v4, s[4:7], s42 offen
s_cmp_lg_u32 s3, 0
s_cbranch_scc1 k_wdd_113
v_mov_b32 v8, 192
k_wd_112:
global_load_dword v9, v8, s[28:29] sc1
s_waitcnt vmcnt(0)
v_readfirstlane_b32 s48, v9
s_cmp_ge_u32 s48, 32
s_cbranch_scc1 k_wdd_113
s_sleep 2
s_sub_u32 s32, s32, 1
s_cmp_gt_i32 s32, 0
s_cbranch_scc1 k_wd_112
k_wdd_113:
s_barrier
k_lay_114:
s_add_u32 s47, s31, 63
s_mov_b32 s33, 120324096
s_mov_b32 s34, 120326144
s_mov_b32 s35, 120330240
s_mul_i32 s48, s31, 655360
s_lshl_b32 s36, s30, 14
s_add_u32 s36, s36, s48
s_add_u32 s36, s36, 0
v_mov_b32 v12, -1
s_and_b32 s48, s30, 15
s_add_u32 s48, s48, 0
s_lshr_b32 s49, s48, 1
s_and_b32 s48, s48, 1
s_lshl_b32 s44, s49, 8
s_lshl_b32 s50, s48, 6
s_add_u32 s44, s44, s50
s_add_u32 s44, s44, s33
s_mul_i32 s48, s48, 5120
s_lshl_b32 s49, s49, 5
s_add_u32 s48, s48, s49
v_lshrrev_b32 v8, 4, v0
v_and_b32 v9, 3, v8
v_mul_u32_u24 v9, 1280, v9
v_bfe_u32 v10, v8, 2, 1
v_lshl_add_u32 v9, v10, 1, v9
v_bfe_u32 v10, v8, 4, 1
v_lshl_add_u32 v9, v10, 4, v9
v_bfe_u32 v10, v8, 5, 1
v_lshl_add_u32 v9, v10, 2, v9
buffer_load_ushort v10, v9, s[24:27], s48 offen
buffer_load_ushort v11, v9, s[24:27], s48 offen offset:8
v_and_b32 v45, 0x30, v0
v_lshrrev_b32 v46, 8, v0
v_lshl_or_b32 v45, v46, 2, v45
v_bfe_u32 v46, v0, 6, 1
v_lshl_or_b32 v45, v46, 7, v45
v_cndmask_b32 v45, v45, 2.0, s[98:99]
s_waitcnt vmcnt(0)
v_lshl_or_b32 v10, v11, 16, v10
s_lshl_b32 s63, s30, 10
s_add_u32 s63, s63, 120356864
s_lshl_b32 s37, s31, 14
s_add_u32 s37, s37, 117440512
s_add_u32 s59, s37, 4096
s_waitcnt vmcnt(0)
s_barrier
s_mov_b64 exec, 1
v_mov_b32 v8, 160
v_mov_b32 v9, 1
global_atomic_add v8, v9, s[28:29] sc1
s_add_u32 s49, s31, 32
k_tb_115:
global_load_dword v9, v8, s[28:29] sc1
s_waitcnt vmcnt(0)
v_readfirstlane_b32 s48, v9
s_cmp_ge_u32 s48, s49
s_cbranch_scc1 k_tbd_116
s_sub_u32 s32, s32, 1
s_cmp_gt_i32 s32, 0
s_cbranch_scc1 k_tb_115
k_tbd_116:
s_mov_b64 exec, -1
s_barrier
buffer_store_dword v10, v45, s[4:7], s44 offen
s_add_u32 s44, s44, 16384
buffer_store_dword v12, v45, s[4:7], s44 offen
s_waitcnt vmcnt(0)
s_barrier
s_mov_b64 exec, 1
v_mov_b32 v8, 160
v_mov_b32 v9, 1
global_atomic_add v8, v9, s[28:29] sc1
s_add_u32 s49, s31, 64
k_tb_117:
global_load_dword v9, v8, s[28:29] sc1
s_waitcnt vmcnt(0)
v_readfirstlane_b32 s48, v9
s_cmp_ge_u32 s48, s49
s_cbranch_scc1 k_tbd_118
s_sub_u32 s32, s32, 1
s_cmp_gt_i32 s32, 0
s_cbranch_scc1 k_tb_117
k_tbd_118:
s_mov_b64 exec, -1
s_barrier
v_lshlrev_b32 v23, v0, s58
v_cndmask_b32 v20, 0, v23, s[90:91]
v_cndmask_b32 v21, 0, v23, s[92:93]
v_cndmask_b32 v22, 0, v23, s[94:95]
v_cndmask_b32 v23, 0, v23, s[96:97]
s_branch k_cold2_121
k_T0_119:
s_waitcnt vmcnt(2)
v_smfmac_f32_16x16x64_bf16 v[40:43], v[4:7], v[48:55], v1
s_waitcnt vmcnt(1)
v_cmp_u_f32 vcc, v4, v8
v_smfmac_f32_16x16x64_bf16 v[24:27], v[8:11], a[24:31], v1
v_smfmac_f32_16x16x64_bf16 v[28:31], v[8:11], a[32:39], v1
s_cbranch_vccnz k_cold_120
k_okC_122:
s_waitcnt vmcnt(1)
v_smfmac_f32_16x16x64_bf16 v[36:39], v[8:11], a[40:47], v1
s_waitcnt lgkmcnt(0)
ds_read_b128 v[48:51], v2 offset:45056
v_smfmac_f32_16x16x64_bf16 v[32:35], v[4:7], v[64:71], v1
ds_read_b128 v[52:55], v2 offset:46080
ds_read_b128 v[64:67], v0 offset:10240
v_smfmac_f32_16x16x64_bf16 v[44:47], v[4:7], v[56:63], v1
ds_read_b128 v[68:71], v0 offset:11264
v_smfmac_f32_16x16x64_bf16 v[28:31], v[4:7], a[8:15], v1
v_smfmac_f32_16x16x64_bf16 v[24:27], v[4:7], a[0:7], v1
ds_read_b128 v[56:59], v2 offset:22528
v_smfmac_f32_16x16x64_bf16 v[36:39], v[4:7], a[16:23], v1
ds_read_b128 v[60:63], v2 offset:23552
s_waitcnt lgkmcnt(4)
v_smfmac_f32_16x16x64_bf16 v[40:43], v[8:11], v[48:55], v1
s_waitcnt vmcnt(0)
ds_write_b128 v0, v[12:15] offset:0
s_waitcnt lgkmcnt(3)
v_smfmac_f32_16x16x64_bf16 v[32:35], v[8:11], v[64:71], v1
buffer_load_dwordx4 v[16:19], v0, s[4:7], s35 offen offset:0 sc1
v_cmp_u_f32 vcc, v12, v12
s_waitcnt lgkmcnt(1)
v_smfmac_f32_16x16x64_bf16 v[44:47], v[8:11], v[56:63], v1
ds_read_b128 v[56:59], v0 offset:20480
ds_read_b128 v[60:63], v0 offset:21504
ds_read_b128 v[64:67], v0 offset:12288
s_cbranch_vccnz k_coldA_123
k_okA_124:
v_smfmac_f32_16x16x64_bf16 v[36:39], v[12:15], a[64:71], v1
ds_read_b128 v[68:71], v0 offset:13312
s_waitcnt lgkmcnt(4)
v_smfmac_f32_16x16x64_bf16 v[40:43], v[12:15], a[72:79], v1
s_barrier
v_smfmac_f32_16x16x64_bf16 v[28:31], v[12:15], a[56:63], v1
ds_read_b128 v[8:11], v0 offset:1024
buffer_load_dwordx4 v[48:51], v0, s[4:7], s36 offen offset:0 sc1
s_waitcnt lgkmcnt(3)
v_smfmac_f32_16x16x64_bf16 v[44:47], v[12:15], v[56:63], v1
ds_read_b128 v[56:59], v2 offset:40960
v_smfmac_f32_16x16x64_bf16 v[24:27], v[12:15], a[48:55], v1
ds_read_b128 v[60:63], v2 offset:41984
s_waitcnt lgkmcnt(3)
v_smfmac_f32_16x16x64_bf16 v[32:35], v[12:15], v[64:71], v1
buffer_load_dwordx4 v[52:55], v0, s[4:7], s36 offen offset:1024 sc1
s_waitcnt lgkmcnt(2)
v_smfmac_f32_16x16x64_bf16 v[24:27], v[8:11], a[80:87], v1
ds_read_b128 v[64:67], v0 offset:14336
ds_read_b128 v[68:71], v0 offset:15360
v_smfmac_f32_16x16x64_bf16 v[36:39], v[8:11], a[96:103], v1
buffer_store_dwordx4 v[4:7], v0, s[8:11], s37 offen offset:0 sc1
s_waitcnt lgkmcnt(2)
s_nop 0
ds_read_b128 v[4:7], v0 offset:2048
v_smfmac_f32_16x16x64_bf16 v[44:47], v[8:11], v[56:63], v1
ds_read_b128 v[56:59], v2 offset:43008
ds_read_b128 v[60:63], v2 offset:44032
v_smfmac_f32_16x16x64_bf16 v[28:31], v[8:11], a[88:95], v1
buffer_store_dwordx4 v[12:15], v0, s[8:11], s37 offen offset:2048 sc1
v_smfmac_f32_16x16x64_bf16 v[40:43], v[8:11], a[104:111], v1
s_waitcnt lgkmcnt(3)
s_waitcnt lgkmcnt(2)
v_smfmac_f32_16x16x64_bf16 v[32:35], v[8:11], v[64:71], v1
ds_read_b128 v[64:67], v0 offset:16384
ds_read_b128 v[12:15], v0 offset:3072
v_smfmac_f32_16x16x64_bf16 v[36:39], v[4:7], a[128:135], v1
s_waitcnt lgkmcnt(2)
v_smfmac_f32_16x16x64_bf16 v[44:47], v[4:7], v[56:63], v1
ds_read_b128 v[68:71], v0 offset:17408
buffer_load_dwordx4 v[56:59], v0, s[4:7], s36 offen offset:2048 sc1
v_smfmac_f32_16x16x64_bf16 v[28:31], v[4:7], a[120:127], v1
v_smfmac_f32_16x16x64_bf16 v[24:27], v[4:7], a[112:119], v1
s_waitcnt vmcnt(5)
ds_write_b128 v0, v[16:19] offset:4096
v_smfmac_f32_16x16x64_bf16 v[40:43], v[4:7], a[136:143], v1
s_waitcnt lgkmcnt(1)
buffer_load_dwordx4 v[60:63], v0, s[4:7], s36 offen offset:3072 sc1
v_cmp_u_f32 vcc, v16, v16
v_smfmac_f32_16x16x64_bf16 v[32:35], v[4:7], v[64:71], v1
ds_read_b128 v[64:67], v0 offset:18432
ds_read_b128 v[68:71], v0 offset:19456
v_smfmac_f32_16x16x64_bf16 v[28:31], v[12:15], a[152:159], v1
v_smfmac_f32_16x16x64_bf16 v[24:27], v[12:15], a[144:151], v1
s_cbranch_vccnz k_coldB_125
k_okB_126:
v_smfmac_f32_16x16x64_bf16 v[36:39], v[12:15], a[160:167], v1
s_waitcnt lgkmcnt(2)
buffer_store_dwordx4 v[16:19], v0, s[8:11], s59 offen offset:2048 sc1
s_barrier
ds_read_b128 v[4:7], v0 offset:6144
v_smfmac_f32_16x16x64_bf16 v[44:47], v[12:15], a[176:183], v1
ds_read_b128 v[8:11], v0 offset:5120
s_waitcnt lgkmcnt(2)
v_smfmac_f32_16x16x64_bf16 v[32:35], v[12:15], v[64:71], v1
ds_read_b128 v[64:67], v2 offset:24576
ds_read_b128 v[68:71], v2 offset:25600
v_smfmac_f32_16x16x64_bf16 v[24:27], v[16:19], a[184:191], v1
v_smfmac_f32_16x16x64_bf16 v[40:43], v[12:15], a[168:175], v1
s_waitcnt lgkmcnt(3)
ds_read_b128 v[12:15], v0 offset:7168
v_smfmac_f32_16x16x64_bf16 v[24:27], v[4:7], a[208:215], v1
s_waitcnt lgkmcnt(3)
v_smfmac_f32_16x16x64_bf16 v[28:31], v[4:7], a[216:223], v1
v_smfmac_f32_16x16x64_bf16 v[28:31], v[8:11], a[200:207], v1
s_waitcnt lgkmcnt(1)
v_smfmac_f32_16x16x64_bf16 v[24:27], v[8:11], v[64:71], v1
ds_read_b128 v[64:67], v2 offset:49152
s_waitcnt lgkmcnt(1)
v_smfmac_f32_16x16x64_bf16 v[24:27], v[12:15], a[224:231], v1
ds_read_b128 v[68:71], v2 offset:50176
v_smfmac_f32_16x16x64_bf16 v[28:31], v[12:15], a[232:239], v1
v_smfmac_f32_16x16x64_bf16 v[28:31], v[16:19], a[192:199], v1
v_cvt_pk_bf16_f32 v24, v24, v25
v_cvt_pk_bf16_f32 v25, v26, v27
v_smfmac_f32_16x16x64_bf16 v[32:35], v[4:7], v[80:87], v1
v_cvt_pk_bf16_f32 v26, v28, v29
v_cvt_pk_bf16_f32 v27, v30, v31
v_smfmac_f32_16x16x64_bf16 v[32:35], v[8:11], a[248:255], v1
s_waitcnt lgkmcnt(0)
v_mfma_f32_16x16x32_bf16 v[28:31], v[24:27], v[20:23], 0
v_and_b32 v26, 0xffffff7f, v0
v_smfmac_f32_16x16x64_bf16 v[32:35], v[16:19], v[64:71], v1
v_and_or_b32 v26, v1, 8, v26
v_mul_f32 v28, s51, v28
v_mul_f32 v29, s51, v29
v_mul_f32 v31, s51, v31
v_cvt_pk_bf16_f32 v24, v28, v29
v_mul_f32 v30, s51, v30
v_cvt_pk_bf16_f32 v25, v30, v31
v_smfmac_f32_16x16x64_bf16 v[32:35], v[12:15], v[96:103], v1
ds_write_b64 v26, v[24:25] offset:0
v_smfmac_f32_16x16x64_bf16 v[36:39], v[8:11], v[72:79], v1
v_cvt_pk_bf16_f32 v32, v32, v33
v_smfmac_f32_16x16x64_bf16 v[36:39], v[16:19], a[240:247], v1
buffer_load_dwordx4 v[64:67], v0, s[4:7], s61 offen offset:0
v_cvt_pk_bf16_f32 v33, v34, v35
v_smfmac_f32_16x16x64_bf16 v[36:39], v[12:15], v[104:111], v1
s_waitcnt lgkmcnt(0)
v_smfmac_f32_16x16x64_bf16 v[36:39], v[4:7], v[88:95], v1
s_barrier
ds_read_b128 v[24:27], v0 offset:0
v_smfmac_f32_16x16x64_bf16 v[40:43], v[4:7], v[144:151], v1
ds_read_b128 v[28:31], v0 offset:1024
s_nop 0
v_cvt_pk_bf16_f32 v34, v36, v37
v_cvt_pk_bf16_f32 v35, v38, v39
s_nop 1
v_mfma_f32_16x16x32_bf16 v[36:39], v[32:35], v[20:23], 0
s_waitcnt vmcnt(6)
buffer_load_dwordx4 v[68:71], v0, s[4:7], s61 offen offset:1024
v_and_b32 v34, 0xffffff7f, v0
v_and_or_b32 v34, v1, 8, v34
s_waitcnt lgkmcnt(1)
v_mfma_f32_16x16x32_bf16 v[48:51], v[48:51], v[24:27], 0
v_cvt_pk_bf16_f32 v32, v36, v37
s_waitcnt lgkmcnt(0)
v_mfma_f32_16x16x32_bf16 v[48:51], v[52:55], v[28:31], v[48:51]
v_mov_b64 v[52:53], s[56:57]
v_cvt_pk_bf16_f32 v33, v38, v39
v_smfmac_f32_16x16x64_bf16 v[44:47], v[4:7], v[152:159], v1
ds_write_b64 v34, v[32:33] offset:2048
v_permlane32_swap_b32 v48, v50
v_permlane32_swap_b32 v49, v51
v_add_f32_dpp v52, v50, v48 row_ror:8 row_mask:0xf bank_mask:0x3
v_exp_f32 v52, v52
v_add_f32_dpp v53, v51, v49 row_ror:8 row_mask:0xf bank_mask:0x3
v_exp_f32 v53, v53
s_nop 0
v_cvt_pk_bf16_f32 v48, v52, v53
v_smfmac_f32_16x16x64_bf16 v[44:47], v[16:19], v[120:127], v1
ds_write_b32 v0, v48 offset:4096
v_smfmac_f32_16x16x64_bf16 v[44:47], v[12:15], v[168:175], v1
buffer_load_dwordx4 v[48:51], v0, s[4:7], s61 offen offset:2048
v_smfmac_f32_16x16x64_bf16 v[40:43], v[12:15], v[160:167], v1
s_waitcnt lgkmcnt(1)
v_xor_b32 v12, 0x80, v0
v_smfmac_f32_16x16x64_bf16 v[40:43], v[8:11], v[128:135], v1
s_waitcnt lgkmcnt(0)
s_barrier
ds_read_b128 v[32:35], v0 offset:2048
v_mov_b64 v[22:23], s[52:53]
v_smfmac_f32_16x16x64_bf16 v[40:43], v[16:19], v[112:119], v1
ds_read_b128 v[36:39], v0 offset:3072
ds_read_b128 v[16:19], v0 offset:4096
buffer_load_dwordx4 v[52:55], v0, s[4:7], s61 offen offset:3072
v_smfmac_f32_16x16x64_bf16 v[44:47], v[8:11], v[136:143], v1
ds_read_b128 v[12:15], v12 offset:4096
v_cvt_pk_bf16_f32 v40, v40, v41
v_mov_b64 v[20:21], s[52:53]
s_waitcnt lgkmcnt(3)
v_mfma_f32_16x16x32_bf16 v[24:27], v[32:35], v[24:27], 0
v_cvt_pk_bf16_f32 v41, v42, v43
s_waitcnt lgkmcnt(2)
v_mfma_f32_16x16x32_bf16 v[24:27], v[36:39], v[28:31], v[24:27]
s_waitcnt vmcnt(5)
s_waitcnt lgkmcnt(1)
v_mfma_f32_16x16x32_bf16 v[8:11], v[56:59], v[16:19], 0
buffer_load_dwordx4 v[56:59], v0, s[4:7], s62 offen offset:0
v_mov_b64 v[28:29], s[56:57]
v_cvt_pk_bf16_f32 v43, v46, v47
v_cvt_pk_bf16_f32 v42, v44, v45
v_permlane32_swap_b32 v25, v27
v_permlane32_swap_b32 v24, v26
v_mfma_f32_16x16x32_bf16 v[4:7], v[20:23], v[16:19], 0
s_waitcnt lgkmcnt(0)
v_add_f32_dpp v28, v26, v24 row_ror:8 row_mask:0xf bank_mask:0x3
v_add_f32_dpp v29, v27, v25 row_ror:8 row_mask:0xf bank_mask:0x3
v_exp_f32 v28, v28
v_mfma_f32_16x16x32_bf16 v[8:11], v[60:63], v[12:15], v[8:11]
buffer_load_dwordx4 v[60:63], v0, s[4:7], s62 offen offset:1024
v_exp_f32 v29, v29
v_permlane32_swap_b32 v42, v43
v_cvt_pk_bf16_f32 v24, v28, v29
v_mov_b64 v[44:45], s[54:55]
v_cvt_pk_bf16_f32 v25, v28, v29
v_mov_b32_dpp v26, v24 row_ror:8 row_mask:0xf bank_mask:0xf
v_mov_b32_dpp v27, v24 row_ror:8 row_mask:0xf bank_mask:0xf
v_mfma_f32_16x16x16_bf16 v[4:7], v[44:45], v[24:25], v[4:7]
v_permlane32_swap_b32 v40, v41
v_mov_b64 v[36:37], 0
v_mov_b64 v[38:39], 0
v_mov_b64 v[30:31], 0
v_mfma_f32_16x16x32_bf16 v[8:11], v[40:43], v[24:27], v[8:11]
buffer_load_dwordx4 v[16:19], v0, s[4:7], s62 offen offset:2048
v_rcp_f32 v6, v4
v_and_b32 v12, 0xffffff7f, v0
v_and_or_b32 v13, v1, 8, v12
v_rcp_f32_dpp v6, v4 row_ror:8 row_mask:0xf bank_mask:0xc
v_mov_b64 v[26:27], 0
v_pk_mul_f32 v[8:9], v[8:9], v[6:7] op_sel_hi:[1,0]
v_cvt_pk_bf16_f32 v44, v8, v9
v_pk_mul_f32 v[10:11], v[10:11], v[6:7] op_sel_hi:[1,0]
v_cvt_pk_bf16_f32 v45, v10, v11
s_waitcnt vmcnt(5)
ds_write_b64 v13, v[44:45] offset:6144
buffer_load_dwordx4 v[20:23], v0, s[4:7], s62 offen offset:3072
v_add_u32 v6, 0xd4800000, v6
v_cmp_lt_u32 vcc, 0x28000000, v6
v_mov_b64 v[34:35], 0
v_mov_b32_dpp v46, v44 row_ror:8 row_mask:0xf bank_mask:0xf
v_mov_b32_dpp v47, v45 row_ror:8 row_mask:0xf bank_mask:0xf
v_mov_b64 v[28:29], 0
v_mov_b64 v[32:33], 0
s_cbranch_vccnz k_slow_127
k_okS_128:
v_smfmac_f32_16x16x64_bf16 v[36:39], v[44:47], v[224:231], v1
s_waitcnt lgkmcnt(0)
s_barrier
ds_read_b128 v[8:11], v12 offset:7168
v_smfmac_f32_16x16x64_bf16 v[32:35], v[44:47], v[200:207], v1
s_waitcnt vmcnt(4)
ds_read_b128 v[4:7], v12 offset:6272
v_mov_b64 v[24:25], 0
v_smfmac_f32_16x16x64_bf16 v[28:31], v[44:47], v[48:55], v1
ds_read_b128 v[12:15], v12 offset:7296
ds_read_b128 v[48:51], v2 offset:16384
v_smfmac_f32_16x16x64_bf16 v[24:27], v[44:47], v[64:71], v1
ds_read_b128 v[52:55], v2 offset:17408
v_mov_b64 v[42:43], 0
s_waitcnt lgkmcnt(4)
v_smfmac_f32_16x16x64_bf16 v[24:27], v[8:11], v[184:191], v1
s_waitcnt lgkmcnt(3)
v_mov_b64 v[40:41], 0
v_smfmac_f32_16x16x64_bf16 v[24:27], v[4:7], v[176:183], v1
s_waitcnt lgkmcnt(2)
ds_read_b128 v[64:67], v2 offset:51200
v_smfmac_f32_16x16x64_bf16 v[24:27], v[12:15], v[192:199], v1
ds_read_b128 v[68:71], v2 offset:52224
v_smfmac_f32_16x16x64_bf16 v[40:43], v[44:47], v[240:247], v1
s_waitcnt vmcnt(2)
s_waitcnt lgkmcnt(2)
v_lshrrev_b32 v44, 16, v1
v_cvt_pk_bf16_f32 v24, v24, v25
v_bfi_b32 v24, 1, s45, v24
v_cvt_pk_bf16_f32 v25, v26, v27
v_smfmac_f32_16x16x64_bf16 v[28:31], v[8:11], v[48:55], v1
buffer_store_dwordx2 v[24:25], v44, s[4:7], s38 offen
ds_read_b128 v[48:51], v2 offset:20480
ds_read_b128 v[52:55], v2 offset:21504
v_smfmac_f32_16x16x64_bf16 v[28:31], v[12:15], v[56:63], v1
s_waitcnt lgkmcnt(2)
ds_read_b128 v[56:59], v2 offset:26624
v_smfmac_f32_16x16x64_bf16 v[28:31], v[4:7], v[64:71], v1
ds_read_b128 v[60:63], v2 offset:27648
v_smfmac_f32_16x16x64_bf16 v[32:35], v[8:11], v[208:215], v1
ds_read_b128 v[64:67], v2 offset:18432
s_nop 0
v_cvt_pk_bf16_f32 v28, v28, v29
v_bfi_b32 v28, 1, s45, v28
v_cvt_pk_bf16_f32 v29, v30, v31
v_smfmac_f32_16x16x64_bf16 v[32:35], v[12:15], v[216:223], v1
buffer_store_dwordx2 v[28:29], v44, s[4:7], s39 offen
v_smfmac_f32_16x16x64_bf16 v[40:43], v[12:15], v[248:255], v1
ds_read_b128 v[68:71], v2 offset:19456
s_waitcnt vmcnt(2)
v_smfmac_f32_16x16x64_bf16 v[32:35], v[4:7], v[16:23], v1
s_waitcnt lgkmcnt(2)
v_smfmac_f32_16x16x64_bf16 v[36:39], v[12:15], v[232:239], v1
ds_read_b128 v[16:19], v2 offset:47104
ds_read_b128 v[20:23], v2 offset:48128
v_cvt_pk_bf16_f32 v32, v32, v33
v_bfi_b32 v32, 1, s45, v32
v_cvt_pk_bf16_f32 v33, v34, v35
v_smfmac_f32_16x16x64_bf16 v[36:39], v[8:11], v[48:55], v1
buffer_store_dwordx2 v[32:33], v44, s[4:7], s40 offen
s_waitcnt lgkmcnt(2)
v_smfmac_f32_16x16x64_bf16 v[36:39], v[4:7], v[64:71], v1
s_nop 6
v_cvt_pk_bf16_f32 v36, v36, v37
v_cvt_pk_bf16_f32 v37, v38, v39
s_waitcnt lgkmcnt(0)
v_bfi_b32 v36, 1, s45, v36
v_smfmac_f32_16x16x64_bf16 v[40:43], v[8:11], v[16:23], v1
buffer_store_dwordx2 v[36:37], v44, s[4:7], s41 offen
v_smfmac_f32_16x16x64_bf16 v[40:43], v[4:7], v[56:63], v1
s_nop 6
v_cvt_pk_bf16_f32 v40, v40, v41
v_bfi_b32 v40, 1, s45, v40
v_cvt_pk_bf16_f32 v41, v42, v43
buffer_store_dwordx2 v[40:41], v44, s[4:7], s42 offen
s_barrier
buffer_load_dwordx4 v[24:27], v0, s[4:7], s43 offen offset:0 sc1
buffer_load_dwordx4 v[28:31], v0, s[4:7], s43 offen offset:1024 sc1
buffer_load_dwordx4 v[32:35], v0, s[4:7], s43 offen offset:2048 sc1
buffer_load_dwordx4 v[36:39], v0, s[4:7], s43 offen offset:3072 sc1
v_lshlrev_b32 v23, v0, s58
v_cndmask_b32 v16, 0, v23, s[12:13]
v_cndmask_b32 v17, 0, v23, s[14:15]
v_cndmask_b32 v18, 0, v23, s[16:17]
v_cndmask_b32 v19, 0, v23, s[18:19]
v_and_b32 v45, 0x30, v0
v_lshrrev_b32 v46, 8, v0
v_lshl_or_b32 v45, v46, 2, v45
v_bfe_u32 v46, v0, 6, 1
v_lshl_or_b32 v45, v46, 7, v45
v_cndmask_b32 v45, v45, 2.0, s[98:99]
v_cndmask_b32 v20, 0, v23, s[90:91]
v_cndmask_b32 v21, 0, v23, s[92:93]
v_cndmask_b32 v22, 0, v23, s[94:95]
v_cndmask_b32 v23, 0, v23, s[96:97]
s_add_u32 s33, s33, 16384
s_bitset0_b32 s33, 16
s_waitcnt vmcnt(3)
v_mfma_f32_16x16x32_bf16 v[40:43], v[24:27], v[16:19], 0
s_waitcnt vmcnt(2)
v_mfma_f32_16x16x32_bf16 v[40:43], v[28:31], v[16:19], v[40:43]
v_bitop3_b32 v46, v24, v28, s45 bitop3:0x7e
s_waitcnt vmcnt(1)
v_mfma_f32_16x16x32_bf16 v[40:43], v[32:35], v[16:19], v[40:43]
s_waitcnt vmcnt(0)
v_mfma_f32_16x16x32_bf16 v[40:43], v[36:39], v[16:19], v[40:43]
v_bitop3_b32 v47, v32, v36, s45 bitop3:0x7e
v_bitop3_b32 v46, v46, v47, 1 bitop3:0xa8
v_cmp_ne_u32 vcc, 0, v46
v_mov_b64 v[24:25], 0
v_mov_b64 v[26:27], 0
v_mov_b64 v[28:29], 0
v_mov_b64 v[30:31], 0
v_permlane32_swap_b32 v40, v41
v_permlane32_swap_b32 v42, v43
v_add_f32 v40, v40, v41
v_add_f32 v41, v42, v43
v_cvt_pk_bf16_f32 v42, v40, v41
s_cbranch_vccnz k_r1_130
k_ok1_131:
buffer_store_dword v42, v45, s[4:7], s44 offen
buffer_load_dwordx4 v[48:51], v0, s[4:7], s60 offen offset:0
buffer_load_dwordx4 v[52:55], v0, s[4:7], s60 offen offset:1024
buffer_load_dwordx4 v[56:59], v0, s[4:7], s60 offen offset:2048
buffer_load_dwordx4 v[60:63], v0, s[4:7], s60 offen offset:3072
s_barrier
buffer_load_dwordx4 v[4:7], v0, s[4:7], s33 offen offset:0 sc1
buffer_load_dwordx4 v[8:11], v0, s[4:7], s33 offen offset:1024 sc1
s_add_u32 s34, s33, 2048
s_add_u32 s35, s33, 6144
s_add_u32 s36, s36, 524288
s_add_u32 s37, s37, 10240
s_add_u32 s59, s59, 10240
v_mov_b64 v[32:33], 0
v_mov_b64 v[34:35], 0
v_mov_b64 v[36:37], 0
v_mov_b64 v[38:39], 0
v_mov_b64 v[40:41], 0
v_mov_b64 v[42:43], 0
v_mov_b64 v[44:45], 0
v_mov_b64 v[46:47], 0
s_add_u32 s44, s44, 16384
s_bitset0_b32 s44, 16
s_sub_u32 s45, s45, 1
s_add_u32 s31, s31, 1
ds_read_b128 v[64:67], v0 offset:8192
ds_read_b128 v[68:71], v0 offset:9216
buffer_load_dwordx4 v[12:15], v0, s[4:7], s34 offen offset:0 sc1
s_cmp_lg_u32 s31, s47
s_cbranch_scc1 k_T0_119
s_branch k_done_129
k_cold2_121:
s_barrier
buffer_load_dwordx4 v[48:51], v0, s[4:7], s60 offen offset:0
buffer_load_dwordx4 v[52:55], v0, s[4:7], s60 offen offset:1024
buffer_load_dwordx4 v[56:59], v0, s[4:7], s60 offen offset:2048
buffer_load_dwordx4 v[60:63], v0, s[4:7], s60 offen offset:3072
ds_read_b128 v[64:67], v0 offset:8192
ds_read_b128 v[68:71], v0 offset:9216
k_cold_120:
buffer_load_dwordx4 v[4:7], v0, s[4:7], s33 offen offset:0 sc1
buffer_load_dwordx4 v[8:11], v0, s[4:7], s33 offen offset:1024 sc1
buffer_load_dwordx4 v[12:15], v0, s[4:7], s34 offen offset:0 sc1
s_sub_u32 s32, s32, 1
s_cmp_gt_i32 s32, 0
s_cbranch_scc0 k_okC_122
v_mov_b64 v[24:25], 0
v_mov_b64 v[26:27], 0
v_mov_b64 v[28:29], 0
v_mov_b64 v[30:31], 0
v_mov_b64 v[32:33], 0
v_mov_b64 v[34:35], 0
v_mov_b64 v[36:37], 0
v_mov_b64 v[38:39], 0
v_mov_b64 v[40:41], 0
v_mov_b64 v[42:43], 0
v_mov_b64 v[44:45], 0
v_mov_b64 v[46:47], 0
s_branch k_T0_119
k_coldA_123:
buffer_load_dwordx4 v[12:15], v0, s[4:7], s34 offen offset:0 sc1
s_sub_u32 s32, s32, 1
s_cmp_gt_i32 s32, 0
s_waitcnt vmcnt(0)
v_cmp_u_f32 vcc, v12, v12
ds_write_b128 v0, v[12:15] offset:0
s_waitcnt lgkmcnt(0)
s_cbranch_vccz k_okA_124
s_cbranch_scc1 k_coldA_123
s_branch k_okA_124
k_coldB_125:
buffer_load_dwordx4 v[16:19], v0, s[4:7], s35 offen offset:0 sc1
s_sub_u32 s32, s32, 1
s_cmp_gt_i32 s32, 0
s_waitcnt vmcnt(0)
v_cmp_u_f32 vcc, v16, v16
ds_write_b128 v0, v[16:19] offset:4096
s_waitcnt lgkmcnt(0)
s_cbranch_vccz k_okB_126
s_cbranch_scc1 k_coldB_125
s_branch k_okB_126
k_r1_130:
buffer_load_dwordx4 v[24:27], v0, s[4:7], s43 offen offset:0 sc1
buffer_load_dwordx4 v[28:31], v0, s[4:7], s43 offen offset:1024 sc1
buffer_load_dwordx4 v[32:35], v0, s[4:7], s43 offen offset:2048 sc1
buffer_load_dwordx4 v[36:39], v0, s[4:7], s43 offen offset:3072 sc1
s_sub_u32 s32, s32, 1
s_cmp_gt_i32 s32, 0
s_waitcnt vmcnt(3)
v_mfma_f32_16x16x32_bf16 v[40:43], v[24:27], v[16:19], 0
s_waitcnt vmcnt(2)
v_mfma_f32_16x16x32_bf16 v[40:43], v[28:31], v[16:19], v[40:43]
v_bitop3_b32 v46, v24, v28, s45 bitop3:0x7e
s_waitcnt vmcnt(1)
v_mfma_f32_16x16x32_bf16 v[40:43], v[32:35], v[16:19], v[40:43]
s_waitcnt vmcnt(0)
v_mfma_f32_16x16x32_bf16 v[40:43], v[36:39], v[16:19], v[40:43]
v_bitop3_b32 v47, v32, v36, s45 bitop3:0x7e
v_bitop3_b32 v46, v46, v47, 1 bitop3:0xa8
v_cmp_ne_u32 vcc, 0, v46
v_mov_b64 v[24:25], 0
v_mov_b64 v[26:27], 0
v_mov_b64 v[28:29], 0
v_mov_b64 v[30:31], 0
v_permlane32_swap_b32 v40, v41
v_permlane32_swap_b32 v42, v43
v_add_f32 v40, v40, v41
v_add_f32 v41, v42, v43
v_cvt_pk_bf16_f32 v42, v40, v41
s_cbranch_vccz k_ok1_131
s_cbranch_scc1 k_r1_130
s_branch k_ok1_131
k_slow_127:
ds_read_b128 v[24:27], v0 offset:0
ds_read_b128 v[28:31], v0 offset:1024
v_mov_b32 v46, 0xff7fffff
s_add_u32 s48, s36, 0x0
buffer_load_dwordx4 v[32:35], v0, s[4:7], s48 offen offset:0 sc1
buffer_load_dwordx4 v[36:39], v0, s[4:7], s48 offen offset:1024 sc1
s_waitcnt vmcnt(1) lgkmcnt(1)
v_mfma_f32_16x16x32_bf16 v[4:7], v[32:35], v[24:27], 0
s_waitcnt vmcnt(0) lgkmcnt(0)
v_mfma_f32_16x16x32_bf16 v[4:7], v[36:39], v[28:31], v[4:7]
v_mov_b64 v[8:9], s[56:57]
s_nop 5
v_permlane32_swap_b32 v4, v6
v_permlane32_swap_b32 v5, v7
v_add_f32_dpp v8, v6, v4 row_ror:8 row_mask:0xf bank_mask:0x3
s_nop 0
v_add_f32_dpp v9, v7, v5 row_ror:8 row_mask:0xf bank_mask:0x3
v_max3_f32 v46, v46, v8, v9
s_add_u32 s48, s36, 0x1000
buffer_load_dwordx4 v[32:35], v0, s[4:7], s48 offen offset:0 sc1
buffer_load_dwordx4 v[36:39], v0, s[4:7], s48 offen offset:1024 sc1
s_waitcnt vmcnt(1)
v_mfma_f32_16x16x32_bf16 v[4:7], v[32:35], v[24:27], 0
s_waitcnt vmcnt(0)
v_mfma_f32_16x16x32_bf16 v[4:7], v[36:39], v[28:31], v[4:7]
v_mov_b64 v[10:11], s[56:57]
s_nop 5
v_permlane32_swap_b32 v4, v6
v_permlane32_swap_b32 v5, v7
v_add_f32_dpp v10, v6, v4 row_ror:8 row_mask:0xf bank_mask:0x3
s_nop 0
v_add_f32_dpp v11, v7, v5 row_ror:8 row_mask:0xf bank_mask:0x3
v_max3_f32 v46, v46, v10, v11
s_add_u32 s48, s36, 0x2000
buffer_load_dwordx4 v[32:35], v0, s[4:7], s48 offen offset:0 sc1
buffer_load_dwordx4 v[36:39], v0, s[4:7], s48 offen offset:1024 sc1
s_waitcnt vmcnt(1)
v_mfma_f32_16x16x32_bf16 v[4:7], v[32:35], v[24:27], 0
s_waitcnt vmcnt(0)
v_mfma_f32_16x16x32_bf16 v[4:7], v[36:39], v[28:31], v[4:7]
v_mov_b64 v[12:13], s[56:57]
s_nop 5
v_permlane32_swap_b32 v4, v6
v_permlane32_swap_b32 v5, v7
v_add_f32_dpp v12, v6, v4 row_ror:8 row_mask:0xf bank_mask:0x3
s_nop 0
v_add_f32_dpp v13, v7, v5 row_ror:8 row_mask:0xf bank_mask:0x3
v_max3_f32 v46, v46, v12, v13
s_add_u32 s48, s36, 0x3000
buffer_load_dwordx4 v[32:35], v0, s[4:7], s48 offen offset:0 sc1
buffer_load_dwordx4 v[36:39], v0, s[4:7], s48 offen offset:1024 sc1
s_waitcnt vmcnt(1)
v_mfma_f32_16x16x32_bf16 v[4:7], v[32:35], v[24:27], 0
s_waitcnt vmcnt(0)
v_mfma_f32_16x16x32_bf16 v[4:7], v[36:39], v[28:31], v[4:7]
v_mov_b64 v[14:15], s[56:57]
s_nop 5
v_permlane32_swap_b32 v4, v6
v_permlane32_swap_b32 v5, v7
v_add_f32_dpp v14, v6, v4 row_ror:8 row_mask:0xf bank_mask:0x3
s_nop 0
v_add_f32_dpp v15, v7, v5 row_ror:8 row_mask:0xf bank_mask:0x3
v_max3_f32 v46, v46, v14, v15
ds_read_b128 v[32:35], v0 offset:2048
ds_read_b128 v[36:39], v0 offset:3072
s_waitcnt lgkmcnt(1)
v_mfma_f32_16x16x32_bf16 v[4:7], v[32:35], v[24:27], 0
s_waitcnt lgkmcnt(0)
v_mfma_f32_16x16x32_bf16 v[4:7], v[36:39], v[28:31], v[4:7]
v_mov_b64 v[44:45], s[56:57]
s_nop 5
v_permlane32_swap_b32 v4, v6
v_permlane32_swap_b32 v5, v7
v_add_f32_dpp v44, v6, v4 row_ror:8 row_mask:0xf bank_mask:0x3
s_nop 0
v_add_f32_dpp v45, v7, v5 row_ror:8 row_mask:0xf bank_mask:0x3
v_max3_f32 v46, v46, v44, v45
buffer_load_dwordx4 v[32:35], v0, s[4:7], s36 offen offset:2048 sc1
buffer_load_dwordx4 v[36:39], v0, s[4:7], s36 offen offset:3072 sc1
v_mov_b32 v47, v46
s_nop 1
v_permlane32_swap_b32 v46, v47
v_max_f32 v46, v46, v47
v_mov_b32 v47, v46
s_nop 1
v_permlane16_swap_b32 v46, v47
v_max_f32 v46, v46, v47
v_sub_f32 v8, v8, v46
v_exp_f32 v8, v8
v_sub_f32 v9, v9, v46
v_exp_f32 v9, v9
v_sub_f32 v10, v10, v46
v_exp_f32 v10, v10
v_sub_f32 v11, v11, v46
v_exp_f32 v11, v11
v_sub_f32 v12, v12, v46
v_exp_f32 v12, v12
v_sub_f32 v13, v13, v46
v_exp_f32 v13, v13
v_sub_f32 v14, v14, v46
v_exp_f32 v14, v14
v_sub_f32 v15, v15, v46
v_exp_f32 v15, v15
v_sub_f32 v44, v44, v46
v_exp_f32 v44, v44
v_sub_f32 v45, v45, v46
v_exp_f32 v45, v45
v_cvt_pk_bf16_f32 v4, v8, v9
v_cvt_pk_bf16_f32 v5, v10, v11
v_cvt_pk_bf16_f32 v6, v12, v13
v_cvt_pk_bf16_f32 v7, v14, v15
v_mov_b32_dpp v8, v4 row_ror:8 row_mask:0xf bank_mask:0xf
v_mov_b32_dpp v9, v5 row_ror:8 row_mask:0xf bank_mask:0xf
v_mov_b32_dpp v10, v6 row_ror:8 row_mask:0xf bank_mask:0xf
v_mov_b32_dpp v11, v7 row_ror:8 row_mask:0xf bank_mask:0xf
v_cvt_pk_bf16_f32 v24, v44, v45
v_cvt_pk_bf16_f32 v25, v44, v45
s_nop 0
v_mov_b32_dpp v26, v24 row_ror:8 row_mask:0xf bank_mask:0xf
v_mov_b32_dpp v27, v24 row_ror:8 row_mask:0xf bank_mask:0xf
v_mov_b64 v[28:29], s[52:53]
v_mov_b64 v[30:31], s[52:53]
s_nop 1
v_mfma_f32_16x16x32_bf16 v[44:47], v[28:31], v[4:7], 0
s_waitcnt vmcnt(1)
v_mfma_f32_16x16x32_bf16 v[12:15], v[32:35], v[4:7], 0
s_waitcnt vmcnt(0)
v_mfma_f32_16x16x32_bf16 v[12:15], v[36:39], v[8:11], v[12:15]
v_mfma_f32_16x16x32_bf16 v[12:15], v[40:43], v[24:27], v[12:15]
v_mov_b64 v[28:29], s[54:55]
s_nop 1
v_mfma_f32_16x16x16_bf16 v[44:47], v[28:29], v[24:25], v[44:47]
s_nop 6
v_rcp_f32 v4, v44
s_nop 1
v_rcp_f32_dpp v4, v44 row_ror:8 row_mask:0xf bank_mask:0xc
s_nop 0
v_mul_f32 v12, v4, v12
v_mul_f32 v13, v4, v13
v_mul_f32 v14, v4, v14
v_mul_f32 v15, v4, v15
v_cvt_pk_bf16_f32 v44, v12, v13
v_cvt_pk_bf16_f32 v45, v14, v15
v_and_b32 v12, 0xffffff7f, v0
v_and_or_b32 v8, v1, 8, v12
ds_write_b64 v8, v[44:45] offset:6144
v_mov_b32_dpp v46, v44 row_ror:8 row_mask:0xf bank_mask:0xf
v_mov_b32_dpp v47, v45 row_ror:8 row_mask:0xf bank_mask:0xf
v_mov_b64 v[24:25], 0
v_mov_b64 v[26:27], 0
v_mov_b64 v[28:29], 0
v_mov_b64 v[30:31], 0
v_mov_b64 v[32:33], 0
v_mov_b64 v[34:35], 0
v_mov_b64 v[36:37], 0
v_mov_b64 v[38:39], 0
s_waitcnt lgkmcnt(0)
s_branch k_okS_128
k_done_129:
buffer_load_dwordx4 v[16:19], v0, s[4:7], s35 offen offset:0 sc1
k_xs_135:
s_waitcnt vmcnt(1)
v_cmp_u_f32 vcc, v4, v12
s_waitcnt vmcnt(0)
v_cmp_u_f32 s[66:67], v16, v16
s_or_b64 vcc, vcc, s[66:67]
s_cbranch_vccz k_xd_136
buffer_load_dwordx4 v[4:7], v0, s[4:7], s33 offen offset:0 sc1
buffer_load_dwordx4 v[8:11], v0, s[4:7], s33 offen offset:1024 sc1
buffer_load_dwordx4 v[12:15], v0, s[4:7], s34 offen offset:0 sc1
buffer_load_dwordx4 v[16:19], v0, s[4:7], s35 offen offset:0 sc1
s_sub_u32 s32, s32, 1
s_cmp_gt_i32 s32, 0
s_cbranch_scc1 k_xs_135
k_xd_136:
s_waitcnt vmcnt(3)
buffer_store_dwordx4 v[4:7], v0, s[8:11], s37 offen offset:0 sc1
s_waitcnt vmcnt(2)
buffer_store_dwordx4 v[12:15], v0, s[8:11], s37 offen offset:2048 sc1
s_waitcnt vmcnt(2)
buffer_store_dwordx4 v[16:19], v0, s[8:11], s59 offen offset:2048 sc1
s_add_u32 s31, s31, 1
s_cmp_lt_u32 s31, 128
s_cbranch_scc1 k_lay_114
s_add_u32 s30, s30, 112
s_waitcnt vmcnt(0) lgkmcnt(0)
s_barrier
s_branch k_fin_7
k_w1_109:
v_lshrrev_b32 v12, 3, v0
v_lshlrev_b32 v10, 13, v12
v_bfe_u32 v12, v0, 1, 2
v_lshrrev_b32 v13, 4, v0
v_xor_b32 v12, v12, v13
v_lshl_add_u32 v10, v12, 5, v10
v_and_b32 v14, 1, v0
v_lshl_add_u32 v10, v14, 4, v10
v_mul_u32_u24 v11, 1280, v13
v_bfe_u32 v12, v0, 1, 3
v_and_b32 v13, 1, v13
v_lshlrev_b32 v13, 1, v13
v_xor_b32 v12, v12, v13
v_xor_b32 v12, 0, v12
v_lshl_add_u32 v11, v12, 5, v11
v_lshl_add_u32 v11, v14, 4, v11
v_bfe_u32 v12, v0, 5, 1
v_lshlrev_b32 v12, 4, v12
v_bfe_u32 v13, v0, 4, 1
v_lshl_add_u32 v12, v13, 1, v12
v_bfe_u32 v13, v0, 2, 1
v_lshl_add_u32 v12, v13, 2, v12
v_bfe_u32 v13, v0, 3, 1
v_mul_u32_u24 v15, 4224, v13
v_add_u32 v12, v13, v12
v_bfe_u32 v13, v12, 1, 2
v_xor_b32 v13, 1, v13
v_lshlrev_b32 v13, 5, v13
v_lshl_add_u32 v4, v12, 7, v13
v_and_b32 v14, 3, v0
v_lshl_add_u32 v4, v14, 3, v4
v_add_u32 v5, 0x10000, v4
v_add_u32 v6, 0x20000, v4
v_bfe_u32 v12, v0, 4, 1
v_lshlrev_b32 v13, 4, v12
v_lshlrev_b32 v12, 2, v12
v_bfe_u32 v8, v0, 5, 1
v_lshl_add_u32 v13, v8, 2, v13
v_bfe_u32 v8, v0, 2, 1
v_add_u32 v13, v8, v13
v_lshl_add_u32 v12, v8, 1, v12
v_bfe_u32 v8, v0, 3, 1
v_add_u32 v8, 2, v8
v_xor_b32 v12, v12, v8
v_lshlrev_b32 v12, 5, v12
v_lshl_add_u32 v7, v13, 8, v12
v_lshl_add_u32 v7, v14, 3, v7
v_add_u32 v8, 0x10000, v7
v_add_u32 v9, 0x20000, v7
v_lshlrev_b32 v0, 4, v0
v_add_u32 v2, 98304, v0
s_lshl_b32 s49, s30, 8
s_mul_i32 s50, s30, 163840
s_mul_i32 s60, s30, 131072
s_add_u32 s60, s60, 120619008
s_add_u32 s61, s60, 4096
s_add_u32 s62, s60, 8192
s_mov_b32 m0, 2048
s_add_u32 s48, s49, 131072
buffer_load_dwordx4 v10, s[8:11], s48 offen lds
s_mov_b32 m0, 3072
s_add_u32 s48, s49, 196608
buffer_load_dwordx4 v10, s[8:11], s48 offen lds
s_mov_b32 m0, 10240
s_add_u32 s48, s49, 131200
buffer_load_dwordx4 v10, s[8:11], s48 offen lds
s_mov_b32 m0, 11264
s_add_u32 s48, s49, 196736
buffer_load_dwordx4 v10, s[8:11], s48 offen lds
s_mov_b32 m0, 18432
s_add_u32 s48, s49, 131200
buffer_load_dwordx4 v10, s[12:15], s48 offen lds
s_mov_b32 m0, 19456
s_add_u32 s48, s49, 196736
buffer_load_dwordx4 v10, s[12:15], s48 offen lds
s_mov_b32 m0, 26624
s_add_u32 s48, s49, 131072
buffer_load_dwordx4 v10, s[16:19], s48 offen lds
s_mov_b32 m0, 27648
s_add_u32 s48, s49, 196608
buffer_load_dwordx4 v10, s[16:19], s48 offen lds
s_mov_b32 m0, 34816
s_add_u32 s48, s49, 131200
buffer_load_dwordx4 v10, s[16:19], s48 offen lds
s_mov_b32 m0, 35840
s_add_u32 s48, s49, 196736
buffer_load_dwordx4 v10, s[16:19], s48 offen lds
s_mov_b32 m0, 43008
s_add_u32 s48, s49, 655360
buffer_load_dwordx4 v10, s[8:11], s48 offen lds
s_mov_b32 m0, 44032
s_add_u32 s48, s49, 720896
buffer_load_dwordx4 v10, s[8:11], s48 offen lds
s_mov_b32 m0, 51200
s_add_u32 s48, s49, 655488
buffer_load_dwordx4 v10, s[8:11], s48 offen lds
s_mov_b32 m0, 52224
s_add_u32 s48, s49, 721024
buffer_load_dwordx4 v10, s[8:11], s48 offen lds
s_mov_b32 m0, 59392
s_add_u32 s48, s49, 655488
buffer_load_dwordx4 v10, s[12:15], s48 offen lds
s_mov_b32 m0, 60416
s_add_u32 s48, s49, 721024
buffer_load_dwordx4 v10, s[12:15], s48 offen lds
s_mov_b32 m0, 67584
s_add_u32 s48, s49, 655360
buffer_load_dwordx4 v10, s[16:19], s48 offen lds
s_mov_b32 m0, 68608
s_add_u32 s48, s49, 720896
buffer_load_dwordx4 v10, s[16:19], s48 offen lds
s_mov_b32 m0, 75776
s_add_u32 s48, s49, 655488
buffer_load_dwordx4 v10, s[16:19], s48 offen lds
s_mov_b32 m0, 76800
s_add_u32 s48, s49, 721024
buffer_load_dwordx4 v10, s[16:19], s48 offen lds
s_mov_b32 m0, 83968
s_add_u32 s48, s49, 1179648
buffer_load_dwordx4 v10, s[8:11], s48 offen lds
s_mov_b32 m0, 84992
s_add_u32 s48, s49, 1245184
buffer_load_dwordx4 v10, s[8:11], s48 offen lds
s_mov_b32 m0, 92160
s_add_u32 s48, s49, 1179776
buffer_load_dwordx4 v10, s[8:11], s48 offen lds
s_mov_b32 m0, 93184
s_add_u32 s48, s49, 1245312
buffer_load_dwordx4 v10, s[8:11], s48 offen lds
s_mov_b32 m0, 100352
s_add_u32 s48, s49, 1179776
buffer_load_dwordx4 v10, s[12:15], s48 offen lds
s_mov_b32 m0, 101376
s_add_u32 s48, s49, 1245312
buffer_load_dwordx4 v10, s[12:15], s48 offen lds
s_mov_b32 m0, 108544
s_add_u32 s48, s49, 1179648
buffer_load_dwordx4 v10, s[16:19], s48 offen lds
s_mov_b32 m0, 109568
s_add_u32 s48, s49, 1245184
buffer_load_dwordx4 v10, s[16:19], s48 offen lds
s_mov_b32 m0, 116736
s_add_u32 s48, s49, 1703936
buffer_load_dwordx4 v10, s[8:11], s48 offen lds
s_mov_b32 m0, 117760
s_add_u32 s48, s49, 1769472
buffer_load_dwordx4 v10, s[8:11], s48 offen lds
s_mov_b32 m0, 124928
s_add_u32 s48, s49, 1704064
buffer_load_dwordx4 v10, s[8:11], s48 offen lds
s_mov_b32 m0, 125952
s_add_u32 s48, s49, 1769600
buffer_load_dwordx4 v10, s[8:11], s48 offen lds
s_waitcnt vmcnt(24)
s_barrier
s_mov_b32 m0, 133120
s_add_u32 s48, s49, 1704064
buffer_load_dwordx4 v10, s[12:15], s48 offen lds
s_mov_b32 m0, 134144
s_add_u32 s48, s49, 1769600
buffer_load_dwordx4 v10, s[12:15], s48 offen lds
s_mov_b32 m0, 141312
s_add_u32 s48, s49, 1703936
buffer_load_dwordx4 v10, s[16:19], s48 offen lds
s_mov_b32 m0, 142336
s_add_u32 s48, s49, 1769472
buffer_load_dwordx4 v10, s[16:19], s48 offen lds
s_mov_b32 m0, 149504
s_add_u32 s48, s49, 2228224
buffer_load_dwordx4 v10, s[8:11], s48 offen lds
s_mov_b32 m0, 150528
s_add_u32 s48, s49, 2293760
buffer_load_dwordx4 v10, s[8:11], s48 offen lds
s_mov_b32 m0, 157696
s_add_u32 s48, s49, 2228352
buffer_load_dwordx4 v10, s[8:11], s48 offen lds
s_mov_b32 m0, 158720
s_add_u32 s48, s49, 2293888
buffer_load_dwordx4 v10, s[8:11], s48 offen lds
ds_read_b64_tr_b16 a[24:25], v4 offset:0
ds_read_b64_tr_b16 a[26:27], v4 offset:1024
ds_read_b64_tr_b16 a[28:29], v4 offset:4096
ds_read_b64_tr_b16 a[30:31], v4 offset:5120
ds_read_b64_tr_b16 a[32:33], v4 offset:8192
ds_read_b64_tr_b16 a[34:35], v4 offset:9216
ds_read_b64_tr_b16 a[36:37], v4 offset:12288
ds_read_b64_tr_b16 a[38:39], v4 offset:13312
ds_read_b64_tr_b16 a[40:41], v4 offset:16384
ds_read_b64_tr_b16 a[42:43], v4 offset:17408
ds_read_b64_tr_b16 a[44:45], v4 offset:20480
ds_read_b64_tr_b16 a[46:47], v4 offset:21504
ds_read_b64_tr_b16 a[176:177], v4 offset:24576
ds_read_b64_tr_b16 a[178:179], v4 offset:25600
ds_read_b64_tr_b16 a[180:181], v4 offset:28672
ds_read_b64_tr_b16 a[182:183], v4 offset:29696
s_waitcnt lgkmcnt(0)
s_waitcnt vmcnt(24)
s_barrier
s_mov_b32 m0, 2048
s_add_u32 s48, s49, 2228352
buffer_load_dwordx4 v10, s[12:15], s48 offen lds
s_mov_b32 m0, 3072
s_add_u32 s48, s49, 2293888
buffer_load_dwordx4 v10, s[12:15], s48 offen lds
s_mov_b32 m0, 10240
s_add_u32 s48, s49, 2228224
buffer_load_dwordx4 v10, s[16:19], s48 offen lds
s_mov_b32 m0, 11264
s_add_u32 s48, s49, 2293760
buffer_load_dwordx4 v10, s[16:19], s48 offen lds
s_mov_b32 m0, 18432
s_add_u32 s48, s49, 2752512
buffer_load_dwordx4 v10, s[8:11], s48 offen lds
s_mov_b32 m0, 19456
s_add_u32 s48, s49, 2818048
buffer_load_dwordx4 v10, s[8:11], s48 offen lds
s_mov_b32 m0, 26624
s_add_u32 s48, s49, 2752640
buffer_load_dwordx4 v10, s[8:11], s48 offen lds
s_mov_b32 m0, 27648
s_add_u32 s48, s49, 2818176
buffer_load_dwordx4 v10, s[8:11], s48 offen lds
ds_read_b64_tr_b16 v[224:225], v4 offset:32768
ds_read_b64_tr_b16 v[226:227], v4 offset:33792
ds_read_b64_tr_b16 v[228:229], v4 offset:36864
ds_read_b64_tr_b16 v[230:231], v4 offset:37888
ds_read_b64_tr_b16 a[0:1], v4 offset:40960
ds_read_b64_tr_b16 a[2:3], v4 offset:41984
ds_read_b64_tr_b16 a[4:5], v4 offset:45056
ds_read_b64_tr_b16 a[6:7], v4 offset:46080
ds_read_b64_tr_b16 a[8:9], v4 offset:49152
ds_read_b64_tr_b16 a[10:11], v4 offset:50176
ds_read_b64_tr_b16 a[12:13], v4 offset:53248
ds_read_b64_tr_b16 a[14:15], v4 offset:54272
ds_read_b64_tr_b16 a[16:17], v4 offset:57344
ds_read_b64_tr_b16 a[18:19], v4 offset:58368
ds_read_b64_tr_b16 a[20:21], v4 offset:61440
ds_read_b64_tr_b16 a[22:23], v4 offset:62464
s_waitcnt lgkmcnt(0)
s_waitcnt vmcnt(24)
s_barrier
s_mov_b32 m0, 34816
s_add_u32 s48, s49, 2752640
buffer_load_dwordx4 v10, s[12:15], s48 offen lds
s_mov_b32 m0, 35840
s_add_u32 s48, s49, 2818176
buffer_load_dwordx4 v10, s[12:15], s48 offen lds
s_mov_b32 m0, 43008
s_add_u32 s48, s49, 2752512
buffer_load_dwordx4 v10, s[16:19], s48 offen lds
s_mov_b32 m0, 44032
s_add_u32 s48, s49, 2818048
buffer_load_dwordx4 v10, s[16:19], s48 offen lds
s_mov_b32 m0, 51200
s_add_u32 s48, s49, 3276928
buffer_load_dwordx4 v10, s[8:11], s48 offen lds
s_mov_b32 m0, 52224
s_add_u32 s48, s49, 3342464
buffer_load_dwordx4 v10, s[8:11], s48 offen lds
s_mov_b32 m0, 59392
s_add_u32 s48, s49, 3801088
buffer_load_dwordx4 v10, s[8:11], s48 offen lds
s_mov_b32 m0, 60416
s_add_u32 s48, s49, 3866624
buffer_load_dwordx4 v10, s[8:11], s48 offen lds
ds_read_b64_tr_b16 v[16:17], v5 offset:0
ds_read_b64_tr_b16 v[18:19], v5 offset:1024
ds_read_b64_tr_b16 v[20:21], v5 offset:4096
ds_read_b64_tr_b16 v[22:23], v5 offset:5120
ds_read_b64_tr_b16 v[24:25], v5 offset:8192
ds_read_b64_tr_b16 v[26:27], v5 offset:9216
ds_read_b64_tr_b16 v[28:29], v5 offset:12288
ds_read_b64_tr_b16 v[30:31], v5 offset:13312
ds_read_b64_tr_b16 a[144:145], v5 offset:16384
ds_read_b64_tr_b16 a[146:147], v5 offset:17408
ds_read_b64_tr_b16 a[148:149], v5 offset:20480
ds_read_b64_tr_b16 a[150:151], v5 offset:21504
ds_read_b64_tr_b16 a[152:153], v5 offset:24576
ds_read_b64_tr_b16 a[154:155], v5 offset:25600
ds_read_b64_tr_b16 a[156:157], v5 offset:28672
ds_read_b64_tr_b16 a[158:159], v5 offset:29696
s_waitcnt lgkmcnt(0)
buffer_store_dwordx4 v[16:19], v0, s[4:7], s60 offen offset:0
buffer_store_dwordx4 v[20:23], v0, s[4:7], s60 offen offset:1024
buffer_store_dwordx4 v[24:27], v0, s[4:7], s60 offen offset:2048
buffer_store_dwordx4 v[28:31], v0, s[4:7], s60 offen offset:3072
s_waitcnt vmcnt(28)
s_barrier
s_mov_b32 m0, 67584
s_add_u32 s48, s49, 3801216
buffer_load_dwordx4 v10, s[8:11], s48 offen lds
s_mov_b32 m0, 68608
s_add_u32 s48, s49, 3866752
buffer_load_dwordx4 v10, s[8:11], s48 offen lds
s_mov_b32 m0, 75776
s_add_u32 s48, s49, 4325376
buffer_load_dwordx4 v10, s[8:11], s48 offen lds
s_mov_b32 m0, 76800
s_add_u32 s48, s49, 4390912
buffer_load_dwordx4 v10, s[8:11], s48 offen lds
s_mov_b32 m0, 83968
s_add_u32 s48, s49, 4325504
buffer_load_dwordx4 v10, s[8:11], s48 offen lds
s_mov_b32 m0, 84992
s_add_u32 s48, s49, 4391040
buffer_load_dwordx4 v10, s[8:11], s48 offen lds
s_mov_b32 m0, 92160
s_add_u32 s48, s49, 4849664
buffer_load_dwordx4 v10, s[8:11], s48 offen lds
s_mov_b32 m0, 93184
s_add_u32 s48, s49, 4915200
buffer_load_dwordx4 v10, s[8:11], s48 offen lds
ds_read_b64_tr_b16 a[160:161], v5 offset:32768
ds_read_b64_tr_b16 a[162:163], v5 offset:33792
ds_read_b64_tr_b16 a[164:165], v5 offset:36864
ds_read_b64_tr_b16 a[166:167], v5 offset:37888
ds_read_b64_tr_b16 a[168:169], v5 offset:40960
ds_read_b64_tr_b16 a[170:171], v5 offset:41984
ds_read_b64_tr_b16 a[172:173], v5 offset:45056
ds_read_b64_tr_b16 a[174:175], v5 offset:46080
ds_read_b64_tr_b16 a[48:49], v5 offset:49152
ds_read_b64_tr_b16 a[50:51], v5 offset:50176
ds_read_b64_tr_b16 a[52:53], v5 offset:53248
ds_read_b64_tr_b16 a[54:55], v5 offset:54272
ds_read_b64_tr_b16 a[56:57], v5 offset:57344
ds_read_b64_tr_b16 a[58:59], v5 offset:58368
ds_read_b64_tr_b16 a[60:61], v5 offset:61440
ds_read_b64_tr_b16 a[62:63], v5 offset:62464
s_waitcnt lgkmcnt(0)
s_waitcnt vmcnt(28)
s_barrier
s_mov_b32 m0, 100352
s_add_u32 s48, s49, 4849792
buffer_load_dwordx4 v10, s[8:11], s48 offen lds
s_mov_b32 m0, 101376
s_add_u32 s48, s49, 4915328
buffer_load_dwordx4 v10, s[8:11], s48 offen lds
s_mov_b32 m0, 108544
s_add_u32 s48, s49, 3276800
buffer_load_dwordx4 v10, s[12:15], s48 offen lds
s_mov_b32 m0, 109568
s_add_u32 s48, s49, 3342336
buffer_load_dwordx4 v10, s[12:15], s48 offen lds
s_mov_b32 m0, 116736
s_add_u32 s48, s49, 3276928
buffer_load_dwordx4 v10, s[12:15], s48 offen lds
s_mov_b32 m0, 117760
s_add_u32 s48, s49, 3342464
buffer_load_dwordx4 v10, s[12:15], s48 offen lds
s_mov_b32 m0, 124928
s_add_u32 s48, s49, 3801088
buffer_load_dwordx4 v10, s[12:15], s48 offen lds
s_mov_b32 m0, 125952
s_add_u32 s48, s49, 3866624
buffer_load_dwordx4 v10, s[12:15], s48 offen lds
ds_read_b64_tr_b16 a[64:65], v6 offset:0
ds_read_b64_tr_b16 a[66:67], v6 offset:1024
ds_read_b64_tr_b16 a[68:69], v6 offset:4096
ds_read_b64_tr_b16 a[70:71], v6 offset:5120
ds_read_b64_tr_b16 a[72:73], v6 offset:8192
ds_read_b64_tr_b16 a[74:75], v6 offset:9216
ds_read_b64_tr_b16 a[76:77], v6 offset:12288
ds_read_b64_tr_b16 a[78:79], v6 offset:13312
ds_read_b64_tr_b16 a[80:81], v6 offset:16384
ds_read_b64_tr_b16 a[82:83], v6 offset:17408
ds_read_b64_tr_b16 a[84:85], v6 offset:20480
ds_read_b64_tr_b16 a[86:87], v6 offset:21504
ds_read_b64_tr_b16 a[88:89], v6 offset:24576
ds_read_b64_tr_b16 a[90:91], v6 offset:25600
ds_read_b64_tr_b16 a[92:93], v6 offset:28672
ds_read_b64_tr_b16 a[94:95], v6 offset:29696
s_waitcnt lgkmcnt(0)
s_waitcnt vmcnt(28)
s_barrier
s_mov_b32 m0, 133120
s_add_u32 s48, s49, 3801216
buffer_load_dwordx4 v10, s[12:15], s48 offen lds
s_mov_b32 m0, 134144
s_add_u32 s48, s49, 3866752
buffer_load_dwordx4 v10, s[12:15], s48 offen lds
s_mov_b32 m0, 141312
s_add_u32 s48, s49, 4325376
buffer_load_dwordx4 v10, s[12:15], s48 offen lds
s_mov_b32 m0, 142336
s_add_u32 s48, s49, 4390912
buffer_load_dwordx4 v10, s[12:15], s48 offen lds
s_mov_b32 m0, 149504
s_add_u32 s48, s49, 4325504
buffer_load_dwordx4 v10, s[12:15], s48 offen lds
s_mov_b32 m0, 150528
s_add_u32 s48, s49, 4391040
buffer_load_dwordx4 v10, s[12:15], s48 offen lds
s_mov_b32 m0, 157696
s_add_u32 s48, s49, 4849664
buffer_load_dwordx4 v10, s[12:15], s48 offen lds
s_mov_b32 m0, 158720
s_add_u32 s48, s49, 4915200
buffer_load_dwordx4 v10, s[12:15], s48 offen lds
ds_read_b64_tr_b16 a[96:97], v4 offset:0
ds_read_b64_tr_b16 a[98:99], v4 offset:1024
ds_read_b64_tr_b16 a[100:101], v4 offset:4096
ds_read_b64_tr_b16 a[102:103], v4 offset:5120
ds_read_b64_tr_b16 a[104:105], v4 offset:8192
ds_read_b64_tr_b16 a[106:107], v4 offset:9216
ds_read_b64_tr_b16 a[108:109], v4 offset:12288
ds_read_b64_tr_b16 a[110:111], v4 offset:13312
ds_read_b64_tr_b16 a[112:113], v4 offset:16384
ds_read_b64_tr_b16 a[114:115], v4 offset:17408
ds_read_b64_tr_b16 a[116:117], v4 offset:20480
ds_read_b64_tr_b16 a[118:119], v4 offset:21504
ds_read_b64_tr_b16 a[120:121], v4 offset:24576
ds_read_b64_tr_b16 a[122:123], v4 offset:25600
ds_read_b64_tr_b16 a[124:125], v4 offset:28672
ds_read_b64_tr_b16 a[126:127], v4 offset:29696
s_waitcnt lgkmcnt(0)
s_waitcnt vmcnt(28)
s_barrier
s_mov_b32 m0, 2048
s_add_u32 s48, s49, 4849792
buffer_load_dwordx4 v10, s[12:15], s48 offen lds
s_mov_b32 m0, 3072
s_add_u32 s48, s49, 4915328
buffer_load_dwordx4 v10, s[12:15], s48 offen lds
s_mov_b32 m0, 10240
s_add_u32 s48, s49, 3276800
buffer_load_dwordx4 v10, s[16:19], s48 offen lds
s_mov_b32 m0, 11264
s_add_u32 s48, s49, 3342336
buffer_load_dwordx4 v10, s[16:19], s48 offen lds
s_mov_b32 m0, 18432
s_add_u32 s48, s49, 3276928
buffer_load_dwordx4 v10, s[16:19], s48 offen lds
s_mov_b32 m0, 19456
s_add_u32 s48, s49, 3342464
buffer_load_dwordx4 v10, s[16:19], s48 offen lds
s_mov_b32 m0, 26624
s_add_u32 s48, s49, 3801088
buffer_load_dwordx4 v10, s[16:19], s48 offen lds
s_mov_b32 m0, 27648
s_add_u32 s48, s49, 3866624
buffer_load_dwordx4 v10, s[16:19], s48 offen lds
ds_read_b64_tr_b16 a[128:129], v4 offset:32768
ds_read_b64_tr_b16 a[130:131], v4 offset:33792
ds_read_b64_tr_b16 a[132:133], v4 offset:36864
ds_read_b64_tr_b16 a[134:135], v4 offset:37888
ds_read_b64_tr_b16 a[136:137], v4 offset:40960
ds_read_b64_tr_b16 a[138:139], v4 offset:41984
ds_read_b64_tr_b16 a[140:141], v4 offset:45056
ds_read_b64_tr_b16 a[142:143], v4 offset:46080
ds_read_b64_tr_b16 a[232:233], v4 offset:49152
ds_read_b64_tr_b16 a[234:235], v4 offset:50176
ds_read_b64_tr_b16 a[236:237], v4 offset:53248
ds_read_b64_tr_b16 a[238:239], v4 offset:54272
ds_read_b64_tr_b16 a[184:185], v4 offset:57344
ds_read_b64_tr_b16 a[186:187], v4 offset:58368
ds_read_b64_tr_b16 a[188:189], v4 offset:61440
ds_read_b64_tr_b16 a[190:191], v4 offset:62464
s_waitcnt lgkmcnt(0)
s_waitcnt vmcnt(24)
s_barrier
s_mov_b32 m0, 34816
s_add_u32 s48, s49, 3801216
buffer_load_dwordx4 v10, s[16:19], s48 offen lds
s_mov_b32 m0, 35840
s_add_u32 s48, s49, 3866752
buffer_load_dwordx4 v10, s[16:19], s48 offen lds
s_mov_b32 m0, 43008
s_add_u32 s48, s49, 4325376
buffer_load_dwordx4 v10, s[16:19], s48 offen lds
s_mov_b32 m0, 44032
s_add_u32 s48, s49, 4390912
buffer_load_dwordx4 v10, s[16:19], s48 offen lds
s_mov_b32 m0, 51200
s_add_u32 s48, s49, 4325504
buffer_load_dwordx4 v10, s[16:19], s48 offen lds
s_mov_b32 m0, 52224
s_add_u32 s48, s49, 4391040
buffer_load_dwordx4 v10, s[16:19], s48 offen lds
s_mov_b32 m0, 59392
s_add_u32 s48, s49, 4849664
buffer_load_dwordx4 v10, s[16:19], s48 offen lds
s_mov_b32 m0, 60416
s_add_u32 s48, s49, 4915200
buffer_load_dwordx4 v10, s[16:19], s48 offen lds
ds_read_b64_tr_b16 a[192:193], v5 offset:0
ds_read_b64_tr_b16 a[194:195], v5 offset:1024
ds_read_b64_tr_b16 a[196:197], v5 offset:4096
ds_read_b64_tr_b16 a[198:199], v5 offset:5120
ds_read_b64_tr_b16 v[248:249], v5 offset:8192
ds_read_b64_tr_b16 v[250:251], v5 offset:9216
ds_read_b64_tr_b16 v[252:253], v5 offset:12288
ds_read_b64_tr_b16 v[254:255], v5 offset:13312
ds_read_b64_tr_b16 a[200:201], v5 offset:16384
ds_read_b64_tr_b16 a[202:203], v5 offset:17408
ds_read_b64_tr_b16 a[204:205], v5 offset:20480
ds_read_b64_tr_b16 a[206:207], v5 offset:21504
ds_read_b64_tr_b16 a[208:209], v5 offset:24576
ds_read_b64_tr_b16 a[210:211], v5 offset:25600
ds_read_b64_tr_b16 a[212:213], v5 offset:28672
ds_read_b64_tr_b16 a[214:215], v5 offset:29696
s_waitcnt lgkmcnt(0)
s_waitcnt vmcnt(24)
s_barrier
s_mov_b32 m0, 67584
s_add_u32 s48, s49, 4849792
buffer_load_dwordx4 v10, s[16:19], s48 offen lds
s_mov_b32 m0, 68608
s_add_u32 s48, s49, 4915328
buffer_load_dwordx4 v10, s[16:19], s48 offen lds
s_mov_b32 m0, 75776
s_add_u32 s48, s50, 10240
buffer_load_dwordx4 v11, s[20:23], s48 offen lds
s_mov_b32 m0, 76800
s_add_u32 s48, s50, 15360
buffer_load_dwordx4 v11, s[20:23], s48 offen lds
s_mov_b32 m0, 83968
s_add_u32 s48, s50, 30720
buffer_load_dwordx4 v11, s[20:23], s48 offen lds
s_mov_b32 m0, 84992
s_add_u32 s48, s50, 35840
buffer_load_dwordx4 v11, s[20:23], s48 offen lds
s_mov_b32 m0, 92160
s_add_u32 s48, s50, 51200
buffer_load_dwordx4 v11, s[20:23], s48 offen lds
s_mov_b32 m0, 93184
s_add_u32 s48, s50, 56320
buffer_load_dwordx4 v11, s[20:23], s48 offen lds
ds_read_b64_tr_b16 a[216:217], v5 offset:32768
ds_read_b64_tr_b16 a[218:219], v5 offset:33792
ds_read_b64_tr_b16 a[220:221], v5 offset:36864
ds_read_b64_tr_b16 a[222:223], v5 offset:37888
ds_read_b64_tr_b16 v[96:97], v5 offset:40960
ds_read_b64_tr_b16 v[98:99], v5 offset:41984
ds_read_b64_tr_b16 v[100:101], v5 offset:45056
ds_read_b64_tr_b16 v[102:103], v5 offset:46080
ds_read_b64_tr_b16 v[104:105], v5 offset:49152
ds_read_b64_tr_b16 v[106:107], v5 offset:50176
ds_read_b64_tr_b16 v[108:109], v5 offset:53248
ds_read_b64_tr_b16 v[110:111], v5 offset:54272
ds_read_b64_tr_b16 v[240:241], v5 offset:57344
ds_read_b64_tr_b16 v[242:243], v5 offset:58368
ds_read_b64_tr_b16 v[244:245], v5 offset:61440
ds_read_b64_tr_b16 v[246:247], v5 offset:62464
s_waitcnt lgkmcnt(0)
s_waitcnt vmcnt(24)
s_barrier
s_mov_b32 m0, 100352
s_add_u32 s48, s50, 71680
buffer_load_dwordx4 v11, s[20:23], s48 offen lds
s_mov_b32 m0, 101376
s_add_u32 s48, s50, 76800
buffer_load_dwordx4 v11, s[20:23], s48 offen lds
s_mov_b32 m0, 108544
s_add_u32 s48, s50, 10496
buffer_load_dwordx4 v11, s[20:23], s48 offen lds
s_mov_b32 m0, 109568
s_add_u32 s48, s50, 15616
buffer_load_dwordx4 v11, s[20:23], s48 offen lds
s_mov_b32 m0, 116736
s_add_u32 s48, s50, 30976
buffer_load_dwordx4 v11, s[20:23], s48 offen lds
s_mov_b32 m0, 117760
s_add_u32 s48, s50, 36096
buffer_load_dwordx4 v11, s[20:23], s48 offen lds
s_mov_b32 m0, 124928
s_add_u32 s48, s50, 51456
buffer_load_dwordx4 v11, s[20:23], s48 offen lds
s_mov_b32 m0, 125952
s_add_u32 s48, s50, 56576
buffer_load_dwordx4 v11, s[20:23], s48 offen lds
ds_read_b64_tr_b16 a[240:241], v6 offset:0
ds_read_b64_tr_b16 a[242:243], v6 offset:1024
ds_read_b64_tr_b16 a[244:245], v6 offset:4096
ds_read_b64_tr_b16 a[246:247], v6 offset:5120
ds_read_b64_tr_b16 a[248:249], v6 offset:8192
ds_read_b64_tr_b16 a[250:251], v6 offset:9216
ds_read_b64_tr_b16 a[252:253], v6 offset:12288
ds_read_b64_tr_b16 a[254:255], v6 offset:13312
ds_read_b64_tr_b16 v[72:73], v6 offset:16384
ds_read_b64_tr_b16 v[74:75], v6 offset:17408
ds_read_b64_tr_b16 v[76:77], v6 offset:20480
ds_read_b64_tr_b16 v[78:79], v6 offset:21504
ds_read_b64_tr_b16 v[80:81], v6 offset:24576
ds_read_b64_tr_b16 v[82:83], v6 offset:25600
ds_read_b64_tr_b16 v[84:85], v6 offset:28672
ds_read_b64_tr_b16 v[86:87], v6 offset:29696
s_waitcnt lgkmcnt(0)
s_waitcnt vmcnt(24)
s_barrier
s_mov_b32 m0, 133120
s_add_u32 s48, s50, 71936
buffer_load_dwordx4 v11, s[20:23], s48 offen lds
s_mov_b32 m0, 134144
s_add_u32 s48, s50, 77056
buffer_load_dwordx4 v11, s[20:23], s48 offen lds
s_mov_b32 m0, 141312
s_add_u32 s48, s50, 10752
buffer_load_dwordx4 v11, s[20:23], s48 offen lds
s_mov_b32 m0, 142336
s_add_u32 s48, s50, 15872
buffer_load_dwordx4 v11, s[20:23], s48 offen lds
s_mov_b32 m0, 149504
s_add_u32 s48, s50, 31232
buffer_load_dwordx4 v11, s[20:23], s48 offen lds
s_mov_b32 m0, 150528
s_add_u32 s48, s50, 36352
buffer_load_dwordx4 v11, s[20:23], s48 offen lds
s_mov_b32 m0, 157696
s_add_u32 s48, s50, 51712
buffer_load_dwordx4 v11, s[20:23], s48 offen lds
s_mov_b32 m0, 158720
s_add_u32 s48, s50, 56832
buffer_load_dwordx4 v11, s[20:23], s48 offen lds
ds_read_b64_tr_b16 v[88:89], v4 offset:0
ds_read_b64_tr_b16 v[90:91], v4 offset:1024
ds_read_b64_tr_b16 v[92:93], v4 offset:4096
ds_read_b64_tr_b16 v[94:95], v4 offset:5120
ds_read_b64_tr_b16 v[160:161], v4 offset:8192
ds_read_b64_tr_b16 v[162:163], v4 offset:9216
ds_read_b64_tr_b16 v[164:165], v4 offset:12288
ds_read_b64_tr_b16 v[166:167], v4 offset:13312
ds_read_b64_tr_b16 v[168:169], v4 offset:16384
ds_read_b64_tr_b16 v[170:171], v4 offset:17408
ds_read_b64_tr_b16 v[172:173], v4 offset:20480
ds_read_b64_tr_b16 v[174:175], v4 offset:21504
ds_read_b64_tr_b16 v[112:113], v4 offset:24576
ds_read_b64_tr_b16 v[114:115], v4 offset:25600
ds_read_b64_tr_b16 v[116:117], v4 offset:28672
ds_read_b64_tr_b16 v[118:119], v4 offset:29696
s_waitcnt lgkmcnt(0)
s_waitcnt vmcnt(24)
s_barrier
s_mov_b32 m0, 2048
s_add_u32 s48, s50, 72192
buffer_load_dwordx4 v11, s[20:23], s48 offen lds
s_mov_b32 m0, 3072
s_add_u32 s48, s50, 77312
buffer_load_dwordx4 v11, s[20:23], s48 offen lds
s_mov_b32 m0, 10240
s_add_u32 s48, s49, 131072
buffer_load_dwordx4 v10, s[12:15], s48 offen lds
s_mov_b32 m0, 11264
s_add_u32 s48, s49, 196608
buffer_load_dwordx4 v10, s[12:15], s48 offen lds
s_mov_b32 m0, 18432
s_add_u32 s48, s49, 655360
buffer_load_dwordx4 v10, s[12:15], s48 offen lds
s_mov_b32 m0, 19456
s_add_u32 s48, s49, 720896
buffer_load_dwordx4 v10, s[12:15], s48 offen lds
s_mov_b32 m0, 26624
s_add_u32 s48, s49, 1179648
buffer_load_dwordx4 v10, s[12:15], s48 offen lds
s_mov_b32 m0, 27648
s_add_u32 s48, s49, 1245184
buffer_load_dwordx4 v10, s[12:15], s48 offen lds
ds_read_b64_tr_b16 v[120:121], v4 offset:32768
ds_read_b64_tr_b16 v[122:123], v4 offset:33792
ds_read_b64_tr_b16 v[124:125], v4 offset:36864
ds_read_b64_tr_b16 v[126:127], v4 offset:37888
ds_read_b64_tr_b16 v[128:129], v4 offset:40960
ds_read_b64_tr_b16 v[130:131], v4 offset:41984
ds_read_b64_tr_b16 v[132:133], v4 offset:45056
ds_read_b64_tr_b16 v[134:135], v4 offset:46080
ds_read_b64_tr_b16 v[136:137], v4 offset:49152
ds_read_b64_tr_b16 v[138:139], v4 offset:50176
ds_read_b64_tr_b16 v[140:141], v4 offset:53248
ds_read_b64_tr_b16 v[142:143], v4 offset:54272
ds_read_b64_tr_b16 v[144:145], v4 offset:57344
ds_read_b64_tr_b16 v[146:147], v4 offset:58368
ds_read_b64_tr_b16 v[148:149], v4 offset:61440
ds_read_b64_tr_b16 v[150:151], v4 offset:62464
s_waitcnt lgkmcnt(0)
s_waitcnt vmcnt(24)
s_barrier
s_mov_b32 m0, 34816
s_add_u32 s48, s49, 1703936
buffer_load_dwordx4 v10, s[12:15], s48 offen lds
s_mov_b32 m0, 35840
s_add_u32 s48, s49, 1769472
buffer_load_dwordx4 v10, s[12:15], s48 offen lds
s_mov_b32 m0, 43008
s_add_u32 s48, s49, 2228224
buffer_load_dwordx4 v10, s[12:15], s48 offen lds
s_mov_b32 m0, 44032
s_add_u32 s48, s49, 2293760
buffer_load_dwordx4 v10, s[12:15], s48 offen lds
s_mov_b32 m0, 51200
s_add_u32 s48, s49, 2752512
buffer_load_dwordx4 v10, s[12:15], s48 offen lds
s_mov_b32 m0, 52224
s_add_u32 s48, s49, 2818048
buffer_load_dwordx4 v10, s[12:15], s48 offen lds
s_mov_b32 m0, 59392
s_add_u32 s48, s49, 1179776
buffer_load_dwordx4 v10, s[16:19], s48 offen lds
s_mov_b32 m0, 60416
s_add_u32 s48, s49, 1245312
buffer_load_dwordx4 v10, s[16:19], s48 offen lds
ds_read_b64_tr_b16 v[152:153], v5 offset:0
ds_read_b64_tr_b16 v[154:155], v5 offset:1024
ds_read_b64_tr_b16 v[156:157], v5 offset:4096
ds_read_b64_tr_b16 v[158:159], v5 offset:5120
ds_read_b64_tr_b16 v[192:193], v8 offset:8192
ds_read_b64_tr_b16 v[194:195], v8 offset:8704
ds_read_b64_tr_b16 v[196:197], v8 offset:10240
ds_read_b64_tr_b16 v[198:199], v8 offset:10752
v_xor_b32 v12, v15, v8
ds_read_b64_tr_b16 v[32:33], v12 offset:16384
ds_read_b64_tr_b16 v[34:35], v12 offset:16896
ds_read_b64_tr_b16 v[36:37], v12 offset:18432
ds_read_b64_tr_b16 v[38:39], v12 offset:18944
ds_read_b64_tr_b16 v[176:177], v8 offset:24576
ds_read_b64_tr_b16 v[178:179], v8 offset:25088
ds_read_b64_tr_b16 v[180:181], v8 offset:26624
ds_read_b64_tr_b16 v[182:183], v8 offset:27136
s_waitcnt lgkmcnt(0)
buffer_store_dwordx4 v[32:35], v0, s[4:7], s61 offen offset:0
buffer_store_dwordx4 v[36:39], v0, s[4:7], s61 offen offset:1024
s_waitcnt vmcnt(26)
s_barrier
s_mov_b32 m0, 67584
s_add_u32 s48, s49, 1704064
buffer_load_dwordx4 v10, s[16:19], s48 offen lds
s_mov_b32 m0, 68608
s_add_u32 s48, s49, 1769600
buffer_load_dwordx4 v10, s[16:19], s48 offen lds
s_mov_b32 m0, 75776
s_add_u32 s48, s49, 2228352
buffer_load_dwordx4 v10, s[16:19], s48 offen lds
s_mov_b32 m0, 76800
s_add_u32 s48, s49, 2293888
buffer_load_dwordx4 v10, s[16:19], s48 offen lds
s_mov_b32 m0, 83968
s_add_u32 s48, s49, 2752640
buffer_load_dwordx4 v10, s[16:19], s48 offen lds
s_mov_b32 m0, 84992
s_add_u32 s48, s49, 2818176
buffer_load_dwordx4 v10, s[16:19], s48 offen lds
s_mov_b32 m0, 92160
s_add_u32 s48, s50, 11008
buffer_load_dwordx4 v11, s[20:23], s48 offen lds
s_mov_b32 m0, 93184
s_add_u32 s48, s50, 16128
buffer_load_dwordx4 v11, s[20:23], s48 offen lds
ds_read_b64_tr_b16 v[184:185], v8 offset:32768
ds_read_b64_tr_b16 v[186:187], v8 offset:33280
ds_read_b64_tr_b16 v[188:189], v8 offset:34816
ds_read_b64_tr_b16 v[190:191], v8 offset:35328
ds_read_b64_tr_b16 v[24:25], v8 offset:40960
ds_read_b64_tr_b16 v[26:27], v8 offset:41472
ds_read_b64_tr_b16 v[28:29], v8 offset:43008
ds_read_b64_tr_b16 v[30:31], v8 offset:43520
v_xor_b32 v12, v15, v8
ds_read_b64_tr_b16 v[32:33], v12 offset:49152
ds_read_b64_tr_b16 v[34:35], v12 offset:49664
ds_read_b64_tr_b16 v[36:37], v12 offset:51200
ds_read_b64_tr_b16 v[38:39], v12 offset:51712
ds_read_b64_tr_b16 a[224:225], v8 offset:57344
ds_read_b64_tr_b16 a[226:227], v8 offset:57856
ds_read_b64_tr_b16 a[228:229], v8 offset:59392
ds_read_b64_tr_b16 a[230:231], v8 offset:59904
s_waitcnt lgkmcnt(0)
buffer_store_dwordx4 v[24:27], v0, s[4:7], s62 offen offset:0
buffer_store_dwordx4 v[28:31], v0, s[4:7], s62 offen offset:1024
buffer_store_dwordx4 v[32:35], v0, s[4:7], s61 offen offset:2048
buffer_store_dwordx4 v[36:39], v0, s[4:7], s61 offen offset:3072
s_waitcnt vmcnt(30)
s_barrier
s_mov_b32 m0, 100352
s_add_u32 s48, s50, 31488
buffer_load_dwordx4 v11, s[20:23], s48 offen lds
s_mov_b32 m0, 101376
s_add_u32 s48, s50, 36608
buffer_load_dwordx4 v11, s[20:23], s48 offen lds
s_mov_b32 m0, 108544
s_add_u32 s48, s50, 51968
buffer_load_dwordx4 v11, s[20:23], s48 offen lds
s_mov_b32 m0, 109568
s_add_u32 s48, s50, 57088
buffer_load_dwordx4 v11, s[20:23], s48 offen lds
s_mov_b32 m0, 116736
s_add_u32 s48, s50, 72448
buffer_load_dwordx4 v11, s[20:23], s48 offen lds
s_mov_b32 m0, 117760
s_add_u32 s48, s50, 77568
buffer_load_dwordx4 v11, s[20:23], s48 offen lds
s_mov_b32 m0, 124928
s_add_u32 s48, s50, 11264
buffer_load_dwordx4 v11, s[20:23], s48 offen lds
s_mov_b32 m0, 125952
s_add_u32 s48, s50, 16384
buffer_load_dwordx4 v11, s[20:23], s48 offen lds
ds_read_b64_tr_b16 v[232:233], v9 offset:0
ds_read_b64_tr_b16 v[234:235], v9 offset:512
ds_read_b64_tr_b16 v[236:237], v9 offset:2048
ds_read_b64_tr_b16 v[238:239], v9 offset:2560
ds_read_b64_tr_b16 v[216:217], v9 offset:8192
ds_read_b64_tr_b16 v[218:219], v9 offset:8704
ds_read_b64_tr_b16 v[220:221], v9 offset:10240
ds_read_b64_tr_b16 v[222:223], v9 offset:10752
v_xor_b32 v12, v15, v9
ds_read_b64_tr_b16 v[200:201], v12 offset:16384
ds_read_b64_tr_b16 v[202:203], v12 offset:16896
ds_read_b64_tr_b16 v[204:205], v12 offset:18432
ds_read_b64_tr_b16 v[206:207], v12 offset:18944
ds_read_b64_tr_b16 v[40:41], v9 offset:24576
ds_read_b64_tr_b16 v[42:43], v9 offset:25088
ds_read_b64_tr_b16 v[44:45], v9 offset:26624
ds_read_b64_tr_b16 v[46:47], v9 offset:27136
s_waitcnt lgkmcnt(0)
buffer_store_dwordx4 v[40:43], v0, s[4:7], s62 offen offset:2048
buffer_store_dwordx4 v[44:47], v0, s[4:7], s62 offen offset:3072
s_waitcnt vmcnt(38)
s_barrier
s_mov_b32 m0, 133120
s_add_u32 s48, s50, 31744
buffer_load_dwordx4 v11, s[20:23], s48 offen lds
s_mov_b32 m0, 134144
s_add_u32 s48, s50, 36864
buffer_load_dwordx4 v11, s[20:23], s48 offen lds
s_mov_b32 m0, 141312
s_add_u32 s48, s50, 52224
buffer_load_dwordx4 v11, s[20:23], s48 offen lds
s_mov_b32 m0, 142336
s_add_u32 s48, s50, 57344
buffer_load_dwordx4 v11, s[20:23], s48 offen lds
s_mov_b32 m0, 149504
s_add_u32 s48, s50, 72704
buffer_load_dwordx4 v11, s[20:23], s48 offen lds
s_mov_b32 m0, 150528
s_add_u32 s48, s50, 77824
buffer_load_dwordx4 v11, s[20:23], s48 offen lds
s_mov_b32 m0, 157696
s_add_u32 s48, s49, 3276800
buffer_load_dwordx4 v10, s[8:11], s48 offen lds
s_mov_b32 m0, 158720
s_add_u32 s48, s49, 3342336
buffer_load_dwordx4 v10, s[8:11], s48 offen lds
ds_read_b64_tr_b16 v[208:209], v7 offset:0
ds_read_b64_tr_b16 v[210:211], v7 offset:512
ds_read_b64_tr_b16 v[212:213], v7 offset:2048
ds_read_b64_tr_b16 v[214:215], v7 offset:2560
s_waitcnt lgkmcnt(0)
s_waitcnt vmcnt(32)
s_barrier
ds_read_b64_tr_b16 v[16:17], v4 offset:8192
ds_read_b64_tr_b16 v[18:19], v4 offset:9216
ds_read_b64_tr_b16 v[20:21], v4 offset:12288
ds_read_b64_tr_b16 v[22:23], v4 offset:13312
ds_read_b64_tr_b16 v[24:25], v4 offset:16384
ds_read_b64_tr_b16 v[26:27], v4 offset:17408
ds_read_b64_tr_b16 v[28:29], v4 offset:20480
ds_read_b64_tr_b16 v[30:31], v4 offset:21504
ds_read_b64_tr_b16 v[32:33], v4 offset:24576
ds_read_b64_tr_b16 v[34:35], v4 offset:25600
ds_read_b64_tr_b16 v[36:37], v4 offset:28672
ds_read_b64_tr_b16 v[38:39], v4 offset:29696
ds_read_b64_tr_b16 v[40:41], v4 offset:32768
ds_read_b64_tr_b16 v[42:43], v4 offset:33792
ds_read_b64_tr_b16 v[44:45], v4 offset:36864
ds_read_b64_tr_b16 v[46:47], v4 offset:37888
ds_read_b64_tr_b16 v[48:49], v4 offset:40960
ds_read_b64_tr_b16 v[50:51], v4 offset:41984
ds_read_b64_tr_b16 v[52:53], v4 offset:45056
ds_read_b64_tr_b16 v[54:55], v4 offset:46080
ds_read_b64_tr_b16 v[56:57], v4 offset:49152
ds_read_b64_tr_b16 v[58:59], v4 offset:50176
ds_read_b64_tr_b16 v[60:61], v4 offset:53248
ds_read_b64_tr_b16 v[62:63], v4 offset:54272
ds_read_b64_tr_b16 v[64:65], v4 offset:57344
ds_read_b64_tr_b16 v[66:67], v4 offset:58368
ds_read_b64_tr_b16 v[68:69], v4 offset:61440
ds_read_b64_tr_b16 v[70:71], v4 offset:62464
s_waitcnt lgkmcnt(0)
s_barrier
ds_write_b128 v0, v[16:19] offset:22528
ds_write_b128 v0, v[20:23] offset:23552
ds_write_b128 v0, v[24:27] offset:24576
ds_write_b128 v0, v[28:31] offset:25600
ds_write_b128 v0, v[32:35] offset:26624
ds_write_b128 v0, v[36:39] offset:27648
ds_write_b128 v0, v[40:43] offset:28672
ds_write_b128 v0, v[44:47] offset:29696
ds_write_b128 v0, v[48:51] offset:30720
ds_write_b128 v0, v[52:55] offset:31744
ds_write_b128 v0, v[56:59] offset:32768
ds_write_b128 v0, v[60:63] offset:33792
ds_write_b128 v0, a[176:179] offset:34816
ds_write_b128 v0, a[180:183] offset:35840
s_waitcnt lgkmcnt(0)
v_accvgpr_write_b32 a176, v64
v_accvgpr_write_b32 a177, v65
v_accvgpr_write_b32 a178, v66
v_accvgpr_write_b32 a179, v67
v_accvgpr_write_b32 a180, v68
v_accvgpr_write_b32 a181, v69
v_accvgpr_write_b32 a182, v70
v_accvgpr_write_b32 a183, v71
s_waitcnt vmcnt(6)
s_barrier
ds_read_b64_tr_b16 v[16:17], v8 offset:24576
ds_read_b64_tr_b16 v[18:19], v8 offset:25088
ds_read_b64_tr_b16 v[20:21], v8 offset:26624
ds_read_b64_tr_b16 v[22:23], v8 offset:27136
v_xor_b32 v12, v15, v8
ds_read_b64_tr_b16 v[24:25], v12 offset:32768
ds_read_b64_tr_b16 v[26:27], v12 offset:33280
ds_read_b64_tr_b16 v[28:29], v12 offset:34816
ds_read_b64_tr_b16 v[30:31], v12 offset:35328
ds_read_b64_tr_b16 v[32:33], v8 offset:40960
ds_read_b64_tr_b16 v[34:35], v8 offset:41472
ds_read_b64_tr_b16 v[36:37], v8 offset:43008
ds_read_b64_tr_b16 v[38:39], v8 offset:43520
ds_read_b64_tr_b16 v[40:41], v8 offset:49152
ds_read_b64_tr_b16 v[42:43], v8 offset:49664
ds_read_b64_tr_b16 v[44:45], v8 offset:51200
ds_read_b64_tr_b16 v[46:47], v8 offset:51712
ds_read_b64_tr_b16 v[48:49], v8 offset:57344
ds_read_b64_tr_b16 v[50:51], v8 offset:57856
ds_read_b64_tr_b16 v[52:53], v8 offset:59392
ds_read_b64_tr_b16 v[54:55], v8 offset:59904
v_xor_b32 v12, v15, v9
ds_read_b64_tr_b16 v[56:57], v12 offset:0
ds_read_b64_tr_b16 v[58:59], v12 offset:512
ds_read_b64_tr_b16 v[60:61], v12 offset:2048
ds_read_b64_tr_b16 v[62:63], v12 offset:2560
s_waitcnt lgkmcnt(0)
s_barrier
ds_write_b128 v2, v[232:235] offset:28672
ds_write_b128 v2, v[236:239] offset:29696
ds_write_b128 v2, v[224:227] offset:30720
ds_write_b128 v2, v[228:231] offset:31744
ds_write_b128 v2, v[32:35] offset:32768
ds_write_b128 v2, v[36:39] offset:33792
ds_write_b128 v2, v[40:43] offset:34816
ds_write_b128 v2, v[44:47] offset:35840
ds_write_b128 v2, v[248:251] offset:36864
ds_write_b128 v2, v[252:255] offset:37888
ds_write_b128 v2, v[240:243] offset:38912
ds_write_b128 v2, v[244:247] offset:39936
s_waitcnt lgkmcnt(0)
v_mov_b32 v232, v16
v_mov_b32 v233, v17
v_mov_b32 v234, v18
v_mov_b32 v235, v19
v_mov_b32 v236, v20
v_mov_b32 v237, v21
v_mov_b32 v238, v22
v_mov_b32 v239, v23
v_mov_b32 v224, v24
v_mov_b32 v225, v25
v_mov_b32 v226, v26
v_mov_b32 v227, v27
v_mov_b32 v228, v28
v_mov_b32 v229, v29
v_mov_b32 v230, v30
v_mov_b32 v231, v31
v_mov_b32 v248, v48
v_mov_b32 v249, v49
v_mov_b32 v250, v50
v_mov_b32 v251, v51
v_mov_b32 v252, v52
v_mov_b32 v253, v53
v_mov_b32 v254, v54
v_mov_b32 v255, v55
v_mov_b32 v240, v56
v_mov_b32 v241, v57
v_mov_b32 v242, v58
v_mov_b32 v243, v59
v_mov_b32 v244, v60
v_mov_b32 v245, v61
v_mov_b32 v246, v62
v_mov_b32 v247, v63
s_waitcnt vmcnt(0)
s_barrier
ds_read_b64_tr_b16 v[16:17], v5 offset:0
ds_read_b64_tr_b16 v[18:19], v5 offset:1024
ds_read_b64_tr_b16 v[20:21], v5 offset:4096
ds_read_b64_tr_b16 v[22:23], v5 offset:5120
ds_read_b64_tr_b16 v[24:25], v5 offset:8192
ds_read_b64_tr_b16 v[26:27], v5 offset:9216
ds_read_b64_tr_b16 v[28:29], v5 offset:12288
ds_read_b64_tr_b16 v[30:31], v5 offset:13312
ds_read_b64_tr_b16 v[32:33], v5 offset:16384
ds_read_b64_tr_b16 v[34:35], v5 offset:17408
ds_read_b64_tr_b16 v[36:37], v5 offset:20480
ds_read_b64_tr_b16 v[38:39], v5 offset:21504
ds_read_b64_tr_b16 v[40:41], v9 offset:8192
ds_read_b64_tr_b16 v[42:43], v9 offset:8704
ds_read_b64_tr_b16 v[44:45], v9 offset:10240
ds_read_b64_tr_b16 v[46:47], v9 offset:10752
ds_read_b64_tr_b16 v[48:49], v9 offset:16384
ds_read_b64_tr_b16 v[50:51], v9 offset:16896
ds_read_b64_tr_b16 v[52:53], v9 offset:18432
ds_read_b64_tr_b16 v[54:55], v9 offset:18944
ds_read_b64_tr_b16 v[56:57], v6 offset:24576
ds_read_b64_tr_b16 v[58:59], v6 offset:25600
ds_read_b64_tr_b16 v[60:61], v6 offset:28672
ds_read_b64_tr_b16 v[62:63], v6 offset:29696
s_waitcnt lgkmcnt(0)
s_barrier
ds_write_b128 v2, v[16:19] offset:53248
ds_write_b128 v2, v[20:23] offset:54272
ds_write_b128 v2, v[24:27] offset:55296
ds_write_b128 v2, v[28:31] offset:56320
ds_write_b128 v2, v[32:35] offset:57344
ds_write_b128 v2, v[36:39] offset:58368
ds_write_b128 v2, v[40:43] offset:59392
ds_write_b128 v2, v[44:47] offset:60416
ds_write_b128 v2, v[48:51] offset:61440
ds_write_b128 v2, v[52:55] offset:62464
ds_write_b128 v2, a[224:227] offset:63488
ds_write_b128 v2, a[228:231] offset:64512
s_waitcnt lgkmcnt(0)
v_accvgpr_write_b32 a224, v56
v_accvgpr_write_b32 a225, v57
v_accvgpr_write_b32 a226, v58
v_accvgpr_write_b32 a227, v59
v_accvgpr_write_b32 a228, v60
v_accvgpr_write_b32 a229, v61
v_accvgpr_write_b32 a230, v62
v_accvgpr_write_b32 a231, v63
s_mov_b32 s90, 0x300003
s_mov_b32 s91, 0x300003
s_mov_b32 s12, 0x3030303
s_mov_b32 s13, 0x3030303
s_mov_b32 s92, 0xc0000c
s_mov_b32 s93, 0xc0000c
s_mov_b32 s14, 0xc0c0c0c
s_mov_b32 s15, 0xc0c0c0c
s_mov_b32 s94, 0x30000300
s_mov_b32 s95, 0x30000300
s_mov_b32 s16, 0x30303030
s_mov_b32 s17, 0x30303030
s_mov_b32 s96, 0xc0000c00
s_mov_b32 s97, 0xc0000c00
s_mov_b32 s18, 0xc0c0c0c0
s_mov_b32 s19, 0xc0c0c0c0
s_mov_b32 s98, 0xff00ff00
s_mov_b32 s99, 0xff00ff00
v_mov_b32 v1, 0x4444
v_mov_b32 v4, 0xeeee
v_cndmask_b32 v1, v1, v4, s[98:99]
v_lshrrev_b32 v4, 8, v0
v_lshl_or_b32 v1, v4, 28, v1
v_bfe_u32 v4, v0, 4, 4
v_lshl_or_b32 v1, v4, 19, v1
s_mov_b32 s51, 0x3e0293ee
s_mov_b32 s52, 0x3f803f80
s_mov_b32 s53, 0x3f803f80
s_mov_b32 s54, 0x3f003f00
s_mov_b32 s55, 0x3f003f00
s_mov_b32 s56, 0xff800000
s_mov_b32 s57, 0xff800000
s_mov_b32 s58, 0x3f80
s_mov_b32 s8, s4
s_mov_b32 s9, s5
s_cmp_eq_u32 s30, 29
s_cselect_b32 s10, s6, 0
s_mov_b32 s31, 0
s_mov_b32 s45, -2
s_lshl_b32 s46, s30, 6
s_add_u32 s46, s46, 222330880
s_lshl_b32 s48, s30, 7
s_and_b32 s49, s30, 31
s_lshl_b32 s49, s49, 12
s_add_u32 s43, s49, 119603200
v_mov_b64 v[12:13], -1
s_add_u32 s38, s48, 119554048
s_add_u32 s39, s48, 119619584
s_add_u32 s40, s48, 119685120
s_add_u32 s41, s48, 119750656
s_add_u32 s42, s48, 119816192
v_lshrrev_b32 v4, 16, v1
buffer_store_dwordx2 v[12:13], v4, s[4:7], s38 offen
buffer_store_dwordx2 v[12:13], v4, s[4:7], s39 offen
buffer_store_dwordx2 v[12:13], v4, s[4:7], s40 offen
buffer_store_dwordx2 v[12:13], v4, s[4:7], s41 offen
buffer_store_dwordx2 v[12:13], v4, s[4:7], s42 offen
s_cmp_lg_u32 s3, 0
s_cbranch_scc1 k_wdd_138
v_mov_b32 v8, 192
k_wd_137:
global_load_dword v9, v8, s[28:29] sc1
s_waitcnt vmcnt(0)
v_readfirstlane_b32 s48, v9
s_cmp_ge_u32 s48, 32
s_cbranch_scc1 k_wdd_138
s_sleep 2
s_sub_u32 s32, s32, 1
s_cmp_gt_i32 s32, 0
s_cbranch_scc1 k_wd_137
k_wdd_138:
s_barrier
k_lay_139:
s_add_u32 s47, s31, 63
s_mov_b32 s33, 120324096
s_mov_b32 s34, 120327168
s_mov_b32 s35, 120331264
s_mul_i32 s48, s31, 655360
s_lshl_b32 s36, s30, 14
s_add_u32 s36, s36, s48
s_add_u32 s36, s36, 4096
v_mov_b32 v12, -1
s_and_b32 s48, s30, 31
s_add_u32 s48, s48, 16
s_lshr_b32 s49, s48, 1
s_and_b32 s48, s48, 1
s_lshl_b32 s44, s49, 8
s_lshl_b32 s50, s48, 6
s_add_u32 s44, s44, s50
s_add_u32 s44, s44, s33
s_mul_i32 s48, s48, 5120
s_lshl_b32 s49, s49, 5
s_add_u32 s48, s48, s49
v_lshrrev_b32 v8, 4, v0
v_and_b32 v9, 3, v8
v_mul_u32_u24 v9, 1280, v9
v_bfe_u32 v10, v8, 2, 1
v_lshl_add_u32 v9, v10, 1, v9
v_bfe_u32 v10, v8, 4, 1
v_lshl_add_u32 v9, v10, 4, v9
v_bfe_u32 v10, v8, 5, 1
v_lshl_add_u32 v9, v10, 2, v9
buffer_load_ushort v10, v9, s[24:27], s48 offen
buffer_load_ushort v11, v9, s[24:27], s48 offen offset:8
v_and_b32 v45, 0x30, v0
v_lshrrev_b32 v46, 8, v0
v_lshl_or_b32 v45, v46, 2, v45
v_bfe_u32 v46, v0, 6, 1
v_lshl_or_b32 v45, v46, 7, v45
v_cndmask_b32 v45, v45, 2.0, s[98:99]
s_waitcnt vmcnt(0)
v_lshl_or_b32 v10, v11, 16, v10
s_lshl_b32 s63, s30, 10
s_add_u32 s63, s63, 120356864
s_lshl_b32 s37, s31, 14
s_add_u32 s37, s37, 117441536
s_add_u32 s59, s37, 4096
s_waitcnt vmcnt(0)
s_barrier
s_barrier
buffer_store_dword v10, v45, s[4:7], s44 offen
s_add_u32 s44, s44, 16384
buffer_store_dword v12, v45, s[4:7], s44 offen
s_waitcnt vmcnt(0)
s_barrier
s_barrier
v_lshlrev_b32 v23, v0, s58
v_cndmask_b32 v20, 0, v23, s[90:91]
v_cndmask_b32 v21, 0, v23, s[92:93]
v_cndmask_b32 v22, 0, v23, s[94:95]
v_cndmask_b32 v23, 0, v23, s[96:97]
s_branch k_cold2_142
k_T0_140:
s_waitcnt vmcnt(2)
v_smfmac_f32_16x16x64_bf16 v[40:43], v[4:7], v[48:55], v1
s_waitcnt vmcnt(1)
v_cmp_u_f32 vcc, v4, v8
v_smfmac_f32_16x16x64_bf16 v[24:27], v[8:11], a[24:31], v1
v_smfmac_f32_16x16x64_bf16 v[28:31], v[8:11], a[32:39], v1
s_cbranch_vccnz k_cold_141
k_okC_143:
s_waitcnt vmcnt(1)
v_smfmac_f32_16x16x64_bf16 v[36:39], v[8:11], a[40:47], v1
s_waitcnt lgkmcnt(0)
ds_read_b128 v[48:51], v0 offset:34816
v_smfmac_f32_16x16x64_bf16 v[32:35], v[4:7], v[64:71], v1
ds_read_b128 v[52:55], v0 offset:35840
ds_read_b128 v[64:67], v0 offset:22528
v_smfmac_f32_16x16x64_bf16 v[44:47], v[4:7], v[56:63], v1
ds_read_b128 v[68:71], v0 offset:23552
v_smfmac_f32_16x16x64_bf16 v[28:31], v[4:7], a[8:15], v1
v_smfmac_f32_16x16x64_bf16 v[24:27], v[4:7], a[0:7], v1
ds_read_b128 v[56:59], v2 offset:30720
v_smfmac_f32_16x16x64_bf16 v[36:39], v[4:7], a[16:23], v1
ds_read_b128 v[60:63], v2 offset:31744
s_waitcnt lgkmcnt(4)
v_smfmac_f32_16x16x64_bf16 v[40:43], v[8:11], v[48:55], v1
s_waitcnt vmcnt(0)
ds_write_b128 v0, v[12:15] offset:1024
s_waitcnt lgkmcnt(3)
v_smfmac_f32_16x16x64_bf16 v[32:35], v[8:11], v[64:71], v1
buffer_load_dwordx4 v[16:19], v0, s[4:7], s35 offen offset:0 sc1
v_cmp_u_f32 vcc, v12, v12
s_waitcnt lgkmcnt(1)
v_smfmac_f32_16x16x64_bf16 v[44:47], v[8:11], v[56:63], v1
ds_read_b128 v[56:59], v2 offset:53248
ds_read_b128 v[60:63], v2 offset:54272
ds_read_b128 v[64:67], v0 offset:28672
s_cbranch_vccnz k_coldA_144
k_okA_145:
v_smfmac_f32_16x16x64_bf16 v[36:39], v[12:15], a[64:71], v1
ds_read_b128 v[68:71], v0 offset:29696
s_waitcnt lgkmcnt(4)
v_smfmac_f32_16x16x64_bf16 v[40:43], v[12:15], a[72:79], v1
s_barrier
v_smfmac_f32_16x16x64_bf16 v[28:31], v[12:15], a[56:63], v1
ds_read_b128 v[8:11], v0 offset:2048
buffer_load_dwordx4 v[48:51], v0, s[4:7], s36 offen offset:0 sc1
s_waitcnt lgkmcnt(3)
v_smfmac_f32_16x16x64_bf16 v[44:47], v[12:15], v[56:63], v1
ds_read_b128 v[56:59], v2 offset:55296
v_smfmac_f32_16x16x64_bf16 v[24:27], v[12:15], a[48:55], v1
ds_read_b128 v[60:63], v2 offset:56320
s_waitcnt lgkmcnt(3)
v_smfmac_f32_16x16x64_bf16 v[32:35], v[12:15], v[64:71], v1
buffer_load_dwordx4 v[52:55], v0, s[4:7], s36 offen offset:1024 sc1
s_waitcnt lgkmcnt(2)
v_smfmac_f32_16x16x64_bf16 v[24:27], v[8:11], a[80:87], v1
ds_read_b128 v[64:67], v0 offset:30720
ds_read_b128 v[68:71], v0 offset:31744
v_smfmac_f32_16x16x64_bf16 v[36:39], v[8:11], a[96:103], v1
buffer_store_dwordx4 v[4:7], v0, s[8:11], s37 offen offset:0 sc1
s_waitcnt lgkmcnt(2)
s_nop 0
ds_read_b128 v[4:7], v0 offset:3072
v_smfmac_f32_16x16x64_bf16 v[44:47], v[8:11], v[56:63], v1
ds_read_b128 v[56:59], v2 offset:57344
ds_read_b128 v[60:63], v2 offset:58368
v_smfmac_f32_16x16x64_bf16 v[28:31], v[8:11], a[88:95], v1
buffer_store_dwordx4 v[12:15], v0, s[8:11], s37 offen offset:2048 sc1
v_smfmac_f32_16x16x64_bf16 v[40:43], v[8:11], a[104:111], v1
s_waitcnt lgkmcnt(3)
s_waitcnt lgkmcnt(2)
v_smfmac_f32_16x16x64_bf16 v[32:35], v[8:11], v[64:71], v1
ds_read_b128 v[64:67], v0 offset:32768
ds_read_b128 v[12:15], v0 offset:0
v_smfmac_f32_16x16x64_bf16 v[36:39], v[4:7], a[128:135], v1
s_waitcnt lgkmcnt(2)
v_smfmac_f32_16x16x64_bf16 v[44:47], v[4:7], v[56:63], v1
ds_read_b128 v[68:71], v0 offset:33792
buffer_load_dwordx4 v[56:59], v0, s[4:7], s36 offen offset:2048 sc1
v_smfmac_f32_16x16x64_bf16 v[28:31], v[4:7], a[120:127], v1
v_smfmac_f32_16x16x64_bf16 v[24:27], v[4:7], a[112:119], v1
s_waitcnt vmcnt(5)
ds_write_b128 v0, v[16:19] offset:5120
v_smfmac_f32_16x16x64_bf16 v[40:43], v[4:7], a[136:143], v1
s_waitcnt lgkmcnt(1)
buffer_load_dwordx4 v[60:63], v0, s[4:7], s36 offen offset:3072 sc1
v_cmp_u_f32 vcc, v16, v16
v_smfmac_f32_16x16x64_bf16 v[32:35], v[4:7], v[64:71], v1
ds_read_b128 v[64:67], v0 offset:26624
ds_read_b128 v[68:71], v0 offset:27648
v_smfmac_f32_16x16x64_bf16 v[28:31], v[12:15], a[152:159], v1
v_smfmac_f32_16x16x64_bf16 v[24:27], v[12:15], a[144:151], v1
s_cbranch_vccnz k_coldB_146
k_okB_147:
v_smfmac_f32_16x16x64_bf16 v[36:39], v[12:15], a[160:167], v1
s_waitcnt lgkmcnt(2)
buffer_store_dwordx4 v[16:19], v0, s[8:11], s59 offen offset:2048 sc1
s_barrier
ds_read_b128 v[4:7], v0 offset:7168
v_smfmac_f32_16x16x64_bf16 v[44:47], v[12:15], a[176:183], v1
ds_read_b128 v[8:11], v0 offset:6144
s_waitcnt lgkmcnt(2)
v_smfmac_f32_16x16x64_bf16 v[32:35], v[12:15], v[64:71], v1
ds_read_b128 v[64:67], v2 offset:36864
ds_read_b128 v[68:71], v2 offset:37888
v_smfmac_f32_16x16x64_bf16 v[24:27], v[16:19], a[184:191], v1
v_smfmac_f32_16x16x64_bf16 v[40:43], v[12:15], a[168:175], v1
s_waitcnt lgkmcnt(3)
ds_read_b128 v[12:15], v0 offset:4096
v_smfmac_f32_16x16x64_bf16 v[24:27], v[4:7], a[208:215], v1
s_waitcnt lgkmcnt(3)
v_smfmac_f32_16x16x64_bf16 v[28:31], v[4:7], a[216:223], v1
v_smfmac_f32_16x16x64_bf16 v[28:31], v[8:11], a[200:207], v1
s_waitcnt lgkmcnt(1)
v_smfmac_f32_16x16x64_bf16 v[24:27], v[8:11], v[64:71], v1
ds_read_b128 v[64:67], v2 offset:38912
s_waitcnt lgkmcnt(1)
v_smfmac_f32_16x16x64_bf16 v[24:27], v[12:15], a[224:231], v1
ds_read_b128 v[68:71], v2 offset:39936
v_smfmac_f32_16x16x64_bf16 v[28:31], v[12:15], a[232:239], v1
v_smfmac_f32_16x16x64_bf16 v[28:31], v[16:19], a[192:199], v1
v_cvt_pk_bf16_f32 v24, v24, v25
v_cvt_pk_bf16_f32 v25, v26, v27
v_smfmac_f32_16x16x64_bf16 v[32:35], v[4:7], v[80:87], v1
v_cvt_pk_bf16_f32 v26, v28, v29
v_cvt_pk_bf16_f32 v27, v30, v31
v_smfmac_f32_16x16x64_bf16 v[32:35], v[8:11], a[248:255], v1
s_waitcnt lgkmcnt(0)
v_mfma_f32_16x16x32_bf16 v[28:31], v[24:27], v[20:23], 0
v_and_b32 v26, 0xffffff7f, v0
v_smfmac_f32_16x16x64_bf16 v[32:35], v[16:19], v[64:71], v1
v_and_or_b32 v26, v1, 8, v26
v_mul_f32 v28, s51, v28
v_mul_f32 v29, s51, v29
v_mul_f32 v31, s51, v31
v_cvt_pk_bf16_f32 v24, v28, v29
v_mul_f32 v30, s51, v30
v_cvt_pk_bf16_f32 v25, v30, v31
v_smfmac_f32_16x16x64_bf16 v[32:35], v[12:15], v[96:103], v1
ds_write_b64 v26, v[24:25] offset:128
v_smfmac_f32_16x16x64_bf16 v[36:39], v[8:11], v[72:79], v1
v_cvt_pk_bf16_f32 v32, v32, v33
v_smfmac_f32_16x16x64_bf16 v[36:39], v[16:19], a[240:247], v1
buffer_load_dwordx4 v[64:67], v0, s[4:7], s61 offen offset:0
v_cvt_pk_bf16_f32 v33, v34, v35
v_smfmac_f32_16x16x64_bf16 v[36:39], v[12:15], v[104:111], v1
s_waitcnt lgkmcnt(0)
v_smfmac_f32_16x16x64_bf16 v[36:39], v[4:7], v[88:95], v1
s_barrier
ds_read_b128 v[24:27], v0 offset:0
v_smfmac_f32_16x16x64_bf16 v[40:43], v[4:7], v[144:151], v1
ds_read_b128 v[28:31], v0 offset:1024
s_nop 0
v_cvt_pk_bf16_f32 v34, v36, v37
v_cvt_pk_bf16_f32 v35, v38, v39
s_nop 1
v_mfma_f32_16x16x32_bf16 v[36:39], v[32:35], v[20:23], 0
s_waitcnt vmcnt(6)
buffer_load_dwordx4 v[68:71], v0, s[4:7], s61 offen offset:1024
v_and_b32 v34, 0xffffff7f, v0
v_and_or_b32 v34, v1, 8, v34
s_waitcnt lgkmcnt(1)
v_mfma_f32_16x16x32_bf16 v[48:51], v[48:51], v[24:27], 0
v_cvt_pk_bf16_f32 v32, v36, v37
s_waitcnt lgkmcnt(0)
v_mfma_f32_16x16x32_bf16 v[48:51], v[52:55], v[28:31], v[48:51]
v_mov_b64 v[52:53], s[56:57]
v_cvt_pk_bf16_f32 v33, v38, v39
v_smfmac_f32_16x16x64_bf16 v[44:47], v[4:7], v[152:159], v1
ds_write_b64 v34, v[32:33] offset:2176
v_permlane32_swap_b32 v48, v50
v_permlane32_swap_b32 v49, v51
v_add_f32_dpp v52, v50, v48 row_ror:8 row_mask:0xf bank_mask:0x3
v_exp_f32 v52, v52
v_add_f32_dpp v53, v51, v49 row_ror:8 row_mask:0xf bank_mask:0x3
v_exp_f32 v53, v53
s_nop 0
v_cvt_pk_bf16_f32 v48, v52, v53
v_smfmac_f32_16x16x64_bf16 v[44:47], v[16:19], v[120:127], v1
ds_write_b32 v0, v48 offset:4100
v_smfmac_f32_16x16x64_bf16 v[44:47], v[12:15], v[168:175], v1
buffer_load_dwordx4 v[48:51], v0, s[4:7], s61 offen offset:2048
v_smfmac_f32_16x16x64_bf16 v[40:43], v[12:15], v[160:167], v1
s_waitcnt lgkmcnt(1)
v_xor_b32 v12, 0x80, v0
v_smfmac_f32_16x16x64_bf16 v[40:43], v[8:11], v[128:135], v1
s_waitcnt lgkmcnt(0)
s_barrier
ds_read_b128 v[32:35], v0 offset:2048
v_mov_b64 v[22:23], s[52:53]
v_smfmac_f32_16x16x64_bf16 v[40:43], v[16:19], v[112:119], v1
ds_read_b128 v[36:39], v0 offset:3072
ds_read_b128 v[16:19], v0 offset:4096
buffer_load_dwordx4 v[52:55], v0, s[4:7], s61 offen offset:3072
v_smfmac_f32_16x16x64_bf16 v[44:47], v[8:11], v[136:143], v1
ds_read_b128 v[12:15], v12 offset:4096
v_cvt_pk_bf16_f32 v40, v40, v41
v_mov_b64 v[20:21], s[52:53]
s_waitcnt lgkmcnt(3)
v_mfma_f32_16x16x32_bf16 v[24:27], v[32:35], v[24:27], 0
v_cvt_pk_bf16_f32 v41, v42, v43
s_waitcnt lgkmcnt(2)
v_mfma_f32_16x16x32_bf16 v[24:27], v[36:39], v[28:31], v[24:27]
s_waitcnt vmcnt(5)
s_waitcnt lgkmcnt(1)
v_mfma_f32_16x16x32_bf16 v[8:11], v[56:59], v[16:19], 0
buffer_load_dwordx4 v[56:59], v0, s[4:7], s62 offen offset:0
v_mov_b64 v[28:29], s[56:57]
v_cvt_pk_bf16_f32 v43, v46, v47
v_cvt_pk_bf16_f32 v42, v44, v45
v_permlane32_swap_b32 v25, v27
v_permlane32_swap_b32 v24, v26
v_mfma_f32_16x16x32_bf16 v[4:7], v[20:23], v[16:19], 0
s_waitcnt lgkmcnt(0)
v_add_f32_dpp v28, v26, v24 row_ror:8 row_mask:0xf bank_mask:0x3
v_add_f32_dpp v29, v27, v25 row_ror:8 row_mask:0xf bank_mask:0x3
v_exp_f32 v28, v28
v_mfma_f32_16x16x32_bf16 v[8:11], v[60:63], v[12:15], v[8:11]
buffer_load_dwordx4 v[60:63], v0, s[4:7], s62 offen offset:1024
v_exp_f32 v29, v29
v_permlane32_swap_b32 v42, v43
v_cvt_pk_bf16_f32 v24, v28, v29
v_mov_b64 v[44:45], s[54:55]
v_cvt_pk_bf16_f32 v25, v28, v29
v_mov_b32_dpp v26, v24 row_ror:8 row_mask:0xf bank_mask:0xf
v_mov_b32_dpp v27, v24 row_ror:8 row_mask:0xf bank_mask:0xf
v_mfma_f32_16x16x16_bf16 v[4:7], v[44:45], v[24:25], v[4:7]
v_permlane32_swap_b32 v40, v41
v_mov_b64 v[36:37], 0
v_mov_b64 v[38:39], 0
v_mov_b64 v[30:31], 0
v_mfma_f32_16x16x32_bf16 v[8:11], v[40:43], v[24:27], v[8:11]
buffer_load_dwordx4 v[16:19], v0, s[4:7], s62 offen offset:2048
v_rcp_f32 v6, v4
v_and_b32 v12, 0xffffff7f, v0
v_and_or_b32 v13, v1, 8, v12
v_rcp_f32_dpp v6, v4 row_ror:8 row_mask:0xf bank_mask:0xc
v_mov_b64 v[26:27], 0
v_pk_mul_f32 v[8:9], v[8:9], v[6:7] op_sel_hi:[1,0]
v_cvt_pk_bf16_f32 v44, v8, v9
v_pk_mul_f32 v[10:11], v[10:11], v[6:7] op_sel_hi:[1,0]
v_cvt_pk_bf16_f32 v45, v10, v11
s_waitcnt vmcnt(5)
ds_write_b64 v13, v[44:45] offset:6272
buffer_load_dwordx4 v[20:23], v0, s[4:7], s62 offen offset:3072
v_add_u32 v6, 0xd4800000, v6
v_cmp_lt_u32 vcc, 0x28000000, v6
v_mov_b64 v[34:35], 0
v_mov_b32_dpp v46, v44 row_ror:8 row_mask:0xf bank_mask:0xf
v_mov_b32_dpp v47, v45 row_ror:8 row_mask:0xf bank_mask:0xf
v_mov_b64 v[28:29], 0
v_mov_b64 v[32:33], 0
s_cbranch_vccnz k_slow_148
k_okS_149:
v_smfmac_f32_16x16x64_bf16 v[36:39], v[44:47], v[224:231], v1
s_waitcnt lgkmcnt(0)
s_barrier
ds_read_b128 v[8:11], v12 offset:7296
v_smfmac_f32_16x16x64_bf16 v[32:35], v[44:47], v[200:207], v1
s_waitcnt vmcnt(4)
ds_read_b128 v[4:7], v12 offset:7168
v_mov_b64 v[24:25], 0
v_smfmac_f32_16x16x64_bf16 v[28:31], v[44:47], v[48:55], v1
ds_read_b128 v[12:15], v12 offset:6144
ds_read_b128 v[48:51], v2 offset:28672
v_smfmac_f32_16x16x64_bf16 v[24:27], v[44:47], v[64:71], v1
ds_read_b128 v[52:55], v2 offset:29696
v_mov_b64 v[42:43], 0
s_waitcnt lgkmcnt(4)
v_smfmac_f32_16x16x64_bf16 v[24:27], v[8:11], v[184:191], v1
s_waitcnt lgkmcnt(3)
v_mov_b64 v[40:41], 0
v_smfmac_f32_16x16x64_bf16 v[24:27], v[4:7], v[176:183], v1
s_waitcnt lgkmcnt(2)
ds_read_b128 v[64:67], v2 offset:63488
v_smfmac_f32_16x16x64_bf16 v[24:27], v[12:15], v[192:199], v1
ds_read_b128 v[68:71], v2 offset:64512
v_smfmac_f32_16x16x64_bf16 v[40:43], v[44:47], v[240:247], v1
s_waitcnt vmcnt(2)
s_waitcnt lgkmcnt(2)
v_lshrrev_b32 v44, 16, v1
v_cvt_pk_bf16_f32 v24, v24, v25
v_bfi_b32 v24, 1, s45, v24
v_cvt_pk_bf16_f32 v25, v26, v27
v_smfmac_f32_16x16x64_bf16 v[28:31], v[8:11], v[48:55], v1
buffer_store_dwordx2 v[24:25], v44, s[4:7], s38 offen
ds_read_b128 v[48:51], v2 offset:34816
ds_read_b128 v[52:55], v2 offset:35840
v_smfmac_f32_16x16x64_bf16 v[28:31], v[12:15], v[56:63], v1
s_waitcnt lgkmcnt(2)
ds_read_b128 v[56:59], v2 offset:59392
v_smfmac_f32_16x16x64_bf16 v[28:31], v[4:7], v[64:71], v1
ds_read_b128 v[60:63], v2 offset:60416
v_smfmac_f32_16x16x64_bf16 v[32:35], v[8:11], v[208:215], v1
ds_read_b128 v[64:67], v2 offset:32768
s_nop 0
v_cvt_pk_bf16_f32 v28, v28, v29
v_bfi_b32 v28, 1, s45, v28
v_cvt_pk_bf16_f32 v29, v30, v31
v_smfmac_f32_16x16x64_bf16 v[32:35], v[12:15], v[216:223], v1
buffer_store_dwordx2 v[28:29], v44, s[4:7], s39 offen
v_smfmac_f32_16x16x64_bf16 v[40:43], v[12:15], v[248:255], v1
ds_read_b128 v[68:71], v2 offset:33792
s_waitcnt vmcnt(2)
v_smfmac_f32_16x16x64_bf16 v[32:35], v[4:7], v[16:23], v1
s_waitcnt lgkmcnt(2)
v_smfmac_f32_16x16x64_bf16 v[36:39], v[12:15], v[232:239], v1
ds_read_b128 v[16:19], v2 offset:61440
ds_read_b128 v[20:23], v2 offset:62464
v_cvt_pk_bf16_f32 v32, v32, v33
v_bfi_b32 v32, 1, s45, v32
v_cvt_pk_bf16_f32 v33, v34, v35
v_smfmac_f32_16x16x64_bf16 v[36:39], v[8:11], v[48:55], v1
buffer_store_dwordx2 v[32:33], v44, s[4:7], s40 offen
s_waitcnt lgkmcnt(2)
v_smfmac_f32_16x16x64_bf16 v[36:39], v[4:7], v[64:71], v1
s_nop 6
v_cvt_pk_bf16_f32 v36, v36, v37
v_cvt_pk_bf16_f32 v37, v38, v39
s_waitcnt lgkmcnt(0)
v_bfi_b32 v36, 1, s45, v36
v_smfmac_f32_16x16x64_bf16 v[40:43], v[8:11], v[16:23], v1
buffer_store_dwordx2 v[36:37], v44, s[4:7], s41 offen
v_smfmac_f32_16x16x64_bf16 v[40:43], v[4:7], v[56:63], v1
s_nop 6
v_cvt_pk_bf16_f32 v40, v40, v41
v_bfi_b32 v40, 1, s45, v40
v_cvt_pk_bf16_f32 v41, v42, v43
buffer_store_dwordx2 v[40:41], v44, s[4:7], s42 offen
s_barrier
buffer_load_dwordx4 v[24:27], v0, s[4:7], s43 offen offset:0 sc1
buffer_load_dwordx4 v[28:31], v0, s[4:7], s43 offen offset:1024 sc1
buffer_load_dwordx4 v[32:35], v0, s[4:7], s43 offen offset:2048 sc1
buffer_load_dwordx4 v[36:39], v0, s[4:7], s43 offen offset:3072 sc1
buffer_load_dwordx4 v[48:51], v0, s[4:7], s60 offen offset:0
buffer_load_dwordx4 v[52:55], v0, s[4:7], s60 offen offset:1024
buffer_load_dwordx4 v[56:59], v0, s[4:7], s60 offen offset:2048
buffer_load_dwordx4 v[60:63], v0, s[4:7], s60 offen offset:3072
v_lshlrev_b32 v23, v0, s58
v_cndmask_b32 v16, 0, v23, s[12:13]
v_cndmask_b32 v17, 0, v23, s[14:15]
v_cndmask_b32 v18, 0, v23, s[16:17]
v_cndmask_b32 v19, 0, v23, s[18:19]
v_and_b32 v45, 0x30, v0
v_lshrrev_b32 v46, 8, v0
v_lshl_or_b32 v45, v46, 2, v45
v_bfe_u32 v46, v0, 6, 1
v_lshl_or_b32 v45, v46, 7, v45
v_cndmask_b32 v45, v45, 2.0, s[98:99]
v_cndmask_b32 v20, 0, v23, s[90:91]
v_cndmask_b32 v21, 0, v23, s[92:93]
v_cndmask_b32 v22, 0, v23, s[94:95]
v_cndmask_b32 v23, 0, v23, s[96:97]
s_add_u32 s33, s33, 16384
s_bitset0_b32 s33, 16
s_waitcnt vmcnt(7)
v_mfma_f32_16x16x32_bf16 v[40:43], v[24:27], v[16:19], 0
s_waitcnt vmcnt(6)
v_mfma_f32_16x16x32_bf16 v[40:43], v[28:31], v[16:19], v[40:43]
v_bitop3_b32 v46, v24, v28, s45 bitop3:0x7e
s_waitcnt vmcnt(5)
v_mfma_f32_16x16x32_bf16 v[40:43], v[32:35], v[16:19], v[40:43]
s_waitcnt vmcnt(4)
v_mfma_f32_16x16x32_bf16 v[40:43], v[36:39], v[16:19], v[40:43]
v_bitop3_b32 v47, v32, v36, s45 bitop3:0x7e
v_bitop3_b32 v46, v46, v47, 1 bitop3:0xa8
v_cmp_ne_u32 vcc, 0, v46
v_mov_b64 v[24:25], 0
v_mov_b64 v[26:27], 0
v_mov_b64 v[28:29], 0
v_mov_b64 v[30:31], 0
v_permlane32_swap_b32 v40, v41
v_permlane32_swap_b32 v42, v43
v_add_f32 v40, v40, v41
v_add_f32 v41, v42, v43
v_cvt_pk_bf16_f32 v42, v40, v41
s_cbranch_vccnz k_r1_151
k_ok1_152:
buffer_store_dword v42, v45, s[4:7], s44 offen
s_barrier
buffer_load_dwordx4 v[4:7], v0, s[4:7], s33 offen offset:1024 sc1
buffer_load_dwordx4 v[8:11], v0, s[4:7], s33 offen offset:0 sc1
s_add_u32 s34, s33, 3072
s_add_u32 s35, s33, 7168
s_add_u32 s36, s36, 524288
s_add_u32 s37, s37, 10240
s_add_u32 s59, s59, 10240
v_mov_b64 v[32:33], 0
v_mov_b64 v[34:35], 0
v_mov_b64 v[36:37], 0
v_mov_b64 v[38:39], 0
v_mov_b64 v[40:41], 0
v_mov_b64 v[42:43], 0
v_mov_b64 v[44:45], 0
v_mov_b64 v[46:47], 0
s_add_u32 s44, s44, 16384
s_bitset0_b32 s44, 16
s_sub_u32 s45, s45, 1
s_add_u32 s31, s31, 1
ds_read_b128 v[64:67], v0 offset:24576
ds_read_b128 v[68:71], v0 offset:25600
buffer_load_dwordx4 v[12:15], v0, s[4:7], s34 offen offset:0 sc1
s_cmp_lg_u32 s31, s47
s_cbranch_scc1 k_T0_140
s_branch k_done_150
k_cold2_142:
s_barrier
buffer_load_dwordx4 v[48:51], v0, s[4:7], s60 offen offset:0
buffer_load_dwordx4 v[52:55], v0, s[4:7], s60 offen offset:1024
buffer_load_dwordx4 v[56:59], v0, s[4:7], s60 offen offset:2048
buffer_load_dwordx4 v[60:63], v0, s[4:7], s60 offen offset:3072
ds_read_b128 v[64:67], v0 offset:24576
ds_read_b128 v[68:71], v0 offset:25600
k_cold_141:
buffer_load_dwordx4 v[4:7], v0, s[4:7], s33 offen offset:1024 sc1
buffer_load_dwordx4 v[8:11], v0, s[4:7], s33 offen offset:0 sc1
buffer_load_dwordx4 v[12:15], v0, s[4:7], s34 offen offset:0 sc1
s_sub_u32 s32, s32, 1
s_cmp_gt_i32 s32, 0
s_cbranch_scc0 k_okC_143
v_mov_b64 v[24:25], 0
v_mov_b64 v[26:27], 0
v_mov_b64 v[28:29], 0
v_mov_b64 v[30:31], 0
v_mov_b64 v[32:33], 0
v_mov_b64 v[34:35], 0
v_mov_b64 v[36:37], 0
v_mov_b64 v[38:39], 0
v_mov_b64 v[40:41], 0
v_mov_b64 v[42:43], 0
v_mov_b64 v[44:45], 0
v_mov_b64 v[46:47], 0
s_branch k_T0_140
k_coldA_144:
buffer_load_dwordx4 v[12:15], v0, s[4:7], s34 offen offset:0 sc1
s_sub_u32 s32, s32, 1
s_cmp_gt_i32 s32, 0
s_waitcnt vmcnt(0)
v_cmp_u_f32 vcc, v12, v12
ds_write_b128 v0, v[12:15] offset:1024
s_waitcnt lgkmcnt(0)
s_cbranch_vccz k_okA_145
s_cbranch_scc1 k_coldA_144
s_branch k_okA_145
k_coldB_146:
buffer_load_dwordx4 v[16:19], v0, s[4:7], s35 offen offset:0 sc1
s_sub_u32 s32, s32, 1
s_cmp_gt_i32 s32, 0
s_waitcnt vmcnt(0)
v_cmp_u_f32 vcc, v16, v16
ds_write_b128 v0, v[16:19] offset:5120
s_waitcnt lgkmcnt(0)
s_cbranch_vccz k_okB_147
s_cbranch_scc1 k_coldB_146
s_branch k_okB_147
k_r1_151:
buffer_load_dwordx4 v[24:27], v0, s[4:7], s43 offen offset:0 sc1
buffer_load_dwordx4 v[28:31], v0, s[4:7], s43 offen offset:1024 sc1
buffer_load_dwordx4 v[32:35], v0, s[4:7], s43 offen offset:2048 sc1
buffer_load_dwordx4 v[36:39], v0, s[4:7], s43 offen offset:3072 sc1
s_sub_u32 s32, s32, 1
s_cmp_gt_i32 s32, 0
s_waitcnt vmcnt(3)
v_mfma_f32_16x16x32_bf16 v[40:43], v[24:27], v[16:19], 0
s_waitcnt vmcnt(2)
v_mfma_f32_16x16x32_bf16 v[40:43], v[28:31], v[16:19], v[40:43]
v_bitop3_b32 v46, v24, v28, s45 bitop3:0x7e
s_waitcnt vmcnt(1)
v_mfma_f32_16x16x32_bf16 v[40:43], v[32:35], v[16:19], v[40:43]
s_waitcnt vmcnt(0)
v_mfma_f32_16x16x32_bf16 v[40:43], v[36:39], v[16:19], v[40:43]
v_bitop3_b32 v47, v32, v36, s45 bitop3:0x7e
v_bitop3_b32 v46, v46, v47, 1 bitop3:0xa8
v_cmp_ne_u32 vcc, 0, v46
v_mov_b64 v[24:25], 0
v_mov_b64 v[26:27], 0
v_mov_b64 v[28:29], 0
v_mov_b64 v[30:31], 0
v_permlane32_swap_b32 v40, v41
v_permlane32_swap_b32 v42, v43
v_add_f32 v40, v40, v41
v_add_f32 v41, v42, v43
v_cvt_pk_bf16_f32 v42, v40, v41
s_cbranch_vccz k_ok1_152
s_cbranch_scc1 k_r1_151
s_branch k_ok1_152
k_slow_148:
ds_read_b128 v[24:27], v0 offset:0
ds_read_b128 v[28:31], v0 offset:1024
v_mov_b32 v46, 0xff7fffff
s_add_u32 s48, s36, 0xfffff000
buffer_load_dwordx4 v[32:35], v0, s[4:7], s48 offen offset:0 sc1
buffer_load_dwordx4 v[36:39], v0, s[4:7], s48 offen offset:1024 sc1
s_waitcnt vmcnt(1) lgkmcnt(1)
v_mfma_f32_16x16x32_bf16 v[4:7], v[32:35], v[24:27], 0
s_waitcnt vmcnt(0) lgkmcnt(0)
v_mfma_f32_16x16x32_bf16 v[4:7], v[36:39], v[28:31], v[4:7]
v_mov_b64 v[8:9], s[56:57]
s_nop 5
v_permlane32_swap_b32 v4, v6
v_permlane32_swap_b32 v5, v7
v_add_f32_dpp v8, v6, v4 row_ror:8 row_mask:0xf bank_mask:0x3
s_nop 0
v_add_f32_dpp v9, v7, v5 row_ror:8 row_mask:0xf bank_mask:0x3
v_max3_f32 v46, v46, v8, v9
s_add_u32 s48, s36, 0x0
buffer_load_dwordx4 v[32:35], v0, s[4:7], s48 offen offset:0 sc1
buffer_load_dwordx4 v[36:39], v0, s[4:7], s48 offen offset:1024 sc1
s_waitcnt vmcnt(1)
v_mfma_f32_16x16x32_bf16 v[4:7], v[32:35], v[24:27], 0
s_waitcnt vmcnt(0)
v_mfma_f32_16x16x32_bf16 v[4:7], v[36:39], v[28:31], v[4:7]
v_mov_b64 v[10:11], s[56:57]
s_nop 5
v_permlane32_swap_b32 v4, v6
v_permlane32_swap_b32 v5, v7
v_add_f32_dpp v10, v6, v4 row_ror:8 row_mask:0xf bank_mask:0x3
s_nop 0
v_add_f32_dpp v11, v7, v5 row_ror:8 row_mask:0xf bank_mask:0x3
v_max3_f32 v46, v46, v10, v11
s_add_u32 s48, s36, 0x1000
buffer_load_dwordx4 v[32:35], v0, s[4:7], s48 offen offset:0 sc1
buffer_load_dwordx4 v[36:39], v0, s[4:7], s48 offen offset:1024 sc1
s_waitcnt vmcnt(1)
v_mfma_f32_16x16x32_bf16 v[4:7], v[32:35], v[24:27], 0
s_waitcnt vmcnt(0)
v_mfma_f32_16x16x32_bf16 v[4:7], v[36:39], v[28:31], v[4:7]
v_mov_b64 v[12:13], s[56:57]
s_nop 5
v_permlane32_swap_b32 v4, v6
v_permlane32_swap_b32 v5, v7
v_add_f32_dpp v12, v6, v4 row_ror:8 row_mask:0xf bank_mask:0x3
s_nop 0
v_add_f32_dpp v13, v7, v5 row_ror:8 row_mask:0xf bank_mask:0x3
v_max3_f32 v46, v46, v12, v13
s_add_u32 s48, s36, 0x2000
buffer_load_dwordx4 v[32:35], v0, s[4:7], s48 offen offset:0 sc1
buffer_load_dwordx4 v[36:39], v0, s[4:7], s48 offen offset:1024 sc1
s_waitcnt vmcnt(1)
v_mfma_f32_16x16x32_bf16 v[4:7], v[32:35], v[24:27], 0
s_waitcnt vmcnt(0)
v_mfma_f32_16x16x32_bf16 v[4:7], v[36:39], v[28:31], v[4:7]
v_mov_b64 v[14:15], s[56:57]
s_nop 5
v_permlane32_swap_b32 v4, v6
v_permlane32_swap_b32 v5, v7
v_add_f32_dpp v14, v6, v4 row_ror:8 row_mask:0xf bank_mask:0x3
s_nop 0
v_add_f32_dpp v15, v7, v5 row_ror:8 row_mask:0xf bank_mask:0x3
v_max3_f32 v46, v46, v14, v15
ds_read_b128 v[32:35], v0 offset:2048
ds_read_b128 v[36:39], v0 offset:3072
s_waitcnt lgkmcnt(1)
v_mfma_f32_16x16x32_bf16 v[4:7], v[32:35], v[24:27], 0
s_waitcnt lgkmcnt(0)
v_mfma_f32_16x16x32_bf16 v[4:7], v[36:39], v[28:31], v[4:7]
v_mov_b64 v[44:45], s[56:57]
s_nop 5
v_permlane32_swap_b32 v4, v6
v_permlane32_swap_b32 v5, v7
v_add_f32_dpp v44, v6, v4 row_ror:8 row_mask:0xf bank_mask:0x3
s_nop 0
v_add_f32_dpp v45, v7, v5 row_ror:8 row_mask:0xf bank_mask:0x3
v_max3_f32 v46, v46, v44, v45
buffer_load_dwordx4 v[32:35], v0, s[4:7], s36 offen offset:2048 sc1
buffer_load_dwordx4 v[36:39], v0, s[4:7], s36 offen offset:3072 sc1
v_mov_b32 v47, v46
s_nop 1
v_permlane32_swap_b32 v46, v47
v_max_f32 v46, v46, v47
v_mov_b32 v47, v46
s_nop 1
v_permlane16_swap_b32 v46, v47
v_max_f32 v46, v46, v47
v_sub_f32 v8, v8, v46
v_exp_f32 v8, v8
v_sub_f32 v9, v9, v46
v_exp_f32 v9, v9
v_sub_f32 v10, v10, v46
v_exp_f32 v10, v10
v_sub_f32 v11, v11, v46
v_exp_f32 v11, v11
v_sub_f32 v12, v12, v46
v_exp_f32 v12, v12
v_sub_f32 v13, v13, v46
v_exp_f32 v13, v13
v_sub_f32 v14, v14, v46
v_exp_f32 v14, v14
v_sub_f32 v15, v15, v46
v_exp_f32 v15, v15
v_sub_f32 v44, v44, v46
v_exp_f32 v44, v44
v_sub_f32 v45, v45, v46
v_exp_f32 v45, v45
v_cvt_pk_bf16_f32 v4, v8, v9
v_cvt_pk_bf16_f32 v5, v10, v11
v_cvt_pk_bf16_f32 v6, v12, v13
v_cvt_pk_bf16_f32 v7, v14, v15
v_mov_b32_dpp v8, v4 row_ror:8 row_mask:0xf bank_mask:0xf
v_mov_b32_dpp v9, v5 row_ror:8 row_mask:0xf bank_mask:0xf
v_mov_b32_dpp v10, v6 row_ror:8 row_mask:0xf bank_mask:0xf
v_mov_b32_dpp v11, v7 row_ror:8 row_mask:0xf bank_mask:0xf
v_cvt_pk_bf16_f32 v24, v44, v45
v_cvt_pk_bf16_f32 v25, v44, v45
s_nop 0
v_mov_b32_dpp v26, v24 row_ror:8 row_mask:0xf bank_mask:0xf
v_mov_b32_dpp v27, v24 row_ror:8 row_mask:0xf bank_mask:0xf
v_mov_b64 v[28:29], s[52:53]
v_mov_b64 v[30:31], s[52:53]
s_nop 1
v_mfma_f32_16x16x32_bf16 v[44:47], v[28:31], v[4:7], 0
s_waitcnt vmcnt(1)
v_mfma_f32_16x16x32_bf16 v[12:15], v[32:35], v[4:7], 0
s_waitcnt vmcnt(0)
v_mfma_f32_16x16x32_bf16 v[12:15], v[36:39], v[8:11], v[12:15]
v_mfma_f32_16x16x32_bf16 v[12:15], v[40:43], v[24:27], v[12:15]
v_mov_b64 v[28:29], s[54:55]
s_nop 1
v_mfma_f32_16x16x16_bf16 v[44:47], v[28:29], v[24:25], v[44:47]
s_nop 6
v_rcp_f32 v4, v44
s_nop 1
v_rcp_f32_dpp v4, v44 row_ror:8 row_mask:0xf bank_mask:0xc
s_nop 0
v_mul_f32 v12, v4, v12
v_mul_f32 v13, v4, v13
v_mul_f32 v14, v4, v14
v_mul_f32 v15, v4, v15
v_cvt_pk_bf16_f32 v44, v12, v13
v_cvt_pk_bf16_f32 v45, v14, v15
v_and_b32 v12, 0xffffff7f, v0
v_and_or_b32 v8, v1, 8, v12
ds_write_b64 v8, v[44:45] offset:6272
v_mov_b32_dpp v46, v44 row_ror:8 row_mask:0xf bank_mask:0xf
v_mov_b32_dpp v47, v45 row_ror:8 row_mask:0xf bank_mask:0xf
v_mov_b64 v[24:25], 0
v_mov_b64 v[26:27], 0
v_mov_b64 v[28:29], 0
v_mov_b64 v[30:31], 0
v_mov_b64 v[32:33], 0
v_mov_b64 v[34:35], 0
v_mov_b64 v[36:37], 0
v_mov_b64 v[38:39], 0
s_waitcnt lgkmcnt(0)
s_branch k_okS_149
k_done_150:
buffer_load_dwordx4 v[16:19], v0, s[4:7], s35 offen offset:0 sc1
k_xs_156:
s_waitcnt vmcnt(1)
v_cmp_u_f32 vcc, v4, v12
s_waitcnt vmcnt(0)
v_cmp_u_f32 s[66:67], v16, v16
s_or_b64 vcc, vcc, s[66:67]
s_cbranch_vccz k_xd_157
buffer_load_dwordx4 v[4:7], v0, s[4:7], s33 offen offset:1024 sc1
buffer_load_dwordx4 v[8:11], v0, s[4:7], s33 offen offset:0 sc1
buffer_load_dwordx4 v[12:15], v0, s[4:7], s34 offen offset:0 sc1
buffer_load_dwordx4 v[16:19], v0, s[4:7], s35 offen offset:0 sc1
s_sub_u32 s32, s32, 1
s_cmp_gt_i32 s32, 0
s_cbranch_scc1 k_xs_156
k_xd_157:
s_waitcnt vmcnt(3)
buffer_store_dwordx4 v[4:7], v0, s[8:11], s37 offen offset:0 sc1
s_waitcnt vmcnt(2)
buffer_store_dwordx4 v[12:15], v0, s[8:11], s37 offen offset:2048 sc1
s_waitcnt vmcnt(2)
buffer_store_dwordx4 v[16:19], v0, s[8:11], s59 offen offset:2048 sc1
s_add_u32 s31, s31, 1
s_cmp_lt_u32 s31, 128
s_cbranch_scc1 k_lay_139
s_add_u32 s30, s30, 112
s_waitcnt vmcnt(0) lgkmcnt(0)
s_barrier
s_branch k_fin_7
k_w2_110:
v_lshrrev_b32 v12, 3, v0
v_lshlrev_b32 v10, 13, v12
v_bfe_u32 v12, v0, 1, 2
v_lshrrev_b32 v13, 4, v0
v_xor_b32 v12, v12, v13
v_lshl_add_u32 v10, v12, 5, v10
v_and_b32 v14, 1, v0
v_lshl_add_u32 v10, v14, 4, v10
v_mul_u32_u24 v11, 1280, v13
v_bfe_u32 v12, v0, 1, 3
v_and_b32 v13, 1, v13
v_lshlrev_b32 v13, 1, v13
v_xor_b32 v12, v12, v13
v_xor_b32 v12, 4, v12
v_lshl_add_u32 v11, v12, 5, v11
v_lshl_add_u32 v11, v14, 4, v11
v_bfe_u32 v12, v0, 5, 1
v_lshlrev_b32 v12, 4, v12
v_bfe_u32 v13, v0, 4, 1
v_lshl_add_u32 v12, v13, 1, v12
v_bfe_u32 v13, v0, 2, 1
v_lshl_add_u32 v12, v13, 2, v12
v_bfe_u32 v13, v0, 3, 1
v_mul_u32_u24 v15, 4224, v13
v_add_u32 v12, v13, v12
v_bfe_u32 v13, v12, 1, 2
v_xor_b32 v13, 2, v13
v_lshlrev_b32 v13, 5, v13
v_lshl_add_u32 v4, v12, 7, v13
v_and_b32 v14, 3, v0
v_lshl_add_u32 v4, v14, 3, v4
v_add_u32 v5, 0x10000, v4
v_add_u32 v6, 0x20000, v4
v_bfe_u32 v12, v0, 4, 1
v_lshlrev_b32 v13, 4, v12
v_lshlrev_b32 v12, 2, v12
v_bfe_u32 v8, v0, 5, 1
v_lshl_add_u32 v13, v8, 2, v13
v_bfe_u32 v8, v0, 2, 1
v_add_u32 v13, v8, v13
v_lshl_add_u32 v12, v8, 1, v12
v_bfe_u32 v8, v0, 3, 1
v_add_u32 v8, 4, v8
v_xor_b32 v12, v12, v8
v_lshlrev_b32 v12, 5, v12
v_lshl_add_u32 v7, v13, 8, v12
v_lshl_add_u32 v7, v14, 3, v7
v_add_u32 v8, 0x10000, v7
v_add_u32 v9, 0x20000, v7
v_lshlrev_b32 v0, 4, v0
v_add_u32 v2, 65536, v0
s_lshl_b32 s49, s30, 8
s_mul_i32 s50, s30, 163840
s_mul_i32 s60, s30, 131072
s_add_u32 s60, s60, 120651776
s_add_u32 s61, s60, 4096
s_add_u32 s62, s60, 8192
s_mov_b32 m0, 4096
s_add_u32 s48, s49, 262144
buffer_load_dwordx4 v10, s[8:11], s48 offen lds
s_mov_b32 m0, 5120
s_add_u32 s48, s49, 327680
buffer_load_dwordx4 v10, s[8:11], s48 offen lds
s_mov_b32 m0, 12288
s_add_u32 s48, s49, 262272
buffer_load_dwordx4 v10, s[8:11], s48 offen lds
s_mov_b32 m0, 13312
s_add_u32 s48, s49, 327808
buffer_load_dwordx4 v10, s[8:11], s48 offen lds
s_mov_b32 m0, 20480
s_add_u32 s48, s49, 262272
buffer_load_dwordx4 v10, s[12:15], s48 offen lds
s_mov_b32 m0, 21504
s_add_u32 s48, s49, 327808
buffer_load_dwordx4 v10, s[12:15], s48 offen lds
s_mov_b32 m0, 28672
s_add_u32 s48, s49, 262144
buffer_load_dwordx4 v10, s[16:19], s48 offen lds
s_mov_b32 m0, 29696
s_add_u32 s48, s49, 327680
buffer_load_dwordx4 v10, s[16:19], s48 offen lds
s_mov_b32 m0, 36864
s_add_u32 s48, s49, 262272
buffer_load_dwordx4 v10, s[16:19], s48 offen lds
s_mov_b32 m0, 37888
s_add_u32 s48, s49, 327808
buffer_load_dwordx4 v10, s[16:19], s48 offen lds
s_mov_b32 m0, 45056
s_add_u32 s48, s49, 786432
buffer_load_dwordx4 v10, s[8:11], s48 offen lds
s_mov_b32 m0, 46080
s_add_u32 s48, s49, 851968
buffer_load_dwordx4 v10, s[8:11], s48 offen lds
s_mov_b32 m0, 53248
s_add_u32 s48, s49, 786560
buffer_load_dwordx4 v10, s[8:11], s48 offen lds
s_mov_b32 m0, 54272
s_add_u32 s48, s49, 852096
buffer_load_dwordx4 v10, s[8:11], s48 offen lds
s_mov_b32 m0, 61440
s_add_u32 s48, s49, 786560
buffer_load_dwordx4 v10, s[12:15], s48 offen lds
s_mov_b32 m0, 62464
s_add_u32 s48, s49, 852096
buffer_load_dwordx4 v10, s[12:15], s48 offen lds
s_mov_b32 m0, 69632
s_add_u32 s48, s49, 786432
buffer_load_dwordx4 v10, s[16:19], s48 offen lds
s_mov_b32 m0, 70656
s_add_u32 s48, s49, 851968
buffer_load_dwordx4 v10, s[16:19], s48 offen lds
s_mov_b32 m0, 77824
s_add_u32 s48, s49, 786560
buffer_load_dwordx4 v10, s[16:19], s48 offen lds
s_mov_b32 m0, 78848
s_add_u32 s48, s49, 852096
buffer_load_dwordx4 v10, s[16:19], s48 offen lds
s_mov_b32 m0, 86016
s_add_u32 s48, s49, 1310720
buffer_load_dwordx4 v10, s[8:11], s48 offen lds
s_mov_b32 m0, 87040
s_add_u32 s48, s49, 1376256
buffer_load_dwordx4 v10, s[8:11], s48 offen lds
s_mov_b32 m0, 94208
s_add_u32 s48, s49, 1310848
buffer_load_dwordx4 v10, s[8:11], s48 offen lds
s_mov_b32 m0, 95232
s_add_u32 s48, s49, 1376384
buffer_load_dwordx4 v10, s[8:11], s48 offen lds
s_mov_b32 m0, 102400
s_add_u32 s48, s49, 1310848
buffer_load_dwordx4 v10, s[12:15], s48 offen lds
s_mov_b32 m0, 103424
s_add_u32 s48, s49, 1376384
buffer_load_dwordx4 v10, s[12:15], s48 offen lds
s_mov_b32 m0, 110592
s_add_u32 s48, s49, 1310720
buffer_load_dwordx4 v10, s[16:19], s48 offen lds
s_mov_b32 m0, 111616
s_add_u32 s48, s49, 1376256
buffer_load_dwordx4 v10, s[16:19], s48 offen lds
s_mov_b32 m0, 118784
s_add_u32 s48, s49, 1835008
buffer_load_dwordx4 v10, s[8:11], s48 offen lds
s_mov_b32 m0, 119808
s_add_u32 s48, s49, 1900544
buffer_load_dwordx4 v10, s[8:11], s48 offen lds
s_mov_b32 m0, 126976
s_add_u32 s48, s49, 1835136
buffer_load_dwordx4 v10, s[8:11], s48 offen lds
s_mov_b32 m0, 128000
s_add_u32 s48, s49, 1900672
buffer_load_dwordx4 v10, s[8:11], s48 offen lds
s_waitcnt vmcnt(24)
s_barrier
s_mov_b32 m0, 135168
s_add_u32 s48, s49, 1835136
buffer_load_dwordx4 v10, s[12:15], s48 offen lds
s_mov_b32 m0, 136192
s_add_u32 s48, s49, 1900672
buffer_load_dwordx4 v10, s[12:15], s48 offen lds
s_mov_b32 m0, 143360
s_add_u32 s48, s49, 1835008
buffer_load_dwordx4 v10, s[16:19], s48 offen lds
s_mov_b32 m0, 144384
s_add_u32 s48, s49, 1900544
buffer_load_dwordx4 v10, s[16:19], s48 offen lds
s_mov_b32 m0, 151552
s_add_u32 s48, s49, 2359296
buffer_load_dwordx4 v10, s[8:11], s48 offen lds
s_mov_b32 m0, 152576
s_add_u32 s48, s49, 2424832
buffer_load_dwordx4 v10, s[8:11], s48 offen lds
s_mov_b32 m0, 159744
s_add_u32 s48, s49, 2359424
buffer_load_dwordx4 v10, s[8:11], s48 offen lds
s_mov_b32 m0, 160768
s_add_u32 s48, s49, 2424960
buffer_load_dwordx4 v10, s[8:11], s48 offen lds
ds_read_b64_tr_b16 a[0:1], v4 offset:0
ds_read_b64_tr_b16 a[2:3], v4 offset:1024
ds_read_b64_tr_b16 a[4:5], v4 offset:4096
ds_read_b64_tr_b16 a[6:7], v4 offset:5120
ds_read_b64_tr_b16 a[8:9], v4 offset:8192
ds_read_b64_tr_b16 a[10:11], v4 offset:9216
ds_read_b64_tr_b16 a[12:13], v4 offset:12288
ds_read_b64_tr_b16 a[14:15], v4 offset:13312
ds_read_b64_tr_b16 a[16:17], v4 offset:16384
ds_read_b64_tr_b16 a[18:19], v4 offset:17408
ds_read_b64_tr_b16 a[20:21], v4 offset:20480
ds_read_b64_tr_b16 a[22:23], v4 offset:21504
ds_read_b64_tr_b16 v[40:41], v4 offset:24576
ds_read_b64_tr_b16 v[42:43], v4 offset:25600
ds_read_b64_tr_b16 v[44:45], v4 offset:28672
ds_read_b64_tr_b16 v[46:47], v4 offset:29696
s_waitcnt lgkmcnt(0)
buffer_store_dwordx4 v[40:43], v0, s[4:7], s60 offen offset:0
buffer_store_dwordx4 v[44:47], v0, s[4:7], s60 offen offset:1024
s_waitcnt vmcnt(26)
s_barrier
s_mov_b32 m0, 4096
s_add_u32 s48, s49, 2359424
buffer_load_dwordx4 v10, s[12:15], s48 offen lds
s_mov_b32 m0, 5120
s_add_u32 s48, s49, 2424960
buffer_load_dwordx4 v10, s[12:15], s48 offen lds
s_mov_b32 m0, 12288
s_add_u32 s48, s49, 2359296
buffer_load_dwordx4 v10, s[16:19], s48 offen lds
s_mov_b32 m0, 13312
s_add_u32 s48, s49, 2424832
buffer_load_dwordx4 v10, s[16:19], s48 offen lds
s_mov_b32 m0, 20480
s_add_u32 s48, s49, 2883584
buffer_load_dwordx4 v10, s[8:11], s48 offen lds
s_mov_b32 m0, 21504
s_add_u32 s48, s49, 2949120
buffer_load_dwordx4 v10, s[8:11], s48 offen lds
s_mov_b32 m0, 28672
s_add_u32 s48, s49, 2883712
buffer_load_dwordx4 v10, s[8:11], s48 offen lds
s_mov_b32 m0, 29696
s_add_u32 s48, s49, 2949248
buffer_load_dwordx4 v10, s[8:11], s48 offen lds
ds_read_b64_tr_b16 v[16:17], v4 offset:32768
ds_read_b64_tr_b16 v[18:19], v4 offset:33792
ds_read_b64_tr_b16 v[20:21], v4 offset:36864
ds_read_b64_tr_b16 v[22:23], v4 offset:37888
ds_read_b64_tr_b16 a[24:25], v4 offset:40960
ds_read_b64_tr_b16 a[26:27], v4 offset:41984
ds_read_b64_tr_b16 a[28:29], v4 offset:45056
ds_read_b64_tr_b16 a[30:31], v4 offset:46080
ds_read_b64_tr_b16 a[32:33], v4 offset:49152
ds_read_b64_tr_b16 a[34:35], v4 offset:50176
ds_read_b64_tr_b16 a[36:37], v4 offset:53248
ds_read_b64_tr_b16 a[38:39], v4 offset:54272
ds_read_b64_tr_b16 a[40:41], v4 offset:57344
ds_read_b64_tr_b16 a[42:43], v4 offset:58368
ds_read_b64_tr_b16 a[44:45], v4 offset:61440
ds_read_b64_tr_b16 a[46:47], v4 offset:62464
s_waitcnt lgkmcnt(0)
buffer_store_dwordx4 v[16:19], v0, s[4:7], s60 offen offset:2048
buffer_store_dwordx4 v[20:23], v0, s[4:7], s60 offen offset:3072
s_waitcnt vmcnt(28)
s_barrier
s_mov_b32 m0, 36864
s_add_u32 s48, s49, 2883712
buffer_load_dwordx4 v10, s[12:15], s48 offen lds
s_mov_b32 m0, 37888
s_add_u32 s48, s49, 2949248
buffer_load_dwordx4 v10, s[12:15], s48 offen lds
s_mov_b32 m0, 45056
s_add_u32 s48, s49, 2883584
buffer_load_dwordx4 v10, s[16:19], s48 offen lds
s_mov_b32 m0, 46080
s_add_u32 s48, s49, 2949120
buffer_load_dwordx4 v10, s[16:19], s48 offen lds
s_mov_b32 m0, 53248
s_add_u32 s48, s49, 3408000
buffer_load_dwordx4 v10, s[8:11], s48 offen lds
s_mov_b32 m0, 54272
s_add_u32 s48, s49, 3473536
buffer_load_dwordx4 v10, s[8:11], s48 offen lds
s_mov_b32 m0, 61440
s_add_u32 s48, s49, 3932160
buffer_load_dwordx4 v10, s[8:11], s48 offen lds
s_mov_b32 m0, 62464
s_add_u32 s48, s49, 3997696
buffer_load_dwordx4 v10, s[8:11], s48 offen lds
ds_read_b64_tr_b16 a[176:177], v5 offset:0
ds_read_b64_tr_b16 a[178:179], v5 offset:1024
ds_read_b64_tr_b16 a[180:181], v5 offset:4096
ds_read_b64_tr_b16 a[182:183], v5 offset:5120
ds_read_b64_tr_b16 v[224:225], v5 offset:8192
ds_read_b64_tr_b16 v[226:227], v5 offset:9216
ds_read_b64_tr_b16 v[228:229], v5 offset:12288
ds_read_b64_tr_b16 v[230:231], v5 offset:13312
ds_read_b64_tr_b16 a[112:113], v5 offset:16384
ds_read_b64_tr_b16 a[114:115], v5 offset:17408
ds_read_b64_tr_b16 a[116:117], v5 offset:20480
ds_read_b64_tr_b16 a[118:119], v5 offset:21504
ds_read_b64_tr_b16 a[120:121], v5 offset:24576
ds_read_b64_tr_b16 a[122:123], v5 offset:25600
ds_read_b64_tr_b16 a[124:125], v5 offset:28672
ds_read_b64_tr_b16 a[126:127], v5 offset:29696
s_waitcnt lgkmcnt(0)
s_waitcnt vmcnt(28)
s_barrier
s_mov_b32 m0, 69632
s_add_u32 s48, s49, 3932288
buffer_load_dwordx4 v10, s[8:11], s48 offen lds
s_mov_b32 m0, 70656
s_add_u32 s48, s49, 3997824
buffer_load_dwordx4 v10, s[8:11], s48 offen lds
s_mov_b32 m0, 77824
s_add_u32 s48, s49, 4456448
buffer_load_dwordx4 v10, s[8:11], s48 offen lds
s_mov_b32 m0, 78848
s_add_u32 s48, s49, 4521984
buffer_load_dwordx4 v10, s[8:11], s48 offen lds
s_mov_b32 m0, 86016
s_add_u32 s48, s49, 4456576
buffer_load_dwordx4 v10, s[8:11], s48 offen lds
s_mov_b32 m0, 87040
s_add_u32 s48, s49, 4522112
buffer_load_dwordx4 v10, s[8:11], s48 offen lds
s_mov_b32 m0, 94208
s_add_u32 s48, s49, 4980736
buffer_load_dwordx4 v10, s[8:11], s48 offen lds
s_mov_b32 m0, 95232
s_add_u32 s48, s49, 5046272
buffer_load_dwordx4 v10, s[8:11], s48 offen lds
ds_read_b64_tr_b16 a[128:129], v5 offset:32768
ds_read_b64_tr_b16 a[130:131], v5 offset:33792
ds_read_b64_tr_b16 a[132:133], v5 offset:36864
ds_read_b64_tr_b16 a[134:135], v5 offset:37888
ds_read_b64_tr_b16 a[136:137], v5 offset:40960
ds_read_b64_tr_b16 a[138:139], v5 offset:41984
ds_read_b64_tr_b16 a[140:141], v5 offset:45056
ds_read_b64_tr_b16 a[142:143], v5 offset:46080
ds_read_b64_tr_b16 a[144:145], v5 offset:49152
ds_read_b64_tr_b16 a[146:147], v5 offset:50176
ds_read_b64_tr_b16 a[148:149], v5 offset:53248
ds_read_b64_tr_b16 a[150:151], v5 offset:54272
ds_read_b64_tr_b16 a[152:153], v5 offset:57344
ds_read_b64_tr_b16 a[154:155], v5 offset:58368
ds_read_b64_tr_b16 a[156:157], v5 offset:61440
ds_read_b64_tr_b16 a[158:159], v5 offset:62464
s_waitcnt lgkmcnt(0)
s_waitcnt vmcnt(28)
s_barrier
s_mov_b32 m0, 102400
s_add_u32 s48, s49, 4980864
buffer_load_dwordx4 v10, s[8:11], s48 offen lds
s_mov_b32 m0, 103424
s_add_u32 s48, s49, 5046400
buffer_load_dwordx4 v10, s[8:11], s48 offen lds
s_mov_b32 m0, 110592
s_add_u32 s48, s49, 3407872
buffer_load_dwordx4 v10, s[12:15], s48 offen lds
s_mov_b32 m0, 111616
s_add_u32 s48, s49, 3473408
buffer_load_dwordx4 v10, s[12:15], s48 offen lds
s_mov_b32 m0, 118784
s_add_u32 s48, s49, 3408000
buffer_load_dwordx4 v10, s[12:15], s48 offen lds
s_mov_b32 m0, 119808
s_add_u32 s48, s49, 3473536
buffer_load_dwordx4 v10, s[12:15], s48 offen lds
s_mov_b32 m0, 126976
s_add_u32 s48, s49, 3932160
buffer_load_dwordx4 v10, s[12:15], s48 offen lds
s_mov_b32 m0, 128000
s_add_u32 s48, s49, 3997696
buffer_load_dwordx4 v10, s[12:15], s48 offen lds
ds_read_b64_tr_b16 a[160:161], v6 offset:0
ds_read_b64_tr_b16 a[162:163], v6 offset:1024
ds_read_b64_tr_b16 a[164:165], v6 offset:4096
ds_read_b64_tr_b16 a[166:167], v6 offset:5120
ds_read_b64_tr_b16 a[168:169], v6 offset:8192
ds_read_b64_tr_b16 a[170:171], v6 offset:9216
ds_read_b64_tr_b16 a[172:173], v6 offset:12288
ds_read_b64_tr_b16 a[174:175], v6 offset:13312
ds_read_b64_tr_b16 a[48:49], v6 offset:16384
ds_read_b64_tr_b16 a[50:51], v6 offset:17408
ds_read_b64_tr_b16 a[52:53], v6 offset:20480
ds_read_b64_tr_b16 a[54:55], v6 offset:21504
ds_read_b64_tr_b16 a[56:57], v6 offset:24576
ds_read_b64_tr_b16 a[58:59], v6 offset:25600
ds_read_b64_tr_b16 a[60:61], v6 offset:28672
ds_read_b64_tr_b16 a[62:63], v6 offset:29696
s_waitcnt lgkmcnt(0)
s_waitcnt vmcnt(26)
s_barrier
s_mov_b32 m0, 135168
s_add_u32 s48, s49, 3932288
buffer_load_dwordx4 v10, s[12:15], s48 offen lds
s_mov_b32 m0, 136192
s_add_u32 s48, s49, 3997824
buffer_load_dwordx4 v10, s[12:15], s48 offen lds
s_mov_b32 m0, 143360
s_add_u32 s48, s49, 4456448
buffer_load_dwordx4 v10, s[12:15], s48 offen lds
s_mov_b32 m0, 144384
s_add_u32 s48, s49, 4521984
buffer_load_dwordx4 v10, s[12:15], s48 offen lds
s_mov_b32 m0, 151552
s_add_u32 s48, s49, 4456576
buffer_load_dwordx4 v10, s[12:15], s48 offen lds
s_mov_b32 m0, 152576
s_add_u32 s48, s49, 4522112
buffer_load_dwordx4 v10, s[12:15], s48 offen lds
s_mov_b32 m0, 159744
s_add_u32 s48, s49, 4980736
buffer_load_dwordx4 v10, s[12:15], s48 offen lds
s_mov_b32 m0, 160768
s_add_u32 s48, s49, 5046272
buffer_load_dwordx4 v10, s[12:15], s48 offen lds
ds_read_b64_tr_b16 a[64:65], v4 offset:0
ds_read_b64_tr_b16 a[66:67], v4 offset:1024
ds_read_b64_tr_b16 a[68:69], v4 offset:4096
ds_read_b64_tr_b16 a[70:71], v4 offset:5120
ds_read_b64_tr_b16 a[72:73], v4 offset:8192
ds_read_b64_tr_b16 a[74:75], v4 offset:9216
ds_read_b64_tr_b16 a[76:77], v4 offset:12288
ds_read_b64_tr_b16 a[78:79], v4 offset:13312
ds_read_b64_tr_b16 a[80:81], v4 offset:16384
ds_read_b64_tr_b16 a[82:83], v4 offset:17408
ds_read_b64_tr_b16 a[84:85], v4 offset:20480
ds_read_b64_tr_b16 a[86:87], v4 offset:21504
ds_read_b64_tr_b16 a[88:89], v4 offset:24576
ds_read_b64_tr_b16 a[90:91], v4 offset:25600
ds_read_b64_tr_b16 a[92:93], v4 offset:28672
ds_read_b64_tr_b16 a[94:95], v4 offset:29696
s_waitcnt lgkmcnt(0)
s_waitcnt vmcnt(24)
s_barrier
s_mov_b32 m0, 4096
s_add_u32 s48, s49, 4980864
buffer_load_dwordx4 v10, s[12:15], s48 offen lds
s_mov_b32 m0, 5120
s_add_u32 s48, s49, 5046400
buffer_load_dwordx4 v10, s[12:15], s48 offen lds
s_mov_b32 m0, 12288
s_add_u32 s48, s49, 3407872
buffer_load_dwordx4 v10, s[16:19], s48 offen lds
s_mov_b32 m0, 13312
s_add_u32 s48, s49, 3473408
buffer_load_dwordx4 v10, s[16:19], s48 offen lds
s_mov_b32 m0, 20480
s_add_u32 s48, s49, 3408000
buffer_load_dwordx4 v10, s[16:19], s48 offen lds
s_mov_b32 m0, 21504
s_add_u32 s48, s49, 3473536
buffer_load_dwordx4 v10, s[16:19], s48 offen lds
s_mov_b32 m0, 28672
s_add_u32 s48, s49, 3932160
buffer_load_dwordx4 v10, s[16:19], s48 offen lds
s_mov_b32 m0, 29696
s_add_u32 s48, s49, 3997696
buffer_load_dwordx4 v10, s[16:19], s48 offen lds
ds_read_b64_tr_b16 a[96:97], v4 offset:32768
ds_read_b64_tr_b16 a[98:99], v4 offset:33792
ds_read_b64_tr_b16 a[100:101], v4 offset:36864
ds_read_b64_tr_b16 a[102:103], v4 offset:37888
ds_read_b64_tr_b16 a[104:105], v4 offset:40960
ds_read_b64_tr_b16 a[106:107], v4 offset:41984
ds_read_b64_tr_b16 a[108:109], v4 offset:45056
ds_read_b64_tr_b16 a[110:111], v4 offset:46080
ds_read_b64_tr_b16 a[216:217], v4 offset:49152
ds_read_b64_tr_b16 a[218:219], v4 offset:50176
ds_read_b64_tr_b16 a[220:221], v4 offset:53248
ds_read_b64_tr_b16 a[222:223], v4 offset:54272
ds_read_b64_tr_b16 a[224:225], v4 offset:57344
ds_read_b64_tr_b16 a[226:227], v4 offset:58368
ds_read_b64_tr_b16 a[228:229], v4 offset:61440
ds_read_b64_tr_b16 a[230:231], v4 offset:62464
s_waitcnt lgkmcnt(0)
s_waitcnt vmcnt(24)
s_barrier
s_mov_b32 m0, 36864
s_add_u32 s48, s49, 3932288
buffer_load_dwordx4 v10, s[16:19], s48 offen lds
s_mov_b32 m0, 37888
s_add_u32 s48, s49, 3997824
buffer_load_dwordx4 v10, s[16:19], s48 offen lds
s_mov_b32 m0, 45056
s_add_u32 s48, s49, 4456448
buffer_load_dwordx4 v10, s[16:19], s48 offen lds
s_mov_b32 m0, 46080
s_add_u32 s48, s49, 4521984
buffer_load_dwordx4 v10, s[16:19], s48 offen lds
s_mov_b32 m0, 53248
s_add_u32 s48, s49, 4456576
buffer_load_dwordx4 v10, s[16:19], s48 offen lds
s_mov_b32 m0, 54272
s_add_u32 s48, s49, 4522112
buffer_load_dwordx4 v10, s[16:19], s48 offen lds
s_mov_b32 m0, 61440
s_add_u32 s48, s49, 4980736
buffer_load_dwordx4 v10, s[16:19], s48 offen lds
s_mov_b32 m0, 62464
s_add_u32 s48, s49, 5046272
buffer_load_dwordx4 v10, s[16:19], s48 offen lds
ds_read_b64_tr_b16 a[232:233], v5 offset:0
ds_read_b64_tr_b16 a[234:235], v5 offset:1024
ds_read_b64_tr_b16 a[236:237], v5 offset:4096
ds_read_b64_tr_b16 a[238:239], v5 offset:5120
ds_read_b64_tr_b16 a[184:185], v5 offset:8192
ds_read_b64_tr_b16 a[186:187], v5 offset:9216
ds_read_b64_tr_b16 a[188:189], v5 offset:12288
ds_read_b64_tr_b16 a[190:191], v5 offset:13312
ds_read_b64_tr_b16 a[192:193], v5 offset:16384
ds_read_b64_tr_b16 a[194:195], v5 offset:17408
ds_read_b64_tr_b16 a[196:197], v5 offset:20480
ds_read_b64_tr_b16 a[198:199], v5 offset:21504
ds_read_b64_tr_b16 v[248:249], v5 offset:24576
ds_read_b64_tr_b16 v[250:251], v5 offset:25600
ds_read_b64_tr_b16 v[252:253], v5 offset:28672
ds_read_b64_tr_b16 v[254:255], v5 offset:29696
s_waitcnt lgkmcnt(0)
s_waitcnt vmcnt(24)
s_barrier
s_mov_b32 m0, 69632
s_add_u32 s48, s49, 4980864
buffer_load_dwordx4 v10, s[16:19], s48 offen lds
s_mov_b32 m0, 70656
s_add_u32 s48, s49, 5046400
buffer_load_dwordx4 v10, s[16:19], s48 offen lds
s_mov_b32 m0, 77824
s_add_u32 s48, s50, 81920
buffer_load_dwordx4 v11, s[20:23], s48 offen lds
s_mov_b32 m0, 78848
s_add_u32 s48, s50, 87040
buffer_load_dwordx4 v11, s[20:23], s48 offen lds
s_mov_b32 m0, 86016
s_add_u32 s48, s50, 102400
buffer_load_dwordx4 v11, s[20:23], s48 offen lds
s_mov_b32 m0, 87040
s_add_u32 s48, s50, 107520
buffer_load_dwordx4 v11, s[20:23], s48 offen lds
s_mov_b32 m0, 94208
s_add_u32 s48, s50, 122880
buffer_load_dwordx4 v11, s[20:23], s48 offen lds
s_mov_b32 m0, 95232
s_add_u32 s48, s50, 128000
buffer_load_dwordx4 v11, s[20:23], s48 offen lds
ds_read_b64_tr_b16 a[200:201], v5 offset:32768
ds_read_b64_tr_b16 a[202:203], v5 offset:33792
ds_read_b64_tr_b16 a[204:205], v5 offset:36864
ds_read_b64_tr_b16 a[206:207], v5 offset:37888
ds_read_b64_tr_b16 v[80:81], v5 offset:40960
ds_read_b64_tr_b16 v[82:83], v5 offset:41984
ds_read_b64_tr_b16 v[84:85], v5 offset:45056
ds_read_b64_tr_b16 v[86:87], v5 offset:46080
ds_read_b64_tr_b16 v[88:89], v5 offset:49152
ds_read_b64_tr_b16 v[90:91], v5 offset:50176
ds_read_b64_tr_b16 v[92:93], v5 offset:53248
ds_read_b64_tr_b16 v[94:95], v5 offset:54272
ds_read_b64_tr_b16 v[96:97], v5 offset:57344
ds_read_b64_tr_b16 v[98:99], v5 offset:58368
ds_read_b64_tr_b16 v[100:101], v5 offset:61440
ds_read_b64_tr_b16 v[102:103], v5 offset:62464
s_waitcnt lgkmcnt(0)
s_waitcnt vmcnt(24)
s_barrier
s_mov_b32 m0, 102400
s_add_u32 s48, s50, 143360
buffer_load_dwordx4 v11, s[20:23], s48 offen lds
s_mov_b32 m0, 103424
s_add_u32 s48, s50, 148480
buffer_load_dwordx4 v11, s[20:23], s48 offen lds
s_mov_b32 m0, 110592
s_add_u32 s48, s50, 82176
buffer_load_dwordx4 v11, s[20:23], s48 offen lds
s_mov_b32 m0, 111616
s_add_u32 s48, s50, 87296
buffer_load_dwordx4 v11, s[20:23], s48 offen lds
s_mov_b32 m0, 118784
s_add_u32 s48, s50, 102656
buffer_load_dwordx4 v11, s[20:23], s48 offen lds
s_mov_b32 m0, 119808
s_add_u32 s48, s50, 107776
buffer_load_dwordx4 v11, s[20:23], s48 offen lds
s_mov_b32 m0, 126976
s_add_u32 s48, s50, 123136
buffer_load_dwordx4 v11, s[20:23], s48 offen lds
s_mov_b32 m0, 128000
s_add_u32 s48, s50, 128256
buffer_load_dwordx4 v11, s[20:23], s48 offen lds
ds_read_b64_tr_b16 v[104:105], v6 offset:0
ds_read_b64_tr_b16 v[106:107], v6 offset:1024
ds_read_b64_tr_b16 v[108:109], v6 offset:4096
ds_read_b64_tr_b16 v[110:111], v6 offset:5120
ds_read_b64_tr_b16 v[240:241], v6 offset:8192
ds_read_b64_tr_b16 v[242:243], v6 offset:9216
ds_read_b64_tr_b16 v[244:245], v6 offset:12288
ds_read_b64_tr_b16 v[246:247], v6 offset:13312
ds_read_b64_tr_b16 a[240:241], v6 offset:16384
ds_read_b64_tr_b16 a[242:243], v6 offset:17408
ds_read_b64_tr_b16 a[244:245], v6 offset:20480
ds_read_b64_tr_b16 a[246:247], v6 offset:21504
ds_read_b64_tr_b16 a[248:249], v6 offset:24576
ds_read_b64_tr_b16 a[250:251], v6 offset:25600
ds_read_b64_tr_b16 a[252:253], v6 offset:28672
ds_read_b64_tr_b16 a[254:255], v6 offset:29696
s_waitcnt lgkmcnt(0)
s_waitcnt vmcnt(24)
s_barrier
s_mov_b32 m0, 135168
s_add_u32 s48, s50, 143616
buffer_load_dwordx4 v11, s[20:23], s48 offen lds
s_mov_b32 m0, 136192
s_add_u32 s48, s50, 148736
buffer_load_dwordx4 v11, s[20:23], s48 offen lds
s_mov_b32 m0, 143360
s_add_u32 s48, s50, 82432
buffer_load_dwordx4 v11, s[20:23], s48 offen lds
s_mov_b32 m0, 144384
s_add_u32 s48, s50, 87552
buffer_load_dwordx4 v11, s[20:23], s48 offen lds
s_mov_b32 m0, 151552
s_add_u32 s48, s50, 102912
buffer_load_dwordx4 v11, s[20:23], s48 offen lds
s_mov_b32 m0, 152576
s_add_u32 s48, s50, 108032
buffer_load_dwordx4 v11, s[20:23], s48 offen lds
s_mov_b32 m0, 159744
s_add_u32 s48, s50, 123392
buffer_load_dwordx4 v11, s[20:23], s48 offen lds
s_mov_b32 m0, 160768
s_add_u32 s48, s50, 128512
buffer_load_dwordx4 v11, s[20:23], s48 offen lds
ds_read_b64_tr_b16 v[72:73], v4 offset:0
ds_read_b64_tr_b16 v[74:75], v4 offset:1024
ds_read_b64_tr_b16 v[76:77], v4 offset:4096
ds_read_b64_tr_b16 v[78:79], v4 offset:5120
ds_read_b64_tr_b16 v[144:145], v4 offset:8192
ds_read_b64_tr_b16 v[146:147], v4 offset:9216
ds_read_b64_tr_b16 v[148:149], v4 offset:12288
ds_read_b64_tr_b16 v[150:151], v4 offset:13312
ds_read_b64_tr_b16 v[152:153], v4 offset:16384
ds_read_b64_tr_b16 v[154:155], v4 offset:17408
ds_read_b64_tr_b16 v[156:157], v4 offset:20480
ds_read_b64_tr_b16 v[158:159], v4 offset:21504
ds_read_b64_tr_b16 v[160:161], v4 offset:24576
ds_read_b64_tr_b16 v[162:163], v4 offset:25600
ds_read_b64_tr_b16 v[164:165], v4 offset:28672
ds_read_b64_tr_b16 v[166:167], v4 offset:29696
s_waitcnt lgkmcnt(0)
s_waitcnt vmcnt(24)
s_barrier
s_mov_b32 m0, 4096
s_add_u32 s48, s50, 143872
buffer_load_dwordx4 v11, s[20:23], s48 offen lds
s_mov_b32 m0, 5120
s_add_u32 s48, s50, 148992
buffer_load_dwordx4 v11, s[20:23], s48 offen lds
s_mov_b32 m0, 12288
s_add_u32 s48, s49, 262144
buffer_load_dwordx4 v10, s[12:15], s48 offen lds
s_mov_b32 m0, 13312
s_add_u32 s48, s49, 327680
buffer_load_dwordx4 v10, s[12:15], s48 offen lds
s_mov_b32 m0, 20480
s_add_u32 s48, s49, 786432
buffer_load_dwordx4 v10, s[12:15], s48 offen lds
s_mov_b32 m0, 21504
s_add_u32 s48, s49, 851968
buffer_load_dwordx4 v10, s[12:15], s48 offen lds
s_mov_b32 m0, 28672
s_add_u32 s48, s49, 1310720
buffer_load_dwordx4 v10, s[12:15], s48 offen lds
s_mov_b32 m0, 29696
s_add_u32 s48, s49, 1376256
buffer_load_dwordx4 v10, s[12:15], s48 offen lds
ds_read_b64_tr_b16 v[168:169], v4 offset:32768
ds_read_b64_tr_b16 v[170:171], v4 offset:33792
ds_read_b64_tr_b16 v[172:173], v4 offset:36864
ds_read_b64_tr_b16 v[174:175], v4 offset:37888
ds_read_b64_tr_b16 v[112:113], v4 offset:40960
ds_read_b64_tr_b16 v[114:115], v4 offset:41984
ds_read_b64_tr_b16 v[116:117], v4 offset:45056
ds_read_b64_tr_b16 v[118:119], v4 offset:46080
ds_read_b64_tr_b16 v[120:121], v4 offset:49152
ds_read_b64_tr_b16 v[122:123], v4 offset:50176
ds_read_b64_tr_b16 v[124:125], v4 offset:53248
ds_read_b64_tr_b16 v[126:127], v4 offset:54272
ds_read_b64_tr_b16 v[128:129], v4 offset:57344
ds_read_b64_tr_b16 v[130:131], v4 offset:58368
ds_read_b64_tr_b16 v[132:133], v4 offset:61440
ds_read_b64_tr_b16 v[134:135], v4 offset:62464
s_waitcnt lgkmcnt(0)
s_waitcnt vmcnt(24)
s_barrier
s_mov_b32 m0, 36864
s_add_u32 s48, s49, 1835008
buffer_load_dwordx4 v10, s[12:15], s48 offen lds
s_mov_b32 m0, 37888
s_add_u32 s48, s49, 1900544
buffer_load_dwordx4 v10, s[12:15], s48 offen lds
s_mov_b32 m0, 45056
s_add_u32 s48, s49, 2359296
buffer_load_dwordx4 v10, s[12:15], s48 offen lds
s_mov_b32 m0, 46080
s_add_u32 s48, s49, 2424832
buffer_load_dwordx4 v10, s[12:15], s48 offen lds
s_mov_b32 m0, 53248
s_add_u32 s48, s49, 2883584
buffer_load_dwordx4 v10, s[12:15], s48 offen lds
s_mov_b32 m0, 54272
s_add_u32 s48, s49, 2949120
buffer_load_dwordx4 v10, s[12:15], s48 offen lds
s_mov_b32 m0, 61440
s_add_u32 s48, s49, 1310848
buffer_load_dwordx4 v10, s[16:19], s48 offen lds
s_mov_b32 m0, 62464
s_add_u32 s48, s49, 1376384
buffer_load_dwordx4 v10, s[16:19], s48 offen lds
ds_read_b64_tr_b16 v[136:137], v5 offset:0
ds_read_b64_tr_b16 v[138:139], v5 offset:1024
ds_read_b64_tr_b16 v[140:141], v5 offset:4096
ds_read_b64_tr_b16 v[142:143], v5 offset:5120
ds_read_b64_tr_b16 v[184:185], v8 offset:8192
ds_read_b64_tr_b16 v[186:187], v8 offset:8704
ds_read_b64_tr_b16 v[188:189], v8 offset:10240
ds_read_b64_tr_b16 v[190:191], v8 offset:10752
ds_read_b64_tr_b16 v[192:193], v8 offset:16384
ds_read_b64_tr_b16 v[194:195], v8 offset:16896
ds_read_b64_tr_b16 v[196:197], v8 offset:18432
ds_read_b64_tr_b16 v[198:199], v8 offset:18944
v_xor_b32 v12, v15, v8
ds_read_b64_tr_b16 v[40:41], v12 offset:24576
ds_read_b64_tr_b16 v[42:43], v12 offset:25088
ds_read_b64_tr_b16 v[44:45], v12 offset:26624
ds_read_b64_tr_b16 v[46:47], v12 offset:27136
s_waitcnt lgkmcnt(0)
buffer_store_dwordx4 v[40:43], v0, s[4:7], s61 offen offset:0
buffer_store_dwordx4 v[44:47], v0, s[4:7], s61 offen offset:1024
s_waitcnt vmcnt(26)
s_barrier
s_mov_b32 m0, 69632
s_add_u32 s48, s49, 1835136
buffer_load_dwordx4 v10, s[16:19], s48 offen lds
s_mov_b32 m0, 70656
s_add_u32 s48, s49, 1900672
buffer_load_dwordx4 v10, s[16:19], s48 offen lds
s_mov_b32 m0, 77824
s_add_u32 s48, s49, 2359424
buffer_load_dwordx4 v10, s[16:19], s48 offen lds
s_mov_b32 m0, 78848
s_add_u32 s48, s49, 2424960
buffer_load_dwordx4 v10, s[16:19], s48 offen lds
s_mov_b32 m0, 86016
s_add_u32 s48, s49, 2883712
buffer_load_dwordx4 v10, s[16:19], s48 offen lds
s_mov_b32 m0, 87040
s_add_u32 s48, s49, 2949248
buffer_load_dwordx4 v10, s[16:19], s48 offen lds
s_mov_b32 m0, 94208
s_add_u32 s48, s50, 82688
buffer_load_dwordx4 v11, s[20:23], s48 offen lds
s_mov_b32 m0, 95232
s_add_u32 s48, s50, 87808
buffer_load_dwordx4 v11, s[20:23], s48 offen lds
ds_read_b64_tr_b16 v[176:177], v8 offset:32768
ds_read_b64_tr_b16 v[178:179], v8 offset:33280
ds_read_b64_tr_b16 v[180:181], v8 offset:34816
ds_read_b64_tr_b16 v[182:183], v8 offset:35328
ds_read_b64_tr_b16 v[232:233], v8 offset:40960
ds_read_b64_tr_b16 v[234:235], v8 offset:41472
ds_read_b64_tr_b16 v[236:237], v8 offset:43008
ds_read_b64_tr_b16 v[238:239], v8 offset:43520
ds_read_b64_tr_b16 v[32:33], v8 offset:49152
ds_read_b64_tr_b16 v[34:35], v8 offset:49664
ds_read_b64_tr_b16 v[36:37], v8 offset:51200
ds_read_b64_tr_b16 v[38:39], v8 offset:51712
v_xor_b32 v12, v15, v8
ds_read_b64_tr_b16 v[40:41], v12 offset:57344
ds_read_b64_tr_b16 v[42:43], v12 offset:57856
ds_read_b64_tr_b16 v[44:45], v12 offset:59392
ds_read_b64_tr_b16 v[46:47], v12 offset:59904
s_waitcnt lgkmcnt(0)
buffer_store_dwordx4 v[32:35], v0, s[4:7], s62 offen offset:0
buffer_store_dwordx4 v[36:39], v0, s[4:7], s62 offen offset:1024
buffer_store_dwordx4 v[40:43], v0, s[4:7], s61 offen offset:2048
buffer_store_dwordx4 v[44:47], v0, s[4:7], s61 offen offset:3072
s_waitcnt vmcnt(30)
s_barrier
s_mov_b32 m0, 102400
s_add_u32 s48, s50, 103168
buffer_load_dwordx4 v11, s[20:23], s48 offen lds
s_mov_b32 m0, 103424
s_add_u32 s48, s50, 108288
buffer_load_dwordx4 v11, s[20:23], s48 offen lds
s_mov_b32 m0, 110592
s_add_u32 s48, s50, 123648
buffer_load_dwordx4 v11, s[20:23], s48 offen lds
s_mov_b32 m0, 111616
s_add_u32 s48, s50, 128768
buffer_load_dwordx4 v11, s[20:23], s48 offen lds
s_mov_b32 m0, 118784
s_add_u32 s48, s50, 144128
buffer_load_dwordx4 v11, s[20:23], s48 offen lds
s_mov_b32 m0, 119808
s_add_u32 s48, s50, 149248
buffer_load_dwordx4 v11, s[20:23], s48 offen lds
s_mov_b32 m0, 126976
s_add_u32 s48, s50, 82944
buffer_load_dwordx4 v11, s[20:23], s48 offen lds
s_mov_b32 m0, 128000
s_add_u32 s48, s50, 88064
buffer_load_dwordx4 v11, s[20:23], s48 offen lds
ds_read_b64_tr_b16 a[208:209], v9 offset:0
ds_read_b64_tr_b16 a[210:211], v9 offset:512
ds_read_b64_tr_b16 a[212:213], v9 offset:2048
ds_read_b64_tr_b16 a[214:215], v9 offset:2560
ds_read_b64_tr_b16 v[208:209], v9 offset:8192
ds_read_b64_tr_b16 v[210:211], v9 offset:8704
ds_read_b64_tr_b16 v[212:213], v9 offset:10240
ds_read_b64_tr_b16 v[214:215], v9 offset:10752
ds_read_b64_tr_b16 v[216:217], v9 offset:16384
ds_read_b64_tr_b16 v[218:219], v9 offset:16896
ds_read_b64_tr_b16 v[220:221], v9 offset:18432
ds_read_b64_tr_b16 v[222:223], v9 offset:18944
v_xor_b32 v12, v15, v9
ds_read_b64_tr_b16 v[200:201], v12 offset:24576
ds_read_b64_tr_b16 v[202:203], v12 offset:25088
ds_read_b64_tr_b16 v[204:205], v12 offset:26624
ds_read_b64_tr_b16 v[206:207], v12 offset:27136
s_waitcnt lgkmcnt(0)
s_waitcnt vmcnt(36)
s_barrier
s_mov_b32 m0, 135168
s_add_u32 s48, s50, 103424
buffer_load_dwordx4 v11, s[20:23], s48 offen lds
s_mov_b32 m0, 136192
s_add_u32 s48, s50, 108544
buffer_load_dwordx4 v11, s[20:23], s48 offen lds
s_mov_b32 m0, 143360
s_add_u32 s48, s50, 123904
buffer_load_dwordx4 v11, s[20:23], s48 offen lds
s_mov_b32 m0, 144384
s_add_u32 s48, s50, 129024
buffer_load_dwordx4 v11, s[20:23], s48 offen lds
s_mov_b32 m0, 151552
s_add_u32 s48, s50, 144384
buffer_load_dwordx4 v11, s[20:23], s48 offen lds
s_mov_b32 m0, 152576
s_add_u32 s48, s50, 149504
buffer_load_dwordx4 v11, s[20:23], s48 offen lds
s_mov_b32 m0, 159744
s_add_u32 s48, s49, 3407872
buffer_load_dwordx4 v10, s[8:11], s48 offen lds
s_mov_b32 m0, 160768
s_add_u32 s48, s49, 3473408
buffer_load_dwordx4 v10, s[8:11], s48 offen lds
ds_read_b64_tr_b16 v[16:17], v7 offset:0
ds_read_b64_tr_b16 v[18:19], v7 offset:512
ds_read_b64_tr_b16 v[20:21], v7 offset:2048
ds_read_b64_tr_b16 v[22:23], v7 offset:2560
s_waitcnt lgkmcnt(0)
buffer_store_dwordx4 v[16:19], v0, s[4:7], s62 offen offset:2048
buffer_store_dwordx4 v[20:23], v0, s[4:7], s62 offen offset:3072
s_waitcnt vmcnt(32)
s_barrier
ds_read_b64_tr_b16 v[16:17], v4 offset:8192
ds_read_b64_tr_b16 v[18:19], v4 offset:9216
ds_read_b64_tr_b16 v[20:21], v4 offset:12288
ds_read_b64_tr_b16 v[22:23], v4 offset:13312
ds_read_b64_tr_b16 v[24:25], v4 offset:16384
ds_read_b64_tr_b16 v[26:27], v4 offset:17408
ds_read_b64_tr_b16 v[28:29], v4 offset:20480
ds_read_b64_tr_b16 v[30:31], v4 offset:21504
ds_read_b64_tr_b16 v[32:33], v4 offset:24576
ds_read_b64_tr_b16 v[34:35], v4 offset:25600
ds_read_b64_tr_b16 v[36:37], v4 offset:28672
ds_read_b64_tr_b16 v[38:39], v4 offset:29696
ds_read_b64_tr_b16 v[40:41], v4 offset:32768
ds_read_b64_tr_b16 v[42:43], v4 offset:33792
ds_read_b64_tr_b16 v[44:45], v4 offset:36864
ds_read_b64_tr_b16 v[46:47], v4 offset:37888
ds_read_b64_tr_b16 v[48:49], v4 offset:40960
ds_read_b64_tr_b16 v[50:51], v4 offset:41984
ds_read_b64_tr_b16 v[52:53], v4 offset:45056
ds_read_b64_tr_b16 v[54:55], v4 offset:46080
ds_read_b64_tr_b16 v[56:57], v4 offset:49152
ds_read_b64_tr_b16 v[58:59], v4 offset:50176
ds_read_b64_tr_b16 v[60:61], v4 offset:53248
ds_read_b64_tr_b16 v[62:63], v4 offset:54272
ds_read_b64_tr_b16 v[64:65], v4 offset:57344
ds_read_b64_tr_b16 v[66:67], v4 offset:58368
ds_read_b64_tr_b16 v[68:69], v4 offset:61440
ds_read_b64_tr_b16 v[70:71], v4 offset:62464
s_waitcnt lgkmcnt(0)
s_barrier
ds_write_b128 v0, v[16:19] offset:36864
ds_write_b128 v0, v[20:23] offset:37888
ds_write_b128 v0, v[24:27] offset:38912
ds_write_b128 v0, v[28:31] offset:39936
ds_write_b128 v0, v[32:35] offset:40960
ds_write_b128 v0, v[36:39] offset:41984
ds_write_b128 v0, v[40:43] offset:43008
ds_write_b128 v0, v[44:47] offset:44032
ds_write_b128 v0, v[48:51] offset:45056
ds_write_b128 v0, v[52:55] offset:46080
ds_write_b128 v0, v[56:59] offset:47104
ds_write_b128 v0, v[60:63] offset:48128
ds_write_b128 v0, v[64:67] offset:49152
ds_write_b128 v0, v[68:71] offset:50176
s_waitcnt lgkmcnt(0)
s_waitcnt vmcnt(8)
s_barrier
ds_read_b64_tr_b16 v[16:17], v8 offset:24576
ds_read_b64_tr_b16 v[18:19], v8 offset:25088
ds_read_b64_tr_b16 v[20:21], v8 offset:26624
ds_read_b64_tr_b16 v[22:23], v8 offset:27136
ds_read_b64_tr_b16 v[24:25], v8 offset:32768
ds_read_b64_tr_b16 v[26:27], v8 offset:33280
ds_read_b64_tr_b16 v[28:29], v8 offset:34816
ds_read_b64_tr_b16 v[30:31], v8 offset:35328
v_xor_b32 v12, v15, v8
ds_read_b64_tr_b16 v[32:33], v12 offset:40960
ds_read_b64_tr_b16 v[34:35], v12 offset:41472
ds_read_b64_tr_b16 v[36:37], v12 offset:43008
ds_read_b64_tr_b16 v[38:39], v12 offset:43520
ds_read_b64_tr_b16 v[40:41], v8 offset:49152
ds_read_b64_tr_b16 v[42:43], v8 offset:49664
ds_read_b64_tr_b16 v[44:45], v8 offset:51200
ds_read_b64_tr_b16 v[46:47], v8 offset:51712
ds_read_b64_tr_b16 v[48:49], v8 offset:57344
ds_read_b64_tr_b16 v[50:51], v8 offset:57856
ds_read_b64_tr_b16 v[52:53], v8 offset:59392
ds_read_b64_tr_b16 v[54:55], v8 offset:59904
ds_read_b64_tr_b16 v[56:57], v9 offset:0
ds_read_b64_tr_b16 v[58:59], v9 offset:512
ds_read_b64_tr_b16 v[60:61], v9 offset:2048
ds_read_b64_tr_b16 v[62:63], v9 offset:2560
s_waitcnt lgkmcnt(0)
s_barrier
ds_write_b128 v2, v[16:19] offset:24576
ds_write_b128 v2, v[20:23] offset:25600
ds_write_b128 v2, v[232:235] offset:26624
ds_write_b128 v2, v[236:239] offset:27648
ds_write_b128 v2, v[224:227] offset:28672
ds_write_b128 v2, v[228:231] offset:29696
ds_write_b128 v2, v[40:43] offset:30720
ds_write_b128 v2, v[44:47] offset:31744
ds_write_b128 v2, v[48:51] offset:32768
ds_write_b128 v2, v[52:55] offset:33792
ds_write_b128 v2, v[248:251] offset:34816
ds_write_b128 v2, v[252:255] offset:35840
s_waitcnt lgkmcnt(0)
v_mov_b32 v232, v24
v_mov_b32 v233, v25
v_mov_b32 v234, v26
v_mov_b32 v235, v27
v_mov_b32 v236, v28
v_mov_b32 v237, v29
v_mov_b32 v238, v30
v_mov_b32 v239, v31
v_mov_b32 v224, v32
v_mov_b32 v225, v33
v_mov_b32 v226, v34
v_mov_b32 v227, v35
v_mov_b32 v228, v36
v_mov_b32 v229, v37
v_mov_b32 v230, v38
v_mov_b32 v231, v39
v_mov_b32 v248, v56
v_mov_b32 v249, v57
v_mov_b32 v250, v58
v_mov_b32 v251, v59
v_mov_b32 v252, v60
v_mov_b32 v253, v61
v_mov_b32 v254, v62
v_mov_b32 v255, v63
s_waitcnt vmcnt(2)
s_barrier
ds_read_b64_tr_b16 v[16:17], v5 offset:0
ds_read_b64_tr_b16 v[18:19], v5 offset:1024
ds_read_b64_tr_b16 v[20:21], v5 offset:4096
ds_read_b64_tr_b16 v[22:23], v5 offset:5120
ds_read_b64_tr_b16 v[24:25], v5 offset:8192
ds_read_b64_tr_b16 v[26:27], v5 offset:9216
ds_read_b64_tr_b16 v[28:29], v5 offset:12288
ds_read_b64_tr_b16 v[30:31], v5 offset:13312
ds_read_b64_tr_b16 v[32:33], v5 offset:16384
ds_read_b64_tr_b16 v[34:35], v5 offset:17408
ds_read_b64_tr_b16 v[36:37], v5 offset:20480
ds_read_b64_tr_b16 v[38:39], v5 offset:21504
v_xor_b32 v12, v15, v9
ds_read_b64_tr_b16 v[40:41], v12 offset:8192
ds_read_b64_tr_b16 v[42:43], v12 offset:8704
ds_read_b64_tr_b16 v[44:45], v12 offset:10240
ds_read_b64_tr_b16 v[46:47], v12 offset:10752
ds_read_b64_tr_b16 v[48:49], v9 offset:16384
ds_read_b64_tr_b16 v[50:51], v9 offset:16896
ds_read_b64_tr_b16 v[52:53], v9 offset:18432
ds_read_b64_tr_b16 v[54:55], v9 offset:18944
ds_read_b64_tr_b16 v[56:57], v6 offset:24576
ds_read_b64_tr_b16 v[58:59], v6 offset:25600
ds_read_b64_tr_b16 v[60:61], v6 offset:28672
ds_read_b64_tr_b16 v[62:63], v6 offset:29696
s_waitcnt lgkmcnt(0)
s_barrier
ds_write_b128 v2, a[176:179] offset:0
ds_write_b128 v2, a[180:183] offset:1024
ds_write_b128 v2, v[24:27] offset:2048
ds_write_b128 v2, v[28:31] offset:3072
ds_write_b128 v2, v[32:35] offset:4096
ds_write_b128 v2, v[36:39] offset:5120
ds_write_b128 v2, v[240:243] offset:6144
ds_write_b128 v2, v[244:247] offset:7168
ds_write_b128 v2, v[48:51] offset:8192
ds_write_b128 v2, v[52:55] offset:9216
ds_write_b128 v2, a[208:211] offset:10240
ds_write_b128 v2, a[212:215] offset:11264
s_waitcnt lgkmcnt(0)
v_accvgpr_write_b32 a176, v16
v_accvgpr_write_b32 a177, v17
v_accvgpr_write_b32 a178, v18
v_accvgpr_write_b32 a179, v19
v_accvgpr_write_b32 a180, v20
v_accvgpr_write_b32 a181, v21
v_accvgpr_write_b32 a182, v22
v_accvgpr_write_b32 a183, v23
v_mov_b32 v240, v40
v_mov_b32 v241, v41
v_mov_b32 v242, v42
v_mov_b32 v243, v43
v_mov_b32 v244, v44
v_mov_b32 v245, v45
v_mov_b32 v246, v46
v_mov_b32 v247, v47
v_accvgpr_write_b32 a208, v56
v_accvgpr_write_b32 a209, v57
v_accvgpr_write_b32 a210, v58
v_accvgpr_write_b32 a211, v59
v_accvgpr_write_b32 a212, v60
v_accvgpr_write_b32 a213, v61
v_accvgpr_write_b32 a214, v62
v_accvgpr_write_b32 a215, v63
s_mov_b32 s90, 0x300003
s_mov_b32 s91, 0x300003
s_mov_b32 s12, 0x3030303
s_mov_b32 s13, 0x3030303
s_mov_b32 s92, 0xc0000c
s_mov_b32 s93, 0xc0000c
s_mov_b32 s14, 0xc0c0c0c
s_mov_b32 s15, 0xc0c0c0c
s_mov_b32 s94, 0x30000300
s_mov_b32 s95, 0x30000300
s_mov_b32 s16, 0x30303030
s_mov_b32 s17, 0x30303030
s_mov_b32 s96, 0xc0000c00
s_mov_b32 s97, 0xc0000c00
s_mov_b32 s18, 0xc0c0c0c0
s_mov_b32 s19, 0xc0c0c0c0
s_mov_b32 s98, 0xff00ff00
s_mov_b32 s99, 0xff00ff00
v_mov_b32 v1, 0x4444
v_mov_b32 v4, 0xeeee
v_cndmask_b32 v1, v1, v4, s[98:99]
v_lshrrev_b32 v4, 8, v0
v_lshl_or_b32 v1, v4, 28, v1
v_bfe_u32 v4, v0, 4, 4
v_lshl_or_b32 v1, v4, 19, v1
s_mov_b32 s51, 0x3e0293ee
s_mov_b32 s52, 0x3f803f80
s_mov_b32 s53, 0x3f803f80
s_mov_b32 s54, 0x3f003f00
s_mov_b32 s55, 0x3f003f00
s_mov_b32 s56, 0xff800000
s_mov_b32 s57, 0xff800000
s_mov_b32 s58, 0x3f80
s_mov_b32 s8, s4
s_mov_b32 s9, s5
s_cmp_eq_u32 s30, 30
s_cselect_b32 s10, s6, 0
s_mov_b32 s31, 0
s_mov_b32 s45, -2
s_lshl_b32 s46, s30, 6
s_add_u32 s46, s46, 222330880
s_mov_b32 s20, s4
s_mov_b32 s21, s5
s_cmp_lt_u32 s30, 10
s_cselect_b32 s22, s6, 0
v_mov_b32 v3, -1
s_lshl_b32 s48, s30, 7
s_and_b32 s49, s30, 31
s_lshl_b32 s49, s49, 12
s_add_u32 s43, s49, 119734272
v_mov_b64 v[12:13], -1
s_add_u32 s38, s48, 119570432
s_add_u32 s39, s48, 119635968
s_add_u32 s40, s48, 119701504
s_add_u32 s41, s48, 119767040
s_add_u32 s42, s48, 119832576
v_lshrrev_b32 v4, 16, v1
buffer_store_dwordx2 v[12:13], v4, s[4:7], s38 offen
buffer_store_dwordx2 v[12:13], v4, s[4:7], s39 offen
buffer_store_dwordx2 v[12:13], v4, s[4:7], s40 offen
buffer_store_dwordx2 v[12:13], v4, s[4:7], s41 offen
buffer_store_dwordx2 v[12:13], v4, s[4:7], s42 offen
s_cmp_lg_u32 s3, 0
s_cbranch_scc1 k_wdd_159
v_mov_b32 v8, 192
k_wd_158:
global_load_dword v9, v8, s[28:29] sc1
s_waitcnt vmcnt(0)
v_readfirstlane_b32 s48, v9
s_cmp_ge_u32 s48, 32
s_cbranch_scc1 k_wdd_159
s_sleep 2
s_sub_u32 s32, s32, 1
s_cmp_gt_i32 s32, 0
s_cbranch_scc1 k_wd_158
k_wdd_159:
s_barrier
k_lay_160:
s_add_u32 s47, s31, 63
s_mov_b32 s33, 120324096
s_mov_b32 s34, 120328192
s_mov_b32 s35, 120332288
s_mul_i32 s48, s31, 655360
s_lshl_b32 s36, s30, 14
s_add_u32 s36, s36, s48
s_add_u32 s36, s36, 8192
v_mov_b32 v12, -1
s_and_b32 s48, s30, 31
s_add_u32 s48, s48, 48
s_lshr_b32 s49, s48, 1
s_and_b32 s48, s48, 1
s_lshl_b32 s44, s49, 8
s_lshl_b32 s50, s48, 6
s_add_u32 s44, s44, s50
s_add_u32 s44, s44, s33
s_mul_i32 s48, s48, 5120
s_lshl_b32 s49, s49, 5
s_add_u32 s48, s48, s49
v_lshrrev_b32 v8, 4, v0
v_and_b32 v9, 3, v8
v_mul_u32_u24 v9, 1280, v9
v_bfe_u32 v10, v8, 2, 1
v_lshl_add_u32 v9, v10, 1, v9
v_bfe_u32 v10, v8, 4, 1
v_lshl_add_u32 v9, v10, 4, v9
v_bfe_u32 v10, v8, 5, 1
v_lshl_add_u32 v9, v10, 2, v9
buffer_load_ushort v10, v9, s[24:27], s48 offen
buffer_load_ushort v11, v9, s[24:27], s48 offen offset:8
v_and_b32 v45, 0x30, v0
v_lshrrev_b32 v46, 8, v0
v_lshl_or_b32 v45, v46, 2, v45
v_bfe_u32 v46, v0, 6, 1
v_lshl_or_b32 v45, v46, 7, v45
v_cndmask_b32 v45, v45, 2.0, s[98:99]
s_waitcnt vmcnt(0)
v_lshl_or_b32 v10, v11, 16, v10
s_lshl_b32 s63, s30, 10
s_add_u32 s63, s63, 120356864
s_lshl_b32 s37, s31, 14
s_add_u32 s37, s37, 117442560
s_add_u32 s59, s37, 4096
s_waitcnt vmcnt(0)
s_barrier
s_barrier
buffer_store_dword v10, v45, s[4:7], s44 offen
s_add_u32 s44, s44, 16384
buffer_store_dword v12, v45, s[4:7], s44 offen
s_waitcnt vmcnt(0)
s_barrier
s_barrier
v_lshlrev_b32 v23, v0, s58
v_cndmask_b32 v20, 0, v23, s[90:91]
v_cndmask_b32 v21, 0, v23, s[92:93]
v_cndmask_b32 v22, 0, v23, s[94:95]
v_cndmask_b32 v23, 0, v23, s[96:97]
s_branch k_cold2_163
k_T0_161:
s_waitcnt vmcnt(2)
v_smfmac_f32_16x16x64_bf16 v[40:43], v[4:7], v[48:55], v1
s_waitcnt vmcnt(1)
v_cmp_u_f32 vcc, v4, v8
v_smfmac_f32_16x16x64_bf16 v[24:27], v[8:11], a[24:31], v1
v_smfmac_f32_16x16x64_bf16 v[28:31], v[8:11], a[32:39], v1
s_cbranch_vccnz k_cold_162
k_okC_164:
s_waitcnt vmcnt(1)
v_smfmac_f32_16x16x64_bf16 v[36:39], v[8:11], a[40:47], v1
s_waitcnt lgkmcnt(0)
ds_read_b128 v[48:51], v2 offset:0
v_smfmac_f32_16x16x64_bf16 v[32:35], v[4:7], v[64:71], v1
ds_read_b128 v[52:55], v2 offset:1024
ds_read_b128 v[64:67], v0 offset:38912
v_smfmac_f32_16x16x64_bf16 v[44:47], v[4:7], v[56:63], v1
ds_read_b128 v[68:71], v0 offset:39936
v_smfmac_f32_16x16x64_bf16 v[28:31], v[4:7], a[8:15], v1
v_smfmac_f32_16x16x64_bf16 v[24:27], v[4:7], a[0:7], v1
ds_read_b128 v[56:59], v2 offset:28672
v_smfmac_f32_16x16x64_bf16 v[36:39], v[4:7], a[16:23], v1
ds_read_b128 v[60:63], v2 offset:29696
s_waitcnt lgkmcnt(4)
v_smfmac_f32_16x16x64_bf16 v[40:43], v[8:11], v[48:55], v1
s_waitcnt vmcnt(0)
ds_write_b128 v0, v[12:15] offset:2048
s_waitcnt lgkmcnt(3)
v_smfmac_f32_16x16x64_bf16 v[32:35], v[8:11], v[64:71], v1
buffer_load_dwordx4 v[16:19], v0, s[4:7], s35 offen offset:0 sc1
v_cmp_u_f32 vcc, v12, v12
s_waitcnt lgkmcnt(1)
v_smfmac_f32_16x16x64_bf16 v[44:47], v[8:11], v[56:63], v1
ds_read_b128 v[56:59], v2 offset:2048
ds_read_b128 v[60:63], v2 offset:3072
ds_read_b128 v[64:67], v0 offset:45056
s_cbranch_vccnz k_coldA_165
k_okA_166:
v_smfmac_f32_16x16x64_bf16 v[36:39], v[12:15], a[64:71], v1
ds_read_b128 v[68:71], v0 offset:46080
s_waitcnt lgkmcnt(4)
v_smfmac_f32_16x16x64_bf16 v[40:43], v[12:15], a[72:79], v1
s_barrier
v_smfmac_f32_16x16x64_bf16 v[28:31], v[12:15], a[56:63], v1
ds_read_b128 v[8:11], v0 offset:3072
buffer_load_dwordx4 v[48:51], v0, s[4:7], s36 offen offset:0 sc1
s_waitcnt lgkmcnt(3)
v_smfmac_f32_16x16x64_bf16 v[44:47], v[12:15], v[56:63], v1
ds_read_b128 v[56:59], v2 offset:4096
v_smfmac_f32_16x16x64_bf16 v[24:27], v[12:15], a[48:55], v1
ds_read_b128 v[60:63], v2 offset:5120
s_waitcnt lgkmcnt(3)
v_smfmac_f32_16x16x64_bf16 v[32:35], v[12:15], v[64:71], v1
buffer_load_dwordx4 v[52:55], v0, s[4:7], s36 offen offset:1024 sc1
s_waitcnt lgkmcnt(2)
v_smfmac_f32_16x16x64_bf16 v[24:27], v[8:11], a[80:87], v1
ds_read_b128 v[64:67], v0 offset:47104
ds_read_b128 v[68:71], v0 offset:48128
v_smfmac_f32_16x16x64_bf16 v[36:39], v[8:11], a[96:103], v1
buffer_store_dword v3, v0, s[20:23], s63 offen
s_waitcnt lgkmcnt(2)
ds_read_b128 v[4:7], v0 offset:0
v_smfmac_f32_16x16x64_bf16 v[44:47], v[8:11], v[56:63], v1
ds_read_b128 v[56:59], v0 offset:49152
ds_read_b128 v[60:63], v0 offset:50176
v_smfmac_f32_16x16x64_bf16 v[28:31], v[8:11], a[88:95], v1
buffer_store_dwordx4 v[12:15], v0, s[8:11], s37 offen offset:2048 sc1
v_smfmac_f32_16x16x64_bf16 v[40:43], v[8:11], a[104:111], v1
s_waitcnt lgkmcnt(3)
s_waitcnt lgkmcnt(2)
v_smfmac_f32_16x16x64_bf16 v[32:35], v[8:11], v[64:71], v1
ds_read_b128 v[64:67], v0 offset:40960
ds_read_b128 v[12:15], v0 offset:1024
v_smfmac_f32_16x16x64_bf16 v[36:39], v[4:7], a[128:135], v1
s_waitcnt lgkmcnt(2)
v_smfmac_f32_16x16x64_bf16 v[44:47], v[4:7], v[56:63], v1
ds_read_b128 v[68:71], v0 offset:41984
buffer_load_dwordx4 v[56:59], v0, s[4:7], s36 offen offset:2048 sc1
v_smfmac_f32_16x16x64_bf16 v[28:31], v[4:7], a[120:127], v1
v_smfmac_f32_16x16x64_bf16 v[24:27], v[4:7], a[112:119], v1
s_waitcnt vmcnt(5)
ds_write_b128 v0, v[16:19] offset:6144
v_smfmac_f32_16x16x64_bf16 v[40:43], v[4:7], a[136:143], v1
s_waitcnt lgkmcnt(1)
buffer_load_dwordx4 v[60:63], v0, s[4:7], s36 offen offset:3072 sc1
v_cmp_u_f32 vcc, v16, v16
v_smfmac_f32_16x16x64_bf16 v[32:35], v[4:7], v[64:71], v1
ds_read_b128 v[64:67], v0 offset:43008
ds_read_b128 v[68:71], v0 offset:44032
v_smfmac_f32_16x16x64_bf16 v[28:31], v[12:15], a[152:159], v1
v_smfmac_f32_16x16x64_bf16 v[24:27], v[12:15], a[144:151], v1
s_cbranch_vccnz k_coldB_167
k_okB_168:
v_smfmac_f32_16x16x64_bf16 v[36:39], v[12:15], a[160:167], v1
s_waitcnt lgkmcnt(2)
buffer_store_dwordx4 v[16:19], v0, s[8:11], s59 offen offset:2048 sc1
s_barrier
ds_read_b128 v[4:7], v0 offset:4096
v_smfmac_f32_16x16x64_bf16 v[44:47], v[12:15], a[176:183], v1
ds_read_b128 v[8:11], v0 offset:7168
s_waitcnt lgkmcnt(2)
v_smfmac_f32_16x16x64_bf16 v[32:35], v[12:15], v[64:71], v1
ds_read_b128 v[64:67], v2 offset:34816
ds_read_b128 v[68:71], v2 offset:35840
v_smfmac_f32_16x16x64_bf16 v[24:27], v[16:19], a[184:191], v1
v_smfmac_f32_16x16x64_bf16 v[40:43], v[12:15], a[168:175], v1
s_waitcnt lgkmcnt(3)
ds_read_b128 v[12:15], v0 offset:5120
v_smfmac_f32_16x16x64_bf16 v[24:27], v[4:7], a[208:215], v1
s_waitcnt lgkmcnt(3)
v_smfmac_f32_16x16x64_bf16 v[28:31], v[4:7], a[216:223], v1
v_smfmac_f32_16x16x64_bf16 v[28:31], v[8:11], a[200:207], v1
s_waitcnt lgkmcnt(1)
v_smfmac_f32_16x16x64_bf16 v[24:27], v[8:11], v[64:71], v1
ds_read_b128 v[64:67], v2 offset:6144
s_waitcnt lgkmcnt(1)
v_smfmac_f32_16x16x64_bf16 v[24:27], v[12:15], a[224:231], v1
ds_read_b128 v[68:71], v2 offset:7168
v_smfmac_f32_16x16x64_bf16 v[28:31], v[12:15], a[232:239], v1
v_smfmac_f32_16x16x64_bf16 v[28:31], v[16:19], a[192:199], v1
v_cvt_pk_bf16_f32 v24, v24, v25
v_cvt_pk_bf16_f32 v25, v26, v27
v_smfmac_f32_16x16x64_bf16 v[32:35], v[4:7], v[80:87], v1
v_cvt_pk_bf16_f32 v26, v28, v29
v_cvt_pk_bf16_f32 v27, v30, v31
v_smfmac_f32_16x16x64_bf16 v[32:35], v[8:11], a[248:255], v1
s_waitcnt lgkmcnt(0)
v_mfma_f32_16x16x32_bf16 v[28:31], v[24:27], v[20:23], 0
v_and_b32 v26, 0xffffff7f, v0
v_smfmac_f32_16x16x64_bf16 v[32:35], v[16:19], v[64:71], v1
v_and_or_b32 v26, v1, 8, v26
v_mul_f32 v28, s51, v28
v_mul_f32 v29, s51, v29
v_mul_f32 v31, s51, v31
v_cvt_pk_bf16_f32 v24, v28, v29
v_mul_f32 v30, s51, v30
v_cvt_pk_bf16_f32 v25, v30, v31
v_smfmac_f32_16x16x64_bf16 v[32:35], v[12:15], v[96:103], v1
ds_write_b64 v26, v[24:25] offset:1024
v_smfmac_f32_16x16x64_bf16 v[36:39], v[8:11], v[72:79], v1
v_cvt_pk_bf16_f32 v32, v32, v33
v_smfmac_f32_16x16x64_bf16 v[36:39], v[16:19], a[240:247], v1
buffer_load_dwordx4 v[64:67], v0, s[4:7], s61 offen offset:0
v_cvt_pk_bf16_f32 v33, v34, v35
v_smfmac_f32_16x16x64_bf16 v[36:39], v[12:15], v[104:111], v1
s_waitcnt lgkmcnt(0)
v_smfmac_f32_16x16x64_bf16 v[36:39], v[4:7], v[88:95], v1
s_barrier
ds_read_b128 v[24:27], v0 offset:0
v_smfmac_f32_16x16x64_bf16 v[40:43], v[4:7], v[144:151], v1
ds_read_b128 v[28:31], v0 offset:1024
s_nop 0
v_cvt_pk_bf16_f32 v34, v36, v37
v_cvt_pk_bf16_f32 v35, v38, v39
s_nop 1
v_mfma_f32_16x16x32_bf16 v[36:39], v[32:35], v[20:23], 0
s_waitcnt vmcnt(6)
buffer_load_dwordx4 v[68:71], v0, s[4:7], s61 offen offset:1024
v_and_b32 v34, 0xffffff7f, v0
v_and_or_b32 v34, v1, 8, v34
s_waitcnt lgkmcnt(1)
v_mfma_f32_16x16x32_bf16 v[48:51], v[48:51], v[24:27], 0
v_cvt_pk_bf16_f32 v32, v36, v37
s_waitcnt lgkmcnt(0)
v_mfma_f32_16x16x32_bf16 v[48:51], v[52:55], v[28:31], v[48:51]
v_mov_b64 v[52:53], s[56:57]
v_cvt_pk_bf16_f32 v33, v38, v39
v_smfmac_f32_16x16x64_bf16 v[44:47], v[4:7], v[152:159], v1
ds_write_b64 v34, v[32:33] offset:3072
v_permlane32_swap_b32 v48, v50
v_permlane32_swap_b32 v49, v51
v_add_f32_dpp v52, v50, v48 row_ror:8 row_mask:0xf bank_mask:0x3
v_exp_f32 v52, v52
v_add_f32_dpp v53, v51, v49 row_ror:8 row_mask:0xf bank_mask:0x3
v_exp_f32 v53, v53
s_nop 0
v_cvt_pk_bf16_f32 v48, v52, v53
v_smfmac_f32_16x16x64_bf16 v[44:47], v[16:19], v[120:127], v1
ds_write_b32 v0, v48 offset:4104
v_smfmac_f32_16x16x64_bf16 v[44:47], v[12:15], v[168:175], v1
buffer_load_dwordx4 v[48:51], v0, s[4:7], s61 offen offset:2048
v_smfmac_f32_16x16x64_bf16 v[40:43], v[12:15], v[160:167], v1
s_waitcnt lgkmcnt(1)
v_xor_b32 v12, 0x80, v0
v_smfmac_f32_16x16x64_bf16 v[40:43], v[8:11], v[128:135], v1
s_waitcnt lgkmcnt(0)
s_barrier
ds_read_b128 v[32:35], v0 offset:2048
v_mov_b64 v[22:23], s[52:53]
v_smfmac_f32_16x16x64_bf16 v[40:43], v[16:19], v[112:119], v1
ds_read_b128 v[36:39], v0 offset:3072
ds_read_b128 v[16:19], v0 offset:4096
buffer_load_dwordx4 v[52:55], v0, s[4:7], s61 offen offset:3072
v_smfmac_f32_16x16x64_bf16 v[44:47], v[8:11], v[136:143], v1
ds_read_b128 v[12:15], v12 offset:4096
v_cvt_pk_bf16_f32 v40, v40, v41
v_mov_b64 v[20:21], s[52:53]
s_waitcnt lgkmcnt(3)
v_mfma_f32_16x16x32_bf16 v[24:27], v[32:35], v[24:27], 0
v_cvt_pk_bf16_f32 v41, v42, v43
s_waitcnt lgkmcnt(2)
v_mfma_f32_16x16x32_bf16 v[24:27], v[36:39], v[28:31], v[24:27]
s_waitcnt vmcnt(5)
s_waitcnt lgkmcnt(1)
v_mfma_f32_16x16x32_bf16 v[8:11], v[56:59], v[16:19], 0
buffer_load_dwordx4 v[56:59], v0, s[4:7], s62 offen offset:0
v_mov_b64 v[28:29], s[56:57]
v_cvt_pk_bf16_f32 v43, v46, v47
v_cvt_pk_bf16_f32 v42, v44, v45
v_permlane32_swap_b32 v25, v27
v_permlane32_swap_b32 v24, v26
v_mfma_f32_16x16x32_bf16 v[4:7], v[20:23], v[16:19], 0
s_waitcnt lgkmcnt(0)
v_add_f32_dpp v28, v26, v24 row_ror:8 row_mask:0xf bank_mask:0x3
v_add_f32_dpp v29, v27, v25 row_ror:8 row_mask:0xf bank_mask:0x3
v_exp_f32 v28, v28
v_mfma_f32_16x16x32_bf16 v[8:11], v[60:63], v[12:15], v[8:11]
buffer_load_dwordx4 v[60:63], v0, s[4:7], s62 offen offset:1024
v_exp_f32 v29, v29
v_permlane32_swap_b32 v42, v43
v_cvt_pk_bf16_f32 v24, v28, v29
v_mov_b64 v[44:45], s[54:55]
v_cvt_pk_bf16_f32 v25, v28, v29
v_mov_b32_dpp v26, v24 row_ror:8 row_mask:0xf bank_mask:0xf
v_mov_b32_dpp v27, v24 row_ror:8 row_mask:0xf bank_mask:0xf
v_mfma_f32_16x16x16_bf16 v[4:7], v[44:45], v[24:25], v[4:7]
v_permlane32_swap_b32 v40, v41
v_mov_b64 v[36:37], 0
v_mov_b64 v[38:39], 0
v_mov_b64 v[30:31], 0
v_mfma_f32_16x16x32_bf16 v[8:11], v[40:43], v[24:27], v[8:11]
buffer_load_dwordx4 v[16:19], v0, s[4:7], s62 offen offset:2048
v_rcp_f32 v6, v4
v_and_b32 v12, 0xffffff7f, v0
v_and_or_b32 v13, v1, 8, v12
v_rcp_f32_dpp v6, v4 row_ror:8 row_mask:0xf bank_mask:0xc
v_mov_b64 v[26:27], 0
v_pk_mul_f32 v[8:9], v[8:9], v[6:7] op_sel_hi:[1,0]
v_cvt_pk_bf16_f32 v44, v8, v9
v_pk_mul_f32 v[10:11], v[10:11], v[6:7] op_sel_hi:[1,0]
v_cvt_pk_bf16_f32 v45, v10, v11
s_waitcnt vmcnt(5)
ds_write_b64 v13, v[44:45] offset:7168
buffer_load_dwordx4 v[20:23], v0, s[4:7], s62 offen offset:3072
v_add_u32 v6, 0xd4800000, v6
v_cmp_lt_u32 vcc, 0x28000000, v6
v_mov_b64 v[34:35], 0
v_mov_b32_dpp v46, v44 row_ror:8 row_mask:0xf bank_mask:0xf
v_mov_b32_dpp v47, v45 row_ror:8 row_mask:0xf bank_mask:0xf
v_mov_b64 v[28:29], 0
v_mov_b64 v[32:33], 0
s_cbranch_vccnz k_slow_169
k_okS_170:
v_smfmac_f32_16x16x64_bf16 v[36:39], v[44:47], v[224:231], v1
s_waitcnt lgkmcnt(0)
s_barrier
ds_read_b128 v[8:11], v12 offset:6144
v_smfmac_f32_16x16x64_bf16 v[32:35], v[44:47], v[200:207], v1
s_waitcnt vmcnt(4)
ds_read_b128 v[4:7], v12 offset:7296
v_mov_b64 v[24:25], 0
v_smfmac_f32_16x16x64_bf16 v[28:31], v[44:47], v[48:55], v1
ds_read_b128 v[12:15], v12 offset:6272
ds_read_b128 v[48:51], v2 offset:26624
v_smfmac_f32_16x16x64_bf16 v[24:27], v[44:47], v[64:71], v1
ds_read_b128 v[52:55], v2 offset:27648
v_mov_b64 v[42:43], 0
s_waitcnt lgkmcnt(4)
v_smfmac_f32_16x16x64_bf16 v[24:27], v[8:11], v[184:191], v1
s_waitcnt lgkmcnt(3)
v_mov_b64 v[40:41], 0
v_smfmac_f32_16x16x64_bf16 v[24:27], v[4:7], v[176:183], v1
s_waitcnt lgkmcnt(2)
ds_read_b128 v[64:67], v2 offset:10240
v_smfmac_f32_16x16x64_bf16 v[24:27], v[12:15], v[192:199], v1
ds_read_b128 v[68:71], v2 offset:11264
v_smfmac_f32_16x16x64_bf16 v[40:43], v[44:47], v[240:247], v1
s_waitcnt vmcnt(2)
s_waitcnt lgkmcnt(2)
v_lshrrev_b32 v44, 16, v1
v_cvt_pk_bf16_f32 v24, v24, v25
v_bfi_b32 v24, 1, s45, v24
v_cvt_pk_bf16_f32 v25, v26, v27
v_smfmac_f32_16x16x64_bf16 v[28:31], v[8:11], v[48:55], v1
buffer_store_dwordx2 v[24:25], v44, s[4:7], s38 offen
ds_read_b128 v[48:51], v2 offset:24576
ds_read_b128 v[52:55], v2 offset:25600
v_smfmac_f32_16x16x64_bf16 v[28:31], v[12:15], v[56:63], v1
s_waitcnt lgkmcnt(2)
ds_read_b128 v[56:59], v2 offset:8192
v_smfmac_f32_16x16x64_bf16 v[28:31], v[4:7], v[64:71], v1
ds_read_b128 v[60:63], v2 offset:9216
v_smfmac_f32_16x16x64_bf16 v[32:35], v[8:11], v[208:215], v1
ds_read_b128 v[64:67], v2 offset:30720
s_nop 0
v_cvt_pk_bf16_f32 v28, v28, v29
v_bfi_b32 v28, 1, s45, v28
v_cvt_pk_bf16_f32 v29, v30, v31
v_smfmac_f32_16x16x64_bf16 v[32:35], v[12:15], v[216:223], v1
buffer_store_dwordx2 v[28:29], v44, s[4:7], s39 offen
v_smfmac_f32_16x16x64_bf16 v[40:43], v[12:15], v[248:255], v1
ds_read_b128 v[68:71], v2 offset:31744
s_waitcnt vmcnt(2)
v_smfmac_f32_16x16x64_bf16 v[32:35], v[4:7], v[16:23], v1
s_waitcnt lgkmcnt(2)
v_smfmac_f32_16x16x64_bf16 v[36:39], v[12:15], v[232:239], v1
ds_read_b128 v[16:19], v2 offset:32768
ds_read_b128 v[20:23], v2 offset:33792
v_cvt_pk_bf16_f32 v32, v32, v33
v_bfi_b32 v32, 1, s45, v32
v_cvt_pk_bf16_f32 v33, v34, v35
v_smfmac_f32_16x16x64_bf16 v[36:39], v[8:11], v[48:55], v1
buffer_store_dwordx2 v[32:33], v44, s[4:7], s40 offen
s_waitcnt lgkmcnt(2)
v_smfmac_f32_16x16x64_bf16 v[36:39], v[4:7], v[64:71], v1
s_nop 6
v_cvt_pk_bf16_f32 v36, v36, v37
v_cvt_pk_bf16_f32 v37, v38, v39
s_waitcnt lgkmcnt(0)
v_bfi_b32 v36, 1, s45, v36
v_smfmac_f32_16x16x64_bf16 v[40:43], v[8:11], v[16:23], v1
buffer_store_dwordx2 v[36:37], v44, s[4:7], s41 offen
v_smfmac_f32_16x16x64_bf16 v[40:43], v[4:7], v[56:63], v1
s_nop 6
v_cvt_pk_bf16_f32 v40, v40, v41
v_bfi_b32 v40, 1, s45, v40
v_cvt_pk_bf16_f32 v41, v42, v43
buffer_store_dwordx2 v[40:41], v44, s[4:7], s42 offen
s_barrier
v_lshlrev_b32 v23, v0, s58
v_cndmask_b32 v16, 0, v23, s[12:13]
v_cndmask_b32 v17, 0, v23, s[14:15]
v_cndmask_b32 v18, 0, v23, s[16:17]
v_cndmask_b32 v19, 0, v23, s[18:19]
v_and_b32 v45, 0x30, v0
v_lshrrev_b32 v46, 8, v0
v_lshl_or_b32 v45, v46, 2, v45
v_bfe_u32 v46, v0, 6, 1
v_lshl_or_b32 v45, v46, 7, v45
v_cndmask_b32 v45, v45, 2.0, s[98:99]
buffer_load_dwordx4 v[48:51], v0, s[4:7], s60 offen offset:0
buffer_load_dwordx4 v[52:55], v0, s[4:7], s60 offen offset:1024
buffer_load_dwordx4 v[56:59], v0, s[4:7], s60 offen offset:2048
buffer_load_dwordx4 v[60:63], v0, s[4:7], s60 offen offset:3072
v_cndmask_b32 v20, 0, v23, s[90:91]
v_cndmask_b32 v21, 0, v23, s[92:93]
v_cndmask_b32 v22, 0, v23, s[94:95]
v_cndmask_b32 v23, 0, v23, s[96:97]
s_waitcnt vmcnt(4)
buffer_load_dwordx4 v[24:27], v0, s[4:7], s43 offen offset:0 sc1
buffer_load_dwordx4 v[28:31], v0, s[4:7], s43 offen offset:1024 sc1
buffer_load_dwordx4 v[32:35], v0, s[4:7], s43 offen offset:2048 sc1
buffer_load_dwordx4 v[36:39], v0, s[4:7], s43 offen offset:3072 sc1
s_add_u32 s33, s33, 16384
s_bitset0_b32 s33, 16
s_waitcnt vmcnt(3)
v_mfma_f32_16x16x32_bf16 v[40:43], v[24:27], v[16:19], 0
s_waitcnt vmcnt(2)
v_mfma_f32_16x16x32_bf16 v[40:43], v[28:31], v[16:19], v[40:43]
v_bitop3_b32 v46, v24, v28, s45 bitop3:0x7e
s_waitcnt vmcnt(1)
v_mfma_f32_16x16x32_bf16 v[40:43], v[32:35], v[16:19], v[40:43]
s_waitcnt vmcnt(0)
v_mfma_f32_16x16x32_bf16 v[40:43], v[36:39], v[16:19], v[40:43]
v_bitop3_b32 v47, v32, v36, s45 bitop3:0x7e
v_bitop3_b32 v46, v46, v47, 1 bitop3:0xa8
v_cmp_ne_u32 vcc, 0, v46
v_mov_b64 v[24:25], 0
v_mov_b64 v[26:27], 0
v_mov_b64 v[28:29], 0
v_mov_b64 v[30:31], 0
v_permlane32_swap_b32 v40, v41
v_permlane32_swap_b32 v42, v43
v_add_f32 v40, v40, v41
v_add_f32 v41, v42, v43
v_cvt_pk_bf16_f32 v42, v40, v41
s_cbranch_vccnz k_r1_172
k_ok1_173:
buffer_store_dword v42, v45, s[4:7], s44 offen
s_barrier
buffer_load_dwordx4 v[4:7], v0, s[4:7], s33 offen offset:0 sc1
buffer_load_dwordx4 v[8:11], v0, s[4:7], s33 offen offset:1024 sc1
s_add_u32 s34, s33, 4096
s_add_u32 s35, s33, 8192
s_add_u32 s36, s36, 524288
s_add_u32 s37, s37, 10240
s_add_u32 s59, s59, 10240
s_add_u32 s63, s63, 16384
s_bitset0_b32 s63, 16
v_mov_b64 v[32:33], 0
v_mov_b64 v[34:35], 0
v_mov_b64 v[36:37], 0
v_mov_b64 v[38:39], 0
v_mov_b64 v[40:41], 0
v_mov_b64 v[42:43], 0
v_mov_b64 v[44:45], 0
v_mov_b64 v[46:47], 0
s_add_u32 s44, s44, 16384
s_bitset0_b32 s44, 16
s_sub_u32 s45, s45, 1
s_add_u32 s31, s31, 1
ds_read_b128 v[64:67], v0 offset:36864
ds_read_b128 v[68:71], v0 offset:37888
buffer_load_dwordx4 v[12:15], v0, s[4:7], s34 offen offset:0 sc1
s_cmp_lg_u32 s31, s47
s_cbranch_scc1 k_T0_161
s_branch k_done_171
k_cold2_163:
s_barrier
buffer_load_dwordx4 v[48:51], v0, s[4:7], s60 offen offset:0
buffer_load_dwordx4 v[52:55], v0, s[4:7], s60 offen offset:1024
buffer_load_dwordx4 v[56:59], v0, s[4:7], s60 offen offset:2048
buffer_load_dwordx4 v[60:63], v0, s[4:7], s60 offen offset:3072
ds_read_b128 v[64:67], v0 offset:36864
ds_read_b128 v[68:71], v0 offset:37888
k_cold_162:
buffer_load_dwordx4 v[4:7], v0, s[4:7], s33 offen offset:0 sc1
buffer_load_dwordx4 v[8:11], v0, s[4:7], s33 offen offset:1024 sc1
buffer_load_dwordx4 v[12:15], v0, s[4:7], s34 offen offset:0 sc1
s_sub_u32 s32, s32, 1
s_cmp_gt_i32 s32, 0
s_cbranch_scc0 k_okC_164
v_mov_b64 v[24:25], 0
v_mov_b64 v[26:27], 0
v_mov_b64 v[28:29], 0
v_mov_b64 v[30:31], 0
v_mov_b64 v[32:33], 0
v_mov_b64 v[34:35], 0
v_mov_b64 v[36:37], 0
v_mov_b64 v[38:39], 0
v_mov_b64 v[40:41], 0
v_mov_b64 v[42:43], 0
v_mov_b64 v[44:45], 0
v_mov_b64 v[46:47], 0
s_branch k_T0_161
k_coldA_165:
buffer_load_dwordx4 v[12:15], v0, s[4:7], s34 offen offset:0 sc1
s_sub_u32 s32, s32, 1
s_cmp_gt_i32 s32, 0
s_waitcnt vmcnt(0)
v_cmp_u_f32 vcc, v12, v12
ds_write_b128 v0, v[12:15] offset:2048
s_waitcnt lgkmcnt(0)
s_cbranch_vccz k_okA_166
s_cbranch_scc1 k_coldA_165
s_branch k_okA_166
k_coldB_167:
buffer_load_dwordx4 v[16:19], v0, s[4:7], s35 offen offset:0 sc1
s_sub_u32 s32, s32, 1
s_cmp_gt_i32 s32, 0
s_waitcnt vmcnt(0)
v_cmp_u_f32 vcc, v16, v16
ds_write_b128 v0, v[16:19] offset:6144
s_waitcnt lgkmcnt(0)
s_cbranch_vccz k_okB_168
s_cbranch_scc1 k_coldB_167
s_branch k_okB_168
k_r1_172:
buffer_load_dwordx4 v[24:27], v0, s[4:7], s43 offen offset:0 sc1
buffer_load_dwordx4 v[28:31], v0, s[4:7], s43 offen offset:1024 sc1
buffer_load_dwordx4 v[32:35], v0, s[4:7], s43 offen offset:2048 sc1
buffer_load_dwordx4 v[36:39], v0, s[4:7], s43 offen offset:3072 sc1
s_sub_u32 s32, s32, 1
s_cmp_gt_i32 s32, 0
s_waitcnt vmcnt(3)
v_mfma_f32_16x16x32_bf16 v[40:43], v[24:27], v[16:19], 0
s_waitcnt vmcnt(2)
v_mfma_f32_16x16x32_bf16 v[40:43], v[28:31], v[16:19], v[40:43]
v_bitop3_b32 v46, v24, v28, s45 bitop3:0x7e
s_waitcnt vmcnt(1)
v_mfma_f32_16x16x32_bf16 v[40:43], v[32:35], v[16:19], v[40:43]
s_waitcnt vmcnt(0)
v_mfma_f32_16x16x32_bf16 v[40:43], v[36:39], v[16:19], v[40:43]
v_bitop3_b32 v47, v32, v36, s45 bitop3:0x7e
v_bitop3_b32 v46, v46, v47, 1 bitop3:0xa8
v_cmp_ne_u32 vcc, 0, v46
v_mov_b64 v[24:25], 0
v_mov_b64 v[26:27], 0
v_mov_b64 v[28:29], 0
v_mov_b64 v[30:31], 0
v_permlane32_swap_b32 v40, v41
v_permlane32_swap_b32 v42, v43
v_add_f32 v40, v40, v41
v_add_f32 v41, v42, v43
v_cvt_pk_bf16_f32 v42, v40, v41
s_cbranch_vccz k_ok1_173
s_cbranch_scc1 k_r1_172
s_branch k_ok1_173
k_slow_169:
ds_read_b128 v[24:27], v0 offset:0
ds_read_b128 v[28:31], v0 offset:1024
v_mov_b32 v46, 0xff7fffff
s_add_u32 s48, s36, 0xffffe000
buffer_load_dwordx4 v[32:35], v0, s[4:7], s48 offen offset:0 sc1
buffer_load_dwordx4 v[36:39], v0, s[4:7], s48 offen offset:1024 sc1
s_waitcnt vmcnt(1) lgkmcnt(1)
v_mfma_f32_16x16x32_bf16 v[4:7], v[32:35], v[24:27], 0
s_waitcnt vmcnt(0) lgkmcnt(0)
v_mfma_f32_16x16x32_bf16 v[4:7], v[36:39], v[28:31], v[4:7]
v_mov_b64 v[8:9], s[56:57]
s_nop 5
v_permlane32_swap_b32 v4, v6
v_permlane32_swap_b32 v5, v7
v_add_f32_dpp v8, v6, v4 row_ror:8 row_mask:0xf bank_mask:0x3
s_nop 0
v_add_f32_dpp v9, v7, v5 row_ror:8 row_mask:0xf bank_mask:0x3
v_max3_f32 v46, v46, v8, v9
s_add_u32 s48, s36, 0xfffff000
buffer_load_dwordx4 v[32:35], v0, s[4:7], s48 offen offset:0 sc1
buffer_load_dwordx4 v[36:39], v0, s[4:7], s48 offen offset:1024 sc1
s_waitcnt vmcnt(1)
v_mfma_f32_16x16x32_bf16 v[4:7], v[32:35], v[24:27], 0
s_waitcnt vmcnt(0)
v_mfma_f32_16x16x32_bf16 v[4:7], v[36:39], v[28:31], v[4:7]
v_mov_b64 v[10:11], s[56:57]
s_nop 5
v_permlane32_swap_b32 v4, v6
v_permlane32_swap_b32 v5, v7
v_add_f32_dpp v10, v6, v4 row_ror:8 row_mask:0xf bank_mask:0x3
s_nop 0
v_add_f32_dpp v11, v7, v5 row_ror:8 row_mask:0xf bank_mask:0x3
v_max3_f32 v46, v46, v10, v11
s_add_u32 s48, s36, 0x0
buffer_load_dwordx4 v[32:35], v0, s[4:7], s48 offen offset:0 sc1
buffer_load_dwordx4 v[36:39], v0, s[4:7], s48 offen offset:1024 sc1
s_waitcnt vmcnt(1)
v_mfma_f32_16x16x32_bf16 v[4:7], v[32:35], v[24:27], 0
s_waitcnt vmcnt(0)
v_mfma_f32_16x16x32_bf16 v[4:7], v[36:39], v[28:31], v[4:7]
v_mov_b64 v[12:13], s[56:57]
s_nop 5
v_permlane32_swap_b32 v4, v6
v_permlane32_swap_b32 v5, v7
v_add_f32_dpp v12, v6, v4 row_ror:8 row_mask:0xf bank_mask:0x3
s_nop 0
v_add_f32_dpp v13, v7, v5 row_ror:8 row_mask:0xf bank_mask:0x3
v_max3_f32 v46, v46, v12, v13
s_add_u32 s48, s36, 0x1000
buffer_load_dwordx4 v[32:35], v0, s[4:7], s48 offen offset:0 sc1
buffer_load_dwordx4 v[36:39], v0, s[4:7], s48 offen offset:1024 sc1
s_waitcnt vmcnt(1)
v_mfma_f32_16x16x32_bf16 v[4:7], v[32:35], v[24:27], 0
s_waitcnt vmcnt(0)
v_mfma_f32_16x16x32_bf16 v[4:7], v[36:39], v[28:31], v[4:7]
v_mov_b64 v[14:15], s[56:57]
s_nop 5
v_permlane32_swap_b32 v4, v6
v_permlane32_swap_b32 v5, v7
v_add_f32_dpp v14, v6, v4 row_ror:8 row_mask:0xf bank_mask:0x3
s_nop 0
v_add_f32_dpp v15, v7, v5 row_ror:8 row_mask:0xf bank_mask:0x3
v_max3_f32 v46, v46, v14, v15
ds_read_b128 v[32:35], v0 offset:2048
ds_read_b128 v[36:39], v0 offset:3072
s_waitcnt lgkmcnt(1)
v_mfma_f32_16x16x32_bf16 v[4:7], v[32:35], v[24:27], 0
s_waitcnt lgkmcnt(0)
v_mfma_f32_16x16x32_bf16 v[4:7], v[36:39], v[28:31], v[4:7]
v_mov_b64 v[44:45], s[56:57]
s_nop 5
v_permlane32_swap_b32 v4, v6
v_permlane32_swap_b32 v5, v7
v_add_f32_dpp v44, v6, v4 row_ror:8 row_mask:0xf bank_mask:0x3
s_nop 0
v_add_f32_dpp v45, v7, v5 row_ror:8 row_mask:0xf bank_mask:0x3
v_max3_f32 v46, v46, v44, v45
buffer_load_dwordx4 v[32:35], v0, s[4:7], s36 offen offset:2048 sc1
buffer_load_dwordx4 v[36:39], v0, s[4:7], s36 offen offset:3072 sc1
v_mov_b32 v47, v46
s_nop 1
v_permlane32_swap_b32 v46, v47
v_max_f32 v46, v46, v47
v_mov_b32 v47, v46
s_nop 1
v_permlane16_swap_b32 v46, v47
v_max_f32 v46, v46, v47
v_sub_f32 v8, v8, v46
v_exp_f32 v8, v8
v_sub_f32 v9, v9, v46
v_exp_f32 v9, v9
v_sub_f32 v10, v10, v46
v_exp_f32 v10, v10
v_sub_f32 v11, v11, v46
v_exp_f32 v11, v11
v_sub_f32 v12, v12, v46
v_exp_f32 v12, v12
v_sub_f32 v13, v13, v46
v_exp_f32 v13, v13
v_sub_f32 v14, v14, v46
v_exp_f32 v14, v14
v_sub_f32 v15, v15, v46
v_exp_f32 v15, v15
v_sub_f32 v44, v44, v46
v_exp_f32 v44, v44
v_sub_f32 v45, v45, v46
v_exp_f32 v45, v45
v_cvt_pk_bf16_f32 v4, v8, v9
v_cvt_pk_bf16_f32 v5, v10, v11
v_cvt_pk_bf16_f32 v6, v12, v13
v_cvt_pk_bf16_f32 v7, v14, v15
v_mov_b32_dpp v8, v4 row_ror:8 row_mask:0xf bank_mask:0xf
v_mov_b32_dpp v9, v5 row_ror:8 row_mask:0xf bank_mask:0xf
v_mov_b32_dpp v10, v6 row_ror:8 row_mask:0xf bank_mask:0xf
v_mov_b32_dpp v11, v7 row_ror:8 row_mask:0xf bank_mask:0xf
v_cvt_pk_bf16_f32 v24, v44, v45
v_cvt_pk_bf16_f32 v25, v44, v45
s_nop 0
v_mov_b32_dpp v26, v24 row_ror:8 row_mask:0xf bank_mask:0xf
v_mov_b32_dpp v27, v24 row_ror:8 row_mask:0xf bank_mask:0xf
v_mov_b64 v[28:29], s[52:53]
v_mov_b64 v[30:31], s[52:53]
s_nop 1
v_mfma_f32_16x16x32_bf16 v[44:47], v[28:31], v[4:7], 0
s_waitcnt vmcnt(1)
v_mfma_f32_16x16x32_bf16 v[12:15], v[32:35], v[4:7], 0
s_waitcnt vmcnt(0)
v_mfma_f32_16x16x32_bf16 v[12:15], v[36:39], v[8:11], v[12:15]
v_mfma_f32_16x16x32_bf16 v[12:15], v[40:43], v[24:27], v[12:15]
v_mov_b64 v[28:29], s[54:55]
s_nop 1
v_mfma_f32_16x16x16_bf16 v[44:47], v[28:29], v[24:25], v[44:47]
s_nop 6
v_rcp_f32 v4, v44
s_nop 1
v_rcp_f32_dpp v4, v44 row_ror:8 row_mask:0xf bank_mask:0xc
s_nop 0
v_mul_f32 v12, v4, v12
v_mul_f32 v13, v4, v13
v_mul_f32 v14, v4, v14
v_mul_f32 v15, v4, v15
v_cvt_pk_bf16_f32 v44, v12, v13
v_cvt_pk_bf16_f32 v45, v14, v15
v_and_b32 v12, 0xffffff7f, v0
v_and_or_b32 v8, v1, 8, v12
ds_write_b64 v8, v[44:45] offset:7168
v_mov_b32_dpp v46, v44 row_ror:8 row_mask:0xf bank_mask:0xf
v_mov_b32_dpp v47, v45 row_ror:8 row_mask:0xf bank_mask:0xf
v_mov_b64 v[24:25], 0
v_mov_b64 v[26:27], 0
v_mov_b64 v[28:29], 0
v_mov_b64 v[30:31], 0
v_mov_b64 v[32:33], 0
v_mov_b64 v[34:35], 0
v_mov_b64 v[36:37], 0
v_mov_b64 v[38:39], 0
s_waitcnt lgkmcnt(0)
s_branch k_okS_170
k_done_171:
buffer_load_dwordx4 v[16:19], v0, s[4:7], s35 offen offset:0 sc1
k_xs_177:
s_waitcnt vmcnt(1)
v_cmp_u_f32 vcc, v4, v12
s_waitcnt vmcnt(0)
v_cmp_u_f32 s[66:67], v16, v16
s_or_b64 vcc, vcc, s[66:67]
s_cbranch_vccz k_xd_178
buffer_load_dwordx4 v[4:7], v0, s[4:7], s33 offen offset:0 sc1
buffer_load_dwordx4 v[8:11], v0, s[4:7], s33 offen offset:1024 sc1
buffer_load_dwordx4 v[12:15], v0, s[4:7], s34 offen offset:0 sc1
buffer_load_dwordx4 v[16:19], v0, s[4:7], s35 offen offset:0 sc1
s_sub_u32 s32, s32, 1
s_cmp_gt_i32 s32, 0
s_cbranch_scc1 k_xs_177
k_xd_178:
s_waitcnt vmcnt(1)
buffer_store_dwordx4 v[12:15], v0, s[8:11], s37 offen offset:2048 sc1
s_waitcnt vmcnt(1)
buffer_store_dwordx4 v[16:19], v0, s[8:11], s59 offen offset:2048 sc1
s_add_u32 s31, s31, 1
s_cmp_lt_u32 s31, 128
s_cbranch_scc1 k_lay_160
s_add_u32 s30, s30, 112
s_waitcnt vmcnt(0) lgkmcnt(0)
s_barrier
s_branch k_fin_7
k_w3_111:
v_lshrrev_b32 v12, 3, v0
v_lshlrev_b32 v10, 13, v12
v_bfe_u32 v12, v0, 1, 2
v_lshrrev_b32 v13, 4, v0
v_xor_b32 v12, v12, v13
v_lshl_add_u32 v10, v12, 5, v10
v_and_b32 v14, 1, v0
v_lshl_add_u32 v10, v14, 4, v10
v_mul_u32_u24 v11, 1280, v13
v_bfe_u32 v12, v0, 1, 3
v_and_b32 v13, 1, v13
v_lshlrev_b32 v13, 1, v13
v_xor_b32 v12, v12, v13
v_xor_b32 v12, 4, v12
v_lshl_add_u32 v11, v12, 5, v11
v_lshl_add_u32 v11, v14, 4, v11
v_bfe_u32 v12, v0, 5, 1
v_lshlrev_b32 v12, 4, v12
v_bfe_u32 v13, v0, 4, 1
v_lshl_add_u32 v12, v13, 1, v12
v_bfe_u32 v13, v0, 2, 1
v_lshl_add_u32 v12, v13, 2, v12
v_bfe_u32 v13, v0, 3, 1
v_mul_u32_u24 v15, 4224, v13
v_add_u32 v12, v13, v12
v_bfe_u32 v13, v12, 1, 2
v_xor_b32 v13, 3, v13
v_lshlrev_b32 v13, 5, v13
v_lshl_add_u32 v4, v12, 7, v13
v_and_b32 v14, 3, v0
v_lshl_add_u32 v4, v14, 3, v4
v_add_u32 v5, 0x10000, v4
v_add_u32 v6, 0x20000, v4
v_bfe_u32 v12, v0, 4, 1
v_lshlrev_b32 v13, 4, v12
v_lshlrev_b32 v12, 2, v12
v_bfe_u32 v8, v0, 5, 1
v_lshl_add_u32 v13, v8, 2, v13
v_bfe_u32 v8, v0, 2, 1
v_add_u32 v13, v8, v13
v_lshl_add_u32 v12, v8, 1, v12
v_bfe_u32 v8, v0, 3, 1
v_add_u32 v8, 6, v8
v_xor_b32 v12, v12, v8
v_lshlrev_b32 v12, 5, v12
v_lshl_add_u32 v7, v13, 8, v12
v_lshl_add_u32 v7, v14, 3, v7
v_add_u32 v8, 0x10000, v7
v_add_u32 v9, 0x20000, v7
v_lshlrev_b32 v0, 4, v0
v_add_u32 v2, 65536, v0
s_lshl_b32 s49, s30, 8
s_mul_i32 s50, s30, 163840
s_mul_i32 s60, s30, 131072
s_add_u32 s60, s60, 120684544
s_add_u32 s61, s60, 4096
s_add_u32 s62, s60, 8192
s_mov_b32 m0, 6144
s_add_u32 s48, s49, 393216
buffer_load_dwordx4 v10, s[8:11], s48 offen lds
s_mov_b32 m0, 7168
s_add_u32 s48, s49, 458752
buffer_load_dwordx4 v10, s[8:11], s48 offen lds
s_mov_b32 m0, 14336
s_add_u32 s48, s49, 393344
buffer_load_dwordx4 v10, s[8:11], s48 offen lds
s_mov_b32 m0, 15360
s_add_u32 s48, s49, 458880
buffer_load_dwordx4 v10, s[8:11], s48 offen lds
s_mov_b32 m0, 22528
s_add_u32 s48, s49, 393344
buffer_load_dwordx4 v10, s[12:15], s48 offen lds
s_mov_b32 m0, 23552
s_add_u32 s48, s49, 458880
buffer_load_dwordx4 v10, s[12:15], s48 offen lds
s_mov_b32 m0, 30720
s_add_u32 s48, s49, 393216
buffer_load_dwordx4 v10, s[16:19], s48 offen lds
s_mov_b32 m0, 31744
s_add_u32 s48, s49, 458752
buffer_load_dwordx4 v10, s[16:19], s48 offen lds
s_mov_b32 m0, 38912
s_add_u32 s48, s49, 393344
buffer_load_dwordx4 v10, s[16:19], s48 offen lds
s_mov_b32 m0, 39936
s_add_u32 s48, s49, 458880
buffer_load_dwordx4 v10, s[16:19], s48 offen lds
s_mov_b32 m0, 47104
s_add_u32 s48, s49, 917504
buffer_load_dwordx4 v10, s[8:11], s48 offen lds
s_mov_b32 m0, 48128
s_add_u32 s48, s49, 983040
buffer_load_dwordx4 v10, s[8:11], s48 offen lds
s_mov_b32 m0, 55296
s_add_u32 s48, s49, 917632
buffer_load_dwordx4 v10, s[8:11], s48 offen lds
s_mov_b32 m0, 56320
s_add_u32 s48, s49, 983168
buffer_load_dwordx4 v10, s[8:11], s48 offen lds
s_mov_b32 m0, 63488
s_add_u32 s48, s49, 917632
buffer_load_dwordx4 v10, s[12:15], s48 offen lds
s_mov_b32 m0, 64512
s_add_u32 s48, s49, 983168
buffer_load_dwordx4 v10, s[12:15], s48 offen lds
s_mov_b32 m0, 71680
s_add_u32 s48, s49, 917504
buffer_load_dwordx4 v10, s[16:19], s48 offen lds
s_mov_b32 m0, 72704
s_add_u32 s48, s49, 983040
buffer_load_dwordx4 v10, s[16:19], s48 offen lds
s_mov_b32 m0, 79872
s_add_u32 s48, s49, 917632
buffer_load_dwordx4 v10, s[16:19], s48 offen lds
s_mov_b32 m0, 80896
s_add_u32 s48, s49, 983168
buffer_load_dwordx4 v10, s[16:19], s48 offen lds
s_mov_b32 m0, 88064
s_add_u32 s48, s49, 1441792
buffer_load_dwordx4 v10, s[8:11], s48 offen lds
s_mov_b32 m0, 89088
s_add_u32 s48, s49, 1507328
buffer_load_dwordx4 v10, s[8:11], s48 offen lds
s_mov_b32 m0, 96256
s_add_u32 s48, s49, 1441920
buffer_load_dwordx4 v10, s[8:11], s48 offen lds
s_mov_b32 m0, 97280
s_add_u32 s48, s49, 1507456
buffer_load_dwordx4 v10, s[8:11], s48 offen lds
s_mov_b32 m0, 104448
s_add_u32 s48, s49, 1441920
buffer_load_dwordx4 v10, s[12:15], s48 offen lds
s_mov_b32 m0, 105472
s_add_u32 s48, s49, 1507456
buffer_load_dwordx4 v10, s[12:15], s48 offen lds
s_mov_b32 m0, 112640
s_add_u32 s48, s49, 1441792
buffer_load_dwordx4 v10, s[16:19], s48 offen lds
s_mov_b32 m0, 113664
s_add_u32 s48, s49, 1507328
buffer_load_dwordx4 v10, s[16:19], s48 offen lds
s_mov_b32 m0, 120832
s_add_u32 s48, s49, 1966080
buffer_load_dwordx4 v10, s[8:11], s48 offen lds
s_mov_b32 m0, 121856
s_add_u32 s48, s49, 2031616
buffer_load_dwordx4 v10, s[8:11], s48 offen lds
s_mov_b32 m0, 129024
s_add_u32 s48, s49, 1966208
buffer_load_dwordx4 v10, s[8:11], s48 offen lds
s_mov_b32 m0, 130048
s_add_u32 s48, s49, 2031744
buffer_load_dwordx4 v10, s[8:11], s48 offen lds
s_waitcnt vmcnt(24)
s_barrier
s_mov_b32 m0, 137216
s_add_u32 s48, s49, 1966208
buffer_load_dwordx4 v10, s[12:15], s48 offen lds
s_mov_b32 m0, 138240
s_add_u32 s48, s49, 2031744
buffer_load_dwordx4 v10, s[12:15], s48 offen lds
s_mov_b32 m0, 145408
s_add_u32 s48, s49, 1966080
buffer_load_dwordx4 v10, s[16:19], s48 offen lds
s_mov_b32 m0, 146432
s_add_u32 s48, s49, 2031616
buffer_load_dwordx4 v10, s[16:19], s48 offen lds
s_mov_b32 m0, 153600
s_add_u32 s48, s49, 2490368
buffer_load_dwordx4 v10, s[8:11], s48 offen lds
s_mov_b32 m0, 154624
s_add_u32 s48, s49, 2555904
buffer_load_dwordx4 v10, s[8:11], s48 offen lds
s_mov_b32 m0, 161792
s_add_u32 s48, s49, 2490496
buffer_load_dwordx4 v10, s[8:11], s48 offen lds
s_mov_b32 m0, 162816
s_add_u32 s48, s49, 2556032
buffer_load_dwordx4 v10, s[8:11], s48 offen lds
ds_read_b64_tr_b16 a[24:25], v4 offset:0
ds_read_b64_tr_b16 a[26:27], v4 offset:1024
ds_read_b64_tr_b16 a[28:29], v4 offset:4096
ds_read_b64_tr_b16 a[30:31], v4 offset:5120
ds_read_b64_tr_b16 a[32:33], v4 offset:8192
ds_read_b64_tr_b16 a[34:35], v4 offset:9216
ds_read_b64_tr_b16 a[36:37], v4 offset:12288
ds_read_b64_tr_b16 a[38:39], v4 offset:13312
ds_read_b64_tr_b16 a[40:41], v4 offset:16384
ds_read_b64_tr_b16 a[42:43], v4 offset:17408
ds_read_b64_tr_b16 a[44:45], v4 offset:20480
ds_read_b64_tr_b16 a[46:47], v4 offset:21504
ds_read_b64_tr_b16 a[176:177], v4 offset:24576
ds_read_b64_tr_b16 a[178:179], v4 offset:25600
ds_read_b64_tr_b16 a[180:181], v4 offset:28672
ds_read_b64_tr_b16 a[182:183], v4 offset:29696
s_waitcnt lgkmcnt(0)
s_waitcnt vmcnt(24)
s_barrier
s_mov_b32 m0, 6144
s_add_u32 s48, s49, 2490496
buffer_load_dwordx4 v10, s[12:15], s48 offen lds
s_mov_b32 m0, 7168
s_add_u32 s48, s49, 2556032
buffer_load_dwordx4 v10, s[12:15], s48 offen lds
s_mov_b32 m0, 14336
s_add_u32 s48, s49, 2490368
buffer_load_dwordx4 v10, s[16:19], s48 offen lds
s_mov_b32 m0, 15360
s_add_u32 s48, s49, 2555904
buffer_load_dwordx4 v10, s[16:19], s48 offen lds
s_mov_b32 m0, 22528
s_add_u32 s48, s49, 3014656
buffer_load_dwordx4 v10, s[8:11], s48 offen lds
s_mov_b32 m0, 23552
s_add_u32 s48, s49, 3080192
buffer_load_dwordx4 v10, s[8:11], s48 offen lds
s_mov_b32 m0, 30720
s_add_u32 s48, s49, 3014784
buffer_load_dwordx4 v10, s[8:11], s48 offen lds
s_mov_b32 m0, 31744
s_add_u32 s48, s49, 3080320
buffer_load_dwordx4 v10, s[8:11], s48 offen lds
ds_read_b64_tr_b16 v[224:225], v4 offset:32768
ds_read_b64_tr_b16 v[226:227], v4 offset:33792
ds_read_b64_tr_b16 v[228:229], v4 offset:36864
ds_read_b64_tr_b16 v[230:231], v4 offset:37888
ds_read_b64_tr_b16 a[0:1], v4 offset:40960
ds_read_b64_tr_b16 a[2:3], v4 offset:41984
ds_read_b64_tr_b16 a[4:5], v4 offset:45056
ds_read_b64_tr_b16 a[6:7], v4 offset:46080
ds_read_b64_tr_b16 a[8:9], v4 offset:49152
ds_read_b64_tr_b16 a[10:11], v4 offset:50176
ds_read_b64_tr_b16 a[12:13], v4 offset:53248
ds_read_b64_tr_b16 a[14:15], v4 offset:54272
ds_read_b64_tr_b16 a[16:17], v4 offset:57344
ds_read_b64_tr_b16 a[18:19], v4 offset:58368
ds_read_b64_tr_b16 a[20:21], v4 offset:61440
ds_read_b64_tr_b16 a[22:23], v4 offset:62464
s_waitcnt lgkmcnt(0)
s_waitcnt vmcnt(24)
s_barrier
s_mov_b32 m0, 38912
s_add_u32 s48, s49, 3014784
buffer_load_dwordx4 v10, s[12:15], s48 offen lds
s_mov_b32 m0, 39936
s_add_u32 s48, s49, 3080320
buffer_load_dwordx4 v10, s[12:15], s48 offen lds
s_mov_b32 m0, 47104
s_add_u32 s48, s49, 3014656
buffer_load_dwordx4 v10, s[16:19], s48 offen lds
s_mov_b32 m0, 48128
s_add_u32 s48, s49, 3080192
buffer_load_dwordx4 v10, s[16:19], s48 offen lds
s_mov_b32 m0, 55296
s_add_u32 s48, s49, 3539072
buffer_load_dwordx4 v10, s[8:11], s48 offen lds
s_mov_b32 m0, 56320
s_add_u32 s48, s49, 3604608
buffer_load_dwordx4 v10, s[8:11], s48 offen lds
s_mov_b32 m0, 63488
s_add_u32 s48, s49, 4063232
buffer_load_dwordx4 v10, s[8:11], s48 offen lds
s_mov_b32 m0, 64512
s_add_u32 s48, s49, 4128768
buffer_load_dwordx4 v10, s[8:11], s48 offen lds
ds_read_b64_tr_b16 v[16:17], v5 offset:0
ds_read_b64_tr_b16 v[18:19], v5 offset:1024
ds_read_b64_tr_b16 v[20:21], v5 offset:4096
ds_read_b64_tr_b16 v[22:23], v5 offset:5120
ds_read_b64_tr_b16 v[24:25], v5 offset:8192
ds_read_b64_tr_b16 v[26:27], v5 offset:9216
ds_read_b64_tr_b16 v[28:29], v5 offset:12288
ds_read_b64_tr_b16 v[30:31], v5 offset:13312
ds_read_b64_tr_b16 a[80:81], v5 offset:16384
ds_read_b64_tr_b16 a[82:83], v5 offset:17408
ds_read_b64_tr_b16 a[84:85], v5 offset:20480
ds_read_b64_tr_b16 a[86:87], v5 offset:21504
ds_read_b64_tr_b16 a[88:89], v5 offset:24576
ds_read_b64_tr_b16 a[90:91], v5 offset:25600
ds_read_b64_tr_b16 a[92:93], v5 offset:28672
ds_read_b64_tr_b16 a[94:95], v5 offset:29696
s_waitcnt lgkmcnt(0)
buffer_store_dwordx4 v[16:19], v0, s[4:7], s60 offen offset:0
buffer_store_dwordx4 v[20:23], v0, s[4:7], s60 offen offset:1024
buffer_store_dwordx4 v[24:27], v0, s[4:7], s60 offen offset:2048
buffer_store_dwordx4 v[28:31], v0, s[4:7], s60 offen offset:3072
s_waitcnt vmcnt(28)
s_barrier
s_mov_b32 m0, 71680
s_add_u32 s48, s49, 4063360
buffer_load_dwordx4 v10, s[8:11], s48 offen lds
s_mov_b32 m0, 72704
s_add_u32 s48, s49, 4128896
buffer_load_dwordx4 v10, s[8:11], s48 offen lds
s_mov_b32 m0, 79872
s_add_u32 s48, s49, 4587520
buffer_load_dwordx4 v10, s[8:11], s48 offen lds
s_mov_b32 m0, 80896
s_add_u32 s48, s49, 4653056
buffer_load_dwordx4 v10, s[8:11], s48 offen lds
s_mov_b32 m0, 88064
s_add_u32 s48, s49, 4587648
buffer_load_dwordx4 v10, s[8:11], s48 offen lds
s_mov_b32 m0, 89088
s_add_u32 s48, s49, 4653184
buffer_load_dwordx4 v10, s[8:11], s48 offen lds
s_mov_b32 m0, 96256
s_add_u32 s48, s49, 5111808
buffer_load_dwordx4 v10, s[8:11], s48 offen lds
s_mov_b32 m0, 97280
s_add_u32 s48, s49, 5177344
buffer_load_dwordx4 v10, s[8:11], s48 offen lds
ds_read_b64_tr_b16 a[96:97], v5 offset:32768
ds_read_b64_tr_b16 a[98:99], v5 offset:33792
ds_read_b64_tr_b16 a[100:101], v5 offset:36864
ds_read_b64_tr_b16 a[102:103], v5 offset:37888
ds_read_b64_tr_b16 a[104:105], v5 offset:40960
ds_read_b64_tr_b16 a[106:107], v5 offset:41984
ds_read_b64_tr_b16 a[108:109], v5 offset:45056
ds_read_b64_tr_b16 a[110:111], v5 offset:46080
ds_read_b64_tr_b16 a[112:113], v5 offset:49152
ds_read_b64_tr_b16 a[114:115], v5 offset:50176
ds_read_b64_tr_b16 a[116:117], v5 offset:53248
ds_read_b64_tr_b16 a[118:119], v5 offset:54272
ds_read_b64_tr_b16 a[120:121], v5 offset:57344
ds_read_b64_tr_b16 a[122:123], v5 offset:58368
ds_read_b64_tr_b16 a[124:125], v5 offset:61440
ds_read_b64_tr_b16 a[126:127], v5 offset:62464
s_waitcnt lgkmcnt(0)
s_waitcnt vmcnt(28)
s_barrier
s_mov_b32 m0, 104448
s_add_u32 s48, s49, 5111936
buffer_load_dwordx4 v10, s[8:11], s48 offen lds
s_mov_b32 m0, 105472
s_add_u32 s48, s49, 5177472
buffer_load_dwordx4 v10, s[8:11], s48 offen lds
s_mov_b32 m0, 112640
s_add_u32 s48, s49, 3538944
buffer_load_dwordx4 v10, s[12:15], s48 offen lds
s_mov_b32 m0, 113664
s_add_u32 s48, s49, 3604480
buffer_load_dwordx4 v10, s[12:15], s48 offen lds
s_mov_b32 m0, 120832
s_add_u32 s48, s49, 3539072
buffer_load_dwordx4 v10, s[12:15], s48 offen lds
s_mov_b32 m0, 121856
s_add_u32 s48, s49, 3604608
buffer_load_dwordx4 v10, s[12:15], s48 offen lds
s_mov_b32 m0, 129024
s_add_u32 s48, s49, 4063232
buffer_load_dwordx4 v10, s[12:15], s48 offen lds
s_mov_b32 m0, 130048
s_add_u32 s48, s49, 4128768
buffer_load_dwordx4 v10, s[12:15], s48 offen lds
ds_read_b64_tr_b16 a[128:129], v6 offset:0
ds_read_b64_tr_b16 a[130:131], v6 offset:1024
ds_read_b64_tr_b16 a[132:133], v6 offset:4096
ds_read_b64_tr_b16 a[134:135], v6 offset:5120
ds_read_b64_tr_b16 a[136:137], v6 offset:8192
ds_read_b64_tr_b16 a[138:139], v6 offset:9216
ds_read_b64_tr_b16 a[140:141], v6 offset:12288
ds_read_b64_tr_b16 a[142:143], v6 offset:13312
ds_read_b64_tr_b16 a[144:145], v6 offset:16384
ds_read_b64_tr_b16 a[146:147], v6 offset:17408
ds_read_b64_tr_b16 a[148:149], v6 offset:20480
ds_read_b64_tr_b16 a[150:151], v6 offset:21504
ds_read_b64_tr_b16 a[152:153], v6 offset:24576
ds_read_b64_tr_b16 a[154:155], v6 offset:25600
ds_read_b64_tr_b16 a[156:157], v6 offset:28672
ds_read_b64_tr_b16 a[158:159], v6 offset:29696
s_waitcnt lgkmcnt(0)
s_waitcnt vmcnt(28)
s_barrier
s_mov_b32 m0, 137216
s_add_u32 s48, s49, 4063360
buffer_load_dwordx4 v10, s[12:15], s48 offen lds
s_mov_b32 m0, 138240
s_add_u32 s48, s49, 4128896
buffer_load_dwordx4 v10, s[12:15], s48 offen lds
s_mov_b32 m0, 145408
s_add_u32 s48, s49, 4587520
buffer_load_dwordx4 v10, s[12:15], s48 offen lds
s_mov_b32 m0, 146432
s_add_u32 s48, s49, 4653056
buffer_load_dwordx4 v10, s[12:15], s48 offen lds
s_mov_b32 m0, 153600
s_add_u32 s48, s49, 4587648
buffer_load_dwordx4 v10, s[12:15], s48 offen lds
s_mov_b32 m0, 154624
s_add_u32 s48, s49, 4653184
buffer_load_dwordx4 v10, s[12:15], s48 offen lds
s_mov_b32 m0, 161792
s_add_u32 s48, s49, 5111808
buffer_load_dwordx4 v10, s[12:15], s48 offen lds
s_mov_b32 m0, 162816
s_add_u32 s48, s49, 5177344
buffer_load_dwordx4 v10, s[12:15], s48 offen lds
ds_read_b64_tr_b16 a[160:161], v4 offset:0
ds_read_b64_tr_b16 a[162:163], v4 offset:1024
ds_read_b64_tr_b16 a[164:165], v4 offset:4096
ds_read_b64_tr_b16 a[166:167], v4 offset:5120
ds_read_b64_tr_b16 a[168:169], v4 offset:8192
ds_read_b64_tr_b16 a[170:171], v4 offset:9216
ds_read_b64_tr_b16 a[172:173], v4 offset:12288
ds_read_b64_tr_b16 a[174:175], v4 offset:13312
ds_read_b64_tr_b16 a[48:49], v4 offset:16384
ds_read_b64_tr_b16 a[50:51], v4 offset:17408
ds_read_b64_tr_b16 a[52:53], v4 offset:20480
ds_read_b64_tr_b16 a[54:55], v4 offset:21504
ds_read_b64_tr_b16 a[56:57], v4 offset:24576
ds_read_b64_tr_b16 a[58:59], v4 offset:25600
ds_read_b64_tr_b16 a[60:61], v4 offset:28672
ds_read_b64_tr_b16 a[62:63], v4 offset:29696
s_waitcnt lgkmcnt(0)
s_waitcnt vmcnt(28)
s_barrier
s_mov_b32 m0, 6144
s_add_u32 s48, s49, 5111936
buffer_load_dwordx4 v10, s[12:15], s48 offen lds
s_mov_b32 m0, 7168
s_add_u32 s48, s49, 5177472
buffer_load_dwordx4 v10, s[12:15], s48 offen lds
s_mov_b32 m0, 14336
s_add_u32 s48, s49, 3538944
buffer_load_dwordx4 v10, s[16:19], s48 offen lds
s_mov_b32 m0, 15360
s_add_u32 s48, s49, 3604480
buffer_load_dwordx4 v10, s[16:19], s48 offen lds
s_mov_b32 m0, 22528
s_add_u32 s48, s49, 3539072
buffer_load_dwordx4 v10, s[16:19], s48 offen lds
s_mov_b32 m0, 23552
s_add_u32 s48, s49, 3604608
buffer_load_dwordx4 v10, s[16:19], s48 offen lds
s_mov_b32 m0, 30720
s_add_u32 s48, s49, 4063232
buffer_load_dwordx4 v10, s[16:19], s48 offen lds
s_mov_b32 m0, 31744
s_add_u32 s48, s49, 4128768
buffer_load_dwordx4 v10, s[16:19], s48 offen lds
ds_read_b64_tr_b16 a[64:65], v4 offset:32768
ds_read_b64_tr_b16 a[66:67], v4 offset:33792
ds_read_b64_tr_b16 a[68:69], v4 offset:36864
ds_read_b64_tr_b16 a[70:71], v4 offset:37888
ds_read_b64_tr_b16 a[72:73], v4 offset:40960
ds_read_b64_tr_b16 a[74:75], v4 offset:41984
ds_read_b64_tr_b16 a[76:77], v4 offset:45056
ds_read_b64_tr_b16 a[78:79], v4 offset:46080
ds_read_b64_tr_b16 a[200:201], v4 offset:49152
ds_read_b64_tr_b16 a[202:203], v4 offset:50176
ds_read_b64_tr_b16 a[204:205], v4 offset:53248
ds_read_b64_tr_b16 a[206:207], v4 offset:54272
ds_read_b64_tr_b16 a[208:209], v4 offset:57344
ds_read_b64_tr_b16 a[210:211], v4 offset:58368
ds_read_b64_tr_b16 a[212:213], v4 offset:61440
ds_read_b64_tr_b16 a[214:215], v4 offset:62464
s_waitcnt lgkmcnt(0)
s_waitcnt vmcnt(24)
s_barrier
s_mov_b32 m0, 38912
s_add_u32 s48, s49, 4063360
buffer_load_dwordx4 v10, s[16:19], s48 offen lds
s_mov_b32 m0, 39936
s_add_u32 s48, s49, 4128896
buffer_load_dwordx4 v10, s[16:19], s48 offen lds
s_mov_b32 m0, 47104
s_add_u32 s48, s49, 4587520
buffer_load_dwordx4 v10, s[16:19], s48 offen lds
s_mov_b32 m0, 48128
s_add_u32 s48, s49, 4653056
buffer_load_dwordx4 v10, s[16:19], s48 offen lds
s_mov_b32 m0, 55296
s_add_u32 s48, s49, 4587648
buffer_load_dwordx4 v10, s[16:19], s48 offen lds
s_mov_b32 m0, 56320
s_add_u32 s48, s49, 4653184
buffer_load_dwordx4 v10, s[16:19], s48 offen lds
s_mov_b32 m0, 63488
s_add_u32 s48, s49, 5111808
buffer_load_dwordx4 v10, s[16:19], s48 offen lds
s_mov_b32 m0, 64512
s_add_u32 s48, s49, 5177344
buffer_load_dwordx4 v10, s[16:19], s48 offen lds
ds_read_b64_tr_b16 a[216:217], v5 offset:0
ds_read_b64_tr_b16 a[218:219], v5 offset:1024
ds_read_b64_tr_b16 a[220:221], v5 offset:4096
ds_read_b64_tr_b16 a[222:223], v5 offset:5120
ds_read_b64_tr_b16 a[224:225], v5 offset:8192
ds_read_b64_tr_b16 a[226:227], v5 offset:9216
ds_read_b64_tr_b16 a[228:229], v5 offset:12288
ds_read_b64_tr_b16 a[230:231], v5 offset:13312
ds_read_b64_tr_b16 a[232:233], v5 offset:16384
ds_read_b64_tr_b16 a[234:235], v5 offset:17408
ds_read_b64_tr_b16 a[236:237], v5 offset:20480
ds_read_b64_tr_b16 a[238:239], v5 offset:21504
ds_read_b64_tr_b16 a[184:185], v5 offset:24576
ds_read_b64_tr_b16 a[186:187], v5 offset:25600
ds_read_b64_tr_b16 a[188:189], v5 offset:28672
ds_read_b64_tr_b16 a[190:191], v5 offset:29696
s_waitcnt lgkmcnt(0)
s_waitcnt vmcnt(24)
s_barrier
s_mov_b32 m0, 71680
s_add_u32 s48, s49, 5111936
buffer_load_dwordx4 v10, s[16:19], s48 offen lds
s_mov_b32 m0, 72704
s_add_u32 s48, s49, 5177472
buffer_load_dwordx4 v10, s[16:19], s48 offen lds
s_mov_b32 m0, 79872
s_add_u32 s48, s50, 92160
buffer_load_dwordx4 v11, s[20:23], s48 offen lds
s_mov_b32 m0, 80896
s_add_u32 s48, s50, 97280
buffer_load_dwordx4 v11, s[20:23], s48 offen lds
s_mov_b32 m0, 88064
s_add_u32 s48, s50, 112640
buffer_load_dwordx4 v11, s[20:23], s48 offen lds
s_mov_b32 m0, 89088
s_add_u32 s48, s50, 117760
buffer_load_dwordx4 v11, s[20:23], s48 offen lds
s_mov_b32 m0, 96256
s_add_u32 s48, s50, 133120
buffer_load_dwordx4 v11, s[20:23], s48 offen lds
s_mov_b32 m0, 97280
s_add_u32 s48, s50, 138240
buffer_load_dwordx4 v11, s[20:23], s48 offen lds
ds_read_b64_tr_b16 a[192:193], v5 offset:32768
ds_read_b64_tr_b16 a[194:195], v5 offset:33792
ds_read_b64_tr_b16 a[196:197], v5 offset:36864
ds_read_b64_tr_b16 a[198:199], v5 offset:37888
ds_read_b64_tr_b16 a[248:249], v5 offset:40960
ds_read_b64_tr_b16 a[250:251], v5 offset:41984
ds_read_b64_tr_b16 a[252:253], v5 offset:45056
ds_read_b64_tr_b16 a[254:255], v5 offset:46080
ds_read_b64_tr_b16 v[72:73], v5 offset:49152
ds_read_b64_tr_b16 v[74:75], v5 offset:50176
ds_read_b64_tr_b16 v[76:77], v5 offset:53248
ds_read_b64_tr_b16 v[78:79], v5 offset:54272
ds_read_b64_tr_b16 v[80:81], v5 offset:57344
ds_read_b64_tr_b16 v[82:83], v5 offset:58368
ds_read_b64_tr_b16 v[84:85], v5 offset:61440
ds_read_b64_tr_b16 v[86:87], v5 offset:62464
s_waitcnt lgkmcnt(0)
s_waitcnt vmcnt(24)
s_barrier
s_mov_b32 m0, 104448
s_add_u32 s48, s50, 153600
buffer_load_dwordx4 v11, s[20:23], s48 offen lds
s_mov_b32 m0, 105472
s_add_u32 s48, s50, 158720
buffer_load_dwordx4 v11, s[20:23], s48 offen lds
s_mov_b32 m0, 112640
s_add_u32 s48, s50, 92416
buffer_load_dwordx4 v11, s[20:23], s48 offen lds
s_mov_b32 m0, 113664
s_add_u32 s48, s50, 97536
buffer_load_dwordx4 v11, s[20:23], s48 offen lds
s_mov_b32 m0, 120832
s_add_u32 s48, s50, 112896
buffer_load_dwordx4 v11, s[20:23], s48 offen lds
s_mov_b32 m0, 121856
s_add_u32 s48, s50, 118016
buffer_load_dwordx4 v11, s[20:23], s48 offen lds
s_mov_b32 m0, 129024
s_add_u32 s48, s50, 133376
buffer_load_dwordx4 v11, s[20:23], s48 offen lds
s_mov_b32 m0, 130048
s_add_u32 s48, s50, 138496
buffer_load_dwordx4 v11, s[20:23], s48 offen lds
ds_read_b64_tr_b16 v[88:89], v6 offset:0
ds_read_b64_tr_b16 v[90:91], v6 offset:1024
ds_read_b64_tr_b16 v[92:93], v6 offset:4096
ds_read_b64_tr_b16 v[94:95], v6 offset:5120
ds_read_b64_tr_b16 v[96:97], v6 offset:8192
ds_read_b64_tr_b16 v[98:99], v6 offset:9216
ds_read_b64_tr_b16 v[100:101], v6 offset:12288
ds_read_b64_tr_b16 v[102:103], v6 offset:13312
ds_read_b64_tr_b16 v[104:105], v6 offset:16384
ds_read_b64_tr_b16 v[106:107], v6 offset:17408
ds_read_b64_tr_b16 v[108:109], v6 offset:20480
ds_read_b64_tr_b16 v[110:111], v6 offset:21504
ds_read_b64_tr_b16 v[248:249], v6 offset:24576
ds_read_b64_tr_b16 v[250:251], v6 offset:25600
ds_read_b64_tr_b16 v[252:253], v6 offset:28672
ds_read_b64_tr_b16 v[254:255], v6 offset:29696
s_waitcnt lgkmcnt(0)
s_waitcnt vmcnt(24)
s_barrier
s_mov_b32 m0, 137216
s_add_u32 s48, s50, 153856
buffer_load_dwordx4 v11, s[20:23], s48 offen lds
s_mov_b32 m0, 138240
s_add_u32 s48, s50, 158976
buffer_load_dwordx4 v11, s[20:23], s48 offen lds
s_mov_b32 m0, 145408
s_add_u32 s48, s50, 92672
buffer_load_dwordx4 v11, s[20:23], s48 offen lds
s_mov_b32 m0, 146432
s_add_u32 s48, s50, 97792
buffer_load_dwordx4 v11, s[20:23], s48 offen lds
s_mov_b32 m0, 153600
s_add_u32 s48, s50, 113152
buffer_load_dwordx4 v11, s[20:23], s48 offen lds
s_mov_b32 m0, 154624
s_add_u32 s48, s50, 118272
buffer_load_dwordx4 v11, s[20:23], s48 offen lds
s_mov_b32 m0, 161792
s_add_u32 s48, s50, 133632
buffer_load_dwordx4 v11, s[20:23], s48 offen lds
s_mov_b32 m0, 162816
s_add_u32 s48, s50, 138752
buffer_load_dwordx4 v11, s[20:23], s48 offen lds
ds_read_b64_tr_b16 a[240:241], v4 offset:0
ds_read_b64_tr_b16 a[242:243], v4 offset:1024
ds_read_b64_tr_b16 a[244:245], v4 offset:4096
ds_read_b64_tr_b16 a[246:247], v4 offset:5120
ds_read_b64_tr_b16 v[128:129], v4 offset:8192
ds_read_b64_tr_b16 v[130:131], v4 offset:9216
ds_read_b64_tr_b16 v[132:133], v4 offset:12288
ds_read_b64_tr_b16 v[134:135], v4 offset:13312
ds_read_b64_tr_b16 v[136:137], v4 offset:16384
ds_read_b64_tr_b16 v[138:139], v4 offset:17408
ds_read_b64_tr_b16 v[140:141], v4 offset:20480
ds_read_b64_tr_b16 v[142:143], v4 offset:21504
ds_read_b64_tr_b16 v[144:145], v4 offset:24576
ds_read_b64_tr_b16 v[146:147], v4 offset:25600
ds_read_b64_tr_b16 v[148:149], v4 offset:28672
ds_read_b64_tr_b16 v[150:151], v4 offset:29696
s_waitcnt lgkmcnt(0)
s_waitcnt vmcnt(24)
s_barrier
s_mov_b32 m0, 6144
s_add_u32 s48, s50, 154112
buffer_load_dwordx4 v11, s[20:23], s48 offen lds
s_mov_b32 m0, 7168
s_add_u32 s48, s50, 159232
buffer_load_dwordx4 v11, s[20:23], s48 offen lds
s_mov_b32 m0, 14336
s_add_u32 s48, s49, 393216
buffer_load_dwordx4 v10, s[12:15], s48 offen lds
s_mov_b32 m0, 15360
s_add_u32 s48, s49, 458752
buffer_load_dwordx4 v10, s[12:15], s48 offen lds
s_mov_b32 m0, 22528
s_add_u32 s48, s49, 917504
buffer_load_dwordx4 v10, s[12:15], s48 offen lds
s_mov_b32 m0, 23552
s_add_u32 s48, s49, 983040
buffer_load_dwordx4 v10, s[12:15], s48 offen lds
s_mov_b32 m0, 30720
s_add_u32 s48, s49, 1441792
buffer_load_dwordx4 v10, s[12:15], s48 offen lds
s_mov_b32 m0, 31744
s_add_u32 s48, s49, 1507328
buffer_load_dwordx4 v10, s[12:15], s48 offen lds
ds_read_b64_tr_b16 v[152:153], v4 offset:32768
ds_read_b64_tr_b16 v[154:155], v4 offset:33792
ds_read_b64_tr_b16 v[156:157], v4 offset:36864
ds_read_b64_tr_b16 v[158:159], v4 offset:37888
ds_read_b64_tr_b16 v[160:161], v4 offset:40960
ds_read_b64_tr_b16 v[162:163], v4 offset:41984
ds_read_b64_tr_b16 v[164:165], v4 offset:45056
ds_read_b64_tr_b16 v[166:167], v4 offset:46080
ds_read_b64_tr_b16 v[168:169], v4 offset:49152
ds_read_b64_tr_b16 v[170:171], v4 offset:50176
ds_read_b64_tr_b16 v[172:173], v4 offset:53248
ds_read_b64_tr_b16 v[174:175], v4 offset:54272
ds_read_b64_tr_b16 v[112:113], v4 offset:57344
ds_read_b64_tr_b16 v[114:115], v4 offset:58368
ds_read_b64_tr_b16 v[116:117], v4 offset:61440
ds_read_b64_tr_b16 v[118:119], v4 offset:62464
s_waitcnt lgkmcnt(0)
s_waitcnt vmcnt(24)
s_barrier
s_mov_b32 m0, 38912
s_add_u32 s48, s49, 1966080
buffer_load_dwordx4 v10, s[12:15], s48 offen lds
s_mov_b32 m0, 39936
s_add_u32 s48, s49, 2031616
buffer_load_dwordx4 v10, s[12:15], s48 offen lds
s_mov_b32 m0, 47104
s_add_u32 s48, s49, 2490368
buffer_load_dwordx4 v10, s[12:15], s48 offen lds
s_mov_b32 m0, 48128
s_add_u32 s48, s49, 2555904
buffer_load_dwordx4 v10, s[12:15], s48 offen lds
s_mov_b32 m0, 55296
s_add_u32 s48, s49, 3014656
buffer_load_dwordx4 v10, s[12:15], s48 offen lds
s_mov_b32 m0, 56320
s_add_u32 s48, s49, 3080192
buffer_load_dwordx4 v10, s[12:15], s48 offen lds
s_mov_b32 m0, 63488
s_add_u32 s48, s49, 1441920
buffer_load_dwordx4 v10, s[16:19], s48 offen lds
s_mov_b32 m0, 64512
s_add_u32 s48, s49, 1507456
buffer_load_dwordx4 v10, s[16:19], s48 offen lds
ds_read_b64_tr_b16 v[120:121], v5 offset:0
ds_read_b64_tr_b16 v[122:123], v5 offset:1024
ds_read_b64_tr_b16 v[124:125], v5 offset:4096
ds_read_b64_tr_b16 v[126:127], v5 offset:5120
ds_read_b64_tr_b16 v[176:177], v8 offset:8192
ds_read_b64_tr_b16 v[178:179], v8 offset:8704
ds_read_b64_tr_b16 v[180:181], v8 offset:10240
ds_read_b64_tr_b16 v[182:183], v8 offset:10752
ds_read_b64_tr_b16 v[184:185], v8 offset:16384
ds_read_b64_tr_b16 v[186:187], v8 offset:16896
ds_read_b64_tr_b16 v[188:189], v8 offset:18432
ds_read_b64_tr_b16 v[190:191], v8 offset:18944
ds_read_b64_tr_b16 v[192:193], v8 offset:24576
ds_read_b64_tr_b16 v[194:195], v8 offset:25088
ds_read_b64_tr_b16 v[196:197], v8 offset:26624
ds_read_b64_tr_b16 v[198:199], v8 offset:27136
s_waitcnt lgkmcnt(0)
s_waitcnt vmcnt(24)
s_barrier
s_mov_b32 m0, 71680
s_add_u32 s48, s49, 1966208
buffer_load_dwordx4 v10, s[16:19], s48 offen lds
s_mov_b32 m0, 72704
s_add_u32 s48, s49, 2031744
buffer_load_dwordx4 v10, s[16:19], s48 offen lds
s_mov_b32 m0, 79872
s_add_u32 s48, s49, 2490496
buffer_load_dwordx4 v10, s[16:19], s48 offen lds
s_mov_b32 m0, 80896
s_add_u32 s48, s49, 2556032
buffer_load_dwordx4 v10, s[16:19], s48 offen lds
s_mov_b32 m0, 88064
s_add_u32 s48, s49, 3014784
buffer_load_dwordx4 v10, s[16:19], s48 offen lds
s_mov_b32 m0, 89088
s_add_u32 s48, s49, 3080320
buffer_load_dwordx4 v10, s[16:19], s48 offen lds
s_mov_b32 m0, 96256
s_add_u32 s48, s50, 92928
buffer_load_dwordx4 v11, s[20:23], s48 offen lds
s_mov_b32 m0, 97280
s_add_u32 s48, s50, 98048
buffer_load_dwordx4 v11, s[20:23], s48 offen lds
v_xor_b32 v12, v15, v8
ds_read_b64_tr_b16 v[16:17], v12 offset:32768
ds_read_b64_tr_b16 v[18:19], v12 offset:33280
ds_read_b64_tr_b16 v[20:21], v12 offset:34816
ds_read_b64_tr_b16 v[22:23], v12 offset:35328
ds_read_b64_tr_b16 v[240:241], v8 offset:40960
ds_read_b64_tr_b16 v[242:243], v8 offset:41472
ds_read_b64_tr_b16 v[244:245], v8 offset:43008
ds_read_b64_tr_b16 v[246:247], v8 offset:43520
ds_read_b64_tr_b16 v[232:233], v8 offset:49152
ds_read_b64_tr_b16 v[234:235], v8 offset:49664
ds_read_b64_tr_b16 v[236:237], v8 offset:51200
ds_read_b64_tr_b16 v[238:239], v8 offset:51712
ds_read_b64_tr_b16 v[40:41], v8 offset:57344
ds_read_b64_tr_b16 v[42:43], v8 offset:57856
ds_read_b64_tr_b16 v[44:45], v8 offset:59392
ds_read_b64_tr_b16 v[46:47], v8 offset:59904
s_waitcnt lgkmcnt(0)
buffer_store_dwordx4 v[16:19], v0, s[4:7], s61 offen offset:0
buffer_store_dwordx4 v[20:23], v0, s[4:7], s61 offen offset:1024
buffer_store_dwordx4 v[40:43], v0, s[4:7], s62 offen offset:0
buffer_store_dwordx4 v[44:47], v0, s[4:7], s62 offen offset:1024
s_waitcnt vmcnt(28)
s_barrier
s_mov_b32 m0, 104448
s_add_u32 s48, s50, 113408
buffer_load_dwordx4 v11, s[20:23], s48 offen lds
s_mov_b32 m0, 105472
s_add_u32 s48, s50, 118528
buffer_load_dwordx4 v11, s[20:23], s48 offen lds
s_mov_b32 m0, 112640
s_add_u32 s48, s50, 133888
buffer_load_dwordx4 v11, s[20:23], s48 offen lds
s_mov_b32 m0, 113664
s_add_u32 s48, s50, 139008
buffer_load_dwordx4 v11, s[20:23], s48 offen lds
s_mov_b32 m0, 120832
s_add_u32 s48, s50, 154368
buffer_load_dwordx4 v11, s[20:23], s48 offen lds
s_mov_b32 m0, 121856
s_add_u32 s48, s50, 159488
buffer_load_dwordx4 v11, s[20:23], s48 offen lds
s_mov_b32 m0, 129024
s_add_u32 s48, s50, 93184
buffer_load_dwordx4 v11, s[20:23], s48 offen lds
s_mov_b32 m0, 130048
s_add_u32 s48, s50, 98304
buffer_load_dwordx4 v11, s[20:23], s48 offen lds
v_xor_b32 v12, v15, v9
ds_read_b64_tr_b16 v[16:17], v12 offset:0
ds_read_b64_tr_b16 v[18:19], v12 offset:512
ds_read_b64_tr_b16 v[20:21], v12 offset:2048
ds_read_b64_tr_b16 v[22:23], v12 offset:2560
ds_read_b64_tr_b16 v[24:25], v9 offset:8192
ds_read_b64_tr_b16 v[26:27], v9 offset:8704
ds_read_b64_tr_b16 v[28:29], v9 offset:10240
ds_read_b64_tr_b16 v[30:31], v9 offset:10752
ds_read_b64_tr_b16 v[208:209], v9 offset:16384
ds_read_b64_tr_b16 v[210:211], v9 offset:16896
ds_read_b64_tr_b16 v[212:213], v9 offset:18432
ds_read_b64_tr_b16 v[214:215], v9 offset:18944
ds_read_b64_tr_b16 v[216:217], v9 offset:24576
ds_read_b64_tr_b16 v[218:219], v9 offset:25088
ds_read_b64_tr_b16 v[220:221], v9 offset:26624
ds_read_b64_tr_b16 v[222:223], v9 offset:27136
s_waitcnt lgkmcnt(0)
buffer_store_dwordx4 v[16:19], v0, s[4:7], s61 offen offset:2048
buffer_store_dwordx4 v[20:23], v0, s[4:7], s61 offen offset:3072
buffer_store_dwordx4 v[24:27], v0, s[4:7], s62 offen offset:2048
buffer_store_dwordx4 v[28:31], v0, s[4:7], s62 offen offset:3072
s_waitcnt vmcnt(38)
s_barrier
s_mov_b32 m0, 137216
s_add_u32 s48, s50, 113664
buffer_load_dwordx4 v11, s[20:23], s48 offen lds
s_mov_b32 m0, 138240
s_add_u32 s48, s50, 118784
buffer_load_dwordx4 v11, s[20:23], s48 offen lds
s_mov_b32 m0, 145408
s_add_u32 s48, s50, 134144
buffer_load_dwordx4 v11, s[20:23], s48 offen lds
s_mov_b32 m0, 146432
s_add_u32 s48, s50, 139264
buffer_load_dwordx4 v11, s[20:23], s48 offen lds
s_mov_b32 m0, 153600
s_add_u32 s48, s50, 154624
buffer_load_dwordx4 v11, s[20:23], s48 offen lds
s_mov_b32 m0, 154624
s_add_u32 s48, s50, 159744
buffer_load_dwordx4 v11, s[20:23], s48 offen lds
s_mov_b32 m0, 161792
s_add_u32 s48, s49, 3538944
buffer_load_dwordx4 v10, s[8:11], s48 offen lds
s_mov_b32 m0, 162816
s_add_u32 s48, s49, 3604480
buffer_load_dwordx4 v10, s[8:11], s48 offen lds
v_xor_b32 v12, v15, v7
ds_read_b64_tr_b16 v[200:201], v12 offset:0
ds_read_b64_tr_b16 v[202:203], v12 offset:512
ds_read_b64_tr_b16 v[204:205], v12 offset:2048
ds_read_b64_tr_b16 v[206:207], v12 offset:2560
s_waitcnt lgkmcnt(0)
s_waitcnt vmcnt(32)
s_barrier
ds_read_b64_tr_b16 v[16:17], v4 offset:8192
ds_read_b64_tr_b16 v[18:19], v4 offset:9216
ds_read_b64_tr_b16 v[20:21], v4 offset:12288
ds_read_b64_tr_b16 v[22:23], v4 offset:13312
ds_read_b64_tr_b16 v[24:25], v4 offset:16384
ds_read_b64_tr_b16 v[26:27], v4 offset:17408
ds_read_b64_tr_b16 v[28:29], v4 offset:20480
ds_read_b64_tr_b16 v[30:31], v4 offset:21504
ds_read_b64_tr_b16 v[32:33], v4 offset:24576
ds_read_b64_tr_b16 v[34:35], v4 offset:25600
ds_read_b64_tr_b16 v[36:37], v4 offset:28672
ds_read_b64_tr_b16 v[38:39], v4 offset:29696
ds_read_b64_tr_b16 v[40:41], v4 offset:32768
ds_read_b64_tr_b16 v[42:43], v4 offset:33792
ds_read_b64_tr_b16 v[44:45], v4 offset:36864
ds_read_b64_tr_b16 v[46:47], v4 offset:37888
ds_read_b64_tr_b16 v[48:49], v4 offset:40960
ds_read_b64_tr_b16 v[50:51], v4 offset:41984
ds_read_b64_tr_b16 v[52:53], v4 offset:45056
ds_read_b64_tr_b16 v[54:55], v4 offset:46080
ds_read_b64_tr_b16 v[56:57], v4 offset:49152
ds_read_b64_tr_b16 v[58:59], v4 offset:50176
ds_read_b64_tr_b16 v[60:61], v4 offset:53248
ds_read_b64_tr_b16 v[62:63], v4 offset:54272
ds_read_b64_tr_b16 v[64:65], v4 offset:57344
ds_read_b64_tr_b16 v[66:67], v4 offset:58368
ds_read_b64_tr_b16 v[68:69], v4 offset:61440
ds_read_b64_tr_b16 v[70:71], v4 offset:62464
s_waitcnt lgkmcnt(0)
s_barrier
ds_write_b128 v0, v[16:19] offset:51200
ds_write_b128 v0, v[20:23] offset:52224
ds_write_b128 v0, v[24:27] offset:53248
ds_write_b128 v0, v[28:31] offset:54272
ds_write_b128 v0, v[32:35] offset:55296
ds_write_b128 v0, v[36:39] offset:56320
ds_write_b128 v0, v[40:43] offset:57344
ds_write_b128 v0, v[44:47] offset:58368
ds_write_b128 v0, v[48:51] offset:59392
ds_write_b128 v0, v[52:55] offset:60416
ds_write_b128 v0, v[56:59] offset:61440
ds_write_b128 v0, v[60:63] offset:62464
ds_write_b128 v0, v[64:67] offset:63488
ds_write_b128 v0, v[68:71] offset:64512
s_waitcnt lgkmcnt(0)
s_waitcnt vmcnt(6)
s_barrier
ds_read_b64_tr_b16 v[16:17], v8 offset:24576
ds_read_b64_tr_b16 v[18:19], v8 offset:25088
ds_read_b64_tr_b16 v[20:21], v8 offset:26624
ds_read_b64_tr_b16 v[22:23], v8 offset:27136
ds_read_b64_tr_b16 v[24:25], v8 offset:32768
ds_read_b64_tr_b16 v[26:27], v8 offset:33280
ds_read_b64_tr_b16 v[28:29], v8 offset:34816
ds_read_b64_tr_b16 v[30:31], v8 offset:35328
ds_read_b64_tr_b16 v[32:33], v8 offset:40960
ds_read_b64_tr_b16 v[34:35], v8 offset:41472
ds_read_b64_tr_b16 v[36:37], v8 offset:43008
ds_read_b64_tr_b16 v[38:39], v8 offset:43520
v_xor_b32 v12, v15, v8
ds_read_b64_tr_b16 v[40:41], v12 offset:49152
ds_read_b64_tr_b16 v[42:43], v12 offset:49664
ds_read_b64_tr_b16 v[44:45], v12 offset:51200
ds_read_b64_tr_b16 v[46:47], v12 offset:51712
ds_read_b64_tr_b16 v[48:49], v8 offset:57344
ds_read_b64_tr_b16 v[50:51], v8 offset:57856
ds_read_b64_tr_b16 v[52:53], v8 offset:59392
ds_read_b64_tr_b16 v[54:55], v8 offset:59904
ds_read_b64_tr_b16 v[56:57], v9 offset:0
ds_read_b64_tr_b16 v[58:59], v9 offset:512
ds_read_b64_tr_b16 v[60:61], v9 offset:2048
ds_read_b64_tr_b16 v[62:63], v9 offset:2560
s_waitcnt lgkmcnt(0)
s_barrier
ds_write_b128 v2, v[16:19] offset:36864
ds_write_b128 v2, v[20:23] offset:37888
ds_write_b128 v2, v[24:27] offset:38912
ds_write_b128 v2, v[28:31] offset:39936
ds_write_b128 v2, v[232:235] offset:40960
ds_write_b128 v2, v[236:239] offset:41984
ds_write_b128 v2, v[224:227] offset:43008
ds_write_b128 v2, v[228:231] offset:44032
ds_write_b128 v2, v[48:51] offset:45056
ds_write_b128 v2, v[52:55] offset:46080
ds_write_b128 v2, v[56:59] offset:47104
ds_write_b128 v2, v[60:63] offset:48128
s_waitcnt lgkmcnt(0)
v_mov_b32 v232, v32
v_mov_b32 v233, v33
v_mov_b32 v234, v34
v_mov_b32 v235, v35
v_mov_b32 v236, v36
v_mov_b32 v237, v37
v_mov_b32 v238, v38
v_mov_b32 v239, v39
v_mov_b32 v224, v40
v_mov_b32 v225, v41
v_mov_b32 v226, v42
v_mov_b32 v227, v43
v_mov_b32 v228, v44
v_mov_b32 v229, v45
v_mov_b32 v230, v46
v_mov_b32 v231, v47
s_waitcnt vmcnt(0)
s_barrier
ds_read_b64_tr_b16 v[16:17], v5 offset:0
ds_read_b64_tr_b16 v[18:19], v5 offset:1024
ds_read_b64_tr_b16 v[20:21], v5 offset:4096
ds_read_b64_tr_b16 v[22:23], v5 offset:5120
ds_read_b64_tr_b16 v[24:25], v5 offset:8192
ds_read_b64_tr_b16 v[26:27], v5 offset:9216
ds_read_b64_tr_b16 v[28:29], v5 offset:12288
ds_read_b64_tr_b16 v[30:31], v5 offset:13312
ds_read_b64_tr_b16 v[32:33], v5 offset:16384
ds_read_b64_tr_b16 v[34:35], v5 offset:17408
ds_read_b64_tr_b16 v[36:37], v5 offset:20480
ds_read_b64_tr_b16 v[38:39], v5 offset:21504
ds_read_b64_tr_b16 v[40:41], v9 offset:8192
ds_read_b64_tr_b16 v[42:43], v9 offset:8704
ds_read_b64_tr_b16 v[44:45], v9 offset:10240
ds_read_b64_tr_b16 v[46:47], v9 offset:10752
v_xor_b32 v12, v15, v9
ds_read_b64_tr_b16 v[48:49], v12 offset:16384
ds_read_b64_tr_b16 v[50:51], v12 offset:16896
ds_read_b64_tr_b16 v[52:53], v12 offset:18432
ds_read_b64_tr_b16 v[54:55], v12 offset:18944
ds_read_b64_tr_b16 v[56:57], v6 offset:24576
ds_read_b64_tr_b16 v[58:59], v6 offset:25600
ds_read_b64_tr_b16 v[60:61], v6 offset:28672
ds_read_b64_tr_b16 v[62:63], v6 offset:29696
s_waitcnt lgkmcnt(0)
s_barrier
ds_write_b128 v2, v[16:19] offset:12288
ds_write_b128 v2, v[20:23] offset:13312
ds_write_b128 v2, a[176:179] offset:14336
ds_write_b128 v2, a[180:183] offset:15360
ds_write_b128 v2, v[32:35] offset:16384
ds_write_b128 v2, v[36:39] offset:17408
ds_write_b128 v2, v[248:251] offset:18432
ds_write_b128 v2, v[252:255] offset:19456
ds_write_b128 v2, v[240:243] offset:20480
ds_write_b128 v2, v[244:247] offset:21504
ds_write_b128 v2, v[56:59] offset:22528
ds_write_b128 v2, v[60:63] offset:23552
s_waitcnt lgkmcnt(0)
v_accvgpr_write_b32 a176, v24
v_accvgpr_write_b32 a177, v25
v_accvgpr_write_b32 a178, v26
v_accvgpr_write_b32 a179, v27
v_accvgpr_write_b32 a180, v28
v_accvgpr_write_b32 a181, v29
v_accvgpr_write_b32 a182, v30
v_accvgpr_write_b32 a183, v31
v_mov_b32 v248, v40
v_mov_b32 v249, v41
v_mov_b32 v250, v42
v_mov_b32 v251, v43
v_mov_b32 v252, v44
v_mov_b32 v253, v45
v_mov_b32 v254, v46
v_mov_b32 v255, v47
v_mov_b32 v240, v48
v_mov_b32 v241, v49
v_mov_b32 v242, v50
v_mov_b32 v243, v51
v_mov_b32 v244, v52
v_mov_b32 v245, v53
v_mov_b32 v246, v54
v_mov_b32 v247, v55
s_mov_b32 s90, 0x300003
s_mov_b32 s91, 0x300003
s_mov_b32 s12, 0x3030303
s_mov_b32 s13, 0x3030303
s_mov_b32 s92, 0xc0000c
s_mov_b32 s93, 0xc0000c
s_mov_b32 s14, 0xc0c0c0c
s_mov_b32 s15, 0xc0c0c0c
s_mov_b32 s94, 0x30000300
s_mov_b32 s95, 0x30000300
s_mov_b32 s16, 0x30303030
s_mov_b32 s17, 0x30303030
s_mov_b32 s96, 0xc0000c00
s_mov_b32 s97, 0xc0000c00
s_mov_b32 s18, 0xc0c0c0c0
s_mov_b32 s19, 0xc0c0c0c0
s_mov_b32 s98, 0xff00ff00
s_mov_b32 s99, 0xff00ff00
v_mov_b32 v1, 0x4444
v_mov_b32 v4, 0xeeee
v_cndmask_b32 v1, v1, v4, s[98:99]
v_lshrrev_b32 v4, 8, v0
v_lshl_or_b32 v1, v4, 28, v1
v_bfe_u32 v4, v0, 4, 4
v_lshl_or_b32 v1, v4, 19, v1
s_mov_b32 s51, 0x3e0293ee
s_mov_b32 s52, 0x3f803f80
s_mov_b32 s53, 0x3f803f80
s_mov_b32 s54, 0x3f003f00
s_mov_b32 s55, 0x3f003f00
s_mov_b32 s56, 0xff800000
s_mov_b32 s57, 0xff800000
s_mov_b32 s58, 0x3f80
s_mov_b32 s8, s4
s_mov_b32 s9, s5
s_cmp_eq_u32 s30, 31
s_cselect_b32 s10, s6, 0
s_mov_b32 s31, 0
s_mov_b32 s45, -2
s_lshl_b32 s46, s30, 6
s_add_u32 s46, s46, 222330880
s_lshl_b32 s48, s30, 7
s_and_b32 s49, s30, 31
s_lshl_b32 s49, s49, 12
s_add_u32 s43, s49, 119537664
v_mov_b64 v[12:13], -1
s_add_u32 s38, s48, 119586816
s_add_u32 s39, s48, 119652352
s_add_u32 s40, s48, 119717888
s_add_u32 s41, s48, 119783424
s_add_u32 s42, s48, 119848960
v_lshrrev_b32 v4, 16, v1
buffer_store_dwordx2 v[12:13], v4, s[4:7], s38 offen
buffer_store_dwordx2 v[12:13], v4, s[4:7], s39 offen
buffer_store_dwordx2 v[12:13], v4, s[4:7], s40 offen
buffer_store_dwordx2 v[12:13], v4, s[4:7], s41 offen
buffer_store_dwordx2 v[12:13], v4, s[4:7], s42 offen
s_cmp_lg_u32 s3, 0
s_cbranch_scc1 k_wdd_180
v_mov_b32 v8, 192
k_wd_179:
global_load_dword v9, v8, s[28:29] sc1
s_waitcnt vmcnt(0)
v_readfirstlane_b32 s48, v9
s_cmp_ge_u32 s48, 32
s_cbranch_scc1 k_wdd_180
s_sleep 2
s_sub_u32 s32, s32, 1
s_cmp_gt_i32 s32, 0
s_cbranch_scc1 k_wd_179
k_wdd_180:
s_barrier
k_lay_181:
s_add_u32 s47, s31, 63
s_mov_b32 s33, 120324096
s_mov_b32 s34, 120329216
s_mov_b32 s35, 120333312
s_mul_i32 s48, s31, 655360
s_lshl_b32 s36, s30, 14
s_add_u32 s36, s36, s48
s_add_u32 s36, s36, 12288
v_mov_b32 v12, -1
s_lshl_b32 s63, s30, 10
s_add_u32 s63, s63, 120356864
s_lshl_b32 s37, s31, 14
s_add_u32 s37, s37, 117443584
s_add_u32 s59, s37, 4096
s_waitcnt vmcnt(0)
s_barrier
s_barrier
s_waitcnt vmcnt(0)
s_barrier
s_barrier
v_lshlrev_b32 v23, v0, s58
v_cndmask_b32 v20, 0, v23, s[90:91]
v_cndmask_b32 v21, 0, v23, s[92:93]
v_cndmask_b32 v22, 0, v23, s[94:95]
v_cndmask_b32 v23, 0, v23, s[96:97]
s_mov_b32 s66, 0
k_fl2_196:
buffer_load_dwordx2 v[46:47], off, s[4:7], s46 sc1
s_waitcnt vmcnt(0)
v_min_u32 v46, v46, v47
v_cmp_lt_u32 vcc, s31, v46
v_mov_b64 v[46:47], 0
s_cbranch_vccnz k_cold2_184
s_sub_u32 s32, s32, 1
s_cmp_gt_i32 s32, 0
s_cbranch_scc1 k_fl2_196
s_branch k_cold2_184
k_T0_182:
s_waitcnt vmcnt(2)
v_smfmac_f32_16x16x64_bf16 v[40:43], v[4:7], v[48:55], v1
s_waitcnt vmcnt(1)
v_cmp_u_f32 vcc, v4, v8
v_smfmac_f32_16x16x64_bf16 v[24:27], v[8:11], a[24:31], v1
v_smfmac_f32_16x16x64_bf16 v[28:31], v[8:11], a[32:39], v1
s_cbranch_vccnz k_cold_183
k_okC_185:
s_waitcnt vmcnt(1)
v_smfmac_f32_16x16x64_bf16 v[36:39], v[8:11], a[40:47], v1
s_waitcnt lgkmcnt(0)
ds_read_b128 v[48:51], v2 offset:14336
v_smfmac_f32_16x16x64_bf16 v[32:35], v[4:7], v[64:71], v1
ds_read_b128 v[52:55], v2 offset:15360
ds_read_b128 v[64:67], v0 offset:51200
v_smfmac_f32_16x16x64_bf16 v[44:47], v[4:7], v[56:63], v1
ds_read_b128 v[68:71], v0 offset:52224
v_smfmac_f32_16x16x64_bf16 v[28:31], v[4:7], a[8:15], v1
v_smfmac_f32_16x16x64_bf16 v[24:27], v[4:7], a[0:7], v1
ds_read_b128 v[56:59], v2 offset:43008
v_smfmac_f32_16x16x64_bf16 v[36:39], v[4:7], a[16:23], v1
ds_read_b128 v[60:63], v2 offset:44032
s_waitcnt lgkmcnt(4)
v_smfmac_f32_16x16x64_bf16 v[40:43], v[8:11], v[48:55], v1
s_waitcnt vmcnt(0)
ds_write_b128 v0, v[12:15] offset:3072
s_waitcnt lgkmcnt(3)
v_smfmac_f32_16x16x64_bf16 v[32:35], v[8:11], v[64:71], v1
buffer_load_dwordx4 v[16:19], v0, s[4:7], s35 offen offset:0 sc1
v_cmp_u_f32 vcc, v12, v12
s_waitcnt lgkmcnt(1)
v_smfmac_f32_16x16x64_bf16 v[44:47], v[8:11], v[56:63], v1
ds_read_b128 v[56:59], v2 offset:16384
ds_read_b128 v[60:63], v2 offset:17408
ds_read_b128 v[64:67], v0 offset:61440
s_cbranch_vccnz k_coldA_186
k_okA_187:
v_smfmac_f32_16x16x64_bf16 v[36:39], v[12:15], a[64:71], v1
ds_read_b128 v[68:71], v0 offset:62464
s_waitcnt lgkmcnt(4)
v_smfmac_f32_16x16x64_bf16 v[40:43], v[12:15], a[72:79], v1
s_barrier
v_smfmac_f32_16x16x64_bf16 v[28:31], v[12:15], a[56:63], v1
ds_read_b128 v[8:11], v0 offset:0
buffer_load_dwordx4 v[48:51], v0, s[4:7], s36 offen offset:0 sc1
s_waitcnt lgkmcnt(3)
v_smfmac_f32_16x16x64_bf16 v[44:47], v[12:15], v[56:63], v1
ds_read_b128 v[56:59], v0 offset:63488
v_smfmac_f32_16x16x64_bf16 v[24:27], v[12:15], a[48:55], v1
ds_read_b128 v[60:63], v0 offset:64512
s_waitcnt lgkmcnt(3)
v_smfmac_f32_16x16x64_bf16 v[32:35], v[12:15], v[64:71], v1
buffer_load_dwordx4 v[52:55], v0, s[4:7], s36 offen offset:1024 sc1
s_waitcnt lgkmcnt(2)
v_smfmac_f32_16x16x64_bf16 v[24:27], v[8:11], a[80:87], v1
ds_read_b128 v[64:67], v0 offset:55296
ds_read_b128 v[68:71], v0 offset:56320
v_smfmac_f32_16x16x64_bf16 v[36:39], v[8:11], a[96:103], v1
s_waitcnt lgkmcnt(2)
ds_read_b128 v[4:7], v0 offset:1024
v_smfmac_f32_16x16x64_bf16 v[44:47], v[8:11], v[56:63], v1
ds_read_b128 v[56:59], v2 offset:12288
ds_read_b128 v[60:63], v2 offset:13312
v_smfmac_f32_16x16x64_bf16 v[28:31], v[8:11], a[88:95], v1
buffer_store_dwordx4 v[12:15], v0, s[8:11], s37 offen offset:2048 sc1
v_smfmac_f32_16x16x64_bf16 v[40:43], v[8:11], a[104:111], v1
s_waitcnt lgkmcnt(3)
s_waitcnt lgkmcnt(2)
v_smfmac_f32_16x16x64_bf16 v[32:35], v[8:11], v[64:71], v1
ds_read_b128 v[64:67], v0 offset:57344
ds_read_b128 v[12:15], v0 offset:2048
v_smfmac_f32_16x16x64_bf16 v[36:39], v[4:7], a[128:135], v1
s_waitcnt lgkmcnt(2)
v_smfmac_f32_16x16x64_bf16 v[44:47], v[4:7], v[56:63], v1
ds_read_b128 v[68:71], v0 offset:58368
buffer_load_dwordx4 v[56:59], v0, s[4:7], s36 offen offset:2048 sc1
v_smfmac_f32_16x16x64_bf16 v[28:31], v[4:7], a[120:127], v1
v_smfmac_f32_16x16x64_bf16 v[24:27], v[4:7], a[112:119], v1
s_waitcnt vmcnt(4)
ds_write_b128 v0, v[16:19] offset:7168
v_smfmac_f32_16x16x64_bf16 v[40:43], v[4:7], a[136:143], v1
s_waitcnt lgkmcnt(1)
buffer_load_dwordx4 v[60:63], v0, s[4:7], s36 offen offset:3072 sc1
v_cmp_u_f32 vcc, v16, v16
v_smfmac_f32_16x16x64_bf16 v[32:35], v[4:7], v[64:71], v1
ds_read_b128 v[64:67], v0 offset:59392
ds_read_b128 v[68:71], v0 offset:60416
v_smfmac_f32_16x16x64_bf16 v[28:31], v[12:15], a[152:159], v1
v_smfmac_f32_16x16x64_bf16 v[24:27], v[12:15], a[144:151], v1
s_cbranch_vccnz k_coldB_188
k_okB_189:
v_smfmac_f32_16x16x64_bf16 v[36:39], v[12:15], a[160:167], v1
s_waitcnt lgkmcnt(2)
buffer_store_dwordx4 v[16:19], v0, s[8:11], s59 offen offset:2048 sc1
s_barrier
ds_read_b128 v[4:7], v0 offset:5120
v_smfmac_f32_16x16x64_bf16 v[44:47], v[12:15], a[176:183], v1
ds_read_b128 v[8:11], v0 offset:4096
s_waitcnt lgkmcnt(2)
v_smfmac_f32_16x16x64_bf16 v[32:35], v[12:15], v[64:71], v1
ds_read_b128 v[64:67], v2 offset:22528
ds_read_b128 v[68:71], v2 offset:23552
v_smfmac_f32_16x16x64_bf16 v[24:27], v[16:19], a[184:191], v1
v_smfmac_f32_16x16x64_bf16 v[40:43], v[12:15], a[168:175], v1
s_waitcnt lgkmcnt(3)
ds_read_b128 v[12:15], v0 offset:6144
v_smfmac_f32_16x16x64_bf16 v[24:27], v[4:7], a[208:215], v1
s_waitcnt lgkmcnt(3)
v_smfmac_f32_16x16x64_bf16 v[28:31], v[4:7], a[216:223], v1
v_smfmac_f32_16x16x64_bf16 v[28:31], v[8:11], a[200:207], v1
s_waitcnt lgkmcnt(1)
v_smfmac_f32_16x16x64_bf16 v[24:27], v[8:11], v[64:71], v1
ds_read_b128 v[64:67], v2 offset:18432
s_waitcnt lgkmcnt(1)
v_smfmac_f32_16x16x64_bf16 v[24:27], v[12:15], a[224:231], v1
ds_read_b128 v[68:71], v2 offset:19456
v_smfmac_f32_16x16x64_bf16 v[28:31], v[12:15], a[232:239], v1
v_smfmac_f32_16x16x64_bf16 v[28:31], v[16:19], a[192:199], v1
v_cvt_pk_bf16_f32 v24, v24, v25
v_cvt_pk_bf16_f32 v25, v26, v27
v_smfmac_f32_16x16x64_bf16 v[32:35], v[4:7], v[80:87], v1
v_cvt_pk_bf16_f32 v26, v28, v29
v_cvt_pk_bf16_f32 v27, v30, v31
v_smfmac_f32_16x16x64_bf16 v[32:35], v[8:11], a[248:255], v1
s_waitcnt lgkmcnt(0)
v_mfma_f32_16x16x32_bf16 v[28:31], v[24:27], v[20:23], 0
v_and_b32 v26, 0xffffff7f, v0
v_smfmac_f32_16x16x64_bf16 v[32:35], v[16:19], v[64:71], v1
v_and_or_b32 v26, v1, 8, v26
v_mul_f32 v28, s51, v28
v_mul_f32 v29, s51, v29
v_mul_f32 v31, s51, v31
v_cvt_pk_bf16_f32 v24, v28, v29
v_mul_f32 v30, s51, v30
v_cvt_pk_bf16_f32 v25, v30, v31
v_smfmac_f32_16x16x64_bf16 v[32:35], v[12:15], v[96:103], v1
ds_write_b64 v26, v[24:25] offset:1152
v_smfmac_f32_16x16x64_bf16 v[36:39], v[8:11], v[72:79], v1
v_cvt_pk_bf16_f32 v32, v32, v33
v_smfmac_f32_16x16x64_bf16 v[36:39], v[16:19], a[240:247], v1
buffer_load_dwordx4 v[64:67], v0, s[4:7], s61 offen offset:0
v_cvt_pk_bf16_f32 v33, v34, v35
v_smfmac_f32_16x16x64_bf16 v[36:39], v[12:15], v[104:111], v1
s_waitcnt lgkmcnt(0)
v_smfmac_f32_16x16x64_bf16 v[36:39], v[4:7], v[88:95], v1
s_barrier
ds_read_b128 v[24:27], v0 offset:0
v_smfmac_f32_16x16x64_bf16 v[40:43], v[4:7], v[144:151], v1
ds_read_b128 v[28:31], v0 offset:1024
s_nop 0
v_cvt_pk_bf16_f32 v34, v36, v37
v_cvt_pk_bf16_f32 v35, v38, v39
s_nop 1
v_mfma_f32_16x16x32_bf16 v[36:39], v[32:35], v[20:23], 0
s_waitcnt vmcnt(5)
buffer_load_dwordx4 v[68:71], v0, s[4:7], s61 offen offset:1024
v_and_b32 v34, 0xffffff7f, v0
v_and_or_b32 v34, v1, 8, v34
s_waitcnt lgkmcnt(1)
v_mfma_f32_16x16x32_bf16 v[48:51], v[48:51], v[24:27], 0
v_cvt_pk_bf16_f32 v32, v36, v37
s_waitcnt lgkmcnt(0)
v_mfma_f32_16x16x32_bf16 v[48:51], v[52:55], v[28:31], v[48:51]
v_mov_b64 v[52:53], s[56:57]
v_cvt_pk_bf16_f32 v33, v38, v39
v_smfmac_f32_16x16x64_bf16 v[44:47], v[4:7], v[152:159], v1
ds_write_b64 v34, v[32:33] offset:3200
v_permlane32_swap_b32 v48, v50
v_permlane32_swap_b32 v49, v51
v_add_f32_dpp v52, v50, v48 row_ror:8 row_mask:0xf bank_mask:0x3
v_exp_f32 v52, v52
v_add_f32_dpp v53, v51, v49 row_ror:8 row_mask:0xf bank_mask:0x3
v_exp_f32 v53, v53
s_nop 0
v_cvt_pk_bf16_f32 v48, v52, v53
v_smfmac_f32_16x16x64_bf16 v[44:47], v[16:19], v[120:127], v1
ds_write_b32 v0, v48 offset:4108
v_smfmac_f32_16x16x64_bf16 v[44:47], v[12:15], v[168:175], v1
buffer_load_dwordx4 v[48:51], v0, s[4:7], s61 offen offset:2048
v_smfmac_f32_16x16x64_bf16 v[40:43], v[12:15], v[160:167], v1
s_waitcnt lgkmcnt(1)
v_xor_b32 v12, 0x80, v0
v_smfmac_f32_16x16x64_bf16 v[40:43], v[8:11], v[128:135], v1
s_waitcnt lgkmcnt(0)
s_barrier
ds_read_b128 v[32:35], v0 offset:2048
v_mov_b64 v[22:23], s[52:53]
v_smfmac_f32_16x16x64_bf16 v[40:43], v[16:19], v[112:119], v1
ds_read_b128 v[36:39], v0 offset:3072
ds_read_b128 v[16:19], v0 offset:4096
buffer_load_dwordx4 v[52:55], v0, s[4:7], s61 offen offset:3072
v_smfmac_f32_16x16x64_bf16 v[44:47], v[8:11], v[136:143], v1
ds_read_b128 v[12:15], v12 offset:4096
v_cvt_pk_bf16_f32 v40, v40, v41
v_mov_b64 v[20:21], s[52:53]
s_waitcnt lgkmcnt(3)
v_mfma_f32_16x16x32_bf16 v[24:27], v[32:35], v[24:27], 0
v_cvt_pk_bf16_f32 v41, v42, v43
s_waitcnt lgkmcnt(2)
v_mfma_f32_16x16x32_bf16 v[24:27], v[36:39], v[28:31], v[24:27]
s_waitcnt vmcnt(5)
s_waitcnt lgkmcnt(1)
v_mfma_f32_16x16x32_bf16 v[8:11], v[56:59], v[16:19], 0
buffer_load_dwordx4 v[56:59], v0, s[4:7], s62 offen offset:0
v_mov_b64 v[28:29], s[56:57]
v_cvt_pk_bf16_f32 v43, v46, v47
v_cvt_pk_bf16_f32 v42, v44, v45
v_permlane32_swap_b32 v25, v27
v_permlane32_swap_b32 v24, v26
v_mfma_f32_16x16x32_bf16 v[4:7], v[20:23], v[16:19], 0
s_waitcnt lgkmcnt(0)
v_add_f32_dpp v28, v26, v24 row_ror:8 row_mask:0xf bank_mask:0x3
v_add_f32_dpp v29, v27, v25 row_ror:8 row_mask:0xf bank_mask:0x3
v_exp_f32 v28, v28
v_mfma_f32_16x16x32_bf16 v[8:11], v[60:63], v[12:15], v[8:11]
buffer_load_dwordx4 v[60:63], v0, s[4:7], s62 offen offset:1024
v_exp_f32 v29, v29
v_permlane32_swap_b32 v42, v43
v_cvt_pk_bf16_f32 v24, v28, v29
v_mov_b64 v[44:45], s[54:55]
v_cvt_pk_bf16_f32 v25, v28, v29
v_mov_b32_dpp v26, v24 row_ror:8 row_mask:0xf bank_mask:0xf
v_mov_b32_dpp v27, v24 row_ror:8 row_mask:0xf bank_mask:0xf
v_mfma_f32_16x16x16_bf16 v[4:7], v[44:45], v[24:25], v[4:7]
v_permlane32_swap_b32 v40, v41
v_mov_b64 v[36:37], 0
v_mov_b64 v[38:39], 0
v_mov_b64 v[30:31], 0
v_mfma_f32_16x16x32_bf16 v[8:11], v[40:43], v[24:27], v[8:11]
buffer_load_dwordx4 v[16:19], v0, s[4:7], s62 offen offset:2048
v_rcp_f32 v6, v4
v_and_b32 v12, 0xffffff7f, v0
v_and_or_b32 v13, v1, 8, v12
v_rcp_f32_dpp v6, v4 row_ror:8 row_mask:0xf bank_mask:0xc
v_mov_b64 v[26:27], 0
v_pk_mul_f32 v[8:9], v[8:9], v[6:7] op_sel_hi:[1,0]
v_cvt_pk_bf16_f32 v44, v8, v9
v_pk_mul_f32 v[10:11], v[10:11], v[6:7] op_sel_hi:[1,0]
v_cvt_pk_bf16_f32 v45, v10, v11
s_waitcnt vmcnt(5)
ds_write_b64 v13, v[44:45] offset:7296
buffer_load_dwordx4 v[20:23], v0, s[4:7], s62 offen offset:3072
v_add_u32 v6, 0xd4800000, v6
v_cmp_lt_u32 vcc, 0x28000000, v6
v_mov_b64 v[34:35], 0
v_mov_b32_dpp v46, v44 row_ror:8 row_mask:0xf bank_mask:0xf
v_mov_b32_dpp v47, v45 row_ror:8 row_mask:0xf bank_mask:0xf
v_mov_b64 v[28:29], 0
v_mov_b64 v[32:33], 0
s_cbranch_vccnz k_slow_190
k_okS_191:
v_smfmac_f32_16x16x64_bf16 v[36:39], v[44:47], v[224:231], v1
s_waitcnt lgkmcnt(0)
s_barrier
ds_read_b128 v[8:11], v12 offset:6272
v_smfmac_f32_16x16x64_bf16 v[32:35], v[44:47], v[200:207], v1
s_waitcnt vmcnt(4)
ds_read_b128 v[4:7], v12 offset:6144
v_mov_b64 v[24:25], 0
v_smfmac_f32_16x16x64_bf16 v[28:31], v[44:47], v[48:55], v1
ds_read_b128 v[12:15], v12 offset:7168
ds_read_b128 v[48:51], v2 offset:40960
v_smfmac_f32_16x16x64_bf16 v[24:27], v[44:47], v[64:71], v1
ds_read_b128 v[52:55], v2 offset:41984
v_mov_b64 v[42:43], 0
s_waitcnt lgkmcnt(4)
v_smfmac_f32_16x16x64_bf16 v[24:27], v[8:11], v[184:191], v1
s_waitcnt lgkmcnt(3)
v_mov_b64 v[40:41], 0
v_smfmac_f32_16x16x64_bf16 v[24:27], v[4:7], v[176:183], v1
s_waitcnt lgkmcnt(2)
ds_read_b128 v[64:67], v2 offset:20480
v_smfmac_f32_16x16x64_bf16 v[24:27], v[12:15], v[192:199], v1
ds_read_b128 v[68:71], v2 offset:21504
v_smfmac_f32_16x16x64_bf16 v[40:43], v[44:47], v[240:247], v1
s_waitcnt vmcnt(2)
s_waitcnt lgkmcnt(2)
v_lshrrev_b32 v44, 16, v1
v_cvt_pk_bf16_f32 v24, v24, v25
v_bfi_b32 v24, 1, s45, v24
v_cvt_pk_bf16_f32 v25, v26, v27
v_smfmac_f32_16x16x64_bf16 v[28:31], v[8:11], v[48:55], v1
buffer_store_dwordx2 v[24:25], v44, s[4:7], s38 offen
ds_read_b128 v[48:51], v2 offset:38912
ds_read_b128 v[52:55], v2 offset:39936
v_smfmac_f32_16x16x64_bf16 v[28:31], v[12:15], v[56:63], v1
s_waitcnt lgkmcnt(2)
ds_read_b128 v[56:59], v2 offset:45056
v_smfmac_f32_16x16x64_bf16 v[28:31], v[4:7], v[64:71], v1
ds_read_b128 v[60:63], v2 offset:46080
v_smfmac_f32_16x16x64_bf16 v[32:35], v[8:11], v[208:215], v1
ds_read_b128 v[64:67], v2 offset:36864
s_nop 0
v_cvt_pk_bf16_f32 v28, v28, v29
v_bfi_b32 v28, 1, s45, v28
v_cvt_pk_bf16_f32 v29, v30, v31
v_smfmac_f32_16x16x64_bf16 v[32:35], v[12:15], v[216:223], v1
buffer_store_dwordx2 v[28:29], v44, s[4:7], s39 offen
v_smfmac_f32_16x16x64_bf16 v[40:43], v[12:15], v[248:255], v1
ds_read_b128 v[68:71], v2 offset:37888
s_waitcnt vmcnt(2)
v_smfmac_f32_16x16x64_bf16 v[32:35], v[4:7], v[16:23], v1
s_waitcnt lgkmcnt(2)
v_smfmac_f32_16x16x64_bf16 v[36:39], v[12:15], v[232:239], v1
ds_read_b128 v[16:19], v2 offset:47104
ds_read_b128 v[20:23], v2 offset:48128
v_cvt_pk_bf16_f32 v32, v32, v33
v_bfi_b32 v32, 1, s45, v32
v_cvt_pk_bf16_f32 v33, v34, v35
v_smfmac_f32_16x16x64_bf16 v[36:39], v[8:11], v[48:55], v1
buffer_store_dwordx2 v[32:33], v44, s[4:7], s40 offen
s_waitcnt lgkmcnt(2)
v_smfmac_f32_16x16x64_bf16 v[36:39], v[4:7], v[64:71], v1
s_nop 6
v_cvt_pk_bf16_f32 v36, v36, v37
v_cvt_pk_bf16_f32 v37, v38, v39
s_waitcnt lgkmcnt(0)
v_bfi_b32 v36, 1, s45, v36
v_smfmac_f32_16x16x64_bf16 v[40:43], v[8:11], v[16:23], v1
buffer_store_dwordx2 v[36:37], v44, s[4:7], s41 offen
v_smfmac_f32_16x16x64_bf16 v[40:43], v[4:7], v[56:63], v1
s_nop 6
v_cvt_pk_bf16_f32 v40, v40, v41
v_bfi_b32 v40, 1, s45, v40
v_cvt_pk_bf16_f32 v41, v42, v43
buffer_store_dwordx2 v[40:41], v44, s[4:7], s42 offen
s_barrier
buffer_load_dwordx4 v[48:51], v0, s[4:7], s60 offen offset:0
buffer_load_dwordx4 v[52:55], v0, s[4:7], s60 offen offset:1024
buffer_load_dwordx4 v[56:59], v0, s[4:7], s60 offen offset:2048
buffer_load_dwordx4 v[60:63], v0, s[4:7], s60 offen offset:3072
s_add_u32 s31, s31, 1
s_min_u32 s66, s66, s67
s_cmp_gt_u32 s66, s31
s_cbranch_scc0 k_fl_195
k_okF_197:
s_buffer_load_dwordx2 s[66:67], s[4:7], s46 glc
s_add_u32 s33, s33, 16384
s_bitset0_b32 s33, 16
s_barrier
buffer_load_dwordx4 v[4:7], v0, s[4:7], s33 offen offset:1024 sc1
buffer_load_dwordx4 v[8:11], v0, s[4:7], s33 offen offset:0 sc1
s_add_u32 s34, s33, 5120
s_add_u32 s35, s33, 9216
s_add_u32 s36, s36, 524288
s_add_u32 s37, s37, 10240
s_add_u32 s59, s59, 10240
v_mov_b64 v[32:33], 0
v_mov_b64 v[34:35], 0
v_mov_b64 v[36:37], 0
v_mov_b64 v[38:39], 0
v_mov_b64 v[40:41], 0
v_mov_b64 v[42:43], 0
v_mov_b64 v[44:45], 0
v_mov_b64 v[46:47], 0
s_sub_u32 s45, s45, 1
v_mov_b64 v[24:25], 0
v_mov_b64 v[26:27], 0
v_mov_b64 v[28:29], 0
v_mov_b64 v[30:31], 0
v_lshlrev_b32 v23, v0, s58
v_cndmask_b32 v20, 0, v23, s[90:91]
v_cndmask_b32 v21, 0, v23, s[92:93]
v_cndmask_b32 v22, 0, v23, s[94:95]
v_cndmask_b32 v23, 0, v23, s[96:97]
ds_read_b128 v[64:67], v0 offset:53248
ds_read_b128 v[68:71], v0 offset:54272
buffer_load_dwordx4 v[12:15], v0, s[4:7], s34 offen offset:0 sc1
s_cmp_lg_u32 s31, s47
s_cbranch_scc1 k_T0_182
s_branch k_done_192
k_cold2_184:
s_barrier
buffer_load_dwordx4 v[48:51], v0, s[4:7], s60 offen offset:0
buffer_load_dwordx4 v[52:55], v0, s[4:7], s60 offen offset:1024
buffer_load_dwordx4 v[56:59], v0, s[4:7], s60 offen offset:2048
buffer_load_dwordx4 v[60:63], v0, s[4:7], s60 offen offset:3072
ds_read_b128 v[64:67], v0 offset:53248
ds_read_b128 v[68:71], v0 offset:54272
k_cold_183:
buffer_load_dwordx4 v[4:7], v0, s[4:7], s33 offen offset:1024 sc1
buffer_load_dwordx4 v[8:11], v0, s[4:7], s33 offen offset:0 sc1
buffer_load_dwordx4 v[12:15], v0, s[4:7], s34 offen offset:0 sc1
s_sub_u32 s32, s32, 1
s_cmp_gt_i32 s32, 0
s_cbranch_scc0 k_okC_185
v_mov_b64 v[24:25], 0
v_mov_b64 v[26:27], 0
v_mov_b64 v[28:29], 0
v_mov_b64 v[30:31], 0
v_mov_b64 v[32:33], 0
v_mov_b64 v[34:35], 0
v_mov_b64 v[36:37], 0
v_mov_b64 v[38:39], 0
v_mov_b64 v[40:41], 0
v_mov_b64 v[42:43], 0
v_mov_b64 v[44:45], 0
v_mov_b64 v[46:47], 0
s_branch k_T0_182
k_coldA_186:
buffer_load_dwordx4 v[12:15], v0, s[4:7], s34 offen offset:0 sc1
s_sub_u32 s32, s32, 1
s_cmp_gt_i32 s32, 0
s_waitcnt vmcnt(0)
v_cmp_u_f32 vcc, v12, v12
ds_write_b128 v0, v[12:15] offset:3072
s_waitcnt lgkmcnt(0)
s_cbranch_vccz k_okA_187
s_cbranch_scc1 k_coldA_186
s_branch k_okA_187
k_coldB_188:
buffer_load_dwordx4 v[16:19], v0, s[4:7], s35 offen offset:0 sc1
s_sub_u32 s32, s32, 1
s_cmp_gt_i32 s32, 0
s_waitcnt vmcnt(0)
v_cmp_u_f32 vcc, v16, v16
ds_write_b128 v0, v[16:19] offset:7168
s_waitcnt lgkmcnt(0)
s_cbranch_vccz k_okB_189
s_cbranch_scc1 k_coldB_188
s_branch k_okB_189
k_fl_195:
buffer_load_dwordx2 v[46:47], off, s[4:7], s46 sc1
s_waitcnt vmcnt(0)
v_min_u32 v46, v46, v47
v_cmp_lt_u32 vcc, s31, v46
v_mov_b64 v[46:47], 0
s_cbranch_vccnz k_okF_197
s_sub_u32 s32, s32, 1
s_cmp_gt_i32 s32, 0
s_cbranch_scc1 k_fl_195
s_branch k_okF_197
k_slow_190:
ds_read_b128 v[24:27], v0 offset:0
ds_read_b128 v[28:31], v0 offset:1024
v_mov_b32 v46, 0xff7fffff
s_add_u32 s48, s36, 0xffffd000
buffer_load_dwordx4 v[32:35], v0, s[4:7], s48 offen offset:0 sc1
buffer_load_dwordx4 v[36:39], v0, s[4:7], s48 offen offset:1024 sc1
s_waitcnt vmcnt(1) lgkmcnt(1)
v_mfma_f32_16x16x32_bf16 v[4:7], v[32:35], v[24:27], 0
s_waitcnt vmcnt(0) lgkmcnt(0)
v_mfma_f32_16x16x32_bf16 v[4:7], v[36:39], v[28:31], v[4:7]
v_mov_b64 v[8:9], s[56:57]
s_nop 5
v_permlane32_swap_b32 v4, v6
v_permlane32_swap_b32 v5, v7
v_add_f32_dpp v8, v6, v4 row_ror:8 row_mask:0xf bank_mask:0x3
s_nop 0
v_add_f32_dpp v9, v7, v5 row_ror:8 row_mask:0xf bank_mask:0x3
v_max3_f32 v46, v46, v8, v9
s_add_u32 s48, s36, 0xffffe000
buffer_load_dwordx4 v[32:35], v0, s[4:7], s48 offen offset:0 sc1
buffer_load_dwordx4 v[36:39], v0, s[4:7], s48 offen offset:1024 sc1
s_waitcnt vmcnt(1)
v_mfma_f32_16x16x32_bf16 v[4:7], v[32:35], v[24:27], 0
s_waitcnt vmcnt(0)
v_mfma_f32_16x16x32_bf16 v[4:7], v[36:39], v[28:31], v[4:7]
v_mov_b64 v[10:11], s[56:57]
s_nop 5
v_permlane32_swap_b32 v4, v6
v_permlane32_swap_b32 v5, v7
v_add_f32_dpp v10, v6, v4 row_ror:8 row_mask:0xf bank_mask:0x3
s_nop 0
v_add_f32_dpp v11, v7, v5 row_ror:8 row_mask:0xf bank_mask:0x3
v_max3_f32 v46, v46, v10, v11
s_add_u32 s48, s36, 0xfffff000
buffer_load_dwordx4 v[32:35], v0, s[4:7], s48 offen offset:0 sc1
buffer_load_dwordx4 v[36:39], v0, s[4:7], s48 offen offset:1024 sc1
s_waitcnt vmcnt(1)
v_mfma_f32_16x16x32_bf16 v[4:7], v[32:35], v[24:27], 0
s_waitcnt vmcnt(0)
v_mfma_f32_16x16x32_bf16 v[4:7], v[36:39], v[28:31], v[4:7]
v_mov_b64 v[12:13], s[56:57]
s_nop 5
v_permlane32_swap_b32 v4, v6
v_permlane32_swap_b32 v5, v7
v_add_f32_dpp v12, v6, v4 row_ror:8 row_mask:0xf bank_mask:0x3
s_nop 0
v_add_f32_dpp v13, v7, v5 row_ror:8 row_mask:0xf bank_mask:0x3
v_max3_f32 v46, v46, v12, v13
s_add_u32 s48, s36, 0x0
buffer_load_dwordx4 v[32:35], v0, s[4:7], s48 offen offset:0 sc1
buffer_load_dwordx4 v[36:39], v0, s[4:7], s48 offen offset:1024 sc1
s_waitcnt vmcnt(1)
v_mfma_f32_16x16x32_bf16 v[4:7], v[32:35], v[24:27], 0
s_waitcnt vmcnt(0)
v_mfma_f32_16x16x32_bf16 v[4:7], v[36:39], v[28:31], v[4:7]
v_mov_b64 v[14:15], s[56:57]
s_nop 5
v_permlane32_swap_b32 v4, v6
v_permlane32_swap_b32 v5, v7
v_add_f32_dpp v14, v6, v4 row_ror:8 row_mask:0xf bank_mask:0x3
s_nop 0
v_add_f32_dpp v15, v7, v5 row_ror:8 row_mask:0xf bank_mask:0x3
v_max3_f32 v46, v46, v14, v15
ds_read_b128 v[32:35], v0 offset:2048
ds_read_b128 v[36:39], v0 offset:3072
s_waitcnt lgkmcnt(1)
v_mfma_f32_16x16x32_bf16 v[4:7], v[32:35], v[24:27], 0
s_waitcnt lgkmcnt(0)
v_mfma_f32_16x16x32_bf16 v[4:7], v[36:39], v[28:31], v[4:7]
v_mov_b64 v[44:45], s[56:57]
s_nop 5
v_permlane32_swap_b32 v4, v6
v_permlane32_swap_b32 v5, v7
v_add_f32_dpp v44, v6, v4 row_ror:8 row_mask:0xf bank_mask:0x3
s_nop 0
v_add_f32_dpp v45, v7, v5 row_ror:8 row_mask:0xf bank_mask:0x3
v_max3_f32 v46, v46, v44, v45
buffer_load_dwordx4 v[32:35], v0, s[4:7], s36 offen offset:2048 sc1
buffer_load_dwordx4 v[36:39], v0, s[4:7], s36 offen offset:3072 sc1
v_mov_b32 v47, v46
s_nop 1
v_permlane32_swap_b32 v46, v47
v_max_f32 v46, v46, v47
v_mov_b32 v47, v46
s_nop 1
v_permlane16_swap_b32 v46, v47
v_max_f32 v46, v46, v47
v_sub_f32 v8, v8, v46
v_exp_f32 v8, v8
v_sub_f32 v9, v9, v46
v_exp_f32 v9, v9
v_sub_f32 v10, v10, v46
v_exp_f32 v10, v10
v_sub_f32 v11, v11, v46
v_exp_f32 v11, v11
v_sub_f32 v12, v12, v46
v_exp_f32 v12, v12
v_sub_f32 v13, v13, v46
v_exp_f32 v13, v13
v_sub_f32 v14, v14, v46
v_exp_f32 v14, v14
v_sub_f32 v15, v15, v46
v_exp_f32 v15, v15
v_sub_f32 v44, v44, v46
v_exp_f32 v44, v44
v_sub_f32 v45, v45, v46
v_exp_f32 v45, v45
v_cvt_pk_bf16_f32 v4, v8, v9
v_cvt_pk_bf16_f32 v5, v10, v11
v_cvt_pk_bf16_f32 v6, v12, v13
v_cvt_pk_bf16_f32 v7, v14, v15
v_mov_b32_dpp v8, v4 row_ror:8 row_mask:0xf bank_mask:0xf
v_mov_b32_dpp v9, v5 row_ror:8 row_mask:0xf bank_mask:0xf
v_mov_b32_dpp v10, v6 row_ror:8 row_mask:0xf bank_mask:0xf
v_mov_b32_dpp v11, v7 row_ror:8 row_mask:0xf bank_mask:0xf
v_cvt_pk_bf16_f32 v24, v44, v45
v_cvt_pk_bf16_f32 v25, v44, v45
s_nop 0
v_mov_b32_dpp v26, v24 row_ror:8 row_mask:0xf bank_mask:0xf
v_mov_b32_dpp v27, v24 row_ror:8 row_mask:0xf bank_mask:0xf
v_mov_b64 v[28:29], s[52:53]
v_mov_b64 v[30:31], s[52:53]
s_nop 1
v_mfma_f32_16x16x32_bf16 v[44:47], v[28:31], v[4:7], 0
s_waitcnt vmcnt(1)
v_mfma_f32_16x16x32_bf16 v[12:15], v[32:35], v[4:7], 0
s_waitcnt vmcnt(0)
v_mfma_f32_16x16x32_bf16 v[12:15], v[36:39], v[8:11], v[12:15]
v_mfma_f32_16x16x32_bf16 v[12:15], v[40:43], v[24:27], v[12:15]
v_mov_b64 v[28:29], s[54:55]
s_nop 1
v_mfma_f32_16x16x16_bf16 v[44:47], v[28:29], v[24:25], v[44:47]
s_nop 6
v_rcp_f32 v4, v44
s_nop 1
v_rcp_f32_dpp v4, v44 row_ror:8 row_mask:0xf bank_mask:0xc
s_nop 0
v_mul_f32 v12, v4, v12
v_mul_f32 v13, v4, v13
v_mul_f32 v14, v4, v14
v_mul_f32 v15, v4, v15
v_cvt_pk_bf16_f32 v44, v12, v13
v_cvt_pk_bf16_f32 v45, v14, v15
v_and_b32 v12, 0xffffff7f, v0
v_and_or_b32 v8, v1, 8, v12
ds_write_b64 v8, v[44:45] offset:7296
v_mov_b32_dpp v46, v44 row_ror:8 row_mask:0xf bank_mask:0xf
v_mov_b32_dpp v47, v45 row_ror:8 row_mask:0xf bank_mask:0xf
v_mov_b64 v[24:25], 0
v_mov_b64 v[26:27], 0
v_mov_b64 v[28:29], 0
v_mov_b64 v[30:31], 0
v_mov_b64 v[32:33], 0
v_mov_b64 v[34:35], 0
v_mov_b64 v[36:37], 0
v_mov_b64 v[38:39], 0
s_waitcnt lgkmcnt(0)
s_branch k_okS_191
k_done_192:
buffer_load_dwordx4 v[16:19], v0, s[4:7], s35 offen offset:0 sc1
k_xs_198:
s_waitcnt vmcnt(1)
v_cmp_u_f32 vcc, v4, v12
s_waitcnt vmcnt(0)
v_cmp_u_f32 s[66:67], v16, v16
s_or_b64 vcc, vcc, s[66:67]
s_cbranch_vccz k_xd_199
buffer_load_dwordx4 v[4:7], v0, s[4:7], s33 offen offset:1024 sc1
buffer_load_dwordx4 v[8:11], v0, s[4:7], s33 offen offset:0 sc1
buffer_load_dwordx4 v[12:15], v0, s[4:7], s34 offen offset:0 sc1
buffer_load_dwordx4 v[16:19], v0, s[4:7], s35 offen offset:0 sc1
s_sub_u32 s32, s32, 1
s_cmp_gt_i32 s32, 0
s_cbranch_scc1 k_xs_198
k_xd_199:
s_waitcnt vmcnt(1)
buffer_store_dwordx4 v[12:15], v0, s[8:11], s37 offen offset:2048 sc1
s_waitcnt vmcnt(1)
buffer_store_dwordx4 v[16:19], v0, s[8:11], s59 offen offset:2048 sc1
s_add_u32 s31, s31, 1
s_cmp_lt_u32 s31, 128
s_cbranch_scc1 k_lay_181
s_add_u32 s30, s30, 112
s_waitcnt vmcnt(0) lgkmcnt(0)
s_barrier
s_branch k_fin_7
.section .rodata,"a"
.p2align 6
.amdhsa_kernel interleave_layers__memory_aug_recurrent_mem_tr__spectral_gfnet__prompt_kernel
  .amdhsa_next_free_vgpr 512
  .amdhsa_next_free_sgpr 102
  .amdhsa_accum_offset 256
  .amdhsa_group_segment_fixed_size 0
  .amdhsa_kernarg_size 104
  .amdhsa_user_sgpr_count 2
  .amdhsa_user_sgpr_kernarg_segment_ptr 1
  .amdhsa_system_sgpr_workgroup_id_x 1
  .amdhsa_float_denorm_mode_32 3
.end_amdhsa_kernel
```

```asm
; @launch grid=(256,1,1) block=(256,1,1) lds=163840
.amdgcn_target "amdgcn-amd-amdhsa--gfx950"
.text
.globl interleave_layers__memory_aug_recurrent_mem_tr__spectral_gfnet__prompt_kernel
.p2align 8
.type interleave_layers__memory_aug_recurrent_mem_tr__spectral_gfnet__prompt_kernel,@function
interleave_layers__memory_aug_recurrent_mem_tr__spectral_gfnet__prompt_kernel:
s_load_dwordx2 s[72:73], s[0:1], 8
s_load_dwordx4 s[76:79], s[0:1], 16
s_load_dwordx4 s[80:83], s[0:1], 32
s_load_dwordx2 s[28:29], s[0:1], 88
s_load_dwordx2 s[74:75], s[0:1], 96
v_lshrrev_b32 v1, 6, v0
v_and_b32 v0, 63, v0
v_readfirstlane_b32 s3, v1
s_waitcnt lgkmcnt(0)
s_mov_b32 s4, s74
s_mov_b32 s5, s75
s_mov_b32 s6, 268435456
s_mov_b32 s7, 0x20000
s_mov_b32 s8, s76
s_mov_b32 s9, s77
s_mov_b32 s10, 5242880
s_mov_b32 s11, 0x20000
s_mov_b32 s12, s78
s_mov_b32 s13, s79
s_mov_b32 s14, 5242880
s_mov_b32 s15, 0x20000
s_mov_b32 s16, s80
s_mov_b32 s17, s81
s_mov_b32 s18, 5242880
s_mov_b32 s19, 0x20000
s_mov_b32 s20, s82
s_mov_b32 s21, s83
s_mov_b32 s22, 5242880
s_mov_b32 s23, 0x20000
s_mov_b32 s24, s72
s_mov_b32 s25, s73
s_mov_b32 s26, 10240
s_mov_b32 s27, 0x20000
s_mov_b32 s32, 400000
s_getreg_b32 s52, hwreg(HW_REG_XCC_ID, 0, 4)
s_cmp_lg_u32 s3, 0
s_cbranch_scc1 k_skip_1
s_mov_b32 s55, s52
s_mov_b32 s54, 400
v_mov_b32 v4, 0
s_mov_b64 exec, 0xff
v_mov_b32 v4, 30
v_writelane_b32 v4, 32, 0
v_writelane_b32 v4, 28, 7
v_lshlrev_b32 v5, 2, v0
v_mov_b32 v2, 1
k_clm_9:
s_mov_b64 exec, 1
s_lshl_b32 s53, s52, 2
v_mov_b32 v1, s53
global_atomic_add v3, v1, v2, s[28:29] sc0 sc1
v_readlane_b32 s53, v4, s52
s_nop 3
s_waitcnt vmcnt(0)
v_cmp_gt_u32 vcc, s53, v3
s_cbranch_vccnz k_got_11
s_mov_b64 exec, 0xff
k_spr_10:
global_load_dword v6, v5, s[28:29] sc1
v_mov_b32 v3, 99
s_waitcnt vmcnt(0)
v_cmp_lt_u32 vcc, v6, v4
s_cbranch_vccz k_got_11
s_sub_u32 s54, s54, 1
s_cmp_gt_i32 s54, 0
s_cbranch_scc1 k_spr_10
s_ff1_i32_b32 s52, vcc_lo
s_branch k_clm_9
k_got_11:
s_mov_b64 exec, 1
s_cmp_lg_u32 s52, s55
s_cselect_b32 s53, 0x10000, 0
v_lshl_or_b32 v3, s52, 8, v3
v_or_b32 v3, s53, v3
v_mov_b32 v1, 0
ds_write_b32 v1, v3
s_mov_b64 exec, -1
s_waitcnt lgkmcnt(0)
k_skip_1:
s_barrier
v_mov_b32 v1, 0
ds_read_b32 v2, v1
s_waitcnt lgkmcnt(0)
v_readfirstlane_b32 s53, v2
s_barrier
s_and_b32 s30, s53, 255
s_bfe_u32 s52, s53, 0x80008
s_and_b32 s64, s53, 0x10000
s_cmp_gt_u32 s30, 31
s_cbranch_scc1 k_end_2
s_cmp_eq_u32 s52, 0
s_cbranch_scc1 k_team_3
v_lshlrev_b32 v0, 4, v0
s_cmp_gt_u32 s52, 4
s_cbranch_scc1 k_nb_8
s_mul_i32 s53, s52, 20
s_add_u32 s53, s53, s30
s_sub_u32 s53, s53, 20
s_cmp_lt_u32 s30, 20
s_cmov_b32 s30, s53
s_cbranch_scc1 k_o_4
s_mul_i32 s53, s52, 10
s_add_u32 s30, s30, s53
s_sub_u32 s30, s30, 30
s_branch k_p_6
k_nb_8:
s_mul_i32 s53, s52, 11
s_add_u32 s53, s53, s30
s_sub_u32 s53, s53, 74
s_cmp_ge_u32 s30, 19
s_cmov_b32 s30, s53
s_cbranch_scc1 k_at_5
s_mul_i32 s53, s52, 19
s_add_u32 s30, s30, s53
s_sub_u32 s30, s30, 55
s_cmp_lt_u32 s30, 96
s_cbranch_scc1 k_p_6
s_mov_b32 s30, 31
s_branch k_at_5
k_end_2:
s_endpgm
k_at_5:
s_lshl_b32 s52, s30, 2
s_add_u32 s52, s52, s3
s_lshl_b32 s52, s52, 9
s_add_u32 s52, s52, 222298112
v_mov_b64 v[2:3], 0
v_lshrrev_b32 v1, 1, v0
buffer_store_dwordx2 v[2:3], v1, s[4:7], s52 offen sc1
s_lshl_b32 s47, s30, 2
s_add_u32 s47, s47, s3
v_bfe_u32 v6, v0, 4, 5
v_lshrrev_b32 v2, 9, v0
v_bfe_u32 v8, v6, 2, 1
s_mov_b32 s56, 0x3acccccd
v_bfe_u32 v9, v6, 3, 1
v_and_b32 v1, 0x13, v6
v_lshl_add_u32 v1, v8, 3, v1
v_lshl_add_u32 v1, v9, 2, v1
k_gt_12:
s_mul_i32 s52, s47, 1639
s_lshr_b32 s52, s52, 16
s_mul_i32 s53, s52, 40
s_sub_u32 s53, s47, s53
s_lshl_b32 s52, s52, 5
s_lshl_b32 s53, s53, 1
v_add_u32 v3, s52, v1
v_add_u32 v6, s53, v2
v_and_b32 v4, 1, v3
v_cvt_f32_u32 v4, v4
v_mul_f32 v4, 0.5, v4
v_mul_f32 v4, 0.5, v4
v_cmp_gt_u32 vcc, 2, v3
s_nop 1
v_cndmask_b32 v4, v4, 0, vcc
v_mov_b32 v5, 0x3d64f92e
v_mov_b32 v8, 0x3d21e89b
v_cndmask_b32 v5, v5, v8, vcc
v_cmp_eq_u32 vcc, 0, v3
v_lshrrev_b32 v3, 1, v3
v_mov_b32 v8, 320
v_cndmask_b32 v3, v3, v8, vcc
v_lshlrev_b32 v6, 3, v6
v_mul_u32_u24 v6, v6, v3
v_cvt_f32_u32 v6, v6
v_cvt_f32_u32 v3, v3
v_fma_f32 v8, v6, s56, v4
v_add_f32 v6, v6, v3
v_fract_f32 v8, v8
v_cos_f32 v8, v8
v_fma_f32 v9, v6, s56, v4
v_add_f32 v6, v6, v3
v_fract_f32 v9, v9
v_cos_f32 v9, v9
v_fma_f32 v10, v6, s56, v4
v_add_f32 v6, v6, v3
v_fract_f32 v10, v10
v_cos_f32 v10, v10
v_fma_f32 v11, v6, s56, v4
v_add_f32 v6, v6, v3
v_fract_f32 v11, v11
v_cos_f32 v11, v11
v_fma_f32 v12, v6, s56, v4
v_add_f32 v6, v6, v3
v_fract_f32 v12, v12
v_cos_f32 v12, v12
v_fma_f32 v13, v6, s56, v4
v_add_f32 v6, v6, v3
v_fract_f32 v13, v13
v_cos_f32 v13, v13
v_fma_f32 v14, v6, s56, v4
v_add_f32 v6, v6, v3
v_fract_f32 v14, v14
v_cos_f32 v14, v14
v_fma_f32 v15, v6, s56, v4
v_add_f32 v6, v6, v3
v_fract_f32 v15, v15
v_cos_f32 v15, v15
v_mul_f32 v8, v5, v8
v_mul_f32 v9, v5, v9
v_mul_f32 v10, v5, v10
v_mul_f32 v11, v5, v11
v_mul_f32 v12, v5, v12
v_mul_f32 v13, v5, v13
v_mul_f32 v14, v5, v14
v_mul_f32 v15, v5, v15
v_cvt_pk_bf16_f32 v16, v8, v9
v_cvt_pk_bf16_f32 v17, v10, v11
v_cvt_pk_bf16_f32 v18, v12, v13
v_cvt_pk_bf16_f32 v19, v14, v15
s_lshl_b32 s52, s47, 10
s_add_u32 s52, s52, 213909504
buffer_store_dwordx4 v[16:19], v0, s[4:7], s52 offen sc1
s_add_u32 s47, s47, 128
s_cmp_lt_u32 s47, 800
s_cbranch_scc1 k_gt_12
s_waitcnt vmcnt(0)
s_barrier
s_cmp_lg_u32 s3, 0
s_cbranch_scc1 k_sd_14
s_mov_b64 exec, 1
v_mov_b32 v2, 128
v_mov_b32 v3, 1
global_atomic_add v2, v3, s[28:29] sc1
s_mov_b64 exec, -1
k_sd_14:
s_lshl_b32 s47, s30, 2
s_add_u32 s47, s47, s3
v_bfe_u32 v6, v0, 4, 5
v_lshrrev_b32 v2, 9, v0
v_bfe_u32 v8, v6, 2, 1
s_mov_b32 s56, 0x3acccccd
v_lshrrev_b32 v9, 3, v6
v_and_b32 v1, 3, v6
v_lshl_add_u32 v1, v8, 4, v1
v_lshl_add_u32 v1, v9, 2, v1
k_gt_15:
s_mul_i32 s52, s47, 1639
s_lshr_b32 s52, s52, 16
s_mul_i32 s53, s52, 40
s_sub_u32 s53, s47, s53
s_lshl_b32 s52, s52, 5
s_lshl_b32 s53, s53, 1
v_add_u32 v3, s52, v1
v_add_u32 v6, s53, v2
v_cmp_eq_u32 vcc, 0, v6
v_lshlrev_b32 v6, 2, v6
v_mul_u32_u24 v6, v6, v3
v_cvt_f32_u32 v6, v6
v_lshlrev_b32 v4, 31, v3
v_cvt_f32_u32 v3, v3
v_mul_f32 v8, s56, v6
v_add_f32 v6, v6, v3
v_fract_f32 v8, v8
v_sin_f32 v9, v8
v_cos_f32 v8, v8
v_mul_f32 v10, s56, v6
v_add_f32 v6, v6, v3
v_fract_f32 v10, v10
v_sin_f32 v11, v10
v_cos_f32 v10, v10
v_mul_f32 v12, s56, v6
v_add_f32 v6, v6, v3
v_fract_f32 v12, v12
v_sin_f32 v13, v12
v_cos_f32 v12, v12
v_mul_f32 v14, s56, v6
v_add_f32 v6, v6, v3
v_fract_f32 v14, v14
v_sin_f32 v15, v14
v_cos_f32 v14, v14
v_mul_f32 v8, 0x3d64f92e, v8
v_mul_f32 v9, 0xbd64f92e, v9
v_mul_f32 v10, 0x3d64f92e, v10
v_mul_f32 v11, 0xbd64f92e, v11
v_mul_f32 v12, 0x3d64f92e, v12
v_mul_f32 v13, 0xbd64f92e, v13
v_mul_f32 v14, 0x3d64f92e, v14
v_mul_f32 v15, 0xbd64f92e, v15
v_mov_b32 v5, 0x3d21e89b
v_xor_b32 v4, v4, v5
v_cndmask_b32 v8, v8, v4, vcc
v_cndmask_b32 v9, v9, v5, vcc
v_cvt_pk_bf16_f32 v16, v8, v9
v_cvt_pk_bf16_f32 v17, v10, v11
v_cvt_pk_bf16_f32 v18, v12, v13
v_cvt_pk_bf16_f32 v19, v14, v15
s_lshl_b32 s52, s47, 10
s_add_u32 s52, s52, 214958080
buffer_store_dwordx4 v[16:19], v0, s[4:7], s52 offen sc1
s_add_u32 s47, s47, 128
s_cmp_lt_u32 s47, 800
s_cbranch_scc1 k_gt_15
s_lshl_b32 s52, s30, 2
s_add_u32 s52, s52, s3
s_lshr_b32 s53, s52, 6
s_mul_i32 s53, s53, 393216
s_mul_i32 s52, s52, 10240
s_add_u32 s52, s52, s53
s_add_u32 s52, s52, 117440512
v_mov_b64 v[4:5], -1
v_mov_b64 v[6:7], -1
buffer_store_dwordx4 v[4:7], v0, s[4:7], s52 offen offset:0 sc1
buffer_store_dwordx4 v[4:7], v0, s[4:7], s52 offen offset:1024 sc1
buffer_store_dwordx4 v[4:7], v0, s[4:7], s52 offen offset:2048 sc1
buffer_store_dwordx4 v[4:7], v0, s[4:7], s52 offen offset:3072 sc1
s_add_u32 s52, s52, 4096
buffer_store_dwordx4 v[4:7], v0, s[4:7], s52 offen offset:0 sc1
buffer_store_dwordx4 v[4:7], v0, s[4:7], s52 offen offset:1024 sc1
buffer_store_dwordx4 v[4:7], v0, s[4:7], s52 offen offset:2048 sc1
buffer_store_dwordx4 v[4:7], v0, s[4:7], s52 offen offset:3072 sc1
s_add_u32 s52, s52, 4096
buffer_store_dwordx4 v[4:7], v0, s[4:7], s52 offen offset:0 sc1
buffer_store_dwordx4 v[4:7], v0, s[4:7], s52 offen offset:1024 sc1
s_waitcnt vmcnt(0)
s_barrier
s_cmp_lg_u32 s3, 0
s_cbranch_scc1 k_sd_17
s_mov_b64 exec, 1
v_mov_b32 v2, 192
v_mov_b32 v3, 1
global_atomic_add v2, v3, s[28:29] sc1
s_mov_b64 exec, -1
k_sd_17:
v_lshrrev_b32 v1, 8, v0
v_and_b32 v2, 0xf0, v0
v_lshl_add_u32 v8, v1, 13, v2
v_bfe_u32 v2, v0, 6, 4
v_and_b32 v3, 7, v2
v_xor_b32 v3, s3, v3
v_lshlrev_b32 v3, 5, v3
v_lshl_add_u32 v16, v2, 10, v3
v_bfe_u32 v2, v0, 4, 2
v_lshl_add_u32 v16, v2, 3, v16
v_xor_b32 v19, 0x80, v16
v_xor_b32 v9, 32, v8
v_xor_b32 v10, 64, v8
v_xor_b32 v11, 96, v8
v_xor_b32 v12, 128, v8
v_xor_b32 v13, 160, v8
v_xor_b32 v14, 192, v8
v_xor_b32 v15, 224, v8
v_add_u32 v17, 65536, v16
v_add_u32 v18, 131072, v16
v_add_u32 v20, 65536, v19
v_add_u32 v21, 131072, v19
s_mul_i32 s52, s3, 1310720
s_lshl_b32 s53, s30, 8
s_add_u32 s52, s52, s53
s_mul_i32 s53, s3, 40960
s_add_u32 m0, s53, 0
s_add_u32 s54, s52, 0
buffer_load_dwordx4 v8, s[12:15], s54 offen lds
s_add_u32 m0, s53, 1024
s_add_u32 s54, s52, 32768
buffer_load_dwordx4 v9, s[12:15], s54 offen lds
s_add_u32 m0, s53, 2048
s_add_u32 s54, s52, 65536
buffer_load_dwordx4 v10, s[12:15], s54 offen lds
s_add_u32 m0, s53, 3072
s_add_u32 s54, s52, 98304
buffer_load_dwordx4 v11, s[12:15], s54 offen lds
s_add_u32 m0, s53, 4096
s_add_u32 s54, s52, 131072
buffer_load_dwordx4 v12, s[12:15], s54 offen lds
s_add_u32 m0, s53, 5120
s_add_u32 s54, s52, 163840
buffer_load_dwordx4 v13, s[12:15], s54 offen lds
s_add_u32 m0, s53, 6144
s_add_u32 s54, s52, 196608
buffer_load_dwordx4 v14, s[12:15], s54 offen lds
s_add_u32 m0, s53, 7168
s_add_u32 s54, s52, 229376
buffer_load_dwordx4 v15, s[12:15], s54 offen lds
s_add_u32 m0, s53, 8192
s_add_u32 s54, s52, 262144
buffer_load_dwordx4 v8, s[12:15], s54 offen lds
s_add_u32 m0, s53, 9216
s_add_u32 s54, s52, 294912
buffer_load_dwordx4 v9, s[12:15], s54 offen lds
s_add_u32 m0, s53, 10240
s_add_u32 s54, s52, 327680
buffer_load_dwordx4 v10, s[12:15], s54 offen lds
s_add_u32 m0, s53, 11264
s_add_u32 s54, s52, 360448
buffer_load_dwordx4 v11, s[12:15], s54 offen lds
s_add_u32 m0, s53, 12288
s_add_u32 s54, s52, 393216
buffer_load_dwordx4 v12, s[12:15], s54 offen lds
s_add_u32 m0, s53, 13312
s_add_u32 s54, s52, 425984
buffer_load_dwordx4 v13, s[12:15], s54 offen lds
s_add_u32 m0, s53, 14336
s_add_u32 s54, s52, 458752
buffer_load_dwordx4 v14, s[12:15], s54 offen lds
s_add_u32 m0, s53, 15360
s_add_u32 s54, s52, 491520
buffer_load_dwordx4 v15, s[12:15], s54 offen lds
s_add_u32 m0, s53, 16384
s_add_u32 s54, s52, 524288
buffer_load_dwordx4 v8, s[12:15], s54 offen lds
s_add_u32 m0, s53, 17408
s_add_u32 s54, s52, 557056
buffer_load_dwordx4 v9, s[12:15], s54 offen lds
s_add_u32 m0, s53, 18432
s_add_u32 s54, s52, 589824
buffer_load_dwordx4 v10, s[12:15], s54 offen lds
s_add_u32 m0, s53, 19456
s_add_u32 s54, s52, 622592
buffer_load_dwordx4 v11, s[12:15], s54 offen lds
s_add_u32 m0, s53, 20480
s_add_u32 s54, s52, 655360
buffer_load_dwordx4 v12, s[12:15], s54 offen lds
s_add_u32 m0, s53, 21504
s_add_u32 s54, s52, 688128
buffer_load_dwordx4 v13, s[12:15], s54 offen lds
s_add_u32 m0, s53, 22528
s_add_u32 s54, s52, 720896
buffer_load_dwordx4 v14, s[12:15], s54 offen lds
s_add_u32 m0, s53, 23552
s_add_u32 s54, s52, 753664
buffer_load_dwordx4 v15, s[12:15], s54 offen lds
s_add_u32 m0, s53, 24576
s_add_u32 s54, s52, 786432
buffer_load_dwordx4 v8, s[12:15], s54 offen lds
s_add_u32 m0, s53, 25600
s_add_u32 s54, s52, 819200
buffer_load_dwordx4 v9, s[12:15], s54 offen lds
s_add_u32 m0, s53, 26624
s_add_u32 s54, s52, 851968
buffer_load_dwordx4 v10, s[12:15], s54 offen lds
s_add_u32 m0, s53, 27648
s_add_u32 s54, s52, 884736
buffer_load_dwordx4 v11, s[12:15], s54 offen lds
s_add_u32 m0, s53, 28672
s_add_u32 s54, s52, 917504
buffer_load_dwordx4 v12, s[12:15], s54 offen lds
s_add_u32 m0, s53, 29696
s_add_u32 s54, s52, 950272
buffer_load_dwordx4 v13, s[12:15], s54 offen lds
s_add_u32 m0, s53, 30720
s_add_u32 s54, s52, 983040
buffer_load_dwordx4 v14, s[12:15], s54 offen lds
s_add_u32 m0, s53, 31744
s_add_u32 s54, s52, 1015808
buffer_load_dwordx4 v15, s[12:15], s54 offen lds
s_add_u32 m0, s53, 32768
s_add_u32 s54, s52, 1048576
buffer_load_dwordx4 v8, s[12:15], s54 offen lds
s_add_u32 m0, s53, 33792
s_add_u32 s54, s52, 1081344
buffer_load_dwordx4 v9, s[12:15], s54 offen lds
s_add_u32 m0, s53, 34816
s_add_u32 s54, s52, 1114112
buffer_load_dwordx4 v10, s[12:15], s54 offen lds
s_add_u32 m0, s53, 35840
s_add_u32 s54, s52, 1146880
buffer_load_dwordx4 v11, s[12:15], s54 offen lds
s_add_u32 m0, s53, 36864
s_add_u32 s54, s52, 1179648
buffer_load_dwordx4 v12, s[12:15], s54 offen lds
s_add_u32 m0, s53, 37888
s_add_u32 s54, s52, 1212416
buffer_load_dwordx4 v13, s[12:15], s54 offen lds
s_add_u32 m0, s53, 38912
s_add_u32 s54, s52, 1245184
buffer_load_dwordx4 v14, s[12:15], s54 offen lds
s_add_u32 m0, s53, 39936
s_add_u32 s54, s52, 1277952
buffer_load_dwordx4 v15, s[12:15], s54 offen lds
s_waitcnt vmcnt(0)
s_barrier
ds_read_b64_tr_b16 a[0:1], v16 offset:0
ds_read_b64_tr_b16 a[2:3], v16 offset:512
ds_read_b64_tr_b16 a[4:5], v19 offset:0
ds_read_b64_tr_b16 a[6:7], v19 offset:512
ds_read_b64_tr_b16 a[16:17], v16 offset:256
ds_read_b64_tr_b16 a[18:19], v16 offset:768
ds_read_b64_tr_b16 a[20:21], v19 offset:256
ds_read_b64_tr_b16 a[22:23], v19 offset:768
ds_read_b64_tr_b16 a[32:33], v16 offset:16384
ds_read_b64_tr_b16 a[34:35], v16 offset:16896
ds_read_b64_tr_b16 a[36:37], v19 offset:16384
ds_read_b64_tr_b16 a[38:39], v19 offset:16896
ds_read_b64_tr_b16 a[48:49], v16 offset:16640
ds_read_b64_tr_b16 a[50:51], v16 offset:17152
ds_read_b64_tr_b16 a[52:53], v19 offset:16640
ds_read_b64_tr_b16 a[54:55], v19 offset:17152
ds_read_b64_tr_b16 a[64:65], v16 offset:32768
ds_read_b64_tr_b16 a[66:67], v16 offset:33280
ds_read_b64_tr_b16 a[68:69], v19 offset:32768
ds_read_b64_tr_b16 a[70:71], v19 offset:33280
ds_read_b64_tr_b16 a[80:81], v16 offset:33024
ds_read_b64_tr_b16 a[82:83], v16 offset:33536
ds_read_b64_tr_b16 a[84:85], v19 offset:33024
ds_read_b64_tr_b16 a[86:87], v19 offset:33536
ds_read_b64_tr_b16 a[96:97], v16 offset:49152
ds_read_b64_tr_b16 a[98:99], v16 offset:49664
ds_read_b64_tr_b16 a[100:101], v19 offset:49152
ds_read_b64_tr_b16 a[102:103], v19 offset:49664
ds_read_b64_tr_b16 a[112:113], v16 offset:49408
ds_read_b64_tr_b16 a[114:115], v16 offset:49920
ds_read_b64_tr_b16 a[116:117], v19 offset:49408
ds_read_b64_tr_b16 a[118:119], v19 offset:49920
ds_read_b64_tr_b16 a[128:129], v17 offset:0
ds_read_b64_tr_b16 a[130:131], v17 offset:512
ds_read_b64_tr_b16 a[132:133], v20 offset:0
ds_read_b64_tr_b16 a[134:135], v20 offset:512
ds_read_b64_tr_b16 a[144:145], v17 offset:256
ds_read_b64_tr_b16 a[146:147], v17 offset:768
ds_read_b64_tr_b16 a[148:149], v20 offset:256
ds_read_b64_tr_b16 a[150:151], v20 offset:768
ds_read_b64_tr_b16 a[160:161], v17 offset:16384
ds_read_b64_tr_b16 a[162:163], v17 offset:16896
ds_read_b64_tr_b16 a[164:165], v20 offset:16384
ds_read_b64_tr_b16 a[166:167], v20 offset:16896
ds_read_b64_tr_b16 a[176:177], v17 offset:16640
ds_read_b64_tr_b16 a[178:179], v17 offset:17152
ds_read_b64_tr_b16 a[180:181], v20 offset:16640
ds_read_b64_tr_b16 a[182:183], v20 offset:17152
ds_read_b64_tr_b16 a[192:193], v17 offset:32768
ds_read_b64_tr_b16 a[194:195], v17 offset:33280
ds_read_b64_tr_b16 a[196:197], v20 offset:32768
ds_read_b64_tr_b16 a[198:199], v20 offset:33280
ds_read_b64_tr_b16 a[208:209], v17 offset:33024
ds_read_b64_tr_b16 a[210:211], v17 offset:33536
ds_read_b64_tr_b16 a[212:213], v20 offset:33024
ds_read_b64_tr_b16 a[214:215], v20 offset:33536
ds_read_b64_tr_b16 a[224:225], v17 offset:49152
ds_read_b64_tr_b16 a[226:227], v17 offset:49664
ds_read_b64_tr_b16 a[228:229], v20 offset:49152
ds_read_b64_tr_b16 a[230:231], v20 offset:49664
ds_read_b64_tr_b16 a[240:241], v17 offset:49408
ds_read_b64_tr_b16 a[242:243], v17 offset:49920
ds_read_b64_tr_b16 a[244:245], v20 offset:49408
ds_read_b64_tr_b16 a[246:247], v20 offset:49920
ds_read_b64_tr_b16 v[192:193], v18 offset:0
ds_read_b64_tr_b16 v[194:195], v18 offset:512
ds_read_b64_tr_b16 v[196:197], v21 offset:0
ds_read_b64_tr_b16 v[198:199], v21 offset:512
ds_read_b64_tr_b16 v[208:209], v18 offset:256
ds_read_b64_tr_b16 v[210:211], v18 offset:768
ds_read_b64_tr_b16 v[212:213], v21 offset:256
ds_read_b64_tr_b16 v[214:215], v21 offset:768
ds_read_b64_tr_b16 v[224:225], v18 offset:16384
ds_read_b64_tr_b16 v[226:227], v18 offset:16896
ds_read_b64_tr_b16 v[228:229], v21 offset:16384
ds_read_b64_tr_b16 v[230:231], v21 offset:16896
ds_read_b64_tr_b16 v[240:241], v18 offset:16640
ds_read_b64_tr_b16 v[242:243], v18 offset:17152
ds_read_b64_tr_b16 v[244:245], v21 offset:16640
ds_read_b64_tr_b16 v[246:247], v21 offset:17152
s_waitcnt lgkmcnt(0)
s_barrier
s_mul_i32 s52, s3, 1310720
s_lshl_b32 s53, s30, 8
s_add_u32 s52, s52, s53
s_mul_i32 s53, s3, 40960
s_add_u32 m0, s53, 0
s_add_u32 s54, s52, 0
buffer_load_dwordx4 v8, s[16:19], s54 offen lds
s_add_u32 m0, s53, 1024
s_add_u32 s54, s52, 32768
buffer_load_dwordx4 v9, s[16:19], s54 offen lds
s_add_u32 m0, s53, 2048
s_add_u32 s54, s52, 65536
buffer_load_dwordx4 v10, s[16:19], s54 offen lds
s_add_u32 m0, s53, 3072
s_add_u32 s54, s52, 98304
buffer_load_dwordx4 v11, s[16:19], s54 offen lds
s_add_u32 m0, s53, 4096
s_add_u32 s54, s52, 131072
buffer_load_dwordx4 v12, s[16:19], s54 offen lds
s_add_u32 m0, s53, 5120
s_add_u32 s54, s52, 163840
buffer_load_dwordx4 v13, s[16:19], s54 offen lds
s_add_u32 m0, s53, 6144
s_add_u32 s54, s52, 196608
buffer_load_dwordx4 v14, s[16:19], s54 offen lds
s_add_u32 m0, s53, 7168
s_add_u32 s54, s52, 229376
buffer_load_dwordx4 v15, s[16:19], s54 offen lds
s_add_u32 m0, s53, 8192
s_add_u32 s54, s52, 262144
buffer_load_dwordx4 v8, s[16:19], s54 offen lds
s_add_u32 m0, s53, 9216
s_add_u32 s54, s52, 294912
buffer_load_dwordx4 v9, s[16:19], s54 offen lds
s_add_u32 m0, s53, 10240
s_add_u32 s54, s52, 327680
buffer_load_dwordx4 v10, s[16:19], s54 offen lds
s_add_u32 m0, s53, 11264
s_add_u32 s54, s52, 360448
buffer_load_dwordx4 v11, s[16:19], s54 offen lds
s_add_u32 m0, s53, 12288
s_add_u32 s54, s52, 393216
buffer_load_dwordx4 v12, s[16:19], s54 offen lds
s_add_u32 m0, s53, 13312
s_add_u32 s54, s52, 425984
buffer_load_dwordx4 v13, s[16:19], s54 offen lds
s_add_u32 m0, s53, 14336
s_add_u32 s54, s52, 458752
buffer_load_dwordx4 v14, s[16:19], s54 offen lds
s_add_u32 m0, s53, 15360
s_add_u32 s54, s52, 491520
buffer_load_dwordx4 v15, s[16:19], s54 offen lds
s_add_u32 m0, s53, 16384
s_add_u32 s54, s52, 524288
buffer_load_dwordx4 v8, s[16:19], s54 offen lds
s_add_u32 m0, s53, 17408
s_add_u32 s54, s52, 557056
buffer_load_dwordx4 v9, s[16:19], s54 offen lds
s_add_u32 m0, s53, 18432
s_add_u32 s54, s52, 589824
buffer_load_dwordx4 v10, s[16:19], s54 offen lds
s_add_u32 m0, s53, 19456
s_add_u32 s54, s52, 622592
buffer_load_dwordx4 v11, s[16:19], s54 offen lds
s_add_u32 m0, s53, 20480
s_add_u32 s54, s52, 655360
buffer_load_dwordx4 v12, s[16:19], s54 offen lds
s_add_u32 m0, s53, 21504
s_add_u32 s54, s52, 688128
buffer_load_dwordx4 v13, s[16:19], s54 offen lds
s_add_u32 m0, s53, 22528
s_add_u32 s54, s52, 720896
buffer_load_dwordx4 v14, s[16:19], s54 offen lds
s_add_u32 m0, s53, 23552
s_add_u32 s54, s52, 753664
buffer_load_dwordx4 v15, s[16:19], s54 offen lds
s_add_u32 m0, s53, 24576
s_add_u32 s54, s52, 786432
buffer_load_dwordx4 v8, s[16:19], s54 offen lds
s_add_u32 m0, s53, 25600
s_add_u32 s54, s52, 819200
buffer_load_dwordx4 v9, s[16:19], s54 offen lds
s_add_u32 m0, s53, 26624
s_add_u32 s54, s52, 851968
buffer_load_dwordx4 v10, s[16:19], s54 offen lds
s_add_u32 m0, s53, 27648
s_add_u32 s54, s52, 884736
buffer_load_dwordx4 v11, s[16:19], s54 offen lds
s_add_u32 m0, s53, 28672
s_add_u32 s54, s52, 917504
buffer_load_dwordx4 v12, s[16:19], s54 offen lds
s_add_u32 m0, s53, 29696
s_add_u32 s54, s52, 950272
buffer_load_dwordx4 v13, s[16:19], s54 offen lds
s_add_u32 m0, s53, 30720
s_add_u32 s54, s52, 983040
buffer_load_dwordx4 v14, s[16:19], s54 offen lds
s_add_u32 m0, s53, 31744
s_add_u32 s54, s52, 1015808
buffer_load_dwordx4 v15, s[16:19], s54 offen lds
s_add_u32 m0, s53, 32768
s_add_u32 s54, s52, 1048576
buffer_load_dwordx4 v8, s[16:19], s54 offen lds
s_add_u32 m0, s53, 33792
s_add_u32 s54, s52, 1081344
buffer_load_dwordx4 v9, s[16:19], s54 offen lds
s_add_u32 m0, s53, 34816
s_add_u32 s54, s52, 1114112
buffer_load_dwordx4 v10, s[16:19], s54 offen lds
s_add_u32 m0, s53, 35840
s_add_u32 s54, s52, 1146880
buffer_load_dwordx4 v11, s[16:19], s54 offen lds
s_add_u32 m0, s53, 36864
s_add_u32 s54, s52, 1179648
buffer_load_dwordx4 v12, s[16:19], s54 offen lds
s_add_u32 m0, s53, 37888
s_add_u32 s54, s52, 1212416
buffer_load_dwordx4 v13, s[16:19], s54 offen lds
s_add_u32 m0, s53, 38912
s_add_u32 s54, s52, 1245184
buffer_load_dwordx4 v14, s[16:19], s54 offen lds
s_add_u32 m0, s53, 39936
s_add_u32 s54, s52, 1277952
buffer_load_dwordx4 v15, s[16:19], s54 offen lds
s_waitcnt vmcnt(0)
s_barrier
ds_read_b64_tr_b16 a[8:9], v16 offset:0
ds_read_b64_tr_b16 a[10:11], v16 offset:512
ds_read_b64_tr_b16 a[12:13], v19 offset:0
ds_read_b64_tr_b16 a[14:15], v19 offset:512
ds_read_b64_tr_b16 a[24:25], v16 offset:256
ds_read_b64_tr_b16 a[26:27], v16 offset:768
ds_read_b64_tr_b16 a[28:29], v19 offset:256
ds_read_b64_tr_b16 a[30:31], v19 offset:768
ds_read_b64_tr_b16 a[40:41], v16 offset:16384
ds_read_b64_tr_b16 a[42:43], v16 offset:16896
ds_read_b64_tr_b16 a[44:45], v19 offset:16384
ds_read_b64_tr_b16 a[46:47], v19 offset:16896
ds_read_b64_tr_b16 a[56:57], v16 offset:16640
ds_read_b64_tr_b16 a[58:59], v16 offset:17152
ds_read_b64_tr_b16 a[60:61], v19 offset:16640
ds_read_b64_tr_b16 a[62:63], v19 offset:17152
ds_read_b64_tr_b16 a[72:73], v16 offset:32768
ds_read_b64_tr_b16 a[74:75], v16 offset:33280
ds_read_b64_tr_b16 a[76:77], v19 offset:32768
ds_read_b64_tr_b16 a[78:79], v19 offset:33280
ds_read_b64_tr_b16 a[88:89], v16 offset:33024
ds_read_b64_tr_b16 a[90:91], v16 offset:33536
ds_read_b64_tr_b16 a[92:93], v19 offset:33024
ds_read_b64_tr_b16 a[94:95], v19 offset:33536
ds_read_b64_tr_b16 a[104:105], v16 offset:49152
ds_read_b64_tr_b16 a[106:107], v16 offset:49664
ds_read_b64_tr_b16 a[108:109], v19 offset:49152
ds_read_b64_tr_b16 a[110:111], v19 offset:49664
ds_read_b64_tr_b16 a[120:121], v16 offset:49408
ds_read_b64_tr_b16 a[122:123], v16 offset:49920
ds_read_b64_tr_b16 a[124:125], v19 offset:49408
ds_read_b64_tr_b16 a[126:127], v19 offset:49920
ds_read_b64_tr_b16 a[136:137], v17 offset:0
ds_read_b64_tr_b16 a[138:139], v17 offset:512
ds_read_b64_tr_b16 a[140:141], v20 offset:0
ds_read_b64_tr_b16 a[142:143], v20 offset:512
ds_read_b64_tr_b16 a[152:153], v17 offset:256
ds_read_b64_tr_b16 a[154:155], v17 offset:768
ds_read_b64_tr_b16 a[156:157], v20 offset:256
ds_read_b64_tr_b16 a[158:159], v20 offset:768
ds_read_b64_tr_b16 a[168:169], v17 offset:16384
ds_read_b64_tr_b16 a[170:171], v17 offset:16896
ds_read_b64_tr_b16 a[172:173], v20 offset:16384
ds_read_b64_tr_b16 a[174:175], v20 offset:16896
ds_read_b64_tr_b16 a[184:185], v17 offset:16640
ds_read_b64_tr_b16 a[186:187], v17 offset:17152
ds_read_b64_tr_b16 a[188:189], v20 offset:16640
ds_read_b64_tr_b16 a[190:191], v20 offset:17152
ds_read_b64_tr_b16 a[200:201], v17 offset:32768
ds_read_b64_tr_b16 a[202:203], v17 offset:33280
ds_read_b64_tr_b16 a[204:205], v20 offset:32768
ds_read_b64_tr_b16 a[206:207], v20 offset:33280
ds_read_b64_tr_b16 a[216:217], v17 offset:33024
ds_read_b64_tr_b16 a[218:219], v17 offset:33536
ds_read_b64_tr_b16 a[220:221], v20 offset:33024
ds_read_b64_tr_b16 a[222:223], v20 offset:33536
ds_read_b64_tr_b16 a[232:233], v17 offset:49152
ds_read_b64_tr_b16 a[234:235], v17 offset:49664
ds_read_b64_tr_b16 a[236:237], v20 offset:49152
ds_read_b64_tr_b16 a[238:239], v20 offset:49664
ds_read_b64_tr_b16 a[248:249], v17 offset:49408
ds_read_b64_tr_b16 a[250:251], v17 offset:49920
ds_read_b64_tr_b16 a[252:253], v20 offset:49408
ds_read_b64_tr_b16 a[254:255], v20 offset:49920
ds_read_b64_tr_b16 v[200:201], v18 offset:0
ds_read_b64_tr_b16 v[202:203], v18 offset:512
ds_read_b64_tr_b16 v[204:205], v21 offset:0
ds_read_b64_tr_b16 v[206:207], v21 offset:512
ds_read_b64_tr_b16 v[216:217], v18 offset:256
ds_read_b64_tr_b16 v[218:219], v18 offset:768
ds_read_b64_tr_b16 v[220:221], v21 offset:256
ds_read_b64_tr_b16 v[222:223], v21 offset:768
ds_read_b64_tr_b16 v[232:233], v18 offset:16384
ds_read_b64_tr_b16 v[234:235], v18 offset:16896
ds_read_b64_tr_b16 v[236:237], v21 offset:16384
ds_read_b64_tr_b16 v[238:239], v21 offset:16896
ds_read_b64_tr_b16 v[248:249], v18 offset:16640
ds_read_b64_tr_b16 v[250:251], v18 offset:17152
ds_read_b64_tr_b16 v[252:253], v21 offset:16640
ds_read_b64_tr_b16 v[254:255], v21 offset:17152
s_waitcnt lgkmcnt(0)
s_barrier
s_and_b32 s47, s3, 1
s_lshr_b32 s52, s3, 1
s_add_u32 s50, s52, 1
v_lshrrev_b32 v20, 9, v0
v_mov_b32 v21, 0xff800000
v_cmp_eq_u32 vcc, s52, v20
s_lshl_b32 s46, s52, 10
s_lshl_b32 s53, s47, 7
s_add_u32 s46, s46, s53
s_add_u32 s46, s46, 117440512
s_lshl_b32 s53, s52, 5
s_add_u32 s53, s53, s30
s_lshl_b32 s44, s53, 14
s_add_u32 s44, s44, 0
s_lshl_b32 s53, s53, 13
s_lshl_b32 s45, s47, 10
s_add_u32 s45, s45, s53
s_add_u32 s45, s45, 125829120
s_lshl_b32 s48, s3, 17
s_lshl_b32 s53, s30, 11
s_add_u32 s48, s48, s53
s_add_u32 s48, s48, 159383552
s_lshl_b32 s56, s30, 6
s_add_u32 s56, s56, 222330880
s_lshl_b32 s57, s3, 8
s_lshl_b32 s53, s30, 2
s_add_u32 s57, s57, s53
s_add_u32 s57, s57, 222339072
s_mov_b32 s58, 0x3e0293ee
v_cndmask_b32 v156, v21, 0, vcc
v_cndmask_b32 v157, v21, 0, vcc
v_cndmask_b32 v158, v21, 0, vcc
v_cndmask_b32 v159, v21, 0, vcc
v_bfe_u32 v20, v0, 7, 1
v_and_b32 v1, 0x370, v0
v_mul_u32_u24 v23, 10240, v20
v_add_u32 v23, v23, v1
v_lshl_add_u32 v1, v20, 16, v1
v_and_b32 v16, 0x350, v0
v_lshl_add_u32 v16, v20, 5, v16
v_bfe_u32 v20, v0, 5, 1
v_lshl_add_u32 v16, v20, 12, v16
v_add_u32 v17, 8192, v16
s_lshl_b32 s52, s3, 10
v_add_u32 v155, s52, v0
v_mov_b32 v2, 2146435072
v_cmp_eq_u32 vcc, 0, v0
s_nop 1
v_cndmask_b32 v2, v2, 0, vcc
v_bfe_u32 v20, v0, 4, 4
s_lshl_b32 s52, s47, 4
v_add_u32 v20, s52, v20
v_lshrrev_b32 v22, 8, v0
v_lshlrev_b32 v22, 2, v22
v_sub_u32 v20, v20, v22
v_add_u32 v3, 4096, v0
v_add_u32 v18, 8192, v0
v_add_u32 v19, 12288, v0
v_cmp_le_i32 vcc, 0, v20
s_nop 1
v_cndmask_b32 v4, v21, 0, vcc
v_cmp_le_i32 vcc, 1, v20
s_nop 1
v_cndmask_b32 v5, v21, 0, vcc
v_cmp_le_i32 vcc, 2, v20
s_nop 1
v_cndmask_b32 v6, v21, 0, vcc
v_cmp_le_i32 vcc, 3, v20
s_nop 1
v_cndmask_b32 v7, v21, 0, vcc
v_cmp_le_i32 vcc, 16, v20
s_nop 1
v_cndmask_b32 v8, v21, 0, vcc
v_cmp_le_i32 vcc, 17, v20
s_nop 1
v_cndmask_b32 v9, v21, 0, vcc
v_cmp_le_i32 vcc, 18, v20
s_nop 1
v_cndmask_b32 v10, v21, 0, vcc
v_cmp_le_i32 vcc, 19, v20
s_nop 1
v_cndmask_b32 v11, v21, 0, vcc
v_mov_b32 v12, 0x3f803f80
v_mov_b32 v13, 0x3f803f80
v_mov_b32 v14, 0x3f803f80
v_mov_b32 v15, 0x3f803f80
s_cmp_lg_u32 s3, 0
s_cbranch_scc1 k_wdd_19
v_mov_b32 v20, 192
k_wd_18:
global_load_dword v21, v20, s[28:29] sc1
s_waitcnt vmcnt(0)
v_readfirstlane_b32 s52, v21
s_cmp_ge_u32 s52, 32
s_cbranch_scc1 k_wdd_19
s_sleep 2
s_sub_u32 s32, s32, 1
s_cmp_gt_i32 s32, 0
s_cbranch_scc1 k_wd_18
k_wdd_19:
s_barrier
v_mov_b32 v154, 0
k_top_20:
s_waitcnt vmcnt(0)
buffer_store_dword v154, v2, s[4:7], s57 offen sc1
s_cmp_gt_u32 s50, 128
s_cbranch_scc1 k_out_27
k_ck_21:
buffer_load_dwordx3 v[20:22], off, s[4:7], s56 sc1
s_waitcnt vmcnt(0)
v_min3_u32 v20, v20, v21, v22
v_cmp_le_u32 vcc, s50, v20
s_cbranch_vccnz k_cd_22
s_sleep 4
s_sub_u32 s32, s32, 1
s_cmp_gt_i32 s32, 0
s_cbranch_scc1 k_ck_21
k_cd_22:
s_add_u32 s52, s46, 4096
s_add_u32 s53, s46, 8192
buffer_load_dwordx4 v[160:163], v23, s[4:7], s46 offen offset:0 sc1
buffer_load_dwordx4 v[164:167], v23, s[4:7], s46 offen offset:2048 sc1
buffer_load_dwordx4 v[168:171], v23, s[4:7], s52 offen offset:0 sc1
buffer_load_dwordx4 v[172:175], v23, s[4:7], s52 offen offset:2048 sc1
buffer_load_dwordx4 v[176:179], v23, s[4:7], s53 offen offset:0 sc1
buffer_load_dwordx4 v[24:27], v0, s[4:7], s45 offen offset:0 sc1
buffer_load_dwordx4 v[40:43], v16, s[4:7], s44 offen offset:0 sc1
buffer_load_dwordx4 v[44:47], v17, s[4:7], s44 offen offset:0 sc1
buffer_load_dwordx4 v[28:31], v0, s[4:7], s45 offen offset:2048 sc1
buffer_load_dwordx4 v[48:51], v16, s[4:7], s44 offen offset:128 sc1
buffer_load_dwordx4 v[52:55], v17, s[4:7], s44 offen offset:128 sc1
buffer_load_dwordx4 v[32:35], v3, s[4:7], s45 offen offset:0 sc1
buffer_load_dwordx4 v[56:59], v16, s[4:7], s44 offen offset:1024 sc1
buffer_load_dwordx4 v[60:63], v17, s[4:7], s44 offen offset:1024 sc1
buffer_load_dwordx4 v[36:39], v3, s[4:7], s45 offen offset:2048 sc1
buffer_load_dwordx4 v[64:67], v16, s[4:7], s44 offen offset:1152 sc1
buffer_load_dwordx4 v[68:71], v17, s[4:7], s44 offen offset:1152 sc1
buffer_load_dwordx4 v[72:75], v0, s[4:7], s44 offen offset:2048 sc1
buffer_load_dwordx4 v[76:79], v0, s[4:7], s44 offen offset:3072 sc1
buffer_load_dwordx4 v[80:83], v3, s[4:7], s44 offen offset:2048 sc1
buffer_load_dwordx4 v[84:87], v3, s[4:7], s44 offen offset:3072 sc1
buffer_load_dwordx4 v[88:91], v18, s[4:7], s44 offen offset:2048 sc1
buffer_load_dwordx4 v[92:95], v18, s[4:7], s44 offen offset:3072 sc1
buffer_load_dwordx4 v[96:99], v19, s[4:7], s44 offen offset:2048 sc1
buffer_load_dwordx4 v[100:103], v19, s[4:7], s44 offen offset:3072 sc1
s_waitcnt vmcnt(22)
v_max3_u32 v20, v160, v164, v168
s_waitcnt vmcnt(20)
v_max3_u32 v20, v20, v172, v176
v_cmp_eq_u32 vcc, -1, v20
buffer_store_dword v154, v2, s[4:7], s57 offen sc1
s_cbranch_vccz k_pmd_25
s_add_u32 s52, s46, 10240
k_pr_23:
buffer_load_dword v20, off, s[4:7], s52 sc1
s_waitcnt vmcnt(0)
v_cmp_eq_u32 vcc, -1, v20
s_cbranch_vccz k_pm_24
s_sleep 2
s_sub_u32 s32, s32, 1
s_cmp_gt_i32 s32, 0
s_cbranch_scc1 k_pr_23
k_pm_24:
s_add_u32 s52, s46, 4096
s_add_u32 s53, s46, 8192
buffer_load_dwordx4 v[160:163], v23, s[4:7], s46 offen offset:0 sc1
buffer_load_dwordx4 v[164:167], v23, s[4:7], s46 offen offset:2048 sc1
buffer_load_dwordx4 v[168:171], v23, s[4:7], s52 offen offset:0 sc1
buffer_load_dwordx4 v[172:175], v23, s[4:7], s52 offen offset:2048 sc1
buffer_load_dwordx4 v[176:179], v23, s[4:7], s53 offen offset:0 sc1
s_waitcnt vmcnt(2)
v_max3_u32 v20, v160, v164, v168
s_waitcnt vmcnt(0)
v_max3_u32 v20, v20, v172, v176
v_cmp_eq_u32 vcc, -1, v20
s_cbranch_vccz k_pmd_25
s_sleep 2
s_sub_u32 s32, s32, 1
s_cmp_gt_i32 s32, 0
s_cbranch_scc1 k_pm_24
k_pmd_25:
ds_write_b128 v155, v[160:163] offset:0
ds_write_b128 v155, v[164:167] offset:4096
ds_write_b128 v155, v[168:171] offset:8192
ds_write_b128 v155, v[172:175] offset:12288
ds_write_b128 v155, v[176:179] offset:16384
s_waitcnt lgkmcnt(0)
s_barrier
ds_read_b128 v[160:163], v0 offset:0
ds_read_b128 v[164:167], v0 offset:1024
ds_read_b128 v[168:171], v0 offset:2048
ds_read_b128 v[172:175], v0 offset:3072
buffer_load_dwordx3 v[20:22], off, s[4:7], s56 sc1
s_waitcnt lgkmcnt(3)
v_mfma_f32_16x16x32_bf16 v[104:107], a[0:3], v[160:163], 0
ds_read_b128 v[176:179], v0 offset:4096
v_mfma_f32_16x16x32_bf16 v[108:111], a[4:7], v[160:163], 0
v_mfma_f32_16x16x32_bf16 v[112:115], v[160:163], a[8:11], 0
v_mfma_f32_16x16x32_bf16 v[116:119], v[160:163], a[12:15], 0
s_waitcnt lgkmcnt(3)
v_mfma_f32_16x16x32_bf16 v[104:107], a[16:19], v[164:167], v[104:107]
ds_read_b128 v[180:183], v0 offset:5120
v_mfma_f32_16x16x32_bf16 v[108:111], a[20:23], v[164:167], v[108:111]
v_mfma_f32_16x16x32_bf16 v[112:115], v[164:167], a[24:27], v[112:115]
v_mfma_f32_16x16x32_bf16 v[116:119], v[164:167], a[28:31], v[116:119]
s_waitcnt lgkmcnt(3)
v_mfma_f32_16x16x32_bf16 v[104:107], a[32:35], v[168:171], v[104:107]
ds_read_b128 v[184:187], v0 offset:6144
v_mfma_f32_16x16x32_bf16 v[108:111], a[36:39], v[168:171], v[108:111]
v_mfma_f32_16x16x32_bf16 v[112:115], v[168:171], a[40:43], v[112:115]
v_mfma_f32_16x16x32_bf16 v[116:119], v[168:171], a[44:47], v[116:119]
s_waitcnt lgkmcnt(3)
v_mfma_f32_16x16x32_bf16 v[104:107], a[48:51], v[172:175], v[104:107]
ds_read_b128 v[188:191], v0 offset:7168
v_mfma_f32_16x16x32_bf16 v[108:111], a[52:55], v[172:175], v[108:111]
v_mfma_f32_16x16x32_bf16 v[112:115], v[172:175], a[56:59], v[112:115]
v_mfma_f32_16x16x32_bf16 v[116:119], v[172:175], a[60:63], v[116:119]
s_waitcnt lgkmcnt(3)
v_mfma_f32_16x16x32_bf16 v[104:107], a[64:67], v[176:179], v[104:107]
ds_read_b128 v[160:163], v0 offset:8192
v_mfma_f32_16x16x32_bf16 v[108:111], a[68:71], v[176:179], v[108:111]
v_mfma_f32_16x16x32_bf16 v[112:115], v[176:179], a[72:75], v[112:115]
v_mfma_f32_16x16x32_bf16 v[116:119], v[176:179], a[76:79], v[116:119]
s_waitcnt lgkmcnt(3)
v_mfma_f32_16x16x32_bf16 v[104:107], a[80:83], v[180:183], v[104:107]
ds_read_b128 v[164:167], v0 offset:9216
v_mfma_f32_16x16x32_bf16 v[108:111], a[84:87], v[180:183], v[108:111]
v_mfma_f32_16x16x32_bf16 v[112:115], v[180:183], a[88:91], v[112:115]
v_mfma_f32_16x16x32_bf16 v[116:119], v[180:183], a[92:95], v[116:119]
s_waitcnt lgkmcnt(3)
v_mfma_f32_16x16x32_bf16 v[104:107], a[96:99], v[184:187], v[104:107]
ds_read_b128 v[168:171], v0 offset:10240
v_mfma_f32_16x16x32_bf16 v[108:111], a[100:103], v[184:187], v[108:111]
v_mfma_f32_16x16x32_bf16 v[112:115], v[184:187], a[104:107], v[112:115]
v_mfma_f32_16x16x32_bf16 v[116:119], v[184:187], a[108:111], v[116:119]
s_waitcnt lgkmcnt(3)
v_mfma_f32_16x16x32_bf16 v[104:107], a[112:115], v[188:191], v[104:107]
ds_read_b128 v[172:175], v0 offset:11264
v_mfma_f32_16x16x32_bf16 v[108:111], a[116:119], v[188:191], v[108:111]
v_mfma_f32_16x16x32_bf16 v[112:115], v[188:191], a[120:123], v[112:115]
v_mfma_f32_16x16x32_bf16 v[116:119], v[188:191], a[124:127], v[116:119]
s_waitcnt lgkmcnt(3)
v_mfma_f32_16x16x32_bf16 v[104:107], a[128:131], v[160:163], v[104:107]
ds_read_b128 v[176:179], v0 offset:12288
v_mfma_f32_16x16x32_bf16 v[108:111], a[132:135], v[160:163], v[108:111]
v_mfma_f32_16x16x32_bf16 v[112:115], v[160:163], a[136:139], v[112:115]
v_mfma_f32_16x16x32_bf16 v[116:119], v[160:163], a[140:143], v[116:119]
s_waitcnt lgkmcnt(3)
v_mfma_f32_16x16x32_bf16 v[104:107], a[144:147], v[164:167], v[104:107]
ds_read_b128 v[180:183], v0 offset:13312
v_mfma_f32_16x16x32_bf16 v[108:111], a[148:151], v[164:167], v[108:111]
v_mfma_f32_16x16x32_bf16 v[112:115], v[164:167], a[152:155], v[112:115]
v_mfma_f32_16x16x32_bf16 v[116:119], v[164:167], a[156:159], v[116:119]
s_waitcnt lgkmcnt(3)
v_mfma_f32_16x16x32_bf16 v[104:107], a[160:163], v[168:171], v[104:107]
ds_read_b128 v[184:187], v0 offset:14336
v_mfma_f32_16x16x32_bf16 v[108:111], a[164:167], v[168:171], v[108:111]
v_mfma_f32_16x16x32_bf16 v[112:115], v[168:171], a[168:171], v[112:115]
v_mfma_f32_16x16x32_bf16 v[116:119], v[168:171], a[172:175], v[116:119]
s_waitcnt lgkmcnt(3)
v_mfma_f32_16x16x32_bf16 v[104:107], a[176:179], v[172:175], v[104:107]
ds_read_b128 v[188:191], v0 offset:15360
v_mfma_f32_16x16x32_bf16 v[108:111], a[180:183], v[172:175], v[108:111]
v_mfma_f32_16x16x32_bf16 v[112:115], v[172:175], a[184:187], v[112:115]
v_mfma_f32_16x16x32_bf16 v[116:119], v[172:175], a[188:191], v[116:119]
s_waitcnt lgkmcnt(3)
v_mfma_f32_16x16x32_bf16 v[104:107], a[192:195], v[176:179], v[104:107]
ds_read_b128 v[160:163], v0 offset:16384
v_mfma_f32_16x16x32_bf16 v[108:111], a[196:199], v[176:179], v[108:111]
v_mfma_f32_16x16x32_bf16 v[112:115], v[176:179], a[200:203], v[112:115]
v_mfma_f32_16x16x32_bf16 v[116:119], v[176:179], a[204:207], v[116:119]
s_waitcnt lgkmcnt(3)
v_mfma_f32_16x16x32_bf16 v[104:107], a[208:211], v[180:183], v[104:107]
ds_read_b128 v[164:167], v0 offset:17408
v_mfma_f32_16x16x32_bf16 v[108:111], a[212:215], v[180:183], v[108:111]
v_mfma_f32_16x16x32_bf16 v[112:115], v[180:183], a[216:219], v[112:115]
v_mfma_f32_16x16x32_bf16 v[116:119], v[180:183], a[220:223], v[116:119]
s_waitcnt lgkmcnt(3)
v_mfma_f32_16x16x32_bf16 v[104:107], a[224:227], v[184:187], v[104:107]
ds_read_b128 v[168:171], v0 offset:18432
v_mfma_f32_16x16x32_bf16 v[108:111], a[228:231], v[184:187], v[108:111]
v_mfma_f32_16x16x32_bf16 v[112:115], v[184:187], a[232:235], v[112:115]
v_mfma_f32_16x16x32_bf16 v[116:119], v[184:187], a[236:239], v[116:119]
s_waitcnt lgkmcnt(3)
v_mfma_f32_16x16x32_bf16 v[104:107], a[240:243], v[188:191], v[104:107]
ds_read_b128 v[172:175], v0 offset:19456
v_mfma_f32_16x16x32_bf16 v[108:111], a[244:247], v[188:191], v[108:111]
v_mfma_f32_16x16x32_bf16 v[112:115], v[188:191], a[248:251], v[112:115]
v_mfma_f32_16x16x32_bf16 v[116:119], v[188:191], a[252:255], v[116:119]
s_waitcnt lgkmcnt(3)
v_mfma_f32_16x16x32_bf16 v[104:107], v[192:195], v[160:163], v[104:107]
v_mfma_f32_16x16x32_bf16 v[108:111], v[196:199], v[160:163], v[108:111]
v_mfma_f32_16x16x32_bf16 v[112:115], v[160:163], v[200:203], v[112:115]
v_mfma_f32_16x16x32_bf16 v[116:119], v[160:163], v[204:207], v[116:119]
s_waitcnt lgkmcnt(2)
v_mfma_f32_16x16x32_bf16 v[104:107], v[208:211], v[164:167], v[104:107]
v_mfma_f32_16x16x32_bf16 v[108:111], v[212:215], v[164:167], v[108:111]
v_mfma_f32_16x16x32_bf16 v[112:115], v[164:167], v[216:219], v[112:115]
v_mfma_f32_16x16x32_bf16 v[116:119], v[164:167], v[220:223], v[116:119]
s_waitcnt lgkmcnt(1)
v_mfma_f32_16x16x32_bf16 v[104:107], v[224:227], v[168:171], v[104:107]
v_mfma_f32_16x16x32_bf16 v[108:111], v[228:231], v[168:171], v[108:111]
v_mfma_f32_16x16x32_bf16 v[112:115], v[168:171], v[232:235], v[112:115]
v_mfma_f32_16x16x32_bf16 v[116:119], v[168:171], v[236:239], v[116:119]
s_waitcnt lgkmcnt(0)
v_mfma_f32_16x16x32_bf16 v[104:107], v[240:243], v[172:175], v[104:107]
v_mfma_f32_16x16x32_bf16 v[108:111], v[244:247], v[172:175], v[108:111]
v_mfma_f32_16x16x32_bf16 v[112:115], v[172:175], v[248:251], v[112:115]
v_mfma_f32_16x16x32_bf16 v[116:119], v[172:175], v[252:255], v[116:119]
v_cvt_pk_bf16_f32 v104, v104, v105
v_cvt_pk_bf16_f32 v105, v106, v107
v_cvt_pk_bf16_f32 v106, v108, v109
v_cvt_pk_bf16_f32 v107, v110, v111
ds_write_b128 v155, v[104:107] offset:20480
v_cvt_pk_bf16_f32 v112, v112, v113
v_cvt_pk_bf16_f32 v113, v114, v115
v_cvt_pk_bf16_f32 v114, v116, v117
v_cvt_pk_bf16_f32 v115, v118, v119
ds_write_b128 v155, v[112:115] offset:24576
s_waitcnt vmcnt(20)
v_mfma_f32_16x16x32_bf16 v[136:139], v[40:43], v[24:27], v[4:7]
s_waitcnt vmcnt(19)
v_mfma_f32_16x16x32_bf16 v[140:143], v[44:47], v[24:27], v[8:11]
s_waitcnt vmcnt(17)
v_mfma_f32_16x16x32_bf16 v[136:139], v[48:51], v[28:31], v[136:139]
s_waitcnt vmcnt(16)
v_mfma_f32_16x16x32_bf16 v[140:143], v[52:55], v[28:31], v[140:143]
s_waitcnt lgkmcnt(0)
s_barrier
ds_read_b128 v[104:107], v0 offset:20480
ds_read_b128 v[108:111], v0 offset:21504
ds_read_b128 v[112:115], v0 offset:22528
ds_read_b128 v[116:119], v0 offset:23552
ds_read_b128 v[120:123], v0 offset:24576
ds_read_b128 v[124:127], v0 offset:25600
ds_read_b128 v[128:131], v0 offset:26624
ds_read_b128 v[132:135], v0 offset:27648
s_waitcnt vmcnt(14)
v_mfma_f32_16x16x32_bf16 v[136:139], v[56:59], v[32:35], v[136:139]
s_waitcnt vmcnt(13)
v_mfma_f32_16x16x32_bf16 v[140:143], v[60:63], v[32:35], v[140:143]
s_waitcnt vmcnt(11)
v_mfma_f32_16x16x32_bf16 v[136:139], v[64:67], v[36:39], v[136:139]
s_waitcnt vmcnt(10)
v_mfma_f32_16x16x32_bf16 v[140:143], v[68:71], v[36:39], v[140:143]
s_waitcnt lgkmcnt(7)
v_mfma_f32_16x16x32_bf16 v[144:147], v[104:107], v[24:27], v[156:159]
s_waitcnt lgkmcnt(6)
v_mfma_f32_16x16x32_bf16 v[144:147], v[108:111], v[28:31], v[144:147]
s_waitcnt lgkmcnt(5)
v_mfma_f32_16x16x32_bf16 v[144:147], v[112:115], v[32:35], v[144:147]
s_waitcnt lgkmcnt(4)
v_mfma_f32_16x16x32_bf16 v[144:147], v[116:119], v[36:39], v[144:147]
v_max3_f32 v44, v136, v137, v138
v_max3_f32 v44, v44, v139, v140
v_max3_f32 v44, v44, v141, v142
s_nop 2
v_max3_f32 v44, v44, v143, v144
v_max3_f32 v44, v44, v145, v146
v_max_f32 v44, v44, v147
v_mov_b32 v45, v44
s_nop 1
v_permlane32_swap_b32 v44, v45
v_max_f32 v44, v44, v45
v_mov_b32 v45, v44
s_nop 1
v_permlane16_swap_b32 v44, v45
v_max_f32 v44, v44, v45
v_mul_f32 v44, s58, v44
v_fma_f32 v136, v136, s58, -v44
v_exp_f32 v136, v136
v_fma_f32 v137, v137, s58, -v44
v_exp_f32 v137, v137
v_fma_f32 v138, v138, s58, -v44
v_exp_f32 v138, v138
v_fma_f32 v139, v139, s58, -v44
v_exp_f32 v139, v139
v_fma_f32 v140, v140, s58, -v44
v_exp_f32 v140, v140
v_fma_f32 v141, v141, s58, -v44
v_exp_f32 v141, v141
v_fma_f32 v142, v142, s58, -v44
v_exp_f32 v142, v142
v_fma_f32 v143, v143, s58, -v44
v_exp_f32 v143, v143
v_fma_f32 v144, v144, s58, -v44
v_exp_f32 v144, v144
v_fma_f32 v145, v145, s58, -v44
v_exp_f32 v145, v145
v_fma_f32 v146, v146, s58, -v44
v_exp_f32 v146, v146
v_fma_f32 v147, v147, s58, -v44
v_exp_f32 v147, v147
v_cvt_pk_bf16_f32 v148, v136, v137
v_cvt_pk_bf16_f32 v149, v138, v139
v_cvt_pk_bf16_f32 v150, v140, v141
v_cvt_pk_bf16_f32 v151, v142, v143
v_cvt_pk_bf16_f32 v152, v144, v145
v_cvt_pk_bf16_f32 v153, v146, v147
v_mfma_f32_16x16x32_bf16 v[40:43], v[12:15], v[148:151], 0
s_waitcnt vmcnt(9)
v_mfma_f32_16x16x32_bf16 v[160:163], v[72:75], v[148:151], 0
s_waitcnt vmcnt(8)
v_mfma_f32_16x16x32_bf16 v[164:167], v[76:79], v[148:151], 0
v_mfma_f32_16x16x16_bf16 v[40:43], v[12:13], v[152:153], v[40:43]
s_waitcnt vmcnt(7)
v_mfma_f32_16x16x32_bf16 v[168:171], v[80:83], v[148:151], 0
s_waitcnt vmcnt(6)
v_mfma_f32_16x16x32_bf16 v[172:175], v[84:87], v[148:151], 0
s_waitcnt vmcnt(5)
v_mfma_f32_16x16x32_bf16 v[176:179], v[88:91], v[148:151], 0
s_waitcnt vmcnt(4)
v_mfma_f32_16x16x32_bf16 v[180:183], v[92:95], v[148:151], 0
s_waitcnt vmcnt(3)
v_mfma_f32_16x16x32_bf16 v[184:187], v[96:99], v[148:151], 0
s_waitcnt vmcnt(2)
v_mfma_f32_16x16x32_bf16 v[188:191], v[100:103], v[148:151], 0
v_rcp_f32 v40, v40
s_waitcnt lgkmcnt(3)
v_mfma_f32_16x16x16_bf16 v[160:163], v[120:121], v[152:153], v[160:163]
v_mfma_f32_16x16x16_bf16 v[164:167], v[122:123], v[152:153], v[164:167]
s_waitcnt lgkmcnt(2)
v_mfma_f32_16x16x16_bf16 v[168:171], v[124:125], v[152:153], v[168:171]
v_mfma_f32_16x16x16_bf16 v[172:175], v[126:127], v[152:153], v[172:175]
s_waitcnt lgkmcnt(1)
v_mfma_f32_16x16x16_bf16 v[176:179], v[128:129], v[152:153], v[176:179]
v_mfma_f32_16x16x16_bf16 v[180:183], v[130:131], v[152:153], v[180:183]
s_waitcnt lgkmcnt(0)
v_mfma_f32_16x16x16_bf16 v[184:187], v[132:133], v[152:153], v[184:187]
v_mfma_f32_16x16x16_bf16 v[188:191], v[134:135], v[152:153], v[188:191]
v_mul_f32 v160, v40, v160
v_mul_f32 v161, v40, v161
v_mul_f32 v162, v40, v162
v_mul_f32 v163, v40, v163
v_mul_f32 v164, v40, v164
v_mul_f32 v165, v40, v165
v_mul_f32 v166, v40, v166
v_mul_f32 v167, v40, v167
v_cvt_pk_bf16_f32 v104, v160, v161
v_cvt_pk_bf16_f32 v105, v162, v163
v_cvt_pk_bf16_f32 v106, v164, v165
v_cvt_pk_bf16_f32 v107, v166, v167
buffer_store_dwordx4 v[104:107], v1, s[4:7], s48 offen offset:0 sc1
v_mul_f32 v168, v40, v168
v_mul_f32 v169, v40, v169
v_mul_f32 v170, v40, v170
v_mul_f32 v171, v40, v171
v_mul_f32 v172, v40, v172
v_mul_f32 v173, v40, v173
v_mul_f32 v174, v40, v174
v_mul_f32 v175, v40, v175
v_cvt_pk_bf16_f32 v108, v168, v169
v_cvt_pk_bf16_f32 v109, v170, v171
v_cvt_pk_bf16_f32 v110, v172, v173
v_cvt_pk_bf16_f32 v111, v174, v175
buffer_store_dwordx4 v[108:111], v1, s[4:7], s48 offen offset:128 sc1
v_mul_f32 v176, v40, v176
v_mul_f32 v177, v40, v177
v_mul_f32 v178, v40, v178
v_mul_f32 v179, v40, v179
v_mul_f32 v180, v40, v180
v_mul_f32 v181, v40, v181
v_mul_f32 v182, v40, v182
v_mul_f32 v183, v40, v183
v_cvt_pk_bf16_f32 v112, v176, v177
v_cvt_pk_bf16_f32 v113, v178, v179
v_cvt_pk_bf16_f32 v114, v180, v181
v_cvt_pk_bf16_f32 v115, v182, v183
buffer_store_dwordx4 v[112:115], v1, s[4:7], s48 offen offset:1024 sc1
v_mul_f32 v184, v40, v184
v_mul_f32 v185, v40, v185
v_mul_f32 v186, v40, v186
v_mul_f32 v187, v40, v187
v_mul_f32 v188, v40, v188
v_mul_f32 v189, v40, v189
v_mul_f32 v190, v40, v190
v_mul_f32 v191, v40, v191
v_cvt_pk_bf16_f32 v116, v184, v185
v_cvt_pk_bf16_f32 v117, v186, v187
v_cvt_pk_bf16_f32 v118, v188, v189
v_cvt_pk_bf16_f32 v119, v190, v191
buffer_store_dwordx4 v[116:119], v1, s[4:7], s48 offen offset:1152 sc1
v_mov_b32 v154, s50
s_add_u32 s44, s44, 1048576
s_add_u32 s45, s45, 524288
s_add_u32 s46, s46, 20480
s_add_u32 s48, s48, 524288
s_add_u32 s50, s50, 2
s_sub_u32 s52, s50, 65
s_cmp_lt_u32 s52, 2
s_cbranch_scc0 k_nosw_26
s_add_u32 s44, s44, 8388608
s_add_u32 s48, s48, 1048576
s_add_u32 s46, s46, 393216
k_nosw_26:
s_waitcnt vmcnt(4)
v_min3_u32 v20, v20, v21, v22
v_cmp_le_u32 vcc, s50, v20
s_cbranch_vccnz k_cd_22
s_branch k_top_20
k_out_27:
s_waitcnt vmcnt(0) lgkmcnt(0)
s_barrier
s_add_u32 s30, s30, 80
s_branch k_fin_7
k_p_6:
s_mul_i32 s57, s30, 21846
s_lshr_b32 s57, s57, 16
s_mul_i32 s52, s57, 3
s_sub_u32 s58, s30, s52
s_cmp_eq_u32 s58, 1
s_cselect_b32 s12, s16, s12
s_cselect_b32 s13, s17, s13
s_cmp_eq_u32 s58, 2
s_cselect_b32 s12, s8, s12
s_cselect_b32 s13, s9, s13
v_lshrrev_b32 v1, 8, v0
v_and_b32 v2, 0xf0, v0
v_lshlrev_b32 v3, 5, v1
v_xor_b32 v2, v2, v3
v_lshl_add_u32 v1, v1, 13, v2
s_mul_i32 s52, s3, 1310720
s_lshl_b32 s53, s57, 8
s_add_u32 s52, s52, s53
s_mul_i32 s53, s3, 40960
s_add_u32 m0, s53, 0
s_add_u32 s54, s52, 0
buffer_load_dwordx4 v1, s[12:15], s54 offen lds
s_add_u32 m0, s53, 1024
s_add_u32 s54, s52, 32768
buffer_load_dwordx4 v1, s[12:15], s54 offen lds
s_add_u32 m0, s53, 2048
s_add_u32 s54, s52, 65536
buffer_load_dwordx4 v1, s[12:15], s54 offen lds
s_add_u32 m0, s53, 3072
s_add_u32 s54, s52, 98304
buffer_load_dwordx4 v1, s[12:15], s54 offen lds
s_add_u32 m0, s53, 4096
s_add_u32 s54, s52, 131072
buffer_load_dwordx4 v1, s[12:15], s54 offen lds
s_add_u32 m0, s53, 5120
s_add_u32 s54, s52, 163840
buffer_load_dwordx4 v1, s[12:15], s54 offen lds
s_add_u32 m0, s53, 6144
s_add_u32 s54, s52, 196608
buffer_load_dwordx4 v1, s[12:15], s54 offen lds
s_add_u32 m0, s53, 7168
s_add_u32 s54, s52, 229376
buffer_load_dwordx4 v1, s[12:15], s54 offen lds
s_add_u32 m0, s53, 8192
s_add_u32 s54, s52, 262144
buffer_load_dwordx4 v1, s[12:15], s54 offen lds
s_add_u32 m0, s53, 9216
s_add_u32 s54, s52, 294912
buffer_load_dwordx4 v1, s[12:15], s54 offen lds
s_add_u32 m0, s53, 10240
s_add_u32 s54, s52, 327680
buffer_load_dwordx4 v1, s[12:15], s54 offen lds
s_add_u32 m0, s53, 11264
s_add_u32 s54, s52, 360448
buffer_load_dwordx4 v1, s[12:15], s54 offen lds
s_add_u32 m0, s53, 12288
s_add_u32 s54, s52, 393216
buffer_load_dwordx4 v1, s[12:15], s54 offen lds
s_add_u32 m0, s53, 13312
s_add_u32 s54, s52, 425984
buffer_load_dwordx4 v1, s[12:15], s54 offen lds
s_add_u32 m0, s53, 14336
s_add_u32 s54, s52, 458752
buffer_load_dwordx4 v1, s[12:15], s54 offen lds
s_add_u32 m0, s53, 15360
s_add_u32 s54, s52, 491520
buffer_load_dwordx4 v1, s[12:15], s54 offen lds
s_add_u32 m0, s53, 16384
s_add_u32 s54, s52, 524288
buffer_load_dwordx4 v1, s[12:15], s54 offen lds
s_add_u32 m0, s53, 17408
s_add_u32 s54, s52, 557056
buffer_load_dwordx4 v1, s[12:15], s54 offen lds
s_add_u32 m0, s53, 18432
s_add_u32 s54, s52, 589824
buffer_load_dwordx4 v1, s[12:15], s54 offen lds
s_add_u32 m0, s53, 19456
s_add_u32 s54, s52, 622592
buffer_load_dwordx4 v1, s[12:15], s54 offen lds
s_add_u32 m0, s53, 20480
s_add_u32 s54, s52, 655360
buffer_load_dwordx4 v1, s[12:15], s54 offen lds
s_add_u32 m0, s53, 21504
s_add_u32 s54, s52, 688128
buffer_load_dwordx4 v1, s[12:15], s54 offen lds
s_add_u32 m0, s53, 22528
s_add_u32 s54, s52, 720896
buffer_load_dwordx4 v1, s[12:15], s54 offen lds
s_add_u32 m0, s53, 23552
s_add_u32 s54, s52, 753664
buffer_load_dwordx4 v1, s[12:15], s54 offen lds
s_add_u32 m0, s53, 24576
s_add_u32 s54, s52, 786432
buffer_load_dwordx4 v1, s[12:15], s54 offen lds
s_add_u32 m0, s53, 25600
s_add_u32 s54, s52, 819200
buffer_load_dwordx4 v1, s[12:15], s54 offen lds
s_add_u32 m0, s53, 26624
s_add_u32 s54, s52, 851968
buffer_load_dwordx4 v1, s[12:15], s54 offen lds
s_add_u32 m0, s53, 27648
s_add_u32 s54, s52, 884736
buffer_load_dwordx4 v1, s[12:15], s54 offen lds
s_add_u32 m0, s53, 28672
s_add_u32 s54, s52, 917504
buffer_load_dwordx4 v1, s[12:15], s54 offen lds
s_add_u32 m0, s53, 29696
s_add_u32 s54, s52, 950272
buffer_load_dwordx4 v1, s[12:15], s54 offen lds
s_add_u32 m0, s53, 30720
s_add_u32 s54, s52, 983040
buffer_load_dwordx4 v1, s[12:15], s54 offen lds
s_add_u32 m0, s53, 31744
s_add_u32 s54, s52, 1015808
buffer_load_dwordx4 v1, s[12:15], s54 offen lds
s_add_u32 m0, s53, 32768
s_add_u32 s54, s52, 1048576
buffer_load_dwordx4 v1, s[12:15], s54 offen lds
s_add_u32 m0, s53, 33792
s_add_u32 s54, s52, 1081344
buffer_load_dwordx4 v1, s[12:15], s54 offen lds
s_add_u32 m0, s53, 34816
s_add_u32 s54, s52, 1114112
buffer_load_dwordx4 v1, s[12:15], s54 offen lds
s_add_u32 m0, s53, 35840
s_add_u32 s54, s52, 1146880
buffer_load_dwordx4 v1, s[12:15], s54 offen lds
s_add_u32 m0, s53, 36864
s_add_u32 s54, s52, 1179648
buffer_load_dwordx4 v1, s[12:15], s54 offen lds
s_add_u32 m0, s53, 37888
s_add_u32 s54, s52, 1212416
buffer_load_dwordx4 v1, s[12:15], s54 offen lds
s_add_u32 m0, s53, 38912
s_add_u32 s54, s52, 1245184
buffer_load_dwordx4 v1, s[12:15], s54 offen lds
s_add_u32 m0, s53, 39936
s_add_u32 s54, s52, 1277952
buffer_load_dwordx4 v1, s[12:15], s54 offen lds
v_bfe_u32 v2, v0, 8, 1
v_bfe_u32 v3, v0, 5, 1
s_cmp_eq_u32 s58, 1
s_cselect_b32 s52, 7, 4
s_cselect_b32 s53, 4, 7
v_lshlrev_b32 v2, s52, v2
v_lshlrev_b32 v3, s53, v3
v_add_u32 v2, v2, v3
v_bfe_u32 v3, v0, 4, 1
v_lshl_add_u32 v2, v3, 3, v2
v_bfe_u32 v3, v0, 6, 2
v_xor_b32 v4, s3, v3
v_lshl_add_u32 v2, v4, 5, v2
v_lshl_add_u32 v2, v3, 8, v2
v_lshrrev_b32 v3, 9, v0
v_lshl_add_u32 v2, v3, 11, v2
v_add_u32 v3, 0x10000, v2
v_add_u32 v4, 0x20000, v2
s_waitcnt vmcnt(0)
s_barrier
ds_read_b64_tr_b16 v[96:97], v2 offset:0
ds_read_b64_tr_b16 v[98:99], v2 offset:1024
ds_read_b64_tr_b16 v[100:101], v2 offset:4096
ds_read_b64_tr_b16 v[102:103], v2 offset:5120
ds_read_b64_tr_b16 v[104:105], v2 offset:8192
ds_read_b64_tr_b16 v[106:107], v2 offset:9216
ds_read_b64_tr_b16 v[108:109], v2 offset:12288
ds_read_b64_tr_b16 v[110:111], v2 offset:13312
ds_read_b64_tr_b16 v[112:113], v2 offset:16384
ds_read_b64_tr_b16 v[114:115], v2 offset:17408
ds_read_b64_tr_b16 v[116:117], v2 offset:20480
ds_read_b64_tr_b16 v[118:119], v2 offset:21504
ds_read_b64_tr_b16 v[120:121], v2 offset:24576
ds_read_b64_tr_b16 v[122:123], v2 offset:25600
ds_read_b64_tr_b16 v[124:125], v2 offset:28672
ds_read_b64_tr_b16 v[126:127], v2 offset:29696
ds_read_b64_tr_b16 v[128:129], v2 offset:32768
ds_read_b64_tr_b16 v[130:131], v2 offset:33792
ds_read_b64_tr_b16 v[132:133], v2 offset:36864
ds_read_b64_tr_b16 v[134:135], v2 offset:37888
ds_read_b64_tr_b16 v[136:137], v2 offset:40960
ds_read_b64_tr_b16 v[138:139], v2 offset:41984
ds_read_b64_tr_b16 v[140:141], v2 offset:45056
ds_read_b64_tr_b16 v[142:143], v2 offset:46080
ds_read_b64_tr_b16 v[144:145], v2 offset:49152
ds_read_b64_tr_b16 v[146:147], v2 offset:50176
ds_read_b64_tr_b16 v[148:149], v2 offset:53248
ds_read_b64_tr_b16 v[150:151], v2 offset:54272
ds_read_b64_tr_b16 v[152:153], v2 offset:57344
ds_read_b64_tr_b16 v[154:155], v2 offset:58368
ds_read_b64_tr_b16 v[156:157], v2 offset:61440
ds_read_b64_tr_b16 v[158:159], v2 offset:62464
ds_read_b64_tr_b16 v[160:161], v3 offset:0
ds_read_b64_tr_b16 v[162:163], v3 offset:1024
ds_read_b64_tr_b16 v[164:165], v3 offset:4096
ds_read_b64_tr_b16 v[166:167], v3 offset:5120
ds_read_b64_tr_b16 v[168:169], v3 offset:8192
ds_read_b64_tr_b16 v[170:171], v3 offset:9216
ds_read_b64_tr_b16 v[172:173], v3 offset:12288
ds_read_b64_tr_b16 v[174:175], v3 offset:13312
ds_read_b64_tr_b16 v[176:177], v3 offset:16384
ds_read_b64_tr_b16 v[178:179], v3 offset:17408
ds_read_b64_tr_b16 v[180:181], v3 offset:20480
ds_read_b64_tr_b16 v[182:183], v3 offset:21504
ds_read_b64_tr_b16 v[184:185], v3 offset:24576
ds_read_b64_tr_b16 v[186:187], v3 offset:25600
ds_read_b64_tr_b16 v[188:189], v3 offset:28672
ds_read_b64_tr_b16 v[190:191], v3 offset:29696
ds_read_b64_tr_b16 v[192:193], v3 offset:32768
ds_read_b64_tr_b16 v[194:195], v3 offset:33792
ds_read_b64_tr_b16 v[196:197], v3 offset:36864
ds_read_b64_tr_b16 v[198:199], v3 offset:37888
ds_read_b64_tr_b16 v[200:201], v3 offset:40960
ds_read_b64_tr_b16 v[202:203], v3 offset:41984
ds_read_b64_tr_b16 v[204:205], v3 offset:45056
ds_read_b64_tr_b16 v[206:207], v3 offset:46080
ds_read_b64_tr_b16 v[208:209], v3 offset:49152
ds_read_b64_tr_b16 v[210:211], v3 offset:50176
ds_read_b64_tr_b16 v[212:213], v3 offset:53248
ds_read_b64_tr_b16 v[214:215], v3 offset:54272
ds_read_b64_tr_b16 v[216:217], v3 offset:57344
ds_read_b64_tr_b16 v[218:219], v3 offset:58368
ds_read_b64_tr_b16 v[220:221], v3 offset:61440
ds_read_b64_tr_b16 v[222:223], v3 offset:62464
ds_read_b64_tr_b16 v[224:225], v4 offset:0
ds_read_b64_tr_b16 v[226:227], v4 offset:1024
ds_read_b64_tr_b16 v[228:229], v4 offset:4096
ds_read_b64_tr_b16 v[230:231], v4 offset:5120
ds_read_b64_tr_b16 v[232:233], v4 offset:8192
ds_read_b64_tr_b16 v[234:235], v4 offset:9216
ds_read_b64_tr_b16 v[236:237], v4 offset:12288
ds_read_b64_tr_b16 v[238:239], v4 offset:13312
ds_read_b64_tr_b16 v[240:241], v4 offset:16384
ds_read_b64_tr_b16 v[242:243], v4 offset:17408
ds_read_b64_tr_b16 v[244:245], v4 offset:20480
ds_read_b64_tr_b16 v[246:247], v4 offset:21504
ds_read_b64_tr_b16 v[248:249], v4 offset:24576
ds_read_b64_tr_b16 v[250:251], v4 offset:25600
ds_read_b64_tr_b16 v[252:253], v4 offset:28672
ds_read_b64_tr_b16 v[254:255], v4 offset:29696
s_waitcnt lgkmcnt(0)
s_cmp_lg_u32 s3, 0
s_cbranch_scc1 k_wdd_29
v_mov_b32 v2, 128
k_wd_28:
global_load_dword v3, v2, s[28:29] sc1
s_waitcnt vmcnt(0)
v_readfirstlane_b32 s52, v3
s_cmp_ge_u32 s52, 32
s_cbranch_scc1 k_wdd_29
s_sleep 2
s_sub_u32 s32, s32, 1
s_cmp_gt_i32 s32, 0
s_cbranch_scc1 k_wd_28
k_wdd_29:
s_barrier
s_mul_i32 s46, s3, 10240
s_add_u32 s46, s46, 213909504
s_mul_i32 s45, s3, 10240
s_mov_b32 s44, 0
v_mov_b32 v64, v0
s_add_u32 m0, s45, 0
s_add_u32 s55, s46, 0
buffer_load_dwordx4 v0, s[4:7], s55 offen offset:0 sc1 lds
buffer_load_dwordx4 v0, s[4:7], s55 offen offset:1024 sc1 lds
buffer_load_dwordx4 v0, s[4:7], s55 offen offset:2048 sc1 lds
buffer_load_dwordx4 v0, s[4:7], s55 offen offset:3072 sc1 lds
s_add_u32 m0, s45, 4096
s_add_u32 s55, s46, 4096
buffer_load_dwordx4 v0, s[4:7], s55 offen offset:0 sc1 lds
buffer_load_dwordx4 v0, s[4:7], s55 offen offset:1024 sc1 lds
buffer_load_dwordx4 v0, s[4:7], s55 offen offset:2048 sc1 lds
buffer_load_dwordx4 v0, s[4:7], s55 offen offset:3072 sc1 lds
s_add_u32 m0, s45, 8192
s_add_u32 s55, s46, 8192
buffer_load_dwordx4 v0, s[4:7], s55 offen offset:0 sc1 lds
buffer_load_dwordx4 v0, s[4:7], s55 offen offset:1024 sc1 lds
s_add_u32 s45, s45, 40960
s_cmp_ge_u32 s45, 122880
s_cselect_b32 s55, 122880, 0
s_sub_u32 s45, s45, s55
s_add_u32 s46, s46, 40960
s_add_u32 m0, s45, 0
s_add_u32 s55, s46, 0
buffer_load_dwordx4 v0, s[4:7], s55 offen offset:0 sc1 lds
buffer_load_dwordx4 v0, s[4:7], s55 offen offset:1024 sc1 lds
buffer_load_dwordx4 v0, s[4:7], s55 offen offset:2048 sc1 lds
buffer_load_dwordx4 v0, s[4:7], s55 offen offset:3072 sc1 lds
s_add_u32 m0, s45, 4096
s_add_u32 s55, s46, 4096
buffer_load_dwordx4 v0, s[4:7], s55 offen offset:0 sc1 lds
buffer_load_dwordx4 v0, s[4:7], s55 offen offset:1024 sc1 lds
buffer_load_dwordx4 v0, s[4:7], s55 offen offset:2048 sc1 lds
buffer_load_dwordx4 v0, s[4:7], s55 offen offset:3072 sc1 lds
s_add_u32 m0, s45, 8192
s_add_u32 s55, s46, 8192
buffer_load_dwordx4 v0, s[4:7], s55 offen offset:0 sc1 lds
buffer_load_dwordx4 v0, s[4:7], s55 offen offset:1024 sc1 lds
s_add_u32 s45, s45, 40960
s_cmp_ge_u32 s45, 122880
s_cselect_b32 s55, 122880, 0
s_sub_u32 s45, s45, s55
s_add_u32 s46, s46, 40960
s_waitcnt vmcnt(10)
s_barrier
ds_read_b128 v[8:11], v64 offset:0
ds_read_b128 v[12:15], v64 offset:1024
ds_read_b128 v[16:19], v64 offset:2048
ds_read_b128 v[20:23], v64 offset:3072
v_mov_b32 v1, 0xffff
v_cmp_gt_u32 vcc, 512, v0
s_nop 1
v_cndmask_b32 v1, -1, v1, vcc
s_waitcnt lgkmcnt(3)
v_mfma_f32_32x32x16_bf16 v[32:47], v[8:11], v[96:99], 0
s_waitcnt lgkmcnt(2)
ds_read_b128 v[24:27], v64 offset:4096
v_mfma_f32_32x32x16_bf16 v[32:47], v[12:15], v[100:103], v[32:47]
s_waitcnt lgkmcnt(2)
ds_read_b128 v[8:11], v64 offset:5120
s_add_u32 m0, s45, 0
s_add_u32 s55, s46, 0
buffer_load_dwordx4 v0, s[4:7], s55 offen offset:0 sc1 lds
buffer_load_dwordx4 v0, s[4:7], s55 offen offset:1024 sc1 lds
v_mfma_f32_32x32x16_bf16 v[32:47], v[16:19], v[104:107], v[32:47]
s_waitcnt lgkmcnt(2)
ds_read_b128 v[12:15], v64 offset:6144
buffer_load_dwordx4 v0, s[4:7], s55 offen offset:2048 sc1 lds
buffer_load_dwordx4 v0, s[4:7], s55 offen offset:3072 sc1 lds
v_mfma_f32_32x32x16_bf16 v[32:47], v[20:23], v[108:111], v[32:47]
s_waitcnt lgkmcnt(2)
ds_read_b128 v[16:19], v64 offset:7168
s_add_u32 m0, s45, 4096
s_add_u32 s55, s46, 4096
buffer_load_dwordx4 v0, s[4:7], s55 offen offset:0 sc1 lds
buffer_load_dwordx4 v0, s[4:7], s55 offen offset:1024 sc1 lds
v_mfma_f32_32x32x16_bf16 v[32:47], v[24:27], v[112:115], v[32:47]
s_waitcnt lgkmcnt(2)
ds_read_b128 v[20:23], v64 offset:8192
buffer_load_dwordx4 v0, s[4:7], s55 offen offset:2048 sc1 lds
buffer_load_dwordx4 v0, s[4:7], s55 offen offset:3072 sc1 lds
v_mfma_f32_32x32x16_bf16 v[32:47], v[8:11], v[116:119], v[32:47]
s_waitcnt lgkmcnt(2)
ds_read_b128 v[24:27], v64 offset:9216
s_add_u32 m0, s45, 8192
s_add_u32 s55, s46, 8192
buffer_load_dwordx4 v0, s[4:7], s55 offen offset:0 sc1 lds
buffer_load_dwordx4 v0, s[4:7], s55 offen offset:1024 sc1 lds
v_mfma_f32_32x32x16_bf16 v[32:47], v[12:15], v[120:123], v[32:47]
s_waitcnt lgkmcnt(2)
ds_read_b128 v[8:11], v64 offset:10240
s_add_u32 s45, s45, 40960
s_cmp_ge_u32 s45, 122880
s_cselect_b32 s55, 122880, 0
s_sub_u32 s45, s45, s55
s_add_u32 s46, s46, 40960
v_mfma_f32_32x32x16_bf16 v[32:47], v[16:19], v[124:127], v[32:47]
s_waitcnt lgkmcnt(2)
ds_read_b128 v[12:15], v64 offset:11264
v_mfma_f32_32x32x16_bf16 v[32:47], v[20:23], v[128:131], v[32:47]
s_waitcnt lgkmcnt(2)
ds_read_b128 v[16:19], v64 offset:12288
v_mfma_f32_32x32x16_bf16 v[32:47], v[24:27], v[132:135], v[32:47]
s_waitcnt lgkmcnt(2)
ds_read_b128 v[20:23], v64 offset:13312
v_mfma_f32_32x32x16_bf16 v[32:47], v[8:11], v[136:139], v[32:47]
s_waitcnt lgkmcnt(2)
ds_read_b128 v[24:27], v64 offset:14336
v_mfma_f32_32x32x16_bf16 v[32:47], v[12:15], v[140:143], v[32:47]
s_waitcnt lgkmcnt(2)
ds_read_b128 v[8:11], v64 offset:15360
v_mfma_f32_32x32x16_bf16 v[32:47], v[16:19], v[144:147], v[32:47]
s_waitcnt lgkmcnt(2)
ds_read_b128 v[12:15], v64 offset:16384
v_mfma_f32_32x32x16_bf16 v[32:47], v[20:23], v[148:151], v[32:47]
s_waitcnt lgkmcnt(2)
ds_read_b128 v[16:19], v64 offset:17408
v_mfma_f32_32x32x16_bf16 v[32:47], v[24:27], v[152:155], v[32:47]
s_waitcnt lgkmcnt(2)
ds_read_b128 v[20:23], v64 offset:18432
v_mfma_f32_32x32x16_bf16 v[32:47], v[8:11], v[156:159], v[32:47]
s_waitcnt lgkmcnt(2)
ds_read_b128 v[24:27], v64 offset:19456
v_mfma_f32_32x32x16_bf16 v[32:47], v[12:15], v[160:163], v[32:47]
s_waitcnt lgkmcnt(2)
ds_read_b128 v[8:11], v64 offset:20480
v_mfma_f32_32x32x16_bf16 v[32:47], v[16:19], v[164:167], v[32:47]
s_waitcnt lgkmcnt(2)
ds_read_b128 v[12:15], v64 offset:21504
v_mfma_f32_32x32x16_bf16 v[32:47], v[20:23], v[168:171], v[32:47]
s_waitcnt lgkmcnt(2)
ds_read_b128 v[16:19], v64 offset:22528
v_mfma_f32_32x32x16_bf16 v[32:47], v[24:27], v[172:175], v[32:47]
s_waitcnt lgkmcnt(2)
ds_read_b128 v[20:23], v64 offset:23552
v_mfma_f32_32x32x16_bf16 v[32:47], v[8:11], v[176:179], v[32:47]
s_waitcnt lgkmcnt(2)
ds_read_b128 v[24:27], v64 offset:24576
v_mfma_f32_32x32x16_bf16 v[32:47], v[12:15], v[180:183], v[32:47]
s_waitcnt lgkmcnt(2)
ds_read_b128 v[8:11], v64 offset:25600
v_mfma_f32_32x32x16_bf16 v[32:47], v[16:19], v[184:187], v[32:47]
s_waitcnt lgkmcnt(2)
ds_read_b128 v[12:15], v64 offset:26624
v_mfma_f32_32x32x16_bf16 v[32:47], v[20:23], v[188:191], v[32:47]
s_waitcnt lgkmcnt(2)
ds_read_b128 v[16:19], v64 offset:27648
v_mfma_f32_32x32x16_bf16 v[32:47], v[24:27], v[192:195], v[32:47]
s_waitcnt lgkmcnt(2)
ds_read_b128 v[20:23], v64 offset:28672
v_mfma_f32_32x32x16_bf16 v[32:47], v[8:11], v[196:199], v[32:47]
s_waitcnt lgkmcnt(2)
ds_read_b128 v[24:27], v64 offset:29696
v_mfma_f32_32x32x16_bf16 v[32:47], v[12:15], v[200:203], v[32:47]
s_waitcnt lgkmcnt(2)
ds_read_b128 v[8:11], v64 offset:30720
v_mfma_f32_32x32x16_bf16 v[32:47], v[16:19], v[204:207], v[32:47]
s_waitcnt lgkmcnt(2)
ds_read_b128 v[12:15], v64 offset:31744
v_mfma_f32_32x32x16_bf16 v[32:47], v[20:23], v[208:211], v[32:47]
s_waitcnt lgkmcnt(2)
ds_read_b128 v[16:19], v64 offset:32768
v_mfma_f32_32x32x16_bf16 v[32:47], v[24:27], v[212:215], v[32:47]
s_waitcnt lgkmcnt(2)
ds_read_b128 v[20:23], v64 offset:33792
v_mfma_f32_32x32x16_bf16 v[32:47], v[8:11], v[216:219], v[32:47]
s_waitcnt lgkmcnt(2)
ds_read_b128 v[24:27], v64 offset:34816
v_mfma_f32_32x32x16_bf16 v[32:47], v[12:15], v[220:223], v[32:47]
s_waitcnt lgkmcnt(2)
ds_read_b128 v[8:11], v64 offset:35840
v_mfma_f32_32x32x16_bf16 v[32:47], v[16:19], v[224:227], v[32:47]
s_waitcnt lgkmcnt(2)
ds_read_b128 v[12:15], v64 offset:36864
v_mfma_f32_32x32x16_bf16 v[32:47], v[20:23], v[228:231], v[32:47]
s_waitcnt lgkmcnt(2)
ds_read_b128 v[16:19], v64 offset:37888
v_mfma_f32_32x32x16_bf16 v[32:47], v[24:27], v[232:235], v[32:47]
s_waitcnt lgkmcnt(2)
ds_read_b128 v[20:23], v64 offset:38912
v_mfma_f32_32x32x16_bf16 v[32:47], v[8:11], v[236:239], v[32:47]
s_waitcnt lgkmcnt(2)
ds_read_b128 v[24:27], v64 offset:39936
v_mfma_f32_32x32x16_bf16 v[32:47], v[12:15], v[240:243], v[32:47]
s_add_u32 s44, s44, 1
s_cmp_eq_u32 s44, 3
s_mov_b32 s56, 40960
s_cmov_b32 s56, -81920
s_cselect_b32 s44, 0, s44
v_add_u32 v64, s56, v64
s_waitcnt vmcnt(10) lgkmcnt(2)
s_barrier
ds_read_b128 v[8:11], v64 offset:0
v_mfma_f32_32x32x16_bf16 v[32:47], v[16:19], v[244:247], v[32:47]
s_waitcnt lgkmcnt(2)
ds_read_b128 v[12:15], v64 offset:1024
v_mfma_f32_32x32x16_bf16 v[32:47], v[20:23], v[248:251], v[32:47]
s_waitcnt lgkmcnt(2)
ds_read_b128 v[16:19], v64 offset:2048
v_mfma_f32_32x32x16_bf16 v[32:47], v[24:27], v[252:255], v[32:47]
s_waitcnt lgkmcnt(2)
ds_read_b128 v[20:23], v64 offset:3072
v_mfma_f32_32x32x16_bf16 v[48:63], v[8:11], v[96:99], 0
s_waitcnt lgkmcnt(2)
ds_read_b128 v[24:27], v64 offset:4096
v_mfma_f32_32x32x16_bf16 v[48:63], v[12:15], v[100:103], v[48:63]
s_waitcnt lgkmcnt(2)
ds_read_b128 v[8:11], v64 offset:5120
v_cvt_pk_bf16_f32 v32, v32, v33
v_cvt_pk_bf16_f32 v33, v34, v35
v_mfma_f32_32x32x16_bf16 v[48:63], v[16:19], v[104:107], v[48:63]
s_waitcnt lgkmcnt(2)
ds_read_b128 v[12:15], v64 offset:6144
v_cvt_pk_bf16_f32 v34, v36, v37
v_cvt_pk_bf16_f32 v35, v38, v39
v_mfma_f32_32x32x16_bf16 v[48:63], v[20:23], v[108:111], v[48:63]
s_waitcnt lgkmcnt(2)
ds_read_b128 v[16:19], v64 offset:7168
v_cvt_pk_bf16_f32 v36, v40, v41
v_cvt_pk_bf16_f32 v37, v42, v43
v_mfma_f32_32x32x16_bf16 v[48:63], v[24:27], v[112:115], v[48:63]
s_waitcnt lgkmcnt(2)
ds_read_b128 v[20:23], v64 offset:8192
v_cvt_pk_bf16_f32 v38, v44, v45
v_cvt_pk_bf16_f32 v39, v46, v47
v_mfma_f32_32x32x16_bf16 v[48:63], v[8:11], v[116:119], v[48:63]
s_waitcnt lgkmcnt(2)
ds_read_b128 v[24:27], v64 offset:9216
v_and_b32 v32, v1, v32
v_accvgpr_write_b32 a0, v32
v_mfma_f32_32x32x16_bf16 v[48:63], v[12:15], v[120:123], v[48:63]
s_waitcnt lgkmcnt(2)
ds_read_b128 v[8:11], v64 offset:10240
v_accvgpr_write_b32 a1, v33
v_accvgpr_write_b32 a2, v34
v_mfma_f32_32x32x16_bf16 v[48:63], v[16:19], v[124:127], v[48:63]
s_waitcnt lgkmcnt(2)
ds_read_b128 v[12:15], v64 offset:11264
v_accvgpr_write_b32 a3, v35
v_accvgpr_write_b32 a4, v36
v_mfma_f32_32x32x16_bf16 v[48:63], v[20:23], v[128:131], v[48:63]
s_waitcnt lgkmcnt(2)
ds_read_b128 v[16:19], v64 offset:12288
v_accvgpr_write_b32 a5, v37
v_accvgpr_write_b32 a6, v38
v_mfma_f32_32x32x16_bf16 v[48:63], v[24:27], v[132:135], v[48:63]
s_waitcnt lgkmcnt(2)
ds_read_b128 v[20:23], v64 offset:13312
v_accvgpr_write_b32 a7, v39
s_add_u32 m0, s45, 0
s_add_u32 s55, s46, 0
buffer_load_dwordx4 v0, s[4:7], s55 offen offset:0 sc1 lds
v_mfma_f32_32x32x16_bf16 v[48:63], v[8:11], v[136:139], v[48:63]
s_waitcnt lgkmcnt(2)
ds_read_b128 v[24:27], v64 offset:14336
buffer_load_dwordx4 v0, s[4:7], s55 offen offset:1024 sc1 lds
buffer_load_dwordx4 v0, s[4:7], s55 offen offset:2048 sc1 lds
v_mfma_f32_32x32x16_bf16 v[48:63], v[12:15], v[140:143], v[48:63]
s_waitcnt lgkmcnt(2)
ds_read_b128 v[8:11], v64 offset:15360
buffer_load_dwordx4 v0, s[4:7], s55 offen offset:3072 sc1 lds
s_add_u32 m0, s45, 4096
s_add_u32 s55, s46, 4096
buffer_load_dwordx4 v0, s[4:7], s55 offen offset:0 sc1 lds
v_mfma_f32_32x32x16_bf16 v[48:63], v[16:19], v[144:147], v[48:63]
s_waitcnt lgkmcnt(2)
ds_read_b128 v[12:15], v64 offset:16384
buffer_load_dwordx4 v0, s[4:7], s55 offen offset:1024 sc1 lds
buffer_load_dwordx4 v0, s[4:7], s55 offen offset:2048 sc1 lds
v_mfma_f32_32x32x16_bf16 v[48:63], v[20:23], v[148:151], v[48:63]
s_waitcnt lgkmcnt(2)
ds_read_b128 v[16:19], v64 offset:17408
buffer_load_dwordx4 v0, s[4:7], s55 offen offset:3072 sc1 lds
s_add_u32 m0, s45, 8192
s_add_u32 s55, s46, 8192
buffer_load_dwordx4 v0, s[4:7], s55 offen offset:0 sc1 lds
v_mfma_f32_32x32x16_bf16 v[48:63], v[24:27], v[152:155], v[48:63]
s_waitcnt lgkmcnt(2)
ds_read_b128 v[20:23], v64 offset:18432
buffer_load_dwordx4 v0, s[4:7], s55 offen offset:1024 sc1 lds
s_add_u32 s45, s45, 40960
s_cmp_ge_u32 s45, 122880
s_cselect_b32 s55, 122880, 0
s_sub_u32 s45, s45, s55
v_mfma_f32_32x32x16_bf16 v[48:63], v[8:11], v[156:159], v[48:63]
s_waitcnt lgkmcnt(2)
ds_read_b128 v[24:27], v64 offset:19456
s_add_u32 s46, s46, 40960
v_mfma_f32_32x32x16_bf16 v[48:63], v[12:15], v[160:163], v[48:63]
s_waitcnt lgkmcnt(2)
ds_read_b128 v[8:11], v64 offset:20480
v_mfma_f32_32x32x16_bf16 v[48:63], v[16:19], v[164:167], v[48:63]
s_waitcnt lgkmcnt(2)
ds_read_b128 v[12:15], v64 offset:21504
v_mfma_f32_32x32x16_bf16 v[48:63], v[20:23], v[168:171], v[48:63]
s_waitcnt lgkmcnt(2)
ds_read_b128 v[16:19], v64 offset:22528
v_mfma_f32_32x32x16_bf16 v[48:63], v[24:27], v[172:175], v[48:63]
s_waitcnt lgkmcnt(2)
ds_read_b128 v[20:23], v64 offset:23552
v_mfma_f32_32x32x16_bf16 v[48:63], v[8:11], v[176:179], v[48:63]
s_waitcnt lgkmcnt(2)
ds_read_b128 v[24:27], v64 offset:24576
v_mfma_f32_32x32x16_bf16 v[48:63], v[12:15], v[180:183], v[48:63]
s_waitcnt lgkmcnt(2)
ds_read_b128 v[8:11], v64 offset:25600
v_mfma_f32_32x32x16_bf16 v[48:63], v[16:19], v[184:187], v[48:63]
s_waitcnt lgkmcnt(2)
ds_read_b128 v[12:15], v64 offset:26624
v_mfma_f32_32x32x16_bf16 v[48:63], v[20:23], v[188:191], v[48:63]
s_waitcnt lgkmcnt(2)
ds_read_b128 v[16:19], v64 offset:27648
v_mfma_f32_32x32x16_bf16 v[48:63], v[24:27], v[192:195], v[48:63]
s_waitcnt lgkmcnt(2)
ds_read_b128 v[20:23], v64 offset:28672
v_mfma_f32_32x32x16_bf16 v[48:63], v[8:11], v[196:199], v[48:63]
s_waitcnt lgkmcnt(2)
ds_read_b128 v[24:27], v64 offset:29696
v_mfma_f32_32x32x16_bf16 v[48:63], v[12:15], v[200:203], v[48:63]
s_waitcnt lgkmcnt(2)
ds_read_b128 v[8:11], v64 offset:30720
v_mfma_f32_32x32x16_bf16 v[48:63], v[16:19], v[204:207], v[48:63]
s_waitcnt lgkmcnt(2)
ds_read_b128 v[12:15], v64 offset:31744
v_mfma_f32_32x32x16_bf16 v[48:63], v[20:23], v[208:211], v[48:63]
s_waitcnt lgkmcnt(2)
ds_read_b128 v[16:19], v64 offset:32768
v_mfma_f32_32x32x16_bf16 v[48:63], v[24:27], v[212:215], v[48:63]
s_waitcnt lgkmcnt(2)
ds_read_b128 v[20:23], v64 offset:33792
v_mfma_f32_32x32x16_bf16 v[48:63], v[8:11], v[216:219], v[48:63]
s_waitcnt lgkmcnt(2)
ds_read_b128 v[24:27], v64 offset:34816
v_mfma_f32_32x32x16_bf16 v[48:63], v[12:15], v[220:223], v[48:63]
s_waitcnt lgkmcnt(2)
ds_read_b128 v[8:11], v64 offset:35840
v_mfma_f32_32x32x16_bf16 v[48:63], v[16:19], v[224:227], v[48:63]
s_waitcnt lgkmcnt(2)
ds_read_b128 v[12:15], v64 offset:36864
v_mfma_f32_32x32x16_bf16 v[48:63], v[20:23], v[228:231], v[48:63]
s_waitcnt lgkmcnt(2)
ds_read_b128 v[16:19], v64 offset:37888
v_mfma_f32_32x32x16_bf16 v[48:63], v[24:27], v[232:235], v[48:63]
s_waitcnt lgkmcnt(2)
ds_read_b128 v[20:23], v64 offset:38912
v_mfma_f32_32x32x16_bf16 v[48:63], v[8:11], v[236:239], v[48:63]
s_waitcnt lgkmcnt(2)
ds_read_b128 v[24:27], v64 offset:39936
v_mfma_f32_32x32x16_bf16 v[48:63], v[12:15], v[240:243], v[48:63]
s_add_u32 s44, s44, 1
s_cmp_eq_u32 s44, 3
s_mov_b32 s56, 40960
s_cmov_b32 s56, -81920
s_cselect_b32 s44, 0, s44
v_add_u32 v64, s56, v64
s_waitcnt vmcnt(10) lgkmcnt(2)
s_barrier
ds_read_b128 v[8:11], v64 offset:0
v_mfma_f32_32x32x16_bf16 v[48:63], v[16:19], v[244:247], v[48:63]
s_waitcnt lgkmcnt(2)
ds_read_b128 v[12:15], v64 offset:1024
v_mfma_f32_32x32x16_bf16 v[48:63], v[20:23], v[248:251], v[48:63]
s_waitcnt lgkmcnt(2)
ds_read_b128 v[16:19], v64 offset:2048
v_mfma_f32_32x32x16_bf16 v[48:63], v[24:27], v[252:255], v[48:63]
s_waitcnt lgkmcnt(2)
ds_read_b128 v[20:23], v64 offset:3072
v_mfma_f32_32x32x16_bf16 v[32:47], v[8:11], v[96:99], 0
s_waitcnt lgkmcnt(2)
ds_read_b128 v[24:27], v64 offset:4096
v_mfma_f32_32x32x16_bf16 v[32:47], v[12:15], v[100:103], v[32:47]
s_waitcnt lgkmcnt(2)
ds_read_b128 v[8:11], v64 offset:5120
v_cvt_pk_bf16_f32 v48, v48, v49
v_cvt_pk_bf16_f32 v49, v50, v51
v_mfma_f32_32x32x16_bf16 v[32:47], v[16:19], v[104:107], v[32:47]
s_waitcnt lgkmcnt(2)
ds_read_b128 v[12:15], v64 offset:6144
v_cvt_pk_bf16_f32 v50, v52, v53
v_cvt_pk_bf16_f32 v51, v54, v55
v_mfma_f32_32x32x16_bf16 v[32:47], v[20:23], v[108:111], v[32:47]
s_waitcnt lgkmcnt(2)
ds_read_b128 v[16:19], v64 offset:7168
v_cvt_pk_bf16_f32 v52, v56, v57
v_cvt_pk_bf16_f32 v53, v58, v59
v_mfma_f32_32x32x16_bf16 v[32:47], v[24:27], v[112:115], v[32:47]
s_waitcnt lgkmcnt(2)
ds_read_b128 v[20:23], v64 offset:8192
v_cvt_pk_bf16_f32 v54, v60, v61
v_cvt_pk_bf16_f32 v55, v62, v63
v_mfma_f32_32x32x16_bf16 v[32:47], v[8:11], v[116:119], v[32:47]
s_waitcnt lgkmcnt(2)
ds_read_b128 v[24:27], v64 offset:9216
v_accvgpr_write_b32 a8, v48
v_accvgpr_write_b32 a9, v49
v_mfma_f32_32x32x16_bf16 v[32:47], v[12:15], v[120:123], v[32:47]
s_waitcnt lgkmcnt(2)
ds_read_b128 v[8:11], v64 offset:10240
v_accvgpr_write_b32 a10, v50
v_accvgpr_write_b32 a11, v51
v_mfma_f32_32x32x16_bf16 v[32:47], v[16:19], v[124:127], v[32:47]
s_waitcnt lgkmcnt(2)
ds_read_b128 v[12:15], v64 offset:11264
v_accvgpr_write_b32 a12, v52
v_accvgpr_write_b32 a13, v53
v_mfma_f32_32x32x16_bf16 v[32:47], v[20:23], v[128:131], v[32:47]
s_waitcnt lgkmcnt(2)
ds_read_b128 v[16:19], v64 offset:12288
v_accvgpr_write_b32 a14, v54
v_accvgpr_write_b32 a15, v55
v_mfma_f32_32x32x16_bf16 v[32:47], v[24:27], v[132:135], v[32:47]
s_waitcnt lgkmcnt(2)
ds_read_b128 v[20:23], v64 offset:13312
s_add_u32 m0, s45, 0
s_add_u32 s55, s46, 0
buffer_load_dwordx4 v0, s[4:7], s55 offen offset:0 sc1 lds
buffer_load_dwordx4 v0, s[4:7], s55 offen offset:1024 sc1 lds
v_mfma_f32_32x32x16_bf16 v[32:47], v[8:11], v[136:139], v[32:47]
s_waitcnt lgkmcnt(2)
ds_read_b128 v[24:27], v64 offset:14336
buffer_load_dwordx4 v0, s[4:7], s55 offen offset:2048 sc1 lds
buffer_load_dwordx4 v0, s[4:7], s55 offen offset:3072 sc1 lds
v_mfma_f32_32x32x16_bf16 v[32:47], v[12:15], v[140:143], v[32:47]
s_waitcnt lgkmcnt(2)
ds_read_b128 v[8:11], v64 offset:15360
s_add_u32 m0, s45, 4096
s_add_u32 s55, s46, 4096
buffer_load_dwordx4 v0, s[4:7], s55 offen offset:0 sc1 lds
buffer_load_dwordx4 v0, s[4:7], s55 offen offset:1024 sc1 lds
v_mfma_f32_32x32x16_bf16 v[32:47], v[16:19], v[144:147], v[32:47]
s_waitcnt lgkmcnt(2)
ds_read_b128 v[12:15], v64 offset:16384
buffer_load_dwordx4 v0, s[4:7], s55 offen offset:2048 sc1 lds
buffer_load_dwordx4 v0, s[4:7], s55 offen offset:3072 sc1 lds
v_mfma_f32_32x32x16_bf16 v[32:47], v[20:23], v[148:151], v[32:47]
s_waitcnt lgkmcnt(2)
ds_read_b128 v[16:19], v64 offset:17408
s_add_u32 m0, s45, 8192
s_add_u32 s55, s46, 8192
buffer_load_dwordx4 v0, s[4:7], s55 offen offset:0 sc1 lds
buffer_load_dwordx4 v0, s[4:7], s55 offen offset:1024 sc1 lds
v_mfma_f32_32x32x16_bf16 v[32:47], v[24:27], v[152:155], v[32:47]
s_waitcnt lgkmcnt(2)
ds_read_b128 v[20:23], v64 offset:18432
s_add_u32 s45, s45, 40960
s_cmp_ge_u32 s45, 122880
s_cselect_b32 s55, 122880, 0
s_sub_u32 s45, s45, s55
s_add_u32 s46, s46, 40960
v_mfma_f32_32x32x16_bf16 v[32:47], v[8:11], v[156:159], v[32:47]
s_waitcnt lgkmcnt(2)
ds_read_b128 v[24:27], v64 offset:19456
v_mfma_f32_32x32x16_bf16 v[32:47], v[12:15], v[160:163], v[32:47]
s_waitcnt lgkmcnt(2)
ds_read_b128 v[8:11], v64 offset:20480
v_mfma_f32_32x32x16_bf16 v[32:47], v[16:19], v[164:167], v[32:47]
s_waitcnt lgkmcnt(2)
ds_read_b128 v[12:15], v64 offset:21504
v_mfma_f32_32x32x16_bf16 v[32:47], v[20:23], v[168:171], v[32:47]
s_waitcnt lgkmcnt(2)
ds_read_b128 v[16:19], v64 offset:22528
v_mfma_f32_32x32x16_bf16 v[32:47], v[24:27], v[172:175], v[32:47]
s_waitcnt lgkmcnt(2)
ds_read_b128 v[20:23], v64 offset:23552
v_mfma_f32_32x32x16_bf16 v[32:47], v[8:11], v[176:179], v[32:47]
s_waitcnt lgkmcnt(2)
ds_read_b128 v[24:27], v64 offset:24576
v_mfma_f32_32x32x16_bf16 v[32:47], v[12:15], v[180:183], v[32:47]
s_waitcnt lgkmcnt(2)
ds_read_b128 v[8:11], v64 offset:25600
v_mfma_f32_32x32x16_bf16 v[32:47], v[16:19], v[184:187], v[32:47]
s_waitcnt lgkmcnt(2)
ds_read_b128 v[12:15], v64 offset:26624
v_mfma_f32_32x32x16_bf16 v[32:47], v[20:23], v[188:191], v[32:47]
s_waitcnt lgkmcnt(2)
ds_read_b128 v[16:19], v64 offset:27648
v_mfma_f32_32x32x16_bf16 v[32:47], v[24:27], v[192:195], v[32:47]
s_waitcnt lgkmcnt(2)
ds_read_b128 v[20:23], v64 offset:28672
v_mfma_f32_32x32x16_bf16 v[32:47], v[8:11], v[196:199], v[32:47]
s_waitcnt lgkmcnt(2)
ds_read_b128 v[24:27], v64 offset:29696
v_mfma_f32_32x32x16_bf16 v[32:47], v[12:15], v[200:203], v[32:47]
s_waitcnt lgkmcnt(2)
ds_read_b128 v[8:11], v64 offset:30720
v_mfma_f32_32x32x16_bf16 v[32:47], v[16:19], v[204:207], v[32:47]
s_waitcnt lgkmcnt(2)
ds_read_b128 v[12:15], v64 offset:31744
v_mfma_f32_32x32x16_bf16 v[32:47], v[20:23], v[208:211], v[32:47]
s_waitcnt lgkmcnt(2)
ds_read_b128 v[16:19], v64 offset:32768
v_mfma_f32_32x32x16_bf16 v[32:47], v[24:27], v[212:215], v[32:47]
s_waitcnt lgkmcnt(2)
ds_read_b128 v[20:23], v64 offset:33792
v_mfma_f32_32x32x16_bf16 v[32:47], v[8:11], v[216:219], v[32:47]
s_waitcnt lgkmcnt(2)
ds_read_b128 v[24:27], v64 offset:34816
v_mfma_f32_32x32x16_bf16 v[32:47], v[12:15], v[220:223], v[32:47]
s_waitcnt lgkmcnt(2)
ds_read_b128 v[8:11], v64 offset:35840
v_mfma_f32_32x32x16_bf16 v[32:47], v[16:19], v[224:227], v[32:47]
s_waitcnt lgkmcnt(2)
ds_read_b128 v[12:15], v64 offset:36864
v_mfma_f32_32x32x16_bf16 v[32:47], v[20:23], v[228:231], v[32:47]
s_waitcnt lgkmcnt(2)
ds_read_b128 v[16:19], v64 offset:37888
v_mfma_f32_32x32x16_bf16 v[32:47], v[24:27], v[232:235], v[32:47]
s_waitcnt lgkmcnt(2)
ds_read_b128 v[20:23], v64 offset:38912
v_mfma_f32_32x32x16_bf16 v[32:47], v[8:11], v[236:239], v[32:47]
s_waitcnt lgkmcnt(2)
ds_read_b128 v[24:27], v64 offset:39936
v_mfma_f32_32x32x16_bf16 v[32:47], v[12:15], v[240:243], v[32:47]
s_add_u32 s44, s44, 1
s_cmp_eq_u32 s44, 3
s_mov_b32 s56, 40960
s_cmov_b32 s56, -81920
s_cselect_b32 s44, 0, s44
v_add_u32 v64, s56, v64
s_waitcnt vmcnt(10) lgkmcnt(2)
s_barrier
ds_read_b128 v[8:11], v64 offset:0
v_mfma_f32_32x32x16_bf16 v[32:47], v[16:19], v[244:247], v[32:47]
s_waitcnt lgkmcnt(2)
ds_read_b128 v[12:15], v64 offset:1024
v_mfma_f32_32x32x16_bf16 v[32:47], v[20:23], v[248:251], v[32:47]
s_waitcnt lgkmcnt(2)
ds_read_b128 v[16:19], v64 offset:2048
v_mfma_f32_32x32x16_bf16 v[32:47], v[24:27], v[252:255], v[32:47]
s_waitcnt lgkmcnt(2)
ds_read_b128 v[20:23], v64 offset:3072
v_mfma_f32_32x32x16_bf16 v[48:63], v[8:11], v[96:99], 0
s_waitcnt lgkmcnt(2)
ds_read_b128 v[24:27], v64 offset:4096
v_mfma_f32_32x32x16_bf16 v[48:63], v[12:15], v[100:103], v[48:63]
s_waitcnt lgkmcnt(2)
ds_read_b128 v[8:11], v64 offset:5120
v_cvt_pk_bf16_f32 v32, v32, v33
v_cvt_pk_bf16_f32 v33, v34, v35
v_mfma_f32_32x32x16_bf16 v[48:63], v[16:19], v[104:107], v[48:63]
s_waitcnt lgkmcnt(2)
ds_read_b128 v[12:15], v64 offset:6144
v_cvt_pk_bf16_f32 v34, v36, v37
v_cvt_pk_bf16_f32 v35, v38, v39
v_mfma_f32_32x32x16_bf16 v[48:63], v[20:23], v[108:111], v[48:63]
s_waitcnt lgkmcnt(2)
ds_read_b128 v[16:19], v64 offset:7168
v_cvt_pk_bf16_f32 v36, v40, v41
v_cvt_pk_bf16_f32 v37, v42, v43
v_mfma_f32_32x32x16_bf16 v[48:63], v[24:27], v[112:115], v[48:63]
s_waitcnt lgkmcnt(2)
ds_read_b128 v[20:23], v64 offset:8192
v_cvt_pk_bf16_f32 v38, v44, v45
v_cvt_pk_bf16_f32 v39, v46, v47
v_mfma_f32_32x32x16_bf16 v[48:63], v[8:11], v[116:119], v[48:63]
s_waitcnt lgkmcnt(2)
ds_read_b128 v[24:27], v64 offset:9216
v_accvgpr_write_b32 a16, v32
v_accvgpr_write_b32 a17, v33
v_mfma_f32_32x32x16_bf16 v[48:63], v[12:15], v[120:123], v[48:63]
s_waitcnt lgkmcnt(2)
ds_read_b128 v[8:11], v64 offset:10240
v_accvgpr_write_b32 a18, v34
v_accvgpr_write_b32 a19, v35
v_mfma_f32_32x32x16_bf16 v[48:63], v[16:19], v[124:127], v[48:63]
s_waitcnt lgkmcnt(2)
ds_read_b128 v[12:15], v64 offset:11264
v_accvgpr_write_b32 a20, v36
v_accvgpr_write_b32 a21, v37
v_mfma_f32_32x32x16_bf16 v[48:63], v[20:23], v[128:131], v[48:63]
s_waitcnt lgkmcnt(2)
ds_read_b128 v[16:19], v64 offset:12288
v_accvgpr_write_b32 a22, v38
v_accvgpr_write_b32 a23, v39
v_mfma_f32_32x32x16_bf16 v[48:63], v[24:27], v[132:135], v[48:63]
s_waitcnt lgkmcnt(2)
ds_read_b128 v[20:23], v64 offset:13312
s_add_u32 m0, s45, 0
s_add_u32 s55, s46, 0
buffer_load_dwordx4 v0, s[4:7], s55 offen offset:0 sc1 lds
buffer_load_dwordx4 v0, s[4:7], s55 offen offset:1024 sc1 lds
v_mfma_f32_32x32x16_bf16 v[48:63], v[8:11], v[136:139], v[48:63]
s_waitcnt lgkmcnt(2)
ds_read_b128 v[24:27], v64 offset:14336
buffer_load_dwordx4 v0, s[4:7], s55 offen offset:2048 sc1 lds
buffer_load_dwordx4 v0, s[4:7], s55 offen offset:3072 sc1 lds
v_mfma_f32_32x32x16_bf16 v[48:63], v[12:15], v[140:143], v[48:63]
s_waitcnt lgkmcnt(2)
ds_read_b128 v[8:11], v64 offset:15360
s_add_u32 m0, s45, 4096
s_add_u32 s55, s46, 4096
buffer_load_dwordx4 v0, s[4:7], s55 offen offset:0 sc1 lds
buffer_load_dwordx4 v0, s[4:7], s55 offen offset:1024 sc1 lds
v_mfma_f32_32x32x16_bf16 v[48:63], v[16:19], v[144:147], v[48:63]
s_waitcnt lgkmcnt(2)
ds_read_b128 v[12:15], v64 offset:16384
buffer_load_dwordx4 v0, s[4:7], s55 offen offset:2048 sc1 lds
buffer_load_dwordx4 v0, s[4:7], s55 offen offset:3072 sc1 lds
v_mfma_f32_32x32x16_bf16 v[48:63], v[20:23], v[148:151], v[48:63]
s_waitcnt lgkmcnt(2)
ds_read_b128 v[16:19], v64 offset:17408
s_add_u32 m0, s45, 8192
s_add_u32 s55, s46, 8192
buffer_load_dwordx4 v0, s[4:7], s55 offen offset:0 sc1 lds
buffer_load_dwordx4 v0, s[4:7], s55 offen offset:1024 sc1 lds
v_mfma_f32_32x32x16_bf16 v[48:63], v[24:27], v[152:155], v[48:63]
s_waitcnt lgkmcnt(2)
ds_read_b128 v[20:23], v64 offset:18432
s_add_u32 s45, s45, 40960
s_cmp_ge_u32 s45, 122880
s_cselect_b32 s55, 122880, 0
s_sub_u32 s45, s45, s55
s_add_u32 s46, s46, 40960
v_mfma_f32_32x32x16_bf16 v[48:63], v[8:11], v[156:159], v[48:63]
s_waitcnt lgkmcnt(2)
ds_read_b128 v[24:27], v64 offset:19456
v_mfma_f32_32x32x16_bf16 v[48:63], v[12:15], v[160:163], v[48:63]
s_waitcnt lgkmcnt(2)
ds_read_b128 v[8:11], v64 offset:20480
v_mfma_f32_32x32x16_bf16 v[48:63], v[16:19], v[164:167], v[48:63]
s_waitcnt lgkmcnt(2)
ds_read_b128 v[12:15], v64 offset:21504
v_mfma_f32_32x32x16_bf16 v[48:63], v[20:23], v[168:171], v[48:63]
s_waitcnt lgkmcnt(2)
ds_read_b128 v[16:19], v64 offset:22528
v_mfma_f32_32x32x16_bf16 v[48:63], v[24:27], v[172:175], v[48:63]
s_waitcnt lgkmcnt(2)
ds_read_b128 v[20:23], v64 offset:23552
v_mfma_f32_32x32x16_bf16 v[48:63], v[8:11], v[176:179], v[48:63]
s_waitcnt lgkmcnt(2)
ds_read_b128 v[24:27], v64 offset:24576
v_mfma_f32_32x32x16_bf16 v[48:63], v[12:15], v[180:183], v[48:63]
s_waitcnt lgkmcnt(2)
ds_read_b128 v[8:11], v64 offset:25600
v_mfma_f32_32x32x16_bf16 v[48:63], v[16:19], v[184:187], v[48:63]
s_waitcnt lgkmcnt(2)
ds_read_b128 v[12:15], v64 offset:26624
v_mfma_f32_32x32x16_bf16 v[48:63], v[20:23], v[188:191], v[48:63]
s_waitcnt lgkmcnt(2)
ds_read_b128 v[16:19], v64 offset:27648
v_mfma_f32_32x32x16_bf16 v[48:63], v[24:27], v[192:195], v[48:63]
s_waitcnt lgkmcnt(2)
ds_read_b128 v[20:23], v64 offset:28672
v_mfma_f32_32x32x16_bf16 v[48:63], v[8:11], v[196:199], v[48:63]
s_waitcnt lgkmcnt(2)
ds_read_b128 v[24:27], v64 offset:29696
v_mfma_f32_32x32x16_bf16 v[48:63], v[12:15], v[200:203], v[48:63]
s_waitcnt lgkmcnt(2)
ds_read_b128 v[8:11], v64 offset:30720
v_mfma_f32_32x32x16_bf16 v[48:63], v[16:19], v[204:207], v[48:63]
s_waitcnt lgkmcnt(2)
ds_read_b128 v[12:15], v64 offset:31744
v_mfma_f32_32x32x16_bf16 v[48:63], v[20:23], v[208:211], v[48:63]
s_waitcnt lgkmcnt(2)
ds_read_b128 v[16:19], v64 offset:32768
v_mfma_f32_32x32x16_bf16 v[48:63], v[24:27], v[212:215], v[48:63]
s_waitcnt lgkmcnt(2)
ds_read_b128 v[20:23], v64 offset:33792
v_mfma_f32_32x32x16_bf16 v[48:63], v[8:11], v[216:219], v[48:63]
s_waitcnt lgkmcnt(2)
ds_read_b128 v[24:27], v64 offset:34816
v_mfma_f32_32x32x16_bf16 v[48:63], v[12:15], v[220:223], v[48:63]
s_waitcnt lgkmcnt(2)
ds_read_b128 v[8:11], v64 offset:35840
v_mfma_f32_32x32x16_bf16 v[48:63], v[16:19], v[224:227], v[48:63]
s_waitcnt lgkmcnt(2)
ds_read_b128 v[12:15], v64 offset:36864
v_mfma_f32_32x32x16_bf16 v[48:63], v[20:23], v[228:231], v[48:63]
s_waitcnt lgkmcnt(2)
ds_read_b128 v[16:19], v64 offset:37888
v_mfma_f32_32x32x16_bf16 v[48:63], v[24:27], v[232:235], v[48:63]
s_waitcnt lgkmcnt(2)
ds_read_b128 v[20:23], v64 offset:38912
v_mfma_f32_32x32x16_bf16 v[48:63], v[8:11], v[236:239], v[48:63]
s_waitcnt lgkmcnt(2)
ds_read_b128 v[24:27], v64 offset:39936
v_mfma_f32_32x32x16_bf16 v[48:63], v[12:15], v[240:243], v[48:63]
s_add_u32 s44, s44, 1
s_cmp_eq_u32 s44, 3
s_mov_b32 s56, 40960
s_cmov_b32 s56, -81920
s_cselect_b32 s44, 0, s44
v_add_u32 v64, s56, v64
s_waitcnt vmcnt(10) lgkmcnt(2)
s_barrier
ds_read_b128 v[8:11], v64 offset:0
v_mfma_f32_32x32x16_bf16 v[48:63], v[16:19], v[244:247], v[48:63]
s_waitcnt lgkmcnt(2)
ds_read_b128 v[12:15], v64 offset:1024
v_mfma_f32_32x32x16_bf16 v[48:63], v[20:23], v[248:251], v[48:63]
s_waitcnt lgkmcnt(2)
ds_read_b128 v[16:19], v64 offset:2048
v_mfma_f32_32x32x16_bf16 v[48:63], v[24:27], v[252:255], v[48:63]
s_waitcnt lgkmcnt(2)
ds_read_b128 v[20:23], v64 offset:3072
v_mfma_f32_32x32x16_bf16 v[32:47], v[8:11], v[96:99], 0
s_waitcnt lgkmcnt(2)
ds_read_b128 v[24:27], v64 offset:4096
v_mfma_f32_32x32x16_bf16 v[32:47], v[12:15], v[100:103], v[32:47]
s_waitcnt lgkmcnt(2)
ds_read_b128 v[8:11], v64 offset:5120
v_cvt_pk_bf16_f32 v48, v48, v49
v_cvt_pk_bf16_f32 v49, v50, v51
v_mfma_f32_32x32x16_bf16 v[32:47], v[16:19], v[104:107], v[32:47]
s_waitcnt lgkmcnt(2)
ds_read_b128 v[12:15], v64 offset:6144
v_cvt_pk_bf16_f32 v50, v52, v53
v_cvt_pk_bf16_f32 v51, v54, v55
v_mfma_f32_32x32x16_bf16 v[32:47], v[20:23], v[108:111], v[32:47]
s_waitcnt lgkmcnt(2)
ds_read_b128 v[16:19], v64 offset:7168
v_cvt_pk_bf16_f32 v52, v56, v57
v_cvt_pk_bf16_f32 v53, v58, v59
v_mfma_f32_32x32x16_bf16 v[32:47], v[24:27], v[112:115], v[32:47]
s_waitcnt lgkmcnt(2)
ds_read_b128 v[20:23], v64 offset:8192
v_cvt_pk_bf16_f32 v54, v60, v61
v_cvt_pk_bf16_f32 v55, v62, v63
v_mfma_f32_32x32x16_bf16 v[32:47], v[8:11], v[116:119], v[32:47]
s_waitcnt lgkmcnt(2)
ds_read_b128 v[24:27], v64 offset:9216
v_accvgpr_write_b32 a24, v48
v_accvgpr_write_b32 a25, v49
v_mfma_f32_32x32x16_bf16 v[32:47], v[12:15], v[120:123], v[32:47]
s_waitcnt lgkmcnt(2)
ds_read_b128 v[8:11], v64 offset:10240
v_accvgpr_write_b32 a26, v50
v_accvgpr_write_b32 a27, v51
v_mfma_f32_32x32x16_bf16 v[32:47], v[16:19], v[124:127], v[32:47]
s_waitcnt lgkmcnt(2)
ds_read_b128 v[12:15], v64 offset:11264
v_accvgpr_write_b32 a28, v52
v_accvgpr_write_b32 a29, v53
v_mfma_f32_32x32x16_bf16 v[32:47], v[20:23], v[128:131], v[32:47]
s_waitcnt lgkmcnt(2)
ds_read_b128 v[16:19], v64 offset:12288
v_accvgpr_write_b32 a30, v54
v_accvgpr_write_b32 a31, v55
v_mfma_f32_32x32x16_bf16 v[32:47], v[24:27], v[132:135], v[32:47]
s_waitcnt lgkmcnt(2)
ds_read_b128 v[20:23], v64 offset:13312
s_add_u32 m0, s45, 0
s_add_u32 s55, s46, 0
buffer_load_dwordx4 v0, s[4:7], s55 offen offset:0 sc1 lds
buffer_load_dwordx4 v0, s[4:7], s55 offen offset:1024 sc1 lds
v_mfma_f32_32x32x16_bf16 v[32:47], v[8:11], v[136:139], v[32:47]
s_waitcnt lgkmcnt(2)
ds_read_b128 v[24:27], v64 offset:14336
buffer_load_dwordx4 v0, s[4:7], s55 offen offset:2048 sc1 lds
buffer_load_dwordx4 v0, s[4:7], s55 offen offset:3072 sc1 lds
v_mfma_f32_32x32x16_bf16 v[32:47], v[12:15], v[140:143], v[32:47]
s_waitcnt lgkmcnt(2)
ds_read_b128 v[8:11], v64 offset:15360
s_add_u32 m0, s45, 4096
s_add_u32 s55, s46, 4096
buffer_load_dwordx4 v0, s[4:7], s55 offen offset:0 sc1 lds
buffer_load_dwordx4 v0, s[4:7], s55 offen offset:1024 sc1 lds
v_mfma_f32_32x32x16_bf16 v[32:47], v[16:19], v[144:147], v[32:47]
s_waitcnt lgkmcnt(2)
ds_read_b128 v[12:15], v64 offset:16384
buffer_load_dwordx4 v0, s[4:7], s55 offen offset:2048 sc1 lds
buffer_load_dwordx4 v0, s[4:7], s55 offen offset:3072 sc1 lds
v_mfma_f32_32x32x16_bf16 v[32:47], v[20:23], v[148:151], v[32:47]
s_waitcnt lgkmcnt(2)
ds_read_b128 v[16:19], v64 offset:17408
s_add_u32 m0, s45, 8192
s_add_u32 s55, s46, 8192
buffer_load_dwordx4 v0, s[4:7], s55 offen offset:0 sc1 lds
buffer_load_dwordx4 v0, s[4:7], s55 offen offset:1024 sc1 lds
v_mfma_f32_32x32x16_bf16 v[32:47], v[24:27], v[152:155], v[32:47]
s_waitcnt lgkmcnt(2)
ds_read_b128 v[20:23], v64 offset:18432
s_add_u32 s45, s45, 40960
s_cmp_ge_u32 s45, 122880
s_cselect_b32 s55, 122880, 0
s_sub_u32 s45, s45, s55
s_add_u32 s46, s46, 40960
v_mfma_f32_32x32x16_bf16 v[32:47], v[8:11], v[156:159], v[32:47]
s_waitcnt lgkmcnt(2)
ds_read_b128 v[24:27], v64 offset:19456
v_mfma_f32_32x32x16_bf16 v[32:47], v[12:15], v[160:163], v[32:47]
s_waitcnt lgkmcnt(2)
ds_read_b128 v[8:11], v64 offset:20480
v_mfma_f32_32x32x16_bf16 v[32:47], v[16:19], v[164:167], v[32:47]
s_waitcnt lgkmcnt(2)
ds_read_b128 v[12:15], v64 offset:21504
v_mfma_f32_32x32x16_bf16 v[32:47], v[20:23], v[168:171], v[32:47]
s_waitcnt lgkmcnt(2)
ds_read_b128 v[16:19], v64 offset:22528
v_mfma_f32_32x32x16_bf16 v[32:47], v[24:27], v[172:175], v[32:47]
s_waitcnt lgkmcnt(2)
ds_read_b128 v[20:23], v64 offset:23552
v_mfma_f32_32x32x16_bf16 v[32:47], v[8:11], v[176:179], v[32:47]
s_waitcnt lgkmcnt(2)
ds_read_b128 v[24:27], v64 offset:24576
v_mfma_f32_32x32x16_bf16 v[32:47], v[12:15], v[180:183], v[32:47]
s_waitcnt lgkmcnt(2)
ds_read_b128 v[8:11], v64 offset:25600
v_mfma_f32_32x32x16_bf16 v[32:47], v[16:19], v[184:187], v[32:47]
s_waitcnt lgkmcnt(2)
ds_read_b128 v[12:15], v64 offset:26624
v_mfma_f32_32x32x16_bf16 v[32:47], v[20:23], v[188:191], v[32:47]
s_waitcnt lgkmcnt(2)
ds_read_b128 v[16:19], v64 offset:27648
v_mfma_f32_32x32x16_bf16 v[32:47], v[24:27], v[192:195], v[32:47]
s_waitcnt lgkmcnt(2)
ds_read_b128 v[20:23], v64 offset:28672
v_mfma_f32_32x32x16_bf16 v[32:47], v[8:11], v[196:199], v[32:47]
s_waitcnt lgkmcnt(2)
ds_read_b128 v[24:27], v64 offset:29696
v_mfma_f32_32x32x16_bf16 v[32:47], v[12:15], v[200:203], v[32:47]
s_waitcnt lgkmcnt(2)
ds_read_b128 v[8:11], v64 offset:30720
v_mfma_f32_32x32x16_bf16 v[32:47], v[16:19], v[204:207], v[32:47]
s_waitcnt lgkmcnt(2)
ds_read_b128 v[12:15], v64 offset:31744
v_mfma_f32_32x32x16_bf16 v[32:47], v[20:23], v[208:211], v[32:47]
s_waitcnt lgkmcnt(2)
ds_read_b128 v[16:19], v64 offset:32768
v_mfma_f32_32x32x16_bf16 v[32:47], v[24:27], v[212:215], v[32:47]
s_waitcnt lgkmcnt(2)
ds_read_b128 v[20:23], v64 offset:33792
v_mfma_f32_32x32x16_bf16 v[32:47], v[8:11], v[216:219], v[32:47]
s_waitcnt lgkmcnt(2)
ds_read_b128 v[24:27], v64 offset:34816
v_mfma_f32_32x32x16_bf16 v[32:47], v[12:15], v[220:223], v[32:47]
s_waitcnt lgkmcnt(2)
ds_read_b128 v[8:11], v64 offset:35840
v_mfma_f32_32x32x16_bf16 v[32:47], v[16:19], v[224:227], v[32:47]
s_waitcnt lgkmcnt(2)
ds_read_b128 v[12:15], v64 offset:36864
v_mfma_f32_32x32x16_bf16 v[32:47], v[20:23], v[228:231], v[32:47]
s_waitcnt lgkmcnt(2)
ds_read_b128 v[16:19], v64 offset:37888
v_mfma_f32_32x32x16_bf16 v[32:47], v[24:27], v[232:235], v[32:47]
s_waitcnt lgkmcnt(2)
ds_read_b128 v[20:23], v64 offset:38912
v_mfma_f32_32x32x16_bf16 v[32:47], v[8:11], v[236:239], v[32:47]
s_waitcnt lgkmcnt(2)
ds_read_b128 v[24:27], v64 offset:39936
v_mfma_f32_32x32x16_bf16 v[32:47], v[12:15], v[240:243], v[32:47]
s_add_u32 s44, s44, 1
s_cmp_eq_u32 s44, 3
s_mov_b32 s56, 40960
s_cmov_b32 s56, -81920
s_cselect_b32 s44, 0, s44
v_add_u32 v64, s56, v64
s_waitcnt vmcnt(10) lgkmcnt(2)
s_barrier
ds_read_b128 v[8:11], v64 offset:0
v_mfma_f32_32x32x16_bf16 v[32:47], v[16:19], v[244:247], v[32:47]
s_waitcnt lgkmcnt(2)
ds_read_b128 v[12:15], v64 offset:1024
v_mfma_f32_32x32x16_bf16 v[32:47], v[20:23], v[248:251], v[32:47]
s_waitcnt lgkmcnt(2)
ds_read_b128 v[16:19], v64 offset:2048
v_mfma_f32_32x32x16_bf16 v[32:47], v[24:27], v[252:255], v[32:47]
s_waitcnt lgkmcnt(2)
ds_read_b128 v[20:23], v64 offset:3072
v_mfma_f32_32x32x16_bf16 v[48:63], v[8:11], v[96:99], 0
s_waitcnt lgkmcnt(2)
ds_read_b128 v[24:27], v64 offset:4096
v_mfma_f32_32x32x16_bf16 v[48:63], v[12:15], v[100:103], v[48:63]
s_waitcnt lgkmcnt(2)
ds_read_b128 v[8:11], v64 offset:5120
v_cvt_pk_bf16_f32 v32, v32, v33
v_cvt_pk_bf16_f32 v33, v34, v35
v_mfma_f32_32x32x16_bf16 v[48:63], v[16:19], v[104:107], v[48:63]
s_waitcnt lgkmcnt(2)
ds_read_b128 v[12:15], v64 offset:6144
v_cvt_pk_bf16_f32 v34, v36, v37
v_cvt_pk_bf16_f32 v35, v38, v39
v_mfma_f32_32x32x16_bf16 v[48:63], v[20:23], v[108:111], v[48:63]
s_waitcnt lgkmcnt(2)
ds_read_b128 v[16:19], v64 offset:7168
v_cvt_pk_bf16_f32 v36, v40, v41
v_cvt_pk_bf16_f32 v37, v42, v43
v_mfma_f32_32x32x16_bf16 v[48:63], v[24:27], v[112:115], v[48:63]
s_waitcnt lgkmcnt(2)
ds_read_b128 v[20:23], v64 offset:8192
v_cvt_pk_bf16_f32 v38, v44, v45
v_cvt_pk_bf16_f32 v39, v46, v47
v_mfma_f32_32x32x16_bf16 v[48:63], v[8:11], v[116:119], v[48:63]
s_waitcnt lgkmcnt(2)
ds_read_b128 v[24:27], v64 offset:9216
v_accvgpr_write_b32 a32, v32
v_accvgpr_write_b32 a33, v33
v_mfma_f32_32x32x16_bf16 v[48:63], v[12:15], v[120:123], v[48:63]
s_waitcnt lgkmcnt(2)
ds_read_b128 v[8:11], v64 offset:10240
v_accvgpr_write_b32 a34, v34
v_accvgpr_write_b32 a35, v35
v_mfma_f32_32x32x16_bf16 v[48:63], v[16:19], v[124:127], v[48:63]
s_waitcnt lgkmcnt(2)
ds_read_b128 v[12:15], v64 offset:11264
v_accvgpr_write_b32 a36, v36
v_accvgpr_write_b32 a37, v37
v_mfma_f32_32x32x16_bf16 v[48:63], v[20:23], v[128:131], v[48:63]
s_waitcnt lgkmcnt(2)
ds_read_b128 v[16:19], v64 offset:12288
v_accvgpr_write_b32 a38, v38
v_accvgpr_write_b32 a39, v39
v_mfma_f32_32x32x16_bf16 v[48:63], v[24:27], v[132:135], v[48:63]
s_waitcnt lgkmcnt(2)
ds_read_b128 v[20:23], v64 offset:13312
s_add_u32 m0, s45, 0
s_add_u32 s55, s46, 0
buffer_load_dwordx4 v0, s[4:7], s55 offen offset:0 sc1 lds
buffer_load_dwordx4 v0, s[4:7], s55 offen offset:1024 sc1 lds
v_mfma_f32_32x32x16_bf16 v[48:63], v[8:11], v[136:139], v[48:63]
s_waitcnt lgkmcnt(2)
ds_read_b128 v[24:27], v64 offset:14336
buffer_load_dwordx4 v0, s[4:7], s55 offen offset:2048 sc1 lds
buffer_load_dwordx4 v0, s[4:7], s55 offen offset:3072 sc1 lds
v_mfma_f32_32x32x16_bf16 v[48:63], v[12:15], v[140:143], v[48:63]
s_waitcnt lgkmcnt(2)
ds_read_b128 v[8:11], v64 offset:15360
s_add_u32 m0, s45, 4096
s_add_u32 s55, s46, 4096
buffer_load_dwordx4 v0, s[4:7], s55 offen offset:0 sc1 lds
buffer_load_dwordx4 v0, s[4:7], s55 offen offset:1024 sc1 lds
v_mfma_f32_32x32x16_bf16 v[48:63], v[16:19], v[144:147], v[48:63]
s_waitcnt lgkmcnt(2)
ds_read_b128 v[12:15], v64 offset:16384
buffer_load_dwordx4 v0, s[4:7], s55 offen offset:2048 sc1 lds
buffer_load_dwordx4 v0, s[4:7], s55 offen offset:3072 sc1 lds
v_mfma_f32_32x32x16_bf16 v[48:63], v[20:23], v[148:151], v[48:63]
s_waitcnt lgkmcnt(2)
ds_read_b128 v[16:19], v64 offset:17408
s_add_u32 m0, s45, 8192
s_add_u32 s55, s46, 8192
buffer_load_dwordx4 v0, s[4:7], s55 offen offset:0 sc1 lds
buffer_load_dwordx4 v0, s[4:7], s55 offen offset:1024 sc1 lds
v_mfma_f32_32x32x16_bf16 v[48:63], v[24:27], v[152:155], v[48:63]
s_waitcnt lgkmcnt(2)
ds_read_b128 v[20:23], v64 offset:18432
s_add_u32 s45, s45, 40960
s_cmp_ge_u32 s45, 122880
s_cselect_b32 s55, 122880, 0
s_sub_u32 s45, s45, s55
s_add_u32 s46, s46, 40960
v_mfma_f32_32x32x16_bf16 v[48:63], v[8:11], v[156:159], v[48:63]
s_waitcnt lgkmcnt(2)
ds_read_b128 v[24:27], v64 offset:19456
v_mfma_f32_32x32x16_bf16 v[48:63], v[12:15], v[160:163], v[48:63]
s_waitcnt lgkmcnt(2)
ds_read_b128 v[8:11], v64 offset:20480
v_mfma_f32_32x32x16_bf16 v[48:63], v[16:19], v[164:167], v[48:63]
s_waitcnt lgkmcnt(2)
ds_read_b128 v[12:15], v64 offset:21504
v_mfma_f32_32x32x16_bf16 v[48:63], v[20:23], v[168:171], v[48:63]
s_waitcnt lgkmcnt(2)
ds_read_b128 v[16:19], v64 offset:22528
v_mfma_f32_32x32x16_bf16 v[48:63], v[24:27], v[172:175], v[48:63]
s_waitcnt lgkmcnt(2)
ds_read_b128 v[20:23], v64 offset:23552
v_mfma_f32_32x32x16_bf16 v[48:63], v[8:11], v[176:179], v[48:63]
s_waitcnt lgkmcnt(2)
ds_read_b128 v[24:27], v64 offset:24576
v_mfma_f32_32x32x16_bf16 v[48:63], v[12:15], v[180:183], v[48:63]
s_waitcnt lgkmcnt(2)
ds_read_b128 v[8:11], v64 offset:25600
v_mfma_f32_32x32x16_bf16 v[48:63], v[16:19], v[184:187], v[48:63]
s_waitcnt lgkmcnt(2)
ds_read_b128 v[12:15], v64 offset:26624
v_mfma_f32_32x32x16_bf16 v[48:63], v[20:23], v[188:191], v[48:63]
s_waitcnt lgkmcnt(2)
ds_read_b128 v[16:19], v64 offset:27648
v_mfma_f32_32x32x16_bf16 v[48:63], v[24:27], v[192:195], v[48:63]
s_waitcnt lgkmcnt(2)
ds_read_b128 v[20:23], v64 offset:28672
v_mfma_f32_32x32x16_bf16 v[48:63], v[8:11], v[196:199], v[48:63]
s_waitcnt lgkmcnt(2)
ds_read_b128 v[24:27], v64 offset:29696
v_mfma_f32_32x32x16_bf16 v[48:63], v[12:15], v[200:203], v[48:63]
s_waitcnt lgkmcnt(2)
ds_read_b128 v[8:11], v64 offset:30720
v_mfma_f32_32x32x16_bf16 v[48:63], v[16:19], v[204:207], v[48:63]
s_waitcnt lgkmcnt(2)
ds_read_b128 v[12:15], v64 offset:31744
v_mfma_f32_32x32x16_bf16 v[48:63], v[20:23], v[208:211], v[48:63]
s_waitcnt lgkmcnt(2)
ds_read_b128 v[16:19], v64 offset:32768
v_mfma_f32_32x32x16_bf16 v[48:63], v[24:27], v[212:215], v[48:63]
s_waitcnt lgkmcnt(2)
ds_read_b128 v[20:23], v64 offset:33792
v_mfma_f32_32x32x16_bf16 v[48:63], v[8:11], v[216:219], v[48:63]
s_waitcnt lgkmcnt(2)
ds_read_b128 v[24:27], v64 offset:34816
v_mfma_f32_32x32x16_bf16 v[48:63], v[12:15], v[220:223], v[48:63]
s_waitcnt lgkmcnt(2)
ds_read_b128 v[8:11], v64 offset:35840
v_mfma_f32_32x32x16_bf16 v[48:63], v[16:19], v[224:227], v[48:63]
s_waitcnt lgkmcnt(2)
ds_read_b128 v[12:15], v64 offset:36864
v_mfma_f32_32x32x16_bf16 v[48:63], v[20:23], v[228:231], v[48:63]
s_waitcnt lgkmcnt(2)
ds_read_b128 v[16:19], v64 offset:37888
v_mfma_f32_32x32x16_bf16 v[48:63], v[24:27], v[232:235], v[48:63]
s_waitcnt lgkmcnt(2)
ds_read_b128 v[20:23], v64 offset:38912
v_mfma_f32_32x32x16_bf16 v[48:63], v[8:11], v[236:239], v[48:63]
s_waitcnt lgkmcnt(2)
ds_read_b128 v[24:27], v64 offset:39936
v_mfma_f32_32x32x16_bf16 v[48:63], v[12:15], v[240:243], v[48:63]
s_add_u32 s44, s44, 1
s_cmp_eq_u32 s44, 3
s_mov_b32 s56, 40960
s_cmov_b32 s56, -81920
s_cselect_b32 s44, 0, s44
v_add_u32 v64, s56, v64
s_waitcnt vmcnt(10) lgkmcnt(2)
s_barrier
ds_read_b128 v[8:11], v64 offset:0
v_mfma_f32_32x32x16_bf16 v[48:63], v[16:19], v[244:247], v[48:63]
s_waitcnt lgkmcnt(2)
ds_read_b128 v[12:15], v64 offset:1024
v_mfma_f32_32x32x16_bf16 v[48:63], v[20:23], v[248:251], v[48:63]
s_waitcnt lgkmcnt(2)
ds_read_b128 v[16:19], v64 offset:2048
v_mfma_f32_32x32x16_bf16 v[48:63], v[24:27], v[252:255], v[48:63]
s_waitcnt lgkmcnt(2)
ds_read_b128 v[20:23], v64 offset:3072
v_mfma_f32_32x32x16_bf16 v[32:47], v[8:11], v[96:99], 0
s_waitcnt lgkmcnt(2)
ds_read_b128 v[24:27], v64 offset:4096
v_mfma_f32_32x32x16_bf16 v[32:47], v[12:15], v[100:103], v[32:47]
s_waitcnt lgkmcnt(2)
ds_read_b128 v[8:11], v64 offset:5120
v_cvt_pk_bf16_f32 v48, v48, v49
v_cvt_pk_bf16_f32 v49, v50, v51
v_mfma_f32_32x32x16_bf16 v[32:47], v[16:19], v[104:107], v[32:47]
s_waitcnt lgkmcnt(2)
ds_read_b128 v[12:15], v64 offset:6144
v_cvt_pk_bf16_f32 v50, v52, v53
v_cvt_pk_bf16_f32 v51, v54, v55
v_mfma_f32_32x32x16_bf16 v[32:47], v[20:23], v[108:111], v[32:47]
s_waitcnt lgkmcnt(2)
ds_read_b128 v[16:19], v64 offset:7168
v_cvt_pk_bf16_f32 v52, v56, v57
v_cvt_pk_bf16_f32 v53, v58, v59
v_mfma_f32_32x32x16_bf16 v[32:47], v[24:27], v[112:115], v[32:47]
s_waitcnt lgkmcnt(2)
ds_read_b128 v[20:23], v64 offset:8192
v_cvt_pk_bf16_f32 v54, v60, v61
v_cvt_pk_bf16_f32 v55, v62, v63
v_mfma_f32_32x32x16_bf16 v[32:47], v[8:11], v[116:119], v[32:47]
s_waitcnt lgkmcnt(2)
ds_read_b128 v[24:27], v64 offset:9216
v_accvgpr_write_b32 a40, v48
v_accvgpr_write_b32 a41, v49
v_mfma_f32_32x32x16_bf16 v[32:47], v[12:15], v[120:123], v[32:47]
s_waitcnt lgkmcnt(2)
ds_read_b128 v[8:11], v64 offset:10240
v_accvgpr_write_b32 a42, v50
v_accvgpr_write_b32 a43, v51
v_mfma_f32_32x32x16_bf16 v[32:47], v[16:19], v[124:127], v[32:47]
s_waitcnt lgkmcnt(2)
ds_read_b128 v[12:15], v64 offset:11264
v_accvgpr_write_b32 a44, v52
v_accvgpr_write_b32 a45, v53
v_mfma_f32_32x32x16_bf16 v[32:47], v[20:23], v[128:131], v[32:47]
s_waitcnt lgkmcnt(2)
ds_read_b128 v[16:19], v64 offset:12288
v_accvgpr_write_b32 a46, v54
v_accvgpr_write_b32 a47, v55
v_mfma_f32_32x32x16_bf16 v[32:47], v[24:27], v[132:135], v[32:47]
s_waitcnt lgkmcnt(2)
ds_read_b128 v[20:23], v64 offset:13312
s_add_u32 m0, s45, 0
s_add_u32 s55, s46, 0
buffer_load_dwordx4 v0, s[4:7], s55 offen offset:0 sc1 lds
buffer_load_dwordx4 v0, s[4:7], s55 offen offset:1024 sc1 lds
v_mfma_f32_32x32x16_bf16 v[32:47], v[8:11], v[136:139], v[32:47]
s_waitcnt lgkmcnt(2)
ds_read_b128 v[24:27], v64 offset:14336
buffer_load_dwordx4 v0, s[4:7], s55 offen offset:2048 sc1 lds
buffer_load_dwordx4 v0, s[4:7], s55 offen offset:3072 sc1 lds
v_mfma_f32_32x32x16_bf16 v[32:47], v[12:15], v[140:143], v[32:47]
s_waitcnt lgkmcnt(2)
ds_read_b128 v[8:11], v64 offset:15360
s_add_u32 m0, s45, 4096
s_add_u32 s55, s46, 4096
buffer_load_dwordx4 v0, s[4:7], s55 offen offset:0 sc1 lds
buffer_load_dwordx4 v0, s[4:7], s55 offen offset:1024 sc1 lds
v_mfma_f32_32x32x16_bf16 v[32:47], v[16:19], v[144:147], v[32:47]
s_waitcnt lgkmcnt(2)
ds_read_b128 v[12:15], v64 offset:16384
buffer_load_dwordx4 v0, s[4:7], s55 offen offset:2048 sc1 lds
buffer_load_dwordx4 v0, s[4:7], s55 offen offset:3072 sc1 lds
v_mfma_f32_32x32x16_bf16 v[32:47], v[20:23], v[148:151], v[32:47]
s_waitcnt lgkmcnt(2)
ds_read_b128 v[16:19], v64 offset:17408
s_add_u32 m0, s45, 8192
s_add_u32 s55, s46, 8192
buffer_load_dwordx4 v0, s[4:7], s55 offen offset:0 sc1 lds
buffer_load_dwordx4 v0, s[4:7], s55 offen offset:1024 sc1 lds
v_mfma_f32_32x32x16_bf16 v[32:47], v[24:27], v[152:155], v[32:47]
s_waitcnt lgkmcnt(2)
ds_read_b128 v[20:23], v64 offset:18432
s_add_u32 s45, s45, 40960
s_cmp_ge_u32 s45, 122880
s_cselect_b32 s55, 122880, 0
s_sub_u32 s45, s45, s55
s_add_u32 s46, s46, 40960
v_mfma_f32_32x32x16_bf16 v[32:47], v[8:11], v[156:159], v[32:47]
s_waitcnt lgkmcnt(2)
ds_read_b128 v[24:27], v64 offset:19456
v_mfma_f32_32x32x16_bf16 v[32:47], v[12:15], v[160:163], v[32:47]
s_waitcnt lgkmcnt(2)
ds_read_b128 v[8:11], v64 offset:20480
v_mfma_f32_32x32x16_bf16 v[32:47], v[16:19], v[164:167], v[32:47]
s_waitcnt lgkmcnt(2)
ds_read_b128 v[12:15], v64 offset:21504
v_mfma_f32_32x32x16_bf16 v[32:47], v[20:23], v[168:171], v[32:47]
s_waitcnt lgkmcnt(2)
ds_read_b128 v[16:19], v64 offset:22528
v_mfma_f32_32x32x16_bf16 v[32:47], v[24:27], v[172:175], v[32:47]
s_waitcnt lgkmcnt(2)
ds_read_b128 v[20:23], v64 offset:23552
v_mfma_f32_32x32x16_bf16 v[32:47], v[8:11], v[176:179], v[32:47]
s_waitcnt lgkmcnt(2)
ds_read_b128 v[24:27], v64 offset:24576
v_mfma_f32_32x32x16_bf16 v[32:47], v[12:15], v[180:183], v[32:47]
s_waitcnt lgkmcnt(2)
ds_read_b128 v[8:11], v64 offset:25600
v_mfma_f32_32x32x16_bf16 v[32:47], v[16:19], v[184:187], v[32:47]
s_waitcnt lgkmcnt(2)
ds_read_b128 v[12:15], v64 offset:26624
v_mfma_f32_32x32x16_bf16 v[32:47], v[20:23], v[188:191], v[32:47]
s_waitcnt lgkmcnt(2)
ds_read_b128 v[16:19], v64 offset:27648
v_mfma_f32_32x32x16_bf16 v[32:47], v[24:27], v[192:195], v[32:47]
s_waitcnt lgkmcnt(2)
ds_read_b128 v[20:23], v64 offset:28672
v_mfma_f32_32x32x16_bf16 v[32:47], v[8:11], v[196:199], v[32:47]
s_waitcnt lgkmcnt(2)
ds_read_b128 v[24:27], v64 offset:29696
v_mfma_f32_32x32x16_bf16 v[32:47], v[12:15], v[200:203], v[32:47]
s_waitcnt lgkmcnt(2)
ds_read_b128 v[8:11], v64 offset:30720
v_mfma_f32_32x32x16_bf16 v[32:47], v[16:19], v[204:207], v[32:47]
s_waitcnt lgkmcnt(2)
ds_read_b128 v[12:15], v64 offset:31744
v_mfma_f32_32x32x16_bf16 v[32:47], v[20:23], v[208:211], v[32:47]
s_waitcnt lgkmcnt(2)
ds_read_b128 v[16:19], v64 offset:32768
v_mfma_f32_32x32x16_bf16 v[32:47], v[24:27], v[212:215], v[32:47]
s_waitcnt lgkmcnt(2)
ds_read_b128 v[20:23], v64 offset:33792
v_mfma_f32_32x32x16_bf16 v[32:47], v[8:11], v[216:219], v[32:47]
s_waitcnt lgkmcnt(2)
ds_read_b128 v[24:27], v64 offset:34816
v_mfma_f32_32x32x16_bf16 v[32:47], v[12:15], v[220:223], v[32:47]
s_waitcnt lgkmcnt(2)
ds_read_b128 v[8:11], v64 offset:35840
v_mfma_f32_32x32x16_bf16 v[32:47], v[16:19], v[224:227], v[32:47]
s_waitcnt lgkmcnt(2)
ds_read_b128 v[12:15], v64 offset:36864
v_mfma_f32_32x32x16_bf16 v[32:47], v[20:23], v[228:231], v[32:47]
s_waitcnt lgkmcnt(2)
ds_read_b128 v[16:19], v64 offset:37888
v_mfma_f32_32x32x16_bf16 v[32:47], v[24:27], v[232:235], v[32:47]
s_waitcnt lgkmcnt(2)
ds_read_b128 v[20:23], v64 offset:38912
v_mfma_f32_32x32x16_bf16 v[32:47], v[8:11], v[236:239], v[32:47]
s_waitcnt lgkmcnt(2)
ds_read_b128 v[24:27], v64 offset:39936
v_mfma_f32_32x32x16_bf16 v[32:47], v[12:15], v[240:243], v[32:47]
s_add_u32 s44, s44, 1
s_cmp_eq_u32 s44, 3
s_mov_b32 s56, 40960
s_cmov_b32 s56, -81920
s_cselect_b32 s44, 0, s44
v_add_u32 v64, s56, v64
s_waitcnt vmcnt(10) lgkmcnt(2)
s_barrier
ds_read_b128 v[8:11], v64 offset:0
v_mfma_f32_32x32x16_bf16 v[32:47], v[16:19], v[244:247], v[32:47]
s_waitcnt lgkmcnt(2)
ds_read_b128 v[12:15], v64 offset:1024
v_mfma_f32_32x32x16_bf16 v[32:47], v[20:23], v[248:251], v[32:47]
s_waitcnt lgkmcnt(2)
ds_read_b128 v[16:19], v64 offset:2048
v_mfma_f32_32x32x16_bf16 v[32:47], v[24:27], v[252:255], v[32:47]
s_waitcnt lgkmcnt(2)
ds_read_b128 v[20:23], v64 offset:3072
v_mfma_f32_32x32x16_bf16 v[48:63], v[8:11], v[96:99], 0
s_waitcnt lgkmcnt(2)
ds_read_b128 v[24:27], v64 offset:4096
v_mfma_f32_32x32x16_bf16 v[48:63], v[12:15], v[100:103], v[48:63]
s_waitcnt lgkmcnt(2)
ds_read_b128 v[8:11], v64 offset:5120
v_cvt_pk_bf16_f32 v32, v32, v33
v_cvt_pk_bf16_f32 v33, v34, v35
v_mfma_f32_32x32x16_bf16 v[48:63], v[16:19], v[104:107], v[48:63]
s_waitcnt lgkmcnt(2)
ds_read_b128 v[12:15], v64 offset:6144
v_cvt_pk_bf16_f32 v34, v36, v37
v_cvt_pk_bf16_f32 v35, v38, v39
v_mfma_f32_32x32x16_bf16 v[48:63], v[20:23], v[108:111], v[48:63]
s_waitcnt lgkmcnt(2)
ds_read_b128 v[16:19], v64 offset:7168
v_cvt_pk_bf16_f32 v36, v40, v41
v_cvt_pk_bf16_f32 v37, v42, v43
v_mfma_f32_32x32x16_bf16 v[48:63], v[24:27], v[112:115], v[48:63]
s_waitcnt lgkmcnt(2)
ds_read_b128 v[20:23], v64 offset:8192
v_cvt_pk_bf16_f32 v38, v44, v45
v_cvt_pk_bf16_f32 v39, v46, v47
v_mfma_f32_32x32x16_bf16 v[48:63], v[8:11], v[116:119], v[48:63]
s_waitcnt lgkmcnt(2)
ds_read_b128 v[24:27], v64 offset:9216
v_accvgpr_write_b32 a48, v32
v_accvgpr_write_b32 a49, v33
v_mfma_f32_32x32x16_bf16 v[48:63], v[12:15], v[120:123], v[48:63]
s_waitcnt lgkmcnt(2)
ds_read_b128 v[8:11], v64 offset:10240
v_accvgpr_write_b32 a50, v34
v_accvgpr_write_b32 a51, v35
v_mfma_f32_32x32x16_bf16 v[48:63], v[16:19], v[124:127], v[48:63]
s_waitcnt lgkmcnt(2)
ds_read_b128 v[12:15], v64 offset:11264
v_accvgpr_write_b32 a52, v36
v_accvgpr_write_b32 a53, v37
v_mfma_f32_32x32x16_bf16 v[48:63], v[20:23], v[128:131], v[48:63]
s_waitcnt lgkmcnt(2)
ds_read_b128 v[16:19], v64 offset:12288
v_accvgpr_write_b32 a54, v38
v_accvgpr_write_b32 a55, v39
v_mfma_f32_32x32x16_bf16 v[48:63], v[24:27], v[132:135], v[48:63]
s_waitcnt lgkmcnt(2)
ds_read_b128 v[20:23], v64 offset:13312
s_add_u32 m0, s45, 0
s_add_u32 s55, s46, 0
buffer_load_dwordx4 v0, s[4:7], s55 offen offset:0 sc1 lds
buffer_load_dwordx4 v0, s[4:7], s55 offen offset:1024 sc1 lds
v_mfma_f32_32x32x16_bf16 v[48:63], v[8:11], v[136:139], v[48:63]
s_waitcnt lgkmcnt(2)
ds_read_b128 v[24:27], v64 offset:14336
buffer_load_dwordx4 v0, s[4:7], s55 offen offset:2048 sc1 lds
buffer_load_dwordx4 v0, s[4:7], s55 offen offset:3072 sc1 lds
v_mfma_f32_32x32x16_bf16 v[48:63], v[12:15], v[140:143], v[48:63]
s_waitcnt lgkmcnt(2)
ds_read_b128 v[8:11], v64 offset:15360
s_add_u32 m0, s45, 4096
s_add_u32 s55, s46, 4096
buffer_load_dwordx4 v0, s[4:7], s55 offen offset:0 sc1 lds
buffer_load_dwordx4 v0, s[4:7], s55 offen offset:1024 sc1 lds
v_mfma_f32_32x32x16_bf16 v[48:63], v[16:19], v[144:147], v[48:63]
s_waitcnt lgkmcnt(2)
ds_read_b128 v[12:15], v64 offset:16384
buffer_load_dwordx4 v0, s[4:7], s55 offen offset:2048 sc1 lds
buffer_load_dwordx4 v0, s[4:7], s55 offen offset:3072 sc1 lds
v_mfma_f32_32x32x16_bf16 v[48:63], v[20:23], v[148:151], v[48:63]
s_waitcnt lgkmcnt(2)
ds_read_b128 v[16:19], v64 offset:17408
s_add_u32 m0, s45, 8192
s_add_u32 s55, s46, 8192
buffer_load_dwordx4 v0, s[4:7], s55 offen offset:0 sc1 lds
buffer_load_dwordx4 v0, s[4:7], s55 offen offset:1024 sc1 lds
v_mfma_f32_32x32x16_bf16 v[48:63], v[24:27], v[152:155], v[48:63]
s_waitcnt lgkmcnt(2)
ds_read_b128 v[20:23], v64 offset:18432
s_add_u32 s45, s45, 40960
s_cmp_ge_u32 s45, 122880
s_cselect_b32 s55, 122880, 0
s_sub_u32 s45, s45, s55
s_add_u32 s46, s46, 40960
v_mfma_f32_32x32x16_bf16 v[48:63], v[8:11], v[156:159], v[48:63]
s_waitcnt lgkmcnt(2)
ds_read_b128 v[24:27], v64 offset:19456
v_mfma_f32_32x32x16_bf16 v[48:63], v[12:15], v[160:163], v[48:63]
s_waitcnt lgkmcnt(2)
ds_read_b128 v[8:11], v64 offset:20480
v_mfma_f32_32x32x16_bf16 v[48:63], v[16:19], v[164:167], v[48:63]
s_waitcnt lgkmcnt(2)
ds_read_b128 v[12:15], v64 offset:21504
v_mfma_f32_32x32x16_bf16 v[48:63], v[20:23], v[168:171], v[48:63]
s_waitcnt lgkmcnt(2)
ds_read_b128 v[16:19], v64 offset:22528
v_mfma_f32_32x32x16_bf16 v[48:63], v[24:27], v[172:175], v[48:63]
s_waitcnt lgkmcnt(2)
ds_read_b128 v[20:23], v64 offset:23552
v_mfma_f32_32x32x16_bf16 v[48:63], v[8:11], v[176:179], v[48:63]
s_waitcnt lgkmcnt(2)
ds_read_b128 v[24:27], v64 offset:24576
v_mfma_f32_32x32x16_bf16 v[48:63], v[12:15], v[180:183], v[48:63]
s_waitcnt lgkmcnt(2)
ds_read_b128 v[8:11], v64 offset:25600
v_mfma_f32_32x32x16_bf16 v[48:63], v[16:19], v[184:187], v[48:63]
s_waitcnt lgkmcnt(2)
ds_read_b128 v[12:15], v64 offset:26624
v_mfma_f32_32x32x16_bf16 v[48:63], v[20:23], v[188:191], v[48:63]
s_waitcnt lgkmcnt(2)
ds_read_b128 v[16:19], v64 offset:27648
v_mfma_f32_32x32x16_bf16 v[48:63], v[24:27], v[192:195], v[48:63]
s_waitcnt lgkmcnt(2)
ds_read_b128 v[20:23], v64 offset:28672
v_mfma_f32_32x32x16_bf16 v[48:63], v[8:11], v[196:199], v[48:63]
s_waitcnt lgkmcnt(2)
ds_read_b128 v[24:27], v64 offset:29696
v_mfma_f32_32x32x16_bf16 v[48:63], v[12:15], v[200:203], v[48:63]
s_waitcnt lgkmcnt(2)
ds_read_b128 v[8:11], v64 offset:30720
v_mfma_f32_32x32x16_bf16 v[48:63], v[16:19], v[204:207], v[48:63]
s_waitcnt lgkmcnt(2)
ds_read_b128 v[12:15], v64 offset:31744
v_mfma_f32_32x32x16_bf16 v[48:63], v[20:23], v[208:211], v[48:63]
s_waitcnt lgkmcnt(2)
ds_read_b128 v[16:19], v64 offset:32768
v_mfma_f32_32x32x16_bf16 v[48:63], v[24:27], v[212:215], v[48:63]
s_waitcnt lgkmcnt(2)
ds_read_b128 v[20:23], v64 offset:33792
v_mfma_f32_32x32x16_bf16 v[48:63], v[8:11], v[216:219], v[48:63]
s_waitcnt lgkmcnt(2)
ds_read_b128 v[24:27], v64 offset:34816
v_mfma_f32_32x32x16_bf16 v[48:63], v[12:15], v[220:223], v[48:63]
s_waitcnt lgkmcnt(2)
ds_read_b128 v[8:11], v64 offset:35840
v_mfma_f32_32x32x16_bf16 v[48:63], v[16:19], v[224:227], v[48:63]
s_waitcnt lgkmcnt(2)
ds_read_b128 v[12:15], v64 offset:36864
v_mfma_f32_32x32x16_bf16 v[48:63], v[20:23], v[228:231], v[48:63]
s_waitcnt lgkmcnt(2)
ds_read_b128 v[16:19], v64 offset:37888
v_mfma_f32_32x32x16_bf16 v[48:63], v[24:27], v[232:235], v[48:63]
s_waitcnt lgkmcnt(2)
ds_read_b128 v[20:23], v64 offset:38912
v_mfma_f32_32x32x16_bf16 v[48:63], v[8:11], v[236:239], v[48:63]
s_waitcnt lgkmcnt(2)
ds_read_b128 v[24:27], v64 offset:39936
v_mfma_f32_32x32x16_bf16 v[48:63], v[12:15], v[240:243], v[48:63]
s_add_u32 s44, s44, 1
s_cmp_eq_u32 s44, 3
s_mov_b32 s56, 40960
s_cmov_b32 s56, -81920
s_cselect_b32 s44, 0, s44
v_add_u32 v64, s56, v64
s_waitcnt vmcnt(10) lgkmcnt(2)
s_barrier
ds_read_b128 v[8:11], v64 offset:0
v_mfma_f32_32x32x16_bf16 v[48:63], v[16:19], v[244:247], v[48:63]
s_waitcnt lgkmcnt(2)
ds_read_b128 v[12:15], v64 offset:1024
v_mfma_f32_32x32x16_bf16 v[48:63], v[20:23], v[248:251], v[48:63]
s_waitcnt lgkmcnt(2)
ds_read_b128 v[16:19], v64 offset:2048
v_mfma_f32_32x32x16_bf16 v[48:63], v[24:27], v[252:255], v[48:63]
s_waitcnt lgkmcnt(2)
ds_read_b128 v[20:23], v64 offset:3072
v_mfma_f32_32x32x16_bf16 v[32:47], v[8:11], v[96:99], 0
s_waitcnt lgkmcnt(2)
ds_read_b128 v[24:27], v64 offset:4096
v_mfma_f32_32x32x16_bf16 v[32:47], v[12:15], v[100:103], v[32:47]
s_waitcnt lgkmcnt(2)
ds_read_b128 v[8:11], v64 offset:5120
v_cvt_pk_bf16_f32 v48, v48, v49
v_cvt_pk_bf16_f32 v49, v50, v51
v_mfma_f32_32x32x16_bf16 v[32:47], v[16:19], v[104:107], v[32:47]
s_waitcnt lgkmcnt(2)
ds_read_b128 v[12:15], v64 offset:6144
v_cvt_pk_bf16_f32 v50, v52, v53
v_cvt_pk_bf16_f32 v51, v54, v55
v_mfma_f32_32x32x16_bf16 v[32:47], v[20:23], v[108:111], v[32:47]
s_waitcnt lgkmcnt(2)
ds_read_b128 v[16:19], v64 offset:7168
v_cvt_pk_bf16_f32 v52, v56, v57
v_cvt_pk_bf16_f32 v53, v58, v59
v_mfma_f32_32x32x16_bf16 v[32:47], v[24:27], v[112:115], v[32:47]
s_waitcnt lgkmcnt(2)
ds_read_b128 v[20:23], v64 offset:8192
v_cvt_pk_bf16_f32 v54, v60, v61
v_cvt_pk_bf16_f32 v55, v62, v63
v_mfma_f32_32x32x16_bf16 v[32:47], v[8:11], v[116:119], v[32:47]
s_waitcnt lgkmcnt(2)
ds_read_b128 v[24:27], v64 offset:9216
v_accvgpr_write_b32 a56, v48
v_accvgpr_write_b32 a57, v49
v_mfma_f32_32x32x16_bf16 v[32:47], v[12:15], v[120:123], v[32:47]
s_waitcnt lgkmcnt(2)
ds_read_b128 v[8:11], v64 offset:10240
v_accvgpr_write_b32 a58, v50
v_accvgpr_write_b32 a59, v51
v_mfma_f32_32x32x16_bf16 v[32:47], v[16:19], v[124:127], v[32:47]
s_waitcnt lgkmcnt(2)
ds_read_b128 v[12:15], v64 offset:11264
v_accvgpr_write_b32 a60, v52
v_accvgpr_write_b32 a61, v53
v_mfma_f32_32x32x16_bf16 v[32:47], v[20:23], v[128:131], v[32:47]
s_waitcnt lgkmcnt(2)
ds_read_b128 v[16:19], v64 offset:12288
v_accvgpr_write_b32 a62, v54
v_accvgpr_write_b32 a63, v55
v_mfma_f32_32x32x16_bf16 v[32:47], v[24:27], v[132:135], v[32:47]
s_waitcnt lgkmcnt(2)
ds_read_b128 v[20:23], v64 offset:13312
s_add_u32 m0, s45, 0
s_add_u32 s55, s46, 0
buffer_load_dwordx4 v0, s[4:7], s55 offen offset:0 sc1 lds
buffer_load_dwordx4 v0, s[4:7], s55 offen offset:1024 sc1 lds
v_mfma_f32_32x32x16_bf16 v[32:47], v[8:11], v[136:139], v[32:47]
s_waitcnt lgkmcnt(2)
ds_read_b128 v[24:27], v64 offset:14336
buffer_load_dwordx4 v0, s[4:7], s55 offen offset:2048 sc1 lds
buffer_load_dwordx4 v0, s[4:7], s55 offen offset:3072 sc1 lds
v_mfma_f32_32x32x16_bf16 v[32:47], v[12:15], v[140:143], v[32:47]
s_waitcnt lgkmcnt(2)
ds_read_b128 v[8:11], v64 offset:15360
s_add_u32 m0, s45, 4096
s_add_u32 s55, s46, 4096
buffer_load_dwordx4 v0, s[4:7], s55 offen offset:0 sc1 lds
buffer_load_dwordx4 v0, s[4:7], s55 offen offset:1024 sc1 lds
v_mfma_f32_32x32x16_bf16 v[32:47], v[16:19], v[144:147], v[32:47]
s_waitcnt lgkmcnt(2)
ds_read_b128 v[12:15], v64 offset:16384
buffer_load_dwordx4 v0, s[4:7], s55 offen offset:2048 sc1 lds
buffer_load_dwordx4 v0, s[4:7], s55 offen offset:3072 sc1 lds
v_mfma_f32_32x32x16_bf16 v[32:47], v[20:23], v[148:151], v[32:47]
s_waitcnt lgkmcnt(2)
ds_read_b128 v[16:19], v64 offset:17408
s_add_u32 m0, s45, 8192
s_add_u32 s55, s46, 8192
buffer_load_dwordx4 v0, s[4:7], s55 offen offset:0 sc1 lds
buffer_load_dwordx4 v0, s[4:7], s55 offen offset:1024 sc1 lds
v_mfma_f32_32x32x16_bf16 v[32:47], v[24:27], v[152:155], v[32:47]
s_waitcnt lgkmcnt(2)
ds_read_b128 v[20:23], v64 offset:18432
s_add_u32 s45, s45, 40960
s_cmp_ge_u32 s45, 122880
s_cselect_b32 s55, 122880, 0
s_sub_u32 s45, s45, s55
s_add_u32 s46, s46, 40960
v_mfma_f32_32x32x16_bf16 v[32:47], v[8:11], v[156:159], v[32:47]
s_waitcnt lgkmcnt(2)
ds_read_b128 v[24:27], v64 offset:19456
v_mfma_f32_32x32x16_bf16 v[32:47], v[12:15], v[160:163], v[32:47]
s_waitcnt lgkmcnt(2)
ds_read_b128 v[8:11], v64 offset:20480
v_mfma_f32_32x32x16_bf16 v[32:47], v[16:19], v[164:167], v[32:47]
s_waitcnt lgkmcnt(2)
ds_read_b128 v[12:15], v64 offset:21504
v_mfma_f32_32x32x16_bf16 v[32:47], v[20:23], v[168:171], v[32:47]
s_waitcnt lgkmcnt(2)
ds_read_b128 v[16:19], v64 offset:22528
v_mfma_f32_32x32x16_bf16 v[32:47], v[24:27], v[172:175], v[32:47]
s_waitcnt lgkmcnt(2)
ds_read_b128 v[20:23], v64 offset:23552
v_mfma_f32_32x32x16_bf16 v[32:47], v[8:11], v[176:179], v[32:47]
s_waitcnt lgkmcnt(2)
ds_read_b128 v[24:27], v64 offset:24576
v_mfma_f32_32x32x16_bf16 v[32:47], v[12:15], v[180:183], v[32:47]
s_waitcnt lgkmcnt(2)
ds_read_b128 v[8:11], v64 offset:25600
v_mfma_f32_32x32x16_bf16 v[32:47], v[16:19], v[184:187], v[32:47]
s_waitcnt lgkmcnt(2)
ds_read_b128 v[12:15], v64 offset:26624
v_mfma_f32_32x32x16_bf16 v[32:47], v[20:23], v[188:191], v[32:47]
s_waitcnt lgkmcnt(2)
ds_read_b128 v[16:19], v64 offset:27648
v_mfma_f32_32x32x16_bf16 v[32:47], v[24:27], v[192:195], v[32:47]
s_waitcnt lgkmcnt(2)
ds_read_b128 v[20:23], v64 offset:28672
v_mfma_f32_32x32x16_bf16 v[32:47], v[8:11], v[196:199], v[32:47]
s_waitcnt lgkmcnt(2)
ds_read_b128 v[24:27], v64 offset:29696
v_mfma_f32_32x32x16_bf16 v[32:47], v[12:15], v[200:203], v[32:47]
s_waitcnt lgkmcnt(2)
ds_read_b128 v[8:11], v64 offset:30720
v_mfma_f32_32x32x16_bf16 v[32:47], v[16:19], v[204:207], v[32:47]
s_waitcnt lgkmcnt(2)
ds_read_b128 v[12:15], v64 offset:31744
v_mfma_f32_32x32x16_bf16 v[32:47], v[20:23], v[208:211], v[32:47]
s_waitcnt lgkmcnt(2)
ds_read_b128 v[16:19], v64 offset:32768
v_mfma_f32_32x32x16_bf16 v[32:47], v[24:27], v[212:215], v[32:47]
s_waitcnt lgkmcnt(2)
ds_read_b128 v[20:23], v64 offset:33792
v_mfma_f32_32x32x16_bf16 v[32:47], v[8:11], v[216:219], v[32:47]
s_waitcnt lgkmcnt(2)
ds_read_b128 v[24:27], v64 offset:34816
v_mfma_f32_32x32x16_bf16 v[32:47], v[12:15], v[220:223], v[32:47]
s_waitcnt lgkmcnt(2)
ds_read_b128 v[8:11], v64 offset:35840
v_mfma_f32_32x32x16_bf16 v[32:47], v[16:19], v[224:227], v[32:47]
s_waitcnt lgkmcnt(2)
ds_read_b128 v[12:15], v64 offset:36864
v_mfma_f32_32x32x16_bf16 v[32:47], v[20:23], v[228:231], v[32:47]
s_waitcnt lgkmcnt(2)
ds_read_b128 v[16:19], v64 offset:37888
v_mfma_f32_32x32x16_bf16 v[32:47], v[24:27], v[232:235], v[32:47]
s_waitcnt lgkmcnt(2)
ds_read_b128 v[20:23], v64 offset:38912
v_mfma_f32_32x32x16_bf16 v[32:47], v[8:11], v[236:239], v[32:47]
s_waitcnt lgkmcnt(2)
ds_read_b128 v[24:27], v64 offset:39936
v_mfma_f32_32x32x16_bf16 v[32:47], v[12:15], v[240:243], v[32:47]
s_add_u32 s44, s44, 1
s_cmp_eq_u32 s44, 3
s_mov_b32 s56, 40960
s_cmov_b32 s56, -81920
s_cselect_b32 s44, 0, s44
v_add_u32 v64, s56, v64
s_waitcnt vmcnt(10) lgkmcnt(2)
s_barrier
ds_read_b128 v[8:11], v64 offset:0
v_mfma_f32_32x32x16_bf16 v[32:47], v[16:19], v[244:247], v[32:47]
s_waitcnt lgkmcnt(2)
ds_read_b128 v[12:15], v64 offset:1024
v_mfma_f32_32x32x16_bf16 v[32:47], v[20:23], v[248:251], v[32:47]
s_waitcnt lgkmcnt(2)
ds_read_b128 v[16:19], v64 offset:2048
v_mfma_f32_32x32x16_bf16 v[32:47], v[24:27], v[252:255], v[32:47]
s_waitcnt lgkmcnt(2)
ds_read_b128 v[20:23], v64 offset:3072
v_mfma_f32_32x32x16_bf16 v[48:63], v[8:11], v[96:99], 0
s_waitcnt lgkmcnt(2)
ds_read_b128 v[24:27], v64 offset:4096
v_mfma_f32_32x32x16_bf16 v[48:63], v[12:15], v[100:103], v[48:63]
s_waitcnt lgkmcnt(2)
ds_read_b128 v[8:11], v64 offset:5120
v_cvt_pk_bf16_f32 v32, v32, v33
v_cvt_pk_bf16_f32 v33, v34, v35
v_mfma_f32_32x32x16_bf16 v[48:63], v[16:19], v[104:107], v[48:63]
s_waitcnt lgkmcnt(2)
ds_read_b128 v[12:15], v64 offset:6144
v_cvt_pk_bf16_f32 v34, v36, v37
v_cvt_pk_bf16_f32 v35, v38, v39
v_mfma_f32_32x32x16_bf16 v[48:63], v[20:23], v[108:111], v[48:63]
s_waitcnt lgkmcnt(2)
ds_read_b128 v[16:19], v64 offset:7168
v_cvt_pk_bf16_f32 v36, v40, v41
v_cvt_pk_bf16_f32 v37, v42, v43
v_mfma_f32_32x32x16_bf16 v[48:63], v[24:27], v[112:115], v[48:63]
s_waitcnt lgkmcnt(2)
ds_read_b128 v[20:23], v64 offset:8192
v_cvt_pk_bf16_f32 v38, v44, v45
v_cvt_pk_bf16_f32 v39, v46, v47
v_mfma_f32_32x32x16_bf16 v[48:63], v[8:11], v[116:119], v[48:63]
s_waitcnt lgkmcnt(2)
ds_read_b128 v[24:27], v64 offset:9216
v_accvgpr_write_b32 a64, v32
v_accvgpr_write_b32 a65, v33
v_mfma_f32_32x32x16_bf16 v[48:63], v[12:15], v[120:123], v[48:63]
s_waitcnt lgkmcnt(2)
ds_read_b128 v[8:11], v64 offset:10240
v_accvgpr_write_b32 a66, v34
v_accvgpr_write_b32 a67, v35
v_mfma_f32_32x32x16_bf16 v[48:63], v[16:19], v[124:127], v[48:63]
s_waitcnt lgkmcnt(2)
ds_read_b128 v[12:15], v64 offset:11264
v_accvgpr_write_b32 a68, v36
v_accvgpr_write_b32 a69, v37
v_mfma_f32_32x32x16_bf16 v[48:63], v[20:23], v[128:131], v[48:63]
s_waitcnt lgkmcnt(2)
ds_read_b128 v[16:19], v64 offset:12288
v_accvgpr_write_b32 a70, v38
v_accvgpr_write_b32 a71, v39
v_mfma_f32_32x32x16_bf16 v[48:63], v[24:27], v[132:135], v[48:63]
s_waitcnt lgkmcnt(2)
ds_read_b128 v[20:23], v64 offset:13312
s_add_u32 m0, s45, 0
s_add_u32 s55, s46, 0
buffer_load_dwordx4 v0, s[4:7], s55 offen offset:0 sc1 lds
buffer_load_dwordx4 v0, s[4:7], s55 offen offset:1024 sc1 lds
v_mfma_f32_32x32x16_bf16 v[48:63], v[8:11], v[136:139], v[48:63]
s_waitcnt lgkmcnt(2)
ds_read_b128 v[24:27], v64 offset:14336
buffer_load_dwordx4 v0, s[4:7], s55 offen offset:2048 sc1 lds
buffer_load_dwordx4 v0, s[4:7], s55 offen offset:3072 sc1 lds
v_mfma_f32_32x32x16_bf16 v[48:63], v[12:15], v[140:143], v[48:63]
s_waitcnt lgkmcnt(2)
ds_read_b128 v[8:11], v64 offset:15360
s_add_u32 m0, s45, 4096
s_add_u32 s55, s46, 4096
buffer_load_dwordx4 v0, s[4:7], s55 offen offset:0 sc1 lds
buffer_load_dwordx4 v0, s[4:7], s55 offen offset:1024 sc1 lds
v_mfma_f32_32x32x16_bf16 v[48:63], v[16:19], v[144:147], v[48:63]
s_waitcnt lgkmcnt(2)
ds_read_b128 v[12:15], v64 offset:16384
buffer_load_dwordx4 v0, s[4:7], s55 offen offset:2048 sc1 lds
buffer_load_dwordx4 v0, s[4:7], s55 offen offset:3072 sc1 lds
v_mfma_f32_32x32x16_bf16 v[48:63], v[20:23], v[148:151], v[48:63]
s_waitcnt lgkmcnt(2)
ds_read_b128 v[16:19], v64 offset:17408
s_add_u32 m0, s45, 8192
s_add_u32 s55, s46, 8192
buffer_load_dwordx4 v0, s[4:7], s55 offen offset:0 sc1 lds
buffer_load_dwordx4 v0, s[4:7], s55 offen offset:1024 sc1 lds
v_mfma_f32_32x32x16_bf16 v[48:63], v[24:27], v[152:155], v[48:63]
s_waitcnt lgkmcnt(2)
ds_read_b128 v[20:23], v64 offset:18432
s_add_u32 s45, s45, 40960
s_cmp_ge_u32 s45, 122880
s_cselect_b32 s55, 122880, 0
s_sub_u32 s45, s45, s55
s_add_u32 s46, s46, 40960
v_mfma_f32_32x32x16_bf16 v[48:63], v[8:11], v[156:159], v[48:63]
s_waitcnt lgkmcnt(2)
ds_read_b128 v[24:27], v64 offset:19456
v_mfma_f32_32x32x16_bf16 v[48:63], v[12:15], v[160:163], v[48:63]
s_waitcnt lgkmcnt(2)
ds_read_b128 v[8:11], v64 offset:20480
v_mfma_f32_32x32x16_bf16 v[48:63], v[16:19], v[164:167], v[48:63]
s_waitcnt lgkmcnt(2)
ds_read_b128 v[12:15], v64 offset:21504
v_mfma_f32_32x32x16_bf16 v[48:63], v[20:23], v[168:171], v[48:63]
s_waitcnt lgkmcnt(2)
ds_read_b128 v[16:19], v64 offset:22528
v_mfma_f32_32x32x16_bf16 v[48:63], v[24:27], v[172:175], v[48:63]
s_waitcnt lgkmcnt(2)
ds_read_b128 v[20:23], v64 offset:23552
v_mfma_f32_32x32x16_bf16 v[48:63], v[8:11], v[176:179], v[48:63]
s_waitcnt lgkmcnt(2)
ds_read_b128 v[24:27], v64 offset:24576
v_mfma_f32_32x32x16_bf16 v[48:63], v[12:15], v[180:183], v[48:63]
s_waitcnt lgkmcnt(2)
ds_read_b128 v[8:11], v64 offset:25600
v_mfma_f32_32x32x16_bf16 v[48:63], v[16:19], v[184:187], v[48:63]
s_waitcnt lgkmcnt(2)
ds_read_b128 v[12:15], v64 offset:26624
v_mfma_f32_32x32x16_bf16 v[48:63], v[20:23], v[188:191], v[48:63]
s_waitcnt lgkmcnt(2)
ds_read_b128 v[16:19], v64 offset:27648
v_mfma_f32_32x32x16_bf16 v[48:63], v[24:27], v[192:195], v[48:63]
s_waitcnt lgkmcnt(2)
ds_read_b128 v[20:23], v64 offset:28672
v_mfma_f32_32x32x16_bf16 v[48:63], v[8:11], v[196:199], v[48:63]
s_waitcnt lgkmcnt(2)
ds_read_b128 v[24:27], v64 offset:29696
v_mfma_f32_32x32x16_bf16 v[48:63], v[12:15], v[200:203], v[48:63]
s_waitcnt lgkmcnt(2)
ds_read_b128 v[8:11], v64 offset:30720
v_mfma_f32_32x32x16_bf16 v[48:63], v[16:19], v[204:207], v[48:63]
s_waitcnt lgkmcnt(2)
ds_read_b128 v[12:15], v64 offset:31744
v_mfma_f32_32x32x16_bf16 v[48:63], v[20:23], v[208:211], v[48:63]
s_waitcnt lgkmcnt(2)
ds_read_b128 v[16:19], v64 offset:32768
v_mfma_f32_32x32x16_bf16 v[48:63], v[24:27], v[212:215], v[48:63]
s_waitcnt lgkmcnt(2)
ds_read_b128 v[20:23], v64 offset:33792
v_mfma_f32_32x32x16_bf16 v[48:63], v[8:11], v[216:219], v[48:63]
s_waitcnt lgkmcnt(2)
ds_read_b128 v[24:27], v64 offset:34816
v_mfma_f32_32x32x16_bf16 v[48:63], v[12:15], v[220:223], v[48:63]
s_waitcnt lgkmcnt(2)
ds_read_b128 v[8:11], v64 offset:35840
v_mfma_f32_32x32x16_bf16 v[48:63], v[16:19], v[224:227], v[48:63]
s_waitcnt lgkmcnt(2)
ds_read_b128 v[12:15], v64 offset:36864
v_mfma_f32_32x32x16_bf16 v[48:63], v[20:23], v[228:231], v[48:63]
s_waitcnt lgkmcnt(2)
ds_read_b128 v[16:19], v64 offset:37888
v_mfma_f32_32x32x16_bf16 v[48:63], v[24:27], v[232:235], v[48:63]
s_waitcnt lgkmcnt(2)
ds_read_b128 v[20:23], v64 offset:38912
v_mfma_f32_32x32x16_bf16 v[48:63], v[8:11], v[236:239], v[48:63]
s_waitcnt lgkmcnt(2)
ds_read_b128 v[24:27], v64 offset:39936
v_mfma_f32_32x32x16_bf16 v[48:63], v[12:15], v[240:243], v[48:63]
s_add_u32 s44, s44, 1
s_cmp_eq_u32 s44, 3
s_mov_b32 s56, 40960
s_cmov_b32 s56, -81920
s_cselect_b32 s44, 0, s44
v_add_u32 v64, s56, v64
s_waitcnt vmcnt(10) lgkmcnt(2)
s_barrier
ds_read_b128 v[8:11], v64 offset:0
v_mfma_f32_32x32x16_bf16 v[48:63], v[16:19], v[244:247], v[48:63]
s_waitcnt lgkmcnt(2)
ds_read_b128 v[12:15], v64 offset:1024
v_mfma_f32_32x32x16_bf16 v[48:63], v[20:23], v[248:251], v[48:63]
s_waitcnt lgkmcnt(2)
ds_read_b128 v[16:19], v64 offset:2048
v_mfma_f32_32x32x16_bf16 v[48:63], v[24:27], v[252:255], v[48:63]
s_waitcnt lgkmcnt(2)
ds_read_b128 v[20:23], v64 offset:3072
v_mfma_f32_32x32x16_bf16 v[32:47], v[8:11], v[96:99], 0
s_waitcnt lgkmcnt(2)
ds_read_b128 v[24:27], v64 offset:4096
v_mfma_f32_32x32x16_bf16 v[32:47], v[12:15], v[100:103], v[32:47]
s_waitcnt lgkmcnt(2)
ds_read_b128 v[8:11], v64 offset:5120
v_cvt_pk_bf16_f32 v48, v48, v49
v_cvt_pk_bf16_f32 v49, v50, v51
v_mfma_f32_32x32x16_bf16 v[32:47], v[16:19], v[104:107], v[32:47]
s_waitcnt lgkmcnt(2)
ds_read_b128 v[12:15], v64 offset:6144
v_cvt_pk_bf16_f32 v50, v52, v53
v_cvt_pk_bf16_f32 v51, v54, v55
v_mfma_f32_32x32x16_bf16 v[32:47], v[20:23], v[108:111], v[32:47]
s_waitcnt lgkmcnt(2)
ds_read_b128 v[16:19], v64 offset:7168
v_cvt_pk_bf16_f32 v52, v56, v57
v_cvt_pk_bf16_f32 v53, v58, v59
v_mfma_f32_32x32x16_bf16 v[32:47], v[24:27], v[112:115], v[32:47]
s_waitcnt lgkmcnt(2)
ds_read_b128 v[20:23], v64 offset:8192
v_cvt_pk_bf16_f32 v54, v60, v61
v_cvt_pk_bf16_f32 v55, v62, v63
v_mfma_f32_32x32x16_bf16 v[32:47], v[8:11], v[116:119], v[32:47]
s_waitcnt lgkmcnt(2)
ds_read_b128 v[24:27], v64 offset:9216
v_accvgpr_write_b32 a72, v48
v_accvgpr_write_b32 a73, v49
v_mfma_f32_32x32x16_bf16 v[32:47], v[12:15], v[120:123], v[32:47]
s_waitcnt lgkmcnt(2)
ds_read_b128 v[8:11], v64 offset:10240
v_accvgpr_write_b32 a74, v50
v_accvgpr_write_b32 a75, v51
v_mfma_f32_32x32x16_bf16 v[32:47], v[16:19], v[124:127], v[32:47]
s_waitcnt lgkmcnt(2)
ds_read_b128 v[12:15], v64 offset:11264
v_accvgpr_write_b32 a76, v52
v_accvgpr_write_b32 a77, v53
v_mfma_f32_32x32x16_bf16 v[32:47], v[20:23], v[128:131], v[32:47]
s_waitcnt lgkmcnt(2)
ds_read_b128 v[16:19], v64 offset:12288
v_accvgpr_write_b32 a78, v54
v_accvgpr_write_b32 a79, v55
v_mfma_f32_32x32x16_bf16 v[32:47], v[24:27], v[132:135], v[32:47]
s_waitcnt lgkmcnt(2)
ds_read_b128 v[20:23], v64 offset:13312
s_add_u32 m0, s45, 0
s_add_u32 s55, s46, 0
buffer_load_dwordx4 v0, s[4:7], s55 offen offset:0 sc1 lds
buffer_load_dwordx4 v0, s[4:7], s55 offen offset:1024 sc1 lds
v_mfma_f32_32x32x16_bf16 v[32:47], v[8:11], v[136:139], v[32:47]
s_waitcnt lgkmcnt(2)
ds_read_b128 v[24:27], v64 offset:14336
buffer_load_dwordx4 v0, s[4:7], s55 offen offset:2048 sc1 lds
buffer_load_dwordx4 v0, s[4:7], s55 offen offset:3072 sc1 lds
v_mfma_f32_32x32x16_bf16 v[32:47], v[12:15], v[140:143], v[32:47]
s_waitcnt lgkmcnt(2)
ds_read_b128 v[8:11], v64 offset:15360
s_add_u32 m0, s45, 4096
s_add_u32 s55, s46, 4096
buffer_load_dwordx4 v0, s[4:7], s55 offen offset:0 sc1 lds
buffer_load_dwordx4 v0, s[4:7], s55 offen offset:1024 sc1 lds
v_mfma_f32_32x32x16_bf16 v[32:47], v[16:19], v[144:147], v[32:47]
s_waitcnt lgkmcnt(2)
ds_read_b128 v[12:15], v64 offset:16384
buffer_load_dwordx4 v0, s[4:7], s55 offen offset:2048 sc1 lds
buffer_load_dwordx4 v0, s[4:7], s55 offen offset:3072 sc1 lds
v_mfma_f32_32x32x16_bf16 v[32:47], v[20:23], v[148:151], v[32:47]
s_waitcnt lgkmcnt(2)
ds_read_b128 v[16:19], v64 offset:17408
s_add_u32 m0, s45, 8192
s_add_u32 s55, s46, 8192
buffer_load_dwordx4 v0, s[4:7], s55 offen offset:0 sc1 lds
buffer_load_dwordx4 v0, s[4:7], s55 offen offset:1024 sc1 lds
v_mfma_f32_32x32x16_bf16 v[32:47], v[24:27], v[152:155], v[32:47]
s_waitcnt lgkmcnt(2)
ds_read_b128 v[20:23], v64 offset:18432
s_add_u32 s45, s45, 40960
s_cmp_ge_u32 s45, 122880
s_cselect_b32 s55, 122880, 0
s_sub_u32 s45, s45, s55
s_add_u32 s46, s46, 40960
v_mfma_f32_32x32x16_bf16 v[32:47], v[8:11], v[156:159], v[32:47]
s_waitcnt lgkmcnt(2)
ds_read_b128 v[24:27], v64 offset:19456
v_mfma_f32_32x32x16_bf16 v[32:47], v[12:15], v[160:163], v[32:47]
s_waitcnt lgkmcnt(2)
ds_read_b128 v[8:11], v64 offset:20480
v_mfma_f32_32x32x16_bf16 v[32:47], v[16:19], v[164:167], v[32:47]
s_waitcnt lgkmcnt(2)
ds_read_b128 v[12:15], v64 offset:21504
v_mfma_f32_32x32x16_bf16 v[32:47], v[20:23], v[168:171], v[32:47]
s_waitcnt lgkmcnt(2)
ds_read_b128 v[16:19], v64 offset:22528
v_mfma_f32_32x32x16_bf16 v[32:47], v[24:27], v[172:175], v[32:47]
s_waitcnt lgkmcnt(2)
ds_read_b128 v[20:23], v64 offset:23552
v_mfma_f32_32x32x16_bf16 v[32:47], v[8:11], v[176:179], v[32:47]
s_waitcnt lgkmcnt(2)
ds_read_b128 v[24:27], v64 offset:24576
v_mfma_f32_32x32x16_bf16 v[32:47], v[12:15], v[180:183], v[32:47]
s_waitcnt lgkmcnt(2)
ds_read_b128 v[8:11], v64 offset:25600
v_mfma_f32_32x32x16_bf16 v[32:47], v[16:19], v[184:187], v[32:47]
s_waitcnt lgkmcnt(2)
ds_read_b128 v[12:15], v64 offset:26624
v_mfma_f32_32x32x16_bf16 v[32:47], v[20:23], v[188:191], v[32:47]
s_waitcnt lgkmcnt(2)
ds_read_b128 v[16:19], v64 offset:27648
v_mfma_f32_32x32x16_bf16 v[32:47], v[24:27], v[192:195], v[32:47]
s_waitcnt lgkmcnt(2)
ds_read_b128 v[20:23], v64 offset:28672
v_mfma_f32_32x32x16_bf16 v[32:47], v[8:11], v[196:199], v[32:47]
s_waitcnt lgkmcnt(2)
ds_read_b128 v[24:27], v64 offset:29696
v_mfma_f32_32x32x16_bf16 v[32:47], v[12:15], v[200:203], v[32:47]
s_waitcnt lgkmcnt(2)
ds_read_b128 v[8:11], v64 offset:30720
v_mfma_f32_32x32x16_bf16 v[32:47], v[16:19], v[204:207], v[32:47]
s_waitcnt lgkmcnt(2)
ds_read_b128 v[12:15], v64 offset:31744
v_mfma_f32_32x32x16_bf16 v[32:47], v[20:23], v[208:211], v[32:47]
s_waitcnt lgkmcnt(2)
ds_read_b128 v[16:19], v64 offset:32768
v_mfma_f32_32x32x16_bf16 v[32:47], v[24:27], v[212:215], v[32:47]
s_waitcnt lgkmcnt(2)
ds_read_b128 v[20:23], v64 offset:33792
v_mfma_f32_32x32x16_bf16 v[32:47], v[8:11], v[216:219], v[32:47]
s_waitcnt lgkmcnt(2)
ds_read_b128 v[24:27], v64 offset:34816
v_mfma_f32_32x32x16_bf16 v[32:47], v[12:15], v[220:223], v[32:47]
s_waitcnt lgkmcnt(2)
ds_read_b128 v[8:11], v64 offset:35840
v_mfma_f32_32x32x16_bf16 v[32:47], v[16:19], v[224:227], v[32:47]
s_waitcnt lgkmcnt(2)
ds_read_b128 v[12:15], v64 offset:36864
v_mfma_f32_32x32x16_bf16 v[32:47], v[20:23], v[228:231], v[32:47]
s_waitcnt lgkmcnt(2)
ds_read_b128 v[16:19], v64 offset:37888
v_mfma_f32_32x32x16_bf16 v[32:47], v[24:27], v[232:235], v[32:47]
s_waitcnt lgkmcnt(2)
ds_read_b128 v[20:23], v64 offset:38912
v_mfma_f32_32x32x16_bf16 v[32:47], v[8:11], v[236:239], v[32:47]
s_waitcnt lgkmcnt(2)
ds_read_b128 v[24:27], v64 offset:39936
v_mfma_f32_32x32x16_bf16 v[32:47], v[12:15], v[240:243], v[32:47]
s_add_u32 s44, s44, 1
s_cmp_eq_u32 s44, 3
s_mov_b32 s56, 40960
s_cmov_b32 s56, -81920
s_cselect_b32 s44, 0, s44
v_add_u32 v64, s56, v64
s_waitcnt vmcnt(10) lgkmcnt(2)
s_barrier
ds_read_b128 v[8:11], v64 offset:0
v_mfma_f32_32x32x16_bf16 v[32:47], v[16:19], v[244:247], v[32:47]
s_waitcnt lgkmcnt(2)
ds_read_b128 v[12:15], v64 offset:1024
v_mfma_f32_32x32x16_bf16 v[32:47], v[20:23], v[248:251], v[32:47]
s_waitcnt lgkmcnt(2)
ds_read_b128 v[16:19], v64 offset:2048
v_mfma_f32_32x32x16_bf16 v[32:47], v[24:27], v[252:255], v[32:47]
s_waitcnt lgkmcnt(2)
ds_read_b128 v[20:23], v64 offset:3072
v_mfma_f32_32x32x16_bf16 v[48:63], v[8:11], v[96:99], 0
s_waitcnt lgkmcnt(2)
ds_read_b128 v[24:27], v64 offset:4096
v_mfma_f32_32x32x16_bf16 v[48:63], v[12:15], v[100:103], v[48:63]
s_waitcnt lgkmcnt(2)
ds_read_b128 v[8:11], v64 offset:5120
v_cvt_pk_bf16_f32 v32, v32, v33
v_cvt_pk_bf16_f32 v33, v34, v35
v_mfma_f32_32x32x16_bf16 v[48:63], v[16:19], v[104:107], v[48:63]
s_waitcnt lgkmcnt(2)
ds_read_b128 v[12:15], v64 offset:6144
v_cvt_pk_bf16_f32 v34, v36, v37
v_cvt_pk_bf16_f32 v35, v38, v39
v_mfma_f32_32x32x16_bf16 v[48:63], v[20:23], v[108:111], v[48:63]
s_waitcnt lgkmcnt(2)
ds_read_b128 v[16:19], v64 offset:7168
v_cvt_pk_bf16_f32 v36, v40, v41
v_cvt_pk_bf16_f32 v37, v42, v43
v_mfma_f32_32x32x16_bf16 v[48:63], v[24:27], v[112:115], v[48:63]
s_waitcnt lgkmcnt(2)
ds_read_b128 v[20:23], v64 offset:8192
v_cvt_pk_bf16_f32 v38, v44, v45
v_cvt_pk_bf16_f32 v39, v46, v47
v_mfma_f32_32x32x16_bf16 v[48:63], v[8:11], v[116:119], v[48:63]
s_waitcnt lgkmcnt(2)
ds_read_b128 v[24:27], v64 offset:9216
v_accvgpr_write_b32 a80, v32
v_accvgpr_write_b32 a81, v33
v_mfma_f32_32x32x16_bf16 v[48:63], v[12:15], v[120:123], v[48:63]
s_waitcnt lgkmcnt(2)
ds_read_b128 v[8:11], v64 offset:10240
v_accvgpr_write_b32 a82, v34
v_accvgpr_write_b32 a83, v35
v_mfma_f32_32x32x16_bf16 v[48:63], v[16:19], v[124:127], v[48:63]
s_waitcnt lgkmcnt(2)
ds_read_b128 v[12:15], v64 offset:11264
v_accvgpr_write_b32 a84, v36
v_accvgpr_write_b32 a85, v37
v_mfma_f32_32x32x16_bf16 v[48:63], v[20:23], v[128:131], v[48:63]
s_waitcnt lgkmcnt(2)
ds_read_b128 v[16:19], v64 offset:12288
v_accvgpr_write_b32 a86, v38
v_accvgpr_write_b32 a87, v39
v_mfma_f32_32x32x16_bf16 v[48:63], v[24:27], v[132:135], v[48:63]
s_waitcnt lgkmcnt(2)
ds_read_b128 v[20:23], v64 offset:13312
s_add_u32 m0, s45, 0
s_add_u32 s55, s46, 0
buffer_load_dwordx4 v0, s[4:7], s55 offen offset:0 sc1 lds
buffer_load_dwordx4 v0, s[4:7], s55 offen offset:1024 sc1 lds
v_mfma_f32_32x32x16_bf16 v[48:63], v[8:11], v[136:139], v[48:63]
s_waitcnt lgkmcnt(2)
ds_read_b128 v[24:27], v64 offset:14336
buffer_load_dwordx4 v0, s[4:7], s55 offen offset:2048 sc1 lds
buffer_load_dwordx4 v0, s[4:7], s55 offen offset:3072 sc1 lds
v_mfma_f32_32x32x16_bf16 v[48:63], v[12:15], v[140:143], v[48:63]
s_waitcnt lgkmcnt(2)
ds_read_b128 v[8:11], v64 offset:15360
s_add_u32 m0, s45, 4096
s_add_u32 s55, s46, 4096
buffer_load_dwordx4 v0, s[4:7], s55 offen offset:0 sc1 lds
buffer_load_dwordx4 v0, s[4:7], s55 offen offset:1024 sc1 lds
v_mfma_f32_32x32x16_bf16 v[48:63], v[16:19], v[144:147], v[48:63]
s_waitcnt lgkmcnt(2)
ds_read_b128 v[12:15], v64 offset:16384
buffer_load_dwordx4 v0, s[4:7], s55 offen offset:2048 sc1 lds
buffer_load_dwordx4 v0, s[4:7], s55 offen offset:3072 sc1 lds
v_mfma_f32_32x32x16_bf16 v[48:63], v[20:23], v[148:151], v[48:63]
s_waitcnt lgkmcnt(2)
ds_read_b128 v[16:19], v64 offset:17408
s_add_u32 m0, s45, 8192
s_add_u32 s55, s46, 8192
buffer_load_dwordx4 v0, s[4:7], s55 offen offset:0 sc1 lds
buffer_load_dwordx4 v0, s[4:7], s55 offen offset:1024 sc1 lds
v_mfma_f32_32x32x16_bf16 v[48:63], v[24:27], v[152:155], v[48:63]
s_waitcnt lgkmcnt(2)
ds_read_b128 v[20:23], v64 offset:18432
s_add_u32 s45, s45, 40960
s_cmp_ge_u32 s45, 122880
s_cselect_b32 s55, 122880, 0
s_sub_u32 s45, s45, s55
s_add_u32 s46, s46, 40960
v_mfma_f32_32x32x16_bf16 v[48:63], v[8:11], v[156:159], v[48:63]
s_waitcnt lgkmcnt(2)
ds_read_b128 v[24:27], v64 offset:19456
v_mfma_f32_32x32x16_bf16 v[48:63], v[12:15], v[160:163], v[48:63]
s_waitcnt lgkmcnt(2)
ds_read_b128 v[8:11], v64 offset:20480
v_mfma_f32_32x32x16_bf16 v[48:63], v[16:19], v[164:167], v[48:63]
s_waitcnt lgkmcnt(2)
ds_read_b128 v[12:15], v64 offset:21504
v_mfma_f32_32x32x16_bf16 v[48:63], v[20:23], v[168:171], v[48:63]
s_waitcnt lgkmcnt(2)
ds_read_b128 v[16:19], v64 offset:22528
v_mfma_f32_32x32x16_bf16 v[48:63], v[24:27], v[172:175], v[48:63]
s_waitcnt lgkmcnt(2)
ds_read_b128 v[20:23], v64 offset:23552
v_mfma_f32_32x32x16_bf16 v[48:63], v[8:11], v[176:179], v[48:63]
s_waitcnt lgkmcnt(2)
ds_read_b128 v[24:27], v64 offset:24576
v_mfma_f32_32x32x16_bf16 v[48:63], v[12:15], v[180:183], v[48:63]
s_waitcnt lgkmcnt(2)
ds_read_b128 v[8:11], v64 offset:25600
v_mfma_f32_32x32x16_bf16 v[48:63], v[16:19], v[184:187], v[48:63]
s_waitcnt lgkmcnt(2)
ds_read_b128 v[12:15], v64 offset:26624
v_mfma_f32_32x32x16_bf16 v[48:63], v[20:23], v[188:191], v[48:63]
s_waitcnt lgkmcnt(2)
ds_read_b128 v[16:19], v64 offset:27648
v_mfma_f32_32x32x16_bf16 v[48:63], v[24:27], v[192:195], v[48:63]
s_waitcnt lgkmcnt(2)
ds_read_b128 v[20:23], v64 offset:28672
v_mfma_f32_32x32x16_bf16 v[48:63], v[8:11], v[196:199], v[48:63]
s_waitcnt lgkmcnt(2)
ds_read_b128 v[24:27], v64 offset:29696
v_mfma_f32_32x32x16_bf16 v[48:63], v[12:15], v[200:203], v[48:63]
s_waitcnt lgkmcnt(2)
ds_read_b128 v[8:11], v64 offset:30720
v_mfma_f32_32x32x16_bf16 v[48:63], v[16:19], v[204:207], v[48:63]
s_waitcnt lgkmcnt(2)
ds_read_b128 v[12:15], v64 offset:31744
v_mfma_f32_32x32x16_bf16 v[48:63], v[20:23], v[208:211], v[48:63]
s_waitcnt lgkmcnt(2)
ds_read_b128 v[16:19], v64 offset:32768
v_mfma_f32_32x32x16_bf16 v[48:63], v[24:27], v[212:215], v[48:63]
s_waitcnt lgkmcnt(2)
ds_read_b128 v[20:23], v64 offset:33792
v_mfma_f32_32x32x16_bf16 v[48:63], v[8:11], v[216:219], v[48:63]
s_waitcnt lgkmcnt(2)
ds_read_b128 v[24:27], v64 offset:34816
v_mfma_f32_32x32x16_bf16 v[48:63], v[12:15], v[220:223], v[48:63]
s_waitcnt lgkmcnt(2)
ds_read_b128 v[8:11], v64 offset:35840
v_mfma_f32_32x32x16_bf16 v[48:63], v[16:19], v[224:227], v[48:63]
s_waitcnt lgkmcnt(2)
ds_read_b128 v[12:15], v64 offset:36864
v_mfma_f32_32x32x16_bf16 v[48:63], v[20:23], v[228:231], v[48:63]
s_waitcnt lgkmcnt(2)
ds_read_b128 v[16:19], v64 offset:37888
v_mfma_f32_32x32x16_bf16 v[48:63], v[24:27], v[232:235], v[48:63]
s_waitcnt lgkmcnt(2)
ds_read_b128 v[20:23], v64 offset:38912
v_mfma_f32_32x32x16_bf16 v[48:63], v[8:11], v[236:239], v[48:63]
s_waitcnt lgkmcnt(2)
ds_read_b128 v[24:27], v64 offset:39936
v_mfma_f32_32x32x16_bf16 v[48:63], v[12:15], v[240:243], v[48:63]
s_add_u32 s44, s44, 1
s_cmp_eq_u32 s44, 3
s_mov_b32 s56, 40960
s_cmov_b32 s56, -81920
s_cselect_b32 s44, 0, s44
v_add_u32 v64, s56, v64
s_waitcnt vmcnt(10) lgkmcnt(2)
s_barrier
ds_read_b128 v[8:11], v64 offset:0
v_mfma_f32_32x32x16_bf16 v[48:63], v[16:19], v[244:247], v[48:63]
s_waitcnt lgkmcnt(2)
ds_read_b128 v[12:15], v64 offset:1024
v_mfma_f32_32x32x16_bf16 v[48:63], v[20:23], v[248:251], v[48:63]
s_waitcnt lgkmcnt(2)
ds_read_b128 v[16:19], v64 offset:2048
v_mfma_f32_32x32x16_bf16 v[48:63], v[24:27], v[252:255], v[48:63]
s_waitcnt lgkmcnt(2)
ds_read_b128 v[20:23], v64 offset:3072
v_mfma_f32_32x32x16_bf16 v[32:47], v[8:11], v[96:99], 0
s_waitcnt lgkmcnt(2)
ds_read_b128 v[24:27], v64 offset:4096
v_mfma_f32_32x32x16_bf16 v[32:47], v[12:15], v[100:103], v[32:47]
s_waitcnt lgkmcnt(2)
ds_read_b128 v[8:11], v64 offset:5120
v_cvt_pk_bf16_f32 v48, v48, v49
v_cvt_pk_bf16_f32 v49, v50, v51
v_mfma_f32_32x32x16_bf16 v[32:47], v[16:19], v[104:107], v[32:47]
s_waitcnt lgkmcnt(2)
ds_read_b128 v[12:15], v64 offset:6144
v_cvt_pk_bf16_f32 v50, v52, v53
v_cvt_pk_bf16_f32 v51, v54, v55
v_mfma_f32_32x32x16_bf16 v[32:47], v[20:23], v[108:111], v[32:47]
s_waitcnt lgkmcnt(2)
ds_read_b128 v[16:19], v64 offset:7168
v_cvt_pk_bf16_f32 v52, v56, v57
v_cvt_pk_bf16_f32 v53, v58, v59
v_mfma_f32_32x32x16_bf16 v[32:47], v[24:27], v[112:115], v[32:47]
s_waitcnt lgkmcnt(2)
ds_read_b128 v[20:23], v64 offset:8192
v_cvt_pk_bf16_f32 v54, v60, v61
v_cvt_pk_bf16_f32 v55, v62, v63
v_mfma_f32_32x32x16_bf16 v[32:47], v[8:11], v[116:119], v[32:47]
s_waitcnt lgkmcnt(2)
ds_read_b128 v[24:27], v64 offset:9216
v_accvgpr_write_b32 a88, v48
v_accvgpr_write_b32 a89, v49
v_mfma_f32_32x32x16_bf16 v[32:47], v[12:15], v[120:123], v[32:47]
s_waitcnt lgkmcnt(2)
ds_read_b128 v[8:11], v64 offset:10240
v_accvgpr_write_b32 a90, v50
v_accvgpr_write_b32 a91, v51
v_mfma_f32_32x32x16_bf16 v[32:47], v[16:19], v[124:127], v[32:47]
s_waitcnt lgkmcnt(2)
ds_read_b128 v[12:15], v64 offset:11264
v_accvgpr_write_b32 a92, v52
v_accvgpr_write_b32 a93, v53
v_mfma_f32_32x32x16_bf16 v[32:47], v[20:23], v[128:131], v[32:47]
s_waitcnt lgkmcnt(2)
ds_read_b128 v[16:19], v64 offset:12288
v_accvgpr_write_b32 a94, v54
v_accvgpr_write_b32 a95, v55
v_mfma_f32_32x32x16_bf16 v[32:47], v[24:27], v[132:135], v[32:47]
s_waitcnt lgkmcnt(2)
ds_read_b128 v[20:23], v64 offset:13312
s_add_u32 m0, s45, 0
s_add_u32 s55, s46, 0
buffer_load_dwordx4 v0, s[4:7], s55 offen offset:0 sc1 lds
buffer_load_dwordx4 v0, s[4:7], s55 offen offset:1024 sc1 lds
v_mfma_f32_32x32x16_bf16 v[32:47], v[8:11], v[136:139], v[32:47]
s_waitcnt lgkmcnt(2)
ds_read_b128 v[24:27], v64 offset:14336
buffer_load_dwordx4 v0, s[4:7], s55 offen offset:2048 sc1 lds
buffer_load_dwordx4 v0, s[4:7], s55 offen offset:3072 sc1 lds
v_mfma_f32_32x32x16_bf16 v[32:47], v[12:15], v[140:143], v[32:47]
s_waitcnt lgkmcnt(2)
ds_read_b128 v[8:11], v64 offset:15360
s_add_u32 m0, s45, 4096
s_add_u32 s55, s46, 4096
buffer_load_dwordx4 v0, s[4:7], s55 offen offset:0 sc1 lds
buffer_load_dwordx4 v0, s[4:7], s55 offen offset:1024 sc1 lds
v_mfma_f32_32x32x16_bf16 v[32:47], v[16:19], v[144:147], v[32:47]
s_waitcnt lgkmcnt(2)
ds_read_b128 v[12:15], v64 offset:16384
buffer_load_dwordx4 v0, s[4:7], s55 offen offset:2048 sc1 lds
buffer_load_dwordx4 v0, s[4:7], s55 offen offset:3072 sc1 lds
v_mfma_f32_32x32x16_bf16 v[32:47], v[20:23], v[148:151], v[32:47]
s_waitcnt lgkmcnt(2)
ds_read_b128 v[16:19], v64 offset:17408
s_add_u32 m0, s45, 8192
s_add_u32 s55, s46, 8192
buffer_load_dwordx4 v0, s[4:7], s55 offen offset:0 sc1 lds
buffer_load_dwordx4 v0, s[4:7], s55 offen offset:1024 sc1 lds
v_mfma_f32_32x32x16_bf16 v[32:47], v[24:27], v[152:155], v[32:47]
s_waitcnt lgkmcnt(2)
ds_read_b128 v[20:23], v64 offset:18432
s_add_u32 s45, s45, 40960
s_cmp_ge_u32 s45, 122880
s_cselect_b32 s55, 122880, 0
s_sub_u32 s45, s45, s55
s_add_u32 s46, s46, 40960
v_mfma_f32_32x32x16_bf16 v[32:47], v[8:11], v[156:159], v[32:47]
s_waitcnt lgkmcnt(2)
ds_read_b128 v[24:27], v64 offset:19456
v_mfma_f32_32x32x16_bf16 v[32:47], v[12:15], v[160:163], v[32:47]
s_waitcnt lgkmcnt(2)
ds_read_b128 v[8:11], v64 offset:20480
v_mfma_f32_32x32x16_bf16 v[32:47], v[16:19], v[164:167], v[32:47]
s_waitcnt lgkmcnt(2)
ds_read_b128 v[12:15], v64 offset:21504
v_mfma_f32_32x32x16_bf16 v[32:47], v[20:23], v[168:171], v[32:47]
s_waitcnt lgkmcnt(2)
ds_read_b128 v[16:19], v64 offset:22528
v_mfma_f32_32x32x16_bf16 v[32:47], v[24:27], v[172:175], v[32:47]
s_waitcnt lgkmcnt(2)
ds_read_b128 v[20:23], v64 offset:23552
v_mfma_f32_32x32x16_bf16 v[32:47], v[8:11], v[176:179], v[32:47]
s_waitcnt lgkmcnt(2)
ds_read_b128 v[24:27], v64 offset:24576
v_mfma_f32_32x32x16_bf16 v[32:47], v[12:15], v[180:183], v[32:47]
s_waitcnt lgkmcnt(2)
ds_read_b128 v[8:11], v64 offset:25600
v_mfma_f32_32x32x16_bf16 v[32:47], v[16:19], v[184:187], v[32:47]
s_waitcnt lgkmcnt(2)
ds_read_b128 v[12:15], v64 offset:26624
v_mfma_f32_32x32x16_bf16 v[32:47], v[20:23], v[188:191], v[32:47]
s_waitcnt lgkmcnt(2)
ds_read_b128 v[16:19], v64 offset:27648
v_mfma_f32_32x32x16_bf16 v[32:47], v[24:27], v[192:195], v[32:47]
s_waitcnt lgkmcnt(2)
ds_read_b128 v[20:23], v64 offset:28672
v_mfma_f32_32x32x16_bf16 v[32:47], v[8:11], v[196:199], v[32:47]
s_waitcnt lgkmcnt(2)
ds_read_b128 v[24:27], v64 offset:29696
v_mfma_f32_32x32x16_bf16 v[32:47], v[12:15], v[200:203], v[32:47]
s_waitcnt lgkmcnt(2)
ds_read_b128 v[8:11], v64 offset:30720
v_mfma_f32_32x32x16_bf16 v[32:47], v[16:19], v[204:207], v[32:47]
s_waitcnt lgkmcnt(2)
ds_read_b128 v[12:15], v64 offset:31744
v_mfma_f32_32x32x16_bf16 v[32:47], v[20:23], v[208:211], v[32:47]
s_waitcnt lgkmcnt(2)
ds_read_b128 v[16:19], v64 offset:32768
v_mfma_f32_32x32x16_bf16 v[32:47], v[24:27], v[212:215], v[32:47]
s_waitcnt lgkmcnt(2)
ds_read_b128 v[20:23], v64 offset:33792
v_mfma_f32_32x32x16_bf16 v[32:47], v[8:11], v[216:219], v[32:47]
s_waitcnt lgkmcnt(2)
ds_read_b128 v[24:27], v64 offset:34816
v_mfma_f32_32x32x16_bf16 v[32:47], v[12:15], v[220:223], v[32:47]
s_waitcnt lgkmcnt(2)
ds_read_b128 v[8:11], v64 offset:35840
v_mfma_f32_32x32x16_bf16 v[32:47], v[16:19], v[224:227], v[32:47]
s_waitcnt lgkmcnt(2)
ds_read_b128 v[12:15], v64 offset:36864
v_mfma_f32_32x32x16_bf16 v[32:47], v[20:23], v[228:231], v[32:47]
s_waitcnt lgkmcnt(2)
ds_read_b128 v[16:19], v64 offset:37888
v_mfma_f32_32x32x16_bf16 v[32:47], v[24:27], v[232:235], v[32:47]
s_waitcnt lgkmcnt(2)
ds_read_b128 v[20:23], v64 offset:38912
v_mfma_f32_32x32x16_bf16 v[32:47], v[8:11], v[236:239], v[32:47]
s_waitcnt lgkmcnt(2)
ds_read_b128 v[24:27], v64 offset:39936
v_mfma_f32_32x32x16_bf16 v[32:47], v[12:15], v[240:243], v[32:47]
s_add_u32 s44, s44, 1
s_cmp_eq_u32 s44, 3
s_mov_b32 s56, 40960
s_cmov_b32 s56, -81920
s_cselect_b32 s44, 0, s44
v_add_u32 v64, s56, v64
s_waitcnt vmcnt(10) lgkmcnt(2)
s_barrier
ds_read_b128 v[8:11], v64 offset:0
v_mfma_f32_32x32x16_bf16 v[32:47], v[16:19], v[244:247], v[32:47]
s_waitcnt lgkmcnt(2)
ds_read_b128 v[12:15], v64 offset:1024
v_mfma_f32_32x32x16_bf16 v[32:47], v[20:23], v[248:251], v[32:47]
s_waitcnt lgkmcnt(2)
ds_read_b128 v[16:19], v64 offset:2048
v_mfma_f32_32x32x16_bf16 v[32:47], v[24:27], v[252:255], v[32:47]
s_waitcnt lgkmcnt(2)
ds_read_b128 v[20:23], v64 offset:3072
v_mfma_f32_32x32x16_bf16 v[48:63], v[8:11], v[96:99], 0
s_waitcnt lgkmcnt(2)
ds_read_b128 v[24:27], v64 offset:4096
v_mfma_f32_32x32x16_bf16 v[48:63], v[12:15], v[100:103], v[48:63]
s_waitcnt lgkmcnt(2)
ds_read_b128 v[8:11], v64 offset:5120
v_cvt_pk_bf16_f32 v32, v32, v33
v_cvt_pk_bf16_f32 v33, v34, v35
v_mfma_f32_32x32x16_bf16 v[48:63], v[16:19], v[104:107], v[48:63]
s_waitcnt lgkmcnt(2)
ds_read_b128 v[12:15], v64 offset:6144
v_cvt_pk_bf16_f32 v34, v36, v37
v_cvt_pk_bf16_f32 v35, v38, v39
v_mfma_f32_32x32x16_bf16 v[48:63], v[20:23], v[108:111], v[48:63]
s_waitcnt lgkmcnt(2)
ds_read_b128 v[16:19], v64 offset:7168
v_cvt_pk_bf16_f32 v36, v40, v41
v_cvt_pk_bf16_f32 v37, v42, v43
v_mfma_f32_32x32x16_bf16 v[48:63], v[24:27], v[112:115], v[48:63]
s_waitcnt lgkmcnt(2)
ds_read_b128 v[20:23], v64 offset:8192
v_cvt_pk_bf16_f32 v38, v44, v45
v_cvt_pk_bf16_f32 v39, v46, v47
v_mfma_f32_32x32x16_bf16 v[48:63], v[8:11], v[116:119], v[48:63]
s_waitcnt lgkmcnt(2)
ds_read_b128 v[24:27], v64 offset:9216
v_accvgpr_write_b32 a96, v32
v_accvgpr_write_b32 a97, v33
v_mfma_f32_32x32x16_bf16 v[48:63], v[12:15], v[120:123], v[48:63]
s_waitcnt lgkmcnt(2)
ds_read_b128 v[8:11], v64 offset:10240
v_accvgpr_write_b32 a98, v34
v_accvgpr_write_b32 a99, v35
v_mfma_f32_32x32x16_bf16 v[48:63], v[16:19], v[124:127], v[48:63]
s_waitcnt lgkmcnt(2)
ds_read_b128 v[12:15], v64 offset:11264
v_accvgpr_write_b32 a100, v36
v_accvgpr_write_b32 a101, v37
v_mfma_f32_32x32x16_bf16 v[48:63], v[20:23], v[128:131], v[48:63]
s_waitcnt lgkmcnt(2)
ds_read_b128 v[16:19], v64 offset:12288
v_accvgpr_write_b32 a102, v38
v_accvgpr_write_b32 a103, v39
v_mfma_f32_32x32x16_bf16 v[48:63], v[24:27], v[132:135], v[48:63]
s_waitcnt lgkmcnt(2)
ds_read_b128 v[20:23], v64 offset:13312
s_add_u32 m0, s45, 0
s_add_u32 s55, s46, 0
buffer_load_dwordx4 v0, s[4:7], s55 offen offset:0 sc1 lds
buffer_load_dwordx4 v0, s[4:7], s55 offen offset:1024 sc1 lds
v_mfma_f32_32x32x16_bf16 v[48:63], v[8:11], v[136:139], v[48:63]
s_waitcnt lgkmcnt(2)
ds_read_b128 v[24:27], v64 offset:14336
buffer_load_dwordx4 v0, s[4:7], s55 offen offset:2048 sc1 lds
buffer_load_dwordx4 v0, s[4:7], s55 offen offset:3072 sc1 lds
v_mfma_f32_32x32x16_bf16 v[48:63], v[12:15], v[140:143], v[48:63]
s_waitcnt lgkmcnt(2)
ds_read_b128 v[8:11], v64 offset:15360
s_add_u32 m0, s45, 4096
s_add_u32 s55, s46, 4096
buffer_load_dwordx4 v0, s[4:7], s55 offen offset:0 sc1 lds
buffer_load_dwordx4 v0, s[4:7], s55 offen offset:1024 sc1 lds
v_mfma_f32_32x32x16_bf16 v[48:63], v[16:19], v[144:147], v[48:63]
s_waitcnt lgkmcnt(2)
ds_read_b128 v[12:15], v64 offset:16384
buffer_load_dwordx4 v0, s[4:7], s55 offen offset:2048 sc1 lds
buffer_load_dwordx4 v0, s[4:7], s55 offen offset:3072 sc1 lds
v_mfma_f32_32x32x16_bf16 v[48:63], v[20:23], v[148:151], v[48:63]
s_waitcnt lgkmcnt(2)
ds_read_b128 v[16:19], v64 offset:17408
s_add_u32 m0, s45, 8192
s_add_u32 s55, s46, 8192
buffer_load_dwordx4 v0, s[4:7], s55 offen offset:0 sc1 lds
buffer_load_dwordx4 v0, s[4:7], s55 offen offset:1024 sc1 lds
v_mfma_f32_32x32x16_bf16 v[48:63], v[24:27], v[152:155], v[48:63]
s_waitcnt lgkmcnt(2)
ds_read_b128 v[20:23], v64 offset:18432
s_add_u32 s45, s45, 40960
s_cmp_ge_u32 s45, 122880
s_cselect_b32 s55, 122880, 0
s_sub_u32 s45, s45, s55
s_add_u32 s46, s46, 40960
v_mfma_f32_32x32x16_bf16 v[48:63], v[8:11], v[156:159], v[48:63]
s_waitcnt lgkmcnt(2)
ds_read_b128 v[24:27], v64 offset:19456
v_mfma_f32_32x32x16_bf16 v[48:63], v[12:15], v[160:163], v[48:63]
s_waitcnt lgkmcnt(2)
ds_read_b128 v[8:11], v64 offset:20480
v_mfma_f32_32x32x16_bf16 v[48:63], v[16:19], v[164:167], v[48:63]
s_waitcnt lgkmcnt(2)
ds_read_b128 v[12:15], v64 offset:21504
v_mfma_f32_32x32x16_bf16 v[48:63], v[20:23], v[168:171], v[48:63]
s_waitcnt lgkmcnt(2)
ds_read_b128 v[16:19], v64 offset:22528
v_mfma_f32_32x32x16_bf16 v[48:63], v[24:27], v[172:175], v[48:63]
s_waitcnt lgkmcnt(2)
ds_read_b128 v[20:23], v64 offset:23552
v_mfma_f32_32x32x16_bf16 v[48:63], v[8:11], v[176:179], v[48:63]
s_waitcnt lgkmcnt(2)
ds_read_b128 v[24:27], v64 offset:24576
v_mfma_f32_32x32x16_bf16 v[48:63], v[12:15], v[180:183], v[48:63]
s_waitcnt lgkmcnt(2)
ds_read_b128 v[8:11], v64 offset:25600
v_mfma_f32_32x32x16_bf16 v[48:63], v[16:19], v[184:187], v[48:63]
s_waitcnt lgkmcnt(2)
ds_read_b128 v[12:15], v64 offset:26624
v_mfma_f32_32x32x16_bf16 v[48:63], v[20:23], v[188:191], v[48:63]
s_waitcnt lgkmcnt(2)
ds_read_b128 v[16:19], v64 offset:27648
v_mfma_f32_32x32x16_bf16 v[48:63], v[24:27], v[192:195], v[48:63]
s_waitcnt lgkmcnt(2)
ds_read_b128 v[20:23], v64 offset:28672
v_mfma_f32_32x32x16_bf16 v[48:63], v[8:11], v[196:199], v[48:63]
s_waitcnt lgkmcnt(2)
ds_read_b128 v[24:27], v64 offset:29696
v_mfma_f32_32x32x16_bf16 v[48:63], v[12:15], v[200:203], v[48:63]
s_waitcnt lgkmcnt(2)
ds_read_b128 v[8:11], v64 offset:30720
v_mfma_f32_32x32x16_bf16 v[48:63], v[16:19], v[204:207], v[48:63]
s_waitcnt lgkmcnt(2)
ds_read_b128 v[12:15], v64 offset:31744
v_mfma_f32_32x32x16_bf16 v[48:63], v[20:23], v[208:211], v[48:63]
s_waitcnt lgkmcnt(2)
ds_read_b128 v[16:19], v64 offset:32768
v_mfma_f32_32x32x16_bf16 v[48:63], v[24:27], v[212:215], v[48:63]
s_waitcnt lgkmcnt(2)
ds_read_b128 v[20:23], v64 offset:33792
v_mfma_f32_32x32x16_bf16 v[48:63], v[8:11], v[216:219], v[48:63]
s_waitcnt lgkmcnt(2)
ds_read_b128 v[24:27], v64 offset:34816
v_mfma_f32_32x32x16_bf16 v[48:63], v[12:15], v[220:223], v[48:63]
s_waitcnt lgkmcnt(2)
ds_read_b128 v[8:11], v64 offset:35840
v_mfma_f32_32x32x16_bf16 v[48:63], v[16:19], v[224:227], v[48:63]
s_waitcnt lgkmcnt(2)
ds_read_b128 v[12:15], v64 offset:36864
v_mfma_f32_32x32x16_bf16 v[48:63], v[20:23], v[228:231], v[48:63]
s_waitcnt lgkmcnt(2)
ds_read_b128 v[16:19], v64 offset:37888
v_mfma_f32_32x32x16_bf16 v[48:63], v[24:27], v[232:235], v[48:63]
s_waitcnt lgkmcnt(2)
ds_read_b128 v[20:23], v64 offset:38912
v_mfma_f32_32x32x16_bf16 v[48:63], v[8:11], v[236:239], v[48:63]
s_waitcnt lgkmcnt(2)
ds_read_b128 v[24:27], v64 offset:39936
v_mfma_f32_32x32x16_bf16 v[48:63], v[12:15], v[240:243], v[48:63]
s_add_u32 s44, s44, 1
s_cmp_eq_u32 s44, 3
s_mov_b32 s56, 40960
s_cmov_b32 s56, -81920
s_cselect_b32 s44, 0, s44
v_add_u32 v64, s56, v64
s_waitcnt vmcnt(10) lgkmcnt(2)
s_barrier
ds_read_b128 v[8:11], v64 offset:0
v_mfma_f32_32x32x16_bf16 v[48:63], v[16:19], v[244:247], v[48:63]
s_waitcnt lgkmcnt(2)
ds_read_b128 v[12:15], v64 offset:1024
v_mfma_f32_32x32x16_bf16 v[48:63], v[20:23], v[248:251], v[48:63]
s_waitcnt lgkmcnt(2)
ds_read_b128 v[16:19], v64 offset:2048
v_mfma_f32_32x32x16_bf16 v[48:63], v[24:27], v[252:255], v[48:63]
s_waitcnt lgkmcnt(2)
ds_read_b128 v[20:23], v64 offset:3072
v_mfma_f32_32x32x16_bf16 v[32:47], v[8:11], v[96:99], 0
s_waitcnt lgkmcnt(2)
ds_read_b128 v[24:27], v64 offset:4096
v_mfma_f32_32x32x16_bf16 v[32:47], v[12:15], v[100:103], v[32:47]
s_waitcnt lgkmcnt(2)
ds_read_b128 v[8:11], v64 offset:5120
v_cvt_pk_bf16_f32 v48, v48, v49
v_cvt_pk_bf16_f32 v49, v50, v51
v_mfma_f32_32x32x16_bf16 v[32:47], v[16:19], v[104:107], v[32:47]
s_waitcnt lgkmcnt(2)
ds_read_b128 v[12:15], v64 offset:6144
v_cvt_pk_bf16_f32 v50, v52, v53
v_cvt_pk_bf16_f32 v51, v54, v55
v_mfma_f32_32x32x16_bf16 v[32:47], v[20:23], v[108:111], v[32:47]
s_waitcnt lgkmcnt(2)
ds_read_b128 v[16:19], v64 offset:7168
v_cvt_pk_bf16_f32 v52, v56, v57
v_cvt_pk_bf16_f32 v53, v58, v59
v_mfma_f32_32x32x16_bf16 v[32:47], v[24:27], v[112:115], v[32:47]
s_waitcnt lgkmcnt(2)
ds_read_b128 v[20:23], v64 offset:8192
v_cvt_pk_bf16_f32 v54, v60, v61
v_cvt_pk_bf16_f32 v55, v62, v63
v_mfma_f32_32x32x16_bf16 v[32:47], v[8:11], v[116:119], v[32:47]
s_waitcnt lgkmcnt(2)
ds_read_b128 v[24:27], v64 offset:9216
v_accvgpr_write_b32 a104, v48
v_accvgpr_write_b32 a105, v49
v_mfma_f32_32x32x16_bf16 v[32:47], v[12:15], v[120:123], v[32:47]
s_waitcnt lgkmcnt(2)
ds_read_b128 v[8:11], v64 offset:10240
v_accvgpr_write_b32 a106, v50
v_accvgpr_write_b32 a107, v51
v_mfma_f32_32x32x16_bf16 v[32:47], v[16:19], v[124:127], v[32:47]
s_waitcnt lgkmcnt(2)
ds_read_b128 v[12:15], v64 offset:11264
v_accvgpr_write_b32 a108, v52
v_accvgpr_write_b32 a109, v53
v_mfma_f32_32x32x16_bf16 v[32:47], v[20:23], v[128:131], v[32:47]
s_waitcnt lgkmcnt(2)
ds_read_b128 v[16:19], v64 offset:12288
v_accvgpr_write_b32 a110, v54
v_accvgpr_write_b32 a111, v55
v_mfma_f32_32x32x16_bf16 v[32:47], v[24:27], v[132:135], v[32:47]
s_waitcnt lgkmcnt(2)
ds_read_b128 v[20:23], v64 offset:13312
s_add_u32 m0, s45, 0
s_add_u32 s55, s46, 0
buffer_load_dwordx4 v0, s[4:7], s55 offen offset:0 sc1 lds
buffer_load_dwordx4 v0, s[4:7], s55 offen offset:1024 sc1 lds
v_mfma_f32_32x32x16_bf16 v[32:47], v[8:11], v[136:139], v[32:47]
s_waitcnt lgkmcnt(2)
ds_read_b128 v[24:27], v64 offset:14336
buffer_load_dwordx4 v0, s[4:7], s55 offen offset:2048 sc1 lds
buffer_load_dwordx4 v0, s[4:7], s55 offen offset:3072 sc1 lds
v_mfma_f32_32x32x16_bf16 v[32:47], v[12:15], v[140:143], v[32:47]
s_waitcnt lgkmcnt(2)
ds_read_b128 v[8:11], v64 offset:15360
s_add_u32 m0, s45, 4096
s_add_u32 s55, s46, 4096
buffer_load_dwordx4 v0, s[4:7], s55 offen offset:0 sc1 lds
buffer_load_dwordx4 v0, s[4:7], s55 offen offset:1024 sc1 lds
v_mfma_f32_32x32x16_bf16 v[32:47], v[16:19], v[144:147], v[32:47]
s_waitcnt lgkmcnt(2)
ds_read_b128 v[12:15], v64 offset:16384
buffer_load_dwordx4 v0, s[4:7], s55 offen offset:2048 sc1 lds
buffer_load_dwordx4 v0, s[4:7], s55 offen offset:3072 sc1 lds
v_mfma_f32_32x32x16_bf16 v[32:47], v[20:23], v[148:151], v[32:47]
s_waitcnt lgkmcnt(2)
ds_read_b128 v[16:19], v64 offset:17408
s_add_u32 m0, s45, 8192
s_add_u32 s55, s46, 8192
buffer_load_dwordx4 v0, s[4:7], s55 offen offset:0 sc1 lds
buffer_load_dwordx4 v0, s[4:7], s55 offen offset:1024 sc1 lds
v_mfma_f32_32x32x16_bf16 v[32:47], v[24:27], v[152:155], v[32:47]
s_waitcnt lgkmcnt(2)
ds_read_b128 v[20:23], v64 offset:18432
s_add_u32 s45, s45, 40960
s_cmp_ge_u32 s45, 122880
s_cselect_b32 s55, 122880, 0
s_sub_u32 s45, s45, s55
s_add_u32 s46, s46, 40960
v_mfma_f32_32x32x16_bf16 v[32:47], v[8:11], v[156:159], v[32:47]
s_waitcnt lgkmcnt(2)
ds_read_b128 v[24:27], v64 offset:19456
v_mfma_f32_32x32x16_bf16 v[32:47], v[12:15], v[160:163], v[32:47]
s_waitcnt lgkmcnt(2)
ds_read_b128 v[8:11], v64 offset:20480
v_mfma_f32_32x32x16_bf16 v[32:47], v[16:19], v[164:167], v[32:47]
s_waitcnt lgkmcnt(2)
ds_read_b128 v[12:15], v64 offset:21504
v_mfma_f32_32x32x16_bf16 v[32:47], v[20:23], v[168:171], v[32:47]
s_waitcnt lgkmcnt(2)
ds_read_b128 v[16:19], v64 offset:22528
v_mfma_f32_32x32x16_bf16 v[32:47], v[24:27], v[172:175], v[32:47]
s_waitcnt lgkmcnt(2)
ds_read_b128 v[20:23], v64 offset:23552
v_mfma_f32_32x32x16_bf16 v[32:47], v[8:11], v[176:179], v[32:47]
s_waitcnt lgkmcnt(2)
ds_read_b128 v[24:27], v64 offset:24576
v_mfma_f32_32x32x16_bf16 v[32:47], v[12:15], v[180:183], v[32:47]
s_waitcnt lgkmcnt(2)
ds_read_b128 v[8:11], v64 offset:25600
v_mfma_f32_32x32x16_bf16 v[32:47], v[16:19], v[184:187], v[32:47]
s_waitcnt lgkmcnt(2)
ds_read_b128 v[12:15], v64 offset:26624
v_mfma_f32_32x32x16_bf16 v[32:47], v[20:23], v[188:191], v[32:47]
s_waitcnt lgkmcnt(2)
ds_read_b128 v[16:19], v64 offset:27648
v_mfma_f32_32x32x16_bf16 v[32:47], v[24:27], v[192:195], v[32:47]
s_waitcnt lgkmcnt(2)
ds_read_b128 v[20:23], v64 offset:28672
v_mfma_f32_32x32x16_bf16 v[32:47], v[8:11], v[196:199], v[32:47]
s_waitcnt lgkmcnt(2)
ds_read_b128 v[24:27], v64 offset:29696
v_mfma_f32_32x32x16_bf16 v[32:47], v[12:15], v[200:203], v[32:47]
s_waitcnt lgkmcnt(2)
ds_read_b128 v[8:11], v64 offset:30720
v_mfma_f32_32x32x16_bf16 v[32:47], v[16:19], v[204:207], v[32:47]
s_waitcnt lgkmcnt(2)
ds_read_b128 v[12:15], v64 offset:31744
v_mfma_f32_32x32x16_bf16 v[32:47], v[20:23], v[208:211], v[32:47]
s_waitcnt lgkmcnt(2)
ds_read_b128 v[16:19], v64 offset:32768
v_mfma_f32_32x32x16_bf16 v[32:47], v[24:27], v[212:215], v[32:47]
s_waitcnt lgkmcnt(2)
ds_read_b128 v[20:23], v64 offset:33792
v_mfma_f32_32x32x16_bf16 v[32:47], v[8:11], v[216:219], v[32:47]
s_waitcnt lgkmcnt(2)
ds_read_b128 v[24:27], v64 offset:34816
v_mfma_f32_32x32x16_bf16 v[32:47], v[12:15], v[220:223], v[32:47]
s_waitcnt lgkmcnt(2)
ds_read_b128 v[8:11], v64 offset:35840
v_mfma_f32_32x32x16_bf16 v[32:47], v[16:19], v[224:227], v[32:47]
s_waitcnt lgkmcnt(2)
ds_read_b128 v[12:15], v64 offset:36864
v_mfma_f32_32x32x16_bf16 v[32:47], v[20:23], v[228:231], v[32:47]
s_waitcnt lgkmcnt(2)
ds_read_b128 v[16:19], v64 offset:37888
v_mfma_f32_32x32x16_bf16 v[32:47], v[24:27], v[232:235], v[32:47]
s_waitcnt lgkmcnt(2)
ds_read_b128 v[20:23], v64 offset:38912
v_mfma_f32_32x32x16_bf16 v[32:47], v[8:11], v[236:239], v[32:47]
s_waitcnt lgkmcnt(2)
ds_read_b128 v[24:27], v64 offset:39936
v_mfma_f32_32x32x16_bf16 v[32:47], v[12:15], v[240:243], v[32:47]
s_add_u32 s44, s44, 1
s_cmp_eq_u32 s44, 3
s_mov_b32 s56, 40960
s_cmov_b32 s56, -81920
s_cselect_b32 s44, 0, s44
v_add_u32 v64, s56, v64
s_waitcnt vmcnt(10) lgkmcnt(2)
s_barrier
ds_read_b128 v[8:11], v64 offset:0
v_mfma_f32_32x32x16_bf16 v[32:47], v[16:19], v[244:247], v[32:47]
s_waitcnt lgkmcnt(2)
ds_read_b128 v[12:15], v64 offset:1024
v_mfma_f32_32x32x16_bf16 v[32:47], v[20:23], v[248:251], v[32:47]
s_waitcnt lgkmcnt(2)
ds_read_b128 v[16:19], v64 offset:2048
v_mfma_f32_32x32x16_bf16 v[32:47], v[24:27], v[252:255], v[32:47]
s_waitcnt lgkmcnt(2)
ds_read_b128 v[20:23], v64 offset:3072
v_mfma_f32_32x32x16_bf16 v[48:63], v[8:11], v[96:99], 0
s_waitcnt lgkmcnt(2)
ds_read_b128 v[24:27], v64 offset:4096
v_mfma_f32_32x32x16_bf16 v[48:63], v[12:15], v[100:103], v[48:63]
s_waitcnt lgkmcnt(2)
ds_read_b128 v[8:11], v64 offset:5120
v_cvt_pk_bf16_f32 v32, v32, v33
v_cvt_pk_bf16_f32 v33, v34, v35
v_mfma_f32_32x32x16_bf16 v[48:63], v[16:19], v[104:107], v[48:63]
s_waitcnt lgkmcnt(2)
ds_read_b128 v[12:15], v64 offset:6144
v_cvt_pk_bf16_f32 v34, v36, v37
v_cvt_pk_bf16_f32 v35, v38, v39
v_mfma_f32_32x32x16_bf16 v[48:63], v[20:23], v[108:111], v[48:63]
s_waitcnt lgkmcnt(2)
ds_read_b128 v[16:19], v64 offset:7168
v_cvt_pk_bf16_f32 v36, v40, v41
v_cvt_pk_bf16_f32 v37, v42, v43
v_mfma_f32_32x32x16_bf16 v[48:63], v[24:27], v[112:115], v[48:63]
s_waitcnt lgkmcnt(2)
ds_read_b128 v[20:23], v64 offset:8192
v_cvt_pk_bf16_f32 v38, v44, v45
v_cvt_pk_bf16_f32 v39, v46, v47
v_mfma_f32_32x32x16_bf16 v[48:63], v[8:11], v[116:119], v[48:63]
s_waitcnt lgkmcnt(2)
ds_read_b128 v[24:27], v64 offset:9216
v_accvgpr_write_b32 a112, v32
v_accvgpr_write_b32 a113, v33
v_mfma_f32_32x32x16_bf16 v[48:63], v[12:15], v[120:123], v[48:63]
s_waitcnt lgkmcnt(2)
ds_read_b128 v[8:11], v64 offset:10240
v_accvgpr_write_b32 a114, v34
v_accvgpr_write_b32 a115, v35
v_mfma_f32_32x32x16_bf16 v[48:63], v[16:19], v[124:127], v[48:63]
s_waitcnt lgkmcnt(2)
ds_read_b128 v[12:15], v64 offset:11264
v_accvgpr_write_b32 a116, v36
v_accvgpr_write_b32 a117, v37
v_mfma_f32_32x32x16_bf16 v[48:63], v[20:23], v[128:131], v[48:63]
s_waitcnt lgkmcnt(2)
ds_read_b128 v[16:19], v64 offset:12288
v_accvgpr_write_b32 a118, v38
v_accvgpr_write_b32 a119, v39
v_mfma_f32_32x32x16_bf16 v[48:63], v[24:27], v[132:135], v[48:63]
s_waitcnt lgkmcnt(2)
ds_read_b128 v[20:23], v64 offset:13312
s_add_u32 m0, s45, 0
s_add_u32 s55, s46, 0
buffer_load_dwordx4 v0, s[4:7], s55 offen offset:0 sc1 lds
buffer_load_dwordx4 v0, s[4:7], s55 offen offset:1024 sc1 lds
v_mfma_f32_32x32x16_bf16 v[48:63], v[8:11], v[136:139], v[48:63]
s_waitcnt lgkmcnt(2)
ds_read_b128 v[24:27], v64 offset:14336
buffer_load_dwordx4 v0, s[4:7], s55 offen offset:2048 sc1 lds
buffer_load_dwordx4 v0, s[4:7], s55 offen offset:3072 sc1 lds
v_mfma_f32_32x32x16_bf16 v[48:63], v[12:15], v[140:143], v[48:63]
s_waitcnt lgkmcnt(2)
ds_read_b128 v[8:11], v64 offset:15360
s_add_u32 m0, s45, 4096
s_add_u32 s55, s46, 4096
buffer_load_dwordx4 v0, s[4:7], s55 offen offset:0 sc1 lds
buffer_load_dwordx4 v0, s[4:7], s55 offen offset:1024 sc1 lds
v_mfma_f32_32x32x16_bf16 v[48:63], v[16:19], v[144:147], v[48:63]
s_waitcnt lgkmcnt(2)
ds_read_b128 v[12:15], v64 offset:16384
buffer_load_dwordx4 v0, s[4:7], s55 offen offset:2048 sc1 lds
buffer_load_dwordx4 v0, s[4:7], s55 offen offset:3072 sc1 lds
v_mfma_f32_32x32x16_bf16 v[48:63], v[20:23], v[148:151], v[48:63]
s_waitcnt lgkmcnt(2)
ds_read_b128 v[16:19], v64 offset:17408
s_add_u32 m0, s45, 8192
s_add_u32 s55, s46, 8192
buffer_load_dwordx4 v0, s[4:7], s55 offen offset:0 sc1 lds
buffer_load_dwordx4 v0, s[4:7], s55 offen offset:1024 sc1 lds
v_mfma_f32_32x32x16_bf16 v[48:63], v[24:27], v[152:155], v[48:63]
s_waitcnt lgkmcnt(2)
ds_read_b128 v[20:23], v64 offset:18432
s_add_u32 s45, s45, 40960
s_cmp_ge_u32 s45, 122880
s_cselect_b32 s55, 122880, 0
s_sub_u32 s45, s45, s55
s_add_u32 s46, s46, 40960
v_mfma_f32_32x32x16_bf16 v[48:63], v[8:11], v[156:159], v[48:63]
s_waitcnt lgkmcnt(2)
ds_read_b128 v[24:27], v64 offset:19456
v_mfma_f32_32x32x16_bf16 v[48:63], v[12:15], v[160:163], v[48:63]
s_waitcnt lgkmcnt(2)
ds_read_b128 v[8:11], v64 offset:20480
v_mfma_f32_32x32x16_bf16 v[48:63], v[16:19], v[164:167], v[48:63]
s_waitcnt lgkmcnt(2)
ds_read_b128 v[12:15], v64 offset:21504
v_mfma_f32_32x32x16_bf16 v[48:63], v[20:23], v[168:171], v[48:63]
s_waitcnt lgkmcnt(2)
ds_read_b128 v[16:19], v64 offset:22528
v_mfma_f32_32x32x16_bf16 v[48:63], v[24:27], v[172:175], v[48:63]
s_waitcnt lgkmcnt(2)
ds_read_b128 v[20:23], v64 offset:23552
v_mfma_f32_32x32x16_bf16 v[48:63], v[8:11], v[176:179], v[48:63]
s_waitcnt lgkmcnt(2)
ds_read_b128 v[24:27], v64 offset:24576
v_mfma_f32_32x32x16_bf16 v[48:63], v[12:15], v[180:183], v[48:63]
s_waitcnt lgkmcnt(2)
ds_read_b128 v[8:11], v64 offset:25600
v_mfma_f32_32x32x16_bf16 v[48:63], v[16:19], v[184:187], v[48:63]
s_waitcnt lgkmcnt(2)
ds_read_b128 v[12:15], v64 offset:26624
v_mfma_f32_32x32x16_bf16 v[48:63], v[20:23], v[188:191], v[48:63]
s_waitcnt lgkmcnt(2)
ds_read_b128 v[16:19], v64 offset:27648
v_mfma_f32_32x32x16_bf16 v[48:63], v[24:27], v[192:195], v[48:63]
s_waitcnt lgkmcnt(2)
ds_read_b128 v[20:23], v64 offset:28672
v_mfma_f32_32x32x16_bf16 v[48:63], v[8:11], v[196:199], v[48:63]
s_waitcnt lgkmcnt(2)
ds_read_b128 v[24:27], v64 offset:29696
v_mfma_f32_32x32x16_bf16 v[48:63], v[12:15], v[200:203], v[48:63]
s_waitcnt lgkmcnt(2)
ds_read_b128 v[8:11], v64 offset:30720
v_mfma_f32_32x32x16_bf16 v[48:63], v[16:19], v[204:207], v[48:63]
s_waitcnt lgkmcnt(2)
ds_read_b128 v[12:15], v64 offset:31744
v_mfma_f32_32x32x16_bf16 v[48:63], v[20:23], v[208:211], v[48:63]
s_waitcnt lgkmcnt(2)
ds_read_b128 v[16:19], v64 offset:32768
v_mfma_f32_32x32x16_bf16 v[48:63], v[24:27], v[212:215], v[48:63]
s_waitcnt lgkmcnt(2)
ds_read_b128 v[20:23], v64 offset:33792
v_mfma_f32_32x32x16_bf16 v[48:63], v[8:11], v[216:219], v[48:63]
s_waitcnt lgkmcnt(2)
ds_read_b128 v[24:27], v64 offset:34816
v_mfma_f32_32x32x16_bf16 v[48:63], v[12:15], v[220:223], v[48:63]
s_waitcnt lgkmcnt(2)
ds_read_b128 v[8:11], v64 offset:35840
v_mfma_f32_32x32x16_bf16 v[48:63], v[16:19], v[224:227], v[48:63]
s_waitcnt lgkmcnt(2)
ds_read_b128 v[12:15], v64 offset:36864
v_mfma_f32_32x32x16_bf16 v[48:63], v[20:23], v[228:231], v[48:63]
s_waitcnt lgkmcnt(2)
ds_read_b128 v[16:19], v64 offset:37888
v_mfma_f32_32x32x16_bf16 v[48:63], v[24:27], v[232:235], v[48:63]
s_waitcnt lgkmcnt(2)
ds_read_b128 v[20:23], v64 offset:38912
v_mfma_f32_32x32x16_bf16 v[48:63], v[8:11], v[236:239], v[48:63]
s_waitcnt lgkmcnt(2)
ds_read_b128 v[24:27], v64 offset:39936
v_mfma_f32_32x32x16_bf16 v[48:63], v[12:15], v[240:243], v[48:63]
s_add_u32 s44, s44, 1
s_cmp_eq_u32 s44, 3
s_mov_b32 s56, 40960
s_cmov_b32 s56, -81920
s_cselect_b32 s44, 0, s44
v_add_u32 v64, s56, v64
s_waitcnt vmcnt(10) lgkmcnt(2)
s_barrier
ds_read_b128 v[8:11], v64 offset:0
v_mfma_f32_32x32x16_bf16 v[48:63], v[16:19], v[244:247], v[48:63]
s_waitcnt lgkmcnt(2)
ds_read_b128 v[12:15], v64 offset:1024
v_mfma_f32_32x32x16_bf16 v[48:63], v[20:23], v[248:251], v[48:63]
s_waitcnt lgkmcnt(2)
ds_read_b128 v[16:19], v64 offset:2048
v_mfma_f32_32x32x16_bf16 v[48:63], v[24:27], v[252:255], v[48:63]
s_waitcnt lgkmcnt(2)
ds_read_b128 v[20:23], v64 offset:3072
v_mfma_f32_32x32x16_bf16 v[32:47], v[8:11], v[96:99], 0
s_waitcnt lgkmcnt(2)
ds_read_b128 v[24:27], v64 offset:4096
v_mfma_f32_32x32x16_bf16 v[32:47], v[12:15], v[100:103], v[32:47]
s_waitcnt lgkmcnt(2)
ds_read_b128 v[8:11], v64 offset:5120
v_cvt_pk_bf16_f32 v48, v48, v49
v_cvt_pk_bf16_f32 v49, v50, v51
v_mfma_f32_32x32x16_bf16 v[32:47], v[16:19], v[104:107], v[32:47]
s_waitcnt lgkmcnt(2)
ds_read_b128 v[12:15], v64 offset:6144
v_cvt_pk_bf16_f32 v50, v52, v53
v_cvt_pk_bf16_f32 v51, v54, v55
v_mfma_f32_32x32x16_bf16 v[32:47], v[20:23], v[108:111], v[32:47]
s_waitcnt lgkmcnt(2)
ds_read_b128 v[16:19], v64 offset:7168
v_cvt_pk_bf16_f32 v52, v56, v57
v_cvt_pk_bf16_f32 v53, v58, v59
v_mfma_f32_32x32x16_bf16 v[32:47], v[24:27], v[112:115], v[32:47]
s_waitcnt lgkmcnt(2)
ds_read_b128 v[20:23], v64 offset:8192
v_cvt_pk_bf16_f32 v54, v60, v61
v_cvt_pk_bf16_f32 v55, v62, v63
v_mfma_f32_32x32x16_bf16 v[32:47], v[8:11], v[116:119], v[32:47]
s_waitcnt lgkmcnt(2)
ds_read_b128 v[24:27], v64 offset:9216
v_accvgpr_write_b32 a120, v48
v_accvgpr_write_b32 a121, v49
v_mfma_f32_32x32x16_bf16 v[32:47], v[12:15], v[120:123], v[32:47]
s_waitcnt lgkmcnt(2)
ds_read_b128 v[8:11], v64 offset:10240
v_accvgpr_write_b32 a122, v50
v_accvgpr_write_b32 a123, v51
v_mfma_f32_32x32x16_bf16 v[32:47], v[16:19], v[124:127], v[32:47]
s_waitcnt lgkmcnt(2)
ds_read_b128 v[12:15], v64 offset:11264
v_accvgpr_write_b32 a124, v52
v_accvgpr_write_b32 a125, v53
v_mfma_f32_32x32x16_bf16 v[32:47], v[20:23], v[128:131], v[32:47]
s_waitcnt lgkmcnt(2)
ds_read_b128 v[16:19], v64 offset:12288
v_accvgpr_write_b32 a126, v54
v_accvgpr_write_b32 a127, v55
v_mfma_f32_32x32x16_bf16 v[32:47], v[24:27], v[132:135], v[32:47]
s_waitcnt lgkmcnt(2)
ds_read_b128 v[20:23], v64 offset:13312
s_add_u32 m0, s45, 0
s_add_u32 s55, s46, 0
buffer_load_dwordx4 v0, s[4:7], s55 offen offset:0 sc1 lds
buffer_load_dwordx4 v0, s[4:7], s55 offen offset:1024 sc1 lds
v_mfma_f32_32x32x16_bf16 v[32:47], v[8:11], v[136:139], v[32:47]
s_waitcnt lgkmcnt(2)
ds_read_b128 v[24:27], v64 offset:14336
buffer_load_dwordx4 v0, s[4:7], s55 offen offset:2048 sc1 lds
buffer_load_dwordx4 v0, s[4:7], s55 offen offset:3072 sc1 lds
v_mfma_f32_32x32x16_bf16 v[32:47], v[12:15], v[140:143], v[32:47]
s_waitcnt lgkmcnt(2)
ds_read_b128 v[8:11], v64 offset:15360
s_add_u32 m0, s45, 4096
s_add_u32 s55, s46, 4096
buffer_load_dwordx4 v0, s[4:7], s55 offen offset:0 sc1 lds
buffer_load_dwordx4 v0, s[4:7], s55 offen offset:1024 sc1 lds
v_mfma_f32_32x32x16_bf16 v[32:47], v[16:19], v[144:147], v[32:47]
s_waitcnt lgkmcnt(2)
ds_read_b128 v[12:15], v64 offset:16384
buffer_load_dwordx4 v0, s[4:7], s55 offen offset:2048 sc1 lds
buffer_load_dwordx4 v0, s[4:7], s55 offen offset:3072 sc1 lds
v_mfma_f32_32x32x16_bf16 v[32:47], v[20:23], v[148:151], v[32:47]
s_waitcnt lgkmcnt(2)
ds_read_b128 v[16:19], v64 offset:17408
s_add_u32 m0, s45, 8192
s_add_u32 s55, s46, 8192
buffer_load_dwordx4 v0, s[4:7], s55 offen offset:0 sc1 lds
buffer_load_dwordx4 v0, s[4:7], s55 offen offset:1024 sc1 lds
v_mfma_f32_32x32x16_bf16 v[32:47], v[24:27], v[152:155], v[32:47]
s_waitcnt lgkmcnt(2)
ds_read_b128 v[20:23], v64 offset:18432
s_add_u32 s45, s45, 40960
s_cmp_ge_u32 s45, 122880
s_cselect_b32 s55, 122880, 0
s_sub_u32 s45, s45, s55
s_add_u32 s46, s46, 40960
v_mfma_f32_32x32x16_bf16 v[32:47], v[8:11], v[156:159], v[32:47]
s_waitcnt lgkmcnt(2)
ds_read_b128 v[24:27], v64 offset:19456
v_mfma_f32_32x32x16_bf16 v[32:47], v[12:15], v[160:163], v[32:47]
s_waitcnt lgkmcnt(2)
ds_read_b128 v[8:11], v64 offset:20480
v_mfma_f32_32x32x16_bf16 v[32:47], v[16:19], v[164:167], v[32:47]
s_waitcnt lgkmcnt(2)
ds_read_b128 v[12:15], v64 offset:21504
v_mfma_f32_32x32x16_bf16 v[32:47], v[20:23], v[168:171], v[32:47]
s_waitcnt lgkmcnt(2)
ds_read_b128 v[16:19], v64 offset:22528
v_mfma_f32_32x32x16_bf16 v[32:47], v[24:27], v[172:175], v[32:47]
s_waitcnt lgkmcnt(2)
ds_read_b128 v[20:23], v64 offset:23552
v_mfma_f32_32x32x16_bf16 v[32:47], v[8:11], v[176:179], v[32:47]
s_waitcnt lgkmcnt(2)
ds_read_b128 v[24:27], v64 offset:24576
v_mfma_f32_32x32x16_bf16 v[32:47], v[12:15], v[180:183], v[32:47]
s_waitcnt lgkmcnt(2)
ds_read_b128 v[8:11], v64 offset:25600
v_mfma_f32_32x32x16_bf16 v[32:47], v[16:19], v[184:187], v[32:47]
s_waitcnt lgkmcnt(2)
ds_read_b128 v[12:15], v64 offset:26624
v_mfma_f32_32x32x16_bf16 v[32:47], v[20:23], v[188:191], v[32:47]
s_waitcnt lgkmcnt(2)
ds_read_b128 v[16:19], v64 offset:27648
v_mfma_f32_32x32x16_bf16 v[32:47], v[24:27], v[192:195], v[32:47]
s_waitcnt lgkmcnt(2)
ds_read_b128 v[20:23], v64 offset:28672
v_mfma_f32_32x32x16_bf16 v[32:47], v[8:11], v[196:199], v[32:47]
s_waitcnt lgkmcnt(2)
ds_read_b128 v[24:27], v64 offset:29696
v_mfma_f32_32x32x16_bf16 v[32:47], v[12:15], v[200:203], v[32:47]
s_waitcnt lgkmcnt(2)
ds_read_b128 v[8:11], v64 offset:30720
v_mfma_f32_32x32x16_bf16 v[32:47], v[16:19], v[204:207], v[32:47]
s_waitcnt lgkmcnt(2)
ds_read_b128 v[12:15], v64 offset:31744
v_mfma_f32_32x32x16_bf16 v[32:47], v[20:23], v[208:211], v[32:47]
s_waitcnt lgkmcnt(2)
ds_read_b128 v[16:19], v64 offset:32768
v_mfma_f32_32x32x16_bf16 v[32:47], v[24:27], v[212:215], v[32:47]
s_waitcnt lgkmcnt(2)
ds_read_b128 v[20:23], v64 offset:33792
v_mfma_f32_32x32x16_bf16 v[32:47], v[8:11], v[216:219], v[32:47]
s_waitcnt lgkmcnt(2)
ds_read_b128 v[24:27], v64 offset:34816
v_mfma_f32_32x32x16_bf16 v[32:47], v[12:15], v[220:223], v[32:47]
s_waitcnt lgkmcnt(2)
ds_read_b128 v[8:11], v64 offset:35840
v_mfma_f32_32x32x16_bf16 v[32:47], v[16:19], v[224:227], v[32:47]
s_waitcnt lgkmcnt(2)
ds_read_b128 v[12:15], v64 offset:36864
v_mfma_f32_32x32x16_bf16 v[32:47], v[20:23], v[228:231], v[32:47]
s_waitcnt lgkmcnt(2)
ds_read_b128 v[16:19], v64 offset:37888
v_mfma_f32_32x32x16_bf16 v[32:47], v[24:27], v[232:235], v[32:47]
s_waitcnt lgkmcnt(2)
ds_read_b128 v[20:23], v64 offset:38912
v_mfma_f32_32x32x16_bf16 v[32:47], v[8:11], v[236:239], v[32:47]
s_waitcnt lgkmcnt(2)
ds_read_b128 v[24:27], v64 offset:39936
v_mfma_f32_32x32x16_bf16 v[32:47], v[12:15], v[240:243], v[32:47]
s_add_u32 s44, s44, 1
s_cmp_eq_u32 s44, 3
s_mov_b32 s56, 40960
s_cmov_b32 s56, -81920
s_cselect_b32 s44, 0, s44
v_add_u32 v64, s56, v64
s_waitcnt vmcnt(10) lgkmcnt(2)
s_barrier
ds_read_b128 v[8:11], v64 offset:0
v_mfma_f32_32x32x16_bf16 v[32:47], v[16:19], v[244:247], v[32:47]
s_waitcnt lgkmcnt(2)
ds_read_b128 v[12:15], v64 offset:1024
v_mfma_f32_32x32x16_bf16 v[32:47], v[20:23], v[248:251], v[32:47]
s_waitcnt lgkmcnt(2)
ds_read_b128 v[16:19], v64 offset:2048
v_mfma_f32_32x32x16_bf16 v[32:47], v[24:27], v[252:255], v[32:47]
s_waitcnt lgkmcnt(2)
ds_read_b128 v[20:23], v64 offset:3072
v_mfma_f32_32x32x16_bf16 v[48:63], v[8:11], v[96:99], 0
s_waitcnt lgkmcnt(2)
ds_read_b128 v[24:27], v64 offset:4096
v_mfma_f32_32x32x16_bf16 v[48:63], v[12:15], v[100:103], v[48:63]
s_waitcnt lgkmcnt(2)
ds_read_b128 v[8:11], v64 offset:5120
v_cvt_pk_bf16_f32 v32, v32, v33
v_cvt_pk_bf16_f32 v33, v34, v35
v_mfma_f32_32x32x16_bf16 v[48:63], v[16:19], v[104:107], v[48:63]
s_waitcnt lgkmcnt(2)
ds_read_b128 v[12:15], v64 offset:6144
v_cvt_pk_bf16_f32 v34, v36, v37
v_cvt_pk_bf16_f32 v35, v38, v39
v_mfma_f32_32x32x16_bf16 v[48:63], v[20:23], v[108:111], v[48:63]
s_waitcnt lgkmcnt(2)
ds_read_b128 v[16:19], v64 offset:7168
v_cvt_pk_bf16_f32 v36, v40, v41
v_cvt_pk_bf16_f32 v37, v42, v43
v_mfma_f32_32x32x16_bf16 v[48:63], v[24:27], v[112:115], v[48:63]
s_waitcnt lgkmcnt(2)
ds_read_b128 v[20:23], v64 offset:8192
v_cvt_pk_bf16_f32 v38, v44, v45
v_cvt_pk_bf16_f32 v39, v46, v47
v_mfma_f32_32x32x16_bf16 v[48:63], v[8:11], v[116:119], v[48:63]
s_waitcnt lgkmcnt(2)
ds_read_b128 v[24:27], v64 offset:9216
v_accvgpr_write_b32 a128, v32
v_accvgpr_write_b32 a129, v33
v_mfma_f32_32x32x16_bf16 v[48:63], v[12:15], v[120:123], v[48:63]
s_waitcnt lgkmcnt(2)
ds_read_b128 v[8:11], v64 offset:10240
v_accvgpr_write_b32 a130, v34
v_accvgpr_write_b32 a131, v35
v_mfma_f32_32x32x16_bf16 v[48:63], v[16:19], v[124:127], v[48:63]
s_waitcnt lgkmcnt(2)
ds_read_b128 v[12:15], v64 offset:11264
v_accvgpr_write_b32 a132, v36
v_accvgpr_write_b32 a133, v37
v_mfma_f32_32x32x16_bf16 v[48:63], v[20:23], v[128:131], v[48:63]
s_waitcnt lgkmcnt(2)
ds_read_b128 v[16:19], v64 offset:12288
v_accvgpr_write_b32 a134, v38
v_accvgpr_write_b32 a135, v39
v_mfma_f32_32x32x16_bf16 v[48:63], v[24:27], v[132:135], v[48:63]
s_waitcnt lgkmcnt(2)
ds_read_b128 v[20:23], v64 offset:13312
s_add_u32 m0, s45, 0
s_add_u32 s55, s46, 0
buffer_load_dwordx4 v0, s[4:7], s55 offen offset:0 sc1 lds
buffer_load_dwordx4 v0, s[4:7], s55 offen offset:1024 sc1 lds
v_mfma_f32_32x32x16_bf16 v[48:63], v[8:11], v[136:139], v[48:63]
s_waitcnt lgkmcnt(2)
ds_read_b128 v[24:27], v64 offset:14336
buffer_load_dwordx4 v0, s[4:7], s55 offen offset:2048 sc1 lds
buffer_load_dwordx4 v0, s[4:7], s55 offen offset:3072 sc1 lds
v_mfma_f32_32x32x16_bf16 v[48:63], v[12:15], v[140:143], v[48:63]
s_waitcnt lgkmcnt(2)
ds_read_b128 v[8:11], v64 offset:15360
s_add_u32 m0, s45, 4096
s_add_u32 s55, s46, 4096
buffer_load_dwordx4 v0, s[4:7], s55 offen offset:0 sc1 lds
buffer_load_dwordx4 v0, s[4:7], s55 offen offset:1024 sc1 lds
v_mfma_f32_32x32x16_bf16 v[48:63], v[16:19], v[144:147], v[48:63]
s_waitcnt lgkmcnt(2)
ds_read_b128 v[12:15], v64 offset:16384
buffer_load_dwordx4 v0, s[4:7], s55 offen offset:2048 sc1 lds
buffer_load_dwordx4 v0, s[4:7], s55 offen offset:3072 sc1 lds
v_mfma_f32_32x32x16_bf16 v[48:63], v[20:23], v[148:151], v[48:63]
s_waitcnt lgkmcnt(2)
ds_read_b128 v[16:19], v64 offset:17408
s_add_u32 m0, s45, 8192
s_add_u32 s55, s46, 8192
buffer_load_dwordx4 v0, s[4:7], s55 offen offset:0 sc1 lds
buffer_load_dwordx4 v0, s[4:7], s55 offen offset:1024 sc1 lds
v_mfma_f32_32x32x16_bf16 v[48:63], v[24:27], v[152:155], v[48:63]
s_waitcnt lgkmcnt(2)
ds_read_b128 v[20:23], v64 offset:18432
s_add_u32 s45, s45, 40960
s_cmp_ge_u32 s45, 122880
s_cselect_b32 s55, 122880, 0
s_sub_u32 s45, s45, s55
s_add_u32 s46, s46, 40960
v_mfma_f32_32x32x16_bf16 v[48:63], v[8:11], v[156:159], v[48:63]
s_waitcnt lgkmcnt(2)
ds_read_b128 v[24:27], v64 offset:19456
v_mfma_f32_32x32x16_bf16 v[48:63], v[12:15], v[160:163], v[48:63]
s_waitcnt lgkmcnt(2)
ds_read_b128 v[8:11], v64 offset:20480
v_mfma_f32_32x32x16_bf16 v[48:63], v[16:19], v[164:167], v[48:63]
s_waitcnt lgkmcnt(2)
ds_read_b128 v[12:15], v64 offset:21504
v_mfma_f32_32x32x16_bf16 v[48:63], v[20:23], v[168:171], v[48:63]
s_waitcnt lgkmcnt(2)
ds_read_b128 v[16:19], v64 offset:22528
v_mfma_f32_32x32x16_bf16 v[48:63], v[24:27], v[172:175], v[48:63]
s_waitcnt lgkmcnt(2)
ds_read_b128 v[20:23], v64 offset:23552
v_mfma_f32_32x32x16_bf16 v[48:63], v[8:11], v[176:179], v[48:63]
s_waitcnt lgkmcnt(2)
ds_read_b128 v[24:27], v64 offset:24576
v_mfma_f32_32x32x16_bf16 v[48:63], v[12:15], v[180:183], v[48:63]
s_waitcnt lgkmcnt(2)
ds_read_b128 v[8:11], v64 offset:25600
v_mfma_f32_32x32x16_bf16 v[48:63], v[16:19], v[184:187], v[48:63]
s_waitcnt lgkmcnt(2)
ds_read_b128 v[12:15], v64 offset:26624
v_mfma_f32_32x32x16_bf16 v[48:63], v[20:23], v[188:191], v[48:63]
s_waitcnt lgkmcnt(2)
ds_read_b128 v[16:19], v64 offset:27648
v_mfma_f32_32x32x16_bf16 v[48:63], v[24:27], v[192:195], v[48:63]
s_waitcnt lgkmcnt(2)
ds_read_b128 v[20:23], v64 offset:28672
v_mfma_f32_32x32x16_bf16 v[48:63], v[8:11], v[196:199], v[48:63]
s_waitcnt lgkmcnt(2)
ds_read_b128 v[24:27], v64 offset:29696
v_mfma_f32_32x32x16_bf16 v[48:63], v[12:15], v[200:203], v[48:63]
s_waitcnt lgkmcnt(2)
ds_read_b128 v[8:11], v64 offset:30720
v_mfma_f32_32x32x16_bf16 v[48:63], v[16:19], v[204:207], v[48:63]
s_waitcnt lgkmcnt(2)
ds_read_b128 v[12:15], v64 offset:31744
v_mfma_f32_32x32x16_bf16 v[48:63], v[20:23], v[208:211], v[48:63]
s_waitcnt lgkmcnt(2)
ds_read_b128 v[16:19], v64 offset:32768
v_mfma_f32_32x32x16_bf16 v[48:63], v[24:27], v[212:215], v[48:63]
s_waitcnt lgkmcnt(2)
ds_read_b128 v[20:23], v64 offset:33792
v_mfma_f32_32x32x16_bf16 v[48:63], v[8:11], v[216:219], v[48:63]
s_waitcnt lgkmcnt(2)
ds_read_b128 v[24:27], v64 offset:34816
v_mfma_f32_32x32x16_bf16 v[48:63], v[12:15], v[220:223], v[48:63]
s_waitcnt lgkmcnt(2)
ds_read_b128 v[8:11], v64 offset:35840
v_mfma_f32_32x32x16_bf16 v[48:63], v[16:19], v[224:227], v[48:63]
s_waitcnt lgkmcnt(2)
ds_read_b128 v[12:15], v64 offset:36864
v_mfma_f32_32x32x16_bf16 v[48:63], v[20:23], v[228:231], v[48:63]
s_waitcnt lgkmcnt(2)
ds_read_b128 v[16:19], v64 offset:37888
v_mfma_f32_32x32x16_bf16 v[48:63], v[24:27], v[232:235], v[48:63]
s_waitcnt lgkmcnt(2)
ds_read_b128 v[20:23], v64 offset:38912
v_mfma_f32_32x32x16_bf16 v[48:63], v[8:11], v[236:239], v[48:63]
s_waitcnt lgkmcnt(2)
ds_read_b128 v[24:27], v64 offset:39936
v_mfma_f32_32x32x16_bf16 v[48:63], v[12:15], v[240:243], v[48:63]
s_add_u32 s44, s44, 1
s_cmp_eq_u32 s44, 3
s_mov_b32 s56, 40960
s_cmov_b32 s56, -81920
s_cselect_b32 s44, 0, s44
v_add_u32 v64, s56, v64
s_waitcnt vmcnt(10) lgkmcnt(2)
s_barrier
ds_read_b128 v[8:11], v64 offset:0
v_mfma_f32_32x32x16_bf16 v[48:63], v[16:19], v[244:247], v[48:63]
s_waitcnt lgkmcnt(2)
ds_read_b128 v[12:15], v64 offset:1024
v_mfma_f32_32x32x16_bf16 v[48:63], v[20:23], v[248:251], v[48:63]
s_waitcnt lgkmcnt(2)
ds_read_b128 v[16:19], v64 offset:2048
v_mfma_f32_32x32x16_bf16 v[48:63], v[24:27], v[252:255], v[48:63]
s_waitcnt lgkmcnt(2)
ds_read_b128 v[20:23], v64 offset:3072
v_mfma_f32_32x32x16_bf16 v[32:47], v[8:11], v[96:99], 0
s_waitcnt lgkmcnt(2)
ds_read_b128 v[24:27], v64 offset:4096
v_mfma_f32_32x32x16_bf16 v[32:47], v[12:15], v[100:103], v[32:47]
s_waitcnt lgkmcnt(2)
ds_read_b128 v[8:11], v64 offset:5120
v_cvt_pk_bf16_f32 v48, v48, v49
v_cvt_pk_bf16_f32 v49, v50, v51
v_mfma_f32_32x32x16_bf16 v[32:47], v[16:19], v[104:107], v[32:47]
s_waitcnt lgkmcnt(2)
ds_read_b128 v[12:15], v64 offset:6144
v_cvt_pk_bf16_f32 v50, v52, v53
v_cvt_pk_bf16_f32 v51, v54, v55
v_mfma_f32_32x32x16_bf16 v[32:47], v[20:23], v[108:111], v[32:47]
s_waitcnt lgkmcnt(2)
ds_read_b128 v[16:19], v64 offset:7168
v_cvt_pk_bf16_f32 v52, v56, v57
v_cvt_pk_bf16_f32 v53, v58, v59
v_mfma_f32_32x32x16_bf16 v[32:47], v[24:27], v[112:115], v[32:47]
s_waitcnt lgkmcnt(2)
ds_read_b128 v[20:23], v64 offset:8192
v_cvt_pk_bf16_f32 v54, v60, v61
v_cvt_pk_bf16_f32 v55, v62, v63
v_mfma_f32_32x32x16_bf16 v[32:47], v[8:11], v[116:119], v[32:47]
s_waitcnt lgkmcnt(2)
ds_read_b128 v[24:27], v64 offset:9216
v_accvgpr_write_b32 a136, v48
v_accvgpr_write_b32 a137, v49
v_mfma_f32_32x32x16_bf16 v[32:47], v[12:15], v[120:123], v[32:47]
s_waitcnt lgkmcnt(2)
ds_read_b128 v[8:11], v64 offset:10240
v_accvgpr_write_b32 a138, v50
v_accvgpr_write_b32 a139, v51
v_mfma_f32_32x32x16_bf16 v[32:47], v[16:19], v[124:127], v[32:47]
s_waitcnt lgkmcnt(2)
ds_read_b128 v[12:15], v64 offset:11264
v_accvgpr_write_b32 a140, v52
v_accvgpr_write_b32 a141, v53
v_mfma_f32_32x32x16_bf16 v[32:47], v[20:23], v[128:131], v[32:47]
s_waitcnt lgkmcnt(2)
ds_read_b128 v[16:19], v64 offset:12288
v_accvgpr_write_b32 a142, v54
v_accvgpr_write_b32 a143, v55
v_mfma_f32_32x32x16_bf16 v[32:47], v[24:27], v[132:135], v[32:47]
s_waitcnt lgkmcnt(2)
ds_read_b128 v[20:23], v64 offset:13312
s_add_u32 m0, s45, 0
s_add_u32 s55, s46, 0
buffer_load_dwordx4 v0, s[4:7], s55 offen offset:0 sc1 lds
buffer_load_dwordx4 v0, s[4:7], s55 offen offset:1024 sc1 lds
v_mfma_f32_32x32x16_bf16 v[32:47], v[8:11], v[136:139], v[32:47]
s_waitcnt lgkmcnt(2)
ds_read_b128 v[24:27], v64 offset:14336
buffer_load_dwordx4 v0, s[4:7], s55 offen offset:2048 sc1 lds
buffer_load_dwordx4 v0, s[4:7], s55 offen offset:3072 sc1 lds
v_mfma_f32_32x32x16_bf16 v[32:47], v[12:15], v[140:143], v[32:47]
s_waitcnt lgkmcnt(2)
ds_read_b128 v[8:11], v64 offset:15360
s_add_u32 m0, s45, 4096
s_add_u32 s55, s46, 4096
buffer_load_dwordx4 v0, s[4:7], s55 offen offset:0 sc1 lds
buffer_load_dwordx4 v0, s[4:7], s55 offen offset:1024 sc1 lds
v_mfma_f32_32x32x16_bf16 v[32:47], v[16:19], v[144:147], v[32:47]
s_waitcnt lgkmcnt(2)
ds_read_b128 v[12:15], v64 offset:16384
buffer_load_dwordx4 v0, s[4:7], s55 offen offset:2048 sc1 lds
buffer_load_dwordx4 v0, s[4:7], s55 offen offset:3072 sc1 lds
v_mfma_f32_32x32x16_bf16 v[32:47], v[20:23], v[148:151], v[32:47]
s_waitcnt lgkmcnt(2)
ds_read_b128 v[16:19], v64 offset:17408
s_add_u32 m0, s45, 8192
s_add_u32 s55, s46, 8192
buffer_load_dwordx4 v0, s[4:7], s55 offen offset:0 sc1 lds
buffer_load_dwordx4 v0, s[4:7], s55 offen offset:1024 sc1 lds
v_mfma_f32_32x32x16_bf16 v[32:47], v[24:27], v[152:155], v[32:47]
s_waitcnt lgkmcnt(2)
ds_read_b128 v[20:23], v64 offset:18432
s_add_u32 s45, s45, 40960
s_cmp_ge_u32 s45, 122880
s_cselect_b32 s55, 122880, 0
s_sub_u32 s45, s45, s55
s_add_u32 s46, s46, 40960
v_mfma_f32_32x32x16_bf16 v[32:47], v[8:11], v[156:159], v[32:47]
s_waitcnt lgkmcnt(2)
ds_read_b128 v[24:27], v64 offset:19456
v_mfma_f32_32x32x16_bf16 v[32:47], v[12:15], v[160:163], v[32:47]
s_waitcnt lgkmcnt(2)
ds_read_b128 v[8:11], v64 offset:20480
v_mfma_f32_32x32x16_bf16 v[32:47], v[16:19], v[164:167], v[32:47]
s_waitcnt lgkmcnt(2)
ds_read_b128 v[12:15], v64 offset:21504
v_mfma_f32_32x32x16_bf16 v[32:47], v[20:23], v[168:171], v[32:47]
s_waitcnt lgkmcnt(2)
ds_read_b128 v[16:19], v64 offset:22528
v_mfma_f32_32x32x16_bf16 v[32:47], v[24:27], v[172:175], v[32:47]
s_waitcnt lgkmcnt(2)
ds_read_b128 v[20:23], v64 offset:23552
v_mfma_f32_32x32x16_bf16 v[32:47], v[8:11], v[176:179], v[32:47]
s_waitcnt lgkmcnt(2)
ds_read_b128 v[24:27], v64 offset:24576
v_mfma_f32_32x32x16_bf16 v[32:47], v[12:15], v[180:183], v[32:47]
s_waitcnt lgkmcnt(2)
ds_read_b128 v[8:11], v64 offset:25600
v_mfma_f32_32x32x16_bf16 v[32:47], v[16:19], v[184:187], v[32:47]
s_waitcnt lgkmcnt(2)
ds_read_b128 v[12:15], v64 offset:26624
v_mfma_f32_32x32x16_bf16 v[32:47], v[20:23], v[188:191], v[32:47]
s_waitcnt lgkmcnt(2)
ds_read_b128 v[16:19], v64 offset:27648
v_mfma_f32_32x32x16_bf16 v[32:47], v[24:27], v[192:195], v[32:47]
s_waitcnt lgkmcnt(2)
ds_read_b128 v[20:23], v64 offset:28672
v_mfma_f32_32x32x16_bf16 v[32:47], v[8:11], v[196:199], v[32:47]
s_waitcnt lgkmcnt(2)
ds_read_b128 v[24:27], v64 offset:29696
v_mfma_f32_32x32x16_bf16 v[32:47], v[12:15], v[200:203], v[32:47]
s_waitcnt lgkmcnt(2)
ds_read_b128 v[8:11], v64 offset:30720
v_mfma_f32_32x32x16_bf16 v[32:47], v[16:19], v[204:207], v[32:47]
s_waitcnt lgkmcnt(2)
ds_read_b128 v[12:15], v64 offset:31744
v_mfma_f32_32x32x16_bf16 v[32:47], v[20:23], v[208:211], v[32:47]
s_waitcnt lgkmcnt(2)
ds_read_b128 v[16:19], v64 offset:32768
v_mfma_f32_32x32x16_bf16 v[32:47], v[24:27], v[212:215], v[32:47]
s_waitcnt lgkmcnt(2)
ds_read_b128 v[20:23], v64 offset:33792
v_mfma_f32_32x32x16_bf16 v[32:47], v[8:11], v[216:219], v[32:47]
s_waitcnt lgkmcnt(2)
ds_read_b128 v[24:27], v64 offset:34816
v_mfma_f32_32x32x16_bf16 v[32:47], v[12:15], v[220:223], v[32:47]
s_waitcnt lgkmcnt(2)
ds_read_b128 v[8:11], v64 offset:35840
v_mfma_f32_32x32x16_bf16 v[32:47], v[16:19], v[224:227], v[32:47]
s_waitcnt lgkmcnt(2)
ds_read_b128 v[12:15], v64 offset:36864
v_mfma_f32_32x32x16_bf16 v[32:47], v[20:23], v[228:231], v[32:47]
s_waitcnt lgkmcnt(2)
ds_read_b128 v[16:19], v64 offset:37888
v_mfma_f32_32x32x16_bf16 v[32:47], v[24:27], v[232:235], v[32:47]
s_waitcnt lgkmcnt(2)
ds_read_b128 v[20:23], v64 offset:38912
v_mfma_f32_32x32x16_bf16 v[32:47], v[8:11], v[236:239], v[32:47]
s_waitcnt lgkmcnt(2)
ds_read_b128 v[24:27], v64 offset:39936
v_mfma_f32_32x32x16_bf16 v[32:47], v[12:15], v[240:243], v[32:47]
s_add_u32 s44, s44, 1
s_cmp_eq_u32 s44, 3
s_mov_b32 s56, 40960
s_cmov_b32 s56, -81920
s_cselect_b32 s44, 0, s44
v_add_u32 v64, s56, v64
s_waitcnt vmcnt(10) lgkmcnt(2)
s_barrier
ds_read_b128 v[8:11], v64 offset:0
v_mfma_f32_32x32x16_bf16 v[32:47], v[16:19], v[244:247], v[32:47]
s_waitcnt lgkmcnt(2)
ds_read_b128 v[12:15], v64 offset:1024
v_mfma_f32_32x32x16_bf16 v[32:47], v[20:23], v[248:251], v[32:47]
s_waitcnt lgkmcnt(2)
ds_read_b128 v[16:19], v64 offset:2048
v_mfma_f32_32x32x16_bf16 v[32:47], v[24:27], v[252:255], v[32:47]
s_waitcnt lgkmcnt(2)
ds_read_b128 v[20:23], v64 offset:3072
v_mfma_f32_32x32x16_bf16 v[48:63], v[8:11], v[96:99], 0
s_waitcnt lgkmcnt(2)
ds_read_b128 v[24:27], v64 offset:4096
v_mfma_f32_32x32x16_bf16 v[48:63], v[12:15], v[100:103], v[48:63]
s_waitcnt lgkmcnt(2)
ds_read_b128 v[8:11], v64 offset:5120
v_cvt_pk_bf16_f32 v32, v32, v33
v_cvt_pk_bf16_f32 v33, v34, v35
v_mfma_f32_32x32x16_bf16 v[48:63], v[16:19], v[104:107], v[48:63]
s_waitcnt lgkmcnt(2)
ds_read_b128 v[12:15], v64 offset:6144
v_cvt_pk_bf16_f32 v34, v36, v37
v_cvt_pk_bf16_f32 v35, v38, v39
v_mfma_f32_32x32x16_bf16 v[48:63], v[20:23], v[108:111], v[48:63]
s_waitcnt lgkmcnt(2)
ds_read_b128 v[16:19], v64 offset:7168
v_cvt_pk_bf16_f32 v36, v40, v41
v_cvt_pk_bf16_f32 v37, v42, v43
v_mfma_f32_32x32x16_bf16 v[48:63], v[24:27], v[112:115], v[48:63]
s_waitcnt lgkmcnt(2)
ds_read_b128 v[20:23], v64 offset:8192
v_cvt_pk_bf16_f32 v38, v44, v45
v_cvt_pk_bf16_f32 v39, v46, v47
v_mfma_f32_32x32x16_bf16 v[48:63], v[8:11], v[116:119], v[48:63]
s_waitcnt lgkmcnt(2)
ds_read_b128 v[24:27], v64 offset:9216
v_accvgpr_write_b32 a144, v32
v_accvgpr_write_b32 a145, v33
v_mfma_f32_32x32x16_bf16 v[48:63], v[12:15], v[120:123], v[48:63]
s_waitcnt lgkmcnt(2)
ds_read_b128 v[8:11], v64 offset:10240
v_accvgpr_write_b32 a146, v34
v_accvgpr_write_b32 a147, v35
v_mfma_f32_32x32x16_bf16 v[48:63], v[16:19], v[124:127], v[48:63]
s_waitcnt lgkmcnt(2)
ds_read_b128 v[12:15], v64 offset:11264
v_accvgpr_write_b32 a148, v36
v_accvgpr_write_b32 a149, v37
v_mfma_f32_32x32x16_bf16 v[48:63], v[20:23], v[128:131], v[48:63]
s_waitcnt lgkmcnt(2)
ds_read_b128 v[16:19], v64 offset:12288
v_accvgpr_write_b32 a150, v38
v_accvgpr_write_b32 a151, v39
v_mfma_f32_32x32x16_bf16 v[48:63], v[24:27], v[132:135], v[48:63]
s_waitcnt lgkmcnt(2)
ds_read_b128 v[20:23], v64 offset:13312
s_add_u32 m0, s45, 0
s_add_u32 s55, s46, 0
buffer_load_dwordx4 v0, s[4:7], s55 offen offset:0 sc1 lds
buffer_load_dwordx4 v0, s[4:7], s55 offen offset:1024 sc1 lds
v_mfma_f32_32x32x16_bf16 v[48:63], v[8:11], v[136:139], v[48:63]
s_waitcnt lgkmcnt(2)
ds_read_b128 v[24:27], v64 offset:14336
buffer_load_dwordx4 v0, s[4:7], s55 offen offset:2048 sc1 lds
buffer_load_dwordx4 v0, s[4:7], s55 offen offset:3072 sc1 lds
v_mfma_f32_32x32x16_bf16 v[48:63], v[12:15], v[140:143], v[48:63]
s_waitcnt lgkmcnt(2)
ds_read_b128 v[8:11], v64 offset:15360
s_add_u32 m0, s45, 4096
s_add_u32 s55, s46, 4096
buffer_load_dwordx4 v0, s[4:7], s55 offen offset:0 sc1 lds
buffer_load_dwordx4 v0, s[4:7], s55 offen offset:1024 sc1 lds
v_mfma_f32_32x32x16_bf16 v[48:63], v[16:19], v[144:147], v[48:63]
s_waitcnt lgkmcnt(2)
ds_read_b128 v[12:15], v64 offset:16384
buffer_load_dwordx4 v0, s[4:7], s55 offen offset:2048 sc1 lds
buffer_load_dwordx4 v0, s[4:7], s55 offen offset:3072 sc1 lds
v_mfma_f32_32x32x16_bf16 v[48:63], v[20:23], v[148:151], v[48:63]
s_waitcnt lgkmcnt(2)
ds_read_b128 v[16:19], v64 offset:17408
s_add_u32 m0, s45, 8192
s_add_u32 s55, s46, 8192
buffer_load_dwordx4 v0, s[4:7], s55 offen offset:0 sc1 lds
buffer_load_dwordx4 v0, s[4:7], s55 offen offset:1024 sc1 lds
v_mfma_f32_32x32x16_bf16 v[48:63], v[24:27], v[152:155], v[48:63]
s_waitcnt lgkmcnt(2)
ds_read_b128 v[20:23], v64 offset:18432
s_add_u32 s45, s45, 40960
s_cmp_ge_u32 s45, 122880
s_cselect_b32 s55, 122880, 0
s_sub_u32 s45, s45, s55
s_add_u32 s46, s46, 40960
v_mfma_f32_32x32x16_bf16 v[48:63], v[8:11], v[156:159], v[48:63]
s_waitcnt lgkmcnt(2)
ds_read_b128 v[24:27], v64 offset:19456
v_mfma_f32_32x32x16_bf16 v[48:63], v[12:15], v[160:163], v[48:63]
s_waitcnt lgkmcnt(2)
ds_read_b128 v[8:11], v64 offset:20480
v_mfma_f32_32x32x16_bf16 v[48:63], v[16:19], v[164:167], v[48:63]
s_waitcnt lgkmcnt(2)
ds_read_b128 v[12:15], v64 offset:21504
v_mfma_f32_32x32x16_bf16 v[48:63], v[20:23], v[168:171], v[48:63]
s_waitcnt lgkmcnt(2)
ds_read_b128 v[16:19], v64 offset:22528
v_mfma_f32_32x32x16_bf16 v[48:63], v[24:27], v[172:175], v[48:63]
s_waitcnt lgkmcnt(2)
ds_read_b128 v[20:23], v64 offset:23552
v_mfma_f32_32x32x16_bf16 v[48:63], v[8:11], v[176:179], v[48:63]
s_waitcnt lgkmcnt(2)
ds_read_b128 v[24:27], v64 offset:24576
v_mfma_f32_32x32x16_bf16 v[48:63], v[12:15], v[180:183], v[48:63]
s_waitcnt lgkmcnt(2)
ds_read_b128 v[8:11], v64 offset:25600
v_mfma_f32_32x32x16_bf16 v[48:63], v[16:19], v[184:187], v[48:63]
s_waitcnt lgkmcnt(2)
ds_read_b128 v[12:15], v64 offset:26624
v_mfma_f32_32x32x16_bf16 v[48:63], v[20:23], v[188:191], v[48:63]
s_waitcnt lgkmcnt(2)
ds_read_b128 v[16:19], v64 offset:27648
v_mfma_f32_32x32x16_bf16 v[48:63], v[24:27], v[192:195], v[48:63]
s_waitcnt lgkmcnt(2)
ds_read_b128 v[20:23], v64 offset:28672
v_mfma_f32_32x32x16_bf16 v[48:63], v[8:11], v[196:199], v[48:63]
s_waitcnt lgkmcnt(2)
ds_read_b128 v[24:27], v64 offset:29696
v_mfma_f32_32x32x16_bf16 v[48:63], v[12:15], v[200:203], v[48:63]
s_waitcnt lgkmcnt(2)
ds_read_b128 v[8:11], v64 offset:30720
v_mfma_f32_32x32x16_bf16 v[48:63], v[16:19], v[204:207], v[48:63]
s_waitcnt lgkmcnt(2)
ds_read_b128 v[12:15], v64 offset:31744
v_mfma_f32_32x32x16_bf16 v[48:63], v[20:23], v[208:211], v[48:63]
s_waitcnt lgkmcnt(2)
ds_read_b128 v[16:19], v64 offset:32768
v_mfma_f32_32x32x16_bf16 v[48:63], v[24:27], v[212:215], v[48:63]
s_waitcnt lgkmcnt(2)
ds_read_b128 v[20:23], v64 offset:33792
v_mfma_f32_32x32x16_bf16 v[48:63], v[8:11], v[216:219], v[48:63]
s_waitcnt lgkmcnt(2)
ds_read_b128 v[24:27], v64 offset:34816
v_mfma_f32_32x32x16_bf16 v[48:63], v[12:15], v[220:223], v[48:63]
s_waitcnt lgkmcnt(2)
ds_read_b128 v[8:11], v64 offset:35840
v_mfma_f32_32x32x16_bf16 v[48:63], v[16:19], v[224:227], v[48:63]
s_waitcnt lgkmcnt(2)
ds_read_b128 v[12:15], v64 offset:36864
v_mfma_f32_32x32x16_bf16 v[48:63], v[20:23], v[228:231], v[48:63]
s_waitcnt lgkmcnt(2)
ds_read_b128 v[16:19], v64 offset:37888
v_mfma_f32_32x32x16_bf16 v[48:63], v[24:27], v[232:235], v[48:63]
s_waitcnt lgkmcnt(2)
ds_read_b128 v[20:23], v64 offset:38912
v_mfma_f32_32x32x16_bf16 v[48:63], v[8:11], v[236:239], v[48:63]
s_waitcnt lgkmcnt(2)
ds_read_b128 v[24:27], v64 offset:39936
v_mfma_f32_32x32x16_bf16 v[48:63], v[12:15], v[240:243], v[48:63]
s_add_u32 s44, s44, 1
s_cmp_eq_u32 s44, 3
s_mov_b32 s56, 40960
s_cmov_b32 s56, -81920
s_cselect_b32 s44, 0, s44
v_add_u32 v64, s56, v64
s_waitcnt vmcnt(10) lgkmcnt(2)
s_barrier
ds_read_b128 v[8:11], v64 offset:0
v_mfma_f32_32x32x16_bf16 v[48:63], v[16:19], v[244:247], v[48:63]
s_waitcnt lgkmcnt(2)
ds_read_b128 v[12:15], v64 offset:1024
v_mfma_f32_32x32x16_bf16 v[48:63], v[20:23], v[248:251], v[48:63]
s_waitcnt lgkmcnt(2)
ds_read_b128 v[16:19], v64 offset:2048
v_mfma_f32_32x32x16_bf16 v[48:63], v[24:27], v[252:255], v[48:63]
s_waitcnt lgkmcnt(2)
ds_read_b128 v[20:23], v64 offset:3072
s_nop 9
v_cvt_pk_bf16_f32 v48, v48, v49
v_cvt_pk_bf16_f32 v49, v50, v51
v_cvt_pk_bf16_f32 v50, v52, v53
v_cvt_pk_bf16_f32 v51, v54, v55
v_cvt_pk_bf16_f32 v52, v56, v57
v_cvt_pk_bf16_f32 v53, v58, v59
v_cvt_pk_bf16_f32 v54, v60, v61
v_cvt_pk_bf16_f32 v55, v62, v63
v_accvgpr_write_b32 a152, v48
v_accvgpr_write_b32 a153, v49
v_accvgpr_write_b32 a154, v50
v_accvgpr_write_b32 a155, v51
v_accvgpr_write_b32 a156, v52
v_accvgpr_write_b32 a157, v53
v_accvgpr_write_b32 a158, v54
v_accvgpr_write_b32 a159, v55
v_bfe_u32 v72, v0, 8, 1
v_and_b32 v1, 0xf0, v0
v_lshl_add_u32 v1, v72, 10, v1
v_and_b32 v2, 0x50, v0
v_lshl_add_u32 v2, v72, 13, v2
v_bfe_u32 v72, v0, 7, 1
v_lshl_add_u32 v2, v72, 5, v2
v_bfe_u32 v72, v0, 5, 1
v_lshl_add_u32 v2, v72, 12, v2
s_cmp_eq_u32 s58, 0
s_cselect_b64 vcc, -1, 0
v_cndmask_b32 v1, v1, v2, vcc
v_lshrrev_b32 v72, 9, v0
v_lshl_add_u32 v1, v72, 8, v1
s_lshl_b32 s52, s3, 10
v_add_u32 v73, s52, v0
v_mov_b32 v2, 2146435072
v_cmp_eq_u32 vcc, 0, v73
s_nop 1
v_cndmask_b32 v2, v2, 0, vcc
v_mov_b32 v3, 0xffff
v_cmp_gt_u32 vcc, 512, v73
s_nop 1
v_cndmask_b32 v3, -1, v3, vcc
v_and_b32 v7, 0x1f0, v0
v_lshrrev_b32 v28, 2, v7
v_lshlrev_b32 v7, 1, v7
v_add_u32 v7, 122880, v7
s_lshl_b32 s52, s3, 3
v_lshl_add_u32 v6, v72, 2, v7
v_add_u32 v6, s52, v6
s_lshl_b32 s52, s3, 7
s_add_u32 s52, s52, 124928
v_add_u32 v28, s52, v28
v_lshlrev_b32 v29, 4, v72
v_add_u32 v29, s52, v29
s_mov_b32 s51, 0
s_mov_b32 s50, 0
k_lay_30:
s_lshl_b32 s54, s51, 13
s_add_u32 s54, s54, 222298112
s_waitcnt vmcnt(0) lgkmcnt(0)
s_cmp_lg_u32 s3, 0
s_cbranch_scc1 k_w8d_34
v_lshlrev_b32 v8, 2, v0
k_w8_33:
buffer_load_dword v9, v8, s[4:7], s54 offen sc1
buffer_load_dword v10, v8, s[4:7], s54 offen offset:1024 sc1
s_waitcnt vmcnt(0)
v_and_b32 v9, v9, v10
v_cmp_eq_u32 vcc, 0, v9
s_cbranch_vccz k_w8d_34
s_sleep 1
s_sub_u32 s32, s32, 1
s_cmp_gt_i32 s32, 0
s_cbranch_scc1 k_w8_33
k_w8d_34:
s_barrier
s_mul_i32 s52, s3, 10240
v_add_u32 v5, s52, v0
s_mul_i32 s46, s51, 3145728
s_add_u32 s46, s46, s52
s_add_u32 s46, s46, 195035136
s_lshl_b32 s52, s57, 2
s_add_u32 s52, s52, s3
s_cmp_eq_u32 s58, 2
s_cselect_b32 s53, 11, 12
s_mov_b32 s49, 524288
s_cmov_b32 s49, 262144
s_lshl_b32 s48, s52, s53
s_lshr_b32 s52, s3, 1
s_mul_i32 s52, s52, 768
s_mul_i32 s53, s3, 3968
s_sub_u32 s52, s53, s52
s_cmp_eq_u32 s58, 0
s_cselect_b32 s52, s52, 0
s_sub_u32 s48, s48, s52
s_cmp_eq_u32 s58, 2
s_mov_b32 s52, 41943040
s_cmov_b32 s52, 16777216
s_cselect_b32 s53, 125829120, 0
s_mul_i32 s52, s52, s51
s_add_u32 s48, s48, s52
s_add_u32 s48, s48, s53
s_lshl_b32 s60, s57, 6
s_lshl_b32 s52, s58, 2
s_add_u32 s60, s60, s52
s_add_u32 s60, s60, 222330880
s_mov_b32 s61, 0x3acccccd
s_cmp_eq_u32 s58, 1
s_cbranch_scc1 k_isv_31
s_mul_i32 s45, s3, 10240
s_mov_b32 s44, 0
v_mov_b32 v64, v0
s_add_u32 m0, s45, 0
s_add_u32 s55, s46, 0
buffer_load_dwordx4 v0, s[4:7], s55 offen offset:0 sc1 lds
buffer_load_dwordx4 v0, s[4:7], s55 offen offset:1024 sc1 lds
buffer_load_dwordx4 v0, s[4:7], s55 offen offset:2048 sc1 lds
buffer_load_dwordx4 v0, s[4:7], s55 offen offset:3072 sc1 lds
s_add_u32 m0, s45, 4096
s_add_u32 s55, s46, 4096
buffer_load_dwordx4 v0, s[4:7], s55 offen offset:0 sc1 lds
buffer_load_dwordx4 v0, s[4:7], s55 offen offset:1024 sc1 lds
buffer_load_dwordx4 v0, s[4:7], s55 offen offset:2048 sc1 lds
buffer_load_dwordx4 v0, s[4:7], s55 offen offset:3072 sc1 lds
s_add_u32 m0, s45, 8192
s_add_u32 s55, s46, 8192
buffer_load_dwordx4 v0, s[4:7], s55 offen offset:0 sc1 lds
buffer_load_dwordx4 v0, s[4:7], s55 offen offset:1024 sc1 lds
s_add_u32 s45, s45, 40960
s_cmp_ge_u32 s45, 122880
s_cselect_b32 s55, 122880, 0
s_sub_u32 s45, s45, s55
s_add_u32 s46, s46, 40960
s_add_u32 m0, s45, 0
s_add_u32 s55, s46, 0
buffer_load_dwordx4 v0, s[4:7], s55 offen offset:0 sc1 lds
buffer_load_dwordx4 v0, s[4:7], s55 offen offset:1024 sc1 lds
buffer_load_dwordx4 v0, s[4:7], s55 offen offset:2048 sc1 lds
buffer_load_dwordx4 v0, s[4:7], s55 offen offset:3072 sc1 lds
s_add_u32 m0, s45, 4096
s_add_u32 s55, s46, 4096
buffer_load_dwordx4 v0, s[4:7], s55 offen offset:0 sc1 lds
buffer_load_dwordx4 v0, s[4:7], s55 offen offset:1024 sc1 lds
buffer_load_dwordx4 v0, s[4:7], s55 offen offset:2048 sc1 lds
buffer_load_dwordx4 v0, s[4:7], s55 offen offset:3072 sc1 lds
s_add_u32 m0, s45, 8192
s_add_u32 s55, s46, 8192
buffer_load_dwordx4 v0, s[4:7], s55 offen offset:0 sc1 lds
buffer_load_dwordx4 v0, s[4:7], s55 offen offset:1024 sc1 lds
s_add_u32 s45, s45, 40960
s_cmp_ge_u32 s45, 122880
s_cselect_b32 s55, 122880, 0
s_sub_u32 s45, s45, s55
s_add_u32 s46, s46, 40960
s_waitcnt vmcnt(10)
s_barrier
ds_read_b128 v[8:11], v64 offset:0
ds_read_b128 v[12:15], v64 offset:1024
ds_read_b128 v[16:19], v64 offset:2048
ds_read_b128 v[20:23], v64 offset:3072
s_mov_b32 s59, 32
s_waitcnt lgkmcnt(3)
v_mfma_f32_32x32x16_bf16 v[32:47], a[0:3], v[8:11], 0
s_waitcnt lgkmcnt(2)
ds_read_b128 v[24:27], v64 offset:4096
v_mfma_f32_32x32x16_bf16 v[32:47], a[4:7], v[12:15], v[32:47]
s_waitcnt lgkmcnt(2)
ds_read_b128 v[8:11], v64 offset:5120
ds_read_b128 v[72:75], v5
v_mov_b32 v4, 0
ds_read_b128 v[76:79], v5 offset:1024
v_mfma_f32_32x32x16_bf16 v[32:47], a[8:11], v[16:19], v[32:47]
s_waitcnt lgkmcnt(4)
ds_read_b128 v[12:15], v64 offset:6144
s_waitcnt lgkmcnt(2)
v_and_b32 v72, v3, v72
v_dot2c_f32_bf16 v4, v72, v72
v_dot2c_f32_bf16 v4, v73, v73
v_dot2c_f32_bf16 v4, v74, v74
v_dot2c_f32_bf16 v4, v75, v75
v_mfma_f32_32x32x16_bf16 v[32:47], a[12:15], v[20:23], v[32:47]
ds_read_b128 v[16:19], v64 offset:7168
ds_read_b128 v[72:75], v5 offset:2048
s_waitcnt lgkmcnt(3)
v_dot2c_f32_bf16 v4, v76, v76
v_dot2c_f32_bf16 v4, v77, v77
v_dot2c_f32_bf16 v4, v78, v78
v_dot2c_f32_bf16 v4, v79, v79
v_mfma_f32_32x32x16_bf16 v[32:47], a[16:19], v[24:27], v[32:47]
ds_read_b128 v[20:23], v64 offset:8192
ds_read_b128 v[76:79], v5 offset:3072
s_waitcnt lgkmcnt(2)
v_dot2c_f32_bf16 v4, v72, v72
v_dot2c_f32_bf16 v4, v73, v73
v_dot2c_f32_bf16 v4, v74, v74
v_dot2c_f32_bf16 v4, v75, v75
v_mfma_f32_32x32x16_bf16 v[32:47], a[20:23], v[8:11], v[32:47]
ds_read_b128 v[24:27], v64 offset:9216
ds_read_b128 v[72:75], v5 offset:4096
s_waitcnt lgkmcnt(2)
v_dot2c_f32_bf16 v4, v76, v76
v_dot2c_f32_bf16 v4, v77, v77
v_dot2c_f32_bf16 v4, v78, v78
v_dot2c_f32_bf16 v4, v79, v79
v_mfma_f32_32x32x16_bf16 v[32:47], a[24:27], v[12:15], v[32:47]
ds_read_b128 v[8:11], v64 offset:10240
ds_read_b128 v[76:79], v5 offset:5120
s_waitcnt lgkmcnt(2)
v_dot2c_f32_bf16 v4, v72, v72
v_dot2c_f32_bf16 v4, v73, v73
v_dot2c_f32_bf16 v4, v74, v74
v_dot2c_f32_bf16 v4, v75, v75
v_mfma_f32_32x32x16_bf16 v[32:47], a[28:31], v[16:19], v[32:47]
ds_read_b128 v[12:15], v64 offset:11264
ds_read_b128 v[72:75], v5 offset:6144
s_waitcnt lgkmcnt(2)
v_dot2c_f32_bf16 v4, v76, v76
v_dot2c_f32_bf16 v4, v77, v77
v_dot2c_f32_bf16 v4, v78, v78
v_dot2c_f32_bf16 v4, v79, v79
v_mfma_f32_32x32x16_bf16 v[32:47], a[32:35], v[20:23], v[32:47]
ds_read_b128 v[16:19], v64 offset:12288
ds_read_b128 v[76:79], v5 offset:7168
s_waitcnt lgkmcnt(2)
v_dot2c_f32_bf16 v4, v72, v72
v_dot2c_f32_bf16 v4, v73, v73
v_dot2c_f32_bf16 v4, v74, v74
v_dot2c_f32_bf16 v4, v75, v75
v_mfma_f32_32x32x16_bf16 v[32:47], a[36:39], v[24:27], v[32:47]
ds_read_b128 v[20:23], v64 offset:13312
ds_read_b128 v[72:75], v5 offset:8192
s_waitcnt lgkmcnt(2)
v_dot2c_f32_bf16 v4, v76, v76
v_dot2c_f32_bf16 v4, v77, v77
v_dot2c_f32_bf16 v4, v78, v78
v_dot2c_f32_bf16 v4, v79, v79
v_mfma_f32_32x32x16_bf16 v[32:47], a[40:43], v[8:11], v[32:47]
ds_read_b128 v[24:27], v64 offset:14336
ds_read_b128 v[76:79], v5 offset:9216
s_waitcnt lgkmcnt(2)
v_dot2c_f32_bf16 v4, v72, v72
v_dot2c_f32_bf16 v4, v73, v73
v_dot2c_f32_bf16 v4, v74, v74
v_dot2c_f32_bf16 v4, v75, v75
v_mfma_f32_32x32x16_bf16 v[32:47], a[44:47], v[12:15], v[32:47]
ds_read_b128 v[8:11], v64 offset:15360
s_waitcnt lgkmcnt(1)
v_dot2c_f32_bf16 v4, v76, v76
v_dot2c_f32_bf16 v4, v77, v77
v_dot2c_f32_bf16 v4, v78, v78
v_dot2c_f32_bf16 v4, v79, v79
s_nop 2
ds_write_b32 v6, v4 offset:0
v_mfma_f32_32x32x16_bf16 v[32:47], a[48:51], v[16:19], v[32:47]
ds_read_b128 v[12:15], v64 offset:16384
s_add_u32 m0, s45, 0
s_add_u32 s55, s46, 0
buffer_load_dwordx4 v0, s[4:7], s55 offen offset:0 sc1 lds
buffer_load_dwordx4 v0, s[4:7], s55 offen offset:1024 sc1 lds
v_mfma_f32_32x32x16_bf16 v[32:47], a[52:55], v[20:23], v[32:47]
ds_read_b128 v[16:19], v64 offset:17408
buffer_load_dwordx4 v0, s[4:7], s55 offen offset:2048 sc1 lds
buffer_load_dwordx4 v0, s[4:7], s55 offen offset:3072 sc1 lds
v_mfma_f32_32x32x16_bf16 v[32:47], a[56:59], v[24:27], v[32:47]
s_waitcnt lgkmcnt(3)
ds_read_b128 v[20:23], v64 offset:18432
s_add_u32 m0, s45, 4096
s_add_u32 s55, s46, 4096
buffer_load_dwordx4 v0, s[4:7], s55 offen offset:0 sc1 lds
buffer_load_dwordx4 v0, s[4:7], s55 offen offset:1024 sc1 lds
v_mfma_f32_32x32x16_bf16 v[32:47], a[60:63], v[8:11], v[32:47]
s_waitcnt lgkmcnt(2)
ds_read_b128 v[24:27], v64 offset:19456
buffer_load_dwordx4 v0, s[4:7], s55 offen offset:2048 sc1 lds
buffer_load_dwordx4 v0, s[4:7], s55 offen offset:3072 sc1 lds
v_mfma_f32_32x32x16_bf16 v[32:47], a[64:67], v[12:15], v[32:47]
s_waitcnt lgkmcnt(2)
ds_read_b128 v[8:11], v64 offset:20480
s_add_u32 m0, s45, 8192
s_add_u32 s55, s46, 8192
buffer_load_dwordx4 v0, s[4:7], s55 offen offset:0 sc1 lds
buffer_load_dwordx4 v0, s[4:7], s55 offen offset:1024 sc1 lds
v_mfma_f32_32x32x16_bf16 v[32:47], a[68:71], v[16:19], v[32:47]
s_waitcnt lgkmcnt(2)
ds_read_b128 v[12:15], v64 offset:21504
s_add_u32 s45, s45, 40960
s_cmp_ge_u32 s45, 122880
s_cselect_b32 s55, 122880, 0
s_sub_u32 s45, s45, s55
s_add_u32 s46, s46, 40960
v_mfma_f32_32x32x16_bf16 v[32:47], a[72:75], v[20:23], v[32:47]
s_waitcnt lgkmcnt(2)
ds_read_b128 v[16:19], v64 offset:22528
v_mfma_f32_32x32x16_bf16 v[32:47], a[76:79], v[24:27], v[32:47]
s_waitcnt lgkmcnt(2)
ds_read_b128 v[20:23], v64 offset:23552
v_mfma_f32_32x32x16_bf16 v[32:47], a[80:83], v[8:11], v[32:47]
s_waitcnt lgkmcnt(2)
ds_read_b128 v[24:27], v64 offset:24576
v_mfma_f32_32x32x16_bf16 v[32:47], a[84:87], v[12:15], v[32:47]
s_waitcnt lgkmcnt(2)
ds_read_b128 v[8:11], v64 offset:25600
v_mfma_f32_32x32x16_bf16 v[32:47], a[88:91], v[16:19], v[32:47]
s_waitcnt lgkmcnt(2)
ds_read_b128 v[12:15], v64 offset:26624
v_mfma_f32_32x32x16_bf16 v[32:47], a[92:95], v[20:23], v[32:47]
s_waitcnt lgkmcnt(2)
ds_read_b128 v[16:19], v64 offset:27648
v_mfma_f32_32x32x16_bf16 v[32:47], a[96:99], v[24:27], v[32:47]
s_waitcnt lgkmcnt(2)
ds_read_b128 v[20:23], v64 offset:28672
v_mfma_f32_32x32x16_bf16 v[32:47], a[100:103], v[8:11], v[32:47]
s_waitcnt lgkmcnt(2)
ds_read_b128 v[24:27], v64 offset:29696
v_mfma_f32_32x32x16_bf16 v[32:47], a[104:107], v[12:15], v[32:47]
s_waitcnt lgkmcnt(2)
ds_read_b128 v[8:11], v64 offset:30720
v_mfma_f32_32x32x16_bf16 v[32:47], a[108:111], v[16:19], v[32:47]
s_waitcnt lgkmcnt(2)
ds_read_b128 v[12:15], v64 offset:31744
v_mfma_f32_32x32x16_bf16 v[32:47], a[112:115], v[20:23], v[32:47]
s_waitcnt lgkmcnt(2)
ds_read_b128 v[16:19], v64 offset:32768
v_mfma_f32_32x32x16_bf16 v[32:47], a[116:119], v[24:27], v[32:47]
s_waitcnt lgkmcnt(2)
ds_read_b128 v[20:23], v64 offset:33792
v_mfma_f32_32x32x16_bf16 v[32:47], a[120:123], v[8:11], v[32:47]
s_waitcnt lgkmcnt(2)
ds_read_b128 v[24:27], v64 offset:34816
v_mfma_f32_32x32x16_bf16 v[32:47], a[124:127], v[12:15], v[32:47]
s_waitcnt lgkmcnt(2)
ds_read_b128 v[8:11], v64 offset:35840
v_mfma_f32_32x32x16_bf16 v[32:47], a[128:131], v[16:19], v[32:47]
s_waitcnt lgkmcnt(2)
ds_read_b128 v[12:15], v64 offset:36864
v_mfma_f32_32x32x16_bf16 v[32:47], a[132:135], v[20:23], v[32:47]
s_waitcnt lgkmcnt(2)
ds_read_b128 v[16:19], v64 offset:37888
v_mfma_f32_32x32x16_bf16 v[32:47], a[136:139], v[24:27], v[32:47]
s_waitcnt lgkmcnt(2)
ds_read_b128 v[20:23], v64 offset:38912
v_mfma_f32_32x32x16_bf16 v[32:47], a[140:143], v[8:11], v[32:47]
s_waitcnt lgkmcnt(2)
ds_read_b128 v[24:27], v64 offset:39936
v_mfma_f32_32x32x16_bf16 v[32:47], a[144:147], v[12:15], v[32:47]
s_add_u32 s44, s44, 1
s_cmp_eq_u32 s44, 3
s_mov_b32 s56, 40960
s_cmov_b32 s56, -81920
s_cselect_b32 s44, 0, s44
v_add_u32 v64, s56, v64
v_add_u32 v5, s56, v5
s_waitcnt vmcnt(10) lgkmcnt(2)
s_barrier
ds_read_b128 v[8:11], v64 offset:0
v_mfma_f32_32x32x16_bf16 v[32:47], a[148:151], v[16:19], v[32:47]
s_waitcnt lgkmcnt(2)
ds_read_b128 v[12:15], v64 offset:1024
v_mfma_f32_32x32x16_bf16 v[32:47], a[152:155], v[20:23], v[32:47]
s_waitcnt lgkmcnt(2)
ds_read_b128 v[16:19], v64 offset:2048
v_mfma_f32_32x32x16_bf16 v[32:47], a[156:159], v[24:27], v[32:47]
s_waitcnt lgkmcnt(2)
ds_read_b128 v[20:23], v64 offset:3072
k_st_35:
v_mfma_f32_32x32x16_bf16 v[48:63], a[0:3], v[8:11], 0
s_waitcnt lgkmcnt(2)
ds_read_b128 v[24:27], v64 offset:4096
v_mfma_f32_32x32x16_bf16 v[48:63], a[4:7], v[12:15], v[48:63]
s_waitcnt lgkmcnt(2)
ds_read_b128 v[8:11], v64 offset:5120
ds_read_b128 v[80:83], v7 offset:0
ds_read_b128 v[84:87], v7 offset:16
v_mov_b32 v88, 0x3727c5ac
v_mfma_f32_32x32x16_bf16 v[48:63], a[8:11], v[16:19], v[48:63]
s_waitcnt lgkmcnt(4)
ds_read_b128 v[12:15], v64 offset:6144
s_waitcnt lgkmcnt(1)
v_add_f32 v80, v80, v84
v_add_f32 v81, v81, v85
v_add_f32 v82, v82, v86
v_add_f32 v83, v83, v87
v_add_f32 v80, v80, v81
v_add_f32 v82, v82, v83
v_add_f32 v80, v80, v82
v_mfma_f32_32x32x16_bf16 v[48:63], a[12:15], v[20:23], v[48:63]
ds_read_b128 v[16:19], v64 offset:7168
v_fma_f32 v80, v80, s61, v88
v_rsq_f32 v80, v80
s_nop 0
v_mul_f32 v32, v80, v32
v_mul_f32 v33, v80, v33
v_cvt_pk_bf16_f32 v32, v32, v33
v_mfma_f32_32x32x16_bf16 v[48:63], a[16:19], v[24:27], v[48:63]
ds_read_b128 v[20:23], v64 offset:8192
v_mul_f32 v34, v80, v34
v_mul_f32 v35, v80, v35
v_cvt_pk_bf16_f32 v33, v34, v35
v_mul_f32 v36, v80, v36
v_mul_f32 v37, v80, v37
v_cvt_pk_bf16_f32 v34, v36, v37
v_mfma_f32_32x32x16_bf16 v[48:63], a[20:23], v[8:11], v[48:63]
s_waitcnt lgkmcnt(2)
ds_read_b128 v[24:27], v64 offset:9216
v_mul_f32 v38, v80, v38
v_mul_f32 v39, v80, v39
v_cvt_pk_bf16_f32 v35, v38, v39
v_mul_f32 v40, v80, v40
v_mul_f32 v41, v80, v41
v_cvt_pk_bf16_f32 v36, v40, v41
v_mfma_f32_32x32x16_bf16 v[48:63], a[24:27], v[12:15], v[48:63]
s_waitcnt lgkmcnt(2)
ds_read_b128 v[8:11], v64 offset:10240
v_mul_f32 v42, v80, v42
v_mul_f32 v43, v80, v43
v_cvt_pk_bf16_f32 v37, v42, v43
v_mul_f32 v44, v80, v44
v_mul_f32 v45, v80, v45
v_cvt_pk_bf16_f32 v38, v44, v45
v_mfma_f32_32x32x16_bf16 v[48:63], a[28:31], v[16:19], v[48:63]
s_waitcnt lgkmcnt(2)
ds_read_b128 v[12:15], v64 offset:11264
v_mul_f32 v46, v80, v46
v_mul_f32 v47, v80, v47
v_cvt_pk_bf16_f32 v39, v46, v47
buffer_store_dwordx4 v[32:35], v1, s[4:7], s48 offen offset:0 sc1
v_mfma_f32_32x32x16_bf16 v[48:63], a[32:35], v[20:23], v[48:63]
s_waitcnt lgkmcnt(2)
ds_read_b128 v[16:19], v64 offset:12288
buffer_store_dwordx4 v[36:39], v1, s[4:7], s48 offen offset:512 sc1
s_add_u32 s48, s48, s49
v_mfma_f32_32x32x16_bf16 v[48:63], a[36:39], v[24:27], v[48:63]
s_waitcnt lgkmcnt(2)
ds_read_b128 v[20:23], v64 offset:13312
ds_read_b128 v[72:75], v5
v_mov_b32 v4, 0
ds_read_b128 v[76:79], v5 offset:1024
v_mfma_f32_32x32x16_bf16 v[48:63], a[40:43], v[8:11], v[48:63]
s_waitcnt lgkmcnt(4)
ds_read_b128 v[24:27], v64 offset:14336
s_waitcnt lgkmcnt(2)
v_and_b32 v72, v3, v72
v_dot2c_f32_bf16 v4, v72, v72
v_dot2c_f32_bf16 v4, v73, v73
v_dot2c_f32_bf16 v4, v74, v74
v_dot2c_f32_bf16 v4, v75, v75
v_mfma_f32_32x32x16_bf16 v[48:63], a[44:47], v[12:15], v[48:63]
ds_read_b128 v[8:11], v64 offset:15360
ds_read_b128 v[72:75], v5 offset:2048
s_waitcnt lgkmcnt(3)
v_dot2c_f32_bf16 v4, v76, v76
v_dot2c_f32_bf16 v4, v77, v77
v_dot2c_f32_bf16 v4, v78, v78
v_dot2c_f32_bf16 v4, v79, v79
v_mfma_f32_32x32x16_bf16 v[48:63], a[48:51], v[16:19], v[48:63]
ds_read_b128 v[12:15], v64 offset:16384
ds_read_b128 v[76:79], v5 offset:3072
s_waitcnt lgkmcnt(2)
v_dot2c_f32_bf16 v4, v72, v72
v_dot2c_f32_bf16 v4, v73, v73
v_dot2c_f32_bf16 v4, v74, v74
v_dot2c_f32_bf16 v4, v75, v75
v_mfma_f32_32x32x16_bf16 v[48:63], a[52:55], v[20:23], v[48:63]
ds_read_b128 v[16:19], v64 offset:17408
ds_read_b128 v[72:75], v5 offset:4096
s_waitcnt lgkmcnt(2)
v_dot2c_f32_bf16 v4, v76, v76
v_dot2c_f32_bf16 v4, v77, v77
v_dot2c_f32_bf16 v4, v78, v78
v_dot2c_f32_bf16 v4, v79, v79
v_mfma_f32_32x32x16_bf16 v[48:63], a[56:59], v[24:27], v[48:63]
ds_read_b128 v[20:23], v64 offset:18432
ds_read_b128 v[76:79], v5 offset:5120
s_waitcnt lgkmcnt(2)
v_dot2c_f32_bf16 v4, v72, v72
v_dot2c_f32_bf16 v4, v73, v73
v_dot2c_f32_bf16 v4, v74, v74
v_dot2c_f32_bf16 v4, v75, v75
v_mfma_f32_32x32x16_bf16 v[48:63], a[60:63], v[8:11], v[48:63]
ds_read_b128 v[24:27], v64 offset:19456
ds_read_b128 v[72:75], v5 offset:6144
s_waitcnt lgkmcnt(2)
v_dot2c_f32_bf16 v4, v76, v76
v_dot2c_f32_bf16 v4, v77, v77
v_dot2c_f32_bf16 v4, v78, v78
v_dot2c_f32_bf16 v4, v79, v79
v_mfma_f32_32x32x16_bf16 v[48:63], a[64:67], v[12:15], v[48:63]
ds_read_b128 v[8:11], v64 offset:20480
ds_read_b128 v[76:79], v5 offset:7168
s_waitcnt lgkmcnt(2)
v_dot2c_f32_bf16 v4, v72, v72
v_dot2c_f32_bf16 v4, v73, v73
v_dot2c_f32_bf16 v4, v74, v74
v_dot2c_f32_bf16 v4, v75, v75
v_mfma_f32_32x32x16_bf16 v[48:63], a[68:71], v[16:19], v[48:63]
ds_read_b128 v[12:15], v64 offset:21504
ds_read_b128 v[72:75], v5 offset:8192
s_waitcnt lgkmcnt(2)
v_dot2c_f32_bf16 v4, v76, v76
v_dot2c_f32_bf16 v4, v77, v77
v_dot2c_f32_bf16 v4, v78, v78
v_dot2c_f32_bf16 v4, v79, v79
v_mfma_f32_32x32x16_bf16 v[48:63], a[72:75], v[20:23], v[48:63]
ds_read_b128 v[16:19], v64 offset:22528
ds_read_b128 v[76:79], v5 offset:9216
s_waitcnt lgkmcnt(2)
v_dot2c_f32_bf16 v4, v72, v72
v_dot2c_f32_bf16 v4, v73, v73
v_dot2c_f32_bf16 v4, v74, v74
v_dot2c_f32_bf16 v4, v75, v75
v_mfma_f32_32x32x16_bf16 v[48:63], a[76:79], v[24:27], v[48:63]
ds_read_b128 v[20:23], v64 offset:23552
s_waitcnt lgkmcnt(1)
v_dot2c_f32_bf16 v4, v76, v76
v_dot2c_f32_bf16 v4, v77, v77
v_dot2c_f32_bf16 v4, v78, v78
v_dot2c_f32_bf16 v4, v79, v79
s_nop 2
ds_write_b32 v6, v4 offset:1024
v_mfma_f32_32x32x16_bf16 v[48:63], a[80:83], v[8:11], v[48:63]
ds_read_b128 v[24:27], v64 offset:24576
s_add_u32 m0, s45, 0
s_add_u32 s55, s46, 0
buffer_load_dwordx4 v0, s[4:7], s55 offen offset:0 sc1 lds
buffer_load_dwordx4 v0, s[4:7], s55 offen offset:1024 sc1 lds
v_mfma_f32_32x32x16_bf16 v[48:63], a[84:87], v[12:15], v[48:63]
ds_read_b128 v[8:11], v64 offset:25600
buffer_load_dwordx4 v0, s[4:7], s55 offen offset:2048 sc1 lds
buffer_load_dwordx4 v0, s[4:7], s55 offen offset:3072 sc1 lds
v_mfma_f32_32x32x16_bf16 v[48:63], a[88:91], v[16:19], v[48:63]
s_waitcnt lgkmcnt(3)
ds_read_b128 v[12:15], v64 offset:26624
s_add_u32 m0, s45, 4096
s_add_u32 s55, s46, 4096
buffer_load_dwordx4 v0, s[4:7], s55 offen offset:0 sc1 lds
buffer_load_dwordx4 v0, s[4:7], s55 offen offset:1024 sc1 lds
v_mfma_f32_32x32x16_bf16 v[48:63], a[92:95], v[20:23], v[48:63]
s_waitcnt lgkmcnt(2)
ds_read_b128 v[16:19], v64 offset:27648
buffer_load_dwordx4 v0, s[4:7], s55 offen offset:2048 sc1 lds
buffer_load_dwordx4 v0, s[4:7], s55 offen offset:3072 sc1 lds
v_mfma_f32_32x32x16_bf16 v[48:63], a[96:99], v[24:27], v[48:63]
s_waitcnt lgkmcnt(2)
ds_read_b128 v[20:23], v64 offset:28672
s_add_u32 m0, s45, 8192
s_add_u32 s55, s46, 8192
buffer_load_dwordx4 v0, s[4:7], s55 offen offset:0 sc1 lds
buffer_load_dwordx4 v0, s[4:7], s55 offen offset:1024 sc1 lds
v_mfma_f32_32x32x16_bf16 v[48:63], a[100:103], v[8:11], v[48:63]
s_waitcnt lgkmcnt(2)
ds_read_b128 v[24:27], v64 offset:29696
s_add_u32 s45, s45, 40960
s_cmp_ge_u32 s45, 122880
s_cselect_b32 s55, 122880, 0
s_sub_u32 s45, s45, s55
s_add_u32 s46, s46, 40960
v_mfma_f32_32x32x16_bf16 v[48:63], a[104:107], v[12:15], v[48:63]
s_waitcnt lgkmcnt(2)
ds_read_b128 v[8:11], v64 offset:30720
v_mfma_f32_32x32x16_bf16 v[48:63], a[108:111], v[16:19], v[48:63]
s_waitcnt lgkmcnt(2)
ds_read_b128 v[12:15], v64 offset:31744
v_mfma_f32_32x32x16_bf16 v[48:63], a[112:115], v[20:23], v[48:63]
s_waitcnt lgkmcnt(2)
ds_read_b128 v[16:19], v64 offset:32768
v_mfma_f32_32x32x16_bf16 v[48:63], a[116:119], v[24:27], v[48:63]
s_waitcnt lgkmcnt(2)
ds_read_b128 v[20:23], v64 offset:33792
v_mfma_f32_32x32x16_bf16 v[48:63], a[120:123], v[8:11], v[48:63]
s_waitcnt lgkmcnt(2)
ds_read_b128 v[24:27], v64 offset:34816
v_mfma_f32_32x32x16_bf16 v[48:63], a[124:127], v[12:15], v[48:63]
s_waitcnt lgkmcnt(2)
ds_read_b128 v[8:11], v64 offset:35840
v_mfma_f32_32x32x16_bf16 v[48:63], a[128:131], v[16:19], v[48:63]
s_waitcnt lgkmcnt(2)
ds_read_b128 v[12:15], v64 offset:36864
v_mfma_f32_32x32x16_bf16 v[48:63], a[132:135], v[20:23], v[48:63]
s_waitcnt lgkmcnt(2)
ds_read_b128 v[16:19], v64 offset:37888
v_mfma_f32_32x32x16_bf16 v[48:63], a[136:139], v[24:27], v[48:63]
s_waitcnt lgkmcnt(2)
ds_read_b128 v[20:23], v64 offset:38912
v_mfma_f32_32x32x16_bf16 v[48:63], a[140:143], v[8:11], v[48:63]
s_waitcnt lgkmcnt(2)
ds_read_b128 v[24:27], v64 offset:39936
v_mfma_f32_32x32x16_bf16 v[48:63], a[144:147], v[12:15], v[48:63]
s_add_u32 s44, s44, 1
s_cmp_eq_u32 s44, 3
s_mov_b32 s56, 40960
s_cmov_b32 s56, -81920
s_cselect_b32 s44, 0, s44
v_add_u32 v64, s56, v64
v_add_u32 v5, s56, v5
s_waitcnt vmcnt(10) lgkmcnt(2)
s_barrier
s_add_u32 s50, s50, 1
v_mov_b32 v4, s50
buffer_store_dword v4, v2, s[4:7], s60 offen sc1
ds_read_b128 v[8:11], v64 offset:0
v_mfma_f32_32x32x16_bf16 v[48:63], a[148:151], v[16:19], v[48:63]
s_waitcnt lgkmcnt(2)
ds_read_b128 v[12:15], v64 offset:1024
v_mfma_f32_32x32x16_bf16 v[48:63], a[152:155], v[20:23], v[48:63]
s_waitcnt lgkmcnt(2)
ds_read_b128 v[16:19], v64 offset:2048
v_mfma_f32_32x32x16_bf16 v[48:63], a[156:159], v[24:27], v[48:63]
s_waitcnt lgkmcnt(2)
ds_read_b128 v[20:23], v64 offset:3072
s_sub_u32 s59, s59, 1
s_cmp_eq_u32 s59, 0
s_cbranch_scc1 k_so_36
v_mfma_f32_32x32x16_bf16 v[32:47], a[0:3], v[8:11], 0
s_waitcnt lgkmcnt(2)
ds_read_b128 v[24:27], v64 offset:4096
v_mfma_f32_32x32x16_bf16 v[32:47], a[4:7], v[12:15], v[32:47]
s_waitcnt lgkmcnt(2)
ds_read_b128 v[8:11], v64 offset:5120
ds_read_b128 v[80:83], v7 offset:1024
ds_read_b128 v[84:87], v7 offset:1040
v_mov_b32 v88, 0x3727c5ac
v_mfma_f32_32x32x16_bf16 v[32:47], a[8:11], v[16:19], v[32:47]
s_waitcnt lgkmcnt(4)
ds_read_b128 v[12:15], v64 offset:6144
s_waitcnt lgkmcnt(1)
v_add_f32 v80, v80, v84
v_add_f32 v81, v81, v85
v_add_f32 v82, v82, v86
v_add_f32 v83, v83, v87
v_add_f32 v80, v80, v81
v_add_f32 v82, v82, v83
v_add_f32 v80, v80, v82
v_mfma_f32_32x32x16_bf16 v[32:47], a[12:15], v[20:23], v[32:47]
ds_read_b128 v[16:19], v64 offset:7168
v_fma_f32 v80, v80, s61, v88
v_rsq_f32 v80, v80
s_nop 0
v_mul_f32 v48, v80, v48
v_mul_f32 v49, v80, v49
v_cvt_pk_bf16_f32 v48, v48, v49
v_mfma_f32_32x32x16_bf16 v[32:47], a[16:19], v[24:27], v[32:47]
ds_read_b128 v[20:23], v64 offset:8192
v_mul_f32 v50, v80, v50
v_mul_f32 v51, v80, v51
v_cvt_pk_bf16_f32 v49, v50, v51
v_mul_f32 v52, v80, v52
v_mul_f32 v53, v80, v53
v_cvt_pk_bf16_f32 v50, v52, v53
v_mfma_f32_32x32x16_bf16 v[32:47], a[20:23], v[8:11], v[32:47]
s_waitcnt lgkmcnt(2)
ds_read_b128 v[24:27], v64 offset:9216
v_mul_f32 v54, v80, v54
v_mul_f32 v55, v80, v55
v_cvt_pk_bf16_f32 v51, v54, v55
v_mul_f32 v56, v80, v56
v_mul_f32 v57, v80, v57
v_cvt_pk_bf16_f32 v52, v56, v57
v_mfma_f32_32x32x16_bf16 v[32:47], a[24:27], v[12:15], v[32:47]
s_waitcnt lgkmcnt(2)
ds_read_b128 v[8:11], v64 offset:10240
v_mul_f32 v58, v80, v58
v_mul_f32 v59, v80, v59
v_cvt_pk_bf16_f32 v53, v58, v59
v_mul_f32 v60, v80, v60
v_mul_f32 v61, v80, v61
v_cvt_pk_bf16_f32 v54, v60, v61
v_mfma_f32_32x32x16_bf16 v[32:47], a[28:31], v[16:19], v[32:47]
s_waitcnt lgkmcnt(2)
ds_read_b128 v[12:15], v64 offset:11264
v_mul_f32 v62, v80, v62
v_mul_f32 v63, v80, v63
v_cvt_pk_bf16_f32 v55, v62, v63
buffer_store_dwordx4 v[48:51], v1, s[4:7], s48 offen offset:0 sc1
v_mfma_f32_32x32x16_bf16 v[32:47], a[32:35], v[20:23], v[32:47]
s_waitcnt lgkmcnt(2)
ds_read_b128 v[16:19], v64 offset:12288
buffer_store_dwordx4 v[52:55], v1, s[4:7], s48 offen offset:512 sc1
s_add_u32 s48, s48, s49
v_mfma_f32_32x32x16_bf16 v[32:47], a[36:39], v[24:27], v[32:47]
s_waitcnt lgkmcnt(2)
ds_read_b128 v[20:23], v64 offset:13312
ds_read_b128 v[72:75], v5
v_mov_b32 v4, 0
ds_read_b128 v[76:79], v5 offset:1024
v_mfma_f32_32x32x16_bf16 v[32:47], a[40:43], v[8:11], v[32:47]
s_waitcnt lgkmcnt(4)
ds_read_b128 v[24:27], v64 offset:14336
s_waitcnt lgkmcnt(2)
v_and_b32 v72, v3, v72
v_dot2c_f32_bf16 v4, v72, v72
v_dot2c_f32_bf16 v4, v73, v73
v_dot2c_f32_bf16 v4, v74, v74
v_dot2c_f32_bf16 v4, v75, v75
v_mfma_f32_32x32x16_bf16 v[32:47], a[44:47], v[12:15], v[32:47]
ds_read_b128 v[8:11], v64 offset:15360
ds_read_b128 v[72:75], v5 offset:2048
s_waitcnt lgkmcnt(3)
v_dot2c_f32_bf16 v4, v76, v76
v_dot2c_f32_bf16 v4, v77, v77
v_dot2c_f32_bf16 v4, v78, v78
v_dot2c_f32_bf16 v4, v79, v79
v_mfma_f32_32x32x16_bf16 v[32:47], a[48:51], v[16:19], v[32:47]
ds_read_b128 v[12:15], v64 offset:16384
ds_read_b128 v[76:79], v5 offset:3072
s_waitcnt lgkmcnt(2)
v_dot2c_f32_bf16 v4, v72, v72
v_dot2c_f32_bf16 v4, v73, v73
v_dot2c_f32_bf16 v4, v74, v74
v_dot2c_f32_bf16 v4, v75, v75
v_mfma_f32_32x32x16_bf16 v[32:47], a[52:55], v[20:23], v[32:47]
ds_read_b128 v[16:19], v64 offset:17408
ds_read_b128 v[72:75], v5 offset:4096
s_waitcnt lgkmcnt(2)
v_dot2c_f32_bf16 v4, v76, v76
v_dot2c_f32_bf16 v4, v77, v77
v_dot2c_f32_bf16 v4, v78, v78
v_dot2c_f32_bf16 v4, v79, v79
v_mfma_f32_32x32x16_bf16 v[32:47], a[56:59], v[24:27], v[32:47]
ds_read_b128 v[20:23], v64 offset:18432
ds_read_b128 v[76:79], v5 offset:5120
s_waitcnt lgkmcnt(2)
v_dot2c_f32_bf16 v4, v72, v72
v_dot2c_f32_bf16 v4, v73, v73
v_dot2c_f32_bf16 v4, v74, v74
v_dot2c_f32_bf16 v4, v75, v75
v_mfma_f32_32x32x16_bf16 v[32:47], a[60:63], v[8:11], v[32:47]
ds_read_b128 v[24:27], v64 offset:19456
ds_read_b128 v[72:75], v5 offset:6144
s_waitcnt lgkmcnt(2)
v_dot2c_f32_bf16 v4, v76, v76
v_dot2c_f32_bf16 v4, v77, v77
v_dot2c_f32_bf16 v4, v78, v78
v_dot2c_f32_bf16 v4, v79, v79
v_mfma_f32_32x32x16_bf16 v[32:47], a[64:67], v[12:15], v[32:47]
ds_read_b128 v[8:11], v64 offset:20480
ds_read_b128 v[76:79], v5 offset:7168
s_waitcnt lgkmcnt(2)
v_dot2c_f32_bf16 v4, v72, v72
v_dot2c_f32_bf16 v4, v73, v73
v_dot2c_f32_bf16 v4, v74, v74
v_dot2c_f32_bf16 v4, v75, v75
v_mfma_f32_32x32x16_bf16 v[32:47], a[68:71], v[16:19], v[32:47]
ds_read_b128 v[12:15], v64 offset:21504
ds_read_b128 v[72:75], v5 offset:8192
s_waitcnt lgkmcnt(2)
v_dot2c_f32_bf16 v4, v76, v76
v_dot2c_f32_bf16 v4, v77, v77
v_dot2c_f32_bf16 v4, v78, v78
v_dot2c_f32_bf16 v4, v79, v79
v_mfma_f32_32x32x16_bf16 v[32:47], a[72:75], v[20:23], v[32:47]
ds_read_b128 v[16:19], v64 offset:22528
ds_read_b128 v[76:79], v5 offset:9216
s_waitcnt lgkmcnt(2)
v_dot2c_f32_bf16 v4, v72, v72
v_dot2c_f32_bf16 v4, v73, v73
v_dot2c_f32_bf16 v4, v74, v74
v_dot2c_f32_bf16 v4, v75, v75
v_mfma_f32_32x32x16_bf16 v[32:47], a[76:79], v[24:27], v[32:47]
ds_read_b128 v[20:23], v64 offset:23552
s_waitcnt lgkmcnt(1)
v_dot2c_f32_bf16 v4, v76, v76
v_dot2c_f32_bf16 v4, v77, v77
v_dot2c_f32_bf16 v4, v78, v78
v_dot2c_f32_bf16 v4, v79, v79
s_nop 2
ds_write_b32 v6, v4 offset:0
v_mfma_f32_32x32x16_bf16 v[32:47], a[80:83], v[8:11], v[32:47]
ds_read_b128 v[24:27], v64 offset:24576
s_add_u32 m0, s45, 0
s_add_u32 s55, s46, 0
buffer_load_dwordx4 v0, s[4:7], s55 offen offset:0 sc1 lds
buffer_load_dwordx4 v0, s[4:7], s55 offen offset:1024 sc1 lds
v_mfma_f32_32x32x16_bf16 v[32:47], a[84:87], v[12:15], v[32:47]
ds_read_b128 v[8:11], v64 offset:25600
buffer_load_dwordx4 v0, s[4:7], s55 offen offset:2048 sc1 lds
buffer_load_dwordx4 v0, s[4:7], s55 offen offset:3072 sc1 lds
v_mfma_f32_32x32x16_bf16 v[32:47], a[88:91], v[16:19], v[32:47]
s_waitcnt lgkmcnt(3)
ds_read_b128 v[12:15], v64 offset:26624
s_add_u32 m0, s45, 4096
s_add_u32 s55, s46, 4096
buffer_load_dwordx4 v0, s[4:7], s55 offen offset:0 sc1 lds
buffer_load_dwordx4 v0, s[4:7], s55 offen offset:1024 sc1 lds
v_mfma_f32_32x32x16_bf16 v[32:47], a[92:95], v[20:23], v[32:47]
s_waitcnt lgkmcnt(2)
ds_read_b128 v[16:19], v64 offset:27648
buffer_load_dwordx4 v0, s[4:7], s55 offen offset:2048 sc1 lds
buffer_load_dwordx4 v0, s[4:7], s55 offen offset:3072 sc1 lds
v_mfma_f32_32x32x16_bf16 v[32:47], a[96:99], v[24:27], v[32:47]
s_waitcnt lgkmcnt(2)
ds_read_b128 v[20:23], v64 offset:28672
s_add_u32 m0, s45, 8192
s_add_u32 s55, s46, 8192
buffer_load_dwordx4 v0, s[4:7], s55 offen offset:0 sc1 lds
buffer_load_dwordx4 v0, s[4:7], s55 offen offset:1024 sc1 lds
v_mfma_f32_32x32x16_bf16 v[32:47], a[100:103], v[8:11], v[32:47]
s_waitcnt lgkmcnt(2)
ds_read_b128 v[24:27], v64 offset:29696
s_add_u32 s45, s45, 40960
s_cmp_ge_u32 s45, 122880
s_cselect_b32 s55, 122880, 0
s_sub_u32 s45, s45, s55
s_add_u32 s46, s46, 40960
v_mfma_f32_32x32x16_bf16 v[32:47], a[104:107], v[12:15], v[32:47]
s_waitcnt lgkmcnt(2)
ds_read_b128 v[8:11], v64 offset:30720
v_mfma_f32_32x32x16_bf16 v[32:47], a[108:111], v[16:19], v[32:47]
s_waitcnt lgkmcnt(2)
ds_read_b128 v[12:15], v64 offset:31744
v_mfma_f32_32x32x16_bf16 v[32:47], a[112:115], v[20:23], v[32:47]
s_waitcnt lgkmcnt(2)
ds_read_b128 v[16:19], v64 offset:32768
v_mfma_f32_32x32x16_bf16 v[32:47], a[116:119], v[24:27], v[32:47]
s_waitcnt lgkmcnt(2)
ds_read_b128 v[20:23], v64 offset:33792
v_mfma_f32_32x32x16_bf16 v[32:47], a[120:123], v[8:11], v[32:47]
s_waitcnt lgkmcnt(2)
ds_read_b128 v[24:27], v64 offset:34816
v_mfma_f32_32x32x16_bf16 v[32:47], a[124:127], v[12:15], v[32:47]
s_waitcnt lgkmcnt(2)
ds_read_b128 v[8:11], v64 offset:35840
v_mfma_f32_32x32x16_bf16 v[32:47], a[128:131], v[16:19], v[32:47]
s_waitcnt lgkmcnt(2)
ds_read_b128 v[12:15], v64 offset:36864
v_mfma_f32_32x32x16_bf16 v[32:47], a[132:135], v[20:23], v[32:47]
s_waitcnt lgkmcnt(2)
ds_read_b128 v[16:19], v64 offset:37888
v_mfma_f32_32x32x16_bf16 v[32:47], a[136:139], v[24:27], v[32:47]
s_waitcnt lgkmcnt(2)
ds_read_b128 v[20:23], v64 offset:38912
v_mfma_f32_32x32x16_bf16 v[32:47], a[140:143], v[8:11], v[32:47]
s_waitcnt lgkmcnt(2)
ds_read_b128 v[24:27], v64 offset:39936
v_mfma_f32_32x32x16_bf16 v[32:47], a[144:147], v[12:15], v[32:47]
s_add_u32 s44, s44, 1
s_cmp_eq_u32 s44, 3
s_mov_b32 s56, 40960
s_cmov_b32 s56, -81920
s_cselect_b32 s44, 0, s44
v_add_u32 v64, s56, v64
v_add_u32 v5, s56, v5
s_waitcnt vmcnt(10) lgkmcnt(2)
s_barrier
s_add_u32 s50, s50, 1
v_mov_b32 v4, s50
buffer_store_dword v4, v2, s[4:7], s60 offen sc1
ds_read_b128 v[8:11], v64 offset:0
v_mfma_f32_32x32x16_bf16 v[32:47], a[148:151], v[16:19], v[32:47]
s_waitcnt lgkmcnt(2)
ds_read_b128 v[12:15], v64 offset:1024
v_mfma_f32_32x32x16_bf16 v[32:47], a[152:155], v[20:23], v[32:47]
s_waitcnt lgkmcnt(2)
ds_read_b128 v[16:19], v64 offset:2048
v_mfma_f32_32x32x16_bf16 v[32:47], a[156:159], v[24:27], v[32:47]
s_waitcnt lgkmcnt(2)
ds_read_b128 v[20:23], v64 offset:3072
s_branch k_st_35
k_so_36:
ds_read_b128 v[80:83], v7 offset:1024
ds_read_b128 v[84:87], v7 offset:1040
v_mov_b32 v88, 0x3727c5ac
s_waitcnt lgkmcnt(0)
v_add_f32 v80, v80, v84
v_add_f32 v81, v81, v85
v_add_f32 v82, v82, v86
v_add_f32 v83, v83, v87
v_add_f32 v80, v80, v81
v_add_f32 v82, v82, v83
v_add_f32 v80, v80, v82
v_fma_f32 v80, v80, s61, v88
v_rsq_f32 v80, v80
s_nop 0
v_mul_f32 v48, v80, v48
v_mul_f32 v49, v80, v49
v_cvt_pk_bf16_f32 v48, v48, v49
v_mul_f32 v50, v80, v50
v_mul_f32 v51, v80, v51
v_cvt_pk_bf16_f32 v49, v50, v51
v_mul_f32 v52, v80, v52
v_mul_f32 v53, v80, v53
v_cvt_pk_bf16_f32 v50, v52, v53
v_mul_f32 v54, v80, v54
v_mul_f32 v55, v80, v55
v_cvt_pk_bf16_f32 v51, v54, v55
v_mul_f32 v56, v80, v56
v_mul_f32 v57, v80, v57
v_cvt_pk_bf16_f32 v52, v56, v57
v_mul_f32 v58, v80, v58
v_mul_f32 v59, v80, v59
v_cvt_pk_bf16_f32 v53, v58, v59
v_mul_f32 v60, v80, v60
v_mul_f32 v61, v80, v61
v_cvt_pk_bf16_f32 v54, v60, v61
v_mul_f32 v62, v80, v62
v_mul_f32 v63, v80, v63
v_cvt_pk_bf16_f32 v55, v62, v63
buffer_store_dwordx4 v[48:51], v1, s[4:7], s48 offen offset:0 sc1
buffer_store_dwordx4 v[52:55], v1, s[4:7], s48 offen offset:512 sc1
s_add_u32 s48, s48, s49
s_branch k_join_32
k_isv_31:
s_mul_i32 s45, s3, 10240
s_mov_b32 s44, 0
v_mov_b32 v64, v0
s_add_u32 m0, s45, 0
s_add_u32 s55, s46, 0
buffer_load_dwordx4 v0, s[4:7], s55 offen offset:0 sc1 lds
buffer_load_dwordx4 v0, s[4:7], s55 offen offset:1024 sc1 lds
buffer_load_dwordx4 v0, s[4:7], s55 offen offset:2048 sc1 lds
buffer_load_dwordx4 v0, s[4:7], s55 offen offset:3072 sc1 lds
s_add_u32 m0, s45, 4096
s_add_u32 s55, s46, 4096
buffer_load_dwordx4 v0, s[4:7], s55 offen offset:0 sc1 lds
buffer_load_dwordx4 v0, s[4:7], s55 offen offset:1024 sc1 lds
buffer_load_dwordx4 v0, s[4:7], s55 offen offset:2048 sc1 lds
buffer_load_dwordx4 v0, s[4:7], s55 offen offset:3072 sc1 lds
s_add_u32 m0, s45, 8192
s_add_u32 s55, s46, 8192
buffer_load_dwordx4 v0, s[4:7], s55 offen offset:0 sc1 lds
buffer_load_dwordx4 v0, s[4:7], s55 offen offset:1024 sc1 lds
s_add_u32 s45, s45, 40960
s_cmp_ge_u32 s45, 122880
s_cselect_b32 s55, 122880, 0
s_sub_u32 s45, s45, s55
s_add_u32 s46, s46, 40960
s_add_u32 m0, s45, 0
s_add_u32 s55, s46, 0
buffer_load_dwordx4 v0, s[4:7], s55 offen offset:0 sc1 lds
buffer_load_dwordx4 v0, s[4:7], s55 offen offset:1024 sc1 lds
buffer_load_dwordx4 v0, s[4:7], s55 offen offset:2048 sc1 lds
buffer_load_dwordx4 v0, s[4:7], s55 offen offset:3072 sc1 lds
s_add_u32 m0, s45, 4096
s_add_u32 s55, s46, 4096
buffer_load_dwordx4 v0, s[4:7], s55 offen offset:0 sc1 lds
buffer_load_dwordx4 v0, s[4:7], s55 offen offset:1024 sc1 lds
buffer_load_dwordx4 v0, s[4:7], s55 offen offset:2048 sc1 lds
buffer_load_dwordx4 v0, s[4:7], s55 offen offset:3072 sc1 lds
s_add_u32 m0, s45, 8192
s_add_u32 s55, s46, 8192
buffer_load_dwordx4 v0, s[4:7], s55 offen offset:0 sc1 lds
buffer_load_dwordx4 v0, s[4:7], s55 offen offset:1024 sc1 lds
s_add_u32 s45, s45, 40960
s_cmp_ge_u32 s45, 122880
s_cselect_b32 s55, 122880, 0
s_sub_u32 s45, s45, s55
s_add_u32 s46, s46, 40960
s_waitcnt vmcnt(10)
s_barrier
ds_read_b128 v[8:11], v64 offset:0
ds_read_b128 v[12:15], v64 offset:1024
ds_read_b128 v[16:19], v64 offset:2048
ds_read_b128 v[20:23], v64 offset:3072
s_mov_b32 s59, 32
s_waitcnt lgkmcnt(3)
v_mfma_f32_32x32x16_bf16 v[32:47], v[8:11], a[0:3], 0
s_waitcnt lgkmcnt(2)
ds_read_b128 v[24:27], v64 offset:4096
v_mfma_f32_32x32x16_bf16 v[32:47], v[12:15], a[4:7], v[32:47]
s_waitcnt lgkmcnt(2)
ds_read_b128 v[8:11], v64 offset:5120
ds_read_b128 v[72:75], v5
v_mov_b32 v4, 0
ds_read_b128 v[76:79], v5 offset:1024
v_mfma_f32_32x32x16_bf16 v[32:47], v[16:19], a[8:11], v[32:47]
s_waitcnt lgkmcnt(4)
ds_read_b128 v[12:15], v64 offset:6144
s_waitcnt lgkmcnt(2)
v_and_b32 v72, v3, v72
v_dot2c_f32_bf16 v4, v72, v72
v_dot2c_f32_bf16 v4, v73, v73
v_dot2c_f32_bf16 v4, v74, v74
v_dot2c_f32_bf16 v4, v75, v75
v_mfma_f32_32x32x16_bf16 v[32:47], v[20:23], a[12:15], v[32:47]
ds_read_b128 v[16:19], v64 offset:7168
ds_read_b128 v[72:75], v5 offset:2048
s_waitcnt lgkmcnt(3)
v_dot2c_f32_bf16 v4, v76, v76
v_dot2c_f32_bf16 v4, v77, v77
v_dot2c_f32_bf16 v4, v78, v78
v_dot2c_f32_bf16 v4, v79, v79
v_mfma_f32_32x32x16_bf16 v[32:47], v[24:27], a[16:19], v[32:47]
ds_read_b128 v[20:23], v64 offset:8192
ds_read_b128 v[76:79], v5 offset:3072
s_waitcnt lgkmcnt(2)
v_dot2c_f32_bf16 v4, v72, v72
v_dot2c_f32_bf16 v4, v73, v73
v_dot2c_f32_bf16 v4, v74, v74
v_dot2c_f32_bf16 v4, v75, v75
v_mfma_f32_32x32x16_bf16 v[32:47], v[8:11], a[20:23], v[32:47]
ds_read_b128 v[24:27], v64 offset:9216
ds_read_b128 v[72:75], v5 offset:4096
s_waitcnt lgkmcnt(2)
v_dot2c_f32_bf16 v4, v76, v76
v_dot2c_f32_bf16 v4, v77, v77
v_dot2c_f32_bf16 v4, v78, v78
v_dot2c_f32_bf16 v4, v79, v79
v_mfma_f32_32x32x16_bf16 v[32:47], v[12:15], a[24:27], v[32:47]
ds_read_b128 v[8:11], v64 offset:10240
ds_read_b128 v[76:79], v5 offset:5120
s_waitcnt lgkmcnt(2)
v_dot2c_f32_bf16 v4, v72, v72
v_dot2c_f32_bf16 v4, v73, v73
v_dot2c_f32_bf16 v4, v74, v74
v_dot2c_f32_bf16 v4, v75, v75
v_mfma_f32_32x32x16_bf16 v[32:47], v[16:19], a[28:31], v[32:47]
ds_read_b128 v[12:15], v64 offset:11264
ds_read_b128 v[72:75], v5 offset:6144
s_waitcnt lgkmcnt(2)
v_dot2c_f32_bf16 v4, v76, v76
v_dot2c_f32_bf16 v4, v77, v77
v_dot2c_f32_bf16 v4, v78, v78
v_dot2c_f32_bf16 v4, v79, v79
v_mfma_f32_32x32x16_bf16 v[32:47], v[20:23], a[32:35], v[32:47]
ds_read_b128 v[16:19], v64 offset:12288
ds_read_b128 v[76:79], v5 offset:7168
s_waitcnt lgkmcnt(2)
v_dot2c_f32_bf16 v4, v72, v72
v_dot2c_f32_bf16 v4, v73, v73
v_dot2c_f32_bf16 v4, v74, v74
v_dot2c_f32_bf16 v4, v75, v75
v_mfma_f32_32x32x16_bf16 v[32:47], v[24:27], a[36:39], v[32:47]
ds_read_b128 v[20:23], v64 offset:13312
ds_read_b128 v[72:75], v5 offset:8192
s_waitcnt lgkmcnt(2)
v_dot2c_f32_bf16 v4, v76, v76
v_dot2c_f32_bf16 v4, v77, v77
v_dot2c_f32_bf16 v4, v78, v78
v_dot2c_f32_bf16 v4, v79, v79
v_mfma_f32_32x32x16_bf16 v[32:47], v[8:11], a[40:43], v[32:47]
ds_read_b128 v[24:27], v64 offset:14336
ds_read_b128 v[76:79], v5 offset:9216
s_waitcnt lgkmcnt(2)
v_dot2c_f32_bf16 v4, v72, v72
v_dot2c_f32_bf16 v4, v73, v73
v_dot2c_f32_bf16 v4, v74, v74
v_dot2c_f32_bf16 v4, v75, v75
v_mfma_f32_32x32x16_bf16 v[32:47], v[12:15], a[44:47], v[32:47]
ds_read_b128 v[8:11], v64 offset:15360
s_waitcnt lgkmcnt(1)
v_dot2c_f32_bf16 v4, v76, v76
v_dot2c_f32_bf16 v4, v77, v77
v_dot2c_f32_bf16 v4, v78, v78
v_dot2c_f32_bf16 v4, v79, v79
s_nop 2
ds_write_b32 v6, v4 offset:0
v_mfma_f32_32x32x16_bf16 v[32:47], v[16:19], a[48:51], v[32:47]
ds_read_b128 v[12:15], v64 offset:16384
s_add_u32 m0, s45, 0
s_add_u32 s55, s46, 0
buffer_load_dwordx4 v0, s[4:7], s55 offen offset:0 sc1 lds
buffer_load_dwordx4 v0, s[4:7], s55 offen offset:1024 sc1 lds
v_mfma_f32_32x32x16_bf16 v[32:47], v[20:23], a[52:55], v[32:47]
ds_read_b128 v[16:19], v64 offset:17408
buffer_load_dwordx4 v0, s[4:7], s55 offen offset:2048 sc1 lds
buffer_load_dwordx4 v0, s[4:7], s55 offen offset:3072 sc1 lds
v_mfma_f32_32x32x16_bf16 v[32:47], v[24:27], a[56:59], v[32:47]
s_waitcnt lgkmcnt(3)
ds_read_b128 v[20:23], v64 offset:18432
s_add_u32 m0, s45, 4096
s_add_u32 s55, s46, 4096
buffer_load_dwordx4 v0, s[4:7], s55 offen offset:0 sc1 lds
buffer_load_dwordx4 v0, s[4:7], s55 offen offset:1024 sc1 lds
v_mfma_f32_32x32x16_bf16 v[32:47], v[8:11], a[60:63], v[32:47]
s_waitcnt lgkmcnt(2)
ds_read_b128 v[24:27], v64 offset:19456
buffer_load_dwordx4 v0, s[4:7], s55 offen offset:2048 sc1 lds
buffer_load_dwordx4 v0, s[4:7], s55 offen offset:3072 sc1 lds
v_mfma_f32_32x32x16_bf16 v[32:47], v[12:15], a[64:67], v[32:47]
s_waitcnt lgkmcnt(2)
ds_read_b128 v[8:11], v64 offset:20480
s_add_u32 m0, s45, 8192
s_add_u32 s55, s46, 8192
buffer_load_dwordx4 v0, s[4:7], s55 offen offset:0 sc1 lds
buffer_load_dwordx4 v0, s[4:7], s55 offen offset:1024 sc1 lds
v_mfma_f32_32x32x16_bf16 v[32:47], v[16:19], a[68:71], v[32:47]
s_waitcnt lgkmcnt(2)
ds_read_b128 v[12:15], v64 offset:21504
s_add_u32 s45, s45, 40960
s_cmp_ge_u32 s45, 122880
s_cselect_b32 s55, 122880, 0
s_sub_u32 s45, s45, s55
s_add_u32 s46, s46, 40960
v_mfma_f32_32x32x16_bf16 v[32:47], v[20:23], a[72:75], v[32:47]
s_waitcnt lgkmcnt(2)
ds_read_b128 v[16:19], v64 offset:22528
v_mfma_f32_32x32x16_bf16 v[32:47], v[24:27], a[76:79], v[32:47]
s_waitcnt lgkmcnt(2)
ds_read_b128 v[20:23], v64 offset:23552
v_mfma_f32_32x32x16_bf16 v[32:47], v[8:11], a[80:83], v[32:47]
s_waitcnt lgkmcnt(2)
ds_read_b128 v[24:27], v64 offset:24576
v_mfma_f32_32x32x16_bf16 v[32:47], v[12:15], a[84:87], v[32:47]
s_waitcnt lgkmcnt(2)
ds_read_b128 v[8:11], v64 offset:25600
v_mfma_f32_32x32x16_bf16 v[32:47], v[16:19], a[88:91], v[32:47]
s_waitcnt lgkmcnt(2)
ds_read_b128 v[12:15], v64 offset:26624
v_mfma_f32_32x32x16_bf16 v[32:47], v[20:23], a[92:95], v[32:47]
s_waitcnt lgkmcnt(2)
ds_read_b128 v[16:19], v64 offset:27648
v_mfma_f32_32x32x16_bf16 v[32:47], v[24:27], a[96:99], v[32:47]
s_waitcnt lgkmcnt(2)
ds_read_b128 v[20:23], v64 offset:28672
v_mfma_f32_32x32x16_bf16 v[32:47], v[8:11], a[100:103], v[32:47]
s_waitcnt lgkmcnt(2)
ds_read_b128 v[24:27], v64 offset:29696
v_mfma_f32_32x32x16_bf16 v[32:47], v[12:15], a[104:107], v[32:47]
s_waitcnt lgkmcnt(2)
ds_read_b128 v[8:11], v64 offset:30720
v_mfma_f32_32x32x16_bf16 v[32:47], v[16:19], a[108:111], v[32:47]
s_waitcnt lgkmcnt(2)
ds_read_b128 v[12:15], v64 offset:31744
v_mfma_f32_32x32x16_bf16 v[32:47], v[20:23], a[112:115], v[32:47]
s_waitcnt lgkmcnt(2)
ds_read_b128 v[16:19], v64 offset:32768
v_mfma_f32_32x32x16_bf16 v[32:47], v[24:27], a[116:119], v[32:47]
s_waitcnt lgkmcnt(2)
ds_read_b128 v[20:23], v64 offset:33792
v_mfma_f32_32x32x16_bf16 v[32:47], v[8:11], a[120:123], v[32:47]
s_waitcnt lgkmcnt(2)
ds_read_b128 v[24:27], v64 offset:34816
v_mfma_f32_32x32x16_bf16 v[32:47], v[12:15], a[124:127], v[32:47]
s_waitcnt lgkmcnt(2)
ds_read_b128 v[8:11], v64 offset:35840
v_mfma_f32_32x32x16_bf16 v[32:47], v[16:19], a[128:131], v[32:47]
s_waitcnt lgkmcnt(2)
ds_read_b128 v[12:15], v64 offset:36864
v_mfma_f32_32x32x16_bf16 v[32:47], v[20:23], a[132:135], v[32:47]
s_waitcnt lgkmcnt(2)
ds_read_b128 v[16:19], v64 offset:37888
v_mfma_f32_32x32x16_bf16 v[32:47], v[24:27], a[136:139], v[32:47]
s_waitcnt lgkmcnt(2)
ds_read_b128 v[20:23], v64 offset:38912
v_mfma_f32_32x32x16_bf16 v[32:47], v[8:11], a[140:143], v[32:47]
s_waitcnt lgkmcnt(2)
ds_read_b128 v[24:27], v64 offset:39936
v_mfma_f32_32x32x16_bf16 v[32:47], v[12:15], a[144:147], v[32:47]
s_add_u32 s44, s44, 1
s_cmp_eq_u32 s44, 3
s_mov_b32 s56, 40960
s_cmov_b32 s56, -81920
s_cselect_b32 s44, 0, s44
v_add_u32 v64, s56, v64
v_add_u32 v5, s56, v5
s_waitcnt vmcnt(10) lgkmcnt(2)
s_barrier
ds_read_b128 v[8:11], v64 offset:0
v_mfma_f32_32x32x16_bf16 v[32:47], v[16:19], a[148:151], v[32:47]
s_waitcnt lgkmcnt(2)
ds_read_b128 v[12:15], v64 offset:1024
v_mfma_f32_32x32x16_bf16 v[32:47], v[20:23], a[152:155], v[32:47]
s_waitcnt lgkmcnt(2)
ds_read_b128 v[16:19], v64 offset:2048
v_mfma_f32_32x32x16_bf16 v[32:47], v[24:27], a[156:159], v[32:47]
s_waitcnt lgkmcnt(2)
ds_read_b128 v[20:23], v64 offset:3072
k_st_37:
v_mfma_f32_32x32x16_bf16 v[48:63], v[8:11], a[0:3], 0
s_waitcnt lgkmcnt(2)
ds_read_b128 v[24:27], v64 offset:4096
v_mfma_f32_32x32x16_bf16 v[48:63], v[12:15], a[4:7], v[48:63]
s_waitcnt lgkmcnt(2)
ds_read_b128 v[8:11], v64 offset:5120
ds_read_b128 v[80:83], v7 offset:0
ds_read_b128 v[84:87], v7 offset:16
v_mov_b32 v88, 0x3727c5ac
v_mfma_f32_32x32x16_bf16 v[48:63], v[16:19], a[8:11], v[48:63]
s_waitcnt lgkmcnt(4)
ds_read_b128 v[12:15], v64 offset:6144
s_waitcnt lgkmcnt(1)
v_add_f32 v80, v80, v84
v_add_f32 v81, v81, v85
v_add_f32 v82, v82, v86
v_add_f32 v83, v83, v87
v_add_f32 v80, v80, v81
v_add_f32 v82, v82, v83
v_add_f32 v80, v80, v82
v_mfma_f32_32x32x16_bf16 v[48:63], v[20:23], a[12:15], v[48:63]
ds_read_b128 v[16:19], v64 offset:7168
v_fma_f32 v80, v80, s61, v88
v_rsq_f32 v80, v80
ds_write_b32 v28, v80
v_mfma_f32_32x32x16_bf16 v[48:63], v[24:27], a[16:19], v[48:63]
ds_read_b128 v[20:23], v64 offset:8192
ds_read_b128 v[80:83], v29 offset:0
ds_read_b128 v[84:87], v29 offset:32
ds_read_b128 v[88:91], v29 offset:64
ds_read_b128 v[92:95], v29 offset:96
v_mfma_f32_32x32x16_bf16 v[48:63], v[8:11], a[20:23], v[48:63]
s_waitcnt lgkmcnt(7)
ds_read_b128 v[24:27], v64 offset:9216
s_waitcnt lgkmcnt(4)
v_mul_f32 v80, v80, v32
v_mul_f32 v81, v81, v33
v_mul_f32 v82, v82, v34
v_mul_f32 v83, v83, v35
v_mfma_f32_32x32x16_bf16 v[48:63], v[12:15], a[24:27], v[48:63]
ds_read_b128 v[8:11], v64 offset:10240
s_waitcnt lgkmcnt(4)
v_mul_f32 v84, v84, v36
v_mul_f32 v85, v85, v37
v_mul_f32 v86, v86, v38
v_mul_f32 v87, v87, v39
v_mfma_f32_32x32x16_bf16 v[48:63], v[16:19], a[28:31], v[48:63]
ds_read_b128 v[12:15], v64 offset:11264
s_waitcnt lgkmcnt(4)
v_mul_f32 v88, v88, v40
v_mul_f32 v89, v89, v41
v_mul_f32 v90, v90, v42
v_mul_f32 v91, v91, v43
v_mfma_f32_32x32x16_bf16 v[48:63], v[20:23], a[32:35], v[48:63]
s_waitcnt lgkmcnt(2)
ds_read_b128 v[16:19], v64 offset:12288
v_mul_f32 v92, v92, v44
v_mul_f32 v93, v93, v45
v_mul_f32 v94, v94, v46
v_mul_f32 v95, v95, v47
v_mfma_f32_32x32x16_bf16 v[48:63], v[24:27], a[36:39], v[48:63]
s_waitcnt lgkmcnt(2)
ds_read_b128 v[20:23], v64 offset:13312
v_cvt_pk_bf16_f32 v32, v80, v81
v_cvt_pk_bf16_f32 v33, v82, v83
v_mfma_f32_32x32x16_bf16 v[48:63], v[8:11], a[40:43], v[48:63]
s_waitcnt lgkmcnt(2)
ds_read_b128 v[24:27], v64 offset:14336
v_cvt_pk_bf16_f32 v36, v84, v85
v_cvt_pk_bf16_f32 v37, v86, v87
v_mfma_f32_32x32x16_bf16 v[48:63], v[12:15], a[44:47], v[48:63]
s_waitcnt lgkmcnt(2)
ds_read_b128 v[8:11], v64 offset:15360
v_cvt_pk_bf16_f32 v34, v88, v89
v_cvt_pk_bf16_f32 v35, v90, v91
v_mfma_f32_32x32x16_bf16 v[48:63], v[16:19], a[48:51], v[48:63]
s_waitcnt lgkmcnt(2)
ds_read_b128 v[12:15], v64 offset:16384
v_cvt_pk_bf16_f32 v38, v92, v93
v_cvt_pk_bf16_f32 v39, v94, v95
v_mfma_f32_32x32x16_bf16 v[48:63], v[20:23], a[52:55], v[48:63]
s_waitcnt lgkmcnt(2)
ds_read_b128 v[16:19], v64 offset:17408
buffer_store_dwordx4 v[32:35], v1, s[4:7], s48 offen offset:2048 sc1
buffer_store_dwordx4 v[36:39], v1, s[4:7], s48 offen offset:2560 sc1
v_mfma_f32_32x32x16_bf16 v[48:63], v[24:27], a[56:59], v[48:63]
s_waitcnt lgkmcnt(2)
ds_read_b128 v[20:23], v64 offset:18432
s_add_u32 s48, s48, s49
ds_read_b128 v[72:75], v5
v_mov_b32 v4, 0
v_mfma_f32_32x32x16_bf16 v[48:63], v[8:11], a[60:63], v[48:63]
s_waitcnt lgkmcnt(3)
ds_read_b128 v[24:27], v64 offset:19456
ds_read_b128 v[76:79], v5 offset:1024
s_waitcnt lgkmcnt(2)
v_and_b32 v72, v3, v72
v_mfma_f32_32x32x16_bf16 v[48:63], v[12:15], a[64:67], v[48:63]
ds_read_b128 v[8:11], v64 offset:20480
v_dot2c_f32_bf16 v4, v72, v72
v_dot2c_f32_bf16 v4, v73, v73
v_dot2c_f32_bf16 v4, v74, v74
v_dot2c_f32_bf16 v4, v75, v75
ds_read_b128 v[72:75], v5 offset:2048
v_mfma_f32_32x32x16_bf16 v[48:63], v[16:19], a[68:71], v[48:63]
ds_read_b128 v[12:15], v64 offset:21504
s_waitcnt lgkmcnt(3)
v_dot2c_f32_bf16 v4, v76, v76
v_dot2c_f32_bf16 v4, v77, v77
v_dot2c_f32_bf16 v4, v78, v78
v_dot2c_f32_bf16 v4, v79, v79
ds_read_b128 v[76:79], v5 offset:3072
v_mfma_f32_32x32x16_bf16 v[48:63], v[20:23], a[72:75], v[48:63]
ds_read_b128 v[16:19], v64 offset:22528
s_waitcnt lgkmcnt(3)
v_dot2c_f32_bf16 v4, v72, v72
v_dot2c_f32_bf16 v4, v73, v73
v_dot2c_f32_bf16 v4, v74, v74
v_dot2c_f32_bf16 v4, v75, v75
ds_read_b128 v[72:75], v5 offset:4096
v_mfma_f32_32x32x16_bf16 v[48:63], v[24:27], a[76:79], v[48:63]
ds_read_b128 v[20:23], v64 offset:23552
s_waitcnt lgkmcnt(3)
v_dot2c_f32_bf16 v4, v76, v76
v_dot2c_f32_bf16 v4, v77, v77
v_dot2c_f32_bf16 v4, v78, v78
v_dot2c_f32_bf16 v4, v79, v79
ds_read_b128 v[76:79], v5 offset:5120
v_mfma_f32_32x32x16_bf16 v[48:63], v[8:11], a[80:83], v[48:63]
ds_read_b128 v[24:27], v64 offset:24576
s_waitcnt lgkmcnt(3)
v_dot2c_f32_bf16 v4, v72, v72
v_dot2c_f32_bf16 v4, v73, v73
v_dot2c_f32_bf16 v4, v74, v74
v_dot2c_f32_bf16 v4, v75, v75
ds_read_b128 v[72:75], v5 offset:6144
v_mfma_f32_32x32x16_bf16 v[48:63], v[12:15], a[84:87], v[48:63]
ds_read_b128 v[8:11], v64 offset:25600
s_waitcnt lgkmcnt(3)
v_dot2c_f32_bf16 v4, v76, v76
v_dot2c_f32_bf16 v4, v77, v77
v_dot2c_f32_bf16 v4, v78, v78
v_dot2c_f32_bf16 v4, v79, v79
ds_read_b128 v[76:79], v5 offset:7168
v_mfma_f32_32x32x16_bf16 v[48:63], v[16:19], a[88:91], v[48:63]
ds_read_b128 v[12:15], v64 offset:26624
s_waitcnt lgkmcnt(3)
v_dot2c_f32_bf16 v4, v72, v72
v_dot2c_f32_bf16 v4, v73, v73
v_dot2c_f32_bf16 v4, v74, v74
v_dot2c_f32_bf16 v4, v75, v75
ds_read_b128 v[72:75], v5 offset:8192
v_mfma_f32_32x32x16_bf16 v[48:63], v[20:23], a[92:95], v[48:63]
ds_read_b128 v[16:19], v64 offset:27648
s_waitcnt lgkmcnt(3)
v_dot2c_f32_bf16 v4, v76, v76
v_dot2c_f32_bf16 v4, v77, v77
v_dot2c_f32_bf16 v4, v78, v78
v_dot2c_f32_bf16 v4, v79, v79
ds_read_b128 v[76:79], v5 offset:9216
v_mfma_f32_32x32x16_bf16 v[48:63], v[24:27], a[96:99], v[48:63]
ds_read_b128 v[20:23], v64 offset:28672
s_waitcnt lgkmcnt(3)
v_dot2c_f32_bf16 v4, v72, v72
v_dot2c_f32_bf16 v4, v73, v73
v_dot2c_f32_bf16 v4, v74, v74
v_dot2c_f32_bf16 v4, v75, v75
s_waitcnt lgkmcnt(1)
v_dot2c_f32_bf16 v4, v76, v76
v_dot2c_f32_bf16 v4, v77, v77
v_dot2c_f32_bf16 v4, v78, v78
v_dot2c_f32_bf16 v4, v79, v79
v_mfma_f32_32x32x16_bf16 v[48:63], v[8:11], a[100:103], v[48:63]
ds_read_b128 v[24:27], v64 offset:29696
ds_write_b32 v6, v4 offset:1024
s_add_u32 m0, s45, 0
s_add_u32 s55, s46, 0
buffer_load_dwordx4 v0, s[4:7], s55 offen offset:0 sc1 lds
v_mfma_f32_32x32x16_bf16 v[48:63], v[12:15], a[104:107], v[48:63]
ds_read_b128 v[8:11], v64 offset:30720
buffer_load_dwordx4 v0, s[4:7], s55 offen offset:1024 sc1 lds
buffer_load_dwordx4 v0, s[4:7], s55 offen offset:2048 sc1 lds
v_mfma_f32_32x32x16_bf16 v[48:63], v[16:19], a[108:111], v[48:63]
s_waitcnt lgkmcnt(3)
ds_read_b128 v[12:15], v64 offset:31744
buffer_load_dwordx4 v0, s[4:7], s55 offen offset:3072 sc1 lds
s_add_u32 m0, s45, 4096
s_add_u32 s55, s46, 4096
buffer_load_dwordx4 v0, s[4:7], s55 offen offset:0 sc1 lds
v_mfma_f32_32x32x16_bf16 v[48:63], v[20:23], a[112:115], v[48:63]
s_waitcnt lgkmcnt(3)
ds_read_b128 v[16:19], v64 offset:32768
buffer_load_dwordx4 v0, s[4:7], s55 offen offset:1024 sc1 lds
buffer_load_dwordx4 v0, s[4:7], s55 offen offset:2048 sc1 lds
v_mfma_f32_32x32x16_bf16 v[48:63], v[24:27], a[116:119], v[48:63]
s_waitcnt lgkmcnt(2)
ds_read_b128 v[20:23], v64 offset:33792
buffer_load_dwordx4 v0, s[4:7], s55 offen offset:3072 sc1 lds
s_add_u32 m0, s45, 8192
s_add_u32 s55, s46, 8192
buffer_load_dwordx4 v0, s[4:7], s55 offen offset:0 sc1 lds
v_mfma_f32_32x32x16_bf16 v[48:63], v[8:11], a[120:123], v[48:63]
s_waitcnt lgkmcnt(2)
ds_read_b128 v[24:27], v64 offset:34816
buffer_load_dwordx4 v0, s[4:7], s55 offen offset:1024 sc1 lds
s_add_u32 s45, s45, 40960
s_cmp_ge_u32 s45, 122880
s_cselect_b32 s55, 122880, 0
s_sub_u32 s45, s45, s55
v_mfma_f32_32x32x16_bf16 v[48:63], v[12:15], a[124:127], v[48:63]
s_waitcnt lgkmcnt(2)
ds_read_b128 v[8:11], v64 offset:35840
s_add_u32 s46, s46, 40960
v_mfma_f32_32x32x16_bf16 v[48:63], v[16:19], a[128:131], v[48:63]
s_waitcnt lgkmcnt(2)
ds_read_b128 v[12:15], v64 offset:36864
v_mfma_f32_32x32x16_bf16 v[48:63], v[20:23], a[132:135], v[48:63]
s_waitcnt lgkmcnt(2)
ds_read_b128 v[16:19], v64 offset:37888
v_mfma_f32_32x32x16_bf16 v[48:63], v[24:27], a[136:139], v[48:63]
s_waitcnt lgkmcnt(2)
ds_read_b128 v[20:23], v64 offset:38912
v_mfma_f32_32x32x16_bf16 v[48:63], v[8:11], a[140:143], v[48:63]
s_waitcnt lgkmcnt(2)
ds_read_b128 v[24:27], v64 offset:39936
v_mfma_f32_32x32x16_bf16 v[48:63], v[12:15], a[144:147], v[48:63]
s_add_u32 s44, s44, 1
s_cmp_eq_u32 s44, 3
s_mov_b32 s56, 40960
s_cmov_b32 s56, -81920
s_cselect_b32 s44, 0, s44
v_add_u32 v64, s56, v64
v_add_u32 v5, s56, v5
s_waitcnt vmcnt(10) lgkmcnt(2)
s_barrier
s_add_u32 s50, s50, 1
v_mov_b32 v4, s50
buffer_store_dword v4, v2, s[4:7], s60 offen sc1
ds_read_b128 v[8:11], v64 offset:0
v_mfma_f32_32x32x16_bf16 v[48:63], v[16:19], a[148:151], v[48:63]
s_waitcnt lgkmcnt(2)
ds_read_b128 v[12:15], v64 offset:1024
v_mfma_f32_32x32x16_bf16 v[48:63], v[20:23], a[152:155], v[48:63]
s_waitcnt lgkmcnt(2)
ds_read_b128 v[16:19], v64 offset:2048
v_mfma_f32_32x32x16_bf16 v[48:63], v[24:27], a[156:159], v[48:63]
s_waitcnt lgkmcnt(2)
ds_read_b128 v[20:23], v64 offset:3072
s_sub_u32 s59, s59, 1
s_cmp_eq_u32 s59, 0
s_cbranch_scc1 k_so_38
v_mfma_f32_32x32x16_bf16 v[32:47], v[8:11], a[0:3], 0
s_waitcnt lgkmcnt(2)
ds_read_b128 v[24:27], v64 offset:4096
v_mfma_f32_32x32x16_bf16 v[32:47], v[12:15], a[4:7], v[32:47]
s_waitcnt lgkmcnt(2)
ds_read_b128 v[8:11], v64 offset:5120
ds_read_b128 v[80:83], v7 offset:1024
ds_read_b128 v[84:87], v7 offset:1040
v_mov_b32 v88, 0x3727c5ac
v_mfma_f32_32x32x16_bf16 v[32:47], v[16:19], a[8:11], v[32:47]
s_waitcnt lgkmcnt(4)
ds_read_b128 v[12:15], v64 offset:6144
s_waitcnt lgkmcnt(1)
v_add_f32 v80, v80, v84
v_add_f32 v81, v81, v85
v_add_f32 v82, v82, v86
v_add_f32 v83, v83, v87
v_add_f32 v80, v80, v81
v_add_f32 v82, v82, v83
v_add_f32 v80, v80, v82
v_mfma_f32_32x32x16_bf16 v[32:47], v[20:23], a[12:15], v[32:47]
ds_read_b128 v[16:19], v64 offset:7168
v_fma_f32 v80, v80, s61, v88
v_rsq_f32 v80, v80
ds_write_b32 v28, v80
v_mfma_f32_32x32x16_bf16 v[32:47], v[24:27], a[16:19], v[32:47]
ds_read_b128 v[20:23], v64 offset:8192
ds_read_b128 v[80:83], v29 offset:0
ds_read_b128 v[84:87], v29 offset:32
ds_read_b128 v[88:91], v29 offset:64
ds_read_b128 v[92:95], v29 offset:96
v_mfma_f32_32x32x16_bf16 v[32:47], v[8:11], a[20:23], v[32:47]
s_waitcnt lgkmcnt(7)
ds_read_b128 v[24:27], v64 offset:9216
s_waitcnt lgkmcnt(4)
v_mul_f32 v80, v80, v48
v_mul_f32 v81, v81, v49
v_mul_f32 v82, v82, v50
v_mul_f32 v83, v83, v51
v_mfma_f32_32x32x16_bf16 v[32:47], v[12:15], a[24:27], v[32:47]
ds_read_b128 v[8:11], v64 offset:10240
s_waitcnt lgkmcnt(4)
v_mul_f32 v84, v84, v52
v_mul_f32 v85, v85, v53
v_mul_f32 v86, v86, v54
v_mul_f32 v87, v87, v55
v_mfma_f32_32x32x16_bf16 v[32:47], v[16:19], a[28:31], v[32:47]
ds_read_b128 v[12:15], v64 offset:11264
s_waitcnt lgkmcnt(4)
v_mul_f32 v88, v88, v56
v_mul_f32 v89, v89, v57
v_mul_f32 v90, v90, v58
v_mul_f32 v91, v91, v59
v_mfma_f32_32x32x16_bf16 v[32:47], v[20:23], a[32:35], v[32:47]
s_waitcnt lgkmcnt(2)
ds_read_b128 v[16:19], v64 offset:12288
v_mul_f32 v92, v92, v60
v_mul_f32 v93, v93, v61
v_mul_f32 v94, v94, v62
v_mul_f32 v95, v95, v63
v_mfma_f32_32x32x16_bf16 v[32:47], v[24:27], a[36:39], v[32:47]
s_waitcnt lgkmcnt(2)
ds_read_b128 v[20:23], v64 offset:13312
v_cvt_pk_bf16_f32 v48, v80, v81
v_cvt_pk_bf16_f32 v49, v82, v83
v_mfma_f32_32x32x16_bf16 v[32:47], v[8:11], a[40:43], v[32:47]
s_waitcnt lgkmcnt(2)
ds_read_b128 v[24:27], v64 offset:14336
v_cvt_pk_bf16_f32 v52, v84, v85
v_cvt_pk_bf16_f32 v53, v86, v87
v_mfma_f32_32x32x16_bf16 v[32:47], v[12:15], a[44:47], v[32:47]
s_waitcnt lgkmcnt(2)
ds_read_b128 v[8:11], v64 offset:15360
v_cvt_pk_bf16_f32 v50, v88, v89
v_cvt_pk_bf16_f32 v51, v90, v91
v_mfma_f32_32x32x16_bf16 v[32:47], v[16:19], a[48:51], v[32:47]
s_waitcnt lgkmcnt(2)
ds_read_b128 v[12:15], v64 offset:16384
v_cvt_pk_bf16_f32 v54, v92, v93
v_cvt_pk_bf16_f32 v55, v94, v95
v_mfma_f32_32x32x16_bf16 v[32:47], v[20:23], a[52:55], v[32:47]
s_waitcnt lgkmcnt(2)
ds_read_b128 v[16:19], v64 offset:17408
buffer_store_dwordx4 v[48:51], v1, s[4:7], s48 offen offset:2048 sc1
buffer_store_dwordx4 v[52:55], v1, s[4:7], s48 offen offset:2560 sc1
v_mfma_f32_32x32x16_bf16 v[32:47], v[24:27], a[56:59], v[32:47]
s_waitcnt lgkmcnt(2)
ds_read_b128 v[20:23], v64 offset:18432
s_add_u32 s48, s48, s49
ds_read_b128 v[72:75], v5
v_mov_b32 v4, 0
v_mfma_f32_32x32x16_bf16 v[32:47], v[8:11], a[60:63], v[32:47]
s_waitcnt lgkmcnt(3)
ds_read_b128 v[24:27], v64 offset:19456
ds_read_b128 v[76:79], v5 offset:1024
s_waitcnt lgkmcnt(2)
v_and_b32 v72, v3, v72
v_mfma_f32_32x32x16_bf16 v[32:47], v[12:15], a[64:67], v[32:47]
ds_read_b128 v[8:11], v64 offset:20480
v_dot2c_f32_bf16 v4, v72, v72
v_dot2c_f32_bf16 v4, v73, v73
v_dot2c_f32_bf16 v4, v74, v74
v_dot2c_f32_bf16 v4, v75, v75
ds_read_b128 v[72:75], v5 offset:2048
v_mfma_f32_32x32x16_bf16 v[32:47], v[16:19], a[68:71], v[32:47]
ds_read_b128 v[12:15], v64 offset:21504
s_waitcnt lgkmcnt(3)
v_dot2c_f32_bf16 v4, v76, v76
v_dot2c_f32_bf16 v4, v77, v77
v_dot2c_f32_bf16 v4, v78, v78
v_dot2c_f32_bf16 v4, v79, v79
ds_read_b128 v[76:79], v5 offset:3072
v_mfma_f32_32x32x16_bf16 v[32:47], v[20:23], a[72:75], v[32:47]
ds_read_b128 v[16:19], v64 offset:22528
s_waitcnt lgkmcnt(3)
v_dot2c_f32_bf16 v4, v72, v72
v_dot2c_f32_bf16 v4, v73, v73
v_dot2c_f32_bf16 v4, v74, v74
v_dot2c_f32_bf16 v4, v75, v75
ds_read_b128 v[72:75], v5 offset:4096
v_mfma_f32_32x32x16_bf16 v[32:47], v[24:27], a[76:79], v[32:47]
ds_read_b128 v[20:23], v64 offset:23552
s_waitcnt lgkmcnt(3)
v_dot2c_f32_bf16 v4, v76, v76
v_dot2c_f32_bf16 v4, v77, v77
v_dot2c_f32_bf16 v4, v78, v78
v_dot2c_f32_bf16 v4, v79, v79
ds_read_b128 v[76:79], v5 offset:5120
v_mfma_f32_32x32x16_bf16 v[32:47], v[8:11], a[80:83], v[32:47]
ds_read_b128 v[24:27], v64 offset:24576
s_waitcnt lgkmcnt(3)
v_dot2c_f32_bf16 v4, v72, v72
v_dot2c_f32_bf16 v4, v73, v73
v_dot2c_f32_bf16 v4, v74, v74
v_dot2c_f32_bf16 v4, v75, v75
ds_read_b128 v[72:75], v5 offset:6144
v_mfma_f32_32x32x16_bf16 v[32:47], v[12:15], a[84:87], v[32:47]
ds_read_b128 v[8:11], v64 offset:25600
s_waitcnt lgkmcnt(3)
v_dot2c_f32_bf16 v4, v76, v76
v_dot2c_f32_bf16 v4, v77, v77
v_dot2c_f32_bf16 v4, v78, v78
v_dot2c_f32_bf16 v4, v79, v79
ds_read_b128 v[76:79], v5 offset:7168
v_mfma_f32_32x32x16_bf16 v[32:47], v[16:19], a[88:91], v[32:47]
ds_read_b128 v[12:15], v64 offset:26624
s_waitcnt lgkmcnt(3)
v_dot2c_f32_bf16 v4, v72, v72
v_dot2c_f32_bf16 v4, v73, v73
v_dot2c_f32_bf16 v4, v74, v74
v_dot2c_f32_bf16 v4, v75, v75
ds_read_b128 v[72:75], v5 offset:8192
v_mfma_f32_32x32x16_bf16 v[32:47], v[20:23], a[92:95], v[32:47]
ds_read_b128 v[16:19], v64 offset:27648
s_waitcnt lgkmcnt(3)
v_dot2c_f32_bf16 v4, v76, v76
v_dot2c_f32_bf16 v4, v77, v77
v_dot2c_f32_bf16 v4, v78, v78
v_dot2c_f32_bf16 v4, v79, v79
ds_read_b128 v[76:79], v5 offset:9216
v_mfma_f32_32x32x16_bf16 v[32:47], v[24:27], a[96:99], v[32:47]
ds_read_b128 v[20:23], v64 offset:28672
s_waitcnt lgkmcnt(3)
v_dot2c_f32_bf16 v4, v72, v72
v_dot2c_f32_bf16 v4, v73, v73
v_dot2c_f32_bf16 v4, v74, v74
v_dot2c_f32_bf16 v4, v75, v75
s_waitcnt lgkmcnt(1)
v_dot2c_f32_bf16 v4, v76, v76
v_dot2c_f32_bf16 v4, v77, v77
v_dot2c_f32_bf16 v4, v78, v78
v_dot2c_f32_bf16 v4, v79, v79
v_mfma_f32_32x32x16_bf16 v[32:47], v[8:11], a[100:103], v[32:47]
ds_read_b128 v[24:27], v64 offset:29696
ds_write_b32 v6, v4 offset:0
s_add_u32 m0, s45, 0
s_add_u32 s55, s46, 0
buffer_load_dwordx4 v0, s[4:7], s55 offen offset:0 sc1 lds
v_mfma_f32_32x32x16_bf16 v[32:47], v[12:15], a[104:107], v[32:47]
ds_read_b128 v[8:11], v64 offset:30720
buffer_load_dwordx4 v0, s[4:7], s55 offen offset:1024 sc1 lds
buffer_load_dwordx4 v0, s[4:7], s55 offen offset:2048 sc1 lds
v_mfma_f32_32x32x16_bf16 v[32:47], v[16:19], a[108:111], v[32:47]
s_waitcnt lgkmcnt(3)
ds_read_b128 v[12:15], v64 offset:31744
buffer_load_dwordx4 v0, s[4:7], s55 offen offset:3072 sc1 lds
s_add_u32 m0, s45, 4096
s_add_u32 s55, s46, 4096
buffer_load_dwordx4 v0, s[4:7], s55 offen offset:0 sc1 lds
v_mfma_f32_32x32x16_bf16 v[32:47], v[20:23], a[112:115], v[32:47]
s_waitcnt lgkmcnt(3)
ds_read_b128 v[16:19], v64 offset:32768
buffer_load_dwordx4 v0, s[4:7], s55 offen offset:1024 sc1 lds
buffer_load_dwordx4 v0, s[4:7], s55 offen offset:2048 sc1 lds
v_mfma_f32_32x32x16_bf16 v[32:47], v[24:27], a[116:119], v[32:47]
s_waitcnt lgkmcnt(2)
ds_read_b128 v[20:23], v64 offset:33792
buffer_load_dwordx4 v0, s[4:7], s55 offen offset:3072 sc1 lds
s_add_u32 m0, s45, 8192
s_add_u32 s55, s46, 8192
buffer_load_dwordx4 v0, s[4:7], s55 offen offset:0 sc1 lds
v_mfma_f32_32x32x16_bf16 v[32:47], v[8:11], a[120:123], v[32:47]
s_waitcnt lgkmcnt(2)
ds_read_b128 v[24:27], v64 offset:34816
buffer_load_dwordx4 v0, s[4:7], s55 offen offset:1024 sc1 lds
s_add_u32 s45, s45, 40960
s_cmp_ge_u32 s45, 122880
s_cselect_b32 s55, 122880, 0
s_sub_u32 s45, s45, s55
v_mfma_f32_32x32x16_bf16 v[32:47], v[12:15], a[124:127], v[32:47]
s_waitcnt lgkmcnt(2)
ds_read_b128 v[8:11], v64 offset:35840
s_add_u32 s46, s46, 40960
v_mfma_f32_32x32x16_bf16 v[32:47], v[16:19], a[128:131], v[32:47]
s_waitcnt lgkmcnt(2)
ds_read_b128 v[12:15], v64 offset:36864
v_mfma_f32_32x32x16_bf16 v[32:47], v[20:23], a[132:135], v[32:47]
s_waitcnt lgkmcnt(2)
ds_read_b128 v[16:19], v64 offset:37888
v_mfma_f32_32x32x16_bf16 v[32:47], v[24:27], a[136:139], v[32:47]
s_waitcnt lgkmcnt(2)
ds_read_b128 v[20:23], v64 offset:38912
v_mfma_f32_32x32x16_bf16 v[32:47], v[8:11], a[140:143], v[32:47]
s_waitcnt lgkmcnt(2)
ds_read_b128 v[24:27], v64 offset:39936
v_mfma_f32_32x32x16_bf16 v[32:47], v[12:15], a[144:147], v[32:47]
s_add_u32 s44, s44, 1
s_cmp_eq_u32 s44, 3
s_mov_b32 s56, 40960
s_cmov_b32 s56, -81920
s_cselect_b32 s44, 0, s44
v_add_u32 v64, s56, v64
v_add_u32 v5, s56, v5
s_waitcnt vmcnt(10) lgkmcnt(2)
s_barrier
s_add_u32 s50, s50, 1
v_mov_b32 v4, s50
buffer_store_dword v4, v2, s[4:7], s60 offen sc1
ds_read_b128 v[8:11], v64 offset:0
v_mfma_f32_32x32x16_bf16 v[32:47], v[16:19], a[148:151], v[32:47]
s_waitcnt lgkmcnt(2)
ds_read_b128 v[12:15], v64 offset:1024
v_mfma_f32_32x32x16_bf16 v[32:47], v[20:23], a[152:155], v[32:47]
s_waitcnt lgkmcnt(2)
ds_read_b128 v[16:19], v64 offset:2048
v_mfma_f32_32x32x16_bf16 v[32:47], v[24:27], a[156:159], v[32:47]
s_waitcnt lgkmcnt(2)
ds_read_b128 v[20:23], v64 offset:3072
s_branch k_st_37
k_so_38:
ds_read_b128 v[80:83], v7 offset:1024
ds_read_b128 v[84:87], v7 offset:1040
v_mov_b32 v88, 0x3727c5ac
s_waitcnt lgkmcnt(0)
v_add_f32 v80, v80, v84
v_add_f32 v81, v81, v85
v_add_f32 v82, v82, v86
v_add_f32 v83, v83, v87
v_add_f32 v80, v80, v81
v_add_f32 v82, v82, v83
v_add_f32 v80, v80, v82
v_fma_f32 v80, v80, s61, v88
v_rsq_f32 v80, v80
ds_write_b32 v28, v80
ds_read_b128 v[80:83], v29 offset:0
ds_read_b128 v[84:87], v29 offset:32
ds_read_b128 v[88:91], v29 offset:64
ds_read_b128 v[92:95], v29 offset:96
s_waitcnt lgkmcnt(3)
v_mul_f32 v80, v80, v48
v_mul_f32 v81, v81, v49
v_mul_f32 v82, v82, v50
v_mul_f32 v83, v83, v51
s_waitcnt lgkmcnt(2)
v_mul_f32 v84, v84, v52
v_mul_f32 v85, v85, v53
v_mul_f32 v86, v86, v54
v_mul_f32 v87, v87, v55
s_waitcnt lgkmcnt(1)
v_mul_f32 v88, v88, v56
v_mul_f32 v89, v89, v57
v_mul_f32 v90, v90, v58
v_mul_f32 v91, v91, v59
s_waitcnt lgkmcnt(0)
v_mul_f32 v92, v92, v60
v_mul_f32 v93, v93, v61
v_mul_f32 v94, v94, v62
v_mul_f32 v95, v95, v63
v_cvt_pk_bf16_f32 v48, v80, v81
v_cvt_pk_bf16_f32 v49, v82, v83
v_cvt_pk_bf16_f32 v52, v84, v85
v_cvt_pk_bf16_f32 v53, v86, v87
v_cvt_pk_bf16_f32 v50, v88, v89
v_cvt_pk_bf16_f32 v51, v90, v91
v_cvt_pk_bf16_f32 v54, v92, v93
v_cvt_pk_bf16_f32 v55, v94, v95
buffer_store_dwordx4 v[48:51], v1, s[4:7], s48 offen offset:2048 sc1
buffer_store_dwordx4 v[52:55], v1, s[4:7], s48 offen offset:2560 sc1
s_add_u32 s48, s48, s49
k_join_32:
s_waitcnt vmcnt(0) lgkmcnt(0)
s_barrier
s_add_u32 s50, s50, 1
v_mov_b32 v4, s50
buffer_store_dword v4, v2, s[4:7], s60 offen sc1
s_cmp_ge_u32 s30, 80
s_cbranch_scc1 k_fend_39
v_bfe_u32 v8, v0, 4, 5
v_lshrrev_b32 v9, 9, v0
s_lshl_b32 s52, s30, 2
s_add_u32 s52, s52, s3
s_cmp_eq_u32 s52, 0
s_cselect_b32 s47, 0xffff, -1
s_cselect_b32 s53, 0x30000, 0
s_cmov_b32 s52, 320
v_add_u32 v26, s53, v0
s_cmp_lg_u32 s51, 0
s_cbranch_scc1 k_fnog_40
s_load_dwordx2 s[36:37], s[0:1], 64
s_mov_b32 s38, 1314816
s_mov_b32 s39, 0x20000
s_load_dwordx2 s[40:41], s[0:1], 72
s_mov_b32 s42, 1314816
s_mov_b32 s43, 0x20000
v_lshl_add_u32 v20, v9, 8, v8
v_mul_u32_u24 v20, 642, v20
s_lshl_b32 s52, s52, 1
v_add_u32 v22, s52, v20
s_waitcnt lgkmcnt(0)
s_mov_b32 s53, 0
buffer_load_ushort v192, v22, s[36:39], s53 offen
buffer_load_ushort v208, v22, s[40:43], s53 offen
s_mov_b32 s53, 41088
buffer_load_ushort v193, v22, s[36:39], s53 offen
buffer_load_ushort v209, v22, s[40:43], s53 offen
s_mov_b32 s53, 82176
buffer_load_ushort v194, v22, s[36:39], s53 offen
buffer_load_ushort v210, v22, s[40:43], s53 offen
s_mov_b32 s53, 123264
buffer_load_ushort v195, v22, s[36:39], s53 offen
buffer_load_ushort v211, v22, s[40:43], s53 offen
s_mov_b32 s53, 328704
buffer_load_ushort v196, v22, s[36:39], s53 offen
buffer_load_ushort v212, v22, s[40:43], s53 offen
s_mov_b32 s53, 369792
buffer_load_ushort v197, v22, s[36:39], s53 offen
buffer_load_ushort v213, v22, s[40:43], s53 offen
s_mov_b32 s53, 410880
buffer_load_ushort v198, v22, s[36:39], s53 offen
buffer_load_ushort v214, v22, s[40:43], s53 offen
s_mov_b32 s53, 451968
buffer_load_ushort v199, v22, s[36:39], s53 offen
buffer_load_ushort v215, v22, s[40:43], s53 offen
s_mov_b32 s53, 657408
buffer_load_ushort v200, v22, s[36:39], s53 offen
buffer_load_ushort v216, v22, s[40:43], s53 offen
s_mov_b32 s53, 698496
buffer_load_ushort v201, v22, s[36:39], s53 offen
buffer_load_ushort v217, v22, s[40:43], s53 offen
s_mov_b32 s53, 739584
buffer_load_ushort v202, v22, s[36:39], s53 offen
buffer_load_ushort v218, v22, s[40:43], s53 offen
s_mov_b32 s53, 780672
buffer_load_ushort v203, v22, s[36:39], s53 offen
buffer_load_ushort v219, v22, s[40:43], s53 offen
s_mov_b32 s53, 986112
buffer_load_ushort v204, v22, s[36:39], s53 offen
buffer_load_ushort v220, v22, s[40:43], s53 offen
s_mov_b32 s53, 1027200
buffer_load_ushort v205, v22, s[36:39], s53 offen
buffer_load_ushort v221, v22, s[40:43], s53 offen
s_mov_b32 s53, 1068288
buffer_load_ushort v206, v22, s[36:39], s53 offen
buffer_load_ushort v222, v22, s[40:43], s53 offen
s_mov_b32 s53, 1109376
buffer_load_ushort v207, v22, s[36:39], s53 offen
buffer_load_ushort v223, v22, s[40:43], s53 offen
s_mov_b32 s53, 20544
buffer_load_ushort v224, v22, s[36:39], s53 offen
buffer_load_ushort v240, v22, s[40:43], s53 offen
s_mov_b32 s53, 61632
buffer_load_ushort v225, v22, s[36:39], s53 offen
buffer_load_ushort v241, v22, s[40:43], s53 offen
s_mov_b32 s53, 102720
buffer_load_ushort v226, v22, s[36:39], s53 offen
buffer_load_ushort v242, v22, s[40:43], s53 offen
s_mov_b32 s53, 143808
buffer_load_ushort v227, v22, s[36:39], s53 offen
buffer_load_ushort v243, v22, s[40:43], s53 offen
s_mov_b32 s53, 349248
buffer_load_ushort v228, v22, s[36:39], s53 offen
buffer_load_ushort v244, v22, s[40:43], s53 offen
s_mov_b32 s53, 390336
buffer_load_ushort v229, v22, s[36:39], s53 offen
buffer_load_ushort v245, v22, s[40:43], s53 offen
s_mov_b32 s53, 431424
buffer_load_ushort v230, v22, s[36:39], s53 offen
buffer_load_ushort v246, v22, s[40:43], s53 offen
s_mov_b32 s53, 472512
buffer_load_ushort v231, v22, s[36:39], s53 offen
buffer_load_ushort v247, v22, s[40:43], s53 offen
s_mov_b32 s53, 677952
buffer_load_ushort v232, v22, s[36:39], s53 offen
buffer_load_ushort v248, v22, s[40:43], s53 offen
s_mov_b32 s53, 719040
buffer_load_ushort v233, v22, s[36:39], s53 offen
buffer_load_ushort v249, v22, s[40:43], s53 offen
s_mov_b32 s53, 760128
buffer_load_ushort v234, v22, s[36:39], s53 offen
buffer_load_ushort v250, v22, s[40:43], s53 offen
s_mov_b32 s53, 801216
buffer_load_ushort v235, v22, s[36:39], s53 offen
buffer_load_ushort v251, v22, s[40:43], s53 offen
s_mov_b32 s53, 1006656
buffer_load_ushort v236, v22, s[36:39], s53 offen
buffer_load_ushort v252, v22, s[40:43], s53 offen
s_mov_b32 s53, 1047744
buffer_load_ushort v237, v22, s[36:39], s53 offen
buffer_load_ushort v253, v22, s[40:43], s53 offen
s_mov_b32 s53, 1088832
buffer_load_ushort v238, v22, s[36:39], s53 offen
buffer_load_ushort v254, v22, s[40:43], s53 offen
s_mov_b32 s53, 1129920
buffer_load_ushort v239, v22, s[36:39], s53 offen
buffer_load_ushort v255, v22, s[40:43], s53 offen
v_lshl_add_u32 v10, v9, 2, 0
v_mul_u32_u24 v10, v10, v8
v_and_b32 v20, 31, v10
v_cvt_f32_u32 v20, v20
v_mul_f32 v20, 0x3d000000, v20
v_sin_f32 v21, v20
v_cos_f32 v20, v20
v_add_u32 v10, v8, v10
v_cvt_pk_bf16_f32 v32, v20, v21
v_cvt_pk_bf16_f32 v36, -v21, v20
v_and_b32 v20, 31, v10
v_cvt_f32_u32 v20, v20
v_mul_f32 v20, 0x3d000000, v20
v_sin_f32 v21, v20
v_cos_f32 v20, v20
v_add_u32 v10, v8, v10
v_cvt_pk_bf16_f32 v33, v20, v21
v_cvt_pk_bf16_f32 v37, -v21, v20
v_and_b32 v20, 31, v10
v_cvt_f32_u32 v20, v20
v_mul_f32 v20, 0x3d000000, v20
v_sin_f32 v21, v20
v_cos_f32 v20, v20
v_add_u32 v10, v8, v10
v_cvt_pk_bf16_f32 v34, v20, v21
v_cvt_pk_bf16_f32 v38, -v21, v20
v_and_b32 v20, 31, v10
v_cvt_f32_u32 v20, v20
v_mul_f32 v20, 0x3d000000, v20
v_sin_f32 v21, v20
v_cos_f32 v20, v20
v_add_u32 v10, v8, v10
v_cvt_pk_bf16_f32 v35, v20, v21
v_cvt_pk_bf16_f32 v39, -v21, v20
v_accvgpr_write_b32 a160, v32
v_accvgpr_write_b32 a161, v33
v_accvgpr_write_b32 a162, v34
v_accvgpr_write_b32 a163, v35
v_accvgpr_write_b32 a164, v36
v_accvgpr_write_b32 a165, v37
v_accvgpr_write_b32 a166, v38
v_accvgpr_write_b32 a167, v39
v_lshl_add_u32 v10, v9, 2, 8
v_mul_u32_u24 v10, v10, v8
v_and_b32 v20, 31, v10
v_cvt_f32_u32 v20, v20
v_mul_f32 v20, 0x3d000000, v20
v_sin_f32 v21, v20
v_cos_f32 v20, v20
v_add_u32 v10, v8, v10
v_cvt_pk_bf16_f32 v32, v20, v21
v_cvt_pk_bf16_f32 v36, -v21, v20
v_and_b32 v20, 31, v10
v_cvt_f32_u32 v20, v20
v_mul_f32 v20, 0x3d000000, v20
v_sin_f32 v21, v20
v_cos_f32 v20, v20
v_add_u32 v10, v8, v10
v_cvt_pk_bf16_f32 v33, v20, v21
v_cvt_pk_bf16_f32 v37, -v21, v20
v_and_b32 v20, 31, v10
v_cvt_f32_u32 v20, v20
v_mul_f32 v20, 0x3d000000, v20
v_sin_f32 v21, v20
v_cos_f32 v20, v20
v_add_u32 v10, v8, v10
v_cvt_pk_bf16_f32 v34, v20, v21
v_cvt_pk_bf16_f32 v38, -v21, v20
v_and_b32 v20, 31, v10
v_cvt_f32_u32 v20, v20
v_mul_f32 v20, 0x3d000000, v20
v_sin_f32 v21, v20
v_cos_f32 v20, v20
v_add_u32 v10, v8, v10
v_cvt_pk_bf16_f32 v35, v20, v21
v_cvt_pk_bf16_f32 v39, -v21, v20
v_accvgpr_write_b32 a168, v32
v_accvgpr_write_b32 a169, v33
v_accvgpr_write_b32 a170, v34
v_accvgpr_write_b32 a171, v35
v_accvgpr_write_b32 a172, v36
v_accvgpr_write_b32 a173, v37
v_accvgpr_write_b32 a174, v38
v_accvgpr_write_b32 a175, v39
v_lshl_add_u32 v10, v9, 2, 16
v_mul_u32_u24 v10, v10, v8
v_and_b32 v20, 31, v10
v_cvt_f32_u32 v20, v20
v_mul_f32 v20, 0x3d000000, v20
v_sin_f32 v21, v20
v_cos_f32 v20, v20
v_add_u32 v10, v8, v10
v_cvt_pk_bf16_f32 v32, v20, v21
v_cvt_pk_bf16_f32 v36, -v21, v20
v_and_b32 v20, 31, v10
v_cvt_f32_u32 v20, v20
v_mul_f32 v20, 0x3d000000, v20
v_sin_f32 v21, v20
v_cos_f32 v20, v20
v_add_u32 v10, v8, v10
v_cvt_pk_bf16_f32 v33, v20, v21
v_cvt_pk_bf16_f32 v37, -v21, v20
v_and_b32 v20, 31, v10
v_cvt_f32_u32 v20, v20
v_mul_f32 v20, 0x3d000000, v20
v_sin_f32 v21, v20
v_cos_f32 v20, v20
v_add_u32 v10, v8, v10
v_cvt_pk_bf16_f32 v34, v20, v21
v_cvt_pk_bf16_f32 v38, -v21, v20
v_and_b32 v20, 31, v10
v_cvt_f32_u32 v20, v20
v_mul_f32 v20, 0x3d000000, v20
v_sin_f32 v21, v20
v_cos_f32 v20, v20
v_add_u32 v10, v8, v10
v_cvt_pk_bf16_f32 v35, v20, v21
v_cvt_pk_bf16_f32 v39, -v21, v20
v_accvgpr_write_b32 a176, v32
v_accvgpr_write_b32 a177, v33
v_accvgpr_write_b32 a178, v34
v_accvgpr_write_b32 a179, v35
v_accvgpr_write_b32 a180, v36
v_accvgpr_write_b32 a181, v37
v_accvgpr_write_b32 a182, v38
v_accvgpr_write_b32 a183, v39
v_lshl_add_u32 v10, v9, 2, 24
v_mul_u32_u24 v10, v10, v8
v_and_b32 v20, 31, v10
v_cvt_f32_u32 v20, v20
v_mul_f32 v20, 0x3d000000, v20
v_sin_f32 v21, v20
v_cos_f32 v20, v20
v_add_u32 v10, v8, v10
v_cvt_pk_bf16_f32 v32, v20, v21
v_cvt_pk_bf16_f32 v36, -v21, v20
v_and_b32 v20, 31, v10
v_cvt_f32_u32 v20, v20
v_mul_f32 v20, 0x3d000000, v20
v_sin_f32 v21, v20
v_cos_f32 v20, v20
v_add_u32 v10, v8, v10
v_cvt_pk_bf16_f32 v33, v20, v21
v_cvt_pk_bf16_f32 v37, -v21, v20
v_and_b32 v20, 31, v10
v_cvt_f32_u32 v20, v20
v_mul_f32 v20, 0x3d000000, v20
v_sin_f32 v21, v20
v_cos_f32 v20, v20
v_add_u32 v10, v8, v10
v_cvt_pk_bf16_f32 v34, v20, v21
v_cvt_pk_bf16_f32 v38, -v21, v20
v_and_b32 v20, 31, v10
v_cvt_f32_u32 v20, v20
v_mul_f32 v20, 0x3d000000, v20
v_sin_f32 v21, v20
v_cos_f32 v20, v20
v_add_u32 v10, v8, v10
v_cvt_pk_bf16_f32 v35, v20, v21
v_cvt_pk_bf16_f32 v39, -v21, v20
v_accvgpr_write_b32 a184, v32
v_accvgpr_write_b32 a185, v33
v_accvgpr_write_b32 a186, v34
v_accvgpr_write_b32 a187, v35
v_accvgpr_write_b32 a188, v36
v_accvgpr_write_b32 a189, v37
v_accvgpr_write_b32 a190, v38
v_accvgpr_write_b32 a191, v39
s_waitcnt vmcnt(63)
v_lshlrev_b32 v192, 16, v192
v_mul_f32 v192, 0x3a000000, v192
s_waitcnt vmcnt(61)
v_lshlrev_b32 v193, 16, v193
v_mul_f32 v193, 0x3a000000, v193
s_waitcnt vmcnt(59)
v_lshlrev_b32 v194, 16, v194
v_mul_f32 v194, 0x3a000000, v194
s_waitcnt vmcnt(57)
v_lshlrev_b32 v195, 16, v195
v_mul_f32 v195, 0x3a000000, v195
s_waitcnt vmcnt(55)
v_lshlrev_b32 v196, 16, v196
v_mul_f32 v196, 0x3a000000, v196
s_waitcnt vmcnt(53)
v_lshlrev_b32 v197, 16, v197
v_mul_f32 v197, 0x3a000000, v197
s_waitcnt vmcnt(51)
v_lshlrev_b32 v198, 16, v198
v_mul_f32 v198, 0x3a000000, v198
s_waitcnt vmcnt(49)
v_lshlrev_b32 v199, 16, v199
v_mul_f32 v199, 0x3a000000, v199
s_waitcnt vmcnt(47)
v_lshlrev_b32 v200, 16, v200
v_mul_f32 v200, 0x3a000000, v200
s_waitcnt vmcnt(45)
v_lshlrev_b32 v201, 16, v201
v_mul_f32 v201, 0x3a000000, v201
s_waitcnt vmcnt(43)
v_lshlrev_b32 v202, 16, v202
v_mul_f32 v202, 0x3a000000, v202
s_waitcnt vmcnt(41)
v_lshlrev_b32 v203, 16, v203
v_mul_f32 v203, 0x3a000000, v203
s_waitcnt vmcnt(39)
v_lshlrev_b32 v204, 16, v204
v_mul_f32 v204, 0x3a000000, v204
s_waitcnt vmcnt(37)
v_lshlrev_b32 v205, 16, v205
v_mul_f32 v205, 0x3a000000, v205
s_waitcnt vmcnt(35)
v_lshlrev_b32 v206, 16, v206
v_mul_f32 v206, 0x3a000000, v206
s_waitcnt vmcnt(33)
v_lshlrev_b32 v207, 16, v207
v_mul_f32 v207, 0x3a000000, v207
v_lshlrev_b32 v208, 16, v208
v_mul_f32 v208, 0x3a000000, v208
v_lshlrev_b32 v209, 16, v209
v_mul_f32 v209, 0x3a000000, v209
v_lshlrev_b32 v210, 16, v210
v_mul_f32 v210, 0x3a000000, v210
v_lshlrev_b32 v211, 16, v211
v_mul_f32 v211, 0x3a000000, v211
v_lshlrev_b32 v212, 16, v212
v_mul_f32 v212, 0x3a000000, v212
v_lshlrev_b32 v213, 16, v213
v_mul_f32 v213, 0x3a000000, v213
v_lshlrev_b32 v214, 16, v214
v_mul_f32 v214, 0x3a000000, v214
v_lshlrev_b32 v215, 16, v215
v_mul_f32 v215, 0x3a000000, v215
v_lshlrev_b32 v216, 16, v216
v_mul_f32 v216, 0x3a000000, v216
v_lshlrev_b32 v217, 16, v217
v_mul_f32 v217, 0x3a000000, v217
v_lshlrev_b32 v218, 16, v218
v_mul_f32 v218, 0x3a000000, v218
v_lshlrev_b32 v219, 16, v219
v_mul_f32 v219, 0x3a000000, v219
v_lshlrev_b32 v220, 16, v220
v_mul_f32 v220, 0x3a000000, v220
v_lshlrev_b32 v221, 16, v221
v_mul_f32 v221, 0x3a000000, v221
v_lshlrev_b32 v222, 16, v222
v_mul_f32 v222, 0x3a000000, v222
s_waitcnt vmcnt(32)
v_lshlrev_b32 v223, 16, v223
v_mul_f32 v223, 0x3a000000, v223
s_waitcnt vmcnt(31)
v_lshlrev_b32 v224, 16, v224
v_mul_f32 v224, 0x3a000000, v224
s_waitcnt vmcnt(29)
v_lshlrev_b32 v225, 16, v225
v_mul_f32 v225, 0x3a000000, v225
s_waitcnt vmcnt(27)
v_lshlrev_b32 v226, 16, v226
v_mul_f32 v226, 0x3a000000, v226
s_waitcnt vmcnt(25)
v_lshlrev_b32 v227, 16, v227
v_mul_f32 v227, 0x3a000000, v227
s_waitcnt vmcnt(23)
v_lshlrev_b32 v228, 16, v228
v_mul_f32 v228, 0x3a000000, v228
s_waitcnt vmcnt(21)
v_lshlrev_b32 v229, 16, v229
v_mul_f32 v229, 0x3a000000, v229
s_waitcnt vmcnt(19)
v_lshlrev_b32 v230, 16, v230
v_mul_f32 v230, 0x3a000000, v230
s_waitcnt vmcnt(17)
v_lshlrev_b32 v231, 16, v231
v_mul_f32 v231, 0x3a000000, v231
s_waitcnt vmcnt(15)
v_lshlrev_b32 v232, 16, v232
v_mul_f32 v232, 0x3a000000, v232
s_waitcnt vmcnt(13)
v_lshlrev_b32 v233, 16, v233
v_mul_f32 v233, 0x3a000000, v233
s_waitcnt vmcnt(11)
v_lshlrev_b32 v234, 16, v234
v_mul_f32 v234, 0x3a000000, v234
s_waitcnt vmcnt(9)
v_lshlrev_b32 v235, 16, v235
v_mul_f32 v235, 0x3a000000, v235
s_waitcnt vmcnt(7)
v_lshlrev_b32 v236, 16, v236
v_mul_f32 v236, 0x3a000000, v236
s_waitcnt vmcnt(5)
v_lshlrev_b32 v237, 16, v237
v_mul_f32 v237, 0x3a000000, v237
s_waitcnt vmcnt(3)
v_lshlrev_b32 v238, 16, v238
v_mul_f32 v238, 0x3a000000, v238
s_waitcnt vmcnt(1)
v_lshlrev_b32 v239, 16, v239
v_mul_f32 v239, 0x3a000000, v239
v_lshlrev_b32 v240, 16, v240
v_mul_f32 v240, 0x3a000000, v240
v_lshlrev_b32 v241, 16, v241
v_mul_f32 v241, 0x3a000000, v241
v_lshlrev_b32 v242, 16, v242
v_mul_f32 v242, 0x3a000000, v242
v_lshlrev_b32 v243, 16, v243
v_mul_f32 v243, 0x3a000000, v243
v_lshlrev_b32 v244, 16, v244
v_mul_f32 v244, 0x3a000000, v244
v_lshlrev_b32 v245, 16, v245
v_mul_f32 v245, 0x3a000000, v245
v_lshlrev_b32 v246, 16, v246
v_mul_f32 v246, 0x3a000000, v246
v_lshlrev_b32 v247, 16, v247
v_mul_f32 v247, 0x3a000000, v247
v_lshlrev_b32 v248, 16, v248
v_mul_f32 v248, 0x3a000000, v248
v_lshlrev_b32 v249, 16, v249
v_mul_f32 v249, 0x3a000000, v249
v_lshlrev_b32 v250, 16, v250
v_mul_f32 v250, 0x3a000000, v250
v_lshlrev_b32 v251, 16, v251
v_mul_f32 v251, 0x3a000000, v251
v_lshlrev_b32 v252, 16, v252
v_mul_f32 v252, 0x3a000000, v252
v_lshlrev_b32 v253, 16, v253
v_mul_f32 v253, 0x3a000000, v253
v_lshlrev_b32 v254, 16, v254
v_mul_f32 v254, 0x3a000000, v254
s_waitcnt vmcnt(0)
v_lshlrev_b32 v255, 16, v255
v_mul_f32 v255, 0x3a000000, v255
k_fnog_40:
s_lshl_b32 s52, s3, 13
v_add_u32 v12, s52, v0
s_lshl_b32 s52, s3, 4
v_lshl_add_u32 v10, v9, 2, s52
v_add_u32 v10, 0, v10
v_add_u32 v11, 0, v8
v_mul_u32_u24 v10, v10, v11
v_and_b32 v20, 63, v10
v_cvt_f32_u32 v20, v20
v_mul_f32 v20, 0x3c800000, v20
v_sin_f32 v21, v20
v_cos_f32 v20, v20
v_add_u32 v10, v11, v10
v_cvt_pk_bf16_f32 v32, v20, v21
v_cvt_pk_bf16_f32 v36, -v21, v20
v_and_b32 v20, 63, v10
v_cvt_f32_u32 v20, v20
v_mul_f32 v20, 0x3c800000, v20
v_sin_f32 v21, v20
v_cos_f32 v20, v20
v_add_u32 v10, v11, v10
v_cvt_pk_bf16_f32 v33, v20, v21
v_cvt_pk_bf16_f32 v37, -v21, v20
v_and_b32 v20, 63, v10
v_cvt_f32_u32 v20, v20
v_mul_f32 v20, 0x3c800000, v20
v_sin_f32 v21, v20
v_cos_f32 v20, v20
v_add_u32 v10, v11, v10
v_cvt_pk_bf16_f32 v34, v20, v21
v_cvt_pk_bf16_f32 v38, -v21, v20
v_and_b32 v20, 63, v10
v_cvt_f32_u32 v20, v20
v_mul_f32 v20, 0x3c800000, v20
v_sin_f32 v21, v20
v_cos_f32 v20, v20
v_add_u32 v10, v11, v10
v_cvt_pk_bf16_f32 v35, v20, v21
v_cvt_pk_bf16_f32 v39, -v21, v20
ds_write_b128 v12, v[32:35] offset:0
ds_write_b128 v12, v[36:39] offset:1024
v_lshl_add_u32 v10, v9, 2, s52
v_add_u32 v10, 0, v10
v_add_u32 v11, 32, v8
v_mul_u32_u24 v10, v10, v11
v_and_b32 v20, 63, v10
v_cvt_f32_u32 v20, v20
v_mul_f32 v20, 0x3c800000, v20
v_sin_f32 v21, v20
v_cos_f32 v20, v20
v_add_u32 v10, v11, v10
v_cvt_pk_bf16_f32 v40, v20, v21
v_cvt_pk_bf16_f32 v44, -v21, v20
v_and_b32 v20, 63, v10
v_cvt_f32_u32 v20, v20
v_mul_f32 v20, 0x3c800000, v20
v_sin_f32 v21, v20
v_cos_f32 v20, v20
v_add_u32 v10, v11, v10
v_cvt_pk_bf16_f32 v41, v20, v21
v_cvt_pk_bf16_f32 v45, -v21, v20
v_and_b32 v20, 63, v10
v_cvt_f32_u32 v20, v20
v_mul_f32 v20, 0x3c800000, v20
v_sin_f32 v21, v20
v_cos_f32 v20, v20
v_add_u32 v10, v11, v10
v_cvt_pk_bf16_f32 v42, v20, v21
v_cvt_pk_bf16_f32 v46, -v21, v20
v_and_b32 v20, 63, v10
v_cvt_f32_u32 v20, v20
v_mul_f32 v20, 0x3c800000, v20
v_sin_f32 v21, v20
v_cos_f32 v20, v20
v_add_u32 v10, v11, v10
v_cvt_pk_bf16_f32 v43, v20, v21
v_cvt_pk_bf16_f32 v47, -v21, v20
ds_write_b128 v12, v[40:43] offset:2048
ds_write_b128 v12, v[44:47] offset:3072
v_lshl_add_u32 v10, v9, 2, s52
v_add_u32 v10, 8, v10
v_add_u32 v11, 0, v8
v_mul_u32_u24 v10, v10, v11
v_and_b32 v20, 63, v10
v_cvt_f32_u32 v20, v20
v_mul_f32 v20, 0x3c800000, v20
v_sin_f32 v21, v20
v_cos_f32 v20, v20
v_add_u32 v10, v11, v10
v_cvt_pk_bf16_f32 v48, v20, v21
v_cvt_pk_bf16_f32 v52, -v21, v20
v_and_b32 v20, 63, v10
v_cvt_f32_u32 v20, v20
v_mul_f32 v20, 0x3c800000, v20
v_sin_f32 v21, v20
v_cos_f32 v20, v20
v_add_u32 v10, v11, v10
v_cvt_pk_bf16_f32 v49, v20, v21
v_cvt_pk_bf16_f32 v53, -v21, v20
v_and_b32 v20, 63, v10
v_cvt_f32_u32 v20, v20
v_mul_f32 v20, 0x3c800000, v20
v_sin_f32 v21, v20
v_cos_f32 v20, v20
v_add_u32 v10, v11, v10
v_cvt_pk_bf16_f32 v50, v20, v21
v_cvt_pk_bf16_f32 v54, -v21, v20
v_and_b32 v20, 63, v10
v_cvt_f32_u32 v20, v20
v_mul_f32 v20, 0x3c800000, v20
v_sin_f32 v21, v20
v_cos_f32 v20, v20
v_add_u32 v10, v11, v10
v_cvt_pk_bf16_f32 v51, v20, v21
v_cvt_pk_bf16_f32 v55, -v21, v20
ds_write_b128 v12, v[48:51] offset:4096
ds_write_b128 v12, v[52:55] offset:5120
v_lshl_add_u32 v10, v9, 2, s52
v_add_u32 v10, 8, v10
v_add_u32 v11, 32, v8
v_mul_u32_u24 v10, v10, v11
v_and_b32 v20, 63, v10
v_cvt_f32_u32 v20, v20
v_mul_f32 v20, 0x3c800000, v20
v_sin_f32 v21, v20
v_cos_f32 v20, v20
v_add_u32 v10, v11, v10
v_cvt_pk_bf16_f32 v56, v20, v21
v_cvt_pk_bf16_f32 v60, -v21, v20
v_and_b32 v20, 63, v10
v_cvt_f32_u32 v20, v20
v_mul_f32 v20, 0x3c800000, v20
v_sin_f32 v21, v20
v_cos_f32 v20, v20
v_add_u32 v10, v11, v10
v_cvt_pk_bf16_f32 v57, v20, v21
v_cvt_pk_bf16_f32 v61, -v21, v20
v_and_b32 v20, 63, v10
v_cvt_f32_u32 v20, v20
v_mul_f32 v20, 0x3c800000, v20
v_sin_f32 v21, v20
v_cos_f32 v20, v20
v_add_u32 v10, v11, v10
v_cvt_pk_bf16_f32 v58, v20, v21
v_cvt_pk_bf16_f32 v62, -v21, v20
v_and_b32 v20, 63, v10
v_cvt_f32_u32 v20, v20
v_mul_f32 v20, 0x3c800000, v20
v_sin_f32 v21, v20
v_cos_f32 v20, v20
v_add_u32 v10, v11, v10
v_cvt_pk_bf16_f32 v59, v20, v21
v_cvt_pk_bf16_f32 v63, -v21, v20
ds_write_b128 v12, v[56:59] offset:6144
ds_write_b128 v12, v[60:63] offset:7168
s_lshl_b32 s52, s3, 11
v_add_u32 v12, s52, v0
s_lshl_b32 s52, s3, 3
v_lshl_add_u32 v10, v9, 2, s52
v_add_u32 v10, 0, v10
v_add_u32 v11, 0, v8
v_mul_u32_u24 v10, v10, v11
v_cvt_f32_u32 v20, v10
v_mul_f32 v20, 0x3a000000, v20
v_add_u32 v10, v11, v10
v_cos_f32 v64, v20
v_sin_f32 v68, v20
v_cvt_f32_u32 v20, v10
v_mul_f32 v20, 0x3a000000, v20
v_add_u32 v10, v11, v10
v_cos_f32 v65, v20
v_sin_f32 v69, v20
v_cvt_f32_u32 v20, v10
v_mul_f32 v20, 0x3a000000, v20
v_add_u32 v10, v11, v10
v_cos_f32 v66, v20
v_sin_f32 v70, v20
v_cvt_f32_u32 v20, v10
v_mul_f32 v20, 0x3a000000, v20
v_add_u32 v10, v11, v10
v_cos_f32 v67, v20
v_sin_f32 v71, v20
ds_write_b128 v12, v[64:67] offset:32768
ds_write_b128 v12, v[68:71] offset:33792
v_lshl_add_u32 v10, v9, 2, s52
v_add_u32 v10, 0, v10
v_add_u32 v11, 32, v8
v_mul_u32_u24 v10, v10, v11
v_cvt_f32_u32 v20, v10
v_mul_f32 v20, 0x3a000000, v20
v_add_u32 v10, v11, v10
v_cos_f32 v72, v20
v_sin_f32 v76, v20
v_cvt_f32_u32 v20, v10
v_mul_f32 v20, 0x3a000000, v20
v_add_u32 v10, v11, v10
v_cos_f32 v73, v20
v_sin_f32 v77, v20
v_cvt_f32_u32 v20, v10
v_mul_f32 v20, 0x3a000000, v20
v_add_u32 v10, v11, v10
v_cos_f32 v74, v20
v_sin_f32 v78, v20
v_cvt_f32_u32 v20, v10
v_mul_f32 v20, 0x3a000000, v20
v_add_u32 v10, v11, v10
v_cos_f32 v75, v20
v_sin_f32 v79, v20
ds_write_b128 v12, v[72:75] offset:40960
ds_write_b128 v12, v[76:79] offset:41984
v_lshl_add_u32 v10, v9, 2, s52
v_add_u32 v10, 32, v10
v_add_u32 v11, 0, v8
v_mul_u32_u24 v10, v10, v11
v_cvt_f32_u32 v20, v10
v_mul_f32 v20, 0x3a000000, v20
v_add_u32 v10, v11, v10
v_cos_f32 v80, v20
v_sin_f32 v84, v20
v_cvt_f32_u32 v20, v10
v_mul_f32 v20, 0x3a000000, v20
v_add_u32 v10, v11, v10
v_cos_f32 v81, v20
v_sin_f32 v85, v20
v_cvt_f32_u32 v20, v10
v_mul_f32 v20, 0x3a000000, v20
v_add_u32 v10, v11, v10
v_cos_f32 v82, v20
v_sin_f32 v86, v20
v_cvt_f32_u32 v20, v10
v_mul_f32 v20, 0x3a000000, v20
v_add_u32 v10, v11, v10
v_cos_f32 v83, v20
v_sin_f32 v87, v20
ds_write_b128 v12, v[80:83] offset:49152
ds_write_b128 v12, v[84:87] offset:50176
s_lshl_b32 s52, s3, 2
v_lshl_add_u32 v30, v8, 4, s52
v_lshl_add_u32 v30, v9, 11, v30
v_mul_u32_u24 v31, 2560, v9
v_lshl_add_u32 v31, v8, 2, v31
s_lshr_b32 s52, s3, 1
s_lshl_b32 s52, s52, 9
s_and_b32 s53, s3, 1
s_lshl_b32 s53, s53, 3
s_add_u32 s52, s52, s53
v_lshl_add_u32 v24, v8, 4, s52
v_lshl_add_u32 v24, v9, 2, v24
s_mov_b32 s52, 163840
v_mul_lo_u32 v25, v9, s52
v_lshl_add_u32 v25, v8, 4, v25
s_mul_i32 s44, s51, 3145728
s_lshl_b32 s52, s30, 15
s_add_u32 s44, s44, s52
s_add_u32 s44, s44, 205520896
s_mul_i32 s45, s51, 1048576
s_mul_i32 s52, s3, 5120
s_add_u32 s45, s45, s52
s_add_u32 s45, s45, 211812352
s_mul_i32 s48, s51, 3145728
s_lshl_b32 s52, s30, 9
s_add_u32 s48, s48, s52
s_mul_i32 s52, s3, 327680
s_add_u32 s48, s48, s52
s_add_u32 s48, s48, 198180864
s_mov_b32 s49, 0x3acccccd
v_mov_b32 v27, 0x3727c5ac
s_waitcnt vmcnt(0) lgkmcnt(0)
s_barrier
ds_read_b128 v[112:115], v0 offset:0
ds_read_b128 v[116:119], v0 offset:1024
ds_read_b128 v[120:123], v0 offset:2048
ds_read_b128 v[124:127], v0 offset:3072
k_pr_41:
buffer_load_dword v18, v30, s[4:7], s44 offen offset:1024 sc1
s_waitcnt vmcnt(0)
v_cmp_eq_u32 vcc, -1, v18
s_cbranch_vccz k_prd_42
s_sleep 8
s_sub_u32 s32, s32, 1
s_cmp_gt_i32 s32, 0
s_cbranch_scc1 k_pr_41
k_prd_42:
k_ps_43:
buffer_load_dword v96, v31, s[4:7], s45 offen offset:0 sc1
buffer_load_dword v97, v31, s[4:7], s45 offen offset:128 sc1
buffer_load_dword v98, v31, s[4:7], s45 offen offset:256 sc1
buffer_load_dword v99, v31, s[4:7], s45 offen offset:384 sc1
buffer_load_dword v100, v31, s[4:7], s45 offen offset:512 sc1
buffer_load_dword v101, v31, s[4:7], s45 offen offset:640 sc1
buffer_load_dword v102, v31, s[4:7], s45 offen offset:768 sc1
buffer_load_dword v103, v31, s[4:7], s45 offen offset:896 sc1
buffer_load_dword v104, v31, s[4:7], s45 offen offset:1024 sc1
buffer_load_dword v105, v31, s[4:7], s45 offen offset:1152 sc1
buffer_load_dword v106, v31, s[4:7], s45 offen offset:1280 sc1
buffer_load_dword v107, v31, s[4:7], s45 offen offset:1408 sc1
buffer_load_dword v108, v31, s[4:7], s45 offen offset:1536 sc1
buffer_load_dword v109, v31, s[4:7], s45 offen offset:1664 sc1
buffer_load_dword v110, v31, s[4:7], s45 offen offset:1792 sc1
buffer_load_dword v111, v31, s[4:7], s45 offen offset:1920 sc1
buffer_load_dword v20, v31, s[4:7], s45 offen offset:2048 sc1
buffer_load_dword v21, v31, s[4:7], s45 offen offset:2176 sc1
buffer_load_dword v22, v31, s[4:7], s45 offen offset:2304 sc1
buffer_load_dword v23, v31, s[4:7], s45 offen offset:2432 sc1
buffer_load_dword v16, v30, s[4:7], s44 offen offset:0 sc1
buffer_load_dword v17, v30, s[4:7], s44 offen offset:512 sc1
buffer_load_dword v19, v30, s[4:7], s44 offen offset:1536 sc1
s_waitcnt vmcnt(21)
v_add_f32 v96, v96, v97
s_waitcnt vmcnt(20)
v_add_f32 v96, v96, v98
s_waitcnt vmcnt(19)
v_add_f32 v96, v96, v99
s_waitcnt vmcnt(18)
v_add_f32 v96, v96, v100
s_waitcnt vmcnt(17)
v_add_f32 v96, v96, v101
s_waitcnt vmcnt(16)
v_add_f32 v96, v96, v102
s_waitcnt vmcnt(15)
v_add_f32 v96, v96, v103
s_waitcnt vmcnt(14)
v_add_f32 v96, v96, v104
s_waitcnt vmcnt(13)
v_add_f32 v96, v96, v105
s_waitcnt vmcnt(12)
v_add_f32 v96, v96, v106
s_waitcnt vmcnt(11)
v_add_f32 v96, v96, v107
s_waitcnt vmcnt(10)
v_add_f32 v96, v96, v108
s_waitcnt vmcnt(9)
v_add_f32 v96, v96, v109
s_waitcnt vmcnt(8)
v_add_f32 v96, v96, v110
s_waitcnt vmcnt(7)
v_add_f32 v96, v96, v111
s_waitcnt vmcnt(6)
v_add_f32 v96, v96, v20
s_waitcnt vmcnt(5)
v_add_f32 v96, v96, v21
s_waitcnt vmcnt(4)
v_add_f32 v96, v96, v22
s_waitcnt vmcnt(3)
v_add_f32 v96, v96, v23
v_cmp_u_f32 vcc, v96, v96
v_fma_f32 v96, v96, s49, v27
s_cbranch_vccz k_psd_44
s_sub_u32 s32, s32, 1
s_cmp_gt_i32 s32, 0
s_cbranch_scc1 k_ps_43
k_psd_44:
v_rsq_f32 v96, v96
s_add_u32 s45, s45, 20480
ds_write_b32 v24, v96 offset:57344
s_branch k_pyd_46
k_py_45:
buffer_load_dword v16, v30, s[4:7], s44 offen offset:0 sc1
buffer_load_dword v17, v30, s[4:7], s44 offen offset:512 sc1
buffer_load_dword v19, v30, s[4:7], s44 offen offset:1536 sc1
s_sub_u32 s32, s32, 1
k_pyd_46:
s_waitcnt vmcnt(0)
v_max3_u32 v20, v16, v17, v19
v_cmp_eq_u32 vcc, -1, v20
s_cmp_gt_i32 s32, 0
s_cselect_b64 vcc, vcc, 0
s_cbranch_vccnz k_py_45
s_add_u32 s44, s44, 4096
s_waitcnt lgkmcnt(0)
s_barrier
ds_read_b128 v[12:15], v0 offset:57344
v_lshlrev_b32 v144, 16, v16
v_and_b32 v128, 0xffff0000, v16
v_lshlrev_b32 v145, 16, v17
v_and_b32 v129, 0xffff0000, v17
v_lshlrev_b32 v146, 16, v18
v_and_b32 v130, 0xffff0000, v18
v_lshlrev_b32 v147, 16, v19
v_and_b32 v131, 0xffff0000, v19
s_waitcnt lgkmcnt(0)
v_mul_f32 v8, v12, v144
v_mul_f32 v12, v12, v128
v_cvt_pk_bf16_f32 v8, v8, v12
v_and_b32 v8, s47, v8
v_mul_f32 v9, v13, v145
v_mul_f32 v13, v13, v129
v_cvt_pk_bf16_f32 v9, v9, v13
v_and_b32 v9, s47, v9
v_mul_f32 v10, v14, v146
v_mul_f32 v14, v14, v130
v_cvt_pk_bf16_f32 v10, v10, v14
v_and_b32 v10, s47, v10
v_mul_f32 v11, v15, v147
v_mul_f32 v15, v15, v131
v_cvt_pk_bf16_f32 v11, v11, v15
v_and_b32 v11, s47, v11
s_nop 1
v_mfma_f32_32x32x16_bf16 v[32:47], v[8:11], v[112:115], 0
v_mfma_f32_32x32x16_bf16 v[48:63], v[8:11], v[116:119], 0
v_mfma_f32_32x32x16_bf16 v[64:79], v[8:11], v[120:123], 0
v_mfma_f32_32x32x16_bf16 v[80:95], v[8:11], v[124:127], 0
ds_read_b128 v[112:115], v0 offset:4096
ds_read_b128 v[116:119], v0 offset:5120
ds_read_b128 v[120:123], v0 offset:6144
ds_read_b128 v[124:127], v0 offset:7168
k_pr_47:
buffer_load_dword v18, v30, s[4:7], s44 offen offset:1024 sc1
s_waitcnt vmcnt(0)
v_cmp_eq_u32 vcc, -1, v18
s_cbranch_vccz k_prd_48
s_sleep 8
s_sub_u32 s32, s32, 1
s_cmp_gt_i32 s32, 0
s_cbranch_scc1 k_pr_47
k_prd_48:
k_ps_49:
buffer_load_dword v96, v31, s[4:7], s45 offen offset:0 sc1
buffer_load_dword v97, v31, s[4:7], s45 offen offset:128 sc1
buffer_load_dword v98, v31, s[4:7], s45 offen offset:256 sc1
buffer_load_dword v99, v31, s[4:7], s45 offen offset:384 sc1
buffer_load_dword v100, v31, s[4:7], s45 offen offset:512 sc1
buffer_load_dword v101, v31, s[4:7], s45 offen offset:640 sc1
buffer_load_dword v102, v31, s[4:7], s45 offen offset:768 sc1
buffer_load_dword v103, v31, s[4:7], s45 offen offset:896 sc1
buffer_load_dword v104, v31, s[4:7], s45 offen offset:1024 sc1
buffer_load_dword v105, v31, s[4:7], s45 offen offset:1152 sc1
buffer_load_dword v106, v31, s[4:7], s45 offen offset:1280 sc1
buffer_load_dword v107, v31, s[4:7], s45 offen offset:1408 sc1
buffer_load_dword v108, v31, s[4:7], s45 offen offset:1536 sc1
buffer_load_dword v109, v31, s[4:7], s45 offen offset:1664 sc1
buffer_load_dword v110, v31, s[4:7], s45 offen offset:1792 sc1
buffer_load_dword v111, v31, s[4:7], s45 offen offset:1920 sc1
buffer_load_dword v20, v31, s[4:7], s45 offen offset:2048 sc1
buffer_load_dword v21, v31, s[4:7], s45 offen offset:2176 sc1
buffer_load_dword v22, v31, s[4:7], s45 offen offset:2304 sc1
buffer_load_dword v23, v31, s[4:7], s45 offen offset:2432 sc1
buffer_load_dword v16, v30, s[4:7], s44 offen offset:0 sc1
buffer_load_dword v17, v30, s[4:7], s44 offen offset:512 sc1
buffer_load_dword v19, v30, s[4:7], s44 offen offset:1536 sc1
s_waitcnt vmcnt(21)
v_add_f32 v96, v96, v97
s_waitcnt vmcnt(20)
v_add_f32 v96, v96, v98
s_waitcnt vmcnt(19)
v_add_f32 v96, v96, v99
s_waitcnt vmcnt(18)
v_add_f32 v96, v96, v100
s_waitcnt vmcnt(17)
v_add_f32 v96, v96, v101
s_waitcnt vmcnt(16)
v_add_f32 v96, v96, v102
s_waitcnt vmcnt(15)
v_add_f32 v96, v96, v103
s_waitcnt vmcnt(14)
v_add_f32 v96, v96, v104
s_waitcnt vmcnt(13)
v_add_f32 v96, v96, v105
s_waitcnt vmcnt(12)
v_add_f32 v96, v96, v106
s_waitcnt vmcnt(11)
v_add_f32 v96, v96, v107
s_waitcnt vmcnt(10)
v_add_f32 v96, v96, v108
s_waitcnt vmcnt(9)
v_add_f32 v96, v96, v109
s_waitcnt vmcnt(8)
v_add_f32 v96, v96, v110
s_waitcnt vmcnt(7)
v_add_f32 v96, v96, v111
s_waitcnt vmcnt(6)
v_add_f32 v96, v96, v20
s_waitcnt vmcnt(5)
v_add_f32 v96, v96, v21
s_waitcnt vmcnt(4)
v_add_f32 v96, v96, v22
s_waitcnt vmcnt(3)
v_add_f32 v96, v96, v23
v_cmp_u_f32 vcc, v96, v96
v_fma_f32 v96, v96, s49, v27
s_cbranch_vccz k_psd_50
s_sub_u32 s32, s32, 1
s_cmp_gt_i32 s32, 0
s_cbranch_scc1 k_ps_49
k_psd_50:
v_rsq_f32 v96, v96
s_add_u32 s45, s45, 20480
ds_write_b32 v24, v96 offset:58368
s_branch k_pyd_52
k_py_51:
buffer_load_dword v16, v30, s[4:7], s44 offen offset:0 sc1
buffer_load_dword v17, v30, s[4:7], s44 offen offset:512 sc1
buffer_load_dword v19, v30, s[4:7], s44 offen offset:1536 sc1
s_sub_u32 s32, s32, 1
k_pyd_52:
s_waitcnt vmcnt(0)
v_max3_u32 v20, v16, v17, v19
v_cmp_eq_u32 vcc, -1, v20
s_cmp_gt_i32 s32, 0
s_cselect_b64 vcc, vcc, 0
s_cbranch_vccnz k_py_51
s_add_u32 s44, s44, 4096
s_waitcnt lgkmcnt(0)
s_barrier
ds_read_b128 v[12:15], v0 offset:58368
v_lshlrev_b32 v148, 16, v16
v_and_b32 v132, 0xffff0000, v16
v_lshlrev_b32 v149, 16, v17
v_and_b32 v133, 0xffff0000, v17
v_lshlrev_b32 v150, 16, v18
v_and_b32 v134, 0xffff0000, v18
v_lshlrev_b32 v151, 16, v19
v_and_b32 v135, 0xffff0000, v19
s_waitcnt lgkmcnt(0)
v_mul_f32 v8, v12, v148
v_mul_f32 v12, v12, v132
v_cvt_pk_bf16_f32 v8, v8, v12
v_and_b32 v8, s47, v8
v_mul_f32 v9, v13, v149
v_mul_f32 v13, v13, v133
v_cvt_pk_bf16_f32 v9, v9, v13
v_and_b32 v9, s47, v9
v_mul_f32 v10, v14, v150
v_mul_f32 v14, v14, v134
v_cvt_pk_bf16_f32 v10, v10, v14
v_and_b32 v10, s47, v10
v_mul_f32 v11, v15, v151
v_mul_f32 v15, v15, v135
v_cvt_pk_bf16_f32 v11, v11, v15
v_and_b32 v11, s47, v11
s_nop 1
v_mfma_f32_32x32x16_bf16 v[32:47], v[8:11], v[112:115], v[32:47]
v_mfma_f32_32x32x16_bf16 v[48:63], v[8:11], v[116:119], v[48:63]
v_mfma_f32_32x32x16_bf16 v[64:79], v[8:11], v[120:123], v[64:79]
v_mfma_f32_32x32x16_bf16 v[80:95], v[8:11], v[124:127], v[80:95]
ds_read_b128 v[112:115], v0 offset:8192
ds_read_b128 v[116:119], v0 offset:9216
ds_read_b128 v[120:123], v0 offset:10240
ds_read_b128 v[124:127], v0 offset:11264
k_pr_53:
buffer_load_dword v18, v30, s[4:7], s44 offen offset:1024 sc1
s_waitcnt vmcnt(0)
v_cmp_eq_u32 vcc, -1, v18
s_cbranch_vccz k_prd_54
s_sleep 8
s_sub_u32 s32, s32, 1
s_cmp_gt_i32 s32, 0
s_cbranch_scc1 k_pr_53
k_prd_54:
k_ps_55:
buffer_load_dword v96, v31, s[4:7], s45 offen offset:0 sc1
buffer_load_dword v97, v31, s[4:7], s45 offen offset:128 sc1
buffer_load_dword v98, v31, s[4:7], s45 offen offset:256 sc1
buffer_load_dword v99, v31, s[4:7], s45 offen offset:384 sc1
buffer_load_dword v100, v31, s[4:7], s45 offen offset:512 sc1
buffer_load_dword v101, v31, s[4:7], s45 offen offset:640 sc1
buffer_load_dword v102, v31, s[4:7], s45 offen offset:768 sc1
buffer_load_dword v103, v31, s[4:7], s45 offen offset:896 sc1
buffer_load_dword v104, v31, s[4:7], s45 offen offset:1024 sc1
buffer_load_dword v105, v31, s[4:7], s45 offen offset:1152 sc1
buffer_load_dword v106, v31, s[4:7], s45 offen offset:1280 sc1
buffer_load_dword v107, v31, s[4:7], s45 offen offset:1408 sc1
buffer_load_dword v108, v31, s[4:7], s45 offen offset:1536 sc1
buffer_load_dword v109, v31, s[4:7], s45 offen offset:1664 sc1
buffer_load_dword v110, v31, s[4:7], s45 offen offset:1792 sc1
buffer_load_dword v111, v31, s[4:7], s45 offen offset:1920 sc1
buffer_load_dword v20, v31, s[4:7], s45 offen offset:2048 sc1
buffer_load_dword v21, v31, s[4:7], s45 offen offset:2176 sc1
buffer_load_dword v22, v31, s[4:7], s45 offen offset:2304 sc1
buffer_load_dword v23, v31, s[4:7], s45 offen offset:2432 sc1
buffer_load_dword v16, v30, s[4:7], s44 offen offset:0 sc1
buffer_load_dword v17, v30, s[4:7], s44 offen offset:512 sc1
buffer_load_dword v19, v30, s[4:7], s44 offen offset:1536 sc1
s_waitcnt vmcnt(21)
v_add_f32 v96, v96, v97
s_waitcnt vmcnt(20)
v_add_f32 v96, v96, v98
s_waitcnt vmcnt(19)
v_add_f32 v96, v96, v99
s_waitcnt vmcnt(18)
v_add_f32 v96, v96, v100
s_waitcnt vmcnt(17)
v_add_f32 v96, v96, v101
s_waitcnt vmcnt(16)
v_add_f32 v96, v96, v102
s_waitcnt vmcnt(15)
v_add_f32 v96, v96, v103
s_waitcnt vmcnt(14)
v_add_f32 v96, v96, v104
s_waitcnt vmcnt(13)
v_add_f32 v96, v96, v105
s_waitcnt vmcnt(12)
v_add_f32 v96, v96, v106
s_waitcnt vmcnt(11)
v_add_f32 v96, v96, v107
s_waitcnt vmcnt(10)
v_add_f32 v96, v96, v108
s_waitcnt vmcnt(9)
v_add_f32 v96, v96, v109
s_waitcnt vmcnt(8)
v_add_f32 v96, v96, v110
s_waitcnt vmcnt(7)
v_add_f32 v96, v96, v111
s_waitcnt vmcnt(6)
v_add_f32 v96, v96, v20
s_waitcnt vmcnt(5)
v_add_f32 v96, v96, v21
s_waitcnt vmcnt(4)
v_add_f32 v96, v96, v22
s_waitcnt vmcnt(3)
v_add_f32 v96, v96, v23
v_cmp_u_f32 vcc, v96, v96
v_fma_f32 v96, v96, s49, v27
s_cbranch_vccz k_psd_56
s_sub_u32 s32, s32, 1
s_cmp_gt_i32 s32, 0
s_cbranch_scc1 k_ps_55
k_psd_56:
v_rsq_f32 v96, v96
s_add_u32 s45, s45, 20480
ds_write_b32 v24, v96 offset:57344
s_branch k_pyd_58
k_py_57:
buffer_load_dword v16, v30, s[4:7], s44 offen offset:0 sc1
buffer_load_dword v17, v30, s[4:7], s44 offen offset:512 sc1
buffer_load_dword v19, v30, s[4:7], s44 offen offset:1536 sc1
s_sub_u32 s32, s32, 1
k_pyd_58:
s_waitcnt vmcnt(0)
v_max3_u32 v20, v16, v17, v19
v_cmp_eq_u32 vcc, -1, v20
s_cmp_gt_i32 s32, 0
s_cselect_b64 vcc, vcc, 0
s_cbranch_vccnz k_py_57
s_add_u32 s44, s44, 4096
s_waitcnt lgkmcnt(0)
s_barrier
ds_read_b128 v[12:15], v0 offset:57344
v_lshlrev_b32 v152, 16, v16
v_and_b32 v136, 0xffff0000, v16
v_lshlrev_b32 v153, 16, v17
v_and_b32 v137, 0xffff0000, v17
v_lshlrev_b32 v154, 16, v18
v_and_b32 v138, 0xffff0000, v18
v_lshlrev_b32 v155, 16, v19
v_and_b32 v139, 0xffff0000, v19
s_waitcnt lgkmcnt(0)
v_mul_f32 v8, v12, v152
v_mul_f32 v12, v12, v136
v_cvt_pk_bf16_f32 v8, v8, v12
v_and_b32 v8, s47, v8
v_mul_f32 v9, v13, v153
v_mul_f32 v13, v13, v137
v_cvt_pk_bf16_f32 v9, v9, v13
v_and_b32 v9, s47, v9
v_mul_f32 v10, v14, v154
v_mul_f32 v14, v14, v138
v_cvt_pk_bf16_f32 v10, v10, v14
v_and_b32 v10, s47, v10
v_mul_f32 v11, v15, v155
v_mul_f32 v15, v15, v139
v_cvt_pk_bf16_f32 v11, v11, v15
v_and_b32 v11, s47, v11
s_nop 1
v_mfma_f32_32x32x16_bf16 v[32:47], v[8:11], v[112:115], v[32:47]
v_mfma_f32_32x32x16_bf16 v[48:63], v[8:11], v[116:119], v[48:63]
v_mfma_f32_32x32x16_bf16 v[64:79], v[8:11], v[120:123], v[64:79]
v_mfma_f32_32x32x16_bf16 v[80:95], v[8:11], v[124:127], v[80:95]
ds_read_b128 v[112:115], v0 offset:12288
ds_read_b128 v[116:119], v0 offset:13312
ds_read_b128 v[120:123], v0 offset:14336
ds_read_b128 v[124:127], v0 offset:15360
k_pr_59:
buffer_load_dword v18, v30, s[4:7], s44 offen offset:1024 sc1
s_waitcnt vmcnt(0)
v_cmp_eq_u32 vcc, -1, v18
s_cbranch_vccz k_prd_60
s_sleep 8
s_sub_u32 s32, s32, 1
s_cmp_gt_i32 s32, 0
s_cbranch_scc1 k_pr_59
k_prd_60:
k_ps_61:
buffer_load_dword v96, v31, s[4:7], s45 offen offset:0 sc1
buffer_load_dword v97, v31, s[4:7], s45 offen offset:128 sc1
buffer_load_dword v98, v31, s[4:7], s45 offen offset:256 sc1
buffer_load_dword v99, v31, s[4:7], s45 offen offset:384 sc1
buffer_load_dword v100, v31, s[4:7], s45 offen offset:512 sc1
buffer_load_dword v101, v31, s[4:7], s45 offen offset:640 sc1
buffer_load_dword v102, v31, s[4:7], s45 offen offset:768 sc1
buffer_load_dword v103, v31, s[4:7], s45 offen offset:896 sc1
buffer_load_dword v104, v31, s[4:7], s45 offen offset:1024 sc1
buffer_load_dword v105, v31, s[4:7], s45 offen offset:1152 sc1
buffer_load_dword v106, v31, s[4:7], s45 offen offset:1280 sc1
buffer_load_dword v107, v31, s[4:7], s45 offen offset:1408 sc1
buffer_load_dword v108, v31, s[4:7], s45 offen offset:1536 sc1
buffer_load_dword v109, v31, s[4:7], s45 offen offset:1664 sc1
buffer_load_dword v110, v31, s[4:7], s45 offen offset:1792 sc1
buffer_load_dword v111, v31, s[4:7], s45 offen offset:1920 sc1
buffer_load_dword v20, v31, s[4:7], s45 offen offset:2048 sc1
buffer_load_dword v21, v31, s[4:7], s45 offen offset:2176 sc1
buffer_load_dword v22, v31, s[4:7], s45 offen offset:2304 sc1
buffer_load_dword v23, v31, s[4:7], s45 offen offset:2432 sc1
buffer_load_dword v16, v30, s[4:7], s44 offen offset:0 sc1
buffer_load_dword v17, v30, s[4:7], s44 offen offset:512 sc1
buffer_load_dword v19, v30, s[4:7], s44 offen offset:1536 sc1
s_waitcnt vmcnt(21)
v_add_f32 v96, v96, v97
s_waitcnt vmcnt(20)
v_add_f32 v96, v96, v98
s_waitcnt vmcnt(19)
v_add_f32 v96, v96, v99
s_waitcnt vmcnt(18)
v_add_f32 v96, v96, v100
s_waitcnt vmcnt(17)
v_add_f32 v96, v96, v101
s_waitcnt vmcnt(16)
v_add_f32 v96, v96, v102
s_waitcnt vmcnt(15)
v_add_f32 v96, v96, v103
s_waitcnt vmcnt(14)
v_add_f32 v96, v96, v104
s_waitcnt vmcnt(13)
v_add_f32 v96, v96, v105
s_waitcnt vmcnt(12)
v_add_f32 v96, v96, v106
s_waitcnt vmcnt(11)
v_add_f32 v96, v96, v107
s_waitcnt vmcnt(10)
v_add_f32 v96, v96, v108
s_waitcnt vmcnt(9)
v_add_f32 v96, v96, v109
s_waitcnt vmcnt(8)
v_add_f32 v96, v96, v110
s_waitcnt vmcnt(7)
v_add_f32 v96, v96, v111
s_waitcnt vmcnt(6)
v_add_f32 v96, v96, v20
s_waitcnt vmcnt(5)
v_add_f32 v96, v96, v21
s_waitcnt vmcnt(4)
v_add_f32 v96, v96, v22
s_waitcnt vmcnt(3)
v_add_f32 v96, v96, v23
v_cmp_u_f32 vcc, v96, v96
v_fma_f32 v96, v96, s49, v27
s_cbranch_vccz k_psd_62
s_sub_u32 s32, s32, 1
s_cmp_gt_i32 s32, 0
s_cbranch_scc1 k_ps_61
k_psd_62:
v_rsq_f32 v96, v96
s_add_u32 s45, s45, 20480
ds_write_b32 v24, v96 offset:58368
s_branch k_pyd_64
k_py_63:
buffer_load_dword v16, v30, s[4:7], s44 offen offset:0 sc1
buffer_load_dword v17, v30, s[4:7], s44 offen offset:512 sc1
buffer_load_dword v19, v30, s[4:7], s44 offen offset:1536 sc1
s_sub_u32 s32, s32, 1
k_pyd_64:
s_waitcnt vmcnt(0)
v_max3_u32 v20, v16, v17, v19
v_cmp_eq_u32 vcc, -1, v20
s_cmp_gt_i32 s32, 0
s_cselect_b64 vcc, vcc, 0
s_cbranch_vccnz k_py_63
s_add_u32 s44, s44, 4096
s_waitcnt lgkmcnt(0)
s_barrier
ds_read_b128 v[12:15], v0 offset:58368
v_lshlrev_b32 v156, 16, v16
v_and_b32 v140, 0xffff0000, v16
v_lshlrev_b32 v157, 16, v17
v_and_b32 v141, 0xffff0000, v17
v_lshlrev_b32 v158, 16, v18
v_and_b32 v142, 0xffff0000, v18
v_lshlrev_b32 v159, 16, v19
v_and_b32 v143, 0xffff0000, v19
s_waitcnt lgkmcnt(0)
v_mul_f32 v8, v12, v156
v_mul_f32 v12, v12, v140
v_cvt_pk_bf16_f32 v8, v8, v12
v_and_b32 v8, s47, v8
v_mul_f32 v9, v13, v157
v_mul_f32 v13, v13, v141
v_cvt_pk_bf16_f32 v9, v9, v13
v_and_b32 v9, s47, v9
v_mul_f32 v10, v14, v158
v_mul_f32 v14, v14, v142
v_cvt_pk_bf16_f32 v10, v10, v14
v_and_b32 v10, s47, v10
v_mul_f32 v11, v15, v159
v_mul_f32 v15, v15, v143
v_cvt_pk_bf16_f32 v11, v11, v15
v_and_b32 v11, s47, v11
s_nop 1
v_mfma_f32_32x32x16_bf16 v[32:47], v[8:11], v[112:115], v[32:47]
v_mfma_f32_32x32x16_bf16 v[48:63], v[8:11], v[116:119], v[48:63]
v_mfma_f32_32x32x16_bf16 v[64:79], v[8:11], v[120:123], v[64:79]
v_mfma_f32_32x32x16_bf16 v[80:95], v[8:11], v[124:127], v[80:95]
ds_read_b128 v[112:115], v0 offset:16384
ds_read_b128 v[116:119], v0 offset:17408
ds_read_b128 v[120:123], v0 offset:18432
ds_read_b128 v[124:127], v0 offset:19456
k_pr_65:
buffer_load_dword v18, v30, s[4:7], s44 offen offset:1024 sc1
s_waitcnt vmcnt(0)
v_cmp_eq_u32 vcc, -1, v18
s_cbranch_vccz k_prd_66
s_sleep 8
s_sub_u32 s32, s32, 1
s_cmp_gt_i32 s32, 0
s_cbranch_scc1 k_pr_65
k_prd_66:
k_ps_67:
buffer_load_dword v96, v31, s[4:7], s45 offen offset:0 sc1
buffer_load_dword v97, v31, s[4:7], s45 offen offset:128 sc1
buffer_load_dword v98, v31, s[4:7], s45 offen offset:256 sc1
buffer_load_dword v99, v31, s[4:7], s45 offen offset:384 sc1
buffer_load_dword v100, v31, s[4:7], s45 offen offset:512 sc1
buffer_load_dword v101, v31, s[4:7], s45 offen offset:640 sc1
buffer_load_dword v102, v31, s[4:7], s45 offen offset:768 sc1
buffer_load_dword v103, v31, s[4:7], s45 offen offset:896 sc1
buffer_load_dword v104, v31, s[4:7], s45 offen offset:1024 sc1
buffer_load_dword v105, v31, s[4:7], s45 offen offset:1152 sc1
buffer_load_dword v106, v31, s[4:7], s45 offen offset:1280 sc1
buffer_load_dword v107, v31, s[4:7], s45 offen offset:1408 sc1
buffer_load_dword v108, v31, s[4:7], s45 offen offset:1536 sc1
buffer_load_dword v109, v31, s[4:7], s45 offen offset:1664 sc1
buffer_load_dword v110, v31, s[4:7], s45 offen offset:1792 sc1
buffer_load_dword v111, v31, s[4:7], s45 offen offset:1920 sc1
buffer_load_dword v20, v31, s[4:7], s45 offen offset:2048 sc1
buffer_load_dword v21, v31, s[4:7], s45 offen offset:2176 sc1
buffer_load_dword v22, v31, s[4:7], s45 offen offset:2304 sc1
buffer_load_dword v23, v31, s[4:7], s45 offen offset:2432 sc1
buffer_load_dword v16, v30, s[4:7], s44 offen offset:0 sc1
buffer_load_dword v17, v30, s[4:7], s44 offen offset:512 sc1
buffer_load_dword v19, v30, s[4:7], s44 offen offset:1536 sc1
s_waitcnt vmcnt(21)
v_add_f32 v96, v96, v97
s_waitcnt vmcnt(20)
v_add_f32 v96, v96, v98
s_waitcnt vmcnt(19)
v_add_f32 v96, v96, v99
s_waitcnt vmcnt(18)
v_add_f32 v96, v96, v100
s_waitcnt vmcnt(17)
v_add_f32 v96, v96, v101
s_waitcnt vmcnt(16)
v_add_f32 v96, v96, v102
s_waitcnt vmcnt(15)
v_add_f32 v96, v96, v103
s_waitcnt vmcnt(14)
v_add_f32 v96, v96, v104
s_waitcnt vmcnt(13)
v_add_f32 v96, v96, v105
s_waitcnt vmcnt(12)
v_add_f32 v96, v96, v106
s_waitcnt vmcnt(11)
v_add_f32 v96, v96, v107
s_waitcnt vmcnt(10)
v_add_f32 v96, v96, v108
s_waitcnt vmcnt(9)
v_add_f32 v96, v96, v109
s_waitcnt vmcnt(8)
v_add_f32 v96, v96, v110
s_waitcnt vmcnt(7)
v_add_f32 v96, v96, v111
s_waitcnt vmcnt(6)
v_add_f32 v96, v96, v20
s_waitcnt vmcnt(5)
v_add_f32 v96, v96, v21
s_waitcnt vmcnt(4)
v_add_f32 v96, v96, v22
s_waitcnt vmcnt(3)
v_add_f32 v96, v96, v23
v_cmp_u_f32 vcc, v96, v96
v_fma_f32 v96, v96, s49, v27
s_cbranch_vccz k_psd_68
s_sub_u32 s32, s32, 1
s_cmp_gt_i32 s32, 0
s_cbranch_scc1 k_ps_67
k_psd_68:
v_rsq_f32 v96, v96
s_add_u32 s45, s45, 20480
ds_write_b32 v24, v96 offset:57344
s_branch k_pyd_70
k_py_69:
buffer_load_dword v16, v30, s[4:7], s44 offen offset:0 sc1
buffer_load_dword v17, v30, s[4:7], s44 offen offset:512 sc1
buffer_load_dword v19, v30, s[4:7], s44 offen offset:1536 sc1
s_sub_u32 s32, s32, 1
k_pyd_70:
s_waitcnt vmcnt(0)
v_max3_u32 v20, v16, v17, v19
v_cmp_eq_u32 vcc, -1, v20
s_cmp_gt_i32 s32, 0
s_cselect_b64 vcc, vcc, 0
s_cbranch_vccnz k_py_69
s_add_u32 s44, s44, 4096
s_waitcnt lgkmcnt(0)
s_barrier
ds_read_b128 v[12:15], v0 offset:57344
v_lshlrev_b32 v176, 16, v16
v_and_b32 v160, 0xffff0000, v16
v_lshlrev_b32 v177, 16, v17
v_and_b32 v161, 0xffff0000, v17
v_lshlrev_b32 v178, 16, v18
v_and_b32 v162, 0xffff0000, v18
v_lshlrev_b32 v179, 16, v19
v_and_b32 v163, 0xffff0000, v19
s_waitcnt lgkmcnt(0)
v_mul_f32 v8, v12, v176
v_mul_f32 v12, v12, v160
v_cvt_pk_bf16_f32 v8, v8, v12
v_and_b32 v8, s47, v8
v_mul_f32 v9, v13, v177
v_mul_f32 v13, v13, v161
v_cvt_pk_bf16_f32 v9, v9, v13
v_and_b32 v9, s47, v9
v_mul_f32 v10, v14, v178
v_mul_f32 v14, v14, v162
v_cvt_pk_bf16_f32 v10, v10, v14
v_and_b32 v10, s47, v10
v_mul_f32 v11, v15, v179
v_mul_f32 v15, v15, v163
v_cvt_pk_bf16_f32 v11, v11, v15
v_and_b32 v11, s47, v11
s_nop 1
v_mfma_f32_32x32x16_bf16 v[32:47], v[8:11], v[112:115], v[32:47]
v_mfma_f32_32x32x16_bf16 v[48:63], v[8:11], v[116:119], v[48:63]
v_mfma_f32_32x32x16_bf16 v[64:79], v[8:11], v[120:123], v[64:79]
v_mfma_f32_32x32x16_bf16 v[80:95], v[8:11], v[124:127], v[80:95]
ds_read_b128 v[112:115], v0 offset:20480
ds_read_b128 v[116:119], v0 offset:21504
ds_read_b128 v[120:123], v0 offset:22528
ds_read_b128 v[124:127], v0 offset:23552
k_pr_71:
buffer_load_dword v18, v30, s[4:7], s44 offen offset:1024 sc1
s_waitcnt vmcnt(0)
v_cmp_eq_u32 vcc, -1, v18
s_cbranch_vccz k_prd_72
s_sleep 8
s_sub_u32 s32, s32, 1
s_cmp_gt_i32 s32, 0
s_cbranch_scc1 k_pr_71
k_prd_72:
k_ps_73:
buffer_load_dword v96, v31, s[4:7], s45 offen offset:0 sc1
buffer_load_dword v97, v31, s[4:7], s45 offen offset:128 sc1
buffer_load_dword v98, v31, s[4:7], s45 offen offset:256 sc1
buffer_load_dword v99, v31, s[4:7], s45 offen offset:384 sc1
buffer_load_dword v100, v31, s[4:7], s45 offen offset:512 sc1
buffer_load_dword v101, v31, s[4:7], s45 offen offset:640 sc1
buffer_load_dword v102, v31, s[4:7], s45 offen offset:768 sc1
buffer_load_dword v103, v31, s[4:7], s45 offen offset:896 sc1
buffer_load_dword v104, v31, s[4:7], s45 offen offset:1024 sc1
buffer_load_dword v105, v31, s[4:7], s45 offen offset:1152 sc1
buffer_load_dword v106, v31, s[4:7], s45 offen offset:1280 sc1
buffer_load_dword v107, v31, s[4:7], s45 offen offset:1408 sc1
buffer_load_dword v108, v31, s[4:7], s45 offen offset:1536 sc1
buffer_load_dword v109, v31, s[4:7], s45 offen offset:1664 sc1
buffer_load_dword v110, v31, s[4:7], s45 offen offset:1792 sc1
buffer_load_dword v111, v31, s[4:7], s45 offen offset:1920 sc1
buffer_load_dword v20, v31, s[4:7], s45 offen offset:2048 sc1
buffer_load_dword v21, v31, s[4:7], s45 offen offset:2176 sc1
buffer_load_dword v22, v31, s[4:7], s45 offen offset:2304 sc1
buffer_load_dword v23, v31, s[4:7], s45 offen offset:2432 sc1
buffer_load_dword v16, v30, s[4:7], s44 offen offset:0 sc1
buffer_load_dword v17, v30, s[4:7], s44 offen offset:512 sc1
buffer_load_dword v19, v30, s[4:7], s44 offen offset:1536 sc1
s_waitcnt vmcnt(21)
v_add_f32 v96, v96, v97
s_waitcnt vmcnt(20)
v_add_f32 v96, v96, v98
s_waitcnt vmcnt(19)
v_add_f32 v96, v96, v99
s_waitcnt vmcnt(18)
v_add_f32 v96, v96, v100
s_waitcnt vmcnt(17)
v_add_f32 v96, v96, v101
s_waitcnt vmcnt(16)
v_add_f32 v96, v96, v102
s_waitcnt vmcnt(15)
v_add_f32 v96, v96, v103
s_waitcnt vmcnt(14)
v_add_f32 v96, v96, v104
s_waitcnt vmcnt(13)
v_add_f32 v96, v96, v105
s_waitcnt vmcnt(12)
v_add_f32 v96, v96, v106
s_waitcnt vmcnt(11)
v_add_f32 v96, v96, v107
s_waitcnt vmcnt(10)
v_add_f32 v96, v96, v108
s_waitcnt vmcnt(9)
v_add_f32 v96, v96, v109
s_waitcnt vmcnt(8)
v_add_f32 v96, v96, v110
s_waitcnt vmcnt(7)
v_add_f32 v96, v96, v111
s_waitcnt vmcnt(6)
v_add_f32 v96, v96, v20
s_waitcnt vmcnt(5)
v_add_f32 v96, v96, v21
s_waitcnt vmcnt(4)
v_add_f32 v96, v96, v22
s_waitcnt vmcnt(3)
v_add_f32 v96, v96, v23
v_cmp_u_f32 vcc, v96, v96
v_fma_f32 v96, v96, s49, v27
s_cbranch_vccz k_psd_74
s_sub_u32 s32, s32, 1
s_cmp_gt_i32 s32, 0
s_cbranch_scc1 k_ps_73
k_psd_74:
v_rsq_f32 v96, v96
s_add_u32 s45, s45, 20480
ds_write_b32 v24, v96 offset:58368
s_branch k_pyd_76
k_py_75:
buffer_load_dword v16, v30, s[4:7], s44 offen offset:0 sc1
buffer_load_dword v17, v30, s[4:7], s44 offen offset:512 sc1
buffer_load_dword v19, v30, s[4:7], s44 offen offset:1536 sc1
s_sub_u32 s32, s32, 1
k_pyd_76:
s_waitcnt vmcnt(0)
v_max3_u32 v20, v16, v17, v19
v_cmp_eq_u32 vcc, -1, v20
s_cmp_gt_i32 s32, 0
s_cselect_b64 vcc, vcc, 0
s_cbranch_vccnz k_py_75
s_add_u32 s44, s44, 4096
s_waitcnt lgkmcnt(0)
s_barrier
ds_read_b128 v[12:15], v0 offset:58368
v_lshlrev_b32 v180, 16, v16
v_and_b32 v164, 0xffff0000, v16
v_lshlrev_b32 v181, 16, v17
v_and_b32 v165, 0xffff0000, v17
v_lshlrev_b32 v182, 16, v18
v_and_b32 v166, 0xffff0000, v18
v_lshlrev_b32 v183, 16, v19
v_and_b32 v167, 0xffff0000, v19
s_waitcnt lgkmcnt(0)
v_mul_f32 v8, v12, v180
v_mul_f32 v12, v12, v164
v_cvt_pk_bf16_f32 v8, v8, v12
v_and_b32 v8, s47, v8
v_mul_f32 v9, v13, v181
v_mul_f32 v13, v13, v165
v_cvt_pk_bf16_f32 v9, v9, v13
v_and_b32 v9, s47, v9
v_mul_f32 v10, v14, v182
v_mul_f32 v14, v14, v166
v_cvt_pk_bf16_f32 v10, v10, v14
v_and_b32 v10, s47, v10
v_mul_f32 v11, v15, v183
v_mul_f32 v15, v15, v167
v_cvt_pk_bf16_f32 v11, v11, v15
v_and_b32 v11, s47, v11
s_nop 1
v_mfma_f32_32x32x16_bf16 v[32:47], v[8:11], v[112:115], v[32:47]
v_mfma_f32_32x32x16_bf16 v[48:63], v[8:11], v[116:119], v[48:63]
v_mfma_f32_32x32x16_bf16 v[64:79], v[8:11], v[120:123], v[64:79]
v_mfma_f32_32x32x16_bf16 v[80:95], v[8:11], v[124:127], v[80:95]
ds_read_b128 v[112:115], v0 offset:24576
ds_read_b128 v[116:119], v0 offset:25600
ds_read_b128 v[120:123], v0 offset:26624
ds_read_b128 v[124:127], v0 offset:27648
k_pr_77:
buffer_load_dword v18, v30, s[4:7], s44 offen offset:1024 sc1
s_waitcnt vmcnt(0)
v_cmp_eq_u32 vcc, -1, v18
s_cbranch_vccz k_prd_78
s_sleep 8
s_sub_u32 s32, s32, 1
s_cmp_gt_i32 s32, 0
s_cbranch_scc1 k_pr_77
k_prd_78:
k_ps_79:
buffer_load_dword v96, v31, s[4:7], s45 offen offset:0 sc1
buffer_load_dword v97, v31, s[4:7], s45 offen offset:128 sc1
buffer_load_dword v98, v31, s[4:7], s45 offen offset:256 sc1
buffer_load_dword v99, v31, s[4:7], s45 offen offset:384 sc1
buffer_load_dword v100, v31, s[4:7], s45 offen offset:512 sc1
buffer_load_dword v101, v31, s[4:7], s45 offen offset:640 sc1
buffer_load_dword v102, v31, s[4:7], s45 offen offset:768 sc1
buffer_load_dword v103, v31, s[4:7], s45 offen offset:896 sc1
buffer_load_dword v104, v31, s[4:7], s45 offen offset:1024 sc1
buffer_load_dword v105, v31, s[4:7], s45 offen offset:1152 sc1
buffer_load_dword v106, v31, s[4:7], s45 offen offset:1280 sc1
buffer_load_dword v107, v31, s[4:7], s45 offen offset:1408 sc1
buffer_load_dword v108, v31, s[4:7], s45 offen offset:1536 sc1
buffer_load_dword v109, v31, s[4:7], s45 offen offset:1664 sc1
buffer_load_dword v110, v31, s[4:7], s45 offen offset:1792 sc1
buffer_load_dword v111, v31, s[4:7], s45 offen offset:1920 sc1
buffer_load_dword v20, v31, s[4:7], s45 offen offset:2048 sc1
buffer_load_dword v21, v31, s[4:7], s45 offen offset:2176 sc1
buffer_load_dword v22, v31, s[4:7], s45 offen offset:2304 sc1
buffer_load_dword v23, v31, s[4:7], s45 offen offset:2432 sc1
buffer_load_dword v16, v30, s[4:7], s44 offen offset:0 sc1
buffer_load_dword v17, v30, s[4:7], s44 offen offset:512 sc1
buffer_load_dword v19, v30, s[4:7], s44 offen offset:1536 sc1
s_waitcnt vmcnt(21)
v_add_f32 v96, v96, v97
s_waitcnt vmcnt(20)
v_add_f32 v96, v96, v98
s_waitcnt vmcnt(19)
v_add_f32 v96, v96, v99
s_waitcnt vmcnt(18)
v_add_f32 v96, v96, v100
s_waitcnt vmcnt(17)
v_add_f32 v96, v96, v101
s_waitcnt vmcnt(16)
v_add_f32 v96, v96, v102
s_waitcnt vmcnt(15)
v_add_f32 v96, v96, v103
s_waitcnt vmcnt(14)
v_add_f32 v96, v96, v104
s_waitcnt vmcnt(13)
v_add_f32 v96, v96, v105
s_waitcnt vmcnt(12)
v_add_f32 v96, v96, v106
s_waitcnt vmcnt(11)
v_add_f32 v96, v96, v107
s_waitcnt vmcnt(10)
v_add_f32 v96, v96, v108
s_waitcnt vmcnt(9)
v_add_f32 v96, v96, v109
s_waitcnt vmcnt(8)
v_add_f32 v96, v96, v110
s_waitcnt vmcnt(7)
v_add_f32 v96, v96, v111
s_waitcnt vmcnt(6)
v_add_f32 v96, v96, v20
s_waitcnt vmcnt(5)
v_add_f32 v96, v96, v21
s_waitcnt vmcnt(4)
v_add_f32 v96, v96, v22
s_waitcnt vmcnt(3)
v_add_f32 v96, v96, v23
v_cmp_u_f32 vcc, v96, v96
v_fma_f32 v96, v96, s49, v27
s_cbranch_vccz k_psd_80
s_sub_u32 s32, s32, 1
s_cmp_gt_i32 s32, 0
s_cbranch_scc1 k_ps_79
k_psd_80:
v_rsq_f32 v96, v96
s_add_u32 s45, s45, 20480
ds_write_b32 v24, v96 offset:57344
s_branch k_pyd_82
k_py_81:
buffer_load_dword v16, v30, s[4:7], s44 offen offset:0 sc1
buffer_load_dword v17, v30, s[4:7], s44 offen offset:512 sc1
buffer_load_dword v19, v30, s[4:7], s44 offen offset:1536 sc1
s_sub_u32 s32, s32, 1
k_pyd_82:
s_waitcnt vmcnt(0)
v_max3_u32 v20, v16, v17, v19
v_cmp_eq_u32 vcc, -1, v20
s_cmp_gt_i32 s32, 0
s_cselect_b64 vcc, vcc, 0
s_cbranch_vccnz k_py_81
s_add_u32 s44, s44, 4096
s_waitcnt lgkmcnt(0)
s_barrier
ds_read_b128 v[12:15], v0 offset:57344
v_lshlrev_b32 v184, 16, v16
v_and_b32 v168, 0xffff0000, v16
v_lshlrev_b32 v185, 16, v17
v_and_b32 v169, 0xffff0000, v17
v_lshlrev_b32 v186, 16, v18
v_and_b32 v170, 0xffff0000, v18
v_lshlrev_b32 v187, 16, v19
v_and_b32 v171, 0xffff0000, v19
s_waitcnt lgkmcnt(0)
v_mul_f32 v8, v12, v184
v_mul_f32 v12, v12, v168
v_cvt_pk_bf16_f32 v8, v8, v12
v_and_b32 v8, s47, v8
v_mul_f32 v9, v13, v185
v_mul_f32 v13, v13, v169
v_cvt_pk_bf16_f32 v9, v9, v13
v_and_b32 v9, s47, v9
v_mul_f32 v10, v14, v186
v_mul_f32 v14, v14, v170
v_cvt_pk_bf16_f32 v10, v10, v14
v_and_b32 v10, s47, v10
v_mul_f32 v11, v15, v187
v_mul_f32 v15, v15, v171
v_cvt_pk_bf16_f32 v11, v11, v15
v_and_b32 v11, s47, v11
s_nop 1
v_mfma_f32_32x32x16_bf16 v[32:47], v[8:11], v[112:115], v[32:47]
v_mfma_f32_32x32x16_bf16 v[48:63], v[8:11], v[116:119], v[48:63]
v_mfma_f32_32x32x16_bf16 v[64:79], v[8:11], v[120:123], v[64:79]
v_mfma_f32_32x32x16_bf16 v[80:95], v[8:11], v[124:127], v[80:95]
ds_read_b128 v[112:115], v0 offset:28672
ds_read_b128 v[116:119], v0 offset:29696
ds_read_b128 v[120:123], v0 offset:30720
ds_read_b128 v[124:127], v0 offset:31744
k_pr_83:
buffer_load_dword v18, v30, s[4:7], s44 offen offset:1024 sc1
s_waitcnt vmcnt(0)
v_cmp_eq_u32 vcc, -1, v18
s_cbranch_vccz k_prd_84
s_sleep 8
s_sub_u32 s32, s32, 1
s_cmp_gt_i32 s32, 0
s_cbranch_scc1 k_pr_83
k_prd_84:
k_ps_85:
buffer_load_dword v96, v31, s[4:7], s45 offen offset:0 sc1
buffer_load_dword v97, v31, s[4:7], s45 offen offset:128 sc1
buffer_load_dword v98, v31, s[4:7], s45 offen offset:256 sc1
buffer_load_dword v99, v31, s[4:7], s45 offen offset:384 sc1
buffer_load_dword v100, v31, s[4:7], s45 offen offset:512 sc1
buffer_load_dword v101, v31, s[4:7], s45 offen offset:640 sc1
buffer_load_dword v102, v31, s[4:7], s45 offen offset:768 sc1
buffer_load_dword v103, v31, s[4:7], s45 offen offset:896 sc1
buffer_load_dword v104, v31, s[4:7], s45 offen offset:1024 sc1
buffer_load_dword v105, v31, s[4:7], s45 offen offset:1152 sc1
buffer_load_dword v106, v31, s[4:7], s45 offen offset:1280 sc1
buffer_load_dword v107, v31, s[4:7], s45 offen offset:1408 sc1
buffer_load_dword v108, v31, s[4:7], s45 offen offset:1536 sc1
buffer_load_dword v109, v31, s[4:7], s45 offen offset:1664 sc1
buffer_load_dword v110, v31, s[4:7], s45 offen offset:1792 sc1
buffer_load_dword v111, v31, s[4:7], s45 offen offset:1920 sc1
buffer_load_dword v20, v31, s[4:7], s45 offen offset:2048 sc1
buffer_load_dword v21, v31, s[4:7], s45 offen offset:2176 sc1
buffer_load_dword v22, v31, s[4:7], s45 offen offset:2304 sc1
buffer_load_dword v23, v31, s[4:7], s45 offen offset:2432 sc1
buffer_load_dword v16, v30, s[4:7], s44 offen offset:0 sc1
buffer_load_dword v17, v30, s[4:7], s44 offen offset:512 sc1
buffer_load_dword v19, v30, s[4:7], s44 offen offset:1536 sc1
s_waitcnt vmcnt(21)
v_add_f32 v96, v96, v97
s_waitcnt vmcnt(20)
v_add_f32 v96, v96, v98
s_waitcnt vmcnt(19)
v_add_f32 v96, v96, v99
s_waitcnt vmcnt(18)
v_add_f32 v96, v96, v100
s_waitcnt vmcnt(17)
v_add_f32 v96, v96, v101
s_waitcnt vmcnt(16)
v_add_f32 v96, v96, v102
s_waitcnt vmcnt(15)
v_add_f32 v96, v96, v103
s_waitcnt vmcnt(14)
v_add_f32 v96, v96, v104
s_waitcnt vmcnt(13)
v_add_f32 v96, v96, v105
s_waitcnt vmcnt(12)
v_add_f32 v96, v96, v106
s_waitcnt vmcnt(11)
v_add_f32 v96, v96, v107
s_waitcnt vmcnt(10)
v_add_f32 v96, v96, v108
s_waitcnt vmcnt(9)
v_add_f32 v96, v96, v109
s_waitcnt vmcnt(8)
v_add_f32 v96, v96, v110
s_waitcnt vmcnt(7)
v_add_f32 v96, v96, v111
s_waitcnt vmcnt(6)
v_add_f32 v96, v96, v20
s_waitcnt vmcnt(5)
v_add_f32 v96, v96, v21
s_waitcnt vmcnt(4)
v_add_f32 v96, v96, v22
s_waitcnt vmcnt(3)
v_add_f32 v96, v96, v23
v_cmp_u_f32 vcc, v96, v96
v_fma_f32 v96, v96, s49, v27
s_cbranch_vccz k_psd_86
s_sub_u32 s32, s32, 1
s_cmp_gt_i32 s32, 0
s_cbranch_scc1 k_ps_85
k_psd_86:
v_rsq_f32 v96, v96
s_add_u32 s45, s45, 20480
ds_write_b32 v24, v96 offset:58368
s_branch k_pyd_88
k_py_87:
buffer_load_dword v16, v30, s[4:7], s44 offen offset:0 sc1
buffer_load_dword v17, v30, s[4:7], s44 offen offset:512 sc1
buffer_load_dword v19, v30, s[4:7], s44 offen offset:1536 sc1
s_sub_u32 s32, s32, 1
k_pyd_88:
s_waitcnt vmcnt(0)
v_max3_u32 v20, v16, v17, v19
v_cmp_eq_u32 vcc, -1, v20
s_cmp_gt_i32 s32, 0
s_cselect_b64 vcc, vcc, 0
s_cbranch_vccnz k_py_87
s_add_u32 s44, s44, 4096
s_waitcnt lgkmcnt(0)
s_barrier
ds_read_b128 v[12:15], v0 offset:58368
v_lshlrev_b32 v188, 16, v16
v_and_b32 v172, 0xffff0000, v16
v_lshlrev_b32 v189, 16, v17
v_and_b32 v173, 0xffff0000, v17
v_lshlrev_b32 v190, 16, v18
v_and_b32 v174, 0xffff0000, v18
v_lshlrev_b32 v191, 16, v19
v_and_b32 v175, 0xffff0000, v19
s_waitcnt lgkmcnt(0)
v_mul_f32 v8, v12, v188
v_mul_f32 v12, v12, v172
v_cvt_pk_bf16_f32 v8, v8, v12
v_and_b32 v8, s47, v8
v_mul_f32 v9, v13, v189
v_mul_f32 v13, v13, v173
v_cvt_pk_bf16_f32 v9, v9, v13
v_and_b32 v9, s47, v9
v_mul_f32 v10, v14, v190
v_mul_f32 v14, v14, v174
v_cvt_pk_bf16_f32 v10, v10, v14
v_and_b32 v10, s47, v10
v_mul_f32 v11, v15, v191
v_mul_f32 v15, v15, v175
v_cvt_pk_bf16_f32 v11, v11, v15
v_and_b32 v11, s47, v11
s_nop 1
v_mfma_f32_32x32x16_bf16 v[32:47], v[8:11], v[112:115], v[32:47]
v_mfma_f32_32x32x16_bf16 v[48:63], v[8:11], v[116:119], v[48:63]
v_mfma_f32_32x32x16_bf16 v[64:79], v[8:11], v[120:123], v[64:79]
v_mfma_f32_32x32x16_bf16 v[80:95], v[8:11], v[124:127], v[80:95]
ds_read_b128 v[112:115], v0 offset:32768
ds_read_b128 v[116:119], v0 offset:33792
ds_read_b128 v[120:123], v0 offset:34816
ds_read_b128 v[124:127], v0 offset:35840
s_waitcnt lgkmcnt(3)
v_mul_f32 v8, v32, v112
v_mul_f32 v9, v48, v112
s_waitcnt lgkmcnt(2)
v_fmac_f32 v8, v48, v116
v_fma_f32 v9, -v32, v116, v9
v_cvt_pk_bf16_f32 v32, v8, v9
v_mul_f32 v10, v33, v113
v_mul_f32 v11, v49, v113
v_fmac_f32 v10, v49, v117
v_fma_f32 v11, -v33, v117, v11
v_cvt_pk_bf16_f32 v33, v10, v11
v_mul_f32 v8, v34, v114
v_mul_f32 v9, v50, v114
v_fmac_f32 v8, v50, v118
v_fma_f32 v9, -v34, v118, v9
v_cvt_pk_bf16_f32 v34, v8, v9
v_mul_f32 v10, v35, v115
v_mul_f32 v11, v51, v115
v_fmac_f32 v10, v51, v119
v_fma_f32 v11, -v35, v119, v11
v_cvt_pk_bf16_f32 v35, v10, v11
ds_read_b128 v[112:115], v0 offset:36864
ds_read_b128 v[116:119], v0 offset:37888
s_waitcnt lgkmcnt(3)
v_mul_f32 v8, v36, v120
v_mul_f32 v9, v52, v120
s_waitcnt lgkmcnt(2)
v_fmac_f32 v8, v52, v124
v_fma_f32 v9, -v36, v124, v9
v_cvt_pk_bf16_f32 v36, v8, v9
v_mul_f32 v10, v37, v121
v_mul_f32 v11, v53, v121
v_fmac_f32 v10, v53, v125
v_fma_f32 v11, -v37, v125, v11
v_cvt_pk_bf16_f32 v37, v10, v11
v_mul_f32 v8, v38, v122
v_mul_f32 v9, v54, v122
v_fmac_f32 v8, v54, v126
v_fma_f32 v9, -v38, v126, v9
v_cvt_pk_bf16_f32 v38, v8, v9
v_mul_f32 v10, v39, v123
v_mul_f32 v11, v55, v123
v_fmac_f32 v10, v55, v127
v_fma_f32 v11, -v39, v127, v11
v_cvt_pk_bf16_f32 v39, v10, v11
ds_read_b128 v[120:123], v0 offset:38912
ds_read_b128 v[124:127], v0 offset:39936
s_waitcnt lgkmcnt(3)
v_mul_f32 v8, v40, v112
v_mul_f32 v9, v56, v112
s_waitcnt lgkmcnt(2)
v_fmac_f32 v8, v56, v116
v_fma_f32 v9, -v40, v116, v9
v_cvt_pk_bf16_f32 v40, v8, v9
v_mul_f32 v10, v41, v113
v_mul_f32 v11, v57, v113
v_fmac_f32 v10, v57, v117
v_fma_f32 v11, -v41, v117, v11
v_cvt_pk_bf16_f32 v41, v10, v11
v_mul_f32 v8, v42, v114
v_mul_f32 v9, v58, v114
v_fmac_f32 v8, v58, v118
v_fma_f32 v9, -v42, v118, v9
v_cvt_pk_bf16_f32 v42, v8, v9
v_mul_f32 v10, v43, v115
v_mul_f32 v11, v59, v115
v_fmac_f32 v10, v59, v119
v_fma_f32 v11, -v43, v119, v11
v_cvt_pk_bf16_f32 v43, v10, v11
ds_read_b128 v[112:115], v0 offset:40960
ds_read_b128 v[116:119], v0 offset:41984
s_waitcnt lgkmcnt(3)
v_mul_f32 v8, v44, v120
v_mul_f32 v9, v60, v120
s_waitcnt lgkmcnt(2)
v_fmac_f32 v8, v60, v124
v_fma_f32 v9, -v44, v124, v9
v_cvt_pk_bf16_f32 v44, v8, v9
v_mul_f32 v10, v45, v121
v_mul_f32 v11, v61, v121
v_fmac_f32 v10, v61, v125
v_fma_f32 v11, -v45, v125, v11
v_cvt_pk_bf16_f32 v45, v10, v11
v_mul_f32 v8, v46, v122
v_mul_f32 v9, v62, v122
v_fmac_f32 v8, v62, v126
v_fma_f32 v9, -v46, v126, v9
v_cvt_pk_bf16_f32 v46, v8, v9
v_mul_f32 v10, v47, v123
v_mul_f32 v11, v63, v123
v_fmac_f32 v10, v63, v127
v_fma_f32 v11, -v47, v127, v11
v_cvt_pk_bf16_f32 v47, v10, v11
ds_read_b128 v[120:123], v0 offset:43008
ds_read_b128 v[124:127], v0 offset:44032
v_mfma_f32_32x32x16_bf16 v[48:63], a[160:163], v[32:35], 0
s_waitcnt lgkmcnt(3)
v_mul_f32 v8, v64, v112
v_mul_f32 v9, v80, v112
s_waitcnt lgkmcnt(2)
v_fmac_f32 v8, v80, v116
v_fma_f32 v9, -v64, v116, v9
v_cvt_pk_bf16_f32 v64, v8, v9
v_mul_f32 v10, v65, v113
v_mul_f32 v11, v81, v113
v_fmac_f32 v10, v81, v117
v_mfma_f32_32x32x16_bf16 v[96:111], a[164:167], v[32:35], 0
v_fma_f32 v11, -v65, v117, v11
v_cvt_pk_bf16_f32 v65, v10, v11
v_mul_f32 v8, v66, v114
v_mul_f32 v9, v82, v114
v_fmac_f32 v8, v82, v118
v_fma_f32 v9, -v66, v118, v9
v_cvt_pk_bf16_f32 v66, v8, v9
v_mul_f32 v10, v67, v115
v_mfma_f32_32x32x16_bf16 v[48:63], a[168:171], v[36:39], v[48:63]
v_mul_f32 v11, v83, v115
v_fmac_f32 v10, v83, v119
v_fma_f32 v11, -v67, v119, v11
v_cvt_pk_bf16_f32 v67, v10, v11
ds_read_b128 v[112:115], v0 offset:45056
ds_read_b128 v[116:119], v0 offset:46080
s_waitcnt lgkmcnt(3)
v_mul_f32 v8, v68, v120
v_mul_f32 v9, v84, v120
v_mfma_f32_32x32x16_bf16 v[96:111], a[172:175], v[36:39], v[96:111]
s_waitcnt lgkmcnt(2)
v_fmac_f32 v8, v84, v124
v_fma_f32 v9, -v68, v124, v9
v_cvt_pk_bf16_f32 v68, v8, v9
v_mul_f32 v10, v69, v121
v_mul_f32 v11, v85, v121
v_fmac_f32 v10, v85, v125
v_fma_f32 v11, -v69, v125, v11
v_cvt_pk_bf16_f32 v69, v10, v11
v_mfma_f32_32x32x16_bf16 v[48:63], a[176:179], v[40:43], v[48:63]
v_mul_f32 v8, v70, v122
v_mul_f32 v9, v86, v122
v_fmac_f32 v8, v86, v126
v_fma_f32 v9, -v70, v126, v9
v_cvt_pk_bf16_f32 v70, v8, v9
v_mul_f32 v10, v71, v123
v_mul_f32 v11, v87, v123
v_fmac_f32 v10, v87, v127
v_mfma_f32_32x32x16_bf16 v[96:111], a[180:183], v[40:43], v[96:111]
v_fma_f32 v11, -v71, v127, v11
v_cvt_pk_bf16_f32 v71, v10, v11
ds_read_b128 v[120:123], v0 offset:47104
ds_read_b128 v[124:127], v0 offset:48128
s_waitcnt lgkmcnt(3)
v_mul_f32 v8, v72, v112
v_mul_f32 v9, v88, v112
s_waitcnt lgkmcnt(2)
v_fmac_f32 v8, v88, v116
v_fma_f32 v9, -v72, v116, v9
v_mfma_f32_32x32x16_bf16 v[48:63], a[184:187], v[44:47], v[48:63]
v_cvt_pk_bf16_f32 v72, v8, v9
v_mul_f32 v10, v73, v113
v_mul_f32 v11, v89, v113
v_fmac_f32 v10, v89, v117
v_fma_f32 v11, -v73, v117, v11
v_cvt_pk_bf16_f32 v73, v10, v11
v_mul_f32 v8, v74, v114
v_mul_f32 v9, v90, v114
v_mfma_f32_32x32x16_bf16 v[96:111], a[188:191], v[44:47], v[96:111]
v_fmac_f32 v8, v90, v118
v_fma_f32 v9, -v74, v118, v9
v_cvt_pk_bf16_f32 v74, v8, v9
v_mul_f32 v10, v75, v115
v_mul_f32 v11, v91, v115
v_fmac_f32 v10, v91, v119
v_fma_f32 v11, -v75, v119, v11
v_cvt_pk_bf16_f32 v75, v10, v11
ds_read_b128 v[112:115], v0 offset:32768
ds_read_b128 v[116:119], v0 offset:33792
s_waitcnt lgkmcnt(3)
v_mul_f32 v8, v76, v120
v_mul_f32 v9, v92, v120
s_waitcnt lgkmcnt(2)
v_fmac_f32 v8, v92, v124
v_fma_f32 v9, -v76, v124, v9
v_cvt_pk_bf16_f32 v76, v8, v9
v_mul_f32 v10, v77, v121
v_mul_f32 v11, v93, v121
v_fmac_f32 v10, v93, v125
v_fma_f32 v11, -v77, v125, v11
v_cvt_pk_bf16_f32 v77, v10, v11
v_mul_f32 v8, v78, v122
v_mul_f32 v9, v94, v122
v_fmac_f32 v8, v94, v126
v_fma_f32 v9, -v78, v126, v9
v_cvt_pk_bf16_f32 v78, v8, v9
v_mul_f32 v10, v79, v123
v_mul_f32 v11, v95, v123
v_fmac_f32 v10, v95, v127
v_fma_f32 v11, -v79, v127, v11
v_cvt_pk_bf16_f32 v79, v10, v11
ds_read_b128 v[120:123], v0 offset:34816
ds_read_b128 v[124:127], v0 offset:35840
v_mfma_f32_32x32x16_bf16 v[80:95], a[160:163], v[64:67], 0
v_mul_f32 v8, v48, v208
v_mul_f32 v9, v96, v208
v_fmac_f32 v8, v96, v192
v_fma_f32 v9, v48, v192, -v9
v_cvt_pk_bf16_f32 v48, v8, v9
v_mul_f32 v10, v49, v209
v_mul_f32 v11, v97, v209
v_fmac_f32 v10, v97, v193
v_mfma_f32_32x32x16_bf16 v[32:47], a[164:167], v[64:67], 0
v_fma_f32 v11, v49, v193, -v11
v_cvt_pk_bf16_f32 v49, v10, v11
v_mul_f32 v8, v50, v210
v_mul_f32 v9, v98, v210
v_fmac_f32 v8, v98, v194
v_fma_f32 v9, v50, v194, -v9
v_cvt_pk_bf16_f32 v50, v8, v9
v_mul_f32 v10, v51, v211
v_mfma_f32_32x32x16_bf16 v[80:95], a[168:171], v[68:71], v[80:95]
v_mul_f32 v11, v99, v211
v_fmac_f32 v10, v99, v195
v_fma_f32 v11, v51, v195, -v11
v_cvt_pk_bf16_f32 v51, v10, v11
v_mul_f32 v8, v52, v212
v_mul_f32 v9, v100, v212
v_fmac_f32 v8, v100, v196
v_fma_f32 v9, v52, v196, -v9
v_mfma_f32_32x32x16_bf16 v[32:47], a[172:175], v[68:71], v[32:47]
v_cvt_pk_bf16_f32 v52, v8, v9
v_mul_f32 v10, v53, v213
v_mul_f32 v11, v101, v213
v_fmac_f32 v10, v101, v197
v_fma_f32 v11, v53, v197, -v11
v_cvt_pk_bf16_f32 v53, v10, v11
v_mul_f32 v8, v54, v214
v_mul_f32 v9, v102, v214
v_mfma_f32_32x32x16_bf16 v[80:95], a[176:179], v[72:75], v[80:95]
v_fmac_f32 v8, v102, v198
v_fma_f32 v9, v54, v198, -v9
v_cvt_pk_bf16_f32 v54, v8, v9
v_mul_f32 v10, v55, v215
v_mul_f32 v11, v103, v215
v_fmac_f32 v10, v103, v199
v_fma_f32 v11, v55, v199, -v11
v_cvt_pk_bf16_f32 v55, v10, v11
v_mfma_f32_32x32x16_bf16 v[32:47], a[180:183], v[72:75], v[32:47]
v_mul_f32 v8, v56, v216
v_mul_f32 v9, v104, v216
v_fmac_f32 v8, v104, v200
v_fma_f32 v9, v56, v200, -v9
v_cvt_pk_bf16_f32 v56, v8, v9
v_mul_f32 v10, v57, v217
v_mul_f32 v11, v105, v217
v_fmac_f32 v10, v105, v201
v_mfma_f32_32x32x16_bf16 v[80:95], a[184:187], v[76:79], v[80:95]
v_fma_f32 v11, v57, v201, -v11
v_cvt_pk_bf16_f32 v57, v10, v11
v_mul_f32 v8, v58, v218
v_mul_f32 v9, v106, v218
v_fmac_f32 v8, v106, v202
v_fma_f32 v9, v58, v202, -v9
v_cvt_pk_bf16_f32 v58, v8, v9
v_mul_f32 v10, v59, v219
v_mfma_f32_32x32x16_bf16 v[32:47], a[188:191], v[76:79], v[32:47]
v_mul_f32 v11, v107, v219
v_fmac_f32 v10, v107, v203
v_fma_f32 v11, v59, v203, -v11
v_cvt_pk_bf16_f32 v59, v10, v11
v_mul_f32 v8, v60, v220
v_mul_f32 v9, v108, v220
v_fmac_f32 v8, v108, v204
v_fma_f32 v9, v60, v204, -v9
v_cvt_pk_bf16_f32 v60, v8, v9
v_mul_f32 v10, v61, v221
v_mul_f32 v11, v109, v221
v_fmac_f32 v10, v109, v205
v_fma_f32 v11, v61, v205, -v11
v_cvt_pk_bf16_f32 v61, v10, v11
v_mul_f32 v8, v62, v222
v_mul_f32 v9, v110, v222
v_fmac_f32 v8, v110, v206
v_fma_f32 v9, v62, v206, -v9
v_cvt_pk_bf16_f32 v62, v8, v9
v_mul_f32 v10, v63, v223
v_mul_f32 v11, v111, v223
v_fmac_f32 v10, v111, v207
v_fma_f32 v11, v63, v207, -v11
v_cvt_pk_bf16_f32 v63, v10, v11
v_mfma_f32_32x32x16_bf16 v[96:111], v[48:51], a[160:163], 0
v_mul_f32 v8, v80, v240
v_mul_f32 v9, v32, v240
v_fmac_f32 v8, v32, v224
v_fma_f32 v9, v80, v224, -v9
v_cvt_pk_bf16_f32 v80, v8, v9
v_mul_f32 v10, v81, v241
v_mul_f32 v11, v33, v241
v_fmac_f32 v10, v33, v225
v_mfma_f32_32x32x16_bf16 v[64:79], v[48:51], a[164:167], 0
v_fma_f32 v11, v81, v225, -v11
v_cvt_pk_bf16_f32 v81, v10, v11
v_mul_f32 v8, v82, v242
v_mul_f32 v9, v34, v242
v_fmac_f32 v8, v34, v226
v_fma_f32 v9, v82, v226, -v9
v_cvt_pk_bf16_f32 v82, v8, v9
v_mul_f32 v10, v83, v243
v_mfma_f32_32x32x16_bf16 v[96:111], v[52:55], a[168:171], v[96:111]
v_mul_f32 v11, v35, v243
v_fmac_f32 v10, v35, v227
v_fma_f32 v11, v83, v227, -v11
v_cvt_pk_bf16_f32 v83, v10, v11
v_mul_f32 v8, v84, v244
v_mul_f32 v9, v36, v244
v_fmac_f32 v8, v36, v228
v_fma_f32 v9, v84, v228, -v9
v_mfma_f32_32x32x16_bf16 v[64:79], v[52:55], a[172:175], v[64:79]
v_cvt_pk_bf16_f32 v84, v8, v9
v_mul_f32 v10, v85, v245
v_mul_f32 v11, v37, v245
v_fmac_f32 v10, v37, v229
v_fma_f32 v11, v85, v229, -v11
v_cvt_pk_bf16_f32 v85, v10, v11
v_mul_f32 v8, v86, v246
v_mul_f32 v9, v38, v246
v_mfma_f32_32x32x16_bf16 v[96:111], v[56:59], a[176:179], v[96:111]
v_fmac_f32 v8, v38, v230
v_fma_f32 v9, v86, v230, -v9
v_cvt_pk_bf16_f32 v86, v8, v9
v_mul_f32 v10, v87, v247
v_mul_f32 v11, v39, v247
v_fmac_f32 v10, v39, v231
v_fma_f32 v11, v87, v231, -v11
v_cvt_pk_bf16_f32 v87, v10, v11
v_mfma_f32_32x32x16_bf16 v[64:79], v[56:59], a[180:183], v[64:79]
v_mul_f32 v8, v88, v248
v_mul_f32 v9, v40, v248
v_fmac_f32 v8, v40, v232
v_fma_f32 v9, v88, v232, -v9
v_cvt_pk_bf16_f32 v88, v8, v9
v_mul_f32 v10, v89, v249
v_mul_f32 v11, v41, v249
v_fmac_f32 v10, v41, v233
v_mfma_f32_32x32x16_bf16 v[96:111], v[60:63], a[184:187], v[96:111]
v_fma_f32 v11, v89, v233, -v11
v_cvt_pk_bf16_f32 v89, v10, v11
v_mul_f32 v8, v90, v250
v_mul_f32 v9, v42, v250
v_fmac_f32 v8, v42, v234
v_fma_f32 v9, v90, v234, -v9
v_cvt_pk_bf16_f32 v90, v8, v9
v_mul_f32 v10, v91, v251
v_mfma_f32_32x32x16_bf16 v[64:79], v[60:63], a[188:191], v[64:79]
v_mul_f32 v11, v43, v251
v_fmac_f32 v10, v43, v235
v_fma_f32 v11, v91, v235, -v11
v_cvt_pk_bf16_f32 v91, v10, v11
v_mul_f32 v8, v92, v252
v_mul_f32 v9, v44, v252
v_fmac_f32 v8, v44, v236
v_fma_f32 v9, v92, v236, -v9
v_cvt_pk_bf16_f32 v92, v8, v9
v_mul_f32 v10, v93, v253
v_mul_f32 v11, v45, v253
v_fmac_f32 v10, v45, v237
v_fma_f32 v11, v93, v237, -v11
v_cvt_pk_bf16_f32 v93, v10, v11
v_mul_f32 v8, v94, v254
v_mul_f32 v9, v46, v254
v_fmac_f32 v8, v46, v238
v_fma_f32 v9, v94, v238, -v9
v_cvt_pk_bf16_f32 v94, v8, v9
v_mul_f32 v10, v95, v255
v_mul_f32 v11, v47, v255
v_fmac_f32 v10, v47, v239
v_fma_f32 v11, v95, v239, -v11
v_cvt_pk_bf16_f32 v95, v10, v11
v_mfma_f32_32x32x16_bf16 v[32:47], v[80:83], a[160:163], 0
s_waitcnt lgkmcnt(3)
v_mul_f32 v8, v96, v112
v_mul_f32 v9, v64, v112
s_waitcnt lgkmcnt(2)
v_fmac_f32 v8, v64, v116
v_fma_f32 v9, -v96, v116, v9
v_cvt_pk_bf16_f32 v96, v8, v9
v_mul_f32 v10, v97, v113
v_mul_f32 v11, v65, v113
v_fmac_f32 v10, v65, v117
v_mfma_f32_32x32x16_bf16 v[48:63], v[80:83], a[164:167], 0
v_fma_f32 v11, -v97, v117, v11
v_cvt_pk_bf16_f32 v97, v10, v11
v_mul_f32 v8, v98, v114
v_mul_f32 v9, v66, v114
v_fmac_f32 v8, v66, v118
v_fma_f32 v9, -v98, v118, v9
v_cvt_pk_bf16_f32 v98, v8, v9
v_mul_f32 v10, v99, v115
v_mfma_f32_32x32x16_bf16 v[32:47], v[84:87], a[168:171], v[32:47]
v_mul_f32 v11, v67, v115
v_fmac_f32 v10, v67, v119
v_fma_f32 v11, -v99, v119, v11
v_cvt_pk_bf16_f32 v99, v10, v11
ds_read_b128 v[112:115], v0 offset:36864
ds_read_b128 v[116:119], v0 offset:37888
s_waitcnt lgkmcnt(3)
v_mul_f32 v8, v100, v120
v_mul_f32 v9, v68, v120
v_mfma_f32_32x32x16_bf16 v[48:63], v[84:87], a[172:175], v[48:63]
s_waitcnt lgkmcnt(2)
v_fmac_f32 v8, v68, v124
v_fma_f32 v9, -v100, v124, v9
v_cvt_pk_bf16_f32 v100, v8, v9
v_mul_f32 v10, v101, v121
v_mul_f32 v11, v69, v121
v_fmac_f32 v10, v69, v125
v_fma_f32 v11, -v101, v125, v11
v_cvt_pk_bf16_f32 v101, v10, v11
v_mfma_f32_32x32x16_bf16 v[32:47], v[88:91], a[176:179], v[32:47]
v_mul_f32 v8, v102, v122
v_mul_f32 v9, v70, v122
v_fmac_f32 v8, v70, v126
v_fma_f32 v9, -v102, v126, v9
v_cvt_pk_bf16_f32 v102, v8, v9
v_mul_f32 v10, v103, v123
v_mul_f32 v11, v71, v123
v_fmac_f32 v10, v71, v127
v_mfma_f32_32x32x16_bf16 v[48:63], v[88:91], a[180:183], v[48:63]
v_fma_f32 v11, -v103, v127, v11
v_cvt_pk_bf16_f32 v103, v10, v11
ds_read_b128 v[120:123], v0 offset:38912
ds_read_b128 v[124:127], v0 offset:39936
s_waitcnt lgkmcnt(3)
v_mul_f32 v8, v104, v112
v_mul_f32 v9, v72, v112
s_waitcnt lgkmcnt(2)
v_fmac_f32 v8, v72, v116
v_fma_f32 v9, -v104, v116, v9
v_mfma_f32_32x32x16_bf16 v[32:47], v[92:95], a[184:187], v[32:47]
v_cvt_pk_bf16_f32 v104, v8, v9
v_mul_f32 v10, v105, v113
v_mul_f32 v11, v73, v113
v_fmac_f32 v10, v73, v117
v_fma_f32 v11, -v105, v117, v11
v_cvt_pk_bf16_f32 v105, v10, v11
v_mul_f32 v8, v106, v114
v_mul_f32 v9, v74, v114
v_mfma_f32_32x32x16_bf16 v[48:63], v[92:95], a[188:191], v[48:63]
v_fmac_f32 v8, v74, v118
v_fma_f32 v9, -v106, v118, v9
v_cvt_pk_bf16_f32 v106, v8, v9
v_mul_f32 v10, v107, v115
v_mul_f32 v11, v75, v115
v_fmac_f32 v10, v75, v119
v_fma_f32 v11, -v107, v119, v11
v_cvt_pk_bf16_f32 v107, v10, v11
ds_read_b128 v[112:115], v0 offset:49152
ds_read_b128 v[116:119], v0 offset:50176
s_waitcnt lgkmcnt(3)
v_mul_f32 v8, v108, v120
v_mul_f32 v9, v76, v120
s_waitcnt lgkmcnt(2)
v_fmac_f32 v8, v76, v124
v_fma_f32 v9, -v108, v124, v9
v_cvt_pk_bf16_f32 v108, v8, v9
v_mul_f32 v10, v109, v121
v_mul_f32 v11, v77, v121
v_fmac_f32 v10, v77, v125
v_fma_f32 v11, -v109, v125, v11
v_cvt_pk_bf16_f32 v109, v10, v11
v_mul_f32 v8, v110, v122
v_mul_f32 v9, v78, v122
v_fmac_f32 v8, v78, v126
v_fma_f32 v9, -v110, v126, v9
v_cvt_pk_bf16_f32 v110, v8, v9
v_mul_f32 v10, v111, v123
v_mul_f32 v11, v79, v123
v_fmac_f32 v10, v79, v127
v_fma_f32 v11, -v111, v127, v11
v_cvt_pk_bf16_f32 v111, v10, v11
ds_read_b128 v[120:123], v0 offset:51200
ds_read_b128 v[124:127], v0 offset:52224
ds_read_b128 v[80:83], v26 offset:0
ds_read_b128 v[84:87], v0 offset:1024
ds_read_b128 v[88:91], v26 offset:2048
ds_read_b128 v[92:95], v0 offset:3072
ds_read_b128 v[64:67], v26 offset:4096
ds_read_b128 v[68:71], v0 offset:5120
s_lshl_b32 s52, s3, 10
v_add_u32 v20, s52, v0
v_add_u32 v20, 65536, v20
s_waitcnt lgkmcnt(5)
v_mfma_f32_32x32x16_bf16 v[128:143], v[80:83], v[96:99], v[128:143]
ds_read_b128 v[72:75], v26 offset:6144
v_mul_f32 v8, v32, v112
v_mul_f32 v9, v48, v112
v_fmac_f32 v8, v48, v116
v_fma_f32 v9, -v32, v116, v9
v_cvt_pk_bf16_f32 v32, v8, v9
v_mul_f32 v10, v33, v113
s_waitcnt lgkmcnt(5)
v_mfma_f32_32x32x16_bf16 v[144:159], v[84:87], v[96:99], v[144:159]
ds_read_b128 v[76:79], v0 offset:7168
v_mul_f32 v11, v49, v113
v_fmac_f32 v10, v49, v117
v_fma_f32 v11, -v33, v117, v11
v_cvt_pk_bf16_f32 v33, v10, v11
v_mul_f32 v8, v34, v114
v_mul_f32 v9, v50, v114
s_waitcnt lgkmcnt(5)
v_mfma_f32_32x32x16_bf16 v[160:175], v[88:91], v[96:99], v[160:175]
ds_read_b128 v[80:83], v26 offset:8192
v_fmac_f32 v8, v50, v118
v_fma_f32 v9, -v34, v118, v9
v_cvt_pk_bf16_f32 v34, v8, v9
v_mul_f32 v10, v35, v115
v_mul_f32 v11, v51, v115
v_fmac_f32 v10, v51, v119
s_waitcnt lgkmcnt(5)
v_mfma_f32_32x32x16_bf16 v[176:191], v[92:95], v[96:99], v[176:191]
ds_read_b128 v[84:87], v0 offset:9216
v_fma_f32 v11, -v35, v119, v11
v_cvt_pk_bf16_f32 v35, v10, v11
ds_read_b128 v[112:115], v0 offset:53248
ds_read_b128 v[116:119], v0 offset:54272
v_mul_f32 v8, v36, v120
v_mul_f32 v9, v52, v120
s_waitcnt lgkmcnt(7)
v_mfma_f32_32x32x16_bf16 v[128:143], v[64:67], v[100:103], v[128:143]
ds_read_b128 v[88:91], v26 offset:10240
v_fmac_f32 v8, v52, v124
v_fma_f32 v9, -v36, v124, v9
v_cvt_pk_bf16_f32 v36, v8, v9
v_mul_f32 v10, v37, v121
v_mul_f32 v11, v53, v121
v_fmac_f32 v10, v53, v125
s_waitcnt lgkmcnt(7)
v_mfma_f32_32x32x16_bf16 v[144:159], v[68:71], v[100:103], v[144:159]
ds_read_b128 v[92:95], v0 offset:11264
v_fma_f32 v11, -v37, v125, v11
v_cvt_pk_bf16_f32 v37, v10, v11
v_mul_f32 v8, v38, v122
v_mul_f32 v9, v54, v122
v_fmac_f32 v8, v54, v126
v_fma_f32 v9, -v38, v126, v9
s_waitcnt lgkmcnt(7)
v_mfma_f32_32x32x16_bf16 v[160:175], v[72:75], v[100:103], v[160:175]
ds_read_b128 v[64:67], v26 offset:12288
v_cvt_pk_bf16_f32 v38, v8, v9
v_mul_f32 v10, v39, v123
v_mul_f32 v11, v55, v123
v_fmac_f32 v10, v55, v127
v_fma_f32 v11, -v39, v127, v11
v_cvt_pk_bf16_f32 v39, v10, v11
s_waitcnt lgkmcnt(7)
v_mfma_f32_32x32x16_bf16 v[176:191], v[76:79], v[100:103], v[176:191]
ds_read_b128 v[68:71], v0 offset:13312
ds_read_b128 v[120:123], v0 offset:55296
ds_read_b128 v[124:127], v0 offset:56320
s_waitcnt lgkmcnt(7)
v_mul_f32 v8, v40, v112
v_mul_f32 v9, v56, v112
s_waitcnt lgkmcnt(6)
v_fmac_f32 v8, v56, v116
v_fma_f32 v9, -v40, v116, v9
v_mfma_f32_32x32x16_bf16 v[128:143], v[80:83], v[104:107], v[128:143]
ds_read_b128 v[72:75], v26 offset:14336
v_cvt_pk_bf16_f32 v40, v8, v9
v_mul_f32 v10, v41, v113
v_mul_f32 v11, v57, v113
v_fmac_f32 v10, v57, v117
v_fma_f32 v11, -v41, v117, v11
v_cvt_pk_bf16_f32 v41, v10, v11
v_mfma_f32_32x32x16_bf16 v[144:159], v[84:87], v[104:107], v[144:159]
ds_read_b128 v[76:79], v0 offset:15360
v_mul_f32 v8, v42, v114
v_mul_f32 v9, v58, v114
v_fmac_f32 v8, v58, v118
v_fma_f32 v9, -v42, v118, v9
v_cvt_pk_bf16_f32 v42, v8, v9
v_mul_f32 v10, v43, v115
s_waitcnt lgkmcnt(7)
v_mfma_f32_32x32x16_bf16 v[160:175], v[88:91], v[104:107], v[160:175]
ds_read_b128 v[80:83], v26 offset:16384
v_mul_f32 v11, v59, v115
v_fmac_f32 v10, v59, v119
v_fma_f32 v11, -v43, v119, v11
v_cvt_pk_bf16_f32 v43, v10, v11
s_waitcnt lgkmcnt(4)
v_mul_f32 v8, v44, v120
v_mul_f32 v9, v60, v120
v_mfma_f32_32x32x16_bf16 v[176:191], v[92:95], v[104:107], v[176:191]
ds_read_b128 v[84:87], v0 offset:17408
s_waitcnt lgkmcnt(4)
v_fmac_f32 v8, v60, v124
v_fma_f32 v9, -v44, v124, v9
v_cvt_pk_bf16_f32 v44, v8, v9
v_mul_f32 v10, v45, v121
v_mul_f32 v11, v61, v121
v_fmac_f32 v10, v61, v125
v_mfma_f32_32x32x16_bf16 v[128:143], v[64:67], v[108:111], v[128:143]
ds_read_b128 v[88:91], v26 offset:20480
v_fma_f32 v11, -v45, v125, v11
v_cvt_pk_bf16_f32 v45, v10, v11
v_mul_f32 v8, v46, v122
v_mul_f32 v9, v62, v122
v_fmac_f32 v8, v62, v126
v_fma_f32 v9, -v46, v126, v9
v_mfma_f32_32x32x16_bf16 v[144:159], v[68:71], v[108:111], v[144:159]
ds_read_b128 v[92:95], v0 offset:21504
v_cvt_pk_bf16_f32 v46, v8, v9
v_mul_f32 v10, v47, v123
v_mul_f32 v11, v63, v123
v_fmac_f32 v10, v63, v127
v_fma_f32 v11, -v47, v127, v11
v_cvt_pk_bf16_f32 v47, v10, v11
s_waitcnt lgkmcnt(5)
v_mfma_f32_32x32x16_bf16 v[160:175], v[72:75], v[108:111], v[160:175]
ds_read_b128 v[64:67], v26 offset:24576
s_waitcnt lgkmcnt(5)
v_mfma_f32_32x32x16_bf16 v[176:191], v[76:79], v[108:111], v[176:191]
ds_read_b128 v[68:71], v0 offset:25600
s_waitcnt lgkmcnt(5)
v_mfma_f32_32x32x16_bf16 v[128:143], v[80:83], v[32:35], v[128:143]
ds_read_b128 v[72:75], v26 offset:28672
s_waitcnt lgkmcnt(5)
v_mfma_f32_32x32x16_bf16 v[144:159], v[84:87], v[32:35], v[144:159]
ds_read_b128 v[76:79], v0 offset:29696
s_waitcnt lgkmcnt(5)
v_mfma_f32_32x32x16_bf16 v[128:143], v[88:91], v[36:39], v[128:143]
ds_read_b128 v[80:83], v26 offset:18432
s_waitcnt lgkmcnt(5)
v_mfma_f32_32x32x16_bf16 v[144:159], v[92:95], v[36:39], v[144:159]
ds_read_b128 v[84:87], v0 offset:19456
s_waitcnt lgkmcnt(5)
v_mfma_f32_32x32x16_bf16 v[128:143], v[64:67], v[40:43], v[128:143]
ds_read_b128 v[88:91], v26 offset:22528
s_waitcnt lgkmcnt(5)
v_mfma_f32_32x32x16_bf16 v[144:159], v[68:71], v[40:43], v[144:159]
ds_read_b128 v[92:95], v0 offset:23552
s_waitcnt lgkmcnt(5)
v_mfma_f32_32x32x16_bf16 v[128:143], v[72:75], v[44:47], v[128:143]
ds_read_b128 v[64:67], v26 offset:26624
s_waitcnt lgkmcnt(5)
v_mfma_f32_32x32x16_bf16 v[144:159], v[76:79], v[44:47], v[144:159]
ds_read_b128 v[68:71], v0 offset:27648
s_waitcnt lgkmcnt(5)
v_mfma_f32_32x32x16_bf16 v[160:175], v[80:83], v[32:35], v[160:175]
ds_read_b128 v[72:75], v26 offset:30720
s_waitcnt lgkmcnt(5)
v_mfma_f32_32x32x16_bf16 v[176:191], v[84:87], v[32:35], v[176:191]
ds_read_b128 v[76:79], v0 offset:31744
v_cvt_pk_bf16_f32 v128, v144, v128
v_cvt_pk_bf16_f32 v129, v145, v129
v_cvt_pk_bf16_f32 v130, v146, v130
v_cvt_pk_bf16_f32 v131, v147, v131
ds_write_b128 v20, v[128:131] offset:0
v_cvt_pk_bf16_f32 v132, v148, v132
s_waitcnt lgkmcnt(6)
v_mfma_f32_32x32x16_bf16 v[160:175], v[88:91], v[36:39], v[160:175]
v_cvt_pk_bf16_f32 v133, v149, v133
v_cvt_pk_bf16_f32 v134, v150, v134
v_cvt_pk_bf16_f32 v135, v151, v135
ds_write_b128 v20, v[132:135] offset:4096
v_cvt_pk_bf16_f32 v136, v152, v136
v_cvt_pk_bf16_f32 v137, v153, v137
s_waitcnt lgkmcnt(6)
v_mfma_f32_32x32x16_bf16 v[176:191], v[92:95], v[36:39], v[176:191]
v_cvt_pk_bf16_f32 v138, v154, v138
v_cvt_pk_bf16_f32 v139, v155, v139
ds_write_b128 v20, v[136:139] offset:8192
v_cvt_pk_bf16_f32 v140, v156, v140
v_cvt_pk_bf16_f32 v141, v157, v141
v_cvt_pk_bf16_f32 v142, v158, v142
s_waitcnt lgkmcnt(6)
v_mfma_f32_32x32x16_bf16 v[160:175], v[64:67], v[40:43], v[160:175]
v_cvt_pk_bf16_f32 v143, v159, v143
ds_write_b128 v20, v[140:143] offset:12288
s_waitcnt lgkmcnt(6)
v_mfma_f32_32x32x16_bf16 v[176:191], v[68:71], v[40:43], v[176:191]
s_waitcnt lgkmcnt(5)
v_mfma_f32_32x32x16_bf16 v[160:175], v[72:75], v[44:47], v[160:175]
s_waitcnt lgkmcnt(4)
v_mfma_f32_32x32x16_bf16 v[176:191], v[76:79], v[44:47], v[176:191]
s_nop 11
v_cvt_pk_bf16_f32 v160, v176, v160
v_cvt_pk_bf16_f32 v161, v177, v161
v_cvt_pk_bf16_f32 v162, v178, v162
v_cvt_pk_bf16_f32 v163, v179, v163
ds_write_b128 v20, v[160:163] offset:16384
v_cvt_pk_bf16_f32 v164, v180, v164
v_cvt_pk_bf16_f32 v165, v181, v165
v_cvt_pk_bf16_f32 v166, v182, v166
v_cvt_pk_bf16_f32 v167, v183, v167
ds_write_b128 v20, v[164:167] offset:20480
v_cvt_pk_bf16_f32 v168, v184, v168
v_cvt_pk_bf16_f32 v169, v185, v169
v_cvt_pk_bf16_f32 v170, v186, v170
v_cvt_pk_bf16_f32 v171, v187, v171
ds_write_b128 v20, v[168:171] offset:24576
v_cvt_pk_bf16_f32 v172, v188, v172
v_cvt_pk_bf16_f32 v173, v189, v173
v_cvt_pk_bf16_f32 v174, v190, v174
v_cvt_pk_bf16_f32 v175, v191, v175
ds_write_b128 v20, v[172:175] offset:28672
s_lshl_b32 s52, s3, 12
s_add_u32 s52, s52, 65536
v_add_u32 v20, s52, v0
s_waitcnt lgkmcnt(0)
s_barrier
ds_read_b128 v[32:35], v20 offset:0
ds_read_b128 v[36:39], v20 offset:1024
ds_read_b128 v[40:43], v20 offset:2048
ds_read_b128 v[44:47], v20 offset:3072
ds_read_b128 v[48:51], v20 offset:16384
ds_read_b128 v[52:55], v20 offset:17408
ds_read_b128 v[56:59], v20 offset:18432
ds_read_b128 v[60:63], v20 offset:19456
s_waitcnt lgkmcnt(6)
v_swap_b32 v33, v36
s_waitcnt lgkmcnt(5)
v_swap_b32 v34, v40
s_waitcnt lgkmcnt(4)
v_swap_b32 v35, v44
buffer_store_dwordx4 v[32:35], v25, s[4:7], s48 offen sc1
s_add_u32 s48, s48, 40960
v_swap_b32 v38, v41
v_swap_b32 v39, v45
buffer_store_dwordx4 v[36:39], v25, s[4:7], s48 offen sc1
s_add_u32 s48, s48, 40960
v_swap_b32 v43, v46
buffer_store_dwordx4 v[40:43], v25, s[4:7], s48 offen sc1
s_add_u32 s48, s48, 40960
buffer_store_dwordx4 v[44:47], v25, s[4:7], s48 offen sc1
s_add_u32 s48, s48, 1187840
s_waitcnt lgkmcnt(2)
v_swap_b32 v49, v52
s_waitcnt lgkmcnt(1)
v_swap_b32 v50, v56
s_waitcnt lgkmcnt(0)
v_swap_b32 v51, v60
buffer_store_dwordx4 v[48:51], v25, s[4:7], s48 offen sc1
s_add_u32 s48, s48, 40960
v_swap_b32 v54, v57
v_swap_b32 v55, v61
buffer_store_dwordx4 v[52:55], v25, s[4:7], s48 offen sc1
s_add_u32 s48, s48, 40960
v_swap_b32 v59, v62
buffer_store_dwordx4 v[56:59], v25, s[4:7], s48 offen sc1
s_add_u32 s48, s48, 40960
buffer_store_dwordx4 v[60:63], v25, s[4:7], s48 offen sc1
s_add_u32 s48, s48, 1187840
s_lshl_b32 s54, s51, 13
s_lshl_b32 s52, s30, 6
s_add_u32 s54, s54, s52
s_add_u32 s54, s54, 222306304
s_waitcnt vmcnt(0)
s_barrier
s_cmp_lg_u32 s3, 0
s_cbranch_scc1 k_s8_89
s_mov_b64 exec, 1
v_mov_b32 v8, 1
buffer_store_dword v8, off, s[4:7], s54 sc1
s_mov_b64 exec, -1
k_s8_89:
k_fend_39:
s_add_u32 s51, s51, 1
s_cmp_lt_u32 s51, 2
s_cbranch_scc1 k_lay_30
s_add_u32 s30, s30, 64
s_cmp_ge_u32 s30, 144
s_cbranch_scc1 k_fin_7
s_endpgm
k_o_4:
s_load_dwordx2 s[36:37], s[0:1], 0
s_mov_b32 s38, 2621440
s_mov_b32 s39, 0x20000
s_mul_i32 s57, s30, 52429
s_lshr_b32 s57, s57, 18
s_mul_i32 s52, s57, 5
s_sub_u32 s58, s30, s52
s_lshl_b32 s58, s58, 2
s_add_u32 s58, s58, s3
v_mov_b64 v[4:5], -1
v_mov_b64 v[6:7], -1
s_lshl_b32 s52, s30, 2
s_add_u32 s52, s52, s3
s_lshl_b32 s53, s52, 13
s_lshl_b32 s52, s52, 9
v_lshrrev_b32 v2, 1, v0
s_add_u32 s54, s52, 211812352
buffer_store_dwordx2 v[4:5], v2, s[4:7], s54 offen sc1
s_add_u32 s54, s53, 205520896
buffer_store_dwordx4 v[4:7], v0, s[4:7], s54 offen offset:0 sc1
buffer_store_dwordx4 v[4:7], v0, s[4:7], s54 offen offset:1024 sc1
buffer_store_dwordx4 v[4:7], v0, s[4:7], s54 offen offset:2048 sc1
buffer_store_dwordx4 v[4:7], v0, s[4:7], s54 offen offset:3072 sc1
s_add_u32 s54, s53, 205524992
buffer_store_dwordx4 v[4:7], v0, s[4:7], s54 offen offset:0 sc1
buffer_store_dwordx4 v[4:7], v0, s[4:7], s54 offen offset:1024 sc1
buffer_store_dwordx4 v[4:7], v0, s[4:7], s54 offen offset:2048 sc1
buffer_store_dwordx4 v[4:7], v0, s[4:7], s54 offen offset:3072 sc1
s_add_u32 s54, s52, 212860928
buffer_store_dwordx2 v[4:5], v2, s[4:7], s54 offen sc1
s_add_u32 s54, s53, 208666624
buffer_store_dwordx4 v[4:7], v0, s[4:7], s54 offen offset:0 sc1
buffer_store_dwordx4 v[4:7], v0, s[4:7], s54 offen offset:1024 sc1
buffer_store_dwordx4 v[4:7], v0, s[4:7], s54 offen offset:2048 sc1
buffer_store_dwordx4 v[4:7], v0, s[4:7], s54 offen offset:3072 sc1
s_add_u32 s54, s53, 208670720
buffer_store_dwordx4 v[4:7], v0, s[4:7], s54 offen offset:0 sc1
buffer_store_dwordx4 v[4:7], v0, s[4:7], s54 offen offset:1024 sc1
buffer_store_dwordx4 v[4:7], v0, s[4:7], s54 offen offset:2048 sc1
buffer_store_dwordx4 v[4:7], v0, s[4:7], s54 offen offset:3072 sc1
s_mul_i32 s52, s3, 640
v_lshrrev_b32 v8, 4, v0
v_add_u32 v8, s52, v8
s_mov_b32 s53, 52429
v_add_u32 v9, 0, v8
v_mul_u32_u24 v10, s53, v9
v_lshrrev_b32 v10, 22, v10
v_mul_u32_u24 v11, 80, v10
v_sub_u32 v9, v9, v11
v_and_b32 v11, 15, v10
v_xor_b32 v9, v9, v11
v_mul_u32_u24 v10, 1280, v10
v_lshl_add_u32 v72, v9, 4, v10
v_add_u32 v9, 64, v8
v_mul_u32_u24 v10, s53, v9
v_lshrrev_b32 v10, 22, v10
v_mul_u32_u24 v11, 80, v10
v_sub_u32 v9, v9, v11
v_and_b32 v11, 15, v10
v_xor_b32 v9, v9, v11
v_mul_u32_u24 v10, 1280, v10
v_lshl_add_u32 v73, v9, 4, v10
v_add_u32 v9, 128, v8
v_mul_u32_u24 v10, s53, v9
v_lshrrev_b32 v10, 22, v10
v_mul_u32_u24 v11, 80, v10
v_sub_u32 v9, v9, v11
v_and_b32 v11, 15, v10
v_xor_b32 v9, v9, v11
v_mul_u32_u24 v10, 1280, v10
v_lshl_add_u32 v74, v9, 4, v10
v_add_u32 v9, 192, v8
v_mul_u32_u24 v10, s53, v9
v_lshrrev_b32 v10, 22, v10
v_mul_u32_u24 v11, 80, v10
v_sub_u32 v9, v9, v11
v_and_b32 v11, 15, v10
v_xor_b32 v9, v9, v11
v_mul_u32_u24 v10, 1280, v10
v_lshl_add_u32 v75, v9, 4, v10
v_add_u32 v9, 256, v8
v_mul_u32_u24 v10, s53, v9
v_lshrrev_b32 v10, 22, v10
v_mul_u32_u24 v11, 80, v10
v_sub_u32 v9, v9, v11
v_and_b32 v11, 15, v10
v_xor_b32 v9, v9, v11
v_mul_u32_u24 v10, 1280, v10
v_lshl_add_u32 v76, v9, 4, v10
v_add_u32 v9, 320, v8
v_mul_u32_u24 v10, s53, v9
v_lshrrev_b32 v10, 22, v10
v_mul_u32_u24 v11, 80, v10
v_sub_u32 v9, v9, v11
v_and_b32 v11, 15, v10
v_xor_b32 v9, v9, v11
v_mul_u32_u24 v10, 1280, v10
v_lshl_add_u32 v77, v9, 4, v10
v_add_u32 v9, 384, v8
v_mul_u32_u24 v10, s53, v9
v_lshrrev_b32 v10, 22, v10
v_mul_u32_u24 v11, 80, v10
v_sub_u32 v9, v9, v11
v_and_b32 v11, 15, v10
v_xor_b32 v9, v9, v11
v_mul_u32_u24 v10, 1280, v10
v_lshl_add_u32 v78, v9, 4, v10
v_add_u32 v9, 448, v8
v_mul_u32_u24 v10, s53, v9
v_lshrrev_b32 v10, 22, v10
v_mul_u32_u24 v11, 80, v10
v_sub_u32 v9, v9, v11
v_and_b32 v11, 15, v10
v_xor_b32 v9, v9, v11
v_mul_u32_u24 v10, 1280, v10
v_lshl_add_u32 v79, v9, 4, v10
v_add_u32 v9, 512, v8
v_mul_u32_u24 v10, s53, v9
v_lshrrev_b32 v10, 22, v10
v_mul_u32_u24 v11, 80, v10
v_sub_u32 v9, v9, v11
v_and_b32 v11, 15, v10
v_xor_b32 v9, v9, v11
v_mul_u32_u24 v10, 1280, v10
v_lshl_add_u32 v80, v9, 4, v10
v_add_u32 v9, 576, v8
v_mul_u32_u24 v10, s53, v9
v_lshrrev_b32 v10, 22, v10
v_mul_u32_u24 v11, 80, v10
v_sub_u32 v9, v9, v11
v_and_b32 v11, 15, v10
v_xor_b32 v9, v9, v11
v_mul_u32_u24 v10, 1280, v10
v_lshl_add_u32 v81, v9, 4, v10
s_cmp_lg_u32 s3, 0
s_cbranch_scc1 k_wdd_91
v_mov_b32 v2, 128
k_wd_90:
global_load_dword v3, v2, s[28:29] sc1
s_waitcnt vmcnt(0)
v_readfirstlane_b32 s52, v3
s_cmp_ge_u32 s52, 32
s_cbranch_scc1 k_wdd_91
s_sleep 2
s_sub_u32 s32, s32, 1
s_cmp_gt_i32 s32, 0
s_cbranch_scc1 k_wd_90
k_wdd_91:
s_barrier
s_mul_i32 s53, s58, 40960
s_add_u32 s53, s53, 213909504
buffer_load_dwordx4 v[96:99], v0, s[4:7], s53 offen offset:0 sc1
buffer_load_dwordx4 v[100:103], v0, s[4:7], s53 offen offset:1024 sc1
buffer_load_dwordx4 v[104:107], v0, s[4:7], s53 offen offset:2048 sc1
buffer_load_dwordx4 v[108:111], v0, s[4:7], s53 offen offset:3072 sc1
s_add_u32 s53, s53, 4096
buffer_load_dwordx4 v[112:115], v0, s[4:7], s53 offen offset:0 sc1
buffer_load_dwordx4 v[116:119], v0, s[4:7], s53 offen offset:1024 sc1
buffer_load_dwordx4 v[120:123], v0, s[4:7], s53 offen offset:2048 sc1
buffer_load_dwordx4 v[124:127], v0, s[4:7], s53 offen offset:3072 sc1
s_add_u32 s53, s53, 4096
buffer_load_dwordx4 v[128:131], v0, s[4:7], s53 offen offset:0 sc1
buffer_load_dwordx4 v[132:135], v0, s[4:7], s53 offen offset:1024 sc1
buffer_load_dwordx4 v[136:139], v0, s[4:7], s53 offen offset:2048 sc1
buffer_load_dwordx4 v[140:143], v0, s[4:7], s53 offen offset:3072 sc1
s_add_u32 s53, s53, 4096
buffer_load_dwordx4 v[144:147], v0, s[4:7], s53 offen offset:0 sc1
buffer_load_dwordx4 v[148:151], v0, s[4:7], s53 offen offset:1024 sc1
buffer_load_dwordx4 v[152:155], v0, s[4:7], s53 offen offset:2048 sc1
buffer_load_dwordx4 v[156:159], v0, s[4:7], s53 offen offset:3072 sc1
s_add_u32 s53, s53, 4096
buffer_load_dwordx4 v[160:163], v0, s[4:7], s53 offen offset:0 sc1
buffer_load_dwordx4 v[164:167], v0, s[4:7], s53 offen offset:1024 sc1
buffer_load_dwordx4 v[168:171], v0, s[4:7], s53 offen offset:2048 sc1
buffer_load_dwordx4 v[172:175], v0, s[4:7], s53 offen offset:3072 sc1
s_add_u32 s53, s53, 4096
buffer_load_dwordx4 v[176:179], v0, s[4:7], s53 offen offset:0 sc1
buffer_load_dwordx4 v[180:183], v0, s[4:7], s53 offen offset:1024 sc1
buffer_load_dwordx4 v[184:187], v0, s[4:7], s53 offen offset:2048 sc1
buffer_load_dwordx4 v[188:191], v0, s[4:7], s53 offen offset:3072 sc1
s_add_u32 s53, s53, 4096
buffer_load_dwordx4 v[192:195], v0, s[4:7], s53 offen offset:0 sc1
buffer_load_dwordx4 v[196:199], v0, s[4:7], s53 offen offset:1024 sc1
buffer_load_dwordx4 v[200:203], v0, s[4:7], s53 offen offset:2048 sc1
buffer_load_dwordx4 v[204:207], v0, s[4:7], s53 offen offset:3072 sc1
s_add_u32 s53, s53, 4096
buffer_load_dwordx4 v[208:211], v0, s[4:7], s53 offen offset:0 sc1
buffer_load_dwordx4 v[212:215], v0, s[4:7], s53 offen offset:1024 sc1
buffer_load_dwordx4 v[216:219], v0, s[4:7], s53 offen offset:2048 sc1
buffer_load_dwordx4 v[220:223], v0, s[4:7], s53 offen offset:3072 sc1
s_add_u32 s53, s53, 4096
buffer_load_dwordx4 v[224:227], v0, s[4:7], s53 offen offset:0 sc1
buffer_load_dwordx4 v[228:231], v0, s[4:7], s53 offen offset:1024 sc1
buffer_load_dwordx4 v[232:235], v0, s[4:7], s53 offen offset:2048 sc1
buffer_load_dwordx4 v[236:239], v0, s[4:7], s53 offen offset:3072 sc1
s_add_u32 s53, s53, 4096
buffer_load_dwordx4 v[240:243], v0, s[4:7], s53 offen offset:0 sc1
buffer_load_dwordx4 v[244:247], v0, s[4:7], s53 offen offset:1024 sc1
buffer_load_dwordx4 v[248:251], v0, s[4:7], s53 offen offset:2048 sc1
buffer_load_dwordx4 v[252:255], v0, s[4:7], s53 offen offset:3072 sc1
s_mul_i32 s46, s57, 163840
s_lshl_b32 s48, s58, 11
s_add_u32 s48, s48, s46
s_add_u32 s48, s48, 195035136
s_mov_b32 s47, 0
s_waitcnt lgkmcnt(0)
s_mul_i32 s45, s3, 10240
s_mov_b32 s44, 0
v_bfe_u32 v8, v0, 4, 5
v_mul_u32_u24 v9, 1280, v8
v_and_b32 v8, 15, v8
v_lshrrev_b32 v10, 9, v0
v_xor_b32 v8, v8, v10
v_xor_b32 v10, 0, v8
v_lshl_add_u32 v64, v10, 4, v9
v_xor_b32 v10, 2, v8
v_lshl_add_u32 v65, v10, 4, v9
v_xor_b32 v10, 4, v8
v_lshl_add_u32 v66, v10, 4, v9
v_xor_b32 v10, 6, v8
v_lshl_add_u32 v67, v10, 4, v9
v_xor_b32 v10, 8, v8
v_lshl_add_u32 v68, v10, 4, v9
v_xor_b32 v10, 10, v8
v_lshl_add_u32 v69, v10, 4, v9
v_xor_b32 v10, 12, v8
v_lshl_add_u32 v70, v10, 4, v9
v_xor_b32 v10, 14, v8
v_lshl_add_u32 v71, v10, 4, v9
s_add_u32 m0, s45, 0
s_nop 0
buffer_load_dwordx4 v72, s[36:39], s46 offen lds
s_add_u32 m0, s45, 1024
s_nop 0
buffer_load_dwordx4 v73, s[36:39], s46 offen lds
s_add_u32 m0, s45, 2048
s_nop 0
buffer_load_dwordx4 v74, s[36:39], s46 offen lds
s_add_u32 m0, s45, 3072
s_nop 0
buffer_load_dwordx4 v75, s[36:39], s46 offen lds
s_add_u32 m0, s45, 4096
s_nop 0
buffer_load_dwordx4 v76, s[36:39], s46 offen lds
s_add_u32 m0, s45, 5120
s_nop 0
buffer_load_dwordx4 v77, s[36:39], s46 offen lds
s_add_u32 m0, s45, 6144
s_nop 0
buffer_load_dwordx4 v78, s[36:39], s46 offen lds
s_add_u32 m0, s45, 7168
s_nop 0
buffer_load_dwordx4 v79, s[36:39], s46 offen lds
s_add_u32 m0, s45, 8192
s_nop 0
buffer_load_dwordx4 v80, s[36:39], s46 offen lds
s_add_u32 m0, s45, 9216
s_nop 0
buffer_load_dwordx4 v81, s[36:39], s46 offen lds
s_add_u32 s45, s45, 40960
s_cmp_ge_u32 s45, 122880
s_cselect_b32 s55, 122880, 0
s_sub_u32 s45, s45, s55
s_add_u32 s47, s47, 1
s_cmp_lt_u32 s47, 4
s_cselect_b32 s55, 40960, 0
s_add_u32 s46, s46, s55
s_add_u32 m0, s45, 0
s_nop 0
buffer_load_dwordx4 v72, s[36:39], s46 offen lds
s_add_u32 m0, s45, 1024
s_nop 0
buffer_load_dwordx4 v73, s[36:39], s46 offen lds
s_add_u32 m0, s45, 2048
s_nop 0
buffer_load_dwordx4 v74, s[36:39], s46 offen lds
s_add_u32 m0, s45, 3072
s_nop 0
buffer_load_dwordx4 v75, s[36:39], s46 offen lds
s_add_u32 m0, s45, 4096
s_nop 0
buffer_load_dwordx4 v76, s[36:39], s46 offen lds
s_add_u32 m0, s45, 5120
s_nop 0
buffer_load_dwordx4 v77, s[36:39], s46 offen lds
s_add_u32 m0, s45, 6144
s_nop 0
buffer_load_dwordx4 v78, s[36:39], s46 offen lds
s_add_u32 m0, s45, 7168
s_nop 0
buffer_load_dwordx4 v79, s[36:39], s46 offen lds
s_add_u32 m0, s45, 8192
s_nop 0
buffer_load_dwordx4 v80, s[36:39], s46 offen lds
s_add_u32 m0, s45, 9216
s_nop 0
buffer_load_dwordx4 v81, s[36:39], s46 offen lds
s_add_u32 s45, s45, 40960
s_cmp_ge_u32 s45, 122880
s_cselect_b32 s55, 122880, 0
s_sub_u32 s45, s45, s55
s_add_u32 s47, s47, 1
s_cmp_lt_u32 s47, 4
s_cselect_b32 s55, 40960, 0
s_add_u32 s46, s46, s55
s_waitcnt vmcnt(10)
s_barrier
ds_read_b128 v[8:11], v64 offset:0
ds_read_b128 v[12:15], v65 offset:0
ds_read_b128 v[16:19], v66 offset:0
ds_read_b128 v[20:23], v67 offset:0
s_mov_b32 s59, 2
s_waitcnt lgkmcnt(3)
v_mfma_f32_32x32x16_bf16 v[32:47], v[96:99], v[8:11], 0
s_waitcnt lgkmcnt(2)
ds_read_b128 v[24:27], v68 offset:0
v_mfma_f32_32x32x16_bf16 v[32:47], v[100:103], v[12:15], v[32:47]
s_waitcnt lgkmcnt(2)
ds_read_b128 v[8:11], v69 offset:0
s_add_u32 m0, s45, 0
s_nop 0
buffer_load_dwordx4 v72, s[36:39], s46 offen lds
s_add_u32 m0, s45, 1024
s_nop 0
buffer_load_dwordx4 v73, s[36:39], s46 offen lds
v_mfma_f32_32x32x16_bf16 v[32:47], v[104:107], v[16:19], v[32:47]
s_waitcnt lgkmcnt(2)
ds_read_b128 v[12:15], v70 offset:0
s_add_u32 m0, s45, 2048
s_nop 0
buffer_load_dwordx4 v74, s[36:39], s46 offen lds
s_add_u32 m0, s45, 3072
s_nop 0
buffer_load_dwordx4 v75, s[36:39], s46 offen lds
v_mfma_f32_32x32x16_bf16 v[32:47], v[108:111], v[20:23], v[32:47]
s_waitcnt lgkmcnt(2)
ds_read_b128 v[16:19], v71 offset:0
s_add_u32 m0, s45, 4096
s_nop 0
buffer_load_dwordx4 v76, s[36:39], s46 offen lds
s_add_u32 m0, s45, 5120
s_nop 0
buffer_load_dwordx4 v77, s[36:39], s46 offen lds
v_mfma_f32_32x32x16_bf16 v[32:47], v[112:115], v[24:27], v[32:47]
s_waitcnt lgkmcnt(2)
ds_read_b128 v[20:23], v64 offset:256
s_add_u32 m0, s45, 6144
s_nop 0
buffer_load_dwordx4 v78, s[36:39], s46 offen lds
s_add_u32 m0, s45, 7168
s_nop 0
buffer_load_dwordx4 v79, s[36:39], s46 offen lds
v_mfma_f32_32x32x16_bf16 v[32:47], v[116:119], v[8:11], v[32:47]
s_waitcnt lgkmcnt(2)
ds_read_b128 v[24:27], v65 offset:256
s_add_u32 m0, s45, 8192
s_nop 0
buffer_load_dwordx4 v80, s[36:39], s46 offen lds
s_add_u32 m0, s45, 9216
s_nop 0
buffer_load_dwordx4 v81, s[36:39], s46 offen lds
v_mfma_f32_32x32x16_bf16 v[32:47], v[120:123], v[12:15], v[32:47]
s_waitcnt lgkmcnt(2)
ds_read_b128 v[8:11], v66 offset:256
s_add_u32 s45, s45, 40960
s_cmp_ge_u32 s45, 122880
s_cselect_b32 s55, 122880, 0
s_sub_u32 s45, s45, s55
s_add_u32 s47, s47, 1
s_cmp_lt_u32 s47, 4
s_cselect_b32 s55, 40960, 0
s_add_u32 s46, s46, s55
v_mfma_f32_32x32x16_bf16 v[32:47], v[124:127], v[16:19], v[32:47]
s_waitcnt lgkmcnt(2)
ds_read_b128 v[12:15], v67 offset:256
v_mfma_f32_32x32x16_bf16 v[32:47], v[128:131], v[20:23], v[32:47]
s_waitcnt lgkmcnt(2)
ds_read_b128 v[16:19], v68 offset:256
v_mfma_f32_32x32x16_bf16 v[32:47], v[132:135], v[24:27], v[32:47]
s_waitcnt lgkmcnt(2)
ds_read_b128 v[20:23], v69 offset:256
v_mfma_f32_32x32x16_bf16 v[32:47], v[136:139], v[8:11], v[32:47]
s_waitcnt lgkmcnt(2)
ds_read_b128 v[24:27], v70 offset:256
v_mfma_f32_32x32x16_bf16 v[32:47], v[140:143], v[12:15], v[32:47]
s_waitcnt lgkmcnt(2)
ds_read_b128 v[8:11], v71 offset:256
v_mfma_f32_32x32x16_bf16 v[32:47], v[144:147], v[16:19], v[32:47]
s_waitcnt lgkmcnt(2)
ds_read_b128 v[12:15], v64 offset:512
v_mfma_f32_32x32x16_bf16 v[32:47], v[148:151], v[20:23], v[32:47]
s_waitcnt lgkmcnt(2)
ds_read_b128 v[16:19], v65 offset:512
v_mfma_f32_32x32x16_bf16 v[32:47], v[152:155], v[24:27], v[32:47]
s_waitcnt lgkmcnt(2)
ds_read_b128 v[20:23], v66 offset:512
v_mfma_f32_32x32x16_bf16 v[32:47], v[156:159], v[8:11], v[32:47]
s_waitcnt lgkmcnt(2)
ds_read_b128 v[24:27], v67 offset:512
v_mfma_f32_32x32x16_bf16 v[32:47], v[160:163], v[12:15], v[32:47]
s_waitcnt lgkmcnt(2)
ds_read_b128 v[8:11], v68 offset:512
v_mfma_f32_32x32x16_bf16 v[32:47], v[164:167], v[16:19], v[32:47]
s_waitcnt lgkmcnt(2)
ds_read_b128 v[12:15], v69 offset:512
v_mfma_f32_32x32x16_bf16 v[32:47], v[168:171], v[20:23], v[32:47]
s_waitcnt lgkmcnt(2)
ds_read_b128 v[16:19], v70 offset:512
v_mfma_f32_32x32x16_bf16 v[32:47], v[172:175], v[24:27], v[32:47]
s_waitcnt lgkmcnt(2)
ds_read_b128 v[20:23], v71 offset:512
v_mfma_f32_32x32x16_bf16 v[32:47], v[176:179], v[8:11], v[32:47]
s_waitcnt lgkmcnt(2)
ds_read_b128 v[24:27], v64 offset:768
v_mfma_f32_32x32x16_bf16 v[32:47], v[180:183], v[12:15], v[32:47]
s_waitcnt lgkmcnt(2)
ds_read_b128 v[8:11], v65 offset:768
v_mfma_f32_32x32x16_bf16 v[32:47], v[184:187], v[16:19], v[32:47]
s_waitcnt lgkmcnt(2)
ds_read_b128 v[12:15], v66 offset:768
v_mfma_f32_32x32x16_bf16 v[32:47], v[188:191], v[20:23], v[32:47]
s_waitcnt lgkmcnt(2)
ds_read_b128 v[16:19], v67 offset:768
v_mfma_f32_32x32x16_bf16 v[32:47], v[192:195], v[24:27], v[32:47]
s_waitcnt lgkmcnt(2)
ds_read_b128 v[20:23], v68 offset:768
v_mfma_f32_32x32x16_bf16 v[32:47], v[196:199], v[8:11], v[32:47]
s_waitcnt lgkmcnt(2)
ds_read_b128 v[24:27], v69 offset:768
v_mfma_f32_32x32x16_bf16 v[32:47], v[200:203], v[12:15], v[32:47]
s_waitcnt lgkmcnt(2)
ds_read_b128 v[8:11], v70 offset:768
v_mfma_f32_32x32x16_bf16 v[32:47], v[204:207], v[16:19], v[32:47]
s_waitcnt lgkmcnt(2)
ds_read_b128 v[12:15], v71 offset:768
v_mfma_f32_32x32x16_bf16 v[32:47], v[208:211], v[20:23], v[32:47]
s_waitcnt lgkmcnt(2)
ds_read_b128 v[16:19], v64 offset:1024
v_mfma_f32_32x32x16_bf16 v[32:47], v[212:215], v[24:27], v[32:47]
s_waitcnt lgkmcnt(2)
ds_read_b128 v[20:23], v65 offset:1024
v_mfma_f32_32x32x16_bf16 v[32:47], v[216:219], v[8:11], v[32:47]
s_waitcnt lgkmcnt(2)
ds_read_b128 v[24:27], v66 offset:1024
v_mfma_f32_32x32x16_bf16 v[32:47], v[220:223], v[12:15], v[32:47]
s_waitcnt lgkmcnt(2)
ds_read_b128 v[8:11], v67 offset:1024
v_mfma_f32_32x32x16_bf16 v[32:47], v[224:227], v[16:19], v[32:47]
s_waitcnt lgkmcnt(2)
ds_read_b128 v[12:15], v68 offset:1024
v_mfma_f32_32x32x16_bf16 v[32:47], v[228:231], v[20:23], v[32:47]
s_waitcnt lgkmcnt(2)
ds_read_b128 v[16:19], v69 offset:1024
v_mfma_f32_32x32x16_bf16 v[32:47], v[232:235], v[24:27], v[32:47]
s_waitcnt lgkmcnt(2)
ds_read_b128 v[20:23], v70 offset:1024
v_mfma_f32_32x32x16_bf16 v[32:47], v[236:239], v[8:11], v[32:47]
s_waitcnt lgkmcnt(2)
ds_read_b128 v[24:27], v71 offset:1024
v_mfma_f32_32x32x16_bf16 v[32:47], v[240:243], v[12:15], v[32:47]
s_add_u32 s44, s44, 1
s_cmp_eq_u32 s44, 3
s_mov_b32 s56, 40960
s_cmov_b32 s56, -81920
s_cselect_b32 s44, 0, s44
v_add_u32 v64, s56, v64
v_add_u32 v65, s56, v65
v_add_u32 v66, s56, v66
v_add_u32 v67, s56, v67
v_add_u32 v68, s56, v68
v_add_u32 v69, s56, v69
v_add_u32 v70, s56, v70
v_add_u32 v71, s56, v71
s_waitcnt vmcnt(10) lgkmcnt(2)
s_barrier
ds_read_b128 v[8:11], v64 offset:0
v_mfma_f32_32x32x16_bf16 v[32:47], v[244:247], v[16:19], v[32:47]
s_waitcnt lgkmcnt(2)
ds_read_b128 v[12:15], v65 offset:0
v_mfma_f32_32x32x16_bf16 v[32:47], v[248:251], v[20:23], v[32:47]
s_waitcnt lgkmcnt(2)
ds_read_b128 v[16:19], v66 offset:0
v_mfma_f32_32x32x16_bf16 v[32:47], v[252:255], v[24:27], v[32:47]
s_waitcnt lgkmcnt(2)
ds_read_b128 v[20:23], v67 offset:0
k_st_92:
v_mfma_f32_32x32x16_bf16 v[48:63], v[96:99], v[8:11], 0
s_waitcnt lgkmcnt(2)
ds_read_b128 v[24:27], v68 offset:0
v_mfma_f32_32x32x16_bf16 v[48:63], v[100:103], v[12:15], v[48:63]
s_waitcnt lgkmcnt(2)
ds_read_b128 v[8:11], v69 offset:0
v_cvt_pk_bf16_f32 v32, v32, v33
v_cvt_pk_bf16_f32 v33, v34, v35
v_mfma_f32_32x32x16_bf16 v[48:63], v[104:107], v[16:19], v[48:63]
s_waitcnt lgkmcnt(2)
ds_read_b128 v[12:15], v70 offset:0
v_cvt_pk_bf16_f32 v34, v36, v37
v_cvt_pk_bf16_f32 v35, v38, v39
v_mfma_f32_32x32x16_bf16 v[48:63], v[108:111], v[20:23], v[48:63]
s_waitcnt lgkmcnt(2)
ds_read_b128 v[16:19], v71 offset:0
v_cvt_pk_bf16_f32 v36, v40, v41
v_cvt_pk_bf16_f32 v37, v42, v43
v_mfma_f32_32x32x16_bf16 v[48:63], v[112:115], v[24:27], v[48:63]
s_waitcnt lgkmcnt(2)
ds_read_b128 v[20:23], v64 offset:256
v_cvt_pk_bf16_f32 v38, v44, v45
v_cvt_pk_bf16_f32 v39, v46, v47
v_mfma_f32_32x32x16_bf16 v[48:63], v[116:119], v[8:11], v[48:63]
s_waitcnt lgkmcnt(2)
ds_read_b128 v[24:27], v65 offset:256
buffer_store_dwordx4 v[32:35], v0, s[4:7], s48 offen offset:0 sc1
buffer_store_dwordx4 v[36:39], v0, s[4:7], s48 offen offset:1024 sc1
v_mfma_f32_32x32x16_bf16 v[48:63], v[120:123], v[12:15], v[48:63]
s_waitcnt lgkmcnt(2)
ds_read_b128 v[8:11], v66 offset:256
s_add_u32 s48, s48, 40960
s_add_u32 m0, s45, 0
s_nop 0
buffer_load_dwordx4 v72, s[36:39], s46 offen lds
v_mfma_f32_32x32x16_bf16 v[48:63], v[124:127], v[16:19], v[48:63]
s_waitcnt lgkmcnt(2)
ds_read_b128 v[12:15], v67 offset:256
s_add_u32 m0, s45, 1024
s_nop 0
buffer_load_dwordx4 v73, s[36:39], s46 offen lds
s_add_u32 m0, s45, 2048
s_nop 0
buffer_load_dwordx4 v74, s[36:39], s46 offen lds
v_mfma_f32_32x32x16_bf16 v[48:63], v[128:131], v[20:23], v[48:63]
s_waitcnt lgkmcnt(2)
ds_read_b128 v[16:19], v68 offset:256
s_add_u32 m0, s45, 3072
s_nop 0
buffer_load_dwordx4 v75, s[36:39], s46 offen lds
s_add_u32 m0, s45, 4096
s_nop 0
buffer_load_dwordx4 v76, s[36:39], s46 offen lds
v_mfma_f32_32x32x16_bf16 v[48:63], v[132:135], v[24:27], v[48:63]
s_waitcnt lgkmcnt(2)
ds_read_b128 v[20:23], v69 offset:256
s_add_u32 m0, s45, 5120
s_nop 0
buffer_load_dwordx4 v77, s[36:39], s46 offen lds
s_add_u32 m0, s45, 6144
s_nop 0
buffer_load_dwordx4 v78, s[36:39], s46 offen lds
v_mfma_f32_32x32x16_bf16 v[48:63], v[136:139], v[8:11], v[48:63]
s_waitcnt lgkmcnt(2)
ds_read_b128 v[24:27], v70 offset:256
s_add_u32 m0, s45, 7168
s_nop 0
buffer_load_dwordx4 v79, s[36:39], s46 offen lds
s_add_u32 m0, s45, 8192
s_nop 0
buffer_load_dwordx4 v80, s[36:39], s46 offen lds
v_mfma_f32_32x32x16_bf16 v[48:63], v[140:143], v[12:15], v[48:63]
s_waitcnt lgkmcnt(2)
ds_read_b128 v[8:11], v71 offset:256
s_add_u32 m0, s45, 9216
s_nop 0
buffer_load_dwordx4 v81, s[36:39], s46 offen lds
s_add_u32 s45, s45, 40960
s_cmp_ge_u32 s45, 122880
s_cselect_b32 s55, 122880, 0
s_sub_u32 s45, s45, s55
v_mfma_f32_32x32x16_bf16 v[48:63], v[144:147], v[16:19], v[48:63]
s_waitcnt lgkmcnt(2)
ds_read_b128 v[12:15], v64 offset:512
s_add_u32 s47, s47, 1
s_cmp_lt_u32 s47, 4
s_cselect_b32 s55, 40960, 0
s_add_u32 s46, s46, s55
v_mfma_f32_32x32x16_bf16 v[48:63], v[148:151], v[20:23], v[48:63]
s_waitcnt lgkmcnt(2)
ds_read_b128 v[16:19], v65 offset:512
v_mfma_f32_32x32x16_bf16 v[48:63], v[152:155], v[24:27], v[48:63]
s_waitcnt lgkmcnt(2)
ds_read_b128 v[20:23], v66 offset:512
v_mfma_f32_32x32x16_bf16 v[48:63], v[156:159], v[8:11], v[48:63]
s_waitcnt lgkmcnt(2)
ds_read_b128 v[24:27], v67 offset:512
v_mfma_f32_32x32x16_bf16 v[48:63], v[160:163], v[12:15], v[48:63]
s_waitcnt lgkmcnt(2)
ds_read_b128 v[8:11], v68 offset:512
v_mfma_f32_32x32x16_bf16 v[48:63], v[164:167], v[16:19], v[48:63]
s_waitcnt lgkmcnt(2)
ds_read_b128 v[12:15], v69 offset:512
v_mfma_f32_32x32x16_bf16 v[48:63], v[168:171], v[20:23], v[48:63]
s_waitcnt lgkmcnt(2)
ds_read_b128 v[16:19], v70 offset:512
v_mfma_f32_32x32x16_bf16 v[48:63], v[172:175], v[24:27], v[48:63]
s_waitcnt lgkmcnt(2)
ds_read_b128 v[20:23], v71 offset:512
v_mfma_f32_32x32x16_bf16 v[48:63], v[176:179], v[8:11], v[48:63]
s_waitcnt lgkmcnt(2)
ds_read_b128 v[24:27], v64 offset:768
v_mfma_f32_32x32x16_bf16 v[48:63], v[180:183], v[12:15], v[48:63]
s_waitcnt lgkmcnt(2)
ds_read_b128 v[8:11], v65 offset:768
v_mfma_f32_32x32x16_bf16 v[48:63], v[184:187], v[16:19], v[48:63]
s_waitcnt lgkmcnt(2)
ds_read_b128 v[12:15], v66 offset:768
v_mfma_f32_32x32x16_bf16 v[48:63], v[188:191], v[20:23], v[48:63]
s_waitcnt lgkmcnt(2)
ds_read_b128 v[16:19], v67 offset:768
v_mfma_f32_32x32x16_bf16 v[48:63], v[192:195], v[24:27], v[48:63]
s_waitcnt lgkmcnt(2)
ds_read_b128 v[20:23], v68 offset:768
v_mfma_f32_32x32x16_bf16 v[48:63], v[196:199], v[8:11], v[48:63]
s_waitcnt lgkmcnt(2)
ds_read_b128 v[24:27], v69 offset:768
v_mfma_f32_32x32x16_bf16 v[48:63], v[200:203], v[12:15], v[48:63]
s_waitcnt lgkmcnt(2)
ds_read_b128 v[8:11], v70 offset:768
v_mfma_f32_32x32x16_bf16 v[48:63], v[204:207], v[16:19], v[48:63]
s_waitcnt lgkmcnt(2)
ds_read_b128 v[12:15], v71 offset:768
v_mfma_f32_32x32x16_bf16 v[48:63], v[208:211], v[20:23], v[48:63]
s_waitcnt lgkmcnt(2)
ds_read_b128 v[16:19], v64 offset:1024
v_mfma_f32_32x32x16_bf16 v[48:63], v[212:215], v[24:27], v[48:63]
s_waitcnt lgkmcnt(2)
ds_read_b128 v[20:23], v65 offset:1024
v_mfma_f32_32x32x16_bf16 v[48:63], v[216:219], v[8:11], v[48:63]
s_waitcnt lgkmcnt(2)
ds_read_b128 v[24:27], v66 offset:1024
v_mfma_f32_32x32x16_bf16 v[48:63], v[220:223], v[12:15], v[48:63]
s_waitcnt lgkmcnt(2)
ds_read_b128 v[8:11], v67 offset:1024
v_mfma_f32_32x32x16_bf16 v[48:63], v[224:227], v[16:19], v[48:63]
s_waitcnt lgkmcnt(2)
ds_read_b128 v[12:15], v68 offset:1024
v_mfma_f32_32x32x16_bf16 v[48:63], v[228:231], v[20:23], v[48:63]
s_waitcnt lgkmcnt(2)
ds_read_b128 v[16:19], v69 offset:1024
v_mfma_f32_32x32x16_bf16 v[48:63], v[232:235], v[24:27], v[48:63]
s_waitcnt lgkmcnt(2)
ds_read_b128 v[20:23], v70 offset:1024
v_mfma_f32_32x32x16_bf16 v[48:63], v[236:239], v[8:11], v[48:63]
s_waitcnt lgkmcnt(2)
ds_read_b128 v[24:27], v71 offset:1024
v_mfma_f32_32x32x16_bf16 v[48:63], v[240:243], v[12:15], v[48:63]
s_add_u32 s44, s44, 1
s_cmp_eq_u32 s44, 3
s_mov_b32 s56, 40960
s_cmov_b32 s56, -81920
s_cselect_b32 s44, 0, s44
v_add_u32 v64, s56, v64
v_add_u32 v65, s56, v65
v_add_u32 v66, s56, v66
v_add_u32 v67, s56, v67
v_add_u32 v68, s56, v68
v_add_u32 v69, s56, v69
v_add_u32 v70, s56, v70
v_add_u32 v71, s56, v71
s_waitcnt vmcnt(10) lgkmcnt(2)
s_barrier
ds_read_b128 v[8:11], v64 offset:0
v_mfma_f32_32x32x16_bf16 v[48:63], v[244:247], v[16:19], v[48:63]
s_waitcnt lgkmcnt(2)
ds_read_b128 v[12:15], v65 offset:0
v_mfma_f32_32x32x16_bf16 v[48:63], v[248:251], v[20:23], v[48:63]
s_waitcnt lgkmcnt(2)
ds_read_b128 v[16:19], v66 offset:0
v_mfma_f32_32x32x16_bf16 v[48:63], v[252:255], v[24:27], v[48:63]
s_waitcnt lgkmcnt(2)
ds_read_b128 v[20:23], v67 offset:0
s_sub_u32 s59, s59, 1
s_cmp_eq_u32 s59, 0
s_cbranch_scc1 k_so_93
v_mfma_f32_32x32x16_bf16 v[32:47], v[96:99], v[8:11], 0
s_waitcnt lgkmcnt(2)
ds_read_b128 v[24:27], v68 offset:0
v_mfma_f32_32x32x16_bf16 v[32:47], v[100:103], v[12:15], v[32:47]
s_waitcnt lgkmcnt(2)
ds_read_b128 v[8:11], v69 offset:0
v_cvt_pk_bf16_f32 v48, v48, v49
v_cvt_pk_bf16_f32 v49, v50, v51
v_mfma_f32_32x32x16_bf16 v[32:47], v[104:107], v[16:19], v[32:47]
s_waitcnt lgkmcnt(2)
ds_read_b128 v[12:15], v70 offset:0
v_cvt_pk_bf16_f32 v50, v52, v53
v_cvt_pk_bf16_f32 v51, v54, v55
v_mfma_f32_32x32x16_bf16 v[32:47], v[108:111], v[20:23], v[32:47]
s_waitcnt lgkmcnt(2)
ds_read_b128 v[16:19], v71 offset:0
v_cvt_pk_bf16_f32 v52, v56, v57
v_cvt_pk_bf16_f32 v53, v58, v59
v_mfma_f32_32x32x16_bf16 v[32:47], v[112:115], v[24:27], v[32:47]
s_waitcnt lgkmcnt(2)
ds_read_b128 v[20:23], v64 offset:256
v_cvt_pk_bf16_f32 v54, v60, v61
v_cvt_pk_bf16_f32 v55, v62, v63
v_mfma_f32_32x32x16_bf16 v[32:47], v[116:119], v[8:11], v[32:47]
s_waitcnt lgkmcnt(2)
ds_read_b128 v[24:27], v65 offset:256
buffer_store_dwordx4 v[48:51], v0, s[4:7], s48 offen offset:0 sc1
buffer_store_dwordx4 v[52:55], v0, s[4:7], s48 offen offset:1024 sc1
v_mfma_f32_32x32x16_bf16 v[32:47], v[120:123], v[12:15], v[32:47]
s_waitcnt lgkmcnt(2)
ds_read_b128 v[8:11], v66 offset:256
s_add_u32 s48, s48, 40960
s_add_u32 m0, s45, 0
s_nop 0
buffer_load_dwordx4 v72, s[36:39], s46 offen lds
v_mfma_f32_32x32x16_bf16 v[32:47], v[124:127], v[16:19], v[32:47]
s_waitcnt lgkmcnt(2)
ds_read_b128 v[12:15], v67 offset:256
s_add_u32 m0, s45, 1024
s_nop 0
buffer_load_dwordx4 v73, s[36:39], s46 offen lds
s_add_u32 m0, s45, 2048
s_nop 0
buffer_load_dwordx4 v74, s[36:39], s46 offen lds
v_mfma_f32_32x32x16_bf16 v[32:47], v[128:131], v[20:23], v[32:47]
s_waitcnt lgkmcnt(2)
ds_read_b128 v[16:19], v68 offset:256
s_add_u32 m0, s45, 3072
s_nop 0
buffer_load_dwordx4 v75, s[36:39], s46 offen lds
s_add_u32 m0, s45, 4096
s_nop 0
buffer_load_dwordx4 v76, s[36:39], s46 offen lds
v_mfma_f32_32x32x16_bf16 v[32:47], v[132:135], v[24:27], v[32:47]
s_waitcnt lgkmcnt(2)
ds_read_b128 v[20:23], v69 offset:256
s_add_u32 m0, s45, 5120
s_nop 0
buffer_load_dwordx4 v77, s[36:39], s46 offen lds
s_add_u32 m0, s45, 6144
s_nop 0
buffer_load_dwordx4 v78, s[36:39], s46 offen lds
v_mfma_f32_32x32x16_bf16 v[32:47], v[136:139], v[8:11], v[32:47]
s_waitcnt lgkmcnt(2)
ds_read_b128 v[24:27], v70 offset:256
s_add_u32 m0, s45, 7168
s_nop 0
buffer_load_dwordx4 v79, s[36:39], s46 offen lds
s_add_u32 m0, s45, 8192
s_nop 0
buffer_load_dwordx4 v80, s[36:39], s46 offen lds
v_mfma_f32_32x32x16_bf16 v[32:47], v[140:143], v[12:15], v[32:47]
s_waitcnt lgkmcnt(2)
ds_read_b128 v[8:11], v71 offset:256
s_add_u32 m0, s45, 9216
s_nop 0
buffer_load_dwordx4 v81, s[36:39], s46 offen lds
s_add_u32 s45, s45, 40960
s_cmp_ge_u32 s45, 122880
s_cselect_b32 s55, 122880, 0
s_sub_u32 s45, s45, s55
v_mfma_f32_32x32x16_bf16 v[32:47], v[144:147], v[16:19], v[32:47]
s_waitcnt lgkmcnt(2)
ds_read_b128 v[12:15], v64 offset:512
s_add_u32 s47, s47, 1
s_cmp_lt_u32 s47, 4
s_cselect_b32 s55, 40960, 0
s_add_u32 s46, s46, s55
v_mfma_f32_32x32x16_bf16 v[32:47], v[148:151], v[20:23], v[32:47]
s_waitcnt lgkmcnt(2)
ds_read_b128 v[16:19], v65 offset:512
v_mfma_f32_32x32x16_bf16 v[32:47], v[152:155], v[24:27], v[32:47]
s_waitcnt lgkmcnt(2)
ds_read_b128 v[20:23], v66 offset:512
v_mfma_f32_32x32x16_bf16 v[32:47], v[156:159], v[8:11], v[32:47]
s_waitcnt lgkmcnt(2)
ds_read_b128 v[24:27], v67 offset:512
v_mfma_f32_32x32x16_bf16 v[32:47], v[160:163], v[12:15], v[32:47]
s_waitcnt lgkmcnt(2)
ds_read_b128 v[8:11], v68 offset:512
v_mfma_f32_32x32x16_bf16 v[32:47], v[164:167], v[16:19], v[32:47]
s_waitcnt lgkmcnt(2)
ds_read_b128 v[12:15], v69 offset:512
v_mfma_f32_32x32x16_bf16 v[32:47], v[168:171], v[20:23], v[32:47]
s_waitcnt lgkmcnt(2)
ds_read_b128 v[16:19], v70 offset:512
v_mfma_f32_32x32x16_bf16 v[32:47], v[172:175], v[24:27], v[32:47]
s_waitcnt lgkmcnt(2)
ds_read_b128 v[20:23], v71 offset:512
v_mfma_f32_32x32x16_bf16 v[32:47], v[176:179], v[8:11], v[32:47]
s_waitcnt lgkmcnt(2)
ds_read_b128 v[24:27], v64 offset:768
v_mfma_f32_32x32x16_bf16 v[32:47], v[180:183], v[12:15], v[32:47]
s_waitcnt lgkmcnt(2)
ds_read_b128 v[8:11], v65 offset:768
v_mfma_f32_32x32x16_bf16 v[32:47], v[184:187], v[16:19], v[32:47]
s_waitcnt lgkmcnt(2)
ds_read_b128 v[12:15], v66 offset:768
v_mfma_f32_32x32x16_bf16 v[32:47], v[188:191], v[20:23], v[32:47]
s_waitcnt lgkmcnt(2)
ds_read_b128 v[16:19], v67 offset:768
v_mfma_f32_32x32x16_bf16 v[32:47], v[192:195], v[24:27], v[32:47]
s_waitcnt lgkmcnt(2)
ds_read_b128 v[20:23], v68 offset:768
v_mfma_f32_32x32x16_bf16 v[32:47], v[196:199], v[8:11], v[32:47]
s_waitcnt lgkmcnt(2)
ds_read_b128 v[24:27], v69 offset:768
v_mfma_f32_32x32x16_bf16 v[32:47], v[200:203], v[12:15], v[32:47]
s_waitcnt lgkmcnt(2)
ds_read_b128 v[8:11], v70 offset:768
v_mfma_f32_32x32x16_bf16 v[32:47], v[204:207], v[16:19], v[32:47]
s_waitcnt lgkmcnt(2)
ds_read_b128 v[12:15], v71 offset:768
v_mfma_f32_32x32x16_bf16 v[32:47], v[208:211], v[20:23], v[32:47]
s_waitcnt lgkmcnt(2)
ds_read_b128 v[16:19], v64 offset:1024
v_mfma_f32_32x32x16_bf16 v[32:47], v[212:215], v[24:27], v[32:47]
s_waitcnt lgkmcnt(2)
ds_read_b128 v[20:23], v65 offset:1024
v_mfma_f32_32x32x16_bf16 v[32:47], v[216:219], v[8:11], v[32:47]
s_waitcnt lgkmcnt(2)
ds_read_b128 v[24:27], v66 offset:1024
v_mfma_f32_32x32x16_bf16 v[32:47], v[220:223], v[12:15], v[32:47]
s_waitcnt lgkmcnt(2)
ds_read_b128 v[8:11], v67 offset:1024
v_mfma_f32_32x32x16_bf16 v[32:47], v[224:227], v[16:19], v[32:47]
s_waitcnt lgkmcnt(2)
ds_read_b128 v[12:15], v68 offset:1024
v_mfma_f32_32x32x16_bf16 v[32:47], v[228:231], v[20:23], v[32:47]
s_waitcnt lgkmcnt(2)
ds_read_b128 v[16:19], v69 offset:1024
v_mfma_f32_32x32x16_bf16 v[32:47], v[232:235], v[24:27], v[32:47]
s_waitcnt lgkmcnt(2)
ds_read_b128 v[20:23], v70 offset:1024
v_mfma_f32_32x32x16_bf16 v[32:47], v[236:239], v[8:11], v[32:47]
s_waitcnt lgkmcnt(2)
ds_read_b128 v[24:27], v71 offset:1024
v_mfma_f32_32x32x16_bf16 v[32:47], v[240:243], v[12:15], v[32:47]
s_add_u32 s44, s44, 1
s_cmp_eq_u32 s44, 3
s_mov_b32 s56, 40960
s_cmov_b32 s56, -81920
s_cselect_b32 s44, 0, s44
v_add_u32 v64, s56, v64
v_add_u32 v65, s56, v65
v_add_u32 v66, s56, v66
v_add_u32 v67, s56, v67
v_add_u32 v68, s56, v68
v_add_u32 v69, s56, v69
v_add_u32 v70, s56, v70
v_add_u32 v71, s56, v71
s_waitcnt vmcnt(10) lgkmcnt(2)
s_barrier
ds_read_b128 v[8:11], v64 offset:0
v_mfma_f32_32x32x16_bf16 v[32:47], v[244:247], v[16:19], v[32:47]
s_waitcnt lgkmcnt(2)
ds_read_b128 v[12:15], v65 offset:0
v_mfma_f32_32x32x16_bf16 v[32:47], v[248:251], v[20:23], v[32:47]
s_waitcnt lgkmcnt(2)
ds_read_b128 v[16:19], v66 offset:0
v_mfma_f32_32x32x16_bf16 v[32:47], v[252:255], v[24:27], v[32:47]
s_waitcnt lgkmcnt(2)
ds_read_b128 v[20:23], v67 offset:0
s_branch k_st_92
k_so_93:
s_nop 6
v_cvt_pk_bf16_f32 v48, v48, v49
v_cvt_pk_bf16_f32 v49, v50, v51
v_cvt_pk_bf16_f32 v50, v52, v53
v_cvt_pk_bf16_f32 v51, v54, v55
v_cvt_pk_bf16_f32 v52, v56, v57
v_cvt_pk_bf16_f32 v53, v58, v59
v_cvt_pk_bf16_f32 v54, v60, v61
v_cvt_pk_bf16_f32 v55, v62, v63
buffer_store_dwordx4 v[48:51], v0, s[4:7], s48 offen offset:0 sc1
buffer_store_dwordx4 v[52:55], v0, s[4:7], s48 offen offset:1024 sc1
s_add_u32 s48, s48, 40960
s_lshl_b32 s54, s30, 6
s_add_u32 s54, s54, 222298112
s_waitcnt lgkmcnt(0)
s_waitcnt vmcnt(0)
s_barrier
s_cmp_lg_u32 s3, 0
s_cbranch_scc1 k_s8_94
s_mov_b64 exec, 1
v_mov_b32 v2, 1
buffer_store_dword v2, off, s[4:7], s54 sc1
s_mov_b64 exec, -1
k_s8_94:
s_mul_i32 s52, s3, 640
v_lshrrev_b32 v8, 4, v0
v_add_u32 v8, s52, v8
s_mov_b32 s53, 52429
v_add_u32 v9, 0, v8
v_mul_u32_u24 v10, s53, v9
v_lshrrev_b32 v10, 22, v10
v_mul_u32_u24 v11, 80, v10
v_sub_u32 v9, v9, v11
v_and_b32 v11, 15, v10
v_xor_b32 v9, v9, v11
v_and_b32 v11, 1, v10
v_bfe_u32 v12, v10, 1, 1
v_lshl_add_u32 v11, v12, 4, v11
v_bfe_u32 v12, v10, 2, 1
v_lshl_add_u32 v11, v12, 6, v11
v_bfe_u32 v12, v10, 3, 1
v_lshl_add_u32 v11, v12, 1, v11
v_bfe_u32 v12, v10, 4, 1
v_lshl_add_u32 v10, v12, 3, v11
v_mul_u32_u24 v10, 1280, v10
v_lshl_add_u32 v72, v9, 4, v10
v_add_u32 v9, 64, v8
v_mul_u32_u24 v10, s53, v9
v_lshrrev_b32 v10, 22, v10
v_mul_u32_u24 v11, 80, v10
v_sub_u32 v9, v9, v11
v_and_b32 v11, 15, v10
v_xor_b32 v9, v9, v11
v_and_b32 v11, 1, v10
v_bfe_u32 v12, v10, 1, 1
v_lshl_add_u32 v11, v12, 4, v11
v_bfe_u32 v12, v10, 2, 1
v_lshl_add_u32 v11, v12, 6, v11
v_bfe_u32 v12, v10, 3, 1
v_lshl_add_u32 v11, v12, 1, v11
v_bfe_u32 v12, v10, 4, 1
v_lshl_add_u32 v10, v12, 3, v11
v_mul_u32_u24 v10, 1280, v10
v_lshl_add_u32 v73, v9, 4, v10
v_add_u32 v9, 128, v8
v_mul_u32_u24 v10, s53, v9
v_lshrrev_b32 v10, 22, v10
v_mul_u32_u24 v11, 80, v10
v_sub_u32 v9, v9, v11
v_and_b32 v11, 15, v10
v_xor_b32 v9, v9, v11
v_and_b32 v11, 1, v10
v_bfe_u32 v12, v10, 1, 1
v_lshl_add_u32 v11, v12, 4, v11
v_bfe_u32 v12, v10, 2, 1
v_lshl_add_u32 v11, v12, 6, v11
v_bfe_u32 v12, v10, 3, 1
v_lshl_add_u32 v11, v12, 1, v11
v_bfe_u32 v12, v10, 4, 1
v_lshl_add_u32 v10, v12, 3, v11
v_mul_u32_u24 v10, 1280, v10
v_lshl_add_u32 v74, v9, 4, v10
v_add_u32 v9, 192, v8
v_mul_u32_u24 v10, s53, v9
v_lshrrev_b32 v10, 22, v10
v_mul_u32_u24 v11, 80, v10
v_sub_u32 v9, v9, v11
v_and_b32 v11, 15, v10
v_xor_b32 v9, v9, v11
v_and_b32 v11, 1, v10
v_bfe_u32 v12, v10, 1, 1
v_lshl_add_u32 v11, v12, 4, v11
v_bfe_u32 v12, v10, 2, 1
v_lshl_add_u32 v11, v12, 6, v11
v_bfe_u32 v12, v10, 3, 1
v_lshl_add_u32 v11, v12, 1, v11
v_bfe_u32 v12, v10, 4, 1
v_lshl_add_u32 v10, v12, 3, v11
v_mul_u32_u24 v10, 1280, v10
v_lshl_add_u32 v75, v9, 4, v10
v_add_u32 v9, 256, v8
v_mul_u32_u24 v10, s53, v9
v_lshrrev_b32 v10, 22, v10
v_mul_u32_u24 v11, 80, v10
v_sub_u32 v9, v9, v11
v_and_b32 v11, 15, v10
v_xor_b32 v9, v9, v11
v_and_b32 v11, 1, v10
v_bfe_u32 v12, v10, 1, 1
v_lshl_add_u32 v11, v12, 4, v11
v_bfe_u32 v12, v10, 2, 1
v_lshl_add_u32 v11, v12, 6, v11
v_bfe_u32 v12, v10, 3, 1
v_lshl_add_u32 v11, v12, 1, v11
v_bfe_u32 v12, v10, 4, 1
v_lshl_add_u32 v10, v12, 3, v11
v_mul_u32_u24 v10, 1280, v10
v_lshl_add_u32 v76, v9, 4, v10
v_add_u32 v9, 320, v8
v_mul_u32_u24 v10, s53, v9
v_lshrrev_b32 v10, 22, v10
v_mul_u32_u24 v11, 80, v10
v_sub_u32 v9, v9, v11
v_and_b32 v11, 15, v10
v_xor_b32 v9, v9, v11
v_and_b32 v11, 1, v10
v_bfe_u32 v12, v10, 1, 1
v_lshl_add_u32 v11, v12, 4, v11
v_bfe_u32 v12, v10, 2, 1
v_lshl_add_u32 v11, v12, 6, v11
v_bfe_u32 v12, v10, 3, 1
v_lshl_add_u32 v11, v12, 1, v11
v_bfe_u32 v12, v10, 4, 1
v_lshl_add_u32 v10, v12, 3, v11
v_mul_u32_u24 v10, 1280, v10
v_lshl_add_u32 v77, v9, 4, v10
v_add_u32 v9, 384, v8
v_mul_u32_u24 v10, s53, v9
v_lshrrev_b32 v10, 22, v10
v_mul_u32_u24 v11, 80, v10
v_sub_u32 v9, v9, v11
v_and_b32 v11, 15, v10
v_xor_b32 v9, v9, v11
v_and_b32 v11, 1, v10
v_bfe_u32 v12, v10, 1, 1
v_lshl_add_u32 v11, v12, 4, v11
v_bfe_u32 v12, v10, 2, 1
v_lshl_add_u32 v11, v12, 6, v11
v_bfe_u32 v12, v10, 3, 1
v_lshl_add_u32 v11, v12, 1, v11
v_bfe_u32 v12, v10, 4, 1
v_lshl_add_u32 v10, v12, 3, v11
v_mul_u32_u24 v10, 1280, v10
v_lshl_add_u32 v78, v9, 4, v10
v_add_u32 v9, 448, v8
v_mul_u32_u24 v10, s53, v9
v_lshrrev_b32 v10, 22, v10
v_mul_u32_u24 v11, 80, v10
v_sub_u32 v9, v9, v11
v_and_b32 v11, 15, v10
v_xor_b32 v9, v9, v11
v_and_b32 v11, 1, v10
v_bfe_u32 v12, v10, 1, 1
v_lshl_add_u32 v11, v12, 4, v11
v_bfe_u32 v12, v10, 2, 1
v_lshl_add_u32 v11, v12, 6, v11
v_bfe_u32 v12, v10, 3, 1
v_lshl_add_u32 v11, v12, 1, v11
v_bfe_u32 v12, v10, 4, 1
v_lshl_add_u32 v10, v12, 3, v11
v_mul_u32_u24 v10, 1280, v10
v_lshl_add_u32 v79, v9, 4, v10
v_add_u32 v9, 512, v8
v_mul_u32_u24 v10, s53, v9
v_lshrrev_b32 v10, 22, v10
v_mul_u32_u24 v11, 80, v10
v_sub_u32 v9, v9, v11
v_and_b32 v11, 15, v10
v_xor_b32 v9, v9, v11
v_and_b32 v11, 1, v10
v_bfe_u32 v12, v10, 1, 1
v_lshl_add_u32 v11, v12, 4, v11
v_bfe_u32 v12, v10, 2, 1
v_lshl_add_u32 v11, v12, 6, v11
v_bfe_u32 v12, v10, 3, 1
v_lshl_add_u32 v11, v12, 1, v11
v_bfe_u32 v12, v10, 4, 1
v_lshl_add_u32 v10, v12, 3, v11
v_mul_u32_u24 v10, 1280, v10
v_lshl_add_u32 v80, v9, 4, v10
v_add_u32 v9, 576, v8
v_mul_u32_u24 v10, s53, v9
v_lshrrev_b32 v10, 22, v10
v_mul_u32_u24 v11, 80, v10
v_sub_u32 v9, v9, v11
v_and_b32 v11, 15, v10
v_xor_b32 v9, v9, v11
v_and_b32 v11, 1, v10
v_bfe_u32 v12, v10, 1, 1
v_lshl_add_u32 v11, v12, 4, v11
v_bfe_u32 v12, v10, 2, 1
v_lshl_add_u32 v11, v12, 6, v11
v_bfe_u32 v12, v10, 3, 1
v_lshl_add_u32 v11, v12, 1, v11
v_bfe_u32 v12, v10, 4, 1
v_lshl_add_u32 v10, v12, 3, v11
v_mul_u32_u24 v10, 1280, v10
v_lshl_add_u32 v81, v9, 4, v10
s_mul_i32 s49, s57, 327680
s_mov_b32 s46, s49
s_mov_b32 s47, 0
s_lshl_b32 s48, s58, 18
s_lshl_b32 s52, s57, 14
s_add_u32 s48, s48, s52
s_add_u32 s48, s48, 216006656
s_mov_b32 s50, 512
v_bfe_u32 v2, v0, 6, 1
v_bfe_u32 v3, v0, 7, 1
v_and_b32 v1, 0x30, v0
v_lshl_add_u32 v1, v2, 7, v1
v_lshl_add_u32 v1, v3, 6, v1
v_bfe_u32 v2, v0, 8, 1
v_lshl_add_u32 v1, v2, 11, v1
v_bfe_u32 v2, v0, 9, 1
v_lshl_add_u32 v1, v2, 8, v1
s_mul_i32 s45, s3, 10240
s_mov_b32 s44, 0
v_bfe_u32 v8, v0, 4, 5
v_mul_u32_u24 v9, 1280, v8
v_and_b32 v8, 15, v8
v_lshrrev_b32 v10, 9, v0
v_xor_b32 v8, v8, v10
v_xor_b32 v10, 0, v8
v_lshl_add_u32 v64, v10, 4, v9
v_xor_b32 v10, 2, v8
v_lshl_add_u32 v65, v10, 4, v9
v_xor_b32 v10, 4, v8
v_lshl_add_u32 v66, v10, 4, v9
v_xor_b32 v10, 6, v8
v_lshl_add_u32 v67, v10, 4, v9
v_xor_b32 v10, 8, v8
v_lshl_add_u32 v68, v10, 4, v9
v_xor_b32 v10, 10, v8
v_lshl_add_u32 v69, v10, 4, v9
v_xor_b32 v10, 12, v8
v_lshl_add_u32 v70, v10, 4, v9
v_xor_b32 v10, 14, v8
v_lshl_add_u32 v71, v10, 4, v9
s_add_u32 m0, s45, 0
s_nop 0
buffer_load_dwordx4 v72, s[20:23], s46 offen lds
s_add_u32 m0, s45, 1024
s_nop 0
buffer_load_dwordx4 v73, s[20:23], s46 offen lds
s_add_u32 m0, s45, 2048
s_nop 0
buffer_load_dwordx4 v74, s[20:23], s46 offen lds
s_add_u32 m0, s45, 3072
s_nop 0
buffer_load_dwordx4 v75, s[20:23], s46 offen lds
s_add_u32 m0, s45, 4096
s_nop 0
buffer_load_dwordx4 v76, s[20:23], s46 offen lds
s_add_u32 m0, s45, 5120
s_nop 0
buffer_load_dwordx4 v77, s[20:23], s46 offen lds
s_add_u32 m0, s45, 6144
s_nop 0
buffer_load_dwordx4 v78, s[20:23], s46 offen lds
s_add_u32 m0, s45, 7168
s_nop 0
buffer_load_dwordx4 v79, s[20:23], s46 offen lds
s_add_u32 m0, s45, 8192
s_nop 0
buffer_load_dwordx4 v80, s[20:23], s46 offen lds
s_add_u32 m0, s45, 9216
s_nop 0
buffer_load_dwordx4 v81, s[20:23], s46 offen lds
s_add_u32 s45, s45, 40960
s_cmp_ge_u32 s45, 122880
s_cselect_b32 s55, 122880, 0
s_sub_u32 s45, s45, s55
s_add_u32 s47, s47, 1
s_and_b32 s55, s47, 1
s_mul_i32 s46, s55, 5120
s_and_b32 s55, s47, 2
s_mul_i32 s55, s55, 20480
s_add_u32 s46, s46, s55
s_and_b32 s55, s47, 4
s_mul_i32 s55, s55, 40960
s_add_u32 s46, s46, s55
s_add_u32 s46, s46, s49
s_add_u32 m0, s45, 0
s_nop 0
buffer_load_dwordx4 v72, s[20:23], s46 offen lds
s_add_u32 m0, s45, 1024
s_nop 0
buffer_load_dwordx4 v73, s[20:23], s46 offen lds
s_add_u32 m0, s45, 2048
s_nop 0
buffer_load_dwordx4 v74, s[20:23], s46 offen lds
s_add_u32 m0, s45, 3072
s_nop 0
buffer_load_dwordx4 v75, s[20:23], s46 offen lds
s_add_u32 m0, s45, 4096
s_nop 0
buffer_load_dwordx4 v76, s[20:23], s46 offen lds
s_add_u32 m0, s45, 5120
s_nop 0
buffer_load_dwordx4 v77, s[20:23], s46 offen lds
s_add_u32 m0, s45, 6144
s_nop 0
buffer_load_dwordx4 v78, s[20:23], s46 offen lds
s_add_u32 m0, s45, 7168
s_nop 0
buffer_load_dwordx4 v79, s[20:23], s46 offen lds
s_add_u32 m0, s45, 8192
s_nop 0
buffer_load_dwordx4 v80, s[20:23], s46 offen lds
s_add_u32 m0, s45, 9216
s_nop 0
buffer_load_dwordx4 v81, s[20:23], s46 offen lds
s_add_u32 s45, s45, 40960
s_cmp_ge_u32 s45, 122880
s_cselect_b32 s55, 122880, 0
s_sub_u32 s45, s45, s55
s_add_u32 s47, s47, 1
s_and_b32 s55, s47, 1
s_mul_i32 s46, s55, 5120
s_and_b32 s55, s47, 2
s_mul_i32 s55, s55, 20480
s_add_u32 s46, s46, s55
s_and_b32 s55, s47, 4
s_mul_i32 s55, s55, 40960
s_add_u32 s46, s46, s55
s_add_u32 s46, s46, s49
s_waitcnt vmcnt(10)
s_barrier
ds_read_b128 v[8:11], v64 offset:0
ds_read_b128 v[12:15], v65 offset:0
ds_read_b128 v[16:19], v66 offset:0
ds_read_b128 v[20:23], v67 offset:0
s_mov_b32 s59, 4
s_waitcnt lgkmcnt(3)
v_mfma_f32_32x32x16_bf16 v[32:47], v[8:11], v[96:99], 0
s_waitcnt lgkmcnt(2)
ds_read_b128 v[24:27], v68 offset:0
v_mfma_f32_32x32x16_bf16 v[32:47], v[12:15], v[100:103], v[32:47]
s_waitcnt lgkmcnt(2)
ds_read_b128 v[8:11], v69 offset:0
s_add_u32 m0, s45, 0
s_nop 0
buffer_load_dwordx4 v72, s[20:23], s46 offen lds
s_add_u32 m0, s45, 1024
s_nop 0
buffer_load_dwordx4 v73, s[20:23], s46 offen lds
v_mfma_f32_32x32x16_bf16 v[32:47], v[16:19], v[104:107], v[32:47]
s_waitcnt lgkmcnt(2)
ds_read_b128 v[12:15], v70 offset:0
s_add_u32 m0, s45, 2048
s_nop 0
buffer_load_dwordx4 v74, s[20:23], s46 offen lds
s_add_u32 m0, s45, 3072
s_nop 0
buffer_load_dwordx4 v75, s[20:23], s46 offen lds
v_mfma_f32_32x32x16_bf16 v[32:47], v[20:23], v[108:111], v[32:47]
s_waitcnt lgkmcnt(2)
ds_read_b128 v[16:19], v71 offset:0
s_add_u32 m0, s45, 4096
s_nop 0
buffer_load_dwordx4 v76, s[20:23], s46 offen lds
s_add_u32 m0, s45, 5120
s_nop 0
buffer_load_dwordx4 v77, s[20:23], s46 offen lds
v_mfma_f32_32x32x16_bf16 v[32:47], v[24:27], v[112:115], v[32:47]
s_waitcnt lgkmcnt(2)
ds_read_b128 v[20:23], v64 offset:256
s_add_u32 m0, s45, 6144
s_nop 0
buffer_load_dwordx4 v78, s[20:23], s46 offen lds
s_add_u32 m0, s45, 7168
s_nop 0
buffer_load_dwordx4 v79, s[20:23], s46 offen lds
v_mfma_f32_32x32x16_bf16 v[32:47], v[8:11], v[116:119], v[32:47]
s_waitcnt lgkmcnt(2)
ds_read_b128 v[24:27], v65 offset:256
s_add_u32 m0, s45, 8192
s_nop 0
buffer_load_dwordx4 v80, s[20:23], s46 offen lds
s_add_u32 m0, s45, 9216
s_nop 0
buffer_load_dwordx4 v81, s[20:23], s46 offen lds
v_mfma_f32_32x32x16_bf16 v[32:47], v[12:15], v[120:123], v[32:47]
s_waitcnt lgkmcnt(2)
ds_read_b128 v[8:11], v66 offset:256
s_add_u32 s45, s45, 40960
s_cmp_ge_u32 s45, 122880
s_cselect_b32 s55, 122880, 0
s_sub_u32 s45, s45, s55
s_add_u32 s47, s47, 1
s_and_b32 s55, s47, 1
s_mul_i32 s46, s55, 5120
s_and_b32 s55, s47, 2
s_mul_i32 s55, s55, 20480
s_add_u32 s46, s46, s55
s_and_b32 s55, s47, 4
s_mul_i32 s55, s55, 40960
s_add_u32 s46, s46, s55
s_add_u32 s46, s46, s49
v_mfma_f32_32x32x16_bf16 v[32:47], v[16:19], v[124:127], v[32:47]
s_waitcnt lgkmcnt(2)
ds_read_b128 v[12:15], v67 offset:256
v_mfma_f32_32x32x16_bf16 v[32:47], v[20:23], v[128:131], v[32:47]
s_waitcnt lgkmcnt(2)
ds_read_b128 v[16:19], v68 offset:256
v_mfma_f32_32x32x16_bf16 v[32:47], v[24:27], v[132:135], v[32:47]
s_waitcnt lgkmcnt(2)
ds_read_b128 v[20:23], v69 offset:256
v_mfma_f32_32x32x16_bf16 v[32:47], v[8:11], v[136:139], v[32:47]
s_waitcnt lgkmcnt(2)
ds_read_b128 v[24:27], v70 offset:256
v_mfma_f32_32x32x16_bf16 v[32:47], v[12:15], v[140:143], v[32:47]
s_waitcnt lgkmcnt(2)
ds_read_b128 v[8:11], v71 offset:256
v_mfma_f32_32x32x16_bf16 v[32:47], v[16:19], v[144:147], v[32:47]
s_waitcnt lgkmcnt(2)
ds_read_b128 v[12:15], v64 offset:512
v_mfma_f32_32x32x16_bf16 v[32:47], v[20:23], v[148:151], v[32:47]
s_waitcnt lgkmcnt(2)
ds_read_b128 v[16:19], v65 offset:512
v_mfma_f32_32x32x16_bf16 v[32:47], v[24:27], v[152:155], v[32:47]
s_waitcnt lgkmcnt(2)
ds_read_b128 v[20:23], v66 offset:512
v_mfma_f32_32x32x16_bf16 v[32:47], v[8:11], v[156:159], v[32:47]
s_waitcnt lgkmcnt(2)
ds_read_b128 v[24:27], v67 offset:512
v_mfma_f32_32x32x16_bf16 v[32:47], v[12:15], v[160:163], v[32:47]
s_waitcnt lgkmcnt(2)
ds_read_b128 v[8:11], v68 offset:512
v_mfma_f32_32x32x16_bf16 v[32:47], v[16:19], v[164:167], v[32:47]
s_waitcnt lgkmcnt(2)
ds_read_b128 v[12:15], v69 offset:512
v_mfma_f32_32x32x16_bf16 v[32:47], v[20:23], v[168:171], v[32:47]
s_waitcnt lgkmcnt(2)
ds_read_b128 v[16:19], v70 offset:512
v_mfma_f32_32x32x16_bf16 v[32:47], v[24:27], v[172:175], v[32:47]
s_waitcnt lgkmcnt(2)
ds_read_b128 v[20:23], v71 offset:512
v_mfma_f32_32x32x16_bf16 v[32:47], v[8:11], v[176:179], v[32:47]
s_waitcnt lgkmcnt(2)
ds_read_b128 v[24:27], v64 offset:768
v_mfma_f32_32x32x16_bf16 v[32:47], v[12:15], v[180:183], v[32:47]
s_waitcnt lgkmcnt(2)
ds_read_b128 v[8:11], v65 offset:768
v_mfma_f32_32x32x16_bf16 v[32:47], v[16:19], v[184:187], v[32:47]
s_waitcnt lgkmcnt(2)
ds_read_b128 v[12:15], v66 offset:768
v_mfma_f32_32x32x16_bf16 v[32:47], v[20:23], v[188:191], v[32:47]
s_waitcnt lgkmcnt(2)
ds_read_b128 v[16:19], v67 offset:768
v_mfma_f32_32x32x16_bf16 v[32:47], v[24:27], v[192:195], v[32:47]
s_waitcnt lgkmcnt(2)
ds_read_b128 v[20:23], v68 offset:768
v_mfma_f32_32x32x16_bf16 v[32:47], v[8:11], v[196:199], v[32:47]
s_waitcnt lgkmcnt(2)
ds_read_b128 v[24:27], v69 offset:768
v_mfma_f32_32x32x16_bf16 v[32:47], v[12:15], v[200:203], v[32:47]
s_waitcnt lgkmcnt(2)
ds_read_b128 v[8:11], v70 offset:768
v_mfma_f32_32x32x16_bf16 v[32:47], v[16:19], v[204:207], v[32:47]
s_waitcnt lgkmcnt(2)
ds_read_b128 v[12:15], v71 offset:768
v_mfma_f32_32x32x16_bf16 v[32:47], v[20:23], v[208:211], v[32:47]
s_waitcnt lgkmcnt(2)
ds_read_b128 v[16:19], v64 offset:1024
v_mfma_f32_32x32x16_bf16 v[32:47], v[24:27], v[212:215], v[32:47]
s_waitcnt lgkmcnt(2)
ds_read_b128 v[20:23], v65 offset:1024
v_mfma_f32_32x32x16_bf16 v[32:47], v[8:11], v[216:219], v[32:47]
s_waitcnt lgkmcnt(2)
ds_read_b128 v[24:27], v66 offset:1024
v_mfma_f32_32x32x16_bf16 v[32:47], v[12:15], v[220:223], v[32:47]
s_waitcnt lgkmcnt(2)
ds_read_b128 v[8:11], v67 offset:1024
v_mfma_f32_32x32x16_bf16 v[32:47], v[16:19], v[224:227], v[32:47]
s_waitcnt lgkmcnt(2)
ds_read_b128 v[12:15], v68 offset:1024
v_mfma_f32_32x32x16_bf16 v[32:47], v[20:23], v[228:231], v[32:47]
s_waitcnt lgkmcnt(2)
ds_read_b128 v[16:19], v69 offset:1024
v_mfma_f32_32x32x16_bf16 v[32:47], v[24:27], v[232:235], v[32:47]
s_waitcnt lgkmcnt(2)
ds_read_b128 v[20:23], v70 offset:1024
v_mfma_f32_32x32x16_bf16 v[32:47], v[8:11], v[236:239], v[32:47]
s_waitcnt lgkmcnt(2)
ds_read_b128 v[24:27], v71 offset:1024
v_mfma_f32_32x32x16_bf16 v[32:47], v[12:15], v[240:243], v[32:47]
s_add_u32 s44, s44, 1
s_cmp_eq_u32 s44, 3
s_mov_b32 s56, 40960
s_cmov_b32 s56, -81920
s_cselect_b32 s44, 0, s44
v_add_u32 v64, s56, v64
v_add_u32 v65, s56, v65
v_add_u32 v66, s56, v66
v_add_u32 v67, s56, v67
v_add_u32 v68, s56, v68
v_add_u32 v69, s56, v69
v_add_u32 v70, s56, v70
v_add_u32 v71, s56, v71
s_waitcnt vmcnt(10) lgkmcnt(2)
s_barrier
ds_read_b128 v[8:11], v64 offset:0
v_mfma_f32_32x32x16_bf16 v[32:47], v[16:19], v[244:247], v[32:47]
s_waitcnt lgkmcnt(2)
ds_read_b128 v[12:15], v65 offset:0
v_mfma_f32_32x32x16_bf16 v[32:47], v[20:23], v[248:251], v[32:47]
s_waitcnt lgkmcnt(2)
ds_read_b128 v[16:19], v66 offset:0
v_mfma_f32_32x32x16_bf16 v[32:47], v[24:27], v[252:255], v[32:47]
s_waitcnt lgkmcnt(2)
ds_read_b128 v[20:23], v67 offset:0
k_st_95:
v_mfma_f32_32x32x16_bf16 v[48:63], v[8:11], v[96:99], 0
s_waitcnt lgkmcnt(2)
ds_read_b128 v[24:27], v68 offset:0
v_mfma_f32_32x32x16_bf16 v[48:63], v[12:15], v[100:103], v[48:63]
s_waitcnt lgkmcnt(2)
ds_read_b128 v[8:11], v69 offset:0
v_cvt_pk_bf16_f32 v32, v32, v33
v_cvt_pk_bf16_f32 v33, v34, v35
v_mfma_f32_32x32x16_bf16 v[48:63], v[16:19], v[104:107], v[48:63]
s_waitcnt lgkmcnt(2)
ds_read_b128 v[12:15], v70 offset:0
v_cvt_pk_bf16_f32 v34, v36, v37
v_cvt_pk_bf16_f32 v35, v38, v39
v_mfma_f32_32x32x16_bf16 v[48:63], v[20:23], v[108:111], v[48:63]
s_waitcnt lgkmcnt(2)
ds_read_b128 v[16:19], v71 offset:0
v_cvt_pk_bf16_f32 v36, v40, v41
v_cvt_pk_bf16_f32 v37, v42, v43
v_mfma_f32_32x32x16_bf16 v[48:63], v[24:27], v[112:115], v[48:63]
s_waitcnt lgkmcnt(2)
ds_read_b128 v[20:23], v64 offset:256
v_cvt_pk_bf16_f32 v38, v44, v45
v_cvt_pk_bf16_f32 v39, v46, v47
v_mfma_f32_32x32x16_bf16 v[48:63], v[8:11], v[116:119], v[48:63]
s_waitcnt lgkmcnt(2)
ds_read_b128 v[24:27], v65 offset:256
buffer_store_dwordx4 v[32:35], v1, s[4:7], s48 offen offset:0 sc1
buffer_store_dwordx4 v[36:39], v1, s[4:7], s48 offen offset:1024 sc1
v_mfma_f32_32x32x16_bf16 v[48:63], v[12:15], v[120:123], v[48:63]
s_waitcnt lgkmcnt(2)
ds_read_b128 v[8:11], v66 offset:256
s_add_u32 s48, s48, s50
s_sub_u32 s50, 4096, s50
s_add_u32 m0, s45, 0
s_nop 0
buffer_load_dwordx4 v72, s[20:23], s46 offen lds
v_mfma_f32_32x32x16_bf16 v[48:63], v[16:19], v[124:127], v[48:63]
s_waitcnt lgkmcnt(2)
ds_read_b128 v[12:15], v67 offset:256
s_add_u32 m0, s45, 1024
s_nop 0
buffer_load_dwordx4 v73, s[20:23], s46 offen lds
s_add_u32 m0, s45, 2048
s_nop 0
buffer_load_dwordx4 v74, s[20:23], s46 offen lds
v_mfma_f32_32x32x16_bf16 v[48:63], v[20:23], v[128:131], v[48:63]
s_waitcnt lgkmcnt(2)
ds_read_b128 v[16:19], v68 offset:256
s_add_u32 m0, s45, 3072
s_nop 0
buffer_load_dwordx4 v75, s[20:23], s46 offen lds
s_add_u32 m0, s45, 4096
s_nop 0
buffer_load_dwordx4 v76, s[20:23], s46 offen lds
v_mfma_f32_32x32x16_bf16 v[48:63], v[24:27], v[132:135], v[48:63]
s_waitcnt lgkmcnt(2)
ds_read_b128 v[20:23], v69 offset:256
s_add_u32 m0, s45, 5120
s_nop 0
buffer_load_dwordx4 v77, s[20:23], s46 offen lds
s_add_u32 m0, s45, 6144
s_nop 0
buffer_load_dwordx4 v78, s[20:23], s46 offen lds
v_mfma_f32_32x32x16_bf16 v[48:63], v[8:11], v[136:139], v[48:63]
s_waitcnt lgkmcnt(2)
ds_read_b128 v[24:27], v70 offset:256
s_add_u32 m0, s45, 7168
s_nop 0
buffer_load_dwordx4 v79, s[20:23], s46 offen lds
s_add_u32 m0, s45, 8192
s_nop 0
buffer_load_dwordx4 v80, s[20:23], s46 offen lds
v_mfma_f32_32x32x16_bf16 v[48:63], v[12:15], v[140:143], v[48:63]
s_waitcnt lgkmcnt(2)
ds_read_b128 v[8:11], v71 offset:256
s_add_u32 m0, s45, 9216
s_nop 0
buffer_load_dwordx4 v81, s[20:23], s46 offen lds
s_add_u32 s45, s45, 40960
s_cmp_ge_u32 s45, 122880
s_cselect_b32 s55, 122880, 0
s_sub_u32 s45, s45, s55
v_mfma_f32_32x32x16_bf16 v[48:63], v[16:19], v[144:147], v[48:63]
s_waitcnt lgkmcnt(2)
ds_read_b128 v[12:15], v64 offset:512
s_add_u32 s47, s47, 1
s_and_b32 s55, s47, 1
s_mul_i32 s46, s55, 5120
s_and_b32 s55, s47, 2
s_mul_i32 s55, s55, 20480
s_add_u32 s46, s46, s55
s_and_b32 s55, s47, 4
s_mul_i32 s55, s55, 40960
s_add_u32 s46, s46, s55
s_add_u32 s46, s46, s49
v_mfma_f32_32x32x16_bf16 v[48:63], v[20:23], v[148:151], v[48:63]
s_waitcnt lgkmcnt(2)
ds_read_b128 v[16:19], v65 offset:512
v_mfma_f32_32x32x16_bf16 v[48:63], v[24:27], v[152:155], v[48:63]
s_waitcnt lgkmcnt(2)
ds_read_b128 v[20:23], v66 offset:512
v_mfma_f32_32x32x16_bf16 v[48:63], v[8:11], v[156:159], v[48:63]
s_waitcnt lgkmcnt(2)
ds_read_b128 v[24:27], v67 offset:512
v_mfma_f32_32x32x16_bf16 v[48:63], v[12:15], v[160:163], v[48:63]
s_waitcnt lgkmcnt(2)
ds_read_b128 v[8:11], v68 offset:512
v_mfma_f32_32x32x16_bf16 v[48:63], v[16:19], v[164:167], v[48:63]
s_waitcnt lgkmcnt(2)
ds_read_b128 v[12:15], v69 offset:512
v_mfma_f32_32x32x16_bf16 v[48:63], v[20:23], v[168:171], v[48:63]
s_waitcnt lgkmcnt(2)
ds_read_b128 v[16:19], v70 offset:512
v_mfma_f32_32x32x16_bf16 v[48:63], v[24:27], v[172:175], v[48:63]
s_waitcnt lgkmcnt(2)
ds_read_b128 v[20:23], v71 offset:512
v_mfma_f32_32x32x16_bf16 v[48:63], v[8:11], v[176:179], v[48:63]
s_waitcnt lgkmcnt(2)
ds_read_b128 v[24:27], v64 offset:768
v_mfma_f32_32x32x16_bf16 v[48:63], v[12:15], v[180:183], v[48:63]
s_waitcnt lgkmcnt(2)
ds_read_b128 v[8:11], v65 offset:768
v_mfma_f32_32x32x16_bf16 v[48:63], v[16:19], v[184:187], v[48:63]
s_waitcnt lgkmcnt(2)
ds_read_b128 v[12:15], v66 offset:768
v_mfma_f32_32x32x16_bf16 v[48:63], v[20:23], v[188:191], v[48:63]
s_waitcnt lgkmcnt(2)
ds_read_b128 v[16:19], v67 offset:768
v_mfma_f32_32x32x16_bf16 v[48:63], v[24:27], v[192:195], v[48:63]
s_waitcnt lgkmcnt(2)
ds_read_b128 v[20:23], v68 offset:768
v_mfma_f32_32x32x16_bf16 v[48:63], v[8:11], v[196:199], v[48:63]
s_waitcnt lgkmcnt(2)
ds_read_b128 v[24:27], v69 offset:768
v_mfma_f32_32x32x16_bf16 v[48:63], v[12:15], v[200:203], v[48:63]
s_waitcnt lgkmcnt(2)
ds_read_b128 v[8:11], v70 offset:768
v_mfma_f32_32x32x16_bf16 v[48:63], v[16:19], v[204:207], v[48:63]
s_waitcnt lgkmcnt(2)
ds_read_b128 v[12:15], v71 offset:768
v_mfma_f32_32x32x16_bf16 v[48:63], v[20:23], v[208:211], v[48:63]
s_waitcnt lgkmcnt(2)
ds_read_b128 v[16:19], v64 offset:1024
v_mfma_f32_32x32x16_bf16 v[48:63], v[24:27], v[212:215], v[48:63]
s_waitcnt lgkmcnt(2)
ds_read_b128 v[20:23], v65 offset:1024
v_mfma_f32_32x32x16_bf16 v[48:63], v[8:11], v[216:219], v[48:63]
s_waitcnt lgkmcnt(2)
ds_read_b128 v[24:27], v66 offset:1024
v_mfma_f32_32x32x16_bf16 v[48:63], v[12:15], v[220:223], v[48:63]
s_waitcnt lgkmcnt(2)
ds_read_b128 v[8:11], v67 offset:1024
v_mfma_f32_32x32x16_bf16 v[48:63], v[16:19], v[224:227], v[48:63]
s_waitcnt lgkmcnt(2)
ds_read_b128 v[12:15], v68 offset:1024
v_mfma_f32_32x32x16_bf16 v[48:63], v[20:23], v[228:231], v[48:63]
s_waitcnt lgkmcnt(2)
ds_read_b128 v[16:19], v69 offset:1024
v_mfma_f32_32x32x16_bf16 v[48:63], v[24:27], v[232:235], v[48:63]
s_waitcnt lgkmcnt(2)
ds_read_b128 v[20:23], v70 offset:1024
v_mfma_f32_32x32x16_bf16 v[48:63], v[8:11], v[236:239], v[48:63]
s_waitcnt lgkmcnt(2)
ds_read_b128 v[24:27], v71 offset:1024
v_mfma_f32_32x32x16_bf16 v[48:63], v[12:15], v[240:243], v[48:63]
s_add_u32 s44, s44, 1
s_cmp_eq_u32 s44, 3
s_mov_b32 s56, 40960
s_cmov_b32 s56, -81920
s_cselect_b32 s44, 0, s44
v_add_u32 v64, s56, v64
v_add_u32 v65, s56, v65
v_add_u32 v66, s56, v66
v_add_u32 v67, s56, v67
v_add_u32 v68, s56, v68
v_add_u32 v69, s56, v69
v_add_u32 v70, s56, v70
v_add_u32 v71, s56, v71
s_waitcnt vmcnt(10) lgkmcnt(2)
s_barrier
ds_read_b128 v[8:11], v64 offset:0
v_mfma_f32_32x32x16_bf16 v[48:63], v[16:19], v[244:247], v[48:63]
s_waitcnt lgkmcnt(2)
ds_read_b128 v[12:15], v65 offset:0
v_mfma_f32_32x32x16_bf16 v[48:63], v[20:23], v[248:251], v[48:63]
s_waitcnt lgkmcnt(2)
ds_read_b128 v[16:19], v66 offset:0
v_mfma_f32_32x32x16_bf16 v[48:63], v[24:27], v[252:255], v[48:63]
s_waitcnt lgkmcnt(2)
ds_read_b128 v[20:23], v67 offset:0
s_sub_u32 s59, s59, 1
s_cmp_eq_u32 s59, 0
s_cbranch_scc1 k_so_96
v_mfma_f32_32x32x16_bf16 v[32:47], v[8:11], v[96:99], 0
s_waitcnt lgkmcnt(2)
ds_read_b128 v[24:27], v68 offset:0
v_mfma_f32_32x32x16_bf16 v[32:47], v[12:15], v[100:103], v[32:47]
s_waitcnt lgkmcnt(2)
ds_read_b128 v[8:11], v69 offset:0
v_cvt_pk_bf16_f32 v48, v48, v49
v_cvt_pk_bf16_f32 v49, v50, v51
v_mfma_f32_32x32x16_bf16 v[32:47], v[16:19], v[104:107], v[32:47]
s_waitcnt lgkmcnt(2)
ds_read_b128 v[12:15], v70 offset:0
v_cvt_pk_bf16_f32 v50, v52, v53
v_cvt_pk_bf16_f32 v51, v54, v55
v_mfma_f32_32x32x16_bf16 v[32:47], v[20:23], v[108:111], v[32:47]
s_waitcnt lgkmcnt(2)
ds_read_b128 v[16:19], v71 offset:0
v_cvt_pk_bf16_f32 v52, v56, v57
v_cvt_pk_bf16_f32 v53, v58, v59
v_mfma_f32_32x32x16_bf16 v[32:47], v[24:27], v[112:115], v[32:47]
s_waitcnt lgkmcnt(2)
ds_read_b128 v[20:23], v64 offset:256
v_cvt_pk_bf16_f32 v54, v60, v61
v_cvt_pk_bf16_f32 v55, v62, v63
v_mfma_f32_32x32x16_bf16 v[32:47], v[8:11], v[116:119], v[32:47]
s_waitcnt lgkmcnt(2)
ds_read_b128 v[24:27], v65 offset:256
buffer_store_dwordx4 v[48:51], v1, s[4:7], s48 offen offset:0 sc1
buffer_store_dwordx4 v[52:55], v1, s[4:7], s48 offen offset:1024 sc1
v_mfma_f32_32x32x16_bf16 v[32:47], v[12:15], v[120:123], v[32:47]
s_waitcnt lgkmcnt(2)
ds_read_b128 v[8:11], v66 offset:256
s_add_u32 s48, s48, s50
s_sub_u32 s50, 4096, s50
s_add_u32 m0, s45, 0
s_nop 0
buffer_load_dwordx4 v72, s[20:23], s46 offen lds
v_mfma_f32_32x32x16_bf16 v[32:47], v[16:19], v[124:127], v[32:47]
s_waitcnt lgkmcnt(2)
ds_read_b128 v[12:15], v67 offset:256
s_add_u32 m0, s45, 1024
s_nop 0
buffer_load_dwordx4 v73, s[20:23], s46 offen lds
s_add_u32 m0, s45, 2048
s_nop 0
buffer_load_dwordx4 v74, s[20:23], s46 offen lds
v_mfma_f32_32x32x16_bf16 v[32:47], v[20:23], v[128:131], v[32:47]
s_waitcnt lgkmcnt(2)
ds_read_b128 v[16:19], v68 offset:256
s_add_u32 m0, s45, 3072
s_nop 0
buffer_load_dwordx4 v75, s[20:23], s46 offen lds
s_add_u32 m0, s45, 4096
s_nop 0
buffer_load_dwordx4 v76, s[20:23], s46 offen lds
v_mfma_f32_32x32x16_bf16 v[32:47], v[24:27], v[132:135], v[32:47]
s_waitcnt lgkmcnt(2)
ds_read_b128 v[20:23], v69 offset:256
s_add_u32 m0, s45, 5120
s_nop 0
buffer_load_dwordx4 v77, s[20:23], s46 offen lds
s_add_u32 m0, s45, 6144
s_nop 0
buffer_load_dwordx4 v78, s[20:23], s46 offen lds
v_mfma_f32_32x32x16_bf16 v[32:47], v[8:11], v[136:139], v[32:47]
s_waitcnt lgkmcnt(2)
ds_read_b128 v[24:27], v70 offset:256
s_add_u32 m0, s45, 7168
s_nop 0
buffer_load_dwordx4 v79, s[20:23], s46 offen lds
s_add_u32 m0, s45, 8192
s_nop 0
buffer_load_dwordx4 v80, s[20:23], s46 offen lds
v_mfma_f32_32x32x16_bf16 v[32:47], v[12:15], v[140:143], v[32:47]
s_waitcnt lgkmcnt(2)
ds_read_b128 v[8:11], v71 offset:256
s_add_u32 m0, s45, 9216
s_nop 0
buffer_load_dwordx4 v81, s[20:23], s46 offen lds
s_add_u32 s45, s45, 40960
s_cmp_ge_u32 s45, 122880
s_cselect_b32 s55, 122880, 0
s_sub_u32 s45, s45, s55
v_mfma_f32_32x32x16_bf16 v[32:47], v[16:19], v[144:147], v[32:47]
s_waitcnt lgkmcnt(2)
ds_read_b128 v[12:15], v64 offset:512
s_add_u32 s47, s47, 1
s_and_b32 s55, s47, 1
s_mul_i32 s46, s55, 5120
s_and_b32 s55, s47, 2
s_mul_i32 s55, s55, 20480
s_add_u32 s46, s46, s55
s_and_b32 s55, s47, 4
s_mul_i32 s55, s55, 40960
s_add_u32 s46, s46, s55
s_add_u32 s46, s46, s49
v_mfma_f32_32x32x16_bf16 v[32:47], v[20:23], v[148:151], v[32:47]
s_waitcnt lgkmcnt(2)
ds_read_b128 v[16:19], v65 offset:512
v_mfma_f32_32x32x16_bf16 v[32:47], v[24:27], v[152:155], v[32:47]
s_waitcnt lgkmcnt(2)
ds_read_b128 v[20:23], v66 offset:512
v_mfma_f32_32x32x16_bf16 v[32:47], v[8:11], v[156:159], v[32:47]
s_waitcnt lgkmcnt(2)
ds_read_b128 v[24:27], v67 offset:512
v_mfma_f32_32x32x16_bf16 v[32:47], v[12:15], v[160:163], v[32:47]
s_waitcnt lgkmcnt(2)
ds_read_b128 v[8:11], v68 offset:512
v_mfma_f32_32x32x16_bf16 v[32:47], v[16:19], v[164:167], v[32:47]
s_waitcnt lgkmcnt(2)
ds_read_b128 v[12:15], v69 offset:512
v_mfma_f32_32x32x16_bf16 v[32:47], v[20:23], v[168:171], v[32:47]
s_waitcnt lgkmcnt(2)
ds_read_b128 v[16:19], v70 offset:512
v_mfma_f32_32x32x16_bf16 v[32:47], v[24:27], v[172:175], v[32:47]
s_waitcnt lgkmcnt(2)
ds_read_b128 v[20:23], v71 offset:512
v_mfma_f32_32x32x16_bf16 v[32:47], v[8:11], v[176:179], v[32:47]
s_waitcnt lgkmcnt(2)
ds_read_b128 v[24:27], v64 offset:768
v_mfma_f32_32x32x16_bf16 v[32:47], v[12:15], v[180:183], v[32:47]
s_waitcnt lgkmcnt(2)
ds_read_b128 v[8:11], v65 offset:768
v_mfma_f32_32x32x16_bf16 v[32:47], v[16:19], v[184:187], v[32:47]
s_waitcnt lgkmcnt(2)
ds_read_b128 v[12:15], v66 offset:768
v_mfma_f32_32x32x16_bf16 v[32:47], v[20:23], v[188:191], v[32:47]
s_waitcnt lgkmcnt(2)
ds_read_b128 v[16:19], v67 offset:768
v_mfma_f32_32x32x16_bf16 v[32:47], v[24:27], v[192:195], v[32:47]
s_waitcnt lgkmcnt(2)
ds_read_b128 v[20:23], v68 offset:768
v_mfma_f32_32x32x16_bf16 v[32:47], v[8:11], v[196:199], v[32:47]
s_waitcnt lgkmcnt(2)
ds_read_b128 v[24:27], v69 offset:768
v_mfma_f32_32x32x16_bf16 v[32:47], v[12:15], v[200:203], v[32:47]
s_waitcnt lgkmcnt(2)
ds_read_b128 v[8:11], v70 offset:768
v_mfma_f32_32x32x16_bf16 v[32:47], v[16:19], v[204:207], v[32:47]
s_waitcnt lgkmcnt(2)
ds_read_b128 v[12:15], v71 offset:768
v_mfma_f32_32x32x16_bf16 v[32:47], v[20:23], v[208:211], v[32:47]
s_waitcnt lgkmcnt(2)
ds_read_b128 v[16:19], v64 offset:1024
v_mfma_f32_32x32x16_bf16 v[32:47], v[24:27], v[212:215], v[32:47]
s_waitcnt lgkmcnt(2)
ds_read_b128 v[20:23], v65 offset:1024
v_mfma_f32_32x32x16_bf16 v[32:47], v[8:11], v[216:219], v[32:47]
s_waitcnt lgkmcnt(2)
ds_read_b128 v[24:27], v66 offset:1024
v_mfma_f32_32x32x16_bf16 v[32:47], v[12:15], v[220:223], v[32:47]
s_waitcnt lgkmcnt(2)
ds_read_b128 v[8:11], v67 offset:1024
v_mfma_f32_32x32x16_bf16 v[32:47], v[16:19], v[224:227], v[32:47]
s_waitcnt lgkmcnt(2)
ds_read_b128 v[12:15], v68 offset:1024
v_mfma_f32_32x32x16_bf16 v[32:47], v[20:23], v[228:231], v[32:47]
s_waitcnt lgkmcnt(2)
ds_read_b128 v[16:19], v69 offset:1024
v_mfma_f32_32x32x16_bf16 v[32:47], v[24:27], v[232:235], v[32:47]
s_waitcnt lgkmcnt(2)
ds_read_b128 v[20:23], v70 offset:1024
v_mfma_f32_32x32x16_bf16 v[32:47], v[8:11], v[236:239], v[32:47]
s_waitcnt lgkmcnt(2)
ds_read_b128 v[24:27], v71 offset:1024
v_mfma_f32_32x32x16_bf16 v[32:47], v[12:15], v[240:243], v[32:47]
s_add_u32 s44, s44, 1
s_cmp_eq_u32 s44, 3
s_mov_b32 s56, 40960
s_cmov_b32 s56, -81920
s_cselect_b32 s44, 0, s44
v_add_u32 v64, s56, v64
v_add_u32 v65, s56, v65
v_add_u32 v66, s56, v66
v_add_u32 v67, s56, v67
v_add_u32 v68, s56, v68
v_add_u32 v69, s56, v69
v_add_u32 v70, s56, v70
v_add_u32 v71, s56, v71
s_waitcnt vmcnt(10) lgkmcnt(2)
s_barrier
ds_read_b128 v[8:11], v64 offset:0
v_mfma_f32_32x32x16_bf16 v[32:47], v[16:19], v[244:247], v[32:47]
s_waitcnt lgkmcnt(2)
ds_read_b128 v[12:15], v65 offset:0
v_mfma_f32_32x32x16_bf16 v[32:47], v[20:23], v[248:251], v[32:47]
s_waitcnt lgkmcnt(2)
ds_read_b128 v[16:19], v66 offset:0
v_mfma_f32_32x32x16_bf16 v[32:47], v[24:27], v[252:255], v[32:47]
s_waitcnt lgkmcnt(2)
ds_read_b128 v[20:23], v67 offset:0
s_branch k_st_95
k_so_96:
s_nop 6
v_cvt_pk_bf16_f32 v48, v48, v49
v_cvt_pk_bf16_f32 v49, v50, v51
v_cvt_pk_bf16_f32 v50, v52, v53
v_cvt_pk_bf16_f32 v51, v54, v55
v_cvt_pk_bf16_f32 v52, v56, v57
v_cvt_pk_bf16_f32 v53, v58, v59
v_cvt_pk_bf16_f32 v54, v60, v61
v_cvt_pk_bf16_f32 v55, v62, v63
buffer_store_dwordx4 v[48:51], v1, s[4:7], s48 offen offset:0 sc1
buffer_store_dwordx4 v[52:55], v1, s[4:7], s48 offen offset:1024 sc1
s_add_u32 s48, s48, s50
s_sub_u32 s50, 4096, s50
s_lshl_b32 s54, s30, 6
s_add_u32 s54, s54, 222322688
s_waitcnt lgkmcnt(0)
s_waitcnt vmcnt(0)
s_barrier
s_cmp_lg_u32 s3, 0
s_cbranch_scc1 k_s8_97
s_mov_b64 exec, 1
v_mov_b32 v2, 1
buffer_store_dword v2, off, s[4:7], s54 sc1
s_mov_b64 exec, -1
k_s8_97:
s_mul_i32 s57, s30, 3277
s_lshr_b32 s57, s57, 16
s_mul_i32 s52, s57, 20
s_sub_u32 s58, s30, s52
s_mov_b32 s54, 222322688
v_add_u32 v10, 4096, v0
v_add_u32 v11, 8192, v0
v_add_u32 v12, 12288, v0
s_cmp_lg_u32 s3, 0
s_cbranch_scc1 k_w8d_99
v_lshlrev_b32 v96, 2, v0
k_w8_98:
buffer_load_dword v97, v96, s[4:7], s54 offen sc1
buffer_load_dword v98, v96, s[4:7], s54 offen offset:1024 sc1
s_waitcnt vmcnt(0)
v_and_b32 v97, v97, v98
v_cmp_eq_u32 vcc, 0, v97
s_cbranch_vccz k_w8d_99
s_sleep 1
s_sub_u32 s32, s32, 1
s_cmp_gt_i32 s32, 0
s_cbranch_scc1 k_w8_98
k_w8d_99:
s_barrier
s_lshl_b32 s52, s58, 2
s_add_u32 s52, s52, s3
s_lshl_b32 s52, s52, 16
s_add_u32 s52, s52, 216006656
buffer_load_dwordx4 a[0:3], v0, s[4:7], s52 offen offset:0 sc1
buffer_load_dwordx4 a[4:7], v0, s[4:7], s52 offen offset:1024 sc1
buffer_load_dwordx4 a[8:11], v0, s[4:7], s52 offen offset:2048 sc1
buffer_load_dwordx4 a[12:15], v0, s[4:7], s52 offen offset:3072 sc1
buffer_load_dwordx4 a[16:19], v10, s[4:7], s52 offen offset:0 sc1
buffer_load_dwordx4 a[20:23], v10, s[4:7], s52 offen offset:1024 sc1
buffer_load_dwordx4 a[24:27], v10, s[4:7], s52 offen offset:2048 sc1
buffer_load_dwordx4 a[28:31], v10, s[4:7], s52 offen offset:3072 sc1
buffer_load_dwordx4 a[32:35], v11, s[4:7], s52 offen offset:0 sc1
buffer_load_dwordx4 a[36:39], v11, s[4:7], s52 offen offset:1024 sc1
buffer_load_dwordx4 a[40:43], v11, s[4:7], s52 offen offset:2048 sc1
buffer_load_dwordx4 a[44:47], v11, s[4:7], s52 offen offset:3072 sc1
buffer_load_dwordx4 a[48:51], v12, s[4:7], s52 offen offset:0 sc1
buffer_load_dwordx4 a[52:55], v12, s[4:7], s52 offen offset:1024 sc1
buffer_load_dwordx4 a[56:59], v12, s[4:7], s52 offen offset:2048 sc1
buffer_load_dwordx4 a[60:63], v12, s[4:7], s52 offen offset:3072 sc1
s_add_u32 s52, s52, 16384
buffer_load_dwordx4 a[64:67], v0, s[4:7], s52 offen offset:0 sc1
buffer_load_dwordx4 a[68:71], v0, s[4:7], s52 offen offset:1024 sc1
buffer_load_dwordx4 a[72:75], v0, s[4:7], s52 offen offset:2048 sc1
buffer_load_dwordx4 a[76:79], v0, s[4:7], s52 offen offset:3072 sc1
buffer_load_dwordx4 a[80:83], v10, s[4:7], s52 offen offset:0 sc1
buffer_load_dwordx4 a[84:87], v10, s[4:7], s52 offen offset:1024 sc1
buffer_load_dwordx4 a[88:91], v10, s[4:7], s52 offen offset:2048 sc1
buffer_load_dwordx4 a[92:95], v10, s[4:7], s52 offen offset:3072 sc1
buffer_load_dwordx4 a[96:99], v11, s[4:7], s52 offen offset:0 sc1
buffer_load_dwordx4 a[100:103], v11, s[4:7], s52 offen offset:1024 sc1
buffer_load_dwordx4 a[104:107], v11, s[4:7], s52 offen offset:2048 sc1
buffer_load_dwordx4 a[108:111], v11, s[4:7], s52 offen offset:3072 sc1
buffer_load_dwordx4 a[112:115], v12, s[4:7], s52 offen offset:0 sc1
buffer_load_dwordx4 a[116:119], v12, s[4:7], s52 offen offset:1024 sc1
buffer_load_dwordx4 a[120:123], v12, s[4:7], s52 offen offset:2048 sc1
buffer_load_dwordx4 a[124:127], v12, s[4:7], s52 offen offset:3072 sc1
s_waitcnt vmcnt(0)
s_add_u32 s52, s52, 16384
buffer_load_dwordx4 a[128:131], v0, s[4:7], s52 offen offset:0 sc1
buffer_load_dwordx4 a[132:135], v0, s[4:7], s52 offen offset:1024 sc1
buffer_load_dwordx4 a[136:139], v0, s[4:7], s52 offen offset:2048 sc1
buffer_load_dwordx4 a[140:143], v0, s[4:7], s52 offen offset:3072 sc1
buffer_load_dwordx4 a[144:147], v10, s[4:7], s52 offen offset:0 sc1
buffer_load_dwordx4 a[148:151], v10, s[4:7], s52 offen offset:1024 sc1
buffer_load_dwordx4 a[152:155], v10, s[4:7], s52 offen offset:2048 sc1
buffer_load_dwordx4 a[156:159], v10, s[4:7], s52 offen offset:3072 sc1
buffer_load_dwordx4 a[160:163], v11, s[4:7], s52 offen offset:0 sc1
buffer_load_dwordx4 a[164:167], v11, s[4:7], s52 offen offset:1024 sc1
buffer_load_dwordx4 a[168:171], v11, s[4:7], s52 offen offset:2048 sc1
buffer_load_dwordx4 a[172:175], v11, s[4:7], s52 offen offset:3072 sc1
buffer_load_dwordx4 a[176:179], v12, s[4:7], s52 offen offset:0 sc1
buffer_load_dwordx4 a[180:183], v12, s[4:7], s52 offen offset:1024 sc1
buffer_load_dwordx4 a[184:187], v12, s[4:7], s52 offen offset:2048 sc1
buffer_load_dwordx4 a[188:191], v12, s[4:7], s52 offen offset:3072 sc1
s_add_u32 s52, s52, 16384
buffer_load_dwordx4 a[192:195], v0, s[4:7], s52 offen offset:0 sc1
buffer_load_dwordx4 a[196:199], v0, s[4:7], s52 offen offset:1024 sc1
buffer_load_dwordx4 a[200:203], v0, s[4:7], s52 offen offset:2048 sc1
buffer_load_dwordx4 a[204:207], v0, s[4:7], s52 offen offset:3072 sc1
buffer_load_dwordx4 a[208:211], v10, s[4:7], s52 offen offset:0 sc1
buffer_load_dwordx4 a[212:215], v10, s[4:7], s52 offen offset:1024 sc1
buffer_load_dwordx4 a[216:219], v10, s[4:7], s52 offen offset:2048 sc1
buffer_load_dwordx4 a[220:223], v10, s[4:7], s52 offen offset:3072 sc1
buffer_load_dwordx4 a[224:227], v11, s[4:7], s52 offen offset:0 sc1
buffer_load_dwordx4 a[228:231], v11, s[4:7], s52 offen offset:1024 sc1
buffer_load_dwordx4 a[232:235], v11, s[4:7], s52 offen offset:2048 sc1
buffer_load_dwordx4 a[236:239], v11, s[4:7], s52 offen offset:3072 sc1
buffer_load_dwordx4 a[240:243], v12, s[4:7], s52 offen offset:0 sc1
buffer_load_dwordx4 a[244:247], v12, s[4:7], s52 offen offset:1024 sc1
buffer_load_dwordx4 a[248:251], v12, s[4:7], s52 offen offset:2048 sc1
buffer_load_dwordx4 a[252:255], v12, s[4:7], s52 offen offset:3072 sc1
s_waitcnt vmcnt(0)
s_lshl_b32 s46, s57, 16
s_lshl_b32 s52, s3, 14
s_add_u32 s46, s46, s52
s_add_u32 s46, s46, 159383552
s_lshl_b32 s53, s57, 7
s_lshl_b32 s44, s58, 11
s_add_u32 s44, s44, s53
s_add_u32 s44, s44, 195035136
s_lshl_b32 s45, s58, 17
s_add_u32 s45, s45, s53
s_add_u32 s45, s45, 205520896
s_lshl_b32 s48, s58, 7
s_lshl_b32 s53, s57, 5
s_add_u32 s48, s48, s53
s_add_u32 s48, s48, 211812352
s_lshr_b32 s49, s57, 1
s_lshl_b32 s49, s49, 8
s_lshl_b32 s53, s3, 5
s_add_u32 s49, s49, s53
s_add_u32 s49, s49, 222339072
s_mov_b32 s50, 1
v_lshrrev_b32 v96, 4, v0
v_and_b32 v97, 8, v96
v_cmp_ne_u32 vcc, 0, v97
v_mov_b32 v1, 0x4444
v_mov_b32 v97, 0xeeee
v_cndmask_b32 v1, v1, v97, vcc
v_and_b32 v97, 7, v96
v_lshrrev_b32 v98, 3, v96
v_lshlrev_b32 v2, 2, v97
v_mul_u32_u24 v4, 144, v98
v_lshl_add_u32 v4, v97, 4, v4
v_and_b32 v99, 1, v96
v_lshlrev_b32 v99, 3, v99
v_lshl_add_u32 v99, v98, 4, v99
v_bfe_u32 v100, v96, 1, 2
v_lshl_add_u32 v5, v100, 9, v99
v_lshl_add_u32 v6, v100, 15, v99
v_lshlrev_b32 v7, 2, v98
v_mov_b32 v99, 2146435072
v_cmp_eq_u32 vcc, 0, v97
s_nop 1
v_cndmask_b32 v7, v99, v7, vcc
v_add_u32 v97, s58, v97
v_cmp_eq_u32 vcc, 0, v97
s_nop 1
v_cndmask_b32 v9, 1.0, 0, vcc
v_and_b32 v3, 15, v96
v_bfe_u32 v97, v96, 4, 1
v_mul_u32_u24 v97, 144, v97
v_add_u32 v3, v3, v97
v_lshrrev_b32 v97, 5, v96
v_lshl_add_u32 v3, v97, 4, v3
v_lshlrev_b32 v3, 2, v3
s_mul_i32 s52, s3, 1152
v_add_u32 v3, s52, v3
s_mov_b32 s56, 8192
k_poll_101:
buffer_load_dword v8, v2, s[4:7], s49 offen sc1
s_waitcnt vmcnt(0)
v_cmp_gt_u32 vcc, s50, v8
s_cbranch_vccz k_pd_102
s_sleep 1
s_sub_u32 s32, s32, 1
s_cmp_gt_i32 s32, 0
s_cbranch_scc1 k_poll_101
k_pd_102:
buffer_load_dwordx2 v[14:15], v5, s[4:7], s44 offen sc1
buffer_load_dwordx4 v[32:35], v0, s[4:7], s46 offen offset:0 sc1
buffer_load_dwordx4 v[36:39], v0, s[4:7], s46 offen offset:1024 sc1
buffer_load_dwordx4 v[40:43], v0, s[4:7], s46 offen offset:2048 sc1
buffer_load_dwordx4 v[44:47], v0, s[4:7], s46 offen offset:3072 sc1
buffer_load_dwordx4 v[48:51], v10, s[4:7], s46 offen offset:0 sc1
buffer_load_dwordx4 v[52:55], v10, s[4:7], s46 offen offset:1024 sc1
buffer_load_dwordx4 v[56:59], v10, s[4:7], s46 offen offset:2048 sc1
buffer_load_dwordx4 v[60:63], v10, s[4:7], s46 offen offset:3072 sc1
buffer_load_dwordx4 v[64:67], v11, s[4:7], s46 offen offset:0 sc1
buffer_load_dwordx4 v[68:71], v11, s[4:7], s46 offen offset:1024 sc1
buffer_load_dwordx4 v[72:75], v11, s[4:7], s46 offen offset:2048 sc1
buffer_load_dwordx4 v[76:79], v11, s[4:7], s46 offen offset:3072 sc1
buffer_load_dwordx4 v[80:83], v12, s[4:7], s46 offen offset:0 sc1
buffer_load_dwordx4 v[84:87], v12, s[4:7], s46 offen offset:1024 sc1
buffer_load_dwordx4 v[88:91], v12, s[4:7], s46 offen offset:2048 sc1
buffer_load_dwordx4 v[92:95], v12, s[4:7], s46 offen offset:3072 sc1
s_xor_b32 s49, s49, 512
buffer_load_dword v8, v2, s[4:7], s49 offen sc1
k_top_100:
v_mov_b64 v[24:25], 0
v_mov_b64 v[26:27], 0
v_mov_b64 v[28:29], 0
v_mov_b64 v[30:31], 0
s_add_u32 s50, s50, 1
s_add_u32 s46, s46, 262144
s_add_u32 s44, s44, 40960
s_cmp_eq_u32 s50, 65
s_cselect_b32 s52, 1048576, 0
s_cselect_b32 s53, 524288, 0
s_add_u32 s46, s46, s52
s_add_u32 s44, s44, s53
s_waitcnt vmcnt(17)
v_lshlrev_b32 v16, 16, v14
v_and_b32 v17, 0xffff0000, v14
v_lshlrev_b32 v18, 16, v15
v_and_b32 v19, 0xffff0000, v15
s_waitcnt vmcnt(16)
v_smfmac_f32_16x16x64_bf16 v[24:27], v[32:35], a[0:7], v1
v_smfmac_f32_16x16x64_bf16 v[28:31], v[32:35], a[8:15], v1
s_waitcnt vmcnt(15)
v_smfmac_f32_16x16x64_bf16 v[24:27], v[36:39], a[16:23], v1
v_smfmac_f32_16x16x64_bf16 v[28:31], v[36:39], a[24:31], v1
s_waitcnt vmcnt(14)
v_smfmac_f32_16x16x64_bf16 v[24:27], v[40:43], a[32:39], v1
v_smfmac_f32_16x16x64_bf16 v[28:31], v[40:43], a[40:47], v1
s_waitcnt vmcnt(13)
v_smfmac_f32_16x16x64_bf16 v[24:27], v[44:47], a[48:55], v1
v_smfmac_f32_16x16x64_bf16 v[28:31], v[44:47], a[56:63], v1
s_waitcnt vmcnt(12)
v_smfmac_f32_16x16x64_bf16 v[24:27], v[48:51], a[64:71], v1
v_smfmac_f32_16x16x64_bf16 v[28:31], v[48:51], a[72:79], v1
s_waitcnt vmcnt(11)
v_smfmac_f32_16x16x64_bf16 v[24:27], v[52:55], a[80:87], v1
v_smfmac_f32_16x16x64_bf16 v[28:31], v[52:55], a[88:95], v1
s_waitcnt vmcnt(10)
v_smfmac_f32_16x16x64_bf16 v[24:27], v[56:59], a[96:103], v1
v_smfmac_f32_16x16x64_bf16 v[28:31], v[56:59], a[104:111], v1
s_waitcnt vmcnt(9)
v_smfmac_f32_16x16x64_bf16 v[24:27], v[60:63], a[112:119], v1
v_smfmac_f32_16x16x64_bf16 v[28:31], v[60:63], a[120:127], v1
s_waitcnt vmcnt(8)
v_smfmac_f32_16x16x64_bf16 v[24:27], v[64:67], a[128:135], v1
v_smfmac_f32_16x16x64_bf16 v[28:31], v[64:67], a[136:143], v1
s_waitcnt vmcnt(7)
v_smfmac_f32_16x16x64_bf16 v[24:27], v[68:71], a[144:151], v1
v_smfmac_f32_16x16x64_bf16 v[28:31], v[68:71], a[152:159], v1
s_waitcnt vmcnt(6)
v_smfmac_f32_16x16x64_bf16 v[24:27], v[72:75], a[160:167], v1
v_smfmac_f32_16x16x64_bf16 v[28:31], v[72:75], a[168:175], v1
s_waitcnt vmcnt(5)
v_smfmac_f32_16x16x64_bf16 v[24:27], v[76:79], a[176:183], v1
v_smfmac_f32_16x16x64_bf16 v[28:31], v[76:79], a[184:191], v1
s_waitcnt vmcnt(4)
v_smfmac_f32_16x16x64_bf16 v[24:27], v[80:83], a[192:199], v1
v_smfmac_f32_16x16x64_bf16 v[28:31], v[80:83], a[200:207], v1
s_waitcnt vmcnt(3)
v_smfmac_f32_16x16x64_bf16 v[24:27], v[84:87], a[208:215], v1
v_smfmac_f32_16x16x64_bf16 v[28:31], v[84:87], a[216:223], v1
s_waitcnt vmcnt(2)
v_smfmac_f32_16x16x64_bf16 v[24:27], v[88:91], a[224:231], v1
v_smfmac_f32_16x16x64_bf16 v[28:31], v[88:91], a[232:239], v1
s_waitcnt vmcnt(1)
v_smfmac_f32_16x16x64_bf16 v[24:27], v[92:95], a[240:247], v1
v_smfmac_f32_16x16x64_bf16 v[28:31], v[92:95], a[248:255], v1
s_waitcnt vmcnt(0)
v_cmp_gt_u32 vcc, s50, v8
s_mov_b32 s47, 0
s_cbranch_vccnz k_nr_103
s_mov_b32 s47, 1
buffer_load_dwordx2 v[14:15], v5, s[4:7], s44 offen sc1
buffer_load_dwordx4 v[32:35], v0, s[4:7], s46 offen offset:0 sc1
buffer_load_dwordx4 v[36:39], v0, s[4:7], s46 offen offset:1024 sc1
buffer_load_dwordx4 v[40:43], v0, s[4:7], s46 offen offset:2048 sc1
buffer_load_dwordx4 v[44:47], v0, s[4:7], s46 offen offset:3072 sc1
buffer_load_dwordx4 v[48:51], v10, s[4:7], s46 offen offset:0 sc1
buffer_load_dwordx4 v[52:55], v10, s[4:7], s46 offen offset:1024 sc1
buffer_load_dwordx4 v[56:59], v10, s[4:7], s46 offen offset:2048 sc1
buffer_load_dwordx4 v[60:63], v10, s[4:7], s46 offen offset:3072 sc1
buffer_load_dwordx4 v[64:67], v11, s[4:7], s46 offen offset:0 sc1
buffer_load_dwordx4 v[68:71], v11, s[4:7], s46 offen offset:1024 sc1
buffer_load_dwordx4 v[72:75], v11, s[4:7], s46 offen offset:2048 sc1
buffer_load_dwordx4 v[76:79], v11, s[4:7], s46 offen offset:3072 sc1
buffer_load_dwordx4 v[80:83], v12, s[4:7], s46 offen offset:0 sc1
buffer_load_dwordx4 v[84:87], v12, s[4:7], s46 offen offset:1024 sc1
buffer_load_dwordx4 v[88:91], v12, s[4:7], s46 offen offset:2048 sc1
buffer_load_dwordx4 v[92:95], v12, s[4:7], s46 offen offset:3072 sc1
s_xor_b32 s49, s49, 512
buffer_load_dword v8, v2, s[4:7], s49 offen sc1
k_nr_103:
s_nop 2
v_permlane32_swap_b32 v24, v28
v_permlane32_swap_b32 v25, v29
v_permlane32_swap_b32 v26, v30
v_permlane32_swap_b32 v27, v31
v_add_f32 v24, v24, v28
ds_write_b32 v3, v24 offset:0
v_add_f32 v25, v25, v29
ds_write_b32 v3, v25 offset:144
v_add_f32 v26, v26, v30
ds_write_b32 v3, v26 offset:288
v_add_f32 v27, v27, v31
ds_write_b32 v3, v27 offset:432
v_add_u32 v3, s56, v3
s_waitcnt lgkmcnt(0)
s_barrier
s_cmp_lg_u32 s3, 0
s_cbranch_scc1 k_ne_104
ds_read_b128 v[96:99], v4 offset:0
ds_read_b128 v[100:103], v4 offset:1152
ds_read_b128 v[104:107], v4 offset:2304
ds_read_b128 v[108:111], v4 offset:3456
v_add_u32 v4, s56, v4
s_waitcnt lgkmcnt(3)
v_add_f32 v16, v16, v96
v_add_f32 v17, v17, v97
v_add_f32 v18, v18, v98
v_add_f32 v19, v19, v99
s_waitcnt lgkmcnt(2)
v_add_f32 v16, v16, v100
v_add_f32 v17, v17, v101
v_add_f32 v18, v18, v102
v_add_f32 v19, v19, v103
s_waitcnt lgkmcnt(1)
v_add_f32 v16, v16, v104
v_add_f32 v17, v17, v105
v_add_f32 v18, v18, v106
v_add_f32 v19, v19, v107
s_waitcnt lgkmcnt(0)
v_add_f32 v16, v16, v108
v_add_f32 v17, v17, v109
v_add_f32 v18, v18, v110
v_add_f32 v19, v19, v111
v_cvt_pk_bf16_f32 v96, v16, v17
v_cvt_pk_bf16_f32 v97, v18, v19
buffer_store_dwordx2 v[96:97], v6, s[4:7], s45 offen sc1
v_mul_f32 v17, v9, v17
v_mul_f32 v16, v16, v16
v_fmac_f32 v16, v17, v17
v_fmac_f32 v16, v18, v18
v_fmac_f32 v16, v19, v19
s_nop 1
v_add_f32_dpp v16, v16, v16 quad_perm:[1,0,3,2] row_mask:0xf bank_mask:0xf
s_nop 1
v_add_f32_dpp v16, v16, v16 quad_perm:[2,3,0,1] row_mask:0xf bank_mask:0xf
s_nop 1
v_add_f32_dpp v16, v16, v16 row_half_mirror row_mask:0xf bank_mask:0xf
buffer_store_dword v16, v7, s[4:7], s48 offen sc1
s_add_u32 s45, s45, 512
s_add_u32 s48, s48, 2560
s_cmp_eq_u32 s50, 65
s_cbranch_scc0 k_ne_104
s_add_u32 s45, s45, 3112960
s_add_u32 s48, s48, 884736
k_ne_104:
s_sub_u32 s56, 0, s56
s_cmp_eq_u32 s47, 1
s_cbranch_scc1 k_top_100
s_cmp_le_u32 s50, 128
s_cbranch_scc1 k_poll_101
s_waitcnt vmcnt(0) lgkmcnt(0)
s_barrier
k_fin_7:
s_mul_i32 s57, s30, 52429
s_lshr_b32 s57, s57, 18
s_mul_i32 s52, s57, 5
s_sub_u32 s58, s30, s52
s_lshl_b32 s58, s58, 2
s_add_u32 s58, s58, s3
s_mul_i32 s53, s58, 40960
s_add_u32 s53, s53, 214958080
s_load_dwordx2 s[36:37], s[0:1], 80
s_mov_b32 s38, 2621440
s_mov_b32 s39, 0x20000
buffer_load_dwordx4 v[96:99], v0, s[4:7], s53 offen offset:0 sc1
buffer_load_dwordx4 v[100:103], v0, s[4:7], s53 offen offset:1024 sc1
buffer_load_dwordx4 v[104:107], v0, s[4:7], s53 offen offset:2048 sc1
buffer_load_dwordx4 v[108:111], v0, s[4:7], s53 offen offset:3072 sc1
s_add_u32 s53, s53, 4096
buffer_load_dwordx4 v[112:115], v0, s[4:7], s53 offen offset:0 sc1
buffer_load_dwordx4 v[116:119], v0, s[4:7], s53 offen offset:1024 sc1
buffer_load_dwordx4 v[120:123], v0, s[4:7], s53 offen offset:2048 sc1
buffer_load_dwordx4 v[124:127], v0, s[4:7], s53 offen offset:3072 sc1
s_add_u32 s53, s53, 4096
buffer_load_dwordx4 v[128:131], v0, s[4:7], s53 offen offset:0 sc1
buffer_load_dwordx4 v[132:135], v0, s[4:7], s53 offen offset:1024 sc1
buffer_load_dwordx4 v[136:139], v0, s[4:7], s53 offen offset:2048 sc1
buffer_load_dwordx4 v[140:143], v0, s[4:7], s53 offen offset:3072 sc1
s_add_u32 s53, s53, 4096
buffer_load_dwordx4 v[144:147], v0, s[4:7], s53 offen offset:0 sc1
buffer_load_dwordx4 v[148:151], v0, s[4:7], s53 offen offset:1024 sc1
buffer_load_dwordx4 v[152:155], v0, s[4:7], s53 offen offset:2048 sc1
buffer_load_dwordx4 v[156:159], v0, s[4:7], s53 offen offset:3072 sc1
s_add_u32 s53, s53, 4096
buffer_load_dwordx4 v[160:163], v0, s[4:7], s53 offen offset:0 sc1
buffer_load_dwordx4 v[164:167], v0, s[4:7], s53 offen offset:1024 sc1
buffer_load_dwordx4 v[168:171], v0, s[4:7], s53 offen offset:2048 sc1
buffer_load_dwordx4 v[172:175], v0, s[4:7], s53 offen offset:3072 sc1
s_add_u32 s53, s53, 4096
buffer_load_dwordx4 v[176:179], v0, s[4:7], s53 offen offset:0 sc1
buffer_load_dwordx4 v[180:183], v0, s[4:7], s53 offen offset:1024 sc1
buffer_load_dwordx4 v[184:187], v0, s[4:7], s53 offen offset:2048 sc1
buffer_load_dwordx4 v[188:191], v0, s[4:7], s53 offen offset:3072 sc1
s_add_u32 s53, s53, 4096
buffer_load_dwordx4 v[192:195], v0, s[4:7], s53 offen offset:0 sc1
buffer_load_dwordx4 v[196:199], v0, s[4:7], s53 offen offset:1024 sc1
buffer_load_dwordx4 v[200:203], v0, s[4:7], s53 offen offset:2048 sc1
buffer_load_dwordx4 v[204:207], v0, s[4:7], s53 offen offset:3072 sc1
s_add_u32 s53, s53, 4096
buffer_load_dwordx4 v[208:211], v0, s[4:7], s53 offen offset:0 sc1
buffer_load_dwordx4 v[212:215], v0, s[4:7], s53 offen offset:1024 sc1
buffer_load_dwordx4 v[216:219], v0, s[4:7], s53 offen offset:2048 sc1
buffer_load_dwordx4 v[220:223], v0, s[4:7], s53 offen offset:3072 sc1
s_add_u32 s53, s53, 4096
buffer_load_dwordx4 v[224:227], v0, s[4:7], s53 offen offset:0 sc1
buffer_load_dwordx4 v[228:231], v0, s[4:7], s53 offen offset:1024 sc1
buffer_load_dwordx4 v[232:235], v0, s[4:7], s53 offen offset:2048 sc1
buffer_load_dwordx4 v[236:239], v0, s[4:7], s53 offen offset:3072 sc1
s_add_u32 s53, s53, 4096
buffer_load_dwordx4 v[240:243], v0, s[4:7], s53 offen offset:0 sc1
buffer_load_dwordx4 v[244:247], v0, s[4:7], s53 offen offset:1024 sc1
buffer_load_dwordx4 v[248:251], v0, s[4:7], s53 offen offset:2048 sc1
buffer_load_dwordx4 v[252:255], v0, s[4:7], s53 offen offset:3072 sc1
s_mul_i32 s48, s57, 40960
s_mul_i32 s52, s3, 10240
s_add_u32 s46, s48, s52
s_add_u32 s46, s46, 201326592
s_lshl_b32 s58, s58, 6
s_add_u32 s48, s48, s58
v_bfe_u32 v1, v0, 4, 5
v_mul_u32_u24 v1, 1280, v1
v_lshrrev_b32 v2, 9, v0
v_lshl_add_u32 v1, v2, 5, v1
s_mov_b32 s49, 1310720
s_mov_b32 s54, 222314496
s_waitcnt vmcnt(0) lgkmcnt(0)
s_cmp_lg_u32 s3, 0
s_cbranch_scc1 k_w8d_108
v_lshlrev_b32 v2, 2, v0
k_w8_107:
buffer_load_dword v3, v2, s[4:7], s54 offen sc1
buffer_load_dword v4, v2, s[4:7], s54 offen offset:1024 sc1
s_waitcnt vmcnt(0)
v_and_b32 v3, v3, v4
v_cmp_eq_u32 vcc, 0, v3
s_cbranch_vccz k_w8d_108
s_sleep 1
s_sub_u32 s32, s32, 1
s_cmp_gt_i32 s32, 0
s_cbranch_scc1 k_w8_107
k_w8d_108:
s_barrier
s_mul_i32 s45, s3, 10240
s_mov_b32 s44, 0
v_mov_b32 v64, v0
s_add_u32 m0, s45, 0
s_add_u32 s55, s46, 0
buffer_load_dwordx4 v0, s[4:7], s55 offen offset:0 sc1 lds
buffer_load_dwordx4 v0, s[4:7], s55 offen offset:1024 sc1 lds
buffer_load_dwordx4 v0, s[4:7], s55 offen offset:2048 sc1 lds
buffer_load_dwordx4 v0, s[4:7], s55 offen offset:3072 sc1 lds
s_add_u32 m0, s45, 4096
s_add_u32 s55, s46, 4096
buffer_load_dwordx4 v0, s[4:7], s55 offen offset:0 sc1 lds
buffer_load_dwordx4 v0, s[4:7], s55 offen offset:1024 sc1 lds
buffer_load_dwordx4 v0, s[4:7], s55 offen offset:2048 sc1 lds
buffer_load_dwordx4 v0, s[4:7], s55 offen offset:3072 sc1 lds
s_add_u32 m0, s45, 8192
s_add_u32 s55, s46, 8192
buffer_load_dwordx4 v0, s[4:7], s55 offen offset:0 sc1 lds
buffer_load_dwordx4 v0, s[4:7], s55 offen offset:1024 sc1 lds
s_add_u32 s45, s45, 40960
s_cmp_ge_u32 s45, 122880
s_cselect_b32 s55, 122880, 0
s_sub_u32 s45, s45, s55
s_add_u32 s46, s46, s49
s_mov_b32 s49, 0
s_add_u32 m0, s45, 0
s_add_u32 s55, s46, 0
buffer_load_dwordx4 v0, s[4:7], s55 offen offset:0 sc1 lds
buffer_load_dwordx4 v0, s[4:7], s55 offen offset:1024 sc1 lds
buffer_load_dwordx4 v0, s[4:7], s55 offen offset:2048 sc1 lds
buffer_load_dwordx4 v0, s[4:7], s55 offen offset:3072 sc1 lds
s_add_u32 m0, s45, 4096
s_add_u32 s55, s46, 4096
buffer_load_dwordx4 v0, s[4:7], s55 offen offset:0 sc1 lds
buffer_load_dwordx4 v0, s[4:7], s55 offen offset:1024 sc1 lds
buffer_load_dwordx4 v0, s[4:7], s55 offen offset:2048 sc1 lds
buffer_load_dwordx4 v0, s[4:7], s55 offen offset:3072 sc1 lds
s_add_u32 m0, s45, 8192
s_add_u32 s55, s46, 8192
buffer_load_dwordx4 v0, s[4:7], s55 offen offset:0 sc1 lds
buffer_load_dwordx4 v0, s[4:7], s55 offen offset:1024 sc1 lds
s_add_u32 s45, s45, 40960
s_cmp_ge_u32 s45, 122880
s_cselect_b32 s55, 122880, 0
s_sub_u32 s45, s45, s55
s_add_u32 s46, s46, s49
s_mov_b32 s49, 0
s_waitcnt vmcnt(10)
s_barrier
ds_read_b128 v[8:11], v64 offset:0
ds_read_b128 v[12:15], v64 offset:1024
ds_read_b128 v[16:19], v64 offset:2048
ds_read_b128 v[20:23], v64 offset:3072
s_mov_b32 s59, 1
s_waitcnt lgkmcnt(3)
v_mfma_f32_32x32x16_bf16 v[32:47], v[96:99], v[8:11], 0
s_waitcnt lgkmcnt(2)
ds_read_b128 v[24:27], v64 offset:4096
v_mfma_f32_32x32x16_bf16 v[32:47], v[100:103], v[12:15], v[32:47]
s_waitcnt lgkmcnt(2)
ds_read_b128 v[8:11], v64 offset:5120
s_add_u32 m0, s45, 0
s_add_u32 s55, s46, 0
buffer_load_dwordx4 v0, s[4:7], s55 offen offset:0 sc1 lds
buffer_load_dwordx4 v0, s[4:7], s55 offen offset:1024 sc1 lds
v_mfma_f32_32x32x16_bf16 v[32:47], v[104:107], v[16:19], v[32:47]
s_waitcnt lgkmcnt(2)
ds_read_b128 v[12:15], v64 offset:6144
buffer_load_dwordx4 v0, s[4:7], s55 offen offset:2048 sc1 lds
buffer_load_dwordx4 v0, s[4:7], s55 offen offset:3072 sc1 lds
v_mfma_f32_32x32x16_bf16 v[32:47], v[108:111], v[20:23], v[32:47]
s_waitcnt lgkmcnt(2)
ds_read_b128 v[16:19], v64 offset:7168
s_add_u32 m0, s45, 4096
s_add_u32 s55, s46, 4096
buffer_load_dwordx4 v0, s[4:7], s55 offen offset:0 sc1 lds
buffer_load_dwordx4 v0, s[4:7], s55 offen offset:1024 sc1 lds
v_mfma_f32_32x32x16_bf16 v[32:47], v[112:115], v[24:27], v[32:47]
s_waitcnt lgkmcnt(2)
ds_read_b128 v[20:23], v64 offset:8192
buffer_load_dwordx4 v0, s[4:7], s55 offen offset:2048 sc1 lds
buffer_load_dwordx4 v0, s[4:7], s55 offen offset:3072 sc1 lds
v_mfma_f32_32x32x16_bf16 v[32:47], v[116:119], v[8:11], v[32:47]
s_waitcnt lgkmcnt(2)
ds_read_b128 v[24:27], v64 offset:9216
s_add_u32 m0, s45, 8192
s_add_u32 s55, s46, 8192
buffer_load_dwordx4 v0, s[4:7], s55 offen offset:0 sc1 lds
buffer_load_dwordx4 v0, s[4:7], s55 offen offset:1024 sc1 lds
v_mfma_f32_32x32x16_bf16 v[32:47], v[120:123], v[12:15], v[32:47]
s_waitcnt lgkmcnt(2)
ds_read_b128 v[8:11], v64 offset:10240
s_add_u32 s45, s45, 40960
s_cmp_ge_u32 s45, 122880
s_cselect_b32 s55, 122880, 0
s_sub_u32 s45, s45, s55
s_add_u32 s46, s46, s49
s_mov_b32 s49, 0
v_mfma_f32_32x32x16_bf16 v[32:47], v[124:127], v[16:19], v[32:47]
s_waitcnt lgkmcnt(2)
ds_read_b128 v[12:15], v64 offset:11264
v_mfma_f32_32x32x16_bf16 v[32:47], v[128:131], v[20:23], v[32:47]
s_waitcnt lgkmcnt(2)
ds_read_b128 v[16:19], v64 offset:12288
v_mfma_f32_32x32x16_bf16 v[32:47], v[132:135], v[24:27], v[32:47]
s_waitcnt lgkmcnt(2)
ds_read_b128 v[20:23], v64 offset:13312
v_mfma_f32_32x32x16_bf16 v[32:47], v[136:139], v[8:11], v[32:47]
s_waitcnt lgkmcnt(2)
ds_read_b128 v[24:27], v64 offset:14336
v_mfma_f32_32x32x16_bf16 v[32:47], v[140:143], v[12:15], v[32:47]
s_waitcnt lgkmcnt(2)
ds_read_b128 v[8:11], v64 offset:15360
v_mfma_f32_32x32x16_bf16 v[32:47], v[144:147], v[16:19], v[32:47]
s_waitcnt lgkmcnt(2)
ds_read_b128 v[12:15], v64 offset:16384
v_mfma_f32_32x32x16_bf16 v[32:47], v[148:151], v[20:23], v[32:47]
s_waitcnt lgkmcnt(2)
ds_read_b128 v[16:19], v64 offset:17408
v_mfma_f32_32x32x16_bf16 v[32:47], v[152:155], v[24:27], v[32:47]
s_waitcnt lgkmcnt(2)
ds_read_b128 v[20:23], v64 offset:18432
v_mfma_f32_32x32x16_bf16 v[32:47], v[156:159], v[8:11], v[32:47]
s_waitcnt lgkmcnt(2)
ds_read_b128 v[24:27], v64 offset:19456
v_mfma_f32_32x32x16_bf16 v[32:47], v[160:163], v[12:15], v[32:47]
s_waitcnt lgkmcnt(2)
ds_read_b128 v[8:11], v64 offset:20480
v_mfma_f32_32x32x16_bf16 v[32:47], v[164:167], v[16:19], v[32:47]
s_waitcnt lgkmcnt(2)
ds_read_b128 v[12:15], v64 offset:21504
v_mfma_f32_32x32x16_bf16 v[32:47], v[168:171], v[20:23], v[32:47]
s_waitcnt lgkmcnt(2)
ds_read_b128 v[16:19], v64 offset:22528
v_mfma_f32_32x32x16_bf16 v[32:47], v[172:175], v[24:27], v[32:47]
s_waitcnt lgkmcnt(2)
ds_read_b128 v[20:23], v64 offset:23552
v_mfma_f32_32x32x16_bf16 v[32:47], v[176:179], v[8:11], v[32:47]
s_waitcnt lgkmcnt(2)
ds_read_b128 v[24:27], v64 offset:24576
v_mfma_f32_32x32x16_bf16 v[32:47], v[180:183], v[12:15], v[32:47]
s_waitcnt lgkmcnt(2)
ds_read_b128 v[8:11], v64 offset:25600
v_mfma_f32_32x32x16_bf16 v[32:47], v[184:187], v[16:19], v[32:47]
s_waitcnt lgkmcnt(2)
ds_read_b128 v[12:15], v64 offset:26624
v_mfma_f32_32x32x16_bf16 v[32:47], v[188:191], v[20:23], v[32:47]
s_waitcnt lgkmcnt(2)
ds_read_b128 v[16:19], v64 offset:27648
v_mfma_f32_32x32x16_bf16 v[32:47], v[192:195], v[24:27], v[32:47]
s_waitcnt lgkmcnt(2)
ds_read_b128 v[20:23], v64 offset:28672
v_mfma_f32_32x32x16_bf16 v[32:47], v[196:199], v[8:11], v[32:47]
s_waitcnt lgkmcnt(2)
ds_read_b128 v[24:27], v64 offset:29696
v_mfma_f32_32x32x16_bf16 v[32:47], v[200:203], v[12:15], v[32:47]
s_waitcnt lgkmcnt(2)
ds_read_b128 v[8:11], v64 offset:30720
v_mfma_f32_32x32x16_bf16 v[32:47], v[204:207], v[16:19], v[32:47]
s_waitcnt lgkmcnt(2)
ds_read_b128 v[12:15], v64 offset:31744
v_mfma_f32_32x32x16_bf16 v[32:47], v[208:211], v[20:23], v[32:47]
s_waitcnt lgkmcnt(2)
ds_read_b128 v[16:19], v64 offset:32768
v_mfma_f32_32x32x16_bf16 v[32:47], v[212:215], v[24:27], v[32:47]
s_waitcnt lgkmcnt(2)
ds_read_b128 v[20:23], v64 offset:33792
v_mfma_f32_32x32x16_bf16 v[32:47], v[216:219], v[8:11], v[32:47]
s_waitcnt lgkmcnt(2)
ds_read_b128 v[24:27], v64 offset:34816
v_mfma_f32_32x32x16_bf16 v[32:47], v[220:223], v[12:15], v[32:47]
s_waitcnt lgkmcnt(2)
ds_read_b128 v[8:11], v64 offset:35840
v_mfma_f32_32x32x16_bf16 v[32:47], v[224:227], v[16:19], v[32:47]
s_waitcnt lgkmcnt(2)
ds_read_b128 v[12:15], v64 offset:36864
v_mfma_f32_32x32x16_bf16 v[32:47], v[228:231], v[20:23], v[32:47]
s_waitcnt lgkmcnt(2)
ds_read_b128 v[16:19], v64 offset:37888
v_mfma_f32_32x32x16_bf16 v[32:47], v[232:235], v[24:27], v[32:47]
s_waitcnt lgkmcnt(2)
ds_read_b128 v[20:23], v64 offset:38912
v_mfma_f32_32x32x16_bf16 v[32:47], v[236:239], v[8:11], v[32:47]
s_waitcnt lgkmcnt(2)
ds_read_b128 v[24:27], v64 offset:39936
v_mfma_f32_32x32x16_bf16 v[32:47], v[240:243], v[12:15], v[32:47]
s_add_u32 s44, s44, 1
s_cmp_eq_u32 s44, 3
s_mov_b32 s56, 40960
s_cmov_b32 s56, -81920
s_cselect_b32 s44, 0, s44
v_add_u32 v64, s56, v64
s_waitcnt vmcnt(10) lgkmcnt(2)
s_barrier
ds_read_b128 v[8:11], v64 offset:0
v_mfma_f32_32x32x16_bf16 v[32:47], v[244:247], v[16:19], v[32:47]
s_waitcnt lgkmcnt(2)
ds_read_b128 v[12:15], v64 offset:1024
v_mfma_f32_32x32x16_bf16 v[32:47], v[248:251], v[20:23], v[32:47]
s_waitcnt lgkmcnt(2)
ds_read_b128 v[16:19], v64 offset:2048
v_mfma_f32_32x32x16_bf16 v[32:47], v[252:255], v[24:27], v[32:47]
s_waitcnt lgkmcnt(2)
ds_read_b128 v[20:23], v64 offset:3072
k_st_109:
v_mfma_f32_32x32x16_bf16 v[48:63], v[96:99], v[8:11], 0
s_waitcnt lgkmcnt(2)
ds_read_b128 v[24:27], v64 offset:4096
v_mfma_f32_32x32x16_bf16 v[48:63], v[100:103], v[12:15], v[48:63]
s_waitcnt lgkmcnt(2)
ds_read_b128 v[8:11], v64 offset:5120
v_cvt_pk_bf16_f32 v32, v32, v33
v_cvt_pk_bf16_f32 v33, v34, v35
v_mfma_f32_32x32x16_bf16 v[48:63], v[104:107], v[16:19], v[48:63]
s_waitcnt lgkmcnt(2)
ds_read_b128 v[12:15], v64 offset:6144
v_cvt_pk_bf16_f32 v34, v36, v37
v_cvt_pk_bf16_f32 v35, v38, v39
v_mfma_f32_32x32x16_bf16 v[48:63], v[108:111], v[20:23], v[48:63]
s_waitcnt lgkmcnt(2)
ds_read_b128 v[16:19], v64 offset:7168
v_cvt_pk_bf16_f32 v36, v40, v41
v_cvt_pk_bf16_f32 v37, v42, v43
v_mfma_f32_32x32x16_bf16 v[48:63], v[112:115], v[24:27], v[48:63]
s_waitcnt lgkmcnt(2)
ds_read_b128 v[20:23], v64 offset:8192
v_cvt_pk_bf16_f32 v38, v44, v45
v_cvt_pk_bf16_f32 v39, v46, v47
v_mfma_f32_32x32x16_bf16 v[48:63], v[116:119], v[8:11], v[48:63]
s_waitcnt lgkmcnt(2)
ds_read_b128 v[24:27], v64 offset:9216
buffer_store_dwordx4 v[32:35], v1, s[36:39], s48 offen offset:0
buffer_store_dwordx4 v[36:39], v1, s[36:39], s48 offen offset:16
v_mfma_f32_32x32x16_bf16 v[48:63], v[120:123], v[12:15], v[48:63]
s_waitcnt lgkmcnt(2)
ds_read_b128 v[8:11], v64 offset:10240
s_add_u32 s48, s48, 1310720
s_add_u32 m0, s45, 0
s_add_u32 s55, s46, 0
buffer_load_dwordx4 v0, s[4:7], s55 offen offset:0 sc1 lds
v_mfma_f32_32x32x16_bf16 v[48:63], v[124:127], v[16:19], v[48:63]
s_waitcnt lgkmcnt(2)
ds_read_b128 v[12:15], v64 offset:11264
buffer_load_dwordx4 v0, s[4:7], s55 offen offset:1024 sc1 lds
buffer_load_dwordx4 v0, s[4:7], s55 offen offset:2048 sc1 lds
v_mfma_f32_32x32x16_bf16 v[48:63], v[128:131], v[20:23], v[48:63]
s_waitcnt lgkmcnt(2)
ds_read_b128 v[16:19], v64 offset:12288
buffer_load_dwordx4 v0, s[4:7], s55 offen offset:3072 sc1 lds
s_add_u32 m0, s45, 4096
s_add_u32 s55, s46, 4096
buffer_load_dwordx4 v0, s[4:7], s55 offen offset:0 sc1 lds
v_mfma_f32_32x32x16_bf16 v[48:63], v[132:135], v[24:27], v[48:63]
s_waitcnt lgkmcnt(2)
ds_read_b128 v[20:23], v64 offset:13312
buffer_load_dwordx4 v0, s[4:7], s55 offen offset:1024 sc1 lds
buffer_load_dwordx4 v0, s[4:7], s55 offen offset:2048 sc1 lds
v_mfma_f32_32x32x16_bf16 v[48:63], v[136:139], v[8:11], v[48:63]
s_waitcnt lgkmcnt(2)
ds_read_b128 v[24:27], v64 offset:14336
buffer_load_dwordx4 v0, s[4:7], s55 offen offset:3072 sc1 lds
s_add_u32 m0, s45, 8192
s_add_u32 s55, s46, 8192
buffer_load_dwordx4 v0, s[4:7], s55 offen offset:0 sc1 lds
v_mfma_f32_32x32x16_bf16 v[48:63], v[140:143], v[12:15], v[48:63]
s_waitcnt lgkmcnt(2)
ds_read_b128 v[8:11], v64 offset:15360
buffer_load_dwordx4 v0, s[4:7], s55 offen offset:1024 sc1 lds
s_add_u32 s45, s45, 40960
s_cmp_ge_u32 s45, 122880
s_cselect_b32 s55, 122880, 0
s_sub_u32 s45, s45, s55
v_mfma_f32_32x32x16_bf16 v[48:63], v[144:147], v[16:19], v[48:63]
s_waitcnt lgkmcnt(2)
ds_read_b128 v[12:15], v64 offset:16384
s_add_u32 s46, s46, s49
s_mov_b32 s49, 0
v_mfma_f32_32x32x16_bf16 v[48:63], v[148:151], v[20:23], v[48:63]
s_waitcnt lgkmcnt(2)
ds_read_b128 v[16:19], v64 offset:17408
v_mfma_f32_32x32x16_bf16 v[48:63], v[152:155], v[24:27], v[48:63]
s_waitcnt lgkmcnt(2)
ds_read_b128 v[20:23], v64 offset:18432
v_mfma_f32_32x32x16_bf16 v[48:63], v[156:159], v[8:11], v[48:63]
s_waitcnt lgkmcnt(2)
ds_read_b128 v[24:27], v64 offset:19456
v_mfma_f32_32x32x16_bf16 v[48:63], v[160:163], v[12:15], v[48:63]
s_waitcnt lgkmcnt(2)
ds_read_b128 v[8:11], v64 offset:20480
v_mfma_f32_32x32x16_bf16 v[48:63], v[164:167], v[16:19], v[48:63]
s_waitcnt lgkmcnt(2)
ds_read_b128 v[12:15], v64 offset:21504
v_mfma_f32_32x32x16_bf16 v[48:63], v[168:171], v[20:23], v[48:63]
s_waitcnt lgkmcnt(2)
ds_read_b128 v[16:19], v64 offset:22528
v_mfma_f32_32x32x16_bf16 v[48:63], v[172:175], v[24:27], v[48:63]
s_waitcnt lgkmcnt(2)
ds_read_b128 v[20:23], v64 offset:23552
v_mfma_f32_32x32x16_bf16 v[48:63], v[176:179], v[8:11], v[48:63]
s_waitcnt lgkmcnt(2)
ds_read_b128 v[24:27], v64 offset:24576
v_mfma_f32_32x32x16_bf16 v[48:63], v[180:183], v[12:15], v[48:63]
s_waitcnt lgkmcnt(2)
ds_read_b128 v[8:11], v64 offset:25600
v_mfma_f32_32x32x16_bf16 v[48:63], v[184:187], v[16:19], v[48:63]
s_waitcnt lgkmcnt(2)
ds_read_b128 v[12:15], v64 offset:26624
v_mfma_f32_32x32x16_bf16 v[48:63], v[188:191], v[20:23], v[48:63]
s_waitcnt lgkmcnt(2)
ds_read_b128 v[16:19], v64 offset:27648
v_mfma_f32_32x32x16_bf16 v[48:63], v[192:195], v[24:27], v[48:63]
s_waitcnt lgkmcnt(2)
ds_read_b128 v[20:23], v64 offset:28672
v_mfma_f32_32x32x16_bf16 v[48:63], v[196:199], v[8:11], v[48:63]
s_waitcnt lgkmcnt(2)
ds_read_b128 v[24:27], v64 offset:29696
v_mfma_f32_32x32x16_bf16 v[48:63], v[200:203], v[12:15], v[48:63]
s_waitcnt lgkmcnt(2)
ds_read_b128 v[8:11], v64 offset:30720
v_mfma_f32_32x32x16_bf16 v[48:63], v[204:207], v[16:19], v[48:63]
s_waitcnt lgkmcnt(2)
ds_read_b128 v[12:15], v64 offset:31744
v_mfma_f32_32x32x16_bf16 v[48:63], v[208:211], v[20:23], v[48:63]
s_waitcnt lgkmcnt(2)
ds_read_b128 v[16:19], v64 offset:32768
v_mfma_f32_32x32x16_bf16 v[48:63], v[212:215], v[24:27], v[48:63]
s_waitcnt lgkmcnt(2)
ds_read_b128 v[20:23], v64 offset:33792
v_mfma_f32_32x32x16_bf16 v[48:63], v[216:219], v[8:11], v[48:63]
s_waitcnt lgkmcnt(2)
ds_read_b128 v[24:27], v64 offset:34816
v_mfma_f32_32x32x16_bf16 v[48:63], v[220:223], v[12:15], v[48:63]
s_waitcnt lgkmcnt(2)
ds_read_b128 v[8:11], v64 offset:35840
v_mfma_f32_32x32x16_bf16 v[48:63], v[224:227], v[16:19], v[48:63]
s_waitcnt lgkmcnt(2)
ds_read_b128 v[12:15], v64 offset:36864
v_mfma_f32_32x32x16_bf16 v[48:63], v[228:231], v[20:23], v[48:63]
s_waitcnt lgkmcnt(2)
ds_read_b128 v[16:19], v64 offset:37888
v_mfma_f32_32x32x16_bf16 v[48:63], v[232:235], v[24:27], v[48:63]
s_waitcnt lgkmcnt(2)
ds_read_b128 v[20:23], v64 offset:38912
v_mfma_f32_32x32x16_bf16 v[48:63], v[236:239], v[8:11], v[48:63]
s_waitcnt lgkmcnt(2)
ds_read_b128 v[24:27], v64 offset:39936
v_mfma_f32_32x32x16_bf16 v[48:63], v[240:243], v[12:15], v[48:63]
s_add_u32 s44, s44, 1
s_cmp_eq_u32 s44, 3
s_mov_b32 s56, 40960
s_cmov_b32 s56, -81920
s_cselect_b32 s44, 0, s44
v_add_u32 v64, s56, v64
s_waitcnt vmcnt(10) lgkmcnt(2)
s_barrier
ds_read_b128 v[8:11], v64 offset:0
v_mfma_f32_32x32x16_bf16 v[48:63], v[244:247], v[16:19], v[48:63]
s_waitcnt lgkmcnt(2)
ds_read_b128 v[12:15], v64 offset:1024
v_mfma_f32_32x32x16_bf16 v[48:63], v[248:251], v[20:23], v[48:63]
s_waitcnt lgkmcnt(2)
ds_read_b128 v[16:19], v64 offset:2048
v_mfma_f32_32x32x16_bf16 v[48:63], v[252:255], v[24:27], v[48:63]
s_waitcnt lgkmcnt(2)
ds_read_b128 v[20:23], v64 offset:3072
s_nop 9
v_cvt_pk_bf16_f32 v48, v48, v49
v_cvt_pk_bf16_f32 v49, v50, v51
v_cvt_pk_bf16_f32 v50, v52, v53
v_cvt_pk_bf16_f32 v51, v54, v55
v_cvt_pk_bf16_f32 v52, v56, v57
v_cvt_pk_bf16_f32 v53, v58, v59
v_cvt_pk_bf16_f32 v54, v60, v61
v_cvt_pk_bf16_f32 v55, v62, v63
buffer_store_dwordx4 v[48:51], v1, s[36:39], s48 offen offset:0
buffer_store_dwordx4 v[52:55], v1, s[36:39], s48 offen offset:16
s_add_u32 s48, s48, 1310720
s_waitcnt vmcnt(0)
s_endpgm
k_team_3:
s_cmp_eq_u32 s3, 1
s_cbranch_scc1 k_w1_112
s_cmp_eq_u32 s3, 2
s_cbranch_scc1 k_w2_113
s_cmp_eq_u32 s3, 3
s_cbranch_scc1 k_w3_114
k_w0_111:
v_lshrrev_b32 v12, 3, v0
v_lshlrev_b32 v10, 13, v12
v_bfe_u32 v12, v0, 1, 2
v_lshrrev_b32 v13, 4, v0
v_xor_b32 v12, v12, v13
v_lshl_add_u32 v10, v12, 5, v10
v_and_b32 v14, 1, v0
v_lshl_add_u32 v10, v14, 4, v10
v_mul_u32_u24 v11, 1280, v13
v_bfe_u32 v12, v0, 1, 3
v_and_b32 v13, 1, v13
v_lshlrev_b32 v13, 1, v13
v_xor_b32 v12, v12, v13
v_xor_b32 v12, 0, v12
v_lshl_add_u32 v11, v12, 5, v11
v_lshl_add_u32 v11, v14, 4, v11
v_bfe_u32 v12, v0, 5, 1
v_lshlrev_b32 v12, 4, v12
v_bfe_u32 v13, v0, 4, 1
v_lshl_add_u32 v12, v13, 1, v12
v_bfe_u32 v13, v0, 2, 1
v_lshl_add_u32 v12, v13, 2, v12
v_bfe_u32 v13, v0, 3, 1
v_mul_u32_u24 v15, 4224, v13
v_add_u32 v12, v13, v12
v_bfe_u32 v13, v12, 1, 2
v_xor_b32 v13, 0, v13
v_lshlrev_b32 v13, 5, v13
v_lshl_add_u32 v4, v12, 7, v13
v_and_b32 v14, 3, v0
v_lshl_add_u32 v4, v14, 3, v4
v_add_u32 v5, 0x10000, v4
v_add_u32 v6, 0x20000, v4
v_bfe_u32 v12, v0, 4, 1
v_lshlrev_b32 v13, 4, v12
v_lshlrev_b32 v12, 2, v12
v_bfe_u32 v8, v0, 5, 1
v_lshl_add_u32 v13, v8, 2, v13
v_bfe_u32 v8, v0, 2, 1
v_add_u32 v13, v8, v13
v_lshl_add_u32 v12, v8, 1, v12
v_bfe_u32 v8, v0, 3, 1
v_add_u32 v8, 0, v8
v_xor_b32 v12, v12, v8
v_lshlrev_b32 v12, 5, v12
v_lshl_add_u32 v7, v13, 8, v12
v_lshl_add_u32 v7, v14, 3, v7
v_add_u32 v8, 0x10000, v7
v_add_u32 v9, 0x20000, v7
v_lshlrev_b32 v0, 4, v0
v_add_u32 v2, 98304, v0
s_lshl_b32 s49, s30, 8
s_mul_i32 s50, s30, 163840
s_mul_i32 s60, s30, 131072
s_add_u32 s60, s60, 120586240
s_add_u32 s61, s60, 4096
s_add_u32 s62, s60, 8192
s_mov_b32 m0, 0
s_add_u32 s48, s49, 0
buffer_load_dwordx4 v10, s[8:11], s48 offen lds
s_mov_b32 m0, 1024
s_add_u32 s48, s49, 65536
buffer_load_dwordx4 v10, s[8:11], s48 offen lds
s_mov_b32 m0, 8192
s_add_u32 s48, s49, 128
buffer_load_dwordx4 v10, s[8:11], s48 offen lds
s_mov_b32 m0, 9216
s_add_u32 s48, s49, 65664
buffer_load_dwordx4 v10, s[8:11], s48 offen lds
s_mov_b32 m0, 16384
s_add_u32 s48, s49, 128
buffer_load_dwordx4 v10, s[12:15], s48 offen lds
s_mov_b32 m0, 17408
s_add_u32 s48, s49, 65664
buffer_load_dwordx4 v10, s[12:15], s48 offen lds
s_mov_b32 m0, 24576
s_add_u32 s48, s49, 0
buffer_load_dwordx4 v10, s[16:19], s48 offen lds
s_mov_b32 m0, 25600
s_add_u32 s48, s49, 65536
buffer_load_dwordx4 v10, s[16:19], s48 offen lds
s_mov_b32 m0, 32768
s_add_u32 s48, s49, 128
buffer_load_dwordx4 v10, s[16:19], s48 offen lds
s_mov_b32 m0, 33792
s_add_u32 s48, s49, 65664
buffer_load_dwordx4 v10, s[16:19], s48 offen lds
s_mov_b32 m0, 40960
s_add_u32 s48, s49, 524288
buffer_load_dwordx4 v10, s[8:11], s48 offen lds
s_mov_b32 m0, 41984
s_add_u32 s48, s49, 589824
buffer_load_dwordx4 v10, s[8:11], s48 offen lds
s_mov_b32 m0, 49152
s_add_u32 s48, s49, 524416
buffer_load_dwordx4 v10, s[8:11], s48 offen lds
s_mov_b32 m0, 50176
s_add_u32 s48, s49, 589952
buffer_load_dwordx4 v10, s[8:11], s48 offen lds
s_mov_b32 m0, 57344
s_add_u32 s48, s49, 524416
buffer_load_dwordx4 v10, s[12:15], s48 offen lds
s_mov_b32 m0, 58368
s_add_u32 s48, s49, 589952
buffer_load_dwordx4 v10, s[12:15], s48 offen lds
s_mov_b32 m0, 65536
s_add_u32 s48, s49, 524288
buffer_load_dwordx4 v10, s[16:19], s48 offen lds
s_mov_b32 m0, 66560
s_add_u32 s48, s49, 589824
buffer_load_dwordx4 v10, s[16:19], s48 offen lds
s_mov_b32 m0, 73728
s_add_u32 s48, s49, 524416
buffer_load_dwordx4 v10, s[16:19], s48 offen lds
s_mov_b32 m0, 74752
s_add_u32 s48, s49, 589952
buffer_load_dwordx4 v10, s[16:19], s48 offen lds
s_mov_b32 m0, 81920
s_add_u32 s48, s49, 1048576
buffer_load_dwordx4 v10, s[8:11], s48 offen lds
s_mov_b32 m0, 82944
s_add_u32 s48, s49, 1114112
buffer_load_dwordx4 v10, s[8:11], s48 offen lds
s_mov_b32 m0, 90112
s_add_u32 s48, s49, 1048704
buffer_load_dwordx4 v10, s[8:11], s48 offen lds
s_mov_b32 m0, 91136
s_add_u32 s48, s49, 1114240
buffer_load_dwordx4 v10, s[8:11], s48 offen lds
s_mov_b32 m0, 98304
s_add_u32 s48, s49, 1048704
buffer_load_dwordx4 v10, s[12:15], s48 offen lds
s_mov_b32 m0, 99328
s_add_u32 s48, s49, 1114240
buffer_load_dwordx4 v10, s[12:15], s48 offen lds
s_mov_b32 m0, 106496
s_add_u32 s48, s49, 1048576
buffer_load_dwordx4 v10, s[16:19], s48 offen lds
s_mov_b32 m0, 107520
s_add_u32 s48, s49, 1114112
buffer_load_dwordx4 v10, s[16:19], s48 offen lds
s_mov_b32 m0, 114688
s_add_u32 s48, s49, 1572864
buffer_load_dwordx4 v10, s[8:11], s48 offen lds
s_mov_b32 m0, 115712
s_add_u32 s48, s49, 1638400
buffer_load_dwordx4 v10, s[8:11], s48 offen lds
s_mov_b32 m0, 122880
s_add_u32 s48, s49, 1572992
buffer_load_dwordx4 v10, s[8:11], s48 offen lds
s_mov_b32 m0, 123904
s_add_u32 s48, s49, 1638528
buffer_load_dwordx4 v10, s[8:11], s48 offen lds
s_waitcnt vmcnt(24)
s_barrier
s_mov_b32 m0, 131072
s_add_u32 s48, s49, 1572992
buffer_load_dwordx4 v10, s[12:15], s48 offen lds
s_mov_b32 m0, 132096
s_add_u32 s48, s49, 1638528
buffer_load_dwordx4 v10, s[12:15], s48 offen lds
s_mov_b32 m0, 139264
s_add_u32 s48, s49, 1572864
buffer_load_dwordx4 v10, s[16:19], s48 offen lds
s_mov_b32 m0, 140288
s_add_u32 s48, s49, 1638400
buffer_load_dwordx4 v10, s[16:19], s48 offen lds
s_mov_b32 m0, 147456
s_add_u32 s48, s49, 2097152
buffer_load_dwordx4 v10, s[8:11], s48 offen lds
s_mov_b32 m0, 148480
s_add_u32 s48, s49, 2162688
buffer_load_dwordx4 v10, s[8:11], s48 offen lds
s_mov_b32 m0, 155648
s_add_u32 s48, s49, 2097280
buffer_load_dwordx4 v10, s[8:11], s48 offen lds
s_mov_b32 m0, 156672
s_add_u32 s48, s49, 2162816
buffer_load_dwordx4 v10, s[8:11], s48 offen lds
ds_read_b64_tr_b16 a[0:1], v4 offset:0
ds_read_b64_tr_b16 a[2:3], v4 offset:1024
ds_read_b64_tr_b16 a[4:5], v4 offset:4096
ds_read_b64_tr_b16 a[6:7], v4 offset:5120
ds_read_b64_tr_b16 a[8:9], v4 offset:8192
ds_read_b64_tr_b16 a[10:11], v4 offset:9216
ds_read_b64_tr_b16 a[12:13], v4 offset:12288
ds_read_b64_tr_b16 a[14:15], v4 offset:13312
ds_read_b64_tr_b16 a[16:17], v4 offset:16384
ds_read_b64_tr_b16 a[18:19], v4 offset:17408
ds_read_b64_tr_b16 a[20:21], v4 offset:20480
ds_read_b64_tr_b16 a[22:23], v4 offset:21504
ds_read_b64_tr_b16 v[40:41], v4 offset:24576
ds_read_b64_tr_b16 v[42:43], v4 offset:25600
ds_read_b64_tr_b16 v[44:45], v4 offset:28672
ds_read_b64_tr_b16 v[46:47], v4 offset:29696
s_waitcnt lgkmcnt(0)
buffer_store_dwordx4 v[40:43], v0, s[4:7], s60 offen offset:0
buffer_store_dwordx4 v[44:47], v0, s[4:7], s60 offen offset:1024
s_waitcnt vmcnt(26)
s_barrier
s_mov_b32 m0, 0
s_add_u32 s48, s49, 2097280
buffer_load_dwordx4 v10, s[12:15], s48 offen lds
s_mov_b32 m0, 1024
s_add_u32 s48, s49, 2162816
buffer_load_dwordx4 v10, s[12:15], s48 offen lds
s_mov_b32 m0, 8192
s_add_u32 s48, s49, 2097152
buffer_load_dwordx4 v10, s[16:19], s48 offen lds
s_mov_b32 m0, 9216
s_add_u32 s48, s49, 2162688
buffer_load_dwordx4 v10, s[16:19], s48 offen lds
s_mov_b32 m0, 16384
s_add_u32 s48, s49, 2621440
buffer_load_dwordx4 v10, s[8:11], s48 offen lds
s_mov_b32 m0, 17408
s_add_u32 s48, s49, 2686976
buffer_load_dwordx4 v10, s[8:11], s48 offen lds
s_mov_b32 m0, 24576
s_add_u32 s48, s49, 2621568
buffer_load_dwordx4 v10, s[8:11], s48 offen lds
s_mov_b32 m0, 25600
s_add_u32 s48, s49, 2687104
buffer_load_dwordx4 v10, s[8:11], s48 offen lds
ds_read_b64_tr_b16 v[16:17], v4 offset:32768
ds_read_b64_tr_b16 v[18:19], v4 offset:33792
ds_read_b64_tr_b16 v[20:21], v4 offset:36864
ds_read_b64_tr_b16 v[22:23], v4 offset:37888
ds_read_b64_tr_b16 a[24:25], v4 offset:40960
ds_read_b64_tr_b16 a[26:27], v4 offset:41984
ds_read_b64_tr_b16 a[28:29], v4 offset:45056
ds_read_b64_tr_b16 a[30:31], v4 offset:46080
ds_read_b64_tr_b16 a[32:33], v4 offset:49152
ds_read_b64_tr_b16 a[34:35], v4 offset:50176
ds_read_b64_tr_b16 a[36:37], v4 offset:53248
ds_read_b64_tr_b16 a[38:39], v4 offset:54272
ds_read_b64_tr_b16 a[40:41], v4 offset:57344
ds_read_b64_tr_b16 a[42:43], v4 offset:58368
ds_read_b64_tr_b16 a[44:45], v4 offset:61440
ds_read_b64_tr_b16 a[46:47], v4 offset:62464
s_waitcnt lgkmcnt(0)
buffer_store_dwordx4 v[16:19], v0, s[4:7], s60 offen offset:2048
buffer_store_dwordx4 v[20:23], v0, s[4:7], s60 offen offset:3072
s_waitcnt vmcnt(28)
s_barrier
s_mov_b32 m0, 32768
s_add_u32 s48, s49, 2621568
buffer_load_dwordx4 v10, s[12:15], s48 offen lds
s_mov_b32 m0, 33792
s_add_u32 s48, s49, 2687104
buffer_load_dwordx4 v10, s[12:15], s48 offen lds
s_mov_b32 m0, 40960
s_add_u32 s48, s49, 2621440
buffer_load_dwordx4 v10, s[16:19], s48 offen lds
s_mov_b32 m0, 41984
s_add_u32 s48, s49, 2686976
buffer_load_dwordx4 v10, s[16:19], s48 offen lds
s_mov_b32 m0, 49152
s_add_u32 s48, s49, 3145856
buffer_load_dwordx4 v10, s[8:11], s48 offen lds
s_mov_b32 m0, 50176
s_add_u32 s48, s49, 3211392
buffer_load_dwordx4 v10, s[8:11], s48 offen lds
s_mov_b32 m0, 57344
s_add_u32 s48, s49, 3670016
buffer_load_dwordx4 v10, s[8:11], s48 offen lds
s_mov_b32 m0, 58368
s_add_u32 s48, s49, 3735552
buffer_load_dwordx4 v10, s[8:11], s48 offen lds
ds_read_b64_tr_b16 a[176:177], v5 offset:0
ds_read_b64_tr_b16 a[178:179], v5 offset:1024
ds_read_b64_tr_b16 a[180:181], v5 offset:4096
ds_read_b64_tr_b16 a[182:183], v5 offset:5120
ds_read_b64_tr_b16 v[232:233], v5 offset:8192
ds_read_b64_tr_b16 v[234:235], v5 offset:9216
ds_read_b64_tr_b16 v[236:237], v5 offset:12288
ds_read_b64_tr_b16 v[238:239], v5 offset:13312
ds_read_b64_tr_b16 a[48:49], v5 offset:16384
ds_read_b64_tr_b16 a[50:51], v5 offset:17408
ds_read_b64_tr_b16 a[52:53], v5 offset:20480
ds_read_b64_tr_b16 a[54:55], v5 offset:21504
ds_read_b64_tr_b16 a[56:57], v5 offset:24576
ds_read_b64_tr_b16 a[58:59], v5 offset:25600
ds_read_b64_tr_b16 a[60:61], v5 offset:28672
ds_read_b64_tr_b16 a[62:63], v5 offset:29696
s_waitcnt lgkmcnt(0)
s_waitcnt vmcnt(28)
s_barrier
s_mov_b32 m0, 65536
s_add_u32 s48, s49, 3670144
buffer_load_dwordx4 v10, s[8:11], s48 offen lds
s_mov_b32 m0, 66560
s_add_u32 s48, s49, 3735680
buffer_load_dwordx4 v10, s[8:11], s48 offen lds
s_mov_b32 m0, 73728
s_add_u32 s48, s49, 4194304
buffer_load_dwordx4 v10, s[8:11], s48 offen lds
s_mov_b32 m0, 74752
s_add_u32 s48, s49, 4259840
buffer_load_dwordx4 v10, s[8:11], s48 offen lds
s_mov_b32 m0, 81920
s_add_u32 s48, s49, 4194432
buffer_load_dwordx4 v10, s[8:11], s48 offen lds
s_mov_b32 m0, 82944
s_add_u32 s48, s49, 4259968
buffer_load_dwordx4 v10, s[8:11], s48 offen lds
s_mov_b32 m0, 90112
s_add_u32 s48, s49, 4718592
buffer_load_dwordx4 v10, s[8:11], s48 offen lds
s_mov_b32 m0, 91136
s_add_u32 s48, s49, 4784128
buffer_load_dwordx4 v10, s[8:11], s48 offen lds
ds_read_b64_tr_b16 a[64:65], v5 offset:32768
ds_read_b64_tr_b16 a[66:67], v5 offset:33792
ds_read_b64_tr_b16 a[68:69], v5 offset:36864
ds_read_b64_tr_b16 a[70:71], v5 offset:37888
ds_read_b64_tr_b16 a[72:73], v5 offset:40960
ds_read_b64_tr_b16 a[74:75], v5 offset:41984
ds_read_b64_tr_b16 a[76:77], v5 offset:45056
ds_read_b64_tr_b16 a[78:79], v5 offset:46080
ds_read_b64_tr_b16 a[80:81], v5 offset:49152
ds_read_b64_tr_b16 a[82:83], v5 offset:50176
ds_read_b64_tr_b16 a[84:85], v5 offset:53248
ds_read_b64_tr_b16 a[86:87], v5 offset:54272
ds_read_b64_tr_b16 a[88:89], v5 offset:57344
ds_read_b64_tr_b16 a[90:91], v5 offset:58368
ds_read_b64_tr_b16 a[92:93], v5 offset:61440
ds_read_b64_tr_b16 a[94:95], v5 offset:62464
s_waitcnt lgkmcnt(0)
s_waitcnt vmcnt(28)
s_barrier
s_mov_b32 m0, 98304
s_add_u32 s48, s49, 4718720
buffer_load_dwordx4 v10, s[8:11], s48 offen lds
s_mov_b32 m0, 99328
s_add_u32 s48, s49, 4784256
buffer_load_dwordx4 v10, s[8:11], s48 offen lds
s_mov_b32 m0, 106496
s_add_u32 s48, s49, 3145728
buffer_load_dwordx4 v10, s[12:15], s48 offen lds
s_mov_b32 m0, 107520
s_add_u32 s48, s49, 3211264
buffer_load_dwordx4 v10, s[12:15], s48 offen lds
s_mov_b32 m0, 114688
s_add_u32 s48, s49, 3145856
buffer_load_dwordx4 v10, s[12:15], s48 offen lds
s_mov_b32 m0, 115712
s_add_u32 s48, s49, 3211392
buffer_load_dwordx4 v10, s[12:15], s48 offen lds
s_mov_b32 m0, 122880
s_add_u32 s48, s49, 3670016
buffer_load_dwordx4 v10, s[12:15], s48 offen lds
s_mov_b32 m0, 123904
s_add_u32 s48, s49, 3735552
buffer_load_dwordx4 v10, s[12:15], s48 offen lds
ds_read_b64_tr_b16 a[96:97], v6 offset:0
ds_read_b64_tr_b16 a[98:99], v6 offset:1024
ds_read_b64_tr_b16 a[100:101], v6 offset:4096
ds_read_b64_tr_b16 a[102:103], v6 offset:5120
ds_read_b64_tr_b16 a[104:105], v6 offset:8192
ds_read_b64_tr_b16 a[106:107], v6 offset:9216
ds_read_b64_tr_b16 a[108:109], v6 offset:12288
ds_read_b64_tr_b16 a[110:111], v6 offset:13312
ds_read_b64_tr_b16 a[112:113], v6 offset:16384
ds_read_b64_tr_b16 a[114:115], v6 offset:17408
ds_read_b64_tr_b16 a[116:117], v6 offset:20480
ds_read_b64_tr_b16 a[118:119], v6 offset:21504
ds_read_b64_tr_b16 a[120:121], v6 offset:24576
ds_read_b64_tr_b16 a[122:123], v6 offset:25600
ds_read_b64_tr_b16 a[124:125], v6 offset:28672
ds_read_b64_tr_b16 a[126:127], v6 offset:29696
s_waitcnt lgkmcnt(0)
s_waitcnt vmcnt(26)
s_barrier
s_mov_b32 m0, 131072
s_add_u32 s48, s49, 3670144
buffer_load_dwordx4 v10, s[12:15], s48 offen lds
s_mov_b32 m0, 132096
s_add_u32 s48, s49, 3735680
buffer_load_dwordx4 v10, s[12:15], s48 offen lds
s_mov_b32 m0, 139264
s_add_u32 s48, s49, 4194304
buffer_load_dwordx4 v10, s[12:15], s48 offen lds
s_mov_b32 m0, 140288
s_add_u32 s48, s49, 4259840
buffer_load_dwordx4 v10, s[12:15], s48 offen lds
s_mov_b32 m0, 147456
s_add_u32 s48, s49, 4194432
buffer_load_dwordx4 v10, s[12:15], s48 offen lds
s_mov_b32 m0, 148480
s_add_u32 s48, s49, 4259968
buffer_load_dwordx4 v10, s[12:15], s48 offen lds
s_mov_b32 m0, 155648
s_add_u32 s48, s49, 4718592
buffer_load_dwordx4 v10, s[12:15], s48 offen lds
s_mov_b32 m0, 156672
s_add_u32 s48, s49, 4784128
buffer_load_dwordx4 v10, s[12:15], s48 offen lds
ds_read_b64_tr_b16 a[128:129], v4 offset:0
ds_read_b64_tr_b16 a[130:131], v4 offset:1024
ds_read_b64_tr_b16 a[132:133], v4 offset:4096
ds_read_b64_tr_b16 a[134:135], v4 offset:5120
ds_read_b64_tr_b16 a[136:137], v4 offset:8192
ds_read_b64_tr_b16 a[138:139], v4 offset:9216
ds_read_b64_tr_b16 a[140:141], v4 offset:12288
ds_read_b64_tr_b16 a[142:143], v4 offset:13312
ds_read_b64_tr_b16 a[144:145], v4 offset:16384
ds_read_b64_tr_b16 a[146:147], v4 offset:17408
ds_read_b64_tr_b16 a[148:149], v4 offset:20480
ds_read_b64_tr_b16 a[150:151], v4 offset:21504
ds_read_b64_tr_b16 a[152:153], v4 offset:24576
ds_read_b64_tr_b16 a[154:155], v4 offset:25600
ds_read_b64_tr_b16 a[156:157], v4 offset:28672
ds_read_b64_tr_b16 a[158:159], v4 offset:29696
s_waitcnt lgkmcnt(0)
s_waitcnt vmcnt(24)
s_barrier
s_mov_b32 m0, 0
s_add_u32 s48, s49, 4718720
buffer_load_dwordx4 v10, s[12:15], s48 offen lds
s_mov_b32 m0, 1024
s_add_u32 s48, s49, 4784256
buffer_load_dwordx4 v10, s[12:15], s48 offen lds
s_mov_b32 m0, 8192
s_add_u32 s48, s49, 3145728
buffer_load_dwordx4 v10, s[16:19], s48 offen lds
s_mov_b32 m0, 9216
s_add_u32 s48, s49, 3211264
buffer_load_dwordx4 v10, s[16:19], s48 offen lds
s_mov_b32 m0, 16384
s_add_u32 s48, s49, 3145856
buffer_load_dwordx4 v10, s[16:19], s48 offen lds
s_mov_b32 m0, 17408
s_add_u32 s48, s49, 3211392
buffer_load_dwordx4 v10, s[16:19], s48 offen lds
s_mov_b32 m0, 24576
s_add_u32 s48, s49, 3670016
buffer_load_dwordx4 v10, s[16:19], s48 offen lds
s_mov_b32 m0, 25600
s_add_u32 s48, s49, 3735552
buffer_load_dwordx4 v10, s[16:19], s48 offen lds
ds_read_b64_tr_b16 a[160:161], v4 offset:32768
ds_read_b64_tr_b16 a[162:163], v4 offset:33792
ds_read_b64_tr_b16 a[164:165], v4 offset:36864
ds_read_b64_tr_b16 a[166:167], v4 offset:37888
ds_read_b64_tr_b16 a[168:169], v4 offset:40960
ds_read_b64_tr_b16 a[170:171], v4 offset:41984
ds_read_b64_tr_b16 a[172:173], v4 offset:45056
ds_read_b64_tr_b16 a[174:175], v4 offset:46080
ds_read_b64_tr_b16 a[192:193], v4 offset:49152
ds_read_b64_tr_b16 a[194:195], v4 offset:50176
ds_read_b64_tr_b16 a[196:197], v4 offset:53248
ds_read_b64_tr_b16 a[198:199], v4 offset:54272
ds_read_b64_tr_b16 v[240:241], v4 offset:57344
ds_read_b64_tr_b16 v[242:243], v4 offset:58368
ds_read_b64_tr_b16 v[244:245], v4 offset:61440
ds_read_b64_tr_b16 v[246:247], v4 offset:62464
s_waitcnt lgkmcnt(0)
s_waitcnt vmcnt(24)
s_barrier
s_mov_b32 m0, 32768
s_add_u32 s48, s49, 3670144
buffer_load_dwordx4 v10, s[16:19], s48 offen lds
s_mov_b32 m0, 33792
s_add_u32 s48, s49, 3735680
buffer_load_dwordx4 v10, s[16:19], s48 offen lds
s_mov_b32 m0, 40960
s_add_u32 s48, s49, 4194304
buffer_load_dwordx4 v10, s[16:19], s48 offen lds
s_mov_b32 m0, 41984
s_add_u32 s48, s49, 4259840
buffer_load_dwordx4 v10, s[16:19], s48 offen lds
s_mov_b32 m0, 49152
s_add_u32 s48, s49, 4194432
buffer_load_dwordx4 v10, s[16:19], s48 offen lds
s_mov_b32 m0, 50176
s_add_u32 s48, s49, 4259968
buffer_load_dwordx4 v10, s[16:19], s48 offen lds
s_mov_b32 m0, 57344
s_add_u32 s48, s49, 4718592
buffer_load_dwordx4 v10, s[16:19], s48 offen lds
s_mov_b32 m0, 58368
s_add_u32 s48, s49, 4784128
buffer_load_dwordx4 v10, s[16:19], s48 offen lds
ds_read_b64_tr_b16 a[200:201], v5 offset:0
ds_read_b64_tr_b16 a[202:203], v5 offset:1024
ds_read_b64_tr_b16 a[204:205], v5 offset:4096
ds_read_b64_tr_b16 a[206:207], v5 offset:5120
ds_read_b64_tr_b16 a[208:209], v5 offset:8192
ds_read_b64_tr_b16 a[210:211], v5 offset:9216
ds_read_b64_tr_b16 a[212:213], v5 offset:12288
ds_read_b64_tr_b16 a[214:215], v5 offset:13312
ds_read_b64_tr_b16 a[216:217], v5 offset:16384
ds_read_b64_tr_b16 a[218:219], v5 offset:17408
ds_read_b64_tr_b16 a[220:221], v5 offset:20480
ds_read_b64_tr_b16 a[222:223], v5 offset:21504
ds_read_b64_tr_b16 a[224:225], v5 offset:24576
ds_read_b64_tr_b16 a[226:227], v5 offset:25600
ds_read_b64_tr_b16 a[228:229], v5 offset:28672
ds_read_b64_tr_b16 a[230:231], v5 offset:29696
s_waitcnt lgkmcnt(0)
s_waitcnt vmcnt(24)
s_barrier
s_mov_b32 m0, 65536
s_add_u32 s48, s49, 4718720
buffer_load_dwordx4 v10, s[16:19], s48 offen lds
s_mov_b32 m0, 66560
s_add_u32 s48, s49, 4784256
buffer_load_dwordx4 v10, s[16:19], s48 offen lds
s_mov_b32 m0, 73728
s_add_u32 s48, s50, 0
buffer_load_dwordx4 v11, s[20:23], s48 offen lds
s_mov_b32 m0, 74752
s_add_u32 s48, s50, 5120
buffer_load_dwordx4 v11, s[20:23], s48 offen lds
s_mov_b32 m0, 81920
s_add_u32 s48, s50, 20480
buffer_load_dwordx4 v11, s[20:23], s48 offen lds
s_mov_b32 m0, 82944
s_add_u32 s48, s50, 25600
buffer_load_dwordx4 v11, s[20:23], s48 offen lds
s_mov_b32 m0, 90112
s_add_u32 s48, s50, 40960
buffer_load_dwordx4 v11, s[20:23], s48 offen lds
s_mov_b32 m0, 91136
s_add_u32 s48, s50, 46080
buffer_load_dwordx4 v11, s[20:23], s48 offen lds
ds_read_b64_tr_b16 a[232:233], v5 offset:32768
ds_read_b64_tr_b16 a[234:235], v5 offset:33792
ds_read_b64_tr_b16 a[236:237], v5 offset:36864
ds_read_b64_tr_b16 a[238:239], v5 offset:37888
ds_read_b64_tr_b16 v[248:249], v5 offset:40960
ds_read_b64_tr_b16 v[250:251], v5 offset:41984
ds_read_b64_tr_b16 v[252:253], v5 offset:45056
ds_read_b64_tr_b16 v[254:255], v5 offset:46080
ds_read_b64_tr_b16 a[240:241], v5 offset:49152
ds_read_b64_tr_b16 a[242:243], v5 offset:50176
ds_read_b64_tr_b16 a[244:245], v5 offset:53248
ds_read_b64_tr_b16 a[246:247], v5 offset:54272
ds_read_b64_tr_b16 a[248:249], v5 offset:57344
ds_read_b64_tr_b16 a[250:251], v5 offset:58368
ds_read_b64_tr_b16 a[252:253], v5 offset:61440
ds_read_b64_tr_b16 a[254:255], v5 offset:62464
s_waitcnt lgkmcnt(0)
s_waitcnt vmcnt(24)
s_barrier
s_mov_b32 m0, 98304
s_add_u32 s48, s50, 61440
buffer_load_dwordx4 v11, s[20:23], s48 offen lds
s_mov_b32 m0, 99328
s_add_u32 s48, s50, 66560
buffer_load_dwordx4 v11, s[20:23], s48 offen lds
s_mov_b32 m0, 106496
s_add_u32 s48, s50, 256
buffer_load_dwordx4 v11, s[20:23], s48 offen lds
s_mov_b32 m0, 107520
s_add_u32 s48, s50, 5376
buffer_load_dwordx4 v11, s[20:23], s48 offen lds
s_mov_b32 m0, 114688
s_add_u32 s48, s50, 20736
buffer_load_dwordx4 v11, s[20:23], s48 offen lds
s_mov_b32 m0, 115712
s_add_u32 s48, s50, 25856
buffer_load_dwordx4 v11, s[20:23], s48 offen lds
s_mov_b32 m0, 122880
s_add_u32 s48, s50, 41216
buffer_load_dwordx4 v11, s[20:23], s48 offen lds
s_mov_b32 m0, 123904
s_add_u32 s48, s50, 46336
buffer_load_dwordx4 v11, s[20:23], s48 offen lds
ds_read_b64_tr_b16 v[72:73], v6 offset:0
ds_read_b64_tr_b16 v[74:75], v6 offset:1024
ds_read_b64_tr_b16 v[76:77], v6 offset:4096
ds_read_b64_tr_b16 v[78:79], v6 offset:5120
ds_read_b64_tr_b16 v[80:81], v6 offset:8192
ds_read_b64_tr_b16 v[82:83], v6 offset:9216
ds_read_b64_tr_b16 v[84:85], v6 offset:12288
ds_read_b64_tr_b16 v[86:87], v6 offset:13312
ds_read_b64_tr_b16 v[88:89], v6 offset:16384
ds_read_b64_tr_b16 v[90:91], v6 offset:17408
ds_read_b64_tr_b16 v[92:93], v6 offset:20480
ds_read_b64_tr_b16 v[94:95], v6 offset:21504
ds_read_b64_tr_b16 v[96:97], v6 offset:24576
ds_read_b64_tr_b16 v[98:99], v6 offset:25600
ds_read_b64_tr_b16 v[100:101], v6 offset:28672
ds_read_b64_tr_b16 v[102:103], v6 offset:29696
s_waitcnt lgkmcnt(0)
s_waitcnt vmcnt(24)
s_barrier
s_mov_b32 m0, 131072
s_add_u32 s48, s50, 61696
buffer_load_dwordx4 v11, s[20:23], s48 offen lds
s_mov_b32 m0, 132096
s_add_u32 s48, s50, 66816
buffer_load_dwordx4 v11, s[20:23], s48 offen lds
s_mov_b32 m0, 139264
s_add_u32 s48, s50, 512
buffer_load_dwordx4 v11, s[20:23], s48 offen lds
s_mov_b32 m0, 140288
s_add_u32 s48, s50, 5632
buffer_load_dwordx4 v11, s[20:23], s48 offen lds
s_mov_b32 m0, 147456
s_add_u32 s48, s50, 20992
buffer_load_dwordx4 v11, s[20:23], s48 offen lds
s_mov_b32 m0, 148480
s_add_u32 s48, s50, 26112
buffer_load_dwordx4 v11, s[20:23], s48 offen lds
s_mov_b32 m0, 155648
s_add_u32 s48, s50, 41472
buffer_load_dwordx4 v11, s[20:23], s48 offen lds
s_mov_b32 m0, 156672
s_add_u32 s48, s50, 46592
buffer_load_dwordx4 v11, s[20:23], s48 offen lds
ds_read_b64_tr_b16 v[104:105], v4 offset:0
ds_read_b64_tr_b16 v[106:107], v4 offset:1024
ds_read_b64_tr_b16 v[108:109], v4 offset:4096
ds_read_b64_tr_b16 v[110:111], v4 offset:5120
ds_read_b64_tr_b16 v[112:113], v4 offset:8192
ds_read_b64_tr_b16 v[114:115], v4 offset:9216
ds_read_b64_tr_b16 v[116:117], v4 offset:12288
ds_read_b64_tr_b16 v[118:119], v4 offset:13312
ds_read_b64_tr_b16 v[120:121], v4 offset:16384
ds_read_b64_tr_b16 v[122:123], v4 offset:17408
ds_read_b64_tr_b16 v[124:125], v4 offset:20480
ds_read_b64_tr_b16 v[126:127], v4 offset:21504
ds_read_b64_tr_b16 v[128:129], v4 offset:24576
ds_read_b64_tr_b16 v[130:131], v4 offset:25600
ds_read_b64_tr_b16 v[132:133], v4 offset:28672
ds_read_b64_tr_b16 v[134:135], v4 offset:29696
s_waitcnt lgkmcnt(0)
s_waitcnt vmcnt(24)
s_barrier
s_mov_b32 m0, 0
s_add_u32 s48, s50, 61952
buffer_load_dwordx4 v11, s[20:23], s48 offen lds
s_mov_b32 m0, 1024
s_add_u32 s48, s50, 67072
buffer_load_dwordx4 v11, s[20:23], s48 offen lds
s_mov_b32 m0, 8192
s_add_u32 s48, s49, 0
buffer_load_dwordx4 v10, s[12:15], s48 offen lds
s_mov_b32 m0, 9216
s_add_u32 s48, s49, 65536
buffer_load_dwordx4 v10, s[12:15], s48 offen lds
s_mov_b32 m0, 16384
s_add_u32 s48, s49, 524288
buffer_load_dwordx4 v10, s[12:15], s48 offen lds
s_mov_b32 m0, 17408
s_add_u32 s48, s49, 589824
buffer_load_dwordx4 v10, s[12:15], s48 offen lds
s_mov_b32 m0, 24576
s_add_u32 s48, s49, 1048576
buffer_load_dwordx4 v10, s[12:15], s48 offen lds
s_mov_b32 m0, 25600
s_add_u32 s48, s49, 1114112
buffer_load_dwordx4 v10, s[12:15], s48 offen lds
ds_read_b64_tr_b16 v[136:137], v4 offset:32768
ds_read_b64_tr_b16 v[138:139], v4 offset:33792
ds_read_b64_tr_b16 v[140:141], v4 offset:36864
ds_read_b64_tr_b16 v[142:143], v4 offset:37888
ds_read_b64_tr_b16 v[144:145], v4 offset:40960
ds_read_b64_tr_b16 v[146:147], v4 offset:41984
ds_read_b64_tr_b16 v[148:149], v4 offset:45056
ds_read_b64_tr_b16 v[150:151], v4 offset:46080
ds_read_b64_tr_b16 v[152:153], v4 offset:49152
ds_read_b64_tr_b16 v[154:155], v4 offset:50176
ds_read_b64_tr_b16 v[156:157], v4 offset:53248
ds_read_b64_tr_b16 v[158:159], v4 offset:54272
ds_read_b64_tr_b16 v[160:161], v4 offset:57344
ds_read_b64_tr_b16 v[162:163], v4 offset:58368
ds_read_b64_tr_b16 v[164:165], v4 offset:61440
ds_read_b64_tr_b16 v[166:167], v4 offset:62464
s_waitcnt lgkmcnt(0)
s_waitcnt vmcnt(24)
s_barrier
s_mov_b32 m0, 32768
s_add_u32 s48, s49, 1572864
buffer_load_dwordx4 v10, s[12:15], s48 offen lds
s_mov_b32 m0, 33792
s_add_u32 s48, s49, 1638400
buffer_load_dwordx4 v10, s[12:15], s48 offen lds
s_mov_b32 m0, 40960
s_add_u32 s48, s49, 2097152
buffer_load_dwordx4 v10, s[12:15], s48 offen lds
s_mov_b32 m0, 41984
s_add_u32 s48, s49, 2162688
buffer_load_dwordx4 v10, s[12:15], s48 offen lds
s_mov_b32 m0, 49152
s_add_u32 s48, s49, 2621440
buffer_load_dwordx4 v10, s[12:15], s48 offen lds
s_mov_b32 m0, 50176
s_add_u32 s48, s49, 2686976
buffer_load_dwordx4 v10, s[12:15], s48 offen lds
s_mov_b32 m0, 57344
s_add_u32 s48, s49, 1048704
buffer_load_dwordx4 v10, s[16:19], s48 offen lds
s_mov_b32 m0, 58368
s_add_u32 s48, s49, 1114240
buffer_load_dwordx4 v10, s[16:19], s48 offen lds
ds_read_b64_tr_b16 v[168:169], v5 offset:0
ds_read_b64_tr_b16 v[170:171], v5 offset:1024
ds_read_b64_tr_b16 v[172:173], v5 offset:4096
ds_read_b64_tr_b16 v[174:175], v5 offset:5120
v_xor_b32 v12, v15, v8
ds_read_b64_tr_b16 v[24:25], v12 offset:8192
ds_read_b64_tr_b16 v[26:27], v12 offset:8704
ds_read_b64_tr_b16 v[28:29], v12 offset:10240
ds_read_b64_tr_b16 v[30:31], v12 offset:10752
ds_read_b64_tr_b16 v[176:177], v8 offset:16384
ds_read_b64_tr_b16 v[178:179], v8 offset:16896
ds_read_b64_tr_b16 v[180:181], v8 offset:18432
ds_read_b64_tr_b16 v[182:183], v8 offset:18944
ds_read_b64_tr_b16 v[184:185], v8 offset:24576
ds_read_b64_tr_b16 v[186:187], v8 offset:25088
ds_read_b64_tr_b16 v[188:189], v8 offset:26624
ds_read_b64_tr_b16 v[190:191], v8 offset:27136
s_waitcnt lgkmcnt(0)
buffer_store_dwordx4 v[24:27], v0, s[4:7], s61 offen offset:0
buffer_store_dwordx4 v[28:31], v0, s[4:7], s61 offen offset:1024
s_waitcnt vmcnt(26)
s_barrier
s_mov_b32 m0, 65536
s_add_u32 s48, s49, 1572992
buffer_load_dwordx4 v10, s[16:19], s48 offen lds
s_mov_b32 m0, 66560
s_add_u32 s48, s49, 1638528
buffer_load_dwordx4 v10, s[16:19], s48 offen lds
s_mov_b32 m0, 73728
s_add_u32 s48, s49, 2097280
buffer_load_dwordx4 v10, s[16:19], s48 offen lds
s_mov_b32 m0, 74752
s_add_u32 s48, s49, 2162816
buffer_load_dwordx4 v10, s[16:19], s48 offen lds
s_mov_b32 m0, 81920
s_add_u32 s48, s49, 2621568
buffer_load_dwordx4 v10, s[16:19], s48 offen lds
s_mov_b32 m0, 82944
s_add_u32 s48, s49, 2687104
buffer_load_dwordx4 v10, s[16:19], s48 offen lds
s_mov_b32 m0, 90112
s_add_u32 s48, s50, 768
buffer_load_dwordx4 v11, s[20:23], s48 offen lds
s_mov_b32 m0, 91136
s_add_u32 s48, s50, 5888
buffer_load_dwordx4 v11, s[20:23], s48 offen lds
ds_read_b64_tr_b16 v[192:193], v8 offset:32768
ds_read_b64_tr_b16 v[194:195], v8 offset:33280
ds_read_b64_tr_b16 v[196:197], v8 offset:34816
ds_read_b64_tr_b16 v[198:199], v8 offset:35328
v_xor_b32 v12, v15, v8
ds_read_b64_tr_b16 v[24:25], v12 offset:40960
ds_read_b64_tr_b16 v[26:27], v12 offset:41472
ds_read_b64_tr_b16 v[28:29], v12 offset:43008
ds_read_b64_tr_b16 v[30:31], v12 offset:43520
ds_read_b64_tr_b16 a[184:185], v8 offset:49152
ds_read_b64_tr_b16 a[186:187], v8 offset:49664
ds_read_b64_tr_b16 a[188:189], v8 offset:51200
ds_read_b64_tr_b16 a[190:191], v8 offset:51712
ds_read_b64_tr_b16 v[224:225], v8 offset:57344
ds_read_b64_tr_b16 v[226:227], v8 offset:57856
ds_read_b64_tr_b16 v[228:229], v8 offset:59392
ds_read_b64_tr_b16 v[230:231], v8 offset:59904
s_waitcnt lgkmcnt(0)
buffer_store_dwordx4 v[24:27], v0, s[4:7], s61 offen offset:2048
buffer_store_dwordx4 v[28:31], v0, s[4:7], s61 offen offset:3072
s_waitcnt vmcnt(28)
s_barrier
s_mov_b32 m0, 98304
s_add_u32 s48, s50, 21248
buffer_load_dwordx4 v11, s[20:23], s48 offen lds
s_mov_b32 m0, 99328
s_add_u32 s48, s50, 26368
buffer_load_dwordx4 v11, s[20:23], s48 offen lds
s_mov_b32 m0, 106496
s_add_u32 s48, s50, 41728
buffer_load_dwordx4 v11, s[20:23], s48 offen lds
s_mov_b32 m0, 107520
s_add_u32 s48, s50, 46848
buffer_load_dwordx4 v11, s[20:23], s48 offen lds
s_mov_b32 m0, 114688
s_add_u32 s48, s50, 62208
buffer_load_dwordx4 v11, s[20:23], s48 offen lds
s_mov_b32 m0, 115712
s_add_u32 s48, s50, 67328
buffer_load_dwordx4 v11, s[20:23], s48 offen lds
s_mov_b32 m0, 122880
s_add_u32 s48, s50, 1024
buffer_load_dwordx4 v11, s[20:23], s48 offen lds
s_mov_b32 m0, 123904
s_add_u32 s48, s50, 6144
buffer_load_dwordx4 v11, s[20:23], s48 offen lds
ds_read_b64_tr_b16 v[16:17], v9 offset:0
ds_read_b64_tr_b16 v[18:19], v9 offset:512
ds_read_b64_tr_b16 v[20:21], v9 offset:2048
ds_read_b64_tr_b16 v[22:23], v9 offset:2560
v_xor_b32 v12, v15, v9
ds_read_b64_tr_b16 v[200:201], v12 offset:8192
ds_read_b64_tr_b16 v[202:203], v12 offset:8704
ds_read_b64_tr_b16 v[204:205], v12 offset:10240
ds_read_b64_tr_b16 v[206:207], v12 offset:10752
ds_read_b64_tr_b16 v[32:33], v9 offset:16384
ds_read_b64_tr_b16 v[34:35], v9 offset:16896
ds_read_b64_tr_b16 v[36:37], v9 offset:18432
ds_read_b64_tr_b16 v[38:39], v9 offset:18944
ds_read_b64_tr_b16 v[208:209], v9 offset:24576
ds_read_b64_tr_b16 v[210:211], v9 offset:25088
ds_read_b64_tr_b16 v[212:213], v9 offset:26624
ds_read_b64_tr_b16 v[214:215], v9 offset:27136
s_waitcnt lgkmcnt(0)
buffer_store_dwordx4 v[16:19], v0, s[4:7], s62 offen offset:0
buffer_store_dwordx4 v[20:23], v0, s[4:7], s62 offen offset:1024
buffer_store_dwordx4 v[32:35], v0, s[4:7], s62 offen offset:2048
buffer_store_dwordx4 v[36:39], v0, s[4:7], s62 offen offset:3072
s_waitcnt vmcnt(38)
s_barrier
s_mov_b32 m0, 131072
s_add_u32 s48, s50, 21504
buffer_load_dwordx4 v11, s[20:23], s48 offen lds
s_mov_b32 m0, 132096
s_add_u32 s48, s50, 26624
buffer_load_dwordx4 v11, s[20:23], s48 offen lds
s_mov_b32 m0, 139264
s_add_u32 s48, s50, 41984
buffer_load_dwordx4 v11, s[20:23], s48 offen lds
s_mov_b32 m0, 140288
s_add_u32 s48, s50, 47104
buffer_load_dwordx4 v11, s[20:23], s48 offen lds
s_mov_b32 m0, 147456
s_add_u32 s48, s50, 62464
buffer_load_dwordx4 v11, s[20:23], s48 offen lds
s_mov_b32 m0, 148480
s_add_u32 s48, s50, 67584
buffer_load_dwordx4 v11, s[20:23], s48 offen lds
s_mov_b32 m0, 155648
s_add_u32 s48, s49, 3145728
buffer_load_dwordx4 v10, s[8:11], s48 offen lds
s_mov_b32 m0, 156672
s_add_u32 s48, s49, 3211264
buffer_load_dwordx4 v10, s[8:11], s48 offen lds
ds_read_b64_tr_b16 v[216:217], v7 offset:0
ds_read_b64_tr_b16 v[218:219], v7 offset:512
ds_read_b64_tr_b16 v[220:221], v7 offset:2048
ds_read_b64_tr_b16 v[222:223], v7 offset:2560
s_waitcnt lgkmcnt(0)
s_waitcnt vmcnt(32)
s_barrier
ds_read_b64_tr_b16 v[16:17], v4 offset:8192
ds_read_b64_tr_b16 v[18:19], v4 offset:9216
ds_read_b64_tr_b16 v[20:21], v4 offset:12288
ds_read_b64_tr_b16 v[22:23], v4 offset:13312
ds_read_b64_tr_b16 v[24:25], v4 offset:16384
ds_read_b64_tr_b16 v[26:27], v4 offset:17408
ds_read_b64_tr_b16 v[28:29], v4 offset:20480
ds_read_b64_tr_b16 v[30:31], v4 offset:21504
ds_read_b64_tr_b16 v[32:33], v4 offset:24576
ds_read_b64_tr_b16 v[34:35], v4 offset:25600
ds_read_b64_tr_b16 v[36:37], v4 offset:28672
ds_read_b64_tr_b16 v[38:39], v4 offset:29696
ds_read_b64_tr_b16 v[40:41], v4 offset:32768
ds_read_b64_tr_b16 v[42:43], v4 offset:33792
ds_read_b64_tr_b16 v[44:45], v4 offset:36864
ds_read_b64_tr_b16 v[46:47], v4 offset:37888
ds_read_b64_tr_b16 v[48:49], v4 offset:40960
ds_read_b64_tr_b16 v[50:51], v4 offset:41984
ds_read_b64_tr_b16 v[52:53], v4 offset:45056
ds_read_b64_tr_b16 v[54:55], v4 offset:46080
ds_read_b64_tr_b16 v[56:57], v4 offset:49152
ds_read_b64_tr_b16 v[58:59], v4 offset:50176
ds_read_b64_tr_b16 v[60:61], v4 offset:53248
ds_read_b64_tr_b16 v[62:63], v4 offset:54272
ds_read_b64_tr_b16 v[64:65], v4 offset:57344
ds_read_b64_tr_b16 v[66:67], v4 offset:58368
ds_read_b64_tr_b16 v[68:69], v4 offset:61440
ds_read_b64_tr_b16 v[70:71], v4 offset:62464
s_waitcnt lgkmcnt(0)
s_barrier
ds_write_b128 v0, v[16:19] offset:8192
ds_write_b128 v0, v[20:23] offset:9216
ds_write_b128 v0, v[24:27] offset:10240
ds_write_b128 v0, v[28:31] offset:11264
ds_write_b128 v0, v[32:35] offset:12288
ds_write_b128 v0, v[36:39] offset:13312
ds_write_b128 v0, v[40:43] offset:14336
ds_write_b128 v0, v[44:47] offset:15360
ds_write_b128 v0, v[48:51] offset:16384
ds_write_b128 v0, v[52:55] offset:17408
ds_write_b128 v0, v[56:59] offset:18432
ds_write_b128 v0, v[60:63] offset:19456
ds_write_b128 v0, v[64:67] offset:20480
ds_write_b128 v0, v[68:71] offset:21504
s_waitcnt lgkmcnt(0)
s_waitcnt vmcnt(6)
s_barrier
v_xor_b32 v12, v15, v8
ds_read_b64_tr_b16 v[16:17], v12 offset:24576
ds_read_b64_tr_b16 v[18:19], v12 offset:25088
ds_read_b64_tr_b16 v[20:21], v12 offset:26624
ds_read_b64_tr_b16 v[22:23], v12 offset:27136
ds_read_b64_tr_b16 v[24:25], v8 offset:32768
ds_read_b64_tr_b16 v[26:27], v8 offset:33280
ds_read_b64_tr_b16 v[28:29], v8 offset:34816
ds_read_b64_tr_b16 v[30:31], v8 offset:35328
ds_read_b64_tr_b16 v[32:33], v8 offset:40960
ds_read_b64_tr_b16 v[34:35], v8 offset:41472
ds_read_b64_tr_b16 v[36:37], v8 offset:43008
ds_read_b64_tr_b16 v[38:39], v8 offset:43520
ds_read_b64_tr_b16 v[40:41], v8 offset:49152
ds_read_b64_tr_b16 v[42:43], v8 offset:49664
ds_read_b64_tr_b16 v[44:45], v8 offset:51200
ds_read_b64_tr_b16 v[46:47], v8 offset:51712
v_xor_b32 v12, v15, v8
ds_read_b64_tr_b16 v[48:49], v12 offset:57344
ds_read_b64_tr_b16 v[50:51], v12 offset:57856
ds_read_b64_tr_b16 v[52:53], v12 offset:59392
ds_read_b64_tr_b16 v[54:55], v12 offset:59904
ds_read_b64_tr_b16 v[56:57], v9 offset:0
ds_read_b64_tr_b16 v[58:59], v9 offset:512
ds_read_b64_tr_b16 v[60:61], v9 offset:2048
ds_read_b64_tr_b16 v[62:63], v9 offset:2560
s_waitcnt lgkmcnt(0)
s_barrier
ds_write_b128 v2, v[224:227] offset:16384
ds_write_b128 v2, v[228:231] offset:17408
ds_write_b128 v2, v[24:27] offset:18432
ds_write_b128 v2, v[28:31] offset:19456
ds_write_b128 v2, v[32:35] offset:20480
ds_write_b128 v2, v[36:39] offset:21504
ds_write_b128 v2, v[232:235] offset:22528
ds_write_b128 v2, v[236:239] offset:23552
ds_write_b128 v2, v[240:243] offset:24576
ds_write_b128 v2, v[244:247] offset:25600
ds_write_b128 v2, v[56:59] offset:26624
ds_write_b128 v2, v[60:63] offset:27648
s_waitcnt lgkmcnt(0)
v_mov_b32 v224, v16
v_mov_b32 v225, v17
v_mov_b32 v226, v18
v_mov_b32 v227, v19
v_mov_b32 v228, v20
v_mov_b32 v229, v21
v_mov_b32 v230, v22
v_mov_b32 v231, v23
v_mov_b32 v232, v40
v_mov_b32 v233, v41
v_mov_b32 v234, v42
v_mov_b32 v235, v43
v_mov_b32 v236, v44
v_mov_b32 v237, v45
v_mov_b32 v238, v46
v_mov_b32 v239, v47
v_mov_b32 v240, v48
v_mov_b32 v241, v49
v_mov_b32 v242, v50
v_mov_b32 v243, v51
v_mov_b32 v244, v52
v_mov_b32 v245, v53
v_mov_b32 v246, v54
v_mov_b32 v247, v55
s_waitcnt vmcnt(0)
s_barrier
ds_read_b64_tr_b16 v[16:17], v5 offset:0
ds_read_b64_tr_b16 v[18:19], v5 offset:1024
ds_read_b64_tr_b16 v[20:21], v5 offset:4096
ds_read_b64_tr_b16 v[22:23], v5 offset:5120
ds_read_b64_tr_b16 v[24:25], v5 offset:8192
ds_read_b64_tr_b16 v[26:27], v5 offset:9216
ds_read_b64_tr_b16 v[28:29], v5 offset:12288
ds_read_b64_tr_b16 v[30:31], v5 offset:13312
ds_read_b64_tr_b16 v[32:33], v5 offset:16384
ds_read_b64_tr_b16 v[34:35], v5 offset:17408
ds_read_b64_tr_b16 v[36:37], v5 offset:20480
ds_read_b64_tr_b16 v[38:39], v5 offset:21504
ds_read_b64_tr_b16 v[40:41], v9 offset:8192
ds_read_b64_tr_b16 v[42:43], v9 offset:8704
ds_read_b64_tr_b16 v[44:45], v9 offset:10240
ds_read_b64_tr_b16 v[46:47], v9 offset:10752
ds_read_b64_tr_b16 v[48:49], v9 offset:16384
ds_read_b64_tr_b16 v[50:51], v9 offset:16896
ds_read_b64_tr_b16 v[52:53], v9 offset:18432
ds_read_b64_tr_b16 v[54:55], v9 offset:18944
ds_read_b64_tr_b16 v[56:57], v6 offset:24576
ds_read_b64_tr_b16 v[58:59], v6 offset:25600
ds_read_b64_tr_b16 v[60:61], v6 offset:28672
ds_read_b64_tr_b16 v[62:63], v6 offset:29696
s_waitcnt lgkmcnt(0)
s_barrier
ds_write_b128 v2, v[16:19] offset:40960
ds_write_b128 v2, v[20:23] offset:41984
ds_write_b128 v2, v[24:27] offset:43008
ds_write_b128 v2, v[28:31] offset:44032
ds_write_b128 v2, a[176:179] offset:45056
ds_write_b128 v2, a[180:183] offset:46080
ds_write_b128 v2, v[40:43] offset:47104
ds_write_b128 v2, v[44:47] offset:48128
ds_write_b128 v2, v[248:251] offset:49152
ds_write_b128 v2, v[252:255] offset:50176
ds_write_b128 v2, a[184:187] offset:51200
ds_write_b128 v2, a[188:191] offset:52224
s_waitcnt lgkmcnt(0)
v_accvgpr_write_b32 a176, v32
v_accvgpr_write_b32 a177, v33
v_accvgpr_write_b32 a178, v34
v_accvgpr_write_b32 a179, v35
v_accvgpr_write_b32 a180, v36
v_accvgpr_write_b32 a181, v37
v_accvgpr_write_b32 a182, v38
v_accvgpr_write_b32 a183, v39
v_mov_b32 v248, v48
v_mov_b32 v249, v49
v_mov_b32 v250, v50
v_mov_b32 v251, v51
v_mov_b32 v252, v52
v_mov_b32 v253, v53
v_mov_b32 v254, v54
v_mov_b32 v255, v55
v_accvgpr_write_b32 a184, v56
v_accvgpr_write_b32 a185, v57
v_accvgpr_write_b32 a186, v58
v_accvgpr_write_b32 a187, v59
v_accvgpr_write_b32 a188, v60
v_accvgpr_write_b32 a189, v61
v_accvgpr_write_b32 a190, v62
v_accvgpr_write_b32 a191, v63
s_mov_b32 s90, 0x300003
s_mov_b32 s91, 0x300003
s_mov_b32 s12, 0x3030303
s_mov_b32 s13, 0x3030303
s_mov_b32 s92, 0xc0000c
s_mov_b32 s93, 0xc0000c
s_mov_b32 s14, 0xc0c0c0c
s_mov_b32 s15, 0xc0c0c0c
s_mov_b32 s94, 0x30000300
s_mov_b32 s95, 0x30000300
s_mov_b32 s16, 0x30303030
s_mov_b32 s17, 0x30303030
s_mov_b32 s96, 0xc0000c00
s_mov_b32 s97, 0xc0000c00
s_mov_b32 s18, 0xc0c0c0c0
s_mov_b32 s19, 0xc0c0c0c0
s_mov_b32 s98, 0xff00ff00
s_mov_b32 s99, 0xff00ff00
v_mov_b32 v1, 0x4444
v_mov_b32 v4, 0xeeee
v_cndmask_b32 v1, v1, v4, s[98:99]
v_lshrrev_b32 v4, 8, v0
v_lshl_or_b32 v1, v4, 28, v1
v_bfe_u32 v4, v0, 4, 4
v_lshl_or_b32 v1, v4, 19, v1
s_mov_b32 s51, 0x3e0293ee
s_mov_b32 s52, 0x3f803f80
s_mov_b32 s53, 0x3f803f80
s_mov_b32 s54, 0x3f003f00
s_mov_b32 s55, 0x3f003f00
s_mov_b32 s56, 0xff800000
s_mov_b32 s57, 0xff800000
s_mov_b32 s58, 0x3f80
s_mov_b32 s8, s4
s_mov_b32 s9, s5
s_cmp_eq_u32 s30, 28
s_cselect_b32 s10, s6, 0
s_mov_b32 s31, 0
s_mov_b32 s45, -2
s_lshl_b32 s46, s30, 6
s_add_u32 s46, s46, 222330880
s_lshl_b32 s48, s30, 7
s_and_b32 s49, s30, 15
s_lshl_b32 s49, s49, 12
s_add_u32 s43, s49, 119537664
v_mov_b64 v[12:13], -1
s_add_u32 s38, s48, 119537664
s_add_u32 s39, s48, 119603200
s_add_u32 s40, s48, 119668736
s_add_u32 s41, s48, 119734272
s_add_u32 s42, s48, 119799808
v_lshrrev_b32 v4, 16, v1
buffer_store_dwordx2 v[12:13], v4, s[4:7], s38 offen sc1
buffer_store_dwordx2 v[12:13], v4, s[4:7], s39 offen sc1
buffer_store_dwordx2 v[12:13], v4, s[4:7], s40 offen sc1
buffer_store_dwordx2 v[12:13], v4, s[4:7], s41 offen sc1
buffer_store_dwordx2 v[12:13], v4, s[4:7], s42 offen sc1
s_cmp_lg_u32 s3, 0
s_cbranch_scc1 k_wdd_116
v_mov_b32 v8, 192
k_wd_115:
global_load_dword v9, v8, s[28:29] sc1
s_waitcnt vmcnt(0)
v_readfirstlane_b32 s48, v9
s_cmp_ge_u32 s48, 32
s_cbranch_scc1 k_wdd_116
s_sleep 2
s_sub_u32 s32, s32, 1
s_cmp_gt_i32 s32, 0
s_cbranch_scc1 k_wd_115
k_wdd_116:
s_barrier
k_lay_117:
s_add_u32 s47, s31, 63
s_mov_b32 s33, 120324096
s_mov_b32 s34, 120326144
s_mov_b32 s35, 120330240
s_mul_i32 s48, s31, 655360
s_lshl_b32 s36, s30, 14
s_add_u32 s36, s36, s48
s_add_u32 s36, s36, 0
v_mov_b32 v12, -1
s_and_b32 s48, s30, 15
s_add_u32 s48, s48, 0
s_lshr_b32 s49, s48, 1
s_and_b32 s48, s48, 1
s_lshl_b32 s44, s49, 8
s_lshl_b32 s50, s48, 6
s_add_u32 s44, s44, s50
s_add_u32 s44, s44, s33
s_mul_i32 s48, s48, 5120
s_lshl_b32 s49, s49, 5
s_add_u32 s48, s48, s49
v_lshrrev_b32 v8, 4, v0
v_and_b32 v9, 3, v8
v_mul_u32_u24 v9, 1280, v9
v_bfe_u32 v10, v8, 2, 1
v_lshl_add_u32 v9, v10, 1, v9
v_bfe_u32 v10, v8, 4, 1
v_lshl_add_u32 v9, v10, 4, v9
v_bfe_u32 v10, v8, 5, 1
v_lshl_add_u32 v9, v10, 2, v9
buffer_load_ushort v10, v9, s[24:27], s48 offen
buffer_load_ushort v11, v9, s[24:27], s48 offen offset:8
v_and_b32 v45, 0x30, v0
v_lshrrev_b32 v46, 8, v0
v_lshl_or_b32 v45, v46, 2, v45
v_bfe_u32 v46, v0, 6, 1
v_lshl_or_b32 v45, v46, 7, v45
v_cndmask_b32 v45, v45, 2.0, s[98:99]
s_waitcnt vmcnt(0)
v_lshl_or_b32 v10, v11, 16, v10
s_lshl_b32 s63, s30, 10
s_add_u32 s63, s63, 120356864
s_lshl_b32 s37, s31, 14
s_add_u32 s37, s37, 117440512
s_add_u32 s59, s37, 4096
s_waitcnt vmcnt(0)
s_barrier
s_mov_b64 exec, 1
v_mov_b32 v8, 160
v_or_b32 v9, s64, 1
global_atomic_add v8, v9, s[28:29] sc1
s_add_u32 s49, s31, 32
k_tb_118:
global_load_dword v9, v8, s[28:29] sc1
s_waitcnt vmcnt(0)
v_readfirstlane_b32 s48, v9
s_and_b32 s48, s48, 0xffff
s_cmp_ge_u32 s48, s49
s_cbranch_scc1 k_tbd_119
s_sub_u32 s32, s32, 1
s_cmp_gt_i32 s32, 0
s_cbranch_scc1 k_tb_118
k_tbd_119:
s_mov_b64 exec, -1
s_barrier
buffer_store_dword v10, v45, s[4:7], s44 offen sc1
s_add_u32 s44, s44, 16384
buffer_store_dword v12, v45, s[4:7], s44 offen sc1
v_mov_b32 v8, 160
global_load_dword v9, v8, s[28:29] sc1
s_waitcnt vmcnt(0)
v_readfirstlane_b32 s64, v9
s_cmp_gt_u32 s64, 0xffff
s_cselect_b32 s64, 0x10000, 0
s_waitcnt vmcnt(0)
s_barrier
s_mov_b64 exec, 1
v_mov_b32 v8, 160
v_or_b32 v9, s64, 1
global_atomic_add v8, v9, s[28:29] sc1
s_add_u32 s49, s31, 64
k_tb_120:
global_load_dword v9, v8, s[28:29] sc1
s_waitcnt vmcnt(0)
v_readfirstlane_b32 s48, v9
s_and_b32 s48, s48, 0xffff
s_cmp_ge_u32 s48, s49
s_cbranch_scc1 k_tbd_121
s_sub_u32 s32, s32, 1
s_cmp_gt_i32 s32, 0
s_cbranch_scc1 k_tb_120
k_tbd_121:
s_mov_b64 exec, -1
s_barrier
v_lshlrev_b32 v23, v0, s58
v_cndmask_b32 v20, 0, v23, s[90:91]
v_cndmask_b32 v21, 0, v23, s[92:93]
v_cndmask_b32 v22, 0, v23, s[94:95]
v_cndmask_b32 v23, 0, v23, s[96:97]
s_cmp_lg_u32 s64, 0
s_cbranch_scc1 k_far_122
s_branch k_cold2_126
k_T0_124:
s_waitcnt vmcnt(2)
v_smfmac_f32_16x16x64_bf16 v[40:43], v[4:7], v[48:55], v1
s_waitcnt vmcnt(1)
v_cmp_u_f32 vcc, v4, v8
v_smfmac_f32_16x16x64_bf16 v[24:27], v[8:11], a[24:31], v1
v_smfmac_f32_16x16x64_bf16 v[28:31], v[8:11], a[32:39], v1
s_cbranch_vccnz k_cold_125
k_okC_127:
s_waitcnt vmcnt(1)
v_smfmac_f32_16x16x64_bf16 v[36:39], v[8:11], a[40:47], v1
s_waitcnt lgkmcnt(0)
ds_read_b128 v[48:51], v2 offset:45056
v_smfmac_f32_16x16x64_bf16 v[32:35], v[4:7], v[64:71], v1
ds_read_b128 v[52:55], v2 offset:46080
ds_read_b128 v[64:67], v0 offset:10240
v_smfmac_f32_16x16x64_bf16 v[44:47], v[4:7], v[56:63], v1
ds_read_b128 v[68:71], v0 offset:11264
v_smfmac_f32_16x16x64_bf16 v[28:31], v[4:7], a[8:15], v1
v_smfmac_f32_16x16x64_bf16 v[24:27], v[4:7], a[0:7], v1
ds_read_b128 v[56:59], v2 offset:22528
v_smfmac_f32_16x16x64_bf16 v[36:39], v[4:7], a[16:23], v1
ds_read_b128 v[60:63], v2 offset:23552
s_waitcnt lgkmcnt(4)
v_smfmac_f32_16x16x64_bf16 v[40:43], v[8:11], v[48:55], v1
s_waitcnt vmcnt(0)
ds_write_b128 v0, v[12:15] offset:0
s_waitcnt lgkmcnt(3)
v_smfmac_f32_16x16x64_bf16 v[32:35], v[8:11], v[64:71], v1
buffer_load_dwordx4 v[16:19], v0, s[4:7], s35 offen offset:0 sc1
v_cmp_u_f32 vcc, v12, v12
s_waitcnt lgkmcnt(1)
v_smfmac_f32_16x16x64_bf16 v[44:47], v[8:11], v[56:63], v1
ds_read_b128 v[56:59], v0 offset:20480
ds_read_b128 v[60:63], v0 offset:21504
ds_read_b128 v[64:67], v0 offset:12288
s_cbranch_vccnz k_coldA_128
k_okA_129:
v_smfmac_f32_16x16x64_bf16 v[36:39], v[12:15], a[64:71], v1
ds_read_b128 v[68:71], v0 offset:13312
s_waitcnt lgkmcnt(4)
v_smfmac_f32_16x16x64_bf16 v[40:43], v[12:15], a[72:79], v1
s_barrier
v_smfmac_f32_16x16x64_bf16 v[28:31], v[12:15], a[56:63], v1
ds_read_b128 v[8:11], v0 offset:1024
buffer_load_dwordx4 v[48:51], v0, s[4:7], s36 offen offset:0 sc1
s_waitcnt lgkmcnt(3)
v_smfmac_f32_16x16x64_bf16 v[44:47], v[12:15], v[56:63], v1
ds_read_b128 v[56:59], v2 offset:40960
v_smfmac_f32_16x16x64_bf16 v[24:27], v[12:15], a[48:55], v1
ds_read_b128 v[60:63], v2 offset:41984
s_waitcnt lgkmcnt(3)
v_smfmac_f32_16x16x64_bf16 v[32:35], v[12:15], v[64:71], v1
buffer_load_dwordx4 v[52:55], v0, s[4:7], s36 offen offset:1024 sc1
s_waitcnt lgkmcnt(2)
v_smfmac_f32_16x16x64_bf16 v[24:27], v[8:11], a[80:87], v1
ds_read_b128 v[64:67], v0 offset:14336
ds_read_b128 v[68:71], v0 offset:15360
v_smfmac_f32_16x16x64_bf16 v[36:39], v[8:11], a[96:103], v1
buffer_store_dwordx4 v[4:7], v0, s[8:11], s37 offen offset:0 sc1
s_waitcnt lgkmcnt(2)
s_nop 0
ds_read_b128 v[4:7], v0 offset:2048
v_smfmac_f32_16x16x64_bf16 v[44:47], v[8:11], v[56:63], v1
ds_read_b128 v[56:59], v2 offset:43008
ds_read_b128 v[60:63], v2 offset:44032
v_smfmac_f32_16x16x64_bf16 v[28:31], v[8:11], a[88:95], v1
buffer_store_dwordx4 v[12:15], v0, s[8:11], s37 offen offset:2048 sc1
v_smfmac_f32_16x16x64_bf16 v[40:43], v[8:11], a[104:111], v1
s_waitcnt lgkmcnt(3)
s_waitcnt lgkmcnt(2)
v_smfmac_f32_16x16x64_bf16 v[32:35], v[8:11], v[64:71], v1
ds_read_b128 v[64:67], v0 offset:16384
ds_read_b128 v[12:15], v0 offset:3072
v_smfmac_f32_16x16x64_bf16 v[36:39], v[4:7], a[128:135], v1
s_waitcnt lgkmcnt(2)
v_smfmac_f32_16x16x64_bf16 v[44:47], v[4:7], v[56:63], v1
ds_read_b128 v[68:71], v0 offset:17408
buffer_load_dwordx4 v[56:59], v0, s[4:7], s36 offen offset:2048 sc1
v_smfmac_f32_16x16x64_bf16 v[28:31], v[4:7], a[120:127], v1
v_smfmac_f32_16x16x64_bf16 v[24:27], v[4:7], a[112:119], v1
s_waitcnt vmcnt(5)
ds_write_b128 v0, v[16:19] offset:4096
v_smfmac_f32_16x16x64_bf16 v[40:43], v[4:7], a[136:143], v1
s_waitcnt lgkmcnt(1)
buffer_load_dwordx4 v[60:63], v0, s[4:7], s36 offen offset:3072 sc1
v_cmp_u_f32 vcc, v16, v16
v_smfmac_f32_16x16x64_bf16 v[32:35], v[4:7], v[64:71], v1
ds_read_b128 v[64:67], v0 offset:18432
ds_read_b128 v[68:71], v0 offset:19456
v_smfmac_f32_16x16x64_bf16 v[28:31], v[12:15], a[152:159], v1
v_smfmac_f32_16x16x64_bf16 v[24:27], v[12:15], a[144:151], v1
s_cbranch_vccnz k_coldB_130
k_okB_131:
v_smfmac_f32_16x16x64_bf16 v[36:39], v[12:15], a[160:167], v1
s_waitcnt lgkmcnt(2)
buffer_store_dwordx4 v[16:19], v0, s[8:11], s59 offen offset:2048 sc1
s_barrier
ds_read_b128 v[4:7], v0 offset:6144
v_smfmac_f32_16x16x64_bf16 v[44:47], v[12:15], a[176:183], v1
ds_read_b128 v[8:11], v0 offset:5120
s_waitcnt lgkmcnt(2)
v_smfmac_f32_16x16x64_bf16 v[32:35], v[12:15], v[64:71], v1
ds_read_b128 v[64:67], v2 offset:24576
ds_read_b128 v[68:71], v2 offset:25600
v_smfmac_f32_16x16x64_bf16 v[24:27], v[16:19], a[184:191], v1
v_smfmac_f32_16x16x64_bf16 v[40:43], v[12:15], a[168:175], v1
s_waitcnt lgkmcnt(3)
ds_read_b128 v[12:15], v0 offset:7168
v_smfmac_f32_16x16x64_bf16 v[24:27], v[4:7], a[208:215], v1
s_waitcnt lgkmcnt(3)
v_smfmac_f32_16x16x64_bf16 v[28:31], v[4:7], a[216:223], v1
v_smfmac_f32_16x16x64_bf16 v[28:31], v[8:11], a[200:207], v1
s_waitcnt lgkmcnt(1)
v_smfmac_f32_16x16x64_bf16 v[24:27], v[8:11], v[64:71], v1
ds_read_b128 v[64:67], v2 offset:49152
s_waitcnt lgkmcnt(1)
v_smfmac_f32_16x16x64_bf16 v[24:27], v[12:15], a[224:231], v1
ds_read_b128 v[68:71], v2 offset:50176
v_smfmac_f32_16x16x64_bf16 v[28:31], v[12:15], a[232:239], v1
v_smfmac_f32_16x16x64_bf16 v[28:31], v[16:19], a[192:199], v1
v_cvt_pk_bf16_f32 v24, v24, v25
v_cvt_pk_bf16_f32 v25, v26, v27
v_smfmac_f32_16x16x64_bf16 v[32:35], v[4:7], v[80:87], v1
v_cvt_pk_bf16_f32 v26, v28, v29
v_cvt_pk_bf16_f32 v27, v30, v31
v_smfmac_f32_16x16x64_bf16 v[32:35], v[8:11], a[248:255], v1
s_waitcnt lgkmcnt(0)
v_mfma_f32_16x16x32_bf16 v[28:31], v[24:27], v[20:23], 0
v_and_b32 v26, 0xffffff7f, v0
v_smfmac_f32_16x16x64_bf16 v[32:35], v[16:19], v[64:71], v1
v_and_or_b32 v26, v1, 8, v26
v_mul_f32 v28, s51, v28
v_mul_f32 v29, s51, v29
v_mul_f32 v31, s51, v31
v_cvt_pk_bf16_f32 v24, v28, v29
v_mul_f32 v30, s51, v30
v_cvt_pk_bf16_f32 v25, v30, v31
v_smfmac_f32_16x16x64_bf16 v[32:35], v[12:15], v[96:103], v1
ds_write_b64 v26, v[24:25] offset:0
v_smfmac_f32_16x16x64_bf16 v[36:39], v[8:11], v[72:79], v1
v_cvt_pk_bf16_f32 v32, v32, v33
v_smfmac_f32_16x16x64_bf16 v[36:39], v[16:19], a[240:247], v1
buffer_load_dwordx4 v[64:67], v0, s[4:7], s61 offen offset:0
v_cvt_pk_bf16_f32 v33, v34, v35
v_smfmac_f32_16x16x64_bf16 v[36:39], v[12:15], v[104:111], v1
s_waitcnt lgkmcnt(0)
v_smfmac_f32_16x16x64_bf16 v[36:39], v[4:7], v[88:95], v1
s_barrier
ds_read_b128 v[24:27], v0 offset:0
v_smfmac_f32_16x16x64_bf16 v[40:43], v[4:7], v[144:151], v1
ds_read_b128 v[28:31], v0 offset:1024
s_nop 0
v_cvt_pk_bf16_f32 v34, v36, v37
v_cvt_pk_bf16_f32 v35, v38, v39
s_nop 1
v_mfma_f32_16x16x32_bf16 v[36:39], v[32:35], v[20:23], 0
s_waitcnt vmcnt(6)
buffer_load_dwordx4 v[68:71], v0, s[4:7], s61 offen offset:1024
v_and_b32 v34, 0xffffff7f, v0
v_and_or_b32 v34, v1, 8, v34
s_waitcnt lgkmcnt(1)
v_mfma_f32_16x16x32_bf16 v[48:51], v[48:51], v[24:27], 0
v_cvt_pk_bf16_f32 v32, v36, v37
s_waitcnt lgkmcnt(0)
v_mfma_f32_16x16x32_bf16 v[48:51], v[52:55], v[28:31], v[48:51]
v_mov_b64 v[52:53], s[56:57]
v_cvt_pk_bf16_f32 v33, v38, v39
v_smfmac_f32_16x16x64_bf16 v[44:47], v[4:7], v[152:159], v1
ds_write_b64 v34, v[32:33] offset:2048
v_permlane32_swap_b32 v48, v50
v_permlane32_swap_b32 v49, v51
v_add_f32_dpp v52, v50, v48 row_ror:8 row_mask:0xf bank_mask:0x3
v_exp_f32 v52, v52
v_add_f32_dpp v53, v51, v49 row_ror:8 row_mask:0xf bank_mask:0x3
v_exp_f32 v53, v53
s_nop 0
v_cvt_pk_bf16_f32 v48, v52, v53
v_smfmac_f32_16x16x64_bf16 v[44:47], v[16:19], v[120:127], v1
ds_write_b32 v0, v48 offset:4096
v_smfmac_f32_16x16x64_bf16 v[44:47], v[12:15], v[168:175], v1
buffer_load_dwordx4 v[48:51], v0, s[4:7], s61 offen offset:2048
v_smfmac_f32_16x16x64_bf16 v[40:43], v[12:15], v[160:167], v1
s_waitcnt lgkmcnt(1)
v_xor_b32 v12, 0x80, v0
v_smfmac_f32_16x16x64_bf16 v[40:43], v[8:11], v[128:135], v1
s_waitcnt lgkmcnt(0)
s_barrier
ds_read_b128 v[32:35], v0 offset:2048
v_mov_b64 v[22:23], s[52:53]
v_smfmac_f32_16x16x64_bf16 v[40:43], v[16:19], v[112:119], v1
ds_read_b128 v[36:39], v0 offset:3072
ds_read_b128 v[16:19], v0 offset:4096
buffer_load_dwordx4 v[52:55], v0, s[4:7], s61 offen offset:3072
v_smfmac_f32_16x16x64_bf16 v[44:47], v[8:11], v[136:143], v1
ds_read_b128 v[12:15], v12 offset:4096
v_cvt_pk_bf16_f32 v40, v40, v41
v_mov_b64 v[20:21], s[52:53]
s_waitcnt lgkmcnt(3)
v_mfma_f32_16x16x32_bf16 v[24:27], v[32:35], v[24:27], 0
v_cvt_pk_bf16_f32 v41, v42, v43
s_waitcnt lgkmcnt(2)
v_mfma_f32_16x16x32_bf16 v[24:27], v[36:39], v[28:31], v[24:27]
s_waitcnt vmcnt(5)
s_waitcnt lgkmcnt(1)
v_mfma_f32_16x16x32_bf16 v[8:11], v[56:59], v[16:19], 0
buffer_load_dwordx4 v[56:59], v0, s[4:7], s62 offen offset:0
v_mov_b64 v[28:29], s[56:57]
v_cvt_pk_bf16_f32 v43, v46, v47
v_cvt_pk_bf16_f32 v42, v44, v45
v_permlane32_swap_b32 v25, v27
v_permlane32_swap_b32 v24, v26
v_mfma_f32_16x16x32_bf16 v[4:7], v[20:23], v[16:19], 0
s_waitcnt lgkmcnt(0)
v_add_f32_dpp v28, v26, v24 row_ror:8 row_mask:0xf bank_mask:0x3
v_add_f32_dpp v29, v27, v25 row_ror:8 row_mask:0xf bank_mask:0x3
v_exp_f32 v28, v28
v_mfma_f32_16x16x32_bf16 v[8:11], v[60:63], v[12:15], v[8:11]
buffer_load_dwordx4 v[60:63], v0, s[4:7], s62 offen offset:1024
v_exp_f32 v29, v29
v_permlane32_swap_b32 v42, v43
v_cvt_pk_bf16_f32 v24, v28, v29
v_mov_b64 v[44:45], s[54:55]
v_cvt_pk_bf16_f32 v25, v28, v29
v_mov_b32_dpp v26, v24 row_ror:8 row_mask:0xf bank_mask:0xf
v_mov_b32_dpp v27, v24 row_ror:8 row_mask:0xf bank_mask:0xf
v_mfma_f32_16x16x16_bf16 v[4:7], v[44:45], v[24:25], v[4:7]
v_permlane32_swap_b32 v40, v41
v_mov_b64 v[36:37], 0
v_mov_b64 v[38:39], 0
v_mov_b64 v[30:31], 0
v_mfma_f32_16x16x32_bf16 v[8:11], v[40:43], v[24:27], v[8:11]
buffer_load_dwordx4 v[16:19], v0, s[4:7], s62 offen offset:2048
v_rcp_f32 v6, v4
v_and_b32 v12, 0xffffff7f, v0
v_and_or_b32 v13, v1, 8, v12
v_rcp_f32_dpp v6, v4 row_ror:8 row_mask:0xf bank_mask:0xc
v_mov_b64 v[26:27], 0
v_pk_mul_f32 v[8:9], v[8:9], v[6:7] op_sel_hi:[1,0]
v_cvt_pk_bf16_f32 v44, v8, v9
v_pk_mul_f32 v[10:11], v[10:11], v[6:7] op_sel_hi:[1,0]
v_cvt_pk_bf16_f32 v45, v10, v11
s_waitcnt vmcnt(5)
ds_write_b64 v13, v[44:45] offset:6144
buffer_load_dwordx4 v[20:23], v0, s[4:7], s62 offen offset:3072
v_add_u32 v6, 0xd4800000, v6
v_cmp_lt_u32 vcc, 0x28000000, v6
v_mov_b64 v[34:35], 0
v_mov_b32_dpp v46, v44 row_ror:8 row_mask:0xf bank_mask:0xf
v_mov_b32_dpp v47, v45 row_ror:8 row_mask:0xf bank_mask:0xf
v_mov_b64 v[28:29], 0
v_mov_b64 v[32:33], 0
s_cbranch_vccnz k_slow_132
k_okS_133:
v_smfmac_f32_16x16x64_bf16 v[36:39], v[44:47], v[224:231], v1
s_waitcnt lgkmcnt(0)
s_barrier
ds_read_b128 v[8:11], v12 offset:7168
v_smfmac_f32_16x16x64_bf16 v[32:35], v[44:47], v[200:207], v1
s_waitcnt vmcnt(4)
ds_read_b128 v[4:7], v12 offset:6272
v_mov_b64 v[24:25], 0
v_smfmac_f32_16x16x64_bf16 v[28:31], v[44:47], v[48:55], v1
ds_read_b128 v[12:15], v12 offset:7296
ds_read_b128 v[48:51], v2 offset:16384
v_smfmac_f32_16x16x64_bf16 v[24:27], v[44:47], v[64:71], v1
ds_read_b128 v[52:55], v2 offset:17408
v_mov_b64 v[42:43], 0
s_waitcnt lgkmcnt(4)
v_smfmac_f32_16x16x64_bf16 v[24:27], v[8:11], v[184:191], v1
s_waitcnt lgkmcnt(3)
v_mov_b64 v[40:41], 0
v_smfmac_f32_16x16x64_bf16 v[24:27], v[4:7], v[176:183], v1
s_waitcnt lgkmcnt(2)
ds_read_b128 v[64:67], v2 offset:51200
v_smfmac_f32_16x16x64_bf16 v[24:27], v[12:15], v[192:199], v1
ds_read_b128 v[68:71], v2 offset:52224
v_smfmac_f32_16x16x64_bf16 v[40:43], v[44:47], v[240:247], v1
s_waitcnt vmcnt(2)
s_waitcnt lgkmcnt(2)
v_lshrrev_b32 v44, 16, v1
v_cvt_pk_bf16_f32 v24, v24, v25
v_bfi_b32 v24, 1, s45, v24
v_cvt_pk_bf16_f32 v25, v26, v27
v_smfmac_f32_16x16x64_bf16 v[28:31], v[8:11], v[48:55], v1
buffer_store_dwordx2 v[24:25], v44, s[4:7], s38 offen
ds_read_b128 v[48:51], v2 offset:20480
ds_read_b128 v[52:55], v2 offset:21504
v_smfmac_f32_16x16x64_bf16 v[28:31], v[12:15], v[56:63], v1
s_waitcnt lgkmcnt(2)
ds_read_b128 v[56:59], v2 offset:26624
v_smfmac_f32_16x16x64_bf16 v[28:31], v[4:7], v[64:71], v1
ds_read_b128 v[60:63], v2 offset:27648
v_smfmac_f32_16x16x64_bf16 v[32:35], v[8:11], v[208:215], v1
ds_read_b128 v[64:67], v2 offset:18432
s_nop 0
v_cvt_pk_bf16_f32 v28, v28, v29
v_bfi_b32 v28, 1, s45, v28
v_cvt_pk_bf16_f32 v29, v30, v31
v_smfmac_f32_16x16x64_bf16 v[32:35], v[12:15], v[216:223], v1
buffer_store_dwordx2 v[28:29], v44, s[4:7], s39 offen
v_smfmac_f32_16x16x64_bf16 v[40:43], v[12:15], v[248:255], v1
ds_read_b128 v[68:71], v2 offset:19456
s_waitcnt vmcnt(2)
v_smfmac_f32_16x16x64_bf16 v[32:35], v[4:7], v[16:23], v1
s_waitcnt lgkmcnt(2)
v_smfmac_f32_16x16x64_bf16 v[36:39], v[12:15], v[232:239], v1
ds_read_b128 v[16:19], v2 offset:47104
ds_read_b128 v[20:23], v2 offset:48128
v_cvt_pk_bf16_f32 v32, v32, v33
v_bfi_b32 v32, 1, s45, v32
v_cvt_pk_bf16_f32 v33, v34, v35
v_smfmac_f32_16x16x64_bf16 v[36:39], v[8:11], v[48:55], v1
buffer_store_dwordx2 v[32:33], v44, s[4:7], s40 offen
s_waitcnt lgkmcnt(2)
v_smfmac_f32_16x16x64_bf16 v[36:39], v[4:7], v[64:71], v1
s_nop 6
v_cvt_pk_bf16_f32 v36, v36, v37
v_cvt_pk_bf16_f32 v37, v38, v39
s_waitcnt lgkmcnt(0)
v_bfi_b32 v36, 1, s45, v36
v_smfmac_f32_16x16x64_bf16 v[40:43], v[8:11], v[16:23], v1
buffer_store_dwordx2 v[36:37], v44, s[4:7], s41 offen
v_smfmac_f32_16x16x64_bf16 v[40:43], v[4:7], v[56:63], v1
s_nop 6
v_cvt_pk_bf16_f32 v40, v40, v41
v_bfi_b32 v40, 1, s45, v40
v_cvt_pk_bf16_f32 v41, v42, v43
buffer_store_dwordx2 v[40:41], v44, s[4:7], s42 offen
s_barrier
buffer_load_dwordx4 v[24:27], v0, s[4:7], s43 offen offset:0 sc1
buffer_load_dwordx4 v[28:31], v0, s[4:7], s43 offen offset:1024 sc1
buffer_load_dwordx4 v[32:35], v0, s[4:7], s43 offen offset:2048 sc1
buffer_load_dwordx4 v[36:39], v0, s[4:7], s43 offen offset:3072 sc1
v_lshlrev_b32 v23, v0, s58
v_cndmask_b32 v16, 0, v23, s[12:13]
v_cndmask_b32 v17, 0, v23, s[14:15]
v_cndmask_b32 v18, 0, v23, s[16:17]
v_cndmask_b32 v19, 0, v23, s[18:19]
v_and_b32 v45, 0x30, v0
v_lshrrev_b32 v46, 8, v0
v_lshl_or_b32 v45, v46, 2, v45
v_bfe_u32 v46, v0, 6, 1
v_lshl_or_b32 v45, v46, 7, v45
v_cndmask_b32 v45, v45, 2.0, s[98:99]
v_cndmask_b32 v20, 0, v23, s[90:91]
v_cndmask_b32 v21, 0, v23, s[92:93]
v_cndmask_b32 v22, 0, v23, s[94:95]
v_cndmask_b32 v23, 0, v23, s[96:97]
s_add_u32 s33, s33, 16384
s_bitset0_b32 s33, 16
s_waitcnt vmcnt(3)
v_mfma_f32_16x16x32_bf16 v[40:43], v[24:27], v[16:19], 0
s_waitcnt vmcnt(2)
v_mfma_f32_16x16x32_bf16 v[40:43], v[28:31], v[16:19], v[40:43]
v_bitop3_b32 v46, v24, v28, s45 bitop3:0x7e
s_waitcnt vmcnt(1)
v_mfma_f32_16x16x32_bf16 v[40:43], v[32:35], v[16:19], v[40:43]
s_waitcnt vmcnt(0)
v_mfma_f32_16x16x32_bf16 v[40:43], v[36:39], v[16:19], v[40:43]
v_bitop3_b32 v47, v32, v36, s45 bitop3:0x7e
v_bitop3_b32 v46, v46, v47, 1 bitop3:0xa8
v_cmp_ne_u32 vcc, 0, v46
v_mov_b64 v[24:25], 0
v_mov_b64 v[26:27], 0
v_mov_b64 v[28:29], 0
v_mov_b64 v[30:31], 0
v_permlane32_swap_b32 v40, v41
v_permlane32_swap_b32 v42, v43
v_add_f32 v40, v40, v41
v_add_f32 v41, v42, v43
v_cvt_pk_bf16_f32 v42, v40, v41
s_cbranch_vccnz k_r1_135
k_ok1_136:
buffer_store_dword v42, v45, s[4:7], s44 offen
buffer_load_dwordx4 v[48:51], v0, s[4:7], s60 offen offset:0
buffer_load_dwordx4 v[52:55], v0, s[4:7], s60 offen offset:1024
buffer_load_dwordx4 v[56:59], v0, s[4:7], s60 offen offset:2048
buffer_load_dwordx4 v[60:63], v0, s[4:7], s60 offen offset:3072
s_barrier
buffer_load_dwordx4 v[4:7], v0, s[4:7], s33 offen offset:0 sc1
buffer_load_dwordx4 v[8:11], v0, s[4:7], s33 offen offset:1024 sc1
s_add_u32 s34, s33, 2048
s_add_u32 s35, s33, 6144
s_add_u32 s36, s36, 524288
s_add_u32 s37, s37, 10240
s_add_u32 s59, s59, 10240
v_mov_b64 v[32:33], 0
v_mov_b64 v[34:35], 0
v_mov_b64 v[36:37], 0
v_mov_b64 v[38:39], 0
v_mov_b64 v[40:41], 0
v_mov_b64 v[42:43], 0
v_mov_b64 v[44:45], 0
v_mov_b64 v[46:47], 0
s_add_u32 s44, s44, 16384
s_bitset0_b32 s44, 16
s_sub_u32 s45, s45, 1
s_add_u32 s31, s31, 1
ds_read_b128 v[64:67], v0 offset:8192
ds_read_b128 v[68:71], v0 offset:9216
buffer_load_dwordx4 v[12:15], v0, s[4:7], s34 offen offset:0 sc1
s_cmp_lg_u32 s31, s47
s_cbranch_scc1 k_T0_124
s_branch k_done_134
k_cold2_126:
s_barrier
buffer_load_dwordx4 v[48:51], v0, s[4:7], s60 offen offset:0
buffer_load_dwordx4 v[52:55], v0, s[4:7], s60 offen offset:1024
buffer_load_dwordx4 v[56:59], v0, s[4:7], s60 offen offset:2048
buffer_load_dwordx4 v[60:63], v0, s[4:7], s60 offen offset:3072
ds_read_b128 v[64:67], v0 offset:8192
ds_read_b128 v[68:71], v0 offset:9216
k_cold_125:
buffer_load_dwordx4 v[4:7], v0, s[4:7], s33 offen offset:0 sc1
buffer_load_dwordx4 v[8:11], v0, s[4:7], s33 offen offset:1024 sc1
buffer_load_dwordx4 v[12:15], v0, s[4:7], s34 offen offset:0 sc1
s_sub_u32 s32, s32, 1
s_cmp_gt_i32 s32, 0
s_cbranch_scc0 k_okC_127
v_mov_b64 v[24:25], 0
v_mov_b64 v[26:27], 0
v_mov_b64 v[28:29], 0
v_mov_b64 v[30:31], 0
v_mov_b64 v[32:33], 0
v_mov_b64 v[34:35], 0
v_mov_b64 v[36:37], 0
v_mov_b64 v[38:39], 0
v_mov_b64 v[40:41], 0
v_mov_b64 v[42:43], 0
v_mov_b64 v[44:45], 0
v_mov_b64 v[46:47], 0
s_branch k_T0_124
k_coldA_128:
buffer_load_dwordx4 v[12:15], v0, s[4:7], s34 offen offset:0 sc1
s_sub_u32 s32, s32, 1
s_cmp_gt_i32 s32, 0
s_waitcnt vmcnt(0)
v_cmp_u_f32 vcc, v12, v12
ds_write_b128 v0, v[12:15] offset:0
s_waitcnt lgkmcnt(0)
s_cbranch_vccz k_okA_129
s_cbranch_scc1 k_coldA_128
s_branch k_okA_129
k_coldB_130:
buffer_load_dwordx4 v[16:19], v0, s[4:7], s35 offen offset:0 sc1
s_sub_u32 s32, s32, 1
s_cmp_gt_i32 s32, 0
s_waitcnt vmcnt(0)
v_cmp_u_f32 vcc, v16, v16
ds_write_b128 v0, v[16:19] offset:4096
s_waitcnt lgkmcnt(0)
s_cbranch_vccz k_okB_131
s_cbranch_scc1 k_coldB_130
s_branch k_okB_131
k_r1_135:
buffer_load_dwordx4 v[24:27], v0, s[4:7], s43 offen offset:0 sc1
buffer_load_dwordx4 v[28:31], v0, s[4:7], s43 offen offset:1024 sc1
buffer_load_dwordx4 v[32:35], v0, s[4:7], s43 offen offset:2048 sc1
buffer_load_dwordx4 v[36:39], v0, s[4:7], s43 offen offset:3072 sc1
s_sub_u32 s32, s32, 1
s_cmp_gt_i32 s32, 0
s_waitcnt vmcnt(3)
v_mfma_f32_16x16x32_bf16 v[40:43], v[24:27], v[16:19], 0
s_waitcnt vmcnt(2)
v_mfma_f32_16x16x32_bf16 v[40:43], v[28:31], v[16:19], v[40:43]
v_bitop3_b32 v46, v24, v28, s45 bitop3:0x7e
s_waitcnt vmcnt(1)
v_mfma_f32_16x16x32_bf16 v[40:43], v[32:35], v[16:19], v[40:43]
s_waitcnt vmcnt(0)
v_mfma_f32_16x16x32_bf16 v[40:43], v[36:39], v[16:19], v[40:43]
v_bitop3_b32 v47, v32, v36, s45 bitop3:0x7e
v_bitop3_b32 v46, v46, v47, 1 bitop3:0xa8
v_cmp_ne_u32 vcc, 0, v46
v_mov_b64 v[24:25], 0
v_mov_b64 v[26:27], 0
v_mov_b64 v[28:29], 0
v_mov_b64 v[30:31], 0
v_permlane32_swap_b32 v40, v41
v_permlane32_swap_b32 v42, v43
v_add_f32 v40, v40, v41
v_add_f32 v41, v42, v43
v_cvt_pk_bf16_f32 v42, v40, v41
s_cbranch_vccz k_ok1_136
s_cbranch_scc1 k_r1_135
s_branch k_ok1_136
k_slow_132:
ds_read_b128 v[24:27], v0 offset:0
ds_read_b128 v[28:31], v0 offset:1024
v_mov_b32 v46, 0xff7fffff
s_add_u32 s48, s36, 0x0
buffer_load_dwordx4 v[32:35], v0, s[4:7], s48 offen offset:0 sc1
buffer_load_dwordx4 v[36:39], v0, s[4:7], s48 offen offset:1024 sc1
s_waitcnt vmcnt(1) lgkmcnt(1)
v_mfma_f32_16x16x32_bf16 v[4:7], v[32:35], v[24:27], 0
s_waitcnt vmcnt(0) lgkmcnt(0)
v_mfma_f32_16x16x32_bf16 v[4:7], v[36:39], v[28:31], v[4:7]
v_mov_b64 v[8:9], s[56:57]
s_nop 5
v_permlane32_swap_b32 v4, v6
v_permlane32_swap_b32 v5, v7
v_add_f32_dpp v8, v6, v4 row_ror:8 row_mask:0xf bank_mask:0x3
s_nop 0
v_add_f32_dpp v9, v7, v5 row_ror:8 row_mask:0xf bank_mask:0x3
v_max3_f32 v46, v46, v8, v9
s_add_u32 s48, s36, 0x1000
buffer_load_dwordx4 v[32:35], v0, s[4:7], s48 offen offset:0 sc1
buffer_load_dwordx4 v[36:39], v0, s[4:7], s48 offen offset:1024 sc1
s_waitcnt vmcnt(1)
v_mfma_f32_16x16x32_bf16 v[4:7], v[32:35], v[24:27], 0
s_waitcnt vmcnt(0)
v_mfma_f32_16x16x32_bf16 v[4:7], v[36:39], v[28:31], v[4:7]
v_mov_b64 v[10:11], s[56:57]
s_nop 5
v_permlane32_swap_b32 v4, v6
v_permlane32_swap_b32 v5, v7
v_add_f32_dpp v10, v6, v4 row_ror:8 row_mask:0xf bank_mask:0x3
s_nop 0
v_add_f32_dpp v11, v7, v5 row_ror:8 row_mask:0xf bank_mask:0x3
v_max3_f32 v46, v46, v10, v11
s_add_u32 s48, s36, 0x2000
buffer_load_dwordx4 v[32:35], v0, s[4:7], s48 offen offset:0 sc1
buffer_load_dwordx4 v[36:39], v0, s[4:7], s48 offen offset:1024 sc1
s_waitcnt vmcnt(1)
v_mfma_f32_16x16x32_bf16 v[4:7], v[32:35], v[24:27], 0
s_waitcnt vmcnt(0)
v_mfma_f32_16x16x32_bf16 v[4:7], v[36:39], v[28:31], v[4:7]
v_mov_b64 v[12:13], s[56:57]
s_nop 5
v_permlane32_swap_b32 v4, v6
v_permlane32_swap_b32 v5, v7
v_add_f32_dpp v12, v6, v4 row_ror:8 row_mask:0xf bank_mask:0x3
s_nop 0
v_add_f32_dpp v13, v7, v5 row_ror:8 row_mask:0xf bank_mask:0x3
v_max3_f32 v46, v46, v12, v13
s_add_u32 s48, s36, 0x3000
buffer_load_dwordx4 v[32:35], v0, s[4:7], s48 offen offset:0 sc1
buffer_load_dwordx4 v[36:39], v0, s[4:7], s48 offen offset:1024 sc1
s_waitcnt vmcnt(1)
v_mfma_f32_16x16x32_bf16 v[4:7], v[32:35], v[24:27], 0
s_waitcnt vmcnt(0)
v_mfma_f32_16x16x32_bf16 v[4:7], v[36:39], v[28:31], v[4:7]
v_mov_b64 v[14:15], s[56:57]
s_nop 5
v_permlane32_swap_b32 v4, v6
v_permlane32_swap_b32 v5, v7
v_add_f32_dpp v14, v6, v4 row_ror:8 row_mask:0xf bank_mask:0x3
s_nop 0
v_add_f32_dpp v15, v7, v5 row_ror:8 row_mask:0xf bank_mask:0x3
v_max3_f32 v46, v46, v14, v15
ds_read_b128 v[32:35], v0 offset:2048
ds_read_b128 v[36:39], v0 offset:3072
s_waitcnt lgkmcnt(1)
v_mfma_f32_16x16x32_bf16 v[4:7], v[32:35], v[24:27], 0
s_waitcnt lgkmcnt(0)
v_mfma_f32_16x16x32_bf16 v[4:7], v[36:39], v[28:31], v[4:7]
v_mov_b64 v[44:45], s[56:57]
s_nop 5
v_permlane32_swap_b32 v4, v6
v_permlane32_swap_b32 v5, v7
v_add_f32_dpp v44, v6, v4 row_ror:8 row_mask:0xf bank_mask:0x3
s_nop 0
v_add_f32_dpp v45, v7, v5 row_ror:8 row_mask:0xf bank_mask:0x3
v_max3_f32 v46, v46, v44, v45
buffer_load_dwordx4 v[32:35], v0, s[4:7], s36 offen offset:2048 sc1
buffer_load_dwordx4 v[36:39], v0, s[4:7], s36 offen offset:3072 sc1
v_mov_b32 v47, v46
s_nop 1
v_permlane32_swap_b32 v46, v47
v_max_f32 v46, v46, v47
v_mov_b32 v47, v46
s_nop 1
v_permlane16_swap_b32 v46, v47
v_max_f32 v46, v46, v47
v_sub_f32 v8, v8, v46
v_exp_f32 v8, v8
v_sub_f32 v9, v9, v46
v_exp_f32 v9, v9
v_sub_f32 v10, v10, v46
v_exp_f32 v10, v10
v_sub_f32 v11, v11, v46
v_exp_f32 v11, v11
v_sub_f32 v12, v12, v46
v_exp_f32 v12, v12
v_sub_f32 v13, v13, v46
v_exp_f32 v13, v13
v_sub_f32 v14, v14, v46
v_exp_f32 v14, v14
v_sub_f32 v15, v15, v46
v_exp_f32 v15, v15
v_sub_f32 v44, v44, v46
v_exp_f32 v44, v44
v_sub_f32 v45, v45, v46
v_exp_f32 v45, v45
v_cvt_pk_bf16_f32 v4, v8, v9
v_cvt_pk_bf16_f32 v5, v10, v11
v_cvt_pk_bf16_f32 v6, v12, v13
v_cvt_pk_bf16_f32 v7, v14, v15
v_mov_b32_dpp v8, v4 row_ror:8 row_mask:0xf bank_mask:0xf
v_mov_b32_dpp v9, v5 row_ror:8 row_mask:0xf bank_mask:0xf
v_mov_b32_dpp v10, v6 row_ror:8 row_mask:0xf bank_mask:0xf
v_mov_b32_dpp v11, v7 row_ror:8 row_mask:0xf bank_mask:0xf
v_cvt_pk_bf16_f32 v24, v44, v45
v_cvt_pk_bf16_f32 v25, v44, v45
s_nop 0
v_mov_b32_dpp v26, v24 row_ror:8 row_mask:0xf bank_mask:0xf
v_mov_b32_dpp v27, v24 row_ror:8 row_mask:0xf bank_mask:0xf
v_mov_b64 v[28:29], s[52:53]
v_mov_b64 v[30:31], s[52:53]
s_nop 1
v_mfma_f32_16x16x32_bf16 v[44:47], v[28:31], v[4:7], 0
s_waitcnt vmcnt(1)
v_mfma_f32_16x16x32_bf16 v[12:15], v[32:35], v[4:7], 0
s_waitcnt vmcnt(0)
v_mfma_f32_16x16x32_bf16 v[12:15], v[36:39], v[8:11], v[12:15]
v_mfma_f32_16x16x32_bf16 v[12:15], v[40:43], v[24:27], v[12:15]
v_mov_b64 v[28:29], s[54:55]
s_nop 1
v_mfma_f32_16x16x16_bf16 v[44:47], v[28:29], v[24:25], v[44:47]
s_nop 6
v_rcp_f32 v4, v44
s_nop 1
v_rcp_f32_dpp v4, v44 row_ror:8 row_mask:0xf bank_mask:0xc
s_nop 0
v_mul_f32 v12, v4, v12
v_mul_f32 v13, v4, v13
v_mul_f32 v14, v4, v14
v_mul_f32 v15, v4, v15
v_cvt_pk_bf16_f32 v44, v12, v13
v_cvt_pk_bf16_f32 v45, v14, v15
v_and_b32 v12, 0xffffff7f, v0
v_and_or_b32 v8, v1, 8, v12
ds_write_b64 v8, v[44:45] offset:6144
v_mov_b32_dpp v46, v44 row_ror:8 row_mask:0xf bank_mask:0xf
v_mov_b32_dpp v47, v45 row_ror:8 row_mask:0xf bank_mask:0xf
v_mov_b64 v[24:25], 0
v_mov_b64 v[26:27], 0
v_mov_b64 v[28:29], 0
v_mov_b64 v[30:31], 0
v_mov_b64 v[32:33], 0
v_mov_b64 v[34:35], 0
v_mov_b64 v[36:37], 0
v_mov_b64 v[38:39], 0
s_waitcnt lgkmcnt(0)
s_branch k_okS_133
k_done_134:
buffer_load_dwordx4 v[16:19], v0, s[4:7], s35 offen offset:0 sc1
k_xs_140:
s_waitcnt vmcnt(1)
v_cmp_u_f32 vcc, v4, v12
s_waitcnt vmcnt(0)
v_cmp_u_f32 s[66:67], v16, v16
s_or_b64 vcc, vcc, s[66:67]
s_cbranch_vccz k_xd_141
buffer_load_dwordx4 v[4:7], v0, s[4:7], s33 offen offset:0 sc1
buffer_load_dwordx4 v[8:11], v0, s[4:7], s33 offen offset:1024 sc1
buffer_load_dwordx4 v[12:15], v0, s[4:7], s34 offen offset:0 sc1
buffer_load_dwordx4 v[16:19], v0, s[4:7], s35 offen offset:0 sc1
s_sub_u32 s32, s32, 1
s_cmp_gt_i32 s32, 0
s_cbranch_scc1 k_xs_140
k_xd_141:
s_waitcnt vmcnt(3)
buffer_store_dwordx4 v[4:7], v0, s[8:11], s37 offen offset:0 sc1
s_waitcnt vmcnt(2)
buffer_store_dwordx4 v[12:15], v0, s[8:11], s37 offen offset:2048 sc1
s_waitcnt vmcnt(2)
buffer_store_dwordx4 v[16:19], v0, s[8:11], s59 offen offset:2048 sc1
s_add_u32 s31, s31, 1
s_branch k_jn_123
k_far_122:
s_branch k_cold2_144
k_T0_142:
s_waitcnt vmcnt(2)
v_smfmac_f32_16x16x64_bf16 v[40:43], v[4:7], v[48:55], v1
s_waitcnt vmcnt(1)
v_cmp_u_f32 vcc, v4, v8
v_smfmac_f32_16x16x64_bf16 v[24:27], v[8:11], a[24:31], v1
v_smfmac_f32_16x16x64_bf16 v[28:31], v[8:11], a[32:39], v1
s_cbranch_vccnz k_cold_143
k_okC_145:
s_waitcnt vmcnt(1)
v_smfmac_f32_16x16x64_bf16 v[36:39], v[8:11], a[40:47], v1
s_waitcnt lgkmcnt(0)
ds_read_b128 v[48:51], v2 offset:45056
v_smfmac_f32_16x16x64_bf16 v[32:35], v[4:7], v[64:71], v1
ds_read_b128 v[52:55], v2 offset:46080
ds_read_b128 v[64:67], v0 offset:10240
v_smfmac_f32_16x16x64_bf16 v[44:47], v[4:7], v[56:63], v1
ds_read_b128 v[68:71], v0 offset:11264
v_smfmac_f32_16x16x64_bf16 v[28:31], v[4:7], a[8:15], v1
v_smfmac_f32_16x16x64_bf16 v[24:27], v[4:7], a[0:7], v1
ds_read_b128 v[56:59], v2 offset:22528
v_smfmac_f32_16x16x64_bf16 v[36:39], v[4:7], a[16:23], v1
ds_read_b128 v[60:63], v2 offset:23552
s_waitcnt lgkmcnt(4)
v_smfmac_f32_16x16x64_bf16 v[40:43], v[8:11], v[48:55], v1
s_waitcnt vmcnt(0)
ds_write_b128 v0, v[12:15] offset:0
s_waitcnt lgkmcnt(3)
v_smfmac_f32_16x16x64_bf16 v[32:35], v[8:11], v[64:71], v1
buffer_load_dwordx4 v[16:19], v0, s[4:7], s35 offen offset:0 sc1
v_cmp_u_f32 vcc, v12, v12
s_waitcnt lgkmcnt(1)
v_smfmac_f32_16x16x64_bf16 v[44:47], v[8:11], v[56:63], v1
ds_read_b128 v[56:59], v0 offset:20480
ds_read_b128 v[60:63], v0 offset:21504
ds_read_b128 v[64:67], v0 offset:12288
s_cbranch_vccnz k_coldA_146
k_okA_147:
v_smfmac_f32_16x16x64_bf16 v[36:39], v[12:15], a[64:71], v1
ds_read_b128 v[68:71], v0 offset:13312
s_waitcnt lgkmcnt(4)
v_smfmac_f32_16x16x64_bf16 v[40:43], v[12:15], a[72:79], v1
s_barrier
v_smfmac_f32_16x16x64_bf16 v[28:31], v[12:15], a[56:63], v1
ds_read_b128 v[8:11], v0 offset:1024
buffer_load_dwordx4 v[48:51], v0, s[4:7], s36 offen offset:0 sc1
s_waitcnt lgkmcnt(3)
v_smfmac_f32_16x16x64_bf16 v[44:47], v[12:15], v[56:63], v1
ds_read_b128 v[56:59], v2 offset:40960
v_smfmac_f32_16x16x64_bf16 v[24:27], v[12:15], a[48:55], v1
ds_read_b128 v[60:63], v2 offset:41984
s_waitcnt lgkmcnt(3)
v_smfmac_f32_16x16x64_bf16 v[32:35], v[12:15], v[64:71], v1
buffer_load_dwordx4 v[52:55], v0, s[4:7], s36 offen offset:1024 sc1
s_waitcnt lgkmcnt(2)
v_smfmac_f32_16x16x64_bf16 v[24:27], v[8:11], a[80:87], v1
ds_read_b128 v[64:67], v0 offset:14336
ds_read_b128 v[68:71], v0 offset:15360
v_smfmac_f32_16x16x64_bf16 v[36:39], v[8:11], a[96:103], v1
buffer_store_dwordx4 v[4:7], v0, s[8:11], s37 offen offset:0 sc1
s_waitcnt lgkmcnt(2)
s_nop 0
ds_read_b128 v[4:7], v0 offset:2048
v_smfmac_f32_16x16x64_bf16 v[44:47], v[8:11], v[56:63], v1
ds_read_b128 v[56:59], v2 offset:43008
ds_read_b128 v[60:63], v2 offset:44032
v_smfmac_f32_16x16x64_bf16 v[28:31], v[8:11], a[88:95], v1
buffer_store_dwordx4 v[12:15], v0, s[8:11], s37 offen offset:2048 sc1
v_smfmac_f32_16x16x64_bf16 v[40:43], v[8:11], a[104:111], v1
s_waitcnt lgkmcnt(3)
s_waitcnt lgkmcnt(2)
v_smfmac_f32_16x16x64_bf16 v[32:35], v[8:11], v[64:71], v1
ds_read_b128 v[64:67], v0 offset:16384
ds_read_b128 v[12:15], v0 offset:3072
v_smfmac_f32_16x16x64_bf16 v[36:39], v[4:7], a[128:135], v1
s_waitcnt lgkmcnt(2)
v_smfmac_f32_16x16x64_bf16 v[44:47], v[4:7], v[56:63], v1
ds_read_b128 v[68:71], v0 offset:17408
buffer_load_dwordx4 v[56:59], v0, s[4:7], s36 offen offset:2048 sc1
v_smfmac_f32_16x16x64_bf16 v[28:31], v[4:7], a[120:127], v1
v_smfmac_f32_16x16x64_bf16 v[24:27], v[4:7], a[112:119], v1
s_waitcnt vmcnt(5)
ds_write_b128 v0, v[16:19] offset:4096
v_smfmac_f32_16x16x64_bf16 v[40:43], v[4:7], a[136:143], v1
s_waitcnt lgkmcnt(1)
buffer_load_dwordx4 v[60:63], v0, s[4:7], s36 offen offset:3072 sc1
v_cmp_u_f32 vcc, v16, v16
v_smfmac_f32_16x16x64_bf16 v[32:35], v[4:7], v[64:71], v1
ds_read_b128 v[64:67], v0 offset:18432
ds_read_b128 v[68:71], v0 offset:19456
v_smfmac_f32_16x16x64_bf16 v[28:31], v[12:15], a[152:159], v1
v_smfmac_f32_16x16x64_bf16 v[24:27], v[12:15], a[144:151], v1
s_cbranch_vccnz k_coldB_148
k_okB_149:
v_smfmac_f32_16x16x64_bf16 v[36:39], v[12:15], a[160:167], v1
s_waitcnt lgkmcnt(2)
buffer_store_dwordx4 v[16:19], v0, s[8:11], s59 offen offset:2048 sc1
s_barrier
ds_read_b128 v[4:7], v0 offset:6144
v_smfmac_f32_16x16x64_bf16 v[44:47], v[12:15], a[176:183], v1
ds_read_b128 v[8:11], v0 offset:5120
s_waitcnt lgkmcnt(2)
v_smfmac_f32_16x16x64_bf16 v[32:35], v[12:15], v[64:71], v1
ds_read_b128 v[64:67], v2 offset:24576
ds_read_b128 v[68:71], v2 offset:25600
v_smfmac_f32_16x16x64_bf16 v[24:27], v[16:19], a[184:191], v1
v_smfmac_f32_16x16x64_bf16 v[40:43], v[12:15], a[168:175], v1
s_waitcnt lgkmcnt(3)
ds_read_b128 v[12:15], v0 offset:7168
v_smfmac_f32_16x16x64_bf16 v[24:27], v[4:7], a[208:215], v1
s_waitcnt lgkmcnt(3)
v_smfmac_f32_16x16x64_bf16 v[28:31], v[4:7], a[216:223], v1
v_smfmac_f32_16x16x64_bf16 v[28:31], v[8:11], a[200:207], v1
s_waitcnt lgkmcnt(1)
v_smfmac_f32_16x16x64_bf16 v[24:27], v[8:11], v[64:71], v1
ds_read_b128 v[64:67], v2 offset:49152
s_waitcnt lgkmcnt(1)
v_smfmac_f32_16x16x64_bf16 v[24:27], v[12:15], a[224:231], v1
ds_read_b128 v[68:71], v2 offset:50176
v_smfmac_f32_16x16x64_bf16 v[28:31], v[12:15], a[232:239], v1
v_smfmac_f32_16x16x64_bf16 v[28:31], v[16:19], a[192:199], v1
v_cvt_pk_bf16_f32 v24, v24, v25
v_cvt_pk_bf16_f32 v25, v26, v27
v_smfmac_f32_16x16x64_bf16 v[32:35], v[4:7], v[80:87], v1
v_cvt_pk_bf16_f32 v26, v28, v29
v_cvt_pk_bf16_f32 v27, v30, v31
v_smfmac_f32_16x16x64_bf16 v[32:35], v[8:11], a[248:255], v1
s_waitcnt lgkmcnt(0)
v_mfma_f32_16x16x32_bf16 v[28:31], v[24:27], v[20:23], 0
v_and_b32 v26, 0xffffff7f, v0
v_smfmac_f32_16x16x64_bf16 v[32:35], v[16:19], v[64:71], v1
v_and_or_b32 v26, v1, 8, v26
v_mul_f32 v28, s51, v28
v_mul_f32 v29, s51, v29
v_mul_f32 v31, s51, v31
v_cvt_pk_bf16_f32 v24, v28, v29
v_mul_f32 v30, s51, v30
v_cvt_pk_bf16_f32 v25, v30, v31
v_smfmac_f32_16x16x64_bf16 v[32:35], v[12:15], v[96:103], v1
ds_write_b64 v26, v[24:25] offset:0
v_smfmac_f32_16x16x64_bf16 v[36:39], v[8:11], v[72:79], v1
v_cvt_pk_bf16_f32 v32, v32, v33
v_smfmac_f32_16x16x64_bf16 v[36:39], v[16:19], a[240:247], v1
buffer_load_dwordx4 v[64:67], v0, s[4:7], s61 offen offset:0
v_cvt_pk_bf16_f32 v33, v34, v35
v_smfmac_f32_16x16x64_bf16 v[36:39], v[12:15], v[104:111], v1
s_waitcnt lgkmcnt(0)
v_smfmac_f32_16x16x64_bf16 v[36:39], v[4:7], v[88:95], v1
s_barrier
ds_read_b128 v[24:27], v0 offset:0
v_smfmac_f32_16x16x64_bf16 v[40:43], v[4:7], v[144:151], v1
ds_read_b128 v[28:31], v0 offset:1024
s_nop 0
v_cvt_pk_bf16_f32 v34, v36, v37
v_cvt_pk_bf16_f32 v35, v38, v39
s_nop 1
v_mfma_f32_16x16x32_bf16 v[36:39], v[32:35], v[20:23], 0
s_waitcnt vmcnt(6)
buffer_load_dwordx4 v[68:71], v0, s[4:7], s61 offen offset:1024
v_and_b32 v34, 0xffffff7f, v0
v_and_or_b32 v34, v1, 8, v34
s_waitcnt lgkmcnt(1)
v_mfma_f32_16x16x32_bf16 v[48:51], v[48:51], v[24:27], 0
v_cvt_pk_bf16_f32 v32, v36, v37
s_waitcnt lgkmcnt(0)
v_mfma_f32_16x16x32_bf16 v[48:51], v[52:55], v[28:31], v[48:51]
v_mov_b64 v[52:53], s[56:57]
v_cvt_pk_bf16_f32 v33, v38, v39
v_smfmac_f32_16x16x64_bf16 v[44:47], v[4:7], v[152:159], v1
ds_write_b64 v34, v[32:33] offset:2048
v_permlane32_swap_b32 v48, v50
v_permlane32_swap_b32 v49, v51
v_add_f32_dpp v52, v50, v48 row_ror:8 row_mask:0xf bank_mask:0x3
v_exp_f32 v52, v52
v_add_f32_dpp v53, v51, v49 row_ror:8 row_mask:0xf bank_mask:0x3
v_exp_f32 v53, v53
s_nop 0
v_cvt_pk_bf16_f32 v48, v52, v53
v_smfmac_f32_16x16x64_bf16 v[44:47], v[16:19], v[120:127], v1
ds_write_b32 v0, v48 offset:4096
v_smfmac_f32_16x16x64_bf16 v[44:47], v[12:15], v[168:175], v1
buffer_load_dwordx4 v[48:51], v0, s[4:7], s61 offen offset:2048
v_smfmac_f32_16x16x64_bf16 v[40:43], v[12:15], v[160:167], v1
s_waitcnt lgkmcnt(1)
v_xor_b32 v12, 0x80, v0
v_smfmac_f32_16x16x64_bf16 v[40:43], v[8:11], v[128:135], v1
s_waitcnt lgkmcnt(0)
s_barrier
ds_read_b128 v[32:35], v0 offset:2048
v_mov_b64 v[22:23], s[52:53]
v_smfmac_f32_16x16x64_bf16 v[40:43], v[16:19], v[112:119], v1
ds_read_b128 v[36:39], v0 offset:3072
ds_read_b128 v[16:19], v0 offset:4096
buffer_load_dwordx4 v[52:55], v0, s[4:7], s61 offen offset:3072
v_smfmac_f32_16x16x64_bf16 v[44:47], v[8:11], v[136:143], v1
ds_read_b128 v[12:15], v12 offset:4096
v_cvt_pk_bf16_f32 v40, v40, v41
v_mov_b64 v[20:21], s[52:53]
s_waitcnt lgkmcnt(3)
v_mfma_f32_16x16x32_bf16 v[24:27], v[32:35], v[24:27], 0
v_cvt_pk_bf16_f32 v41, v42, v43
s_waitcnt lgkmcnt(2)
v_mfma_f32_16x16x32_bf16 v[24:27], v[36:39], v[28:31], v[24:27]
s_waitcnt vmcnt(5)
s_waitcnt lgkmcnt(1)
v_mfma_f32_16x16x32_bf16 v[8:11], v[56:59], v[16:19], 0
buffer_load_dwordx4 v[56:59], v0, s[4:7], s62 offen offset:0
v_mov_b64 v[28:29], s[56:57]
v_cvt_pk_bf16_f32 v43, v46, v47
v_cvt_pk_bf16_f32 v42, v44, v45
v_permlane32_swap_b32 v25, v27
v_permlane32_swap_b32 v24, v26
v_mfma_f32_16x16x32_bf16 v[4:7], v[20:23], v[16:19], 0
s_waitcnt lgkmcnt(0)
v_add_f32_dpp v28, v26, v24 row_ror:8 row_mask:0xf bank_mask:0x3
v_add_f32_dpp v29, v27, v25 row_ror:8 row_mask:0xf bank_mask:0x3
v_exp_f32 v28, v28
v_mfma_f32_16x16x32_bf16 v[8:11], v[60:63], v[12:15], v[8:11]
buffer_load_dwordx4 v[60:63], v0, s[4:7], s62 offen offset:1024
v_exp_f32 v29, v29
v_permlane32_swap_b32 v42, v43
v_cvt_pk_bf16_f32 v24, v28, v29
v_mov_b64 v[44:45], s[54:55]
v_cvt_pk_bf16_f32 v25, v28, v29
v_mov_b32_dpp v26, v24 row_ror:8 row_mask:0xf bank_mask:0xf
v_mov_b32_dpp v27, v24 row_ror:8 row_mask:0xf bank_mask:0xf
v_mfma_f32_16x16x16_bf16 v[4:7], v[44:45], v[24:25], v[4:7]
v_permlane32_swap_b32 v40, v41
v_mov_b64 v[36:37], 0
v_mov_b64 v[38:39], 0
v_mov_b64 v[30:31], 0
v_mfma_f32_16x16x32_bf16 v[8:11], v[40:43], v[24:27], v[8:11]
buffer_load_dwordx4 v[16:19], v0, s[4:7], s62 offen offset:2048
v_rcp_f32 v6, v4
v_and_b32 v12, 0xffffff7f, v0
v_and_or_b32 v13, v1, 8, v12
v_rcp_f32_dpp v6, v4 row_ror:8 row_mask:0xf bank_mask:0xc
v_mov_b64 v[26:27], 0
v_pk_mul_f32 v[8:9], v[8:9], v[6:7] op_sel_hi:[1,0]
v_cvt_pk_bf16_f32 v44, v8, v9
v_pk_mul_f32 v[10:11], v[10:11], v[6:7] op_sel_hi:[1,0]
v_cvt_pk_bf16_f32 v45, v10, v11
s_waitcnt vmcnt(5)
ds_write_b64 v13, v[44:45] offset:6144
buffer_load_dwordx4 v[20:23], v0, s[4:7], s62 offen offset:3072
v_add_u32 v6, 0xd4800000, v6
v_cmp_lt_u32 vcc, 0x28000000, v6
v_mov_b64 v[34:35], 0
v_mov_b32_dpp v46, v44 row_ror:8 row_mask:0xf bank_mask:0xf
v_mov_b32_dpp v47, v45 row_ror:8 row_mask:0xf bank_mask:0xf
v_mov_b64 v[28:29], 0
v_mov_b64 v[32:33], 0
s_cbranch_vccnz k_slow_150
k_okS_151:
v_smfmac_f32_16x16x64_bf16 v[36:39], v[44:47], v[224:231], v1
s_waitcnt lgkmcnt(0)
s_barrier
ds_read_b128 v[8:11], v12 offset:7168
v_smfmac_f32_16x16x64_bf16 v[32:35], v[44:47], v[200:207], v1
s_waitcnt vmcnt(4)
ds_read_b128 v[4:7], v12 offset:6272
v_mov_b64 v[24:25], 0
v_smfmac_f32_16x16x64_bf16 v[28:31], v[44:47], v[48:55], v1
ds_read_b128 v[12:15], v12 offset:7296
ds_read_b128 v[48:51], v2 offset:16384
v_smfmac_f32_16x16x64_bf16 v[24:27], v[44:47], v[64:71], v1
ds_read_b128 v[52:55], v2 offset:17408
v_mov_b64 v[42:43], 0
s_waitcnt lgkmcnt(4)
v_smfmac_f32_16x16x64_bf16 v[24:27], v[8:11], v[184:191], v1
s_waitcnt lgkmcnt(3)
v_mov_b64 v[40:41], 0
v_smfmac_f32_16x16x64_bf16 v[24:27], v[4:7], v[176:183], v1
s_waitcnt lgkmcnt(2)
ds_read_b128 v[64:67], v2 offset:51200
v_smfmac_f32_16x16x64_bf16 v[24:27], v[12:15], v[192:199], v1
ds_read_b128 v[68:71], v2 offset:52224
v_smfmac_f32_16x16x64_bf16 v[40:43], v[44:47], v[240:247], v1
s_waitcnt vmcnt(2)
s_waitcnt lgkmcnt(2)
v_lshrrev_b32 v44, 16, v1
v_cvt_pk_bf16_f32 v24, v24, v25
v_bfi_b32 v24, 1, s45, v24
v_cvt_pk_bf16_f32 v25, v26, v27
v_smfmac_f32_16x16x64_bf16 v[28:31], v[8:11], v[48:55], v1
buffer_store_dwordx2 v[24:25], v44, s[4:7], s38 offen sc1
ds_read_b128 v[48:51], v2 offset:20480
ds_read_b128 v[52:55], v2 offset:21504
v_smfmac_f32_16x16x64_bf16 v[28:31], v[12:15], v[56:63], v1
s_waitcnt lgkmcnt(2)
ds_read_b128 v[56:59], v2 offset:26624
v_smfmac_f32_16x16x64_bf16 v[28:31], v[4:7], v[64:71], v1
ds_read_b128 v[60:63], v2 offset:27648
v_smfmac_f32_16x16x64_bf16 v[32:35], v[8:11], v[208:215], v1
ds_read_b128 v[64:67], v2 offset:18432
s_nop 0
v_cvt_pk_bf16_f32 v28, v28, v29
v_bfi_b32 v28, 1, s45, v28
v_cvt_pk_bf16_f32 v29, v30, v31
v_smfmac_f32_16x16x64_bf16 v[32:35], v[12:15], v[216:223], v1
buffer_store_dwordx2 v[28:29], v44, s[4:7], s39 offen sc1
v_smfmac_f32_16x16x64_bf16 v[40:43], v[12:15], v[248:255], v1
ds_read_b128 v[68:71], v2 offset:19456
s_waitcnt vmcnt(2)
v_smfmac_f32_16x16x64_bf16 v[32:35], v[4:7], v[16:23], v1
s_waitcnt lgkmcnt(2)
v_smfmac_f32_16x16x64_bf16 v[36:39], v[12:15], v[232:239], v1
ds_read_b128 v[16:19], v2 offset:47104
ds_read_b128 v[20:23], v2 offset:48128
v_cvt_pk_bf16_f32 v32, v32, v33
v_bfi_b32 v32, 1, s45, v32
v_cvt_pk_bf16_f32 v33, v34, v35
v_smfmac_f32_16x16x64_bf16 v[36:39], v[8:11], v[48:55], v1
buffer_store_dwordx2 v[32:33], v44, s[4:7], s40 offen sc1
s_waitcnt lgkmcnt(2)
v_smfmac_f32_16x16x64_bf16 v[36:39], v[4:7], v[64:71], v1
s_nop 6
v_cvt_pk_bf16_f32 v36, v36, v37
v_cvt_pk_bf16_f32 v37, v38, v39
s_waitcnt lgkmcnt(0)
v_bfi_b32 v36, 1, s45, v36
v_smfmac_f32_16x16x64_bf16 v[40:43], v[8:11], v[16:23], v1
buffer_store_dwordx2 v[36:37], v44, s[4:7], s41 offen sc1
v_smfmac_f32_16x16x64_bf16 v[40:43], v[4:7], v[56:63], v1
s_nop 6
v_cvt_pk_bf16_f32 v40, v40, v41
v_bfi_b32 v40, 1, s45, v40
v_cvt_pk_bf16_f32 v41, v42, v43
buffer_store_dwordx2 v[40:41], v44, s[4:7], s42 offen sc1
s_barrier
buffer_load_dwordx4 v[24:27], v0, s[4:7], s43 offen offset:0 sc1
buffer_load_dwordx4 v[28:31], v0, s[4:7], s43 offen offset:1024 sc1
buffer_load_dwordx4 v[32:35], v0, s[4:7], s43 offen offset:2048 sc1
buffer_load_dwordx4 v[36:39], v0, s[4:7], s43 offen offset:3072 sc1
v_lshlrev_b32 v23, v0, s58
v_cndmask_b32 v16, 0, v23, s[12:13]
v_cndmask_b32 v17, 0, v23, s[14:15]
v_cndmask_b32 v18, 0, v23, s[16:17]
v_cndmask_b32 v19, 0, v23, s[18:19]
v_and_b32 v45, 0x30, v0
v_lshrrev_b32 v46, 8, v0
v_lshl_or_b32 v45, v46, 2, v45
v_bfe_u32 v46, v0, 6, 1
v_lshl_or_b32 v45, v46, 7, v45
v_cndmask_b32 v45, v45, 2.0, s[98:99]
v_cndmask_b32 v20, 0, v23, s[90:91]
v_cndmask_b32 v21, 0, v23, s[92:93]
v_cndmask_b32 v22, 0, v23, s[94:95]
v_cndmask_b32 v23, 0, v23, s[96:97]
s_add_u32 s33, s33, 16384
s_bitset0_b32 s33, 16
s_waitcnt vmcnt(3)
v_mfma_f32_16x16x32_bf16 v[40:43], v[24:27], v[16:19], 0
s_waitcnt vmcnt(2)
v_mfma_f32_16x16x32_bf16 v[40:43], v[28:31], v[16:19], v[40:43]
v_bitop3_b32 v46, v24, v28, s45 bitop3:0x7e
s_waitcnt vmcnt(1)
v_mfma_f32_16x16x32_bf16 v[40:43], v[32:35], v[16:19], v[40:43]
s_waitcnt vmcnt(0)
v_mfma_f32_16x16x32_bf16 v[40:43], v[36:39], v[16:19], v[40:43]
v_bitop3_b32 v47, v32, v36, s45 bitop3:0x7e
v_bitop3_b32 v46, v46, v47, 1 bitop3:0xa8
v_cmp_ne_u32 vcc, 0, v46
v_mov_b64 v[24:25], 0
v_mov_b64 v[26:27], 0
v_mov_b64 v[28:29], 0
v_mov_b64 v[30:31], 0
v_permlane32_swap_b32 v40, v41
v_permlane32_swap_b32 v42, v43
v_add_f32 v40, v40, v41
v_add_f32 v41, v42, v43
v_cvt_pk_bf16_f32 v42, v40, v41
s_cbranch_vccnz k_r1_153
k_ok1_154:
buffer_store_dword v42, v45, s[4:7], s44 offen sc1
buffer_load_dwordx4 v[48:51], v0, s[4:7], s60 offen offset:0
buffer_load_dwordx4 v[52:55], v0, s[4:7], s60 offen offset:1024
buffer_load_dwordx4 v[56:59], v0, s[4:7], s60 offen offset:2048
buffer_load_dwordx4 v[60:63], v0, s[4:7], s60 offen offset:3072
s_barrier
buffer_load_dwordx4 v[4:7], v0, s[4:7], s33 offen offset:0 sc1
buffer_load_dwordx4 v[8:11], v0, s[4:7], s33 offen offset:1024 sc1
s_add_u32 s34, s33, 2048
s_add_u32 s35, s33, 6144
s_add_u32 s36, s36, 524288
s_add_u32 s37, s37, 10240
s_add_u32 s59, s59, 10240
v_mov_b64 v[32:33], 0
v_mov_b64 v[34:35], 0
v_mov_b64 v[36:37], 0
v_mov_b64 v[38:39], 0
v_mov_b64 v[40:41], 0
v_mov_b64 v[42:43], 0
v_mov_b64 v[44:45], 0
v_mov_b64 v[46:47], 0
s_add_u32 s44, s44, 16384
s_bitset0_b32 s44, 16
s_sub_u32 s45, s45, 1
s_add_u32 s31, s31, 1
ds_read_b128 v[64:67], v0 offset:8192
ds_read_b128 v[68:71], v0 offset:9216
buffer_load_dwordx4 v[12:15], v0, s[4:7], s34 offen offset:0 sc1
s_cmp_lg_u32 s31, s47
s_cbranch_scc1 k_T0_142
s_branch k_done_152
k_cold2_144:
s_barrier
buffer_load_dwordx4 v[48:51], v0, s[4:7], s60 offen offset:0
buffer_load_dwordx4 v[52:55], v0, s[4:7], s60 offen offset:1024
buffer_load_dwordx4 v[56:59], v0, s[4:7], s60 offen offset:2048
buffer_load_dwordx4 v[60:63], v0, s[4:7], s60 offen offset:3072
ds_read_b128 v[64:67], v0 offset:8192
ds_read_b128 v[68:71], v0 offset:9216
k_cold_143:
buffer_load_dwordx4 v[4:7], v0, s[4:7], s33 offen offset:0 sc1
buffer_load_dwordx4 v[8:11], v0, s[4:7], s33 offen offset:1024 sc1
buffer_load_dwordx4 v[12:15], v0, s[4:7], s34 offen offset:0 sc1
s_sub_u32 s32, s32, 1
s_cmp_gt_i32 s32, 0
s_cbranch_scc0 k_okC_145
v_mov_b64 v[24:25], 0
v_mov_b64 v[26:27], 0
v_mov_b64 v[28:29], 0
v_mov_b64 v[30:31], 0
v_mov_b64 v[32:33], 0
v_mov_b64 v[34:35], 0
v_mov_b64 v[36:37], 0
v_mov_b64 v[38:39], 0
v_mov_b64 v[40:41], 0
v_mov_b64 v[42:43], 0
v_mov_b64 v[44:45], 0
v_mov_b64 v[46:47], 0
s_branch k_T0_142
k_coldA_146:
buffer_load_dwordx4 v[12:15], v0, s[4:7], s34 offen offset:0 sc1
s_sub_u32 s32, s32, 1
s_cmp_gt_i32 s32, 0
s_waitcnt vmcnt(0)
v_cmp_u_f32 vcc, v12, v12
ds_write_b128 v0, v[12:15] offset:0
s_waitcnt lgkmcnt(0)
s_cbranch_vccz k_okA_147
s_cbranch_scc1 k_coldA_146
s_branch k_okA_147
k_coldB_148:
buffer_load_dwordx4 v[16:19], v0, s[4:7], s35 offen offset:0 sc1
s_sub_u32 s32, s32, 1
s_cmp_gt_i32 s32, 0
s_waitcnt vmcnt(0)
v_cmp_u_f32 vcc, v16, v16
ds_write_b128 v0, v[16:19] offset:4096
s_waitcnt lgkmcnt(0)
s_cbranch_vccz k_okB_149
s_cbranch_scc1 k_coldB_148
s_branch k_okB_149
k_r1_153:
buffer_load_dwordx4 v[24:27], v0, s[4:7], s43 offen offset:0 sc1
buffer_load_dwordx4 v[28:31], v0, s[4:7], s43 offen offset:1024 sc1
buffer_load_dwordx4 v[32:35], v0, s[4:7], s43 offen offset:2048 sc1
buffer_load_dwordx4 v[36:39], v0, s[4:7], s43 offen offset:3072 sc1
s_sub_u32 s32, s32, 1
s_cmp_gt_i32 s32, 0
s_waitcnt vmcnt(3)
v_mfma_f32_16x16x32_bf16 v[40:43], v[24:27], v[16:19], 0
s_waitcnt vmcnt(2)
v_mfma_f32_16x16x32_bf16 v[40:43], v[28:31], v[16:19], v[40:43]
v_bitop3_b32 v46, v24, v28, s45 bitop3:0x7e
s_waitcnt vmcnt(1)
v_mfma_f32_16x16x32_bf16 v[40:43], v[32:35], v[16:19], v[40:43]
s_waitcnt vmcnt(0)
v_mfma_f32_16x16x32_bf16 v[40:43], v[36:39], v[16:19], v[40:43]
v_bitop3_b32 v47, v32, v36, s45 bitop3:0x7e
v_bitop3_b32 v46, v46, v47, 1 bitop3:0xa8
v_cmp_ne_u32 vcc, 0, v46
v_mov_b64 v[24:25], 0
v_mov_b64 v[26:27], 0
v_mov_b64 v[28:29], 0
v_mov_b64 v[30:31], 0
v_permlane32_swap_b32 v40, v41
v_permlane32_swap_b32 v42, v43
v_add_f32 v40, v40, v41
v_add_f32 v41, v42, v43
v_cvt_pk_bf16_f32 v42, v40, v41
s_cbranch_vccz k_ok1_154
s_cbranch_scc1 k_r1_153
s_branch k_ok1_154
k_slow_150:
ds_read_b128 v[24:27], v0 offset:0
ds_read_b128 v[28:31], v0 offset:1024
v_mov_b32 v46, 0xff7fffff
s_add_u32 s48, s36, 0x0
buffer_load_dwordx4 v[32:35], v0, s[4:7], s48 offen offset:0 sc1
buffer_load_dwordx4 v[36:39], v0, s[4:7], s48 offen offset:1024 sc1
s_waitcnt vmcnt(1) lgkmcnt(1)
v_mfma_f32_16x16x32_bf16 v[4:7], v[32:35], v[24:27], 0
s_waitcnt vmcnt(0) lgkmcnt(0)
v_mfma_f32_16x16x32_bf16 v[4:7], v[36:39], v[28:31], v[4:7]
v_mov_b64 v[8:9], s[56:57]
s_nop 5
v_permlane32_swap_b32 v4, v6
v_permlane32_swap_b32 v5, v7
v_add_f32_dpp v8, v6, v4 row_ror:8 row_mask:0xf bank_mask:0x3
s_nop 0
v_add_f32_dpp v9, v7, v5 row_ror:8 row_mask:0xf bank_mask:0x3
v_max3_f32 v46, v46, v8, v9
s_add_u32 s48, s36, 0x1000
buffer_load_dwordx4 v[32:35], v0, s[4:7], s48 offen offset:0 sc1
buffer_load_dwordx4 v[36:39], v0, s[4:7], s48 offen offset:1024 sc1
s_waitcnt vmcnt(1)
v_mfma_f32_16x16x32_bf16 v[4:7], v[32:35], v[24:27], 0
s_waitcnt vmcnt(0)
v_mfma_f32_16x16x32_bf16 v[4:7], v[36:39], v[28:31], v[4:7]
v_mov_b64 v[10:11], s[56:57]
s_nop 5
v_permlane32_swap_b32 v4, v6
v_permlane32_swap_b32 v5, v7
v_add_f32_dpp v10, v6, v4 row_ror:8 row_mask:0xf bank_mask:0x3
s_nop 0
v_add_f32_dpp v11, v7, v5 row_ror:8 row_mask:0xf bank_mask:0x3
v_max3_f32 v46, v46, v10, v11
s_add_u32 s48, s36, 0x2000
buffer_load_dwordx4 v[32:35], v0, s[4:7], s48 offen offset:0 sc1
buffer_load_dwordx4 v[36:39], v0, s[4:7], s48 offen offset:1024 sc1
s_waitcnt vmcnt(1)
v_mfma_f32_16x16x32_bf16 v[4:7], v[32:35], v[24:27], 0
s_waitcnt vmcnt(0)
v_mfma_f32_16x16x32_bf16 v[4:7], v[36:39], v[28:31], v[4:7]
v_mov_b64 v[12:13], s[56:57]
s_nop 5
v_permlane32_swap_b32 v4, v6
v_permlane32_swap_b32 v5, v7
v_add_f32_dpp v12, v6, v4 row_ror:8 row_mask:0xf bank_mask:0x3
s_nop 0
v_add_f32_dpp v13, v7, v5 row_ror:8 row_mask:0xf bank_mask:0x3
v_max3_f32 v46, v46, v12, v13
s_add_u32 s48, s36, 0x3000
buffer_load_dwordx4 v[32:35], v0, s[4:7], s48 offen offset:0 sc1
buffer_load_dwordx4 v[36:39], v0, s[4:7], s48 offen offset:1024 sc1
s_waitcnt vmcnt(1)
v_mfma_f32_16x16x32_bf16 v[4:7], v[32:35], v[24:27], 0
s_waitcnt vmcnt(0)
v_mfma_f32_16x16x32_bf16 v[4:7], v[36:39], v[28:31], v[4:7]
v_mov_b64 v[14:15], s[56:57]
s_nop 5
v_permlane32_swap_b32 v4, v6
v_permlane32_swap_b32 v5, v7
v_add_f32_dpp v14, v6, v4 row_ror:8 row_mask:0xf bank_mask:0x3
s_nop 0
v_add_f32_dpp v15, v7, v5 row_ror:8 row_mask:0xf bank_mask:0x3
v_max3_f32 v46, v46, v14, v15
ds_read_b128 v[32:35], v0 offset:2048
ds_read_b128 v[36:39], v0 offset:3072
s_waitcnt lgkmcnt(1)
v_mfma_f32_16x16x32_bf16 v[4:7], v[32:35], v[24:27], 0
s_waitcnt lgkmcnt(0)
v_mfma_f32_16x16x32_bf16 v[4:7], v[36:39], v[28:31], v[4:7]
v_mov_b64 v[44:45], s[56:57]
s_nop 5
v_permlane32_swap_b32 v4, v6
v_permlane32_swap_b32 v5, v7
v_add_f32_dpp v44, v6, v4 row_ror:8 row_mask:0xf bank_mask:0x3
s_nop 0
v_add_f32_dpp v45, v7, v5 row_ror:8 row_mask:0xf bank_mask:0x3
v_max3_f32 v46, v46, v44, v45
buffer_load_dwordx4 v[32:35], v0, s[4:7], s36 offen offset:2048 sc1
buffer_load_dwordx4 v[36:39], v0, s[4:7], s36 offen offset:3072 sc1
v_mov_b32 v47, v46
s_nop 1
v_permlane32_swap_b32 v46, v47
v_max_f32 v46, v46, v47
v_mov_b32 v47, v46
s_nop 1
v_permlane16_swap_b32 v46, v47
v_max_f32 v46, v46, v47
v_sub_f32 v8, v8, v46
v_exp_f32 v8, v8
v_sub_f32 v9, v9, v46
v_exp_f32 v9, v9
v_sub_f32 v10, v10, v46
v_exp_f32 v10, v10
v_sub_f32 v11, v11, v46
v_exp_f32 v11, v11
v_sub_f32 v12, v12, v46
v_exp_f32 v12, v12
v_sub_f32 v13, v13, v46
v_exp_f32 v13, v13
v_sub_f32 v14, v14, v46
v_exp_f32 v14, v14
v_sub_f32 v15, v15, v46
v_exp_f32 v15, v15
v_sub_f32 v44, v44, v46
v_exp_f32 v44, v44
v_sub_f32 v45, v45, v46
v_exp_f32 v45, v45
v_cvt_pk_bf16_f32 v4, v8, v9
v_cvt_pk_bf16_f32 v5, v10, v11
v_cvt_pk_bf16_f32 v6, v12, v13
v_cvt_pk_bf16_f32 v7, v14, v15
v_mov_b32_dpp v8, v4 row_ror:8 row_mask:0xf bank_mask:0xf
v_mov_b32_dpp v9, v5 row_ror:8 row_mask:0xf bank_mask:0xf
v_mov_b32_dpp v10, v6 row_ror:8 row_mask:0xf bank_mask:0xf
v_mov_b32_dpp v11, v7 row_ror:8 row_mask:0xf bank_mask:0xf
v_cvt_pk_bf16_f32 v24, v44, v45
v_cvt_pk_bf16_f32 v25, v44, v45
s_nop 0
v_mov_b32_dpp v26, v24 row_ror:8 row_mask:0xf bank_mask:0xf
v_mov_b32_dpp v27, v24 row_ror:8 row_mask:0xf bank_mask:0xf
v_mov_b64 v[28:29], s[52:53]
v_mov_b64 v[30:31], s[52:53]
s_nop 1
v_mfma_f32_16x16x32_bf16 v[44:47], v[28:31], v[4:7], 0
s_waitcnt vmcnt(1)
v_mfma_f32_16x16x32_bf16 v[12:15], v[32:35], v[4:7], 0
s_waitcnt vmcnt(0)
v_mfma_f32_16x16x32_bf16 v[12:15], v[36:39], v[8:11], v[12:15]
v_mfma_f32_16x16x32_bf16 v[12:15], v[40:43], v[24:27], v[12:15]
v_mov_b64 v[28:29], s[54:55]
s_nop 1
v_mfma_f32_16x16x16_bf16 v[44:47], v[28:29], v[24:25], v[44:47]
s_nop 6
v_rcp_f32 v4, v44
s_nop 1
v_rcp_f32_dpp v4, v44 row_ror:8 row_mask:0xf bank_mask:0xc
s_nop 0
v_mul_f32 v12, v4, v12
v_mul_f32 v13, v4, v13
v_mul_f32 v14, v4, v14
v_mul_f32 v15, v4, v15
v_cvt_pk_bf16_f32 v44, v12, v13
v_cvt_pk_bf16_f32 v45, v14, v15
v_and_b32 v12, 0xffffff7f, v0
v_and_or_b32 v8, v1, 8, v12
ds_write_b64 v8, v[44:45] offset:6144
v_mov_b32_dpp v46, v44 row_ror:8 row_mask:0xf bank_mask:0xf
v_mov_b32_dpp v47, v45 row_ror:8 row_mask:0xf bank_mask:0xf
v_mov_b64 v[24:25], 0
v_mov_b64 v[26:27], 0
v_mov_b64 v[28:29], 0
v_mov_b64 v[30:31], 0
v_mov_b64 v[32:33], 0
v_mov_b64 v[34:35], 0
v_mov_b64 v[36:37], 0
v_mov_b64 v[38:39], 0
s_waitcnt lgkmcnt(0)
s_branch k_okS_151
k_done_152:
buffer_load_dwordx4 v[16:19], v0, s[4:7], s35 offen offset:0 sc1
k_xs_158:
s_waitcnt vmcnt(1)
v_cmp_u_f32 vcc, v4, v12
s_waitcnt vmcnt(0)
v_cmp_u_f32 s[66:67], v16, v16
s_or_b64 vcc, vcc, s[66:67]
s_cbranch_vccz k_xd_159
buffer_load_dwordx4 v[4:7], v0, s[4:7], s33 offen offset:0 sc1
buffer_load_dwordx4 v[8:11], v0, s[4:7], s33 offen offset:1024 sc1
buffer_load_dwordx4 v[12:15], v0, s[4:7], s34 offen offset:0 sc1
buffer_load_dwordx4 v[16:19], v0, s[4:7], s35 offen offset:0 sc1
s_sub_u32 s32, s32, 1
s_cmp_gt_i32 s32, 0
s_cbranch_scc1 k_xs_158
k_xd_159:
s_waitcnt vmcnt(3)
buffer_store_dwordx4 v[4:7], v0, s[8:11], s37 offen offset:0 sc1
s_waitcnt vmcnt(2)
buffer_store_dwordx4 v[12:15], v0, s[8:11], s37 offen offset:2048 sc1
s_waitcnt vmcnt(2)
buffer_store_dwordx4 v[16:19], v0, s[8:11], s59 offen offset:2048 sc1
s_add_u32 s31, s31, 1
k_jn_123:
s_cmp_lt_u32 s31, 128
s_cbranch_scc1 k_lay_117
s_add_u32 s30, s30, 112
s_waitcnt vmcnt(0) lgkmcnt(0)
s_barrier
s_branch k_fin_7
k_w1_112:
v_lshrrev_b32 v12, 3, v0
v_lshlrev_b32 v10, 13, v12
v_bfe_u32 v12, v0, 1, 2
v_lshrrev_b32 v13, 4, v0
v_xor_b32 v12, v12, v13
v_lshl_add_u32 v10, v12, 5, v10
v_and_b32 v14, 1, v0
v_lshl_add_u32 v10, v14, 4, v10
v_mul_u32_u24 v11, 1280, v13
v_bfe_u32 v12, v0, 1, 3
v_and_b32 v13, 1, v13
v_lshlrev_b32 v13, 1, v13
v_xor_b32 v12, v12, v13
v_xor_b32 v12, 0, v12
v_lshl_add_u32 v11, v12, 5, v11
v_lshl_add_u32 v11, v14, 4, v11
v_bfe_u32 v12, v0, 5, 1
v_lshlrev_b32 v12, 4, v12
v_bfe_u32 v13, v0, 4, 1
v_lshl_add_u32 v12, v13, 1, v12
v_bfe_u32 v13, v0, 2, 1
v_lshl_add_u32 v12, v13, 2, v12
v_bfe_u32 v13, v0, 3, 1
v_mul_u32_u24 v15, 4224, v13
v_add_u32 v12, v13, v12
v_bfe_u32 v13, v12, 1, 2
v_xor_b32 v13, 1, v13
v_lshlrev_b32 v13, 5, v13
v_lshl_add_u32 v4, v12, 7, v13
v_and_b32 v14, 3, v0
v_lshl_add_u32 v4, v14, 3, v4
v_add_u32 v5, 0x10000, v4
v_add_u32 v6, 0x20000, v4
v_bfe_u32 v12, v0, 4, 1
v_lshlrev_b32 v13, 4, v12
v_lshlrev_b32 v12, 2, v12
v_bfe_u32 v8, v0, 5, 1
v_lshl_add_u32 v13, v8, 2, v13
v_bfe_u32 v8, v0, 2, 1
v_add_u32 v13, v8, v13
v_lshl_add_u32 v12, v8, 1, v12
v_bfe_u32 v8, v0, 3, 1
v_add_u32 v8, 2, v8
v_xor_b32 v12, v12, v8
v_lshlrev_b32 v12, 5, v12
v_lshl_add_u32 v7, v13, 8, v12
v_lshl_add_u32 v7, v14, 3, v7
v_add_u32 v8, 0x10000, v7
v_add_u32 v9, 0x20000, v7
v_lshlrev_b32 v0, 4, v0
v_add_u32 v2, 98304, v0
s_lshl_b32 s49, s30, 8
s_mul_i32 s50, s30, 163840
s_mul_i32 s60, s30, 131072
s_add_u32 s60, s60, 120619008
s_add_u32 s61, s60, 4096
s_add_u32 s62, s60, 8192
s_mov_b32 m0, 2048
s_add_u32 s48, s49, 131072
buffer_load_dwordx4 v10, s[8:11], s48 offen lds
s_mov_b32 m0, 3072
s_add_u32 s48, s49, 196608
buffer_load_dwordx4 v10, s[8:11], s48 offen lds
s_mov_b32 m0, 10240
s_add_u32 s48, s49, 131200
buffer_load_dwordx4 v10, s[8:11], s48 offen lds
s_mov_b32 m0, 11264
s_add_u32 s48, s49, 196736
buffer_load_dwordx4 v10, s[8:11], s48 offen lds
s_mov_b32 m0, 18432
s_add_u32 s48, s49, 131200
buffer_load_dwordx4 v10, s[12:15], s48 offen lds
s_mov_b32 m0, 19456
s_add_u32 s48, s49, 196736
buffer_load_dwordx4 v10, s[12:15], s48 offen lds
s_mov_b32 m0, 26624
s_add_u32 s48, s49, 131072
buffer_load_dwordx4 v10, s[16:19], s48 offen lds
s_mov_b32 m0, 27648
s_add_u32 s48, s49, 196608
buffer_load_dwordx4 v10, s[16:19], s48 offen lds
s_mov_b32 m0, 34816
s_add_u32 s48, s49, 131200
buffer_load_dwordx4 v10, s[16:19], s48 offen lds
s_mov_b32 m0, 35840
s_add_u32 s48, s49, 196736
buffer_load_dwordx4 v10, s[16:19], s48 offen lds
s_mov_b32 m0, 43008
s_add_u32 s48, s49, 655360
buffer_load_dwordx4 v10, s[8:11], s48 offen lds
s_mov_b32 m0, 44032
s_add_u32 s48, s49, 720896
buffer_load_dwordx4 v10, s[8:11], s48 offen lds
s_mov_b32 m0, 51200
s_add_u32 s48, s49, 655488
buffer_load_dwordx4 v10, s[8:11], s48 offen lds
s_mov_b32 m0, 52224
s_add_u32 s48, s49, 721024
buffer_load_dwordx4 v10, s[8:11], s48 offen lds
s_mov_b32 m0, 59392
s_add_u32 s48, s49, 655488
buffer_load_dwordx4 v10, s[12:15], s48 offen lds
s_mov_b32 m0, 60416
s_add_u32 s48, s49, 721024
buffer_load_dwordx4 v10, s[12:15], s48 offen lds
s_mov_b32 m0, 67584
s_add_u32 s48, s49, 655360
buffer_load_dwordx4 v10, s[16:19], s48 offen lds
s_mov_b32 m0, 68608
s_add_u32 s48, s49, 720896
buffer_load_dwordx4 v10, s[16:19], s48 offen lds
s_mov_b32 m0, 75776
s_add_u32 s48, s49, 655488
buffer_load_dwordx4 v10, s[16:19], s48 offen lds
s_mov_b32 m0, 76800
s_add_u32 s48, s49, 721024
buffer_load_dwordx4 v10, s[16:19], s48 offen lds
s_mov_b32 m0, 83968
s_add_u32 s48, s49, 1179648
buffer_load_dwordx4 v10, s[8:11], s48 offen lds
s_mov_b32 m0, 84992
s_add_u32 s48, s49, 1245184
buffer_load_dwordx4 v10, s[8:11], s48 offen lds
s_mov_b32 m0, 92160
s_add_u32 s48, s49, 1179776
buffer_load_dwordx4 v10, s[8:11], s48 offen lds
s_mov_b32 m0, 93184
s_add_u32 s48, s49, 1245312
buffer_load_dwordx4 v10, s[8:11], s48 offen lds
s_mov_b32 m0, 100352
s_add_u32 s48, s49, 1179776
buffer_load_dwordx4 v10, s[12:15], s48 offen lds
s_mov_b32 m0, 101376
s_add_u32 s48, s49, 1245312
buffer_load_dwordx4 v10, s[12:15], s48 offen lds
s_mov_b32 m0, 108544
s_add_u32 s48, s49, 1179648
buffer_load_dwordx4 v10, s[16:19], s48 offen lds
s_mov_b32 m0, 109568
s_add_u32 s48, s49, 1245184
buffer_load_dwordx4 v10, s[16:19], s48 offen lds
s_mov_b32 m0, 116736
s_add_u32 s48, s49, 1703936
buffer_load_dwordx4 v10, s[8:11], s48 offen lds
s_mov_b32 m0, 117760
s_add_u32 s48, s49, 1769472
buffer_load_dwordx4 v10, s[8:11], s48 offen lds
s_mov_b32 m0, 124928
s_add_u32 s48, s49, 1704064
buffer_load_dwordx4 v10, s[8:11], s48 offen lds
s_mov_b32 m0, 125952
s_add_u32 s48, s49, 1769600
buffer_load_dwordx4 v10, s[8:11], s48 offen lds
s_waitcnt vmcnt(24)
s_barrier
s_mov_b32 m0, 133120
s_add_u32 s48, s49, 1704064
buffer_load_dwordx4 v10, s[12:15], s48 offen lds
s_mov_b32 m0, 134144
s_add_u32 s48, s49, 1769600
buffer_load_dwordx4 v10, s[12:15], s48 offen lds
s_mov_b32 m0, 141312
s_add_u32 s48, s49, 1703936
buffer_load_dwordx4 v10, s[16:19], s48 offen lds
s_mov_b32 m0, 142336
s_add_u32 s48, s49, 1769472
buffer_load_dwordx4 v10, s[16:19], s48 offen lds
s_mov_b32 m0, 149504
s_add_u32 s48, s49, 2228224
buffer_load_dwordx4 v10, s[8:11], s48 offen lds
s_mov_b32 m0, 150528
s_add_u32 s48, s49, 2293760
buffer_load_dwordx4 v10, s[8:11], s48 offen lds
s_mov_b32 m0, 157696
s_add_u32 s48, s49, 2228352
buffer_load_dwordx4 v10, s[8:11], s48 offen lds
s_mov_b32 m0, 158720
s_add_u32 s48, s49, 2293888
buffer_load_dwordx4 v10, s[8:11], s48 offen lds
ds_read_b64_tr_b16 a[24:25], v4 offset:0
ds_read_b64_tr_b16 a[26:27], v4 offset:1024
ds_read_b64_tr_b16 a[28:29], v4 offset:4096
ds_read_b64_tr_b16 a[30:31], v4 offset:5120
ds_read_b64_tr_b16 a[32:33], v4 offset:8192
ds_read_b64_tr_b16 a[34:35], v4 offset:9216
ds_read_b64_tr_b16 a[36:37], v4 offset:12288
ds_read_b64_tr_b16 a[38:39], v4 offset:13312
ds_read_b64_tr_b16 a[40:41], v4 offset:16384
ds_read_b64_tr_b16 a[42:43], v4 offset:17408
ds_read_b64_tr_b16 a[44:45], v4 offset:20480
ds_read_b64_tr_b16 a[46:47], v4 offset:21504
ds_read_b64_tr_b16 a[176:177], v4 offset:24576
ds_read_b64_tr_b16 a[178:179], v4 offset:25600
ds_read_b64_tr_b16 a[180:181], v4 offset:28672
ds_read_b64_tr_b16 a[182:183], v4 offset:29696
s_waitcnt lgkmcnt(0)
s_waitcnt vmcnt(24)
s_barrier
s_mov_b32 m0, 2048
s_add_u32 s48, s49, 2228352
buffer_load_dwordx4 v10, s[12:15], s48 offen lds
s_mov_b32 m0, 3072
s_add_u32 s48, s49, 2293888
buffer_load_dwordx4 v10, s[12:15], s48 offen lds
s_mov_b32 m0, 10240
s_add_u32 s48, s49, 2228224
buffer_load_dwordx4 v10, s[16:19], s48 offen lds
s_mov_b32 m0, 11264
s_add_u32 s48, s49, 2293760
buffer_load_dwordx4 v10, s[16:19], s48 offen lds
s_mov_b32 m0, 18432
s_add_u32 s48, s49, 2752512
buffer_load_dwordx4 v10, s[8:11], s48 offen lds
s_mov_b32 m0, 19456
s_add_u32 s48, s49, 2818048
buffer_load_dwordx4 v10, s[8:11], s48 offen lds
s_mov_b32 m0, 26624
s_add_u32 s48, s49, 2752640
buffer_load_dwordx4 v10, s[8:11], s48 offen lds
s_mov_b32 m0, 27648
s_add_u32 s48, s49, 2818176
buffer_load_dwordx4 v10, s[8:11], s48 offen lds
ds_read_b64_tr_b16 v[224:225], v4 offset:32768
ds_read_b64_tr_b16 v[226:227], v4 offset:33792
ds_read_b64_tr_b16 v[228:229], v4 offset:36864
ds_read_b64_tr_b16 v[230:231], v4 offset:37888
ds_read_b64_tr_b16 a[0:1], v4 offset:40960
ds_read_b64_tr_b16 a[2:3], v4 offset:41984
ds_read_b64_tr_b16 a[4:5], v4 offset:45056
ds_read_b64_tr_b16 a[6:7], v4 offset:46080
ds_read_b64_tr_b16 a[8:9], v4 offset:49152
ds_read_b64_tr_b16 a[10:11], v4 offset:50176
ds_read_b64_tr_b16 a[12:13], v4 offset:53248
ds_read_b64_tr_b16 a[14:15], v4 offset:54272
ds_read_b64_tr_b16 a[16:17], v4 offset:57344
ds_read_b64_tr_b16 a[18:19], v4 offset:58368
ds_read_b64_tr_b16 a[20:21], v4 offset:61440
ds_read_b64_tr_b16 a[22:23], v4 offset:62464
s_waitcnt lgkmcnt(0)
s_waitcnt vmcnt(24)
s_barrier
s_mov_b32 m0, 34816
s_add_u32 s48, s49, 2752640
buffer_load_dwordx4 v10, s[12:15], s48 offen lds
s_mov_b32 m0, 35840
s_add_u32 s48, s49, 2818176
buffer_load_dwordx4 v10, s[12:15], s48 offen lds
s_mov_b32 m0, 43008
s_add_u32 s48, s49, 2752512
buffer_load_dwordx4 v10, s[16:19], s48 offen lds
s_mov_b32 m0, 44032
s_add_u32 s48, s49, 2818048
buffer_load_dwordx4 v10, s[16:19], s48 offen lds
s_mov_b32 m0, 51200
s_add_u32 s48, s49, 3276928
buffer_load_dwordx4 v10, s[8:11], s48 offen lds
s_mov_b32 m0, 52224
s_add_u32 s48, s49, 3342464
buffer_load_dwordx4 v10, s[8:11], s48 offen lds
s_mov_b32 m0, 59392
s_add_u32 s48, s49, 3801088
buffer_load_dwordx4 v10, s[8:11], s48 offen lds
s_mov_b32 m0, 60416
s_add_u32 s48, s49, 3866624
buffer_load_dwordx4 v10, s[8:11], s48 offen lds
ds_read_b64_tr_b16 v[16:17], v5 offset:0
ds_read_b64_tr_b16 v[18:19], v5 offset:1024
ds_read_b64_tr_b16 v[20:21], v5 offset:4096
ds_read_b64_tr_b16 v[22:23], v5 offset:5120
ds_read_b64_tr_b16 v[24:25], v5 offset:8192
ds_read_b64_tr_b16 v[26:27], v5 offset:9216
ds_read_b64_tr_b16 v[28:29], v5 offset:12288
ds_read_b64_tr_b16 v[30:31], v5 offset:13312
ds_read_b64_tr_b16 a[144:145], v5 offset:16384
ds_read_b64_tr_b16 a[146:147], v5 offset:17408
ds_read_b64_tr_b16 a[148:149], v5 offset:20480
ds_read_b64_tr_b16 a[150:151], v5 offset:21504
ds_read_b64_tr_b16 a[152:153], v5 offset:24576
ds_read_b64_tr_b16 a[154:155], v5 offset:25600
ds_read_b64_tr_b16 a[156:157], v5 offset:28672
ds_read_b64_tr_b16 a[158:159], v5 offset:29696
s_waitcnt lgkmcnt(0)
buffer_store_dwordx4 v[16:19], v0, s[4:7], s60 offen offset:0
buffer_store_dwordx4 v[20:23], v0, s[4:7], s60 offen offset:1024
buffer_store_dwordx4 v[24:27], v0, s[4:7], s60 offen offset:2048
buffer_store_dwordx4 v[28:31], v0, s[4:7], s60 offen offset:3072
s_waitcnt vmcnt(28)
s_barrier
s_mov_b32 m0, 67584
s_add_u32 s48, s49, 3801216
buffer_load_dwordx4 v10, s[8:11], s48 offen lds
s_mov_b32 m0, 68608
s_add_u32 s48, s49, 3866752
buffer_load_dwordx4 v10, s[8:11], s48 offen lds
s_mov_b32 m0, 75776
s_add_u32 s48, s49, 4325376
buffer_load_dwordx4 v10, s[8:11], s48 offen lds
s_mov_b32 m0, 76800
s_add_u32 s48, s49, 4390912
buffer_load_dwordx4 v10, s[8:11], s48 offen lds
s_mov_b32 m0, 83968
s_add_u32 s48, s49, 4325504
buffer_load_dwordx4 v10, s[8:11], s48 offen lds
s_mov_b32 m0, 84992
s_add_u32 s48, s49, 4391040
buffer_load_dwordx4 v10, s[8:11], s48 offen lds
s_mov_b32 m0, 92160
s_add_u32 s48, s49, 4849664
buffer_load_dwordx4 v10, s[8:11], s48 offen lds
s_mov_b32 m0, 93184
s_add_u32 s48, s49, 4915200
buffer_load_dwordx4 v10, s[8:11], s48 offen lds
ds_read_b64_tr_b16 a[160:161], v5 offset:32768
ds_read_b64_tr_b16 a[162:163], v5 offset:33792
ds_read_b64_tr_b16 a[164:165], v5 offset:36864
ds_read_b64_tr_b16 a[166:167], v5 offset:37888
ds_read_b64_tr_b16 a[168:169], v5 offset:40960
ds_read_b64_tr_b16 a[170:171], v5 offset:41984
ds_read_b64_tr_b16 a[172:173], v5 offset:45056
ds_read_b64_tr_b16 a[174:175], v5 offset:46080
ds_read_b64_tr_b16 a[48:49], v5 offset:49152
ds_read_b64_tr_b16 a[50:51], v5 offset:50176
ds_read_b64_tr_b16 a[52:53], v5 offset:53248
ds_read_b64_tr_b16 a[54:55], v5 offset:54272
ds_read_b64_tr_b16 a[56:57], v5 offset:57344
ds_read_b64_tr_b16 a[58:59], v5 offset:58368
ds_read_b64_tr_b16 a[60:61], v5 offset:61440
ds_read_b64_tr_b16 a[62:63], v5 offset:62464
s_waitcnt lgkmcnt(0)
s_waitcnt vmcnt(28)
s_barrier
s_mov_b32 m0, 100352
s_add_u32 s48, s49, 4849792
buffer_load_dwordx4 v10, s[8:11], s48 offen lds
s_mov_b32 m0, 101376
s_add_u32 s48, s49, 4915328
buffer_load_dwordx4 v10, s[8:11], s48 offen lds
s_mov_b32 m0, 108544
s_add_u32 s48, s49, 3276800
buffer_load_dwordx4 v10, s[12:15], s48 offen lds
s_mov_b32 m0, 109568
s_add_u32 s48, s49, 3342336
buffer_load_dwordx4 v10, s[12:15], s48 offen lds
s_mov_b32 m0, 116736
s_add_u32 s48, s49, 3276928
buffer_load_dwordx4 v10, s[12:15], s48 offen lds
s_mov_b32 m0, 117760
s_add_u32 s48, s49, 3342464
buffer_load_dwordx4 v10, s[12:15], s48 offen lds
s_mov_b32 m0, 124928
s_add_u32 s48, s49, 3801088
buffer_load_dwordx4 v10, s[12:15], s48 offen lds
s_mov_b32 m0, 125952
s_add_u32 s48, s49, 3866624
buffer_load_dwordx4 v10, s[12:15], s48 offen lds
ds_read_b64_tr_b16 a[64:65], v6 offset:0
ds_read_b64_tr_b16 a[66:67], v6 offset:1024
ds_read_b64_tr_b16 a[68:69], v6 offset:4096
ds_read_b64_tr_b16 a[70:71], v6 offset:5120
ds_read_b64_tr_b16 a[72:73], v6 offset:8192
ds_read_b64_tr_b16 a[74:75], v6 offset:9216
ds_read_b64_tr_b16 a[76:77], v6 offset:12288
ds_read_b64_tr_b16 a[78:79], v6 offset:13312
ds_read_b64_tr_b16 a[80:81], v6 offset:16384
ds_read_b64_tr_b16 a[82:83], v6 offset:17408
ds_read_b64_tr_b16 a[84:85], v6 offset:20480
ds_read_b64_tr_b16 a[86:87], v6 offset:21504
ds_read_b64_tr_b16 a[88:89], v6 offset:24576
ds_read_b64_tr_b16 a[90:91], v6 offset:25600
ds_read_b64_tr_b16 a[92:93], v6 offset:28672
ds_read_b64_tr_b16 a[94:95], v6 offset:29696
s_waitcnt lgkmcnt(0)
s_waitcnt vmcnt(28)
s_barrier
s_mov_b32 m0, 133120
s_add_u32 s48, s49, 3801216
buffer_load_dwordx4 v10, s[12:15], s48 offen lds
s_mov_b32 m0, 134144
s_add_u32 s48, s49, 3866752
buffer_load_dwordx4 v10, s[12:15], s48 offen lds
s_mov_b32 m0, 141312
s_add_u32 s48, s49, 4325376
buffer_load_dwordx4 v10, s[12:15], s48 offen lds
s_mov_b32 m0, 142336
s_add_u32 s48, s49, 4390912
buffer_load_dwordx4 v10, s[12:15], s48 offen lds
s_mov_b32 m0, 149504
s_add_u32 s48, s49, 4325504
buffer_load_dwordx4 v10, s[12:15], s48 offen lds
s_mov_b32 m0, 150528
s_add_u32 s48, s49, 4391040
buffer_load_dwordx4 v10, s[12:15], s48 offen lds
s_mov_b32 m0, 157696
s_add_u32 s48, s49, 4849664
buffer_load_dwordx4 v10, s[12:15], s48 offen lds
s_mov_b32 m0, 158720
s_add_u32 s48, s49, 4915200
buffer_load_dwordx4 v10, s[12:15], s48 offen lds
ds_read_b64_tr_b16 a[96:97], v4 offset:0
ds_read_b64_tr_b16 a[98:99], v4 offset:1024
ds_read_b64_tr_b16 a[100:101], v4 offset:4096
ds_read_b64_tr_b16 a[102:103], v4 offset:5120
ds_read_b64_tr_b16 a[104:105], v4 offset:8192
ds_read_b64_tr_b16 a[106:107], v4 offset:9216
ds_read_b64_tr_b16 a[108:109], v4 offset:12288
ds_read_b64_tr_b16 a[110:111], v4 offset:13312
ds_read_b64_tr_b16 a[112:113], v4 offset:16384
ds_read_b64_tr_b16 a[114:115], v4 offset:17408
ds_read_b64_tr_b16 a[116:117], v4 offset:20480
ds_read_b64_tr_b16 a[118:119], v4 offset:21504
ds_read_b64_tr_b16 a[120:121], v4 offset:24576
ds_read_b64_tr_b16 a[122:123], v4 offset:25600
ds_read_b64_tr_b16 a[124:125], v4 offset:28672
ds_read_b64_tr_b16 a[126:127], v4 offset:29696
s_waitcnt lgkmcnt(0)
s_waitcnt vmcnt(28)
s_barrier
s_mov_b32 m0, 2048
s_add_u32 s48, s49, 4849792
buffer_load_dwordx4 v10, s[12:15], s48 offen lds
s_mov_b32 m0, 3072
s_add_u32 s48, s49, 4915328
buffer_load_dwordx4 v10, s[12:15], s48 offen lds
s_mov_b32 m0, 10240
s_add_u32 s48, s49, 3276800
buffer_load_dwordx4 v10, s[16:19], s48 offen lds
s_mov_b32 m0, 11264
s_add_u32 s48, s49, 3342336
buffer_load_dwordx4 v10, s[16:19], s48 offen lds
s_mov_b32 m0, 18432
s_add_u32 s48, s49, 3276928
buffer_load_dwordx4 v10, s[16:19], s48 offen lds
s_mov_b32 m0, 19456
s_add_u32 s48, s49, 3342464
buffer_load_dwordx4 v10, s[16:19], s48 offen lds
s_mov_b32 m0, 26624
s_add_u32 s48, s49, 3801088
buffer_load_dwordx4 v10, s[16:19], s48 offen lds
s_mov_b32 m0, 27648
s_add_u32 s48, s49, 3866624
buffer_load_dwordx4 v10, s[16:19], s48 offen lds
ds_read_b64_tr_b16 a[128:129], v4 offset:32768
ds_read_b64_tr_b16 a[130:131], v4 offset:33792
ds_read_b64_tr_b16 a[132:133], v4 offset:36864
ds_read_b64_tr_b16 a[134:135], v4 offset:37888
ds_read_b64_tr_b16 a[136:137], v4 offset:40960
ds_read_b64_tr_b16 a[138:139], v4 offset:41984
ds_read_b64_tr_b16 a[140:141], v4 offset:45056
ds_read_b64_tr_b16 a[142:143], v4 offset:46080
ds_read_b64_tr_b16 a[232:233], v4 offset:49152
ds_read_b64_tr_b16 a[234:235], v4 offset:50176
ds_read_b64_tr_b16 a[236:237], v4 offset:53248
ds_read_b64_tr_b16 a[238:239], v4 offset:54272
ds_read_b64_tr_b16 a[184:185], v4 offset:57344
ds_read_b64_tr_b16 a[186:187], v4 offset:58368
ds_read_b64_tr_b16 a[188:189], v4 offset:61440
ds_read_b64_tr_b16 a[190:191], v4 offset:62464
s_waitcnt lgkmcnt(0)
s_waitcnt vmcnt(24)
s_barrier
s_mov_b32 m0, 34816
s_add_u32 s48, s49, 3801216
buffer_load_dwordx4 v10, s[16:19], s48 offen lds
s_mov_b32 m0, 35840
s_add_u32 s48, s49, 3866752
buffer_load_dwordx4 v10, s[16:19], s48 offen lds
s_mov_b32 m0, 43008
s_add_u32 s48, s49, 4325376
buffer_load_dwordx4 v10, s[16:19], s48 offen lds
s_mov_b32 m0, 44032
s_add_u32 s48, s49, 4390912
buffer_load_dwordx4 v10, s[16:19], s48 offen lds
s_mov_b32 m0, 51200
s_add_u32 s48, s49, 4325504
buffer_load_dwordx4 v10, s[16:19], s48 offen lds
s_mov_b32 m0, 52224
s_add_u32 s48, s49, 4391040
buffer_load_dwordx4 v10, s[16:19], s48 offen lds
s_mov_b32 m0, 59392
s_add_u32 s48, s49, 4849664
buffer_load_dwordx4 v10, s[16:19], s48 offen lds
s_mov_b32 m0, 60416
s_add_u32 s48, s49, 4915200
buffer_load_dwordx4 v10, s[16:19], s48 offen lds
ds_read_b64_tr_b16 a[192:193], v5 offset:0
ds_read_b64_tr_b16 a[194:195], v5 offset:1024
ds_read_b64_tr_b16 a[196:197], v5 offset:4096
ds_read_b64_tr_b16 a[198:199], v5 offset:5120
ds_read_b64_tr_b16 v[248:249], v5 offset:8192
ds_read_b64_tr_b16 v[250:251], v5 offset:9216
ds_read_b64_tr_b16 v[252:253], v5 offset:12288
ds_read_b64_tr_b16 v[254:255], v5 offset:13312
ds_read_b64_tr_b16 a[200:201], v5 offset:16384
ds_read_b64_tr_b16 a[202:203], v5 offset:17408
ds_read_b64_tr_b16 a[204:205], v5 offset:20480
ds_read_b64_tr_b16 a[206:207], v5 offset:21504
ds_read_b64_tr_b16 a[208:209], v5 offset:24576
ds_read_b64_tr_b16 a[210:211], v5 offset:25600
ds_read_b64_tr_b16 a[212:213], v5 offset:28672
ds_read_b64_tr_b16 a[214:215], v5 offset:29696
s_waitcnt lgkmcnt(0)
s_waitcnt vmcnt(24)
s_barrier
s_mov_b32 m0, 67584
s_add_u32 s48, s49, 4849792
buffer_load_dwordx4 v10, s[16:19], s48 offen lds
s_mov_b32 m0, 68608
s_add_u32 s48, s49, 4915328
buffer_load_dwordx4 v10, s[16:19], s48 offen lds
s_mov_b32 m0, 75776
s_add_u32 s48, s50, 10240
buffer_load_dwordx4 v11, s[20:23], s48 offen lds
s_mov_b32 m0, 76800
s_add_u32 s48, s50, 15360
buffer_load_dwordx4 v11, s[20:23], s48 offen lds
s_mov_b32 m0, 83968
s_add_u32 s48, s50, 30720
buffer_load_dwordx4 v11, s[20:23], s48 offen lds
s_mov_b32 m0, 84992
s_add_u32 s48, s50, 35840
buffer_load_dwordx4 v11, s[20:23], s48 offen lds
s_mov_b32 m0, 92160
s_add_u32 s48, s50, 51200
buffer_load_dwordx4 v11, s[20:23], s48 offen lds
s_mov_b32 m0, 93184
s_add_u32 s48, s50, 56320
buffer_load_dwordx4 v11, s[20:23], s48 offen lds
ds_read_b64_tr_b16 a[216:217], v5 offset:32768
ds_read_b64_tr_b16 a[218:219], v5 offset:33792
ds_read_b64_tr_b16 a[220:221], v5 offset:36864
ds_read_b64_tr_b16 a[222:223], v5 offset:37888
ds_read_b64_tr_b16 v[96:97], v5 offset:40960
ds_read_b64_tr_b16 v[98:99], v5 offset:41984
ds_read_b64_tr_b16 v[100:101], v5 offset:45056
ds_read_b64_tr_b16 v[102:103], v5 offset:46080
ds_read_b64_tr_b16 v[104:105], v5 offset:49152
ds_read_b64_tr_b16 v[106:107], v5 offset:50176
ds_read_b64_tr_b16 v[108:109], v5 offset:53248
ds_read_b64_tr_b16 v[110:111], v5 offset:54272
ds_read_b64_tr_b16 v[240:241], v5 offset:57344
ds_read_b64_tr_b16 v[242:243], v5 offset:58368
ds_read_b64_tr_b16 v[244:245], v5 offset:61440
ds_read_b64_tr_b16 v[246:247], v5 offset:62464
s_waitcnt lgkmcnt(0)
s_waitcnt vmcnt(24)
s_barrier
s_mov_b32 m0, 100352
s_add_u32 s48, s50, 71680
buffer_load_dwordx4 v11, s[20:23], s48 offen lds
s_mov_b32 m0, 101376
s_add_u32 s48, s50, 76800
buffer_load_dwordx4 v11, s[20:23], s48 offen lds
s_mov_b32 m0, 108544
s_add_u32 s48, s50, 10496
buffer_load_dwordx4 v11, s[20:23], s48 offen lds
s_mov_b32 m0, 109568
s_add_u32 s48, s50, 15616
buffer_load_dwordx4 v11, s[20:23], s48 offen lds
s_mov_b32 m0, 116736
s_add_u32 s48, s50, 30976
buffer_load_dwordx4 v11, s[20:23], s48 offen lds
s_mov_b32 m0, 117760
s_add_u32 s48, s50, 36096
buffer_load_dwordx4 v11, s[20:23], s48 offen lds
s_mov_b32 m0, 124928
s_add_u32 s48, s50, 51456
buffer_load_dwordx4 v11, s[20:23], s48 offen lds
s_mov_b32 m0, 125952
s_add_u32 s48, s50, 56576
buffer_load_dwordx4 v11, s[20:23], s48 offen lds
ds_read_b64_tr_b16 a[240:241], v6 offset:0
ds_read_b64_tr_b16 a[242:243], v6 offset:1024
ds_read_b64_tr_b16 a[244:245], v6 offset:4096
ds_read_b64_tr_b16 a[246:247], v6 offset:5120
ds_read_b64_tr_b16 a[248:249], v6 offset:8192
ds_read_b64_tr_b16 a[250:251], v6 offset:9216
ds_read_b64_tr_b16 a[252:253], v6 offset:12288
ds_read_b64_tr_b16 a[254:255], v6 offset:13312
ds_read_b64_tr_b16 v[72:73], v6 offset:16384
ds_read_b64_tr_b16 v[74:75], v6 offset:17408
ds_read_b64_tr_b16 v[76:77], v6 offset:20480
ds_read_b64_tr_b16 v[78:79], v6 offset:21504
ds_read_b64_tr_b16 v[80:81], v6 offset:24576
ds_read_b64_tr_b16 v[82:83], v6 offset:25600
ds_read_b64_tr_b16 v[84:85], v6 offset:28672
ds_read_b64_tr_b16 v[86:87], v6 offset:29696
s_waitcnt lgkmcnt(0)
s_waitcnt vmcnt(24)
s_barrier
s_mov_b32 m0, 133120
s_add_u32 s48, s50, 71936
buffer_load_dwordx4 v11, s[20:23], s48 offen lds
s_mov_b32 m0, 134144
s_add_u32 s48, s50, 77056
buffer_load_dwordx4 v11, s[20:23], s48 offen lds
s_mov_b32 m0, 141312
s_add_u32 s48, s50, 10752
buffer_load_dwordx4 v11, s[20:23], s48 offen lds
s_mov_b32 m0, 142336
s_add_u32 s48, s50, 15872
buffer_load_dwordx4 v11, s[20:23], s48 offen lds
s_mov_b32 m0, 149504
s_add_u32 s48, s50, 31232
buffer_load_dwordx4 v11, s[20:23], s48 offen lds
s_mov_b32 m0, 150528
s_add_u32 s48, s50, 36352
buffer_load_dwordx4 v11, s[20:23], s48 offen lds
s_mov_b32 m0, 157696
s_add_u32 s48, s50, 51712
buffer_load_dwordx4 v11, s[20:23], s48 offen lds
s_mov_b32 m0, 158720
s_add_u32 s48, s50, 56832
buffer_load_dwordx4 v11, s[20:23], s48 offen lds
ds_read_b64_tr_b16 v[88:89], v4 offset:0
ds_read_b64_tr_b16 v[90:91], v4 offset:1024
ds_read_b64_tr_b16 v[92:93], v4 offset:4096
ds_read_b64_tr_b16 v[94:95], v4 offset:5120
ds_read_b64_tr_b16 v[160:161], v4 offset:8192
ds_read_b64_tr_b16 v[162:163], v4 offset:9216
ds_read_b64_tr_b16 v[164:165], v4 offset:12288
ds_read_b64_tr_b16 v[166:167], v4 offset:13312
ds_read_b64_tr_b16 v[168:169], v4 offset:16384
ds_read_b64_tr_b16 v[170:171], v4 offset:17408
ds_read_b64_tr_b16 v[172:173], v4 offset:20480
ds_read_b64_tr_b16 v[174:175], v4 offset:21504
ds_read_b64_tr_b16 v[112:113], v4 offset:24576
ds_read_b64_tr_b16 v[114:115], v4 offset:25600
ds_read_b64_tr_b16 v[116:117], v4 offset:28672
ds_read_b64_tr_b16 v[118:119], v4 offset:29696
s_waitcnt lgkmcnt(0)
s_waitcnt vmcnt(24)
s_barrier
s_mov_b32 m0, 2048
s_add_u32 s48, s50, 72192
buffer_load_dwordx4 v11, s[20:23], s48 offen lds
s_mov_b32 m0, 3072
s_add_u32 s48, s50, 77312
buffer_load_dwordx4 v11, s[20:23], s48 offen lds
s_mov_b32 m0, 10240
s_add_u32 s48, s49, 131072
buffer_load_dwordx4 v10, s[12:15], s48 offen lds
s_mov_b32 m0, 11264
s_add_u32 s48, s49, 196608
buffer_load_dwordx4 v10, s[12:15], s48 offen lds
s_mov_b32 m0, 18432
s_add_u32 s48, s49, 655360
buffer_load_dwordx4 v10, s[12:15], s48 offen lds
s_mov_b32 m0, 19456
s_add_u32 s48, s49, 720896
buffer_load_dwordx4 v10, s[12:15], s48 offen lds
s_mov_b32 m0, 26624
s_add_u32 s48, s49, 1179648
buffer_load_dwordx4 v10, s[12:15], s48 offen lds
s_mov_b32 m0, 27648
s_add_u32 s48, s49, 1245184
buffer_load_dwordx4 v10, s[12:15], s48 offen lds
ds_read_b64_tr_b16 v[120:121], v4 offset:32768
ds_read_b64_tr_b16 v[122:123], v4 offset:33792
ds_read_b64_tr_b16 v[124:125], v4 offset:36864
ds_read_b64_tr_b16 v[126:127], v4 offset:37888
ds_read_b64_tr_b16 v[128:129], v4 offset:40960
ds_read_b64_tr_b16 v[130:131], v4 offset:41984
ds_read_b64_tr_b16 v[132:133], v4 offset:45056
ds_read_b64_tr_b16 v[134:135], v4 offset:46080
ds_read_b64_tr_b16 v[136:137], v4 offset:49152
ds_read_b64_tr_b16 v[138:139], v4 offset:50176
ds_read_b64_tr_b16 v[140:141], v4 offset:53248
ds_read_b64_tr_b16 v[142:143], v4 offset:54272
ds_read_b64_tr_b16 v[144:145], v4 offset:57344
ds_read_b64_tr_b16 v[146:147], v4 offset:58368
ds_read_b64_tr_b16 v[148:149], v4 offset:61440
ds_read_b64_tr_b16 v[150:151], v4 offset:62464
s_waitcnt lgkmcnt(0)
s_waitcnt vmcnt(24)
s_barrier
s_mov_b32 m0, 34816
s_add_u32 s48, s49, 1703936
buffer_load_dwordx4 v10, s[12:15], s48 offen lds
s_mov_b32 m0, 35840
s_add_u32 s48, s49, 1769472
buffer_load_dwordx4 v10, s[12:15], s48 offen lds
s_mov_b32 m0, 43008
s_add_u32 s48, s49, 2228224
buffer_load_dwordx4 v10, s[12:15], s48 offen lds
s_mov_b32 m0, 44032
s_add_u32 s48, s49, 2293760
buffer_load_dwordx4 v10, s[12:15], s48 offen lds
s_mov_b32 m0, 51200
s_add_u32 s48, s49, 2752512
buffer_load_dwordx4 v10, s[12:15], s48 offen lds
s_mov_b32 m0, 52224
s_add_u32 s48, s49, 2818048
buffer_load_dwordx4 v10, s[12:15], s48 offen lds
s_mov_b32 m0, 59392
s_add_u32 s48, s49, 1179776
buffer_load_dwordx4 v10, s[16:19], s48 offen lds
s_mov_b32 m0, 60416
s_add_u32 s48, s49, 1245312
buffer_load_dwordx4 v10, s[16:19], s48 offen lds
ds_read_b64_tr_b16 v[152:153], v5 offset:0
ds_read_b64_tr_b16 v[154:155], v5 offset:1024
ds_read_b64_tr_b16 v[156:157], v5 offset:4096
ds_read_b64_tr_b16 v[158:159], v5 offset:5120
ds_read_b64_tr_b16 v[192:193], v8 offset:8192
ds_read_b64_tr_b16 v[194:195], v8 offset:8704
ds_read_b64_tr_b16 v[196:197], v8 offset:10240
ds_read_b64_tr_b16 v[198:199], v8 offset:10752
v_xor_b32 v12, v15, v8
ds_read_b64_tr_b16 v[32:33], v12 offset:16384
ds_read_b64_tr_b16 v[34:35], v12 offset:16896
ds_read_b64_tr_b16 v[36:37], v12 offset:18432
ds_read_b64_tr_b16 v[38:39], v12 offset:18944
ds_read_b64_tr_b16 v[176:177], v8 offset:24576
ds_read_b64_tr_b16 v[178:179], v8 offset:25088
ds_read_b64_tr_b16 v[180:181], v8 offset:26624
ds_read_b64_tr_b16 v[182:183], v8 offset:27136
s_waitcnt lgkmcnt(0)
buffer_store_dwordx4 v[32:35], v0, s[4:7], s61 offen offset:0
buffer_store_dwordx4 v[36:39], v0, s[4:7], s61 offen offset:1024
s_waitcnt vmcnt(26)
s_barrier
s_mov_b32 m0, 67584
s_add_u32 s48, s49, 1704064
buffer_load_dwordx4 v10, s[16:19], s48 offen lds
s_mov_b32 m0, 68608
s_add_u32 s48, s49, 1769600
buffer_load_dwordx4 v10, s[16:19], s48 offen lds
s_mov_b32 m0, 75776
s_add_u32 s48, s49, 2228352
buffer_load_dwordx4 v10, s[16:19], s48 offen lds
s_mov_b32 m0, 76800
s_add_u32 s48, s49, 2293888
buffer_load_dwordx4 v10, s[16:19], s48 offen lds
s_mov_b32 m0, 83968
s_add_u32 s48, s49, 2752640
buffer_load_dwordx4 v10, s[16:19], s48 offen lds
s_mov_b32 m0, 84992
s_add_u32 s48, s49, 2818176
buffer_load_dwordx4 v10, s[16:19], s48 offen lds
s_mov_b32 m0, 92160
s_add_u32 s48, s50, 11008
buffer_load_dwordx4 v11, s[20:23], s48 offen lds
s_mov_b32 m0, 93184
s_add_u32 s48, s50, 16128
buffer_load_dwordx4 v11, s[20:23], s48 offen lds
ds_read_b64_tr_b16 v[184:185], v8 offset:32768
ds_read_b64_tr_b16 v[186:187], v8 offset:33280
ds_read_b64_tr_b16 v[188:189], v8 offset:34816
ds_read_b64_tr_b16 v[190:191], v8 offset:35328
ds_read_b64_tr_b16 v[24:25], v8 offset:40960
ds_read_b64_tr_b16 v[26:27], v8 offset:41472
ds_read_b64_tr_b16 v[28:29], v8 offset:43008
ds_read_b64_tr_b16 v[30:31], v8 offset:43520
v_xor_b32 v12, v15, v8
ds_read_b64_tr_b16 v[32:33], v12 offset:49152
ds_read_b64_tr_b16 v[34:35], v12 offset:49664
ds_read_b64_tr_b16 v[36:37], v12 offset:51200
ds_read_b64_tr_b16 v[38:39], v12 offset:51712
ds_read_b64_tr_b16 a[224:225], v8 offset:57344
ds_read_b64_tr_b16 a[226:227], v8 offset:57856
ds_read_b64_tr_b16 a[228:229], v8 offset:59392
ds_read_b64_tr_b16 a[230:231], v8 offset:59904
s_waitcnt lgkmcnt(0)
buffer_store_dwordx4 v[24:27], v0, s[4:7], s62 offen offset:0
buffer_store_dwordx4 v[28:31], v0, s[4:7], s62 offen offset:1024
buffer_store_dwordx4 v[32:35], v0, s[4:7], s61 offen offset:2048
buffer_store_dwordx4 v[36:39], v0, s[4:7], s61 offen offset:3072
s_waitcnt vmcnt(30)
s_barrier
s_mov_b32 m0, 100352
s_add_u32 s48, s50, 31488
buffer_load_dwordx4 v11, s[20:23], s48 offen lds
s_mov_b32 m0, 101376
s_add_u32 s48, s50, 36608
buffer_load_dwordx4 v11, s[20:23], s48 offen lds
s_mov_b32 m0, 108544
s_add_u32 s48, s50, 51968
buffer_load_dwordx4 v11, s[20:23], s48 offen lds
s_mov_b32 m0, 109568
s_add_u32 s48, s50, 57088
buffer_load_dwordx4 v11, s[20:23], s48 offen lds
s_mov_b32 m0, 116736
s_add_u32 s48, s50, 72448
buffer_load_dwordx4 v11, s[20:23], s48 offen lds
s_mov_b32 m0, 117760
s_add_u32 s48, s50, 77568
buffer_load_dwordx4 v11, s[20:23], s48 offen lds
s_mov_b32 m0, 124928
s_add_u32 s48, s50, 11264
buffer_load_dwordx4 v11, s[20:23], s48 offen lds
s_mov_b32 m0, 125952
s_add_u32 s48, s50, 16384
buffer_load_dwordx4 v11, s[20:23], s48 offen lds
ds_read_b64_tr_b16 v[232:233], v9 offset:0
ds_read_b64_tr_b16 v[234:235], v9 offset:512
ds_read_b64_tr_b16 v[236:237], v9 offset:2048
ds_read_b64_tr_b16 v[238:239], v9 offset:2560
ds_read_b64_tr_b16 v[216:217], v9 offset:8192
ds_read_b64_tr_b16 v[218:219], v9 offset:8704
ds_read_b64_tr_b16 v[220:221], v9 offset:10240
ds_read_b64_tr_b16 v[222:223], v9 offset:10752
v_xor_b32 v12, v15, v9
ds_read_b64_tr_b16 v[200:201], v12 offset:16384
ds_read_b64_tr_b16 v[202:203], v12 offset:16896
ds_read_b64_tr_b16 v[204:205], v12 offset:18432
ds_read_b64_tr_b16 v[206:207], v12 offset:18944
ds_read_b64_tr_b16 v[40:41], v9 offset:24576
ds_read_b64_tr_b16 v[42:43], v9 offset:25088
ds_read_b64_tr_b16 v[44:45], v9 offset:26624
ds_read_b64_tr_b16 v[46:47], v9 offset:27136
s_waitcnt lgkmcnt(0)
buffer_store_dwordx4 v[40:43], v0, s[4:7], s62 offen offset:2048
buffer_store_dwordx4 v[44:47], v0, s[4:7], s62 offen offset:3072
s_waitcnt vmcnt(38)
s_barrier
s_mov_b32 m0, 133120
s_add_u32 s48, s50, 31744
buffer_load_dwordx4 v11, s[20:23], s48 offen lds
s_mov_b32 m0, 134144
s_add_u32 s48, s50, 36864
buffer_load_dwordx4 v11, s[20:23], s48 offen lds
s_mov_b32 m0, 141312
s_add_u32 s48, s50, 52224
buffer_load_dwordx4 v11, s[20:23], s48 offen lds
s_mov_b32 m0, 142336
s_add_u32 s48, s50, 57344
buffer_load_dwordx4 v11, s[20:23], s48 offen lds
s_mov_b32 m0, 149504
s_add_u32 s48, s50, 72704
buffer_load_dwordx4 v11, s[20:23], s48 offen lds
s_mov_b32 m0, 150528
s_add_u32 s48, s50, 77824
buffer_load_dwordx4 v11, s[20:23], s48 offen lds
s_mov_b32 m0, 157696
s_add_u32 s48, s49, 3276800
buffer_load_dwordx4 v10, s[8:11], s48 offen lds
s_mov_b32 m0, 158720
s_add_u32 s48, s49, 3342336
buffer_load_dwordx4 v10, s[8:11], s48 offen lds
ds_read_b64_tr_b16 v[208:209], v7 offset:0
ds_read_b64_tr_b16 v[210:211], v7 offset:512
ds_read_b64_tr_b16 v[212:213], v7 offset:2048
ds_read_b64_tr_b16 v[214:215], v7 offset:2560
s_waitcnt lgkmcnt(0)
s_waitcnt vmcnt(32)
s_barrier
ds_read_b64_tr_b16 v[16:17], v4 offset:8192
ds_read_b64_tr_b16 v[18:19], v4 offset:9216
ds_read_b64_tr_b16 v[20:21], v4 offset:12288
ds_read_b64_tr_b16 v[22:23], v4 offset:13312
ds_read_b64_tr_b16 v[24:25], v4 offset:16384
ds_read_b64_tr_b16 v[26:27], v4 offset:17408
ds_read_b64_tr_b16 v[28:29], v4 offset:20480
ds_read_b64_tr_b16 v[30:31], v4 offset:21504
ds_read_b64_tr_b16 v[32:33], v4 offset:24576
ds_read_b64_tr_b16 v[34:35], v4 offset:25600
ds_read_b64_tr_b16 v[36:37], v4 offset:28672
ds_read_b64_tr_b16 v[38:39], v4 offset:29696
ds_read_b64_tr_b16 v[40:41], v4 offset:32768
ds_read_b64_tr_b16 v[42:43], v4 offset:33792
ds_read_b64_tr_b16 v[44:45], v4 offset:36864
ds_read_b64_tr_b16 v[46:47], v4 offset:37888
ds_read_b64_tr_b16 v[48:49], v4 offset:40960
ds_read_b64_tr_b16 v[50:51], v4 offset:41984
ds_read_b64_tr_b16 v[52:53], v4 offset:45056
ds_read_b64_tr_b16 v[54:55], v4 offset:46080
ds_read_b64_tr_b16 v[56:57], v4 offset:49152
ds_read_b64_tr_b16 v[58:59], v4 offset:50176
ds_read_b64_tr_b16 v[60:61], v4 offset:53248
ds_read_b64_tr_b16 v[62:63], v4 offset:54272
ds_read_b64_tr_b16 v[64:65], v4 offset:57344
ds_read_b64_tr_b16 v[66:67], v4 offset:58368
ds_read_b64_tr_b16 v[68:69], v4 offset:61440
ds_read_b64_tr_b16 v[70:71], v4 offset:62464
s_waitcnt lgkmcnt(0)
s_barrier
ds_write_b128 v0, v[16:19] offset:22528
ds_write_b128 v0, v[20:23] offset:23552
ds_write_b128 v0, v[24:27] offset:24576
ds_write_b128 v0, v[28:31] offset:25600
ds_write_b128 v0, v[32:35] offset:26624
ds_write_b128 v0, v[36:39] offset:27648
ds_write_b128 v0, v[40:43] offset:28672
ds_write_b128 v0, v[44:47] offset:29696
ds_write_b128 v0, v[48:51] offset:30720
ds_write_b128 v0, v[52:55] offset:31744
ds_write_b128 v0, v[56:59] offset:32768
ds_write_b128 v0, v[60:63] offset:33792
ds_write_b128 v0, a[176:179] offset:34816
ds_write_b128 v0, a[180:183] offset:35840
s_waitcnt lgkmcnt(0)
v_accvgpr_write_b32 a176, v64
v_accvgpr_write_b32 a177, v65
v_accvgpr_write_b32 a178, v66
v_accvgpr_write_b32 a179, v67
v_accvgpr_write_b32 a180, v68
v_accvgpr_write_b32 a181, v69
v_accvgpr_write_b32 a182, v70
v_accvgpr_write_b32 a183, v71
s_waitcnt vmcnt(6)
s_barrier
ds_read_b64_tr_b16 v[16:17], v8 offset:24576
ds_read_b64_tr_b16 v[18:19], v8 offset:25088
ds_read_b64_tr_b16 v[20:21], v8 offset:26624
ds_read_b64_tr_b16 v[22:23], v8 offset:27136
v_xor_b32 v12, v15, v8
ds_read_b64_tr_b16 v[24:25], v12 offset:32768
ds_read_b64_tr_b16 v[26:27], v12 offset:33280
ds_read_b64_tr_b16 v[28:29], v12 offset:34816
ds_read_b64_tr_b16 v[30:31], v12 offset:35328
ds_read_b64_tr_b16 v[32:33], v8 offset:40960
ds_read_b64_tr_b16 v[34:35], v8 offset:41472
ds_read_b64_tr_b16 v[36:37], v8 offset:43008
ds_read_b64_tr_b16 v[38:39], v8 offset:43520
ds_read_b64_tr_b16 v[40:41], v8 offset:49152
ds_read_b64_tr_b16 v[42:43], v8 offset:49664
ds_read_b64_tr_b16 v[44:45], v8 offset:51200
ds_read_b64_tr_b16 v[46:47], v8 offset:51712
ds_read_b64_tr_b16 v[48:49], v8 offset:57344
ds_read_b64_tr_b16 v[50:51], v8 offset:57856
ds_read_b64_tr_b16 v[52:53], v8 offset:59392
ds_read_b64_tr_b16 v[54:55], v8 offset:59904
v_xor_b32 v12, v15, v9
ds_read_b64_tr_b16 v[56:57], v12 offset:0
ds_read_b64_tr_b16 v[58:59], v12 offset:512
ds_read_b64_tr_b16 v[60:61], v12 offset:2048
ds_read_b64_tr_b16 v[62:63], v12 offset:2560
s_waitcnt lgkmcnt(0)
s_barrier
ds_write_b128 v2, v[232:235] offset:28672
ds_write_b128 v2, v[236:239] offset:29696
ds_write_b128 v2, v[224:227] offset:30720
ds_write_b128 v2, v[228:231] offset:31744
ds_write_b128 v2, v[32:35] offset:32768
ds_write_b128 v2, v[36:39] offset:33792
ds_write_b128 v2, v[40:43] offset:34816
ds_write_b128 v2, v[44:47] offset:35840
ds_write_b128 v2, v[248:251] offset:36864
ds_write_b128 v2, v[252:255] offset:37888
ds_write_b128 v2, v[240:243] offset:38912
ds_write_b128 v2, v[244:247] offset:39936
s_waitcnt lgkmcnt(0)
v_mov_b32 v232, v16
v_mov_b32 v233, v17
v_mov_b32 v234, v18
v_mov_b32 v235, v19
v_mov_b32 v236, v20
v_mov_b32 v237, v21
v_mov_b32 v238, v22
v_mov_b32 v239, v23
v_mov_b32 v224, v24
v_mov_b32 v225, v25
v_mov_b32 v226, v26
v_mov_b32 v227, v27
v_mov_b32 v228, v28
v_mov_b32 v229, v29
v_mov_b32 v230, v30
v_mov_b32 v231, v31
v_mov_b32 v248, v48
v_mov_b32 v249, v49
v_mov_b32 v250, v50
v_mov_b32 v251, v51
v_mov_b32 v252, v52
v_mov_b32 v253, v53
v_mov_b32 v254, v54
v_mov_b32 v255, v55
v_mov_b32 v240, v56
v_mov_b32 v241, v57
v_mov_b32 v242, v58
v_mov_b32 v243, v59
v_mov_b32 v244, v60
v_mov_b32 v245, v61
v_mov_b32 v246, v62
v_mov_b32 v247, v63
s_waitcnt vmcnt(0)
s_barrier
ds_read_b64_tr_b16 v[16:17], v5 offset:0
ds_read_b64_tr_b16 v[18:19], v5 offset:1024
ds_read_b64_tr_b16 v[20:21], v5 offset:4096
ds_read_b64_tr_b16 v[22:23], v5 offset:5120
ds_read_b64_tr_b16 v[24:25], v5 offset:8192
ds_read_b64_tr_b16 v[26:27], v5 offset:9216
ds_read_b64_tr_b16 v[28:29], v5 offset:12288
ds_read_b64_tr_b16 v[30:31], v5 offset:13312
ds_read_b64_tr_b16 v[32:33], v5 offset:16384
ds_read_b64_tr_b16 v[34:35], v5 offset:17408
ds_read_b64_tr_b16 v[36:37], v5 offset:20480
ds_read_b64_tr_b16 v[38:39], v5 offset:21504
ds_read_b64_tr_b16 v[40:41], v9 offset:8192
ds_read_b64_tr_b16 v[42:43], v9 offset:8704
ds_read_b64_tr_b16 v[44:45], v9 offset:10240
ds_read_b64_tr_b16 v[46:47], v9 offset:10752
ds_read_b64_tr_b16 v[48:49], v9 offset:16384
ds_read_b64_tr_b16 v[50:51], v9 offset:16896
ds_read_b64_tr_b16 v[52:53], v9 offset:18432
ds_read_b64_tr_b16 v[54:55], v9 offset:18944
ds_read_b64_tr_b16 v[56:57], v6 offset:24576
ds_read_b64_tr_b16 v[58:59], v6 offset:25600
ds_read_b64_tr_b16 v[60:61], v6 offset:28672
ds_read_b64_tr_b16 v[62:63], v6 offset:29696
s_waitcnt lgkmcnt(0)
s_barrier
ds_write_b128 v2, v[16:19] offset:53248
ds_write_b128 v2, v[20:23] offset:54272
ds_write_b128 v2, v[24:27] offset:55296
ds_write_b128 v2, v[28:31] offset:56320
ds_write_b128 v2, v[32:35] offset:57344
ds_write_b128 v2, v[36:39] offset:58368
ds_write_b128 v2, v[40:43] offset:59392
ds_write_b128 v2, v[44:47] offset:60416
ds_write_b128 v2, v[48:51] offset:61440
ds_write_b128 v2, v[52:55] offset:62464
ds_write_b128 v2, a[224:227] offset:63488
ds_write_b128 v2, a[228:231] offset:64512
s_waitcnt lgkmcnt(0)
v_accvgpr_write_b32 a224, v56
v_accvgpr_write_b32 a225, v57
v_accvgpr_write_b32 a226, v58
v_accvgpr_write_b32 a227, v59
v_accvgpr_write_b32 a228, v60
v_accvgpr_write_b32 a229, v61
v_accvgpr_write_b32 a230, v62
v_accvgpr_write_b32 a231, v63
s_mov_b32 s90, 0x300003
s_mov_b32 s91, 0x300003
s_mov_b32 s12, 0x3030303
s_mov_b32 s13, 0x3030303
s_mov_b32 s92, 0xc0000c
s_mov_b32 s93, 0xc0000c
s_mov_b32 s14, 0xc0c0c0c
s_mov_b32 s15, 0xc0c0c0c
s_mov_b32 s94, 0x30000300
s_mov_b32 s95, 0x30000300
s_mov_b32 s16, 0x30303030
s_mov_b32 s17, 0x30303030
s_mov_b32 s96, 0xc0000c00
s_mov_b32 s97, 0xc0000c00
s_mov_b32 s18, 0xc0c0c0c0
s_mov_b32 s19, 0xc0c0c0c0
s_mov_b32 s98, 0xff00ff00
s_mov_b32 s99, 0xff00ff00
v_mov_b32 v1, 0x4444
v_mov_b32 v4, 0xeeee
v_cndmask_b32 v1, v1, v4, s[98:99]
v_lshrrev_b32 v4, 8, v0
v_lshl_or_b32 v1, v4, 28, v1
v_bfe_u32 v4, v0, 4, 4
v_lshl_or_b32 v1, v4, 19, v1
s_mov_b32 s51, 0x3e0293ee
s_mov_b32 s52, 0x3f803f80
s_mov_b32 s53, 0x3f803f80
s_mov_b32 s54, 0x3f003f00
s_mov_b32 s55, 0x3f003f00
s_mov_b32 s56, 0xff800000
s_mov_b32 s57, 0xff800000
s_mov_b32 s58, 0x3f80
s_mov_b32 s8, s4
s_mov_b32 s9, s5
s_cmp_eq_u32 s30, 29
s_cselect_b32 s10, s6, 0
s_mov_b32 s31, 0
s_mov_b32 s45, -2
s_lshl_b32 s46, s30, 6
s_add_u32 s46, s46, 222330880
s_lshl_b32 s48, s30, 7
s_and_b32 s49, s30, 31
s_lshl_b32 s49, s49, 12
s_add_u32 s43, s49, 119603200
v_mov_b64 v[12:13], -1
s_add_u32 s38, s48, 119554048
s_add_u32 s39, s48, 119619584
s_add_u32 s40, s48, 119685120
s_add_u32 s41, s48, 119750656
s_add_u32 s42, s48, 119816192
v_lshrrev_b32 v4, 16, v1
buffer_store_dwordx2 v[12:13], v4, s[4:7], s38 offen sc1
buffer_store_dwordx2 v[12:13], v4, s[4:7], s39 offen sc1
buffer_store_dwordx2 v[12:13], v4, s[4:7], s40 offen sc1
buffer_store_dwordx2 v[12:13], v4, s[4:7], s41 offen sc1
buffer_store_dwordx2 v[12:13], v4, s[4:7], s42 offen sc1
s_cmp_lg_u32 s3, 0
s_cbranch_scc1 k_wdd_161
v_mov_b32 v8, 192
k_wd_160:
global_load_dword v9, v8, s[28:29] sc1
s_waitcnt vmcnt(0)
v_readfirstlane_b32 s48, v9
s_cmp_ge_u32 s48, 32
s_cbranch_scc1 k_wdd_161
s_sleep 2
s_sub_u32 s32, s32, 1
s_cmp_gt_i32 s32, 0
s_cbranch_scc1 k_wd_160
k_wdd_161:
s_barrier
k_lay_162:
s_add_u32 s47, s31, 63
s_mov_b32 s33, 120324096
s_mov_b32 s34, 120327168
s_mov_b32 s35, 120331264
s_mul_i32 s48, s31, 655360
s_lshl_b32 s36, s30, 14
s_add_u32 s36, s36, s48
s_add_u32 s36, s36, 4096
v_mov_b32 v12, -1
s_and_b32 s48, s30, 31
s_add_u32 s48, s48, 16
s_lshr_b32 s49, s48, 1
s_and_b32 s48, s48, 1
s_lshl_b32 s44, s49, 8
s_lshl_b32 s50, s48, 6
s_add_u32 s44, s44, s50
s_add_u32 s44, s44, s33
s_mul_i32 s48, s48, 5120
s_lshl_b32 s49, s49, 5
s_add_u32 s48, s48, s49
v_lshrrev_b32 v8, 4, v0
v_and_b32 v9, 3, v8
v_mul_u32_u24 v9, 1280, v9
v_bfe_u32 v10, v8, 2, 1
v_lshl_add_u32 v9, v10, 1, v9
v_bfe_u32 v10, v8, 4, 1
v_lshl_add_u32 v9, v10, 4, v9
v_bfe_u32 v10, v8, 5, 1
v_lshl_add_u32 v9, v10, 2, v9
buffer_load_ushort v10, v9, s[24:27], s48 offen
buffer_load_ushort v11, v9, s[24:27], s48 offen offset:8
v_and_b32 v45, 0x30, v0
v_lshrrev_b32 v46, 8, v0
v_lshl_or_b32 v45, v46, 2, v45
v_bfe_u32 v46, v0, 6, 1
v_lshl_or_b32 v45, v46, 7, v45
v_cndmask_b32 v45, v45, 2.0, s[98:99]
s_waitcnt vmcnt(0)
v_lshl_or_b32 v10, v11, 16, v10
s_lshl_b32 s63, s30, 10
s_add_u32 s63, s63, 120356864
s_lshl_b32 s37, s31, 14
s_add_u32 s37, s37, 117441536
s_add_u32 s59, s37, 4096
s_waitcnt vmcnt(0)
s_barrier
s_barrier
buffer_store_dword v10, v45, s[4:7], s44 offen sc1
s_add_u32 s44, s44, 16384
buffer_store_dword v12, v45, s[4:7], s44 offen sc1
v_mov_b32 v8, 160
global_load_dword v9, v8, s[28:29] sc1
s_waitcnt vmcnt(0)
v_readfirstlane_b32 s64, v9
s_cmp_gt_u32 s64, 0xffff
s_cselect_b32 s64, 0x10000, 0
s_waitcnt vmcnt(0)
s_barrier
s_barrier
v_lshlrev_b32 v23, v0, s58
v_cndmask_b32 v20, 0, v23, s[90:91]
v_cndmask_b32 v21, 0, v23, s[92:93]
v_cndmask_b32 v22, 0, v23, s[94:95]
v_cndmask_b32 v23, 0, v23, s[96:97]
s_cmp_lg_u32 s64, 0
s_cbranch_scc1 k_far_163
s_branch k_cold2_167
k_T0_165:
s_waitcnt vmcnt(2)
v_smfmac_f32_16x16x64_bf16 v[40:43], v[4:7], v[48:55], v1
s_waitcnt vmcnt(1)
v_cmp_u_f32 vcc, v4, v8
v_smfmac_f32_16x16x64_bf16 v[24:27], v[8:11], a[24:31], v1
v_smfmac_f32_16x16x64_bf16 v[28:31], v[8:11], a[32:39], v1
s_cbranch_vccnz k_cold_166
k_okC_168:
s_waitcnt vmcnt(1)
v_smfmac_f32_16x16x64_bf16 v[36:39], v[8:11], a[40:47], v1
s_waitcnt lgkmcnt(0)
ds_read_b128 v[48:51], v0 offset:34816
v_smfmac_f32_16x16x64_bf16 v[32:35], v[4:7], v[64:71], v1
ds_read_b128 v[52:55], v0 offset:35840
ds_read_b128 v[64:67], v0 offset:22528
v_smfmac_f32_16x16x64_bf16 v[44:47], v[4:7], v[56:63], v1
ds_read_b128 v[68:71], v0 offset:23552
v_smfmac_f32_16x16x64_bf16 v[28:31], v[4:7], a[8:15], v1
v_smfmac_f32_16x16x64_bf16 v[24:27], v[4:7], a[0:7], v1
ds_read_b128 v[56:59], v2 offset:30720
v_smfmac_f32_16x16x64_bf16 v[36:39], v[4:7], a[16:23], v1
ds_read_b128 v[60:63], v2 offset:31744
s_waitcnt lgkmcnt(4)
v_smfmac_f32_16x16x64_bf16 v[40:43], v[8:11], v[48:55], v1
s_waitcnt vmcnt(0)
ds_write_b128 v0, v[12:15] offset:1024
s_waitcnt lgkmcnt(3)
v_smfmac_f32_16x16x64_bf16 v[32:35], v[8:11], v[64:71], v1
buffer_load_dwordx4 v[16:19], v0, s[4:7], s35 offen offset:0 sc1
v_cmp_u_f32 vcc, v12, v12
s_waitcnt lgkmcnt(1)
v_smfmac_f32_16x16x64_bf16 v[44:47], v[8:11], v[56:63], v1
ds_read_b128 v[56:59], v2 offset:53248
ds_read_b128 v[60:63], v2 offset:54272
ds_read_b128 v[64:67], v0 offset:28672
s_cbranch_vccnz k_coldA_169
k_okA_170:
v_smfmac_f32_16x16x64_bf16 v[36:39], v[12:15], a[64:71], v1
ds_read_b128 v[68:71], v0 offset:29696
s_waitcnt lgkmcnt(4)
v_smfmac_f32_16x16x64_bf16 v[40:43], v[12:15], a[72:79], v1
s_barrier
v_smfmac_f32_16x16x64_bf16 v[28:31], v[12:15], a[56:63], v1
ds_read_b128 v[8:11], v0 offset:2048
buffer_load_dwordx4 v[48:51], v0, s[4:7], s36 offen offset:0 sc1
s_waitcnt lgkmcnt(3)
v_smfmac_f32_16x16x64_bf16 v[44:47], v[12:15], v[56:63], v1
ds_read_b128 v[56:59], v2 offset:55296
v_smfmac_f32_16x16x64_bf16 v[24:27], v[12:15], a[48:55], v1
ds_read_b128 v[60:63], v2 offset:56320
s_waitcnt lgkmcnt(3)
v_smfmac_f32_16x16x64_bf16 v[32:35], v[12:15], v[64:71], v1
buffer_load_dwordx4 v[52:55], v0, s[4:7], s36 offen offset:1024 sc1
s_waitcnt lgkmcnt(2)
v_smfmac_f32_16x16x64_bf16 v[24:27], v[8:11], a[80:87], v1
ds_read_b128 v[64:67], v0 offset:30720
ds_read_b128 v[68:71], v0 offset:31744
v_smfmac_f32_16x16x64_bf16 v[36:39], v[8:11], a[96:103], v1
buffer_store_dwordx4 v[4:7], v0, s[8:11], s37 offen offset:0 sc1
s_waitcnt lgkmcnt(2)
s_nop 0
ds_read_b128 v[4:7], v0 offset:3072
v_smfmac_f32_16x16x64_bf16 v[44:47], v[8:11], v[56:63], v1
ds_read_b128 v[56:59], v2 offset:57344
ds_read_b128 v[60:63], v2 offset:58368
v_smfmac_f32_16x16x64_bf16 v[28:31], v[8:11], a[88:95], v1
buffer_store_dwordx4 v[12:15], v0, s[8:11], s37 offen offset:2048 sc1
v_smfmac_f32_16x16x64_bf16 v[40:43], v[8:11], a[104:111], v1
s_waitcnt lgkmcnt(3)
s_waitcnt lgkmcnt(2)
v_smfmac_f32_16x16x64_bf16 v[32:35], v[8:11], v[64:71], v1
ds_read_b128 v[64:67], v0 offset:32768
ds_read_b128 v[12:15], v0 offset:0
v_smfmac_f32_16x16x64_bf16 v[36:39], v[4:7], a[128:135], v1
s_waitcnt lgkmcnt(2)
v_smfmac_f32_16x16x64_bf16 v[44:47], v[4:7], v[56:63], v1
ds_read_b128 v[68:71], v0 offset:33792
buffer_load_dwordx4 v[56:59], v0, s[4:7], s36 offen offset:2048 sc1
v_smfmac_f32_16x16x64_bf16 v[28:31], v[4:7], a[120:127], v1
v_smfmac_f32_16x16x64_bf16 v[24:27], v[4:7], a[112:119], v1
s_waitcnt vmcnt(5)
ds_write_b128 v0, v[16:19] offset:5120
v_smfmac_f32_16x16x64_bf16 v[40:43], v[4:7], a[136:143], v1
s_waitcnt lgkmcnt(1)
buffer_load_dwordx4 v[60:63], v0, s[4:7], s36 offen offset:3072 sc1
v_cmp_u_f32 vcc, v16, v16
v_smfmac_f32_16x16x64_bf16 v[32:35], v[4:7], v[64:71], v1
ds_read_b128 v[64:67], v0 offset:26624
ds_read_b128 v[68:71], v0 offset:27648
v_smfmac_f32_16x16x64_bf16 v[28:31], v[12:15], a[152:159], v1
v_smfmac_f32_16x16x64_bf16 v[24:27], v[12:15], a[144:151], v1
s_cbranch_vccnz k_coldB_171
k_okB_172:
v_smfmac_f32_16x16x64_bf16 v[36:39], v[12:15], a[160:167], v1
s_waitcnt lgkmcnt(2)
buffer_store_dwordx4 v[16:19], v0, s[8:11], s59 offen offset:2048 sc1
s_barrier
ds_read_b128 v[4:7], v0 offset:7168
v_smfmac_f32_16x16x64_bf16 v[44:47], v[12:15], a[176:183], v1
ds_read_b128 v[8:11], v0 offset:6144
s_waitcnt lgkmcnt(2)
v_smfmac_f32_16x16x64_bf16 v[32:35], v[12:15], v[64:71], v1
ds_read_b128 v[64:67], v2 offset:36864
ds_read_b128 v[68:71], v2 offset:37888
v_smfmac_f32_16x16x64_bf16 v[24:27], v[16:19], a[184:191], v1
v_smfmac_f32_16x16x64_bf16 v[40:43], v[12:15], a[168:175], v1
s_waitcnt lgkmcnt(3)
ds_read_b128 v[12:15], v0 offset:4096
v_smfmac_f32_16x16x64_bf16 v[24:27], v[4:7], a[208:215], v1
s_waitcnt lgkmcnt(3)
v_smfmac_f32_16x16x64_bf16 v[28:31], v[4:7], a[216:223], v1
v_smfmac_f32_16x16x64_bf16 v[28:31], v[8:11], a[200:207], v1
s_waitcnt lgkmcnt(1)
v_smfmac_f32_16x16x64_bf16 v[24:27], v[8:11], v[64:71], v1
ds_read_b128 v[64:67], v2 offset:38912
s_waitcnt lgkmcnt(1)
v_smfmac_f32_16x16x64_bf16 v[24:27], v[12:15], a[224:231], v1
ds_read_b128 v[68:71], v2 offset:39936
v_smfmac_f32_16x16x64_bf16 v[28:31], v[12:15], a[232:239], v1
v_smfmac_f32_16x16x64_bf16 v[28:31], v[16:19], a[192:199], v1
v_cvt_pk_bf16_f32 v24, v24, v25
v_cvt_pk_bf16_f32 v25, v26, v27
v_smfmac_f32_16x16x64_bf16 v[32:35], v[4:7], v[80:87], v1
v_cvt_pk_bf16_f32 v26, v28, v29
v_cvt_pk_bf16_f32 v27, v30, v31
v_smfmac_f32_16x16x64_bf16 v[32:35], v[8:11], a[248:255], v1
s_waitcnt lgkmcnt(0)
v_mfma_f32_16x16x32_bf16 v[28:31], v[24:27], v[20:23], 0
v_and_b32 v26, 0xffffff7f, v0
v_smfmac_f32_16x16x64_bf16 v[32:35], v[16:19], v[64:71], v1
v_and_or_b32 v26, v1, 8, v26
v_mul_f32 v28, s51, v28
v_mul_f32 v29, s51, v29
v_mul_f32 v31, s51, v31
v_cvt_pk_bf16_f32 v24, v28, v29
v_mul_f32 v30, s51, v30
v_cvt_pk_bf16_f32 v25, v30, v31
v_smfmac_f32_16x16x64_bf16 v[32:35], v[12:15], v[96:103], v1
ds_write_b64 v26, v[24:25] offset:128
v_smfmac_f32_16x16x64_bf16 v[36:39], v[8:11], v[72:79], v1
v_cvt_pk_bf16_f32 v32, v32, v33
v_smfmac_f32_16x16x64_bf16 v[36:39], v[16:19], a[240:247], v1
buffer_load_dwordx4 v[64:67], v0, s[4:7], s61 offen offset:0
v_cvt_pk_bf16_f32 v33, v34, v35
v_smfmac_f32_16x16x64_bf16 v[36:39], v[12:15], v[104:111], v1
s_waitcnt lgkmcnt(0)
v_smfmac_f32_16x16x64_bf16 v[36:39], v[4:7], v[88:95], v1
s_barrier
ds_read_b128 v[24:27], v0 offset:0
v_smfmac_f32_16x16x64_bf16 v[40:43], v[4:7], v[144:151], v1
ds_read_b128 v[28:31], v0 offset:1024
s_nop 0
v_cvt_pk_bf16_f32 v34, v36, v37
v_cvt_pk_bf16_f32 v35, v38, v39
s_nop 1
v_mfma_f32_16x16x32_bf16 v[36:39], v[32:35], v[20:23], 0
s_waitcnt vmcnt(6)
buffer_load_dwordx4 v[68:71], v0, s[4:7], s61 offen offset:1024
v_and_b32 v34, 0xffffff7f, v0
v_and_or_b32 v34, v1, 8, v34
s_waitcnt lgkmcnt(1)
v_mfma_f32_16x16x32_bf16 v[48:51], v[48:51], v[24:27], 0
v_cvt_pk_bf16_f32 v32, v36, v37
s_waitcnt lgkmcnt(0)
v_mfma_f32_16x16x32_bf16 v[48:51], v[52:55], v[28:31], v[48:51]
v_mov_b64 v[52:53], s[56:57]
v_cvt_pk_bf16_f32 v33, v38, v39
v_smfmac_f32_16x16x64_bf16 v[44:47], v[4:7], v[152:159], v1
ds_write_b64 v34, v[32:33] offset:2176
v_permlane32_swap_b32 v48, v50
v_permlane32_swap_b32 v49, v51
v_add_f32_dpp v52, v50, v48 row_ror:8 row_mask:0xf bank_mask:0x3
v_exp_f32 v52, v52
v_add_f32_dpp v53, v51, v49 row_ror:8 row_mask:0xf bank_mask:0x3
v_exp_f32 v53, v53
s_nop 0
v_cvt_pk_bf16_f32 v48, v52, v53
v_smfmac_f32_16x16x64_bf16 v[44:47], v[16:19], v[120:127], v1
ds_write_b32 v0, v48 offset:4100
v_smfmac_f32_16x16x64_bf16 v[44:47], v[12:15], v[168:175], v1
buffer_load_dwordx4 v[48:51], v0, s[4:7], s61 offen offset:2048
v_smfmac_f32_16x16x64_bf16 v[40:43], v[12:15], v[160:167], v1
s_waitcnt lgkmcnt(1)
v_xor_b32 v12, 0x80, v0
v_smfmac_f32_16x16x64_bf16 v[40:43], v[8:11], v[128:135], v1
s_waitcnt lgkmcnt(0)
s_barrier
ds_read_b128 v[32:35], v0 offset:2048
v_mov_b64 v[22:23], s[52:53]
v_smfmac_f32_16x16x64_bf16 v[40:43], v[16:19], v[112:119], v1
ds_read_b128 v[36:39], v0 offset:3072
ds_read_b128 v[16:19], v0 offset:4096
buffer_load_dwordx4 v[52:55], v0, s[4:7], s61 offen offset:3072
v_smfmac_f32_16x16x64_bf16 v[44:47], v[8:11], v[136:143], v1
ds_read_b128 v[12:15], v12 offset:4096
v_cvt_pk_bf16_f32 v40, v40, v41
v_mov_b64 v[20:21], s[52:53]
s_waitcnt lgkmcnt(3)
v_mfma_f32_16x16x32_bf16 v[24:27], v[32:35], v[24:27], 0
v_cvt_pk_bf16_f32 v41, v42, v43
s_waitcnt lgkmcnt(2)
v_mfma_f32_16x16x32_bf16 v[24:27], v[36:39], v[28:31], v[24:27]
s_waitcnt vmcnt(5)
s_waitcnt lgkmcnt(1)
v_mfma_f32_16x16x32_bf16 v[8:11], v[56:59], v[16:19], 0
buffer_load_dwordx4 v[56:59], v0, s[4:7], s62 offen offset:0
v_mov_b64 v[28:29], s[56:57]
v_cvt_pk_bf16_f32 v43, v46, v47
v_cvt_pk_bf16_f32 v42, v44, v45
v_permlane32_swap_b32 v25, v27
v_permlane32_swap_b32 v24, v26
v_mfma_f32_16x16x32_bf16 v[4:7], v[20:23], v[16:19], 0
s_waitcnt lgkmcnt(0)
v_add_f32_dpp v28, v26, v24 row_ror:8 row_mask:0xf bank_mask:0x3
v_add_f32_dpp v29, v27, v25 row_ror:8 row_mask:0xf bank_mask:0x3
v_exp_f32 v28, v28
v_mfma_f32_16x16x32_bf16 v[8:11], v[60:63], v[12:15], v[8:11]
buffer_load_dwordx4 v[60:63], v0, s[4:7], s62 offen offset:1024
v_exp_f32 v29, v29
v_permlane32_swap_b32 v42, v43
v_cvt_pk_bf16_f32 v24, v28, v29
v_mov_b64 v[44:45], s[54:55]
v_cvt_pk_bf16_f32 v25, v28, v29
v_mov_b32_dpp v26, v24 row_ror:8 row_mask:0xf bank_mask:0xf
v_mov_b32_dpp v27, v24 row_ror:8 row_mask:0xf bank_mask:0xf
v_mfma_f32_16x16x16_bf16 v[4:7], v[44:45], v[24:25], v[4:7]
v_permlane32_swap_b32 v40, v41
v_mov_b64 v[36:37], 0
v_mov_b64 v[38:39], 0
v_mov_b64 v[30:31], 0
v_mfma_f32_16x16x32_bf16 v[8:11], v[40:43], v[24:27], v[8:11]
buffer_load_dwordx4 v[16:19], v0, s[4:7], s62 offen offset:2048
v_rcp_f32 v6, v4
v_and_b32 v12, 0xffffff7f, v0
v_and_or_b32 v13, v1, 8, v12
v_rcp_f32_dpp v6, v4 row_ror:8 row_mask:0xf bank_mask:0xc
v_mov_b64 v[26:27], 0
v_pk_mul_f32 v[8:9], v[8:9], v[6:7] op_sel_hi:[1,0]
v_cvt_pk_bf16_f32 v44, v8, v9
v_pk_mul_f32 v[10:11], v[10:11], v[6:7] op_sel_hi:[1,0]
v_cvt_pk_bf16_f32 v45, v10, v11
s_waitcnt vmcnt(5)
ds_write_b64 v13, v[44:45] offset:6272
buffer_load_dwordx4 v[20:23], v0, s[4:7], s62 offen offset:3072
v_add_u32 v6, 0xd4800000, v6
v_cmp_lt_u32 vcc, 0x28000000, v6
v_mov_b64 v[34:35], 0
v_mov_b32_dpp v46, v44 row_ror:8 row_mask:0xf bank_mask:0xf
v_mov_b32_dpp v47, v45 row_ror:8 row_mask:0xf bank_mask:0xf
v_mov_b64 v[28:29], 0
v_mov_b64 v[32:33], 0
s_cbranch_vccnz k_slow_173
k_okS_174:
v_smfmac_f32_16x16x64_bf16 v[36:39], v[44:47], v[224:231], v1
s_waitcnt lgkmcnt(0)
s_barrier
ds_read_b128 v[8:11], v12 offset:7296
v_smfmac_f32_16x16x64_bf16 v[32:35], v[44:47], v[200:207], v1
s_waitcnt vmcnt(4)
ds_read_b128 v[4:7], v12 offset:7168
v_mov_b64 v[24:25], 0
v_smfmac_f32_16x16x64_bf16 v[28:31], v[44:47], v[48:55], v1
ds_read_b128 v[12:15], v12 offset:6144
ds_read_b128 v[48:51], v2 offset:28672
v_smfmac_f32_16x16x64_bf16 v[24:27], v[44:47], v[64:71], v1
ds_read_b128 v[52:55], v2 offset:29696
v_mov_b64 v[42:43], 0
s_waitcnt lgkmcnt(4)
v_smfmac_f32_16x16x64_bf16 v[24:27], v[8:11], v[184:191], v1
s_waitcnt lgkmcnt(3)
v_mov_b64 v[40:41], 0
v_smfmac_f32_16x16x64_bf16 v[24:27], v[4:7], v[176:183], v1
s_waitcnt lgkmcnt(2)
ds_read_b128 v[64:67], v2 offset:63488
v_smfmac_f32_16x16x64_bf16 v[24:27], v[12:15], v[192:199], v1
ds_read_b128 v[68:71], v2 offset:64512
v_smfmac_f32_16x16x64_bf16 v[40:43], v[44:47], v[240:247], v1
s_waitcnt vmcnt(2)
s_waitcnt lgkmcnt(2)
v_lshrrev_b32 v44, 16, v1
v_cvt_pk_bf16_f32 v24, v24, v25
v_bfi_b32 v24, 1, s45, v24
v_cvt_pk_bf16_f32 v25, v26, v27
v_smfmac_f32_16x16x64_bf16 v[28:31], v[8:11], v[48:55], v1
buffer_store_dwordx2 v[24:25], v44, s[4:7], s38 offen
ds_read_b128 v[48:51], v2 offset:34816
ds_read_b128 v[52:55], v2 offset:35840
v_smfmac_f32_16x16x64_bf16 v[28:31], v[12:15], v[56:63], v1
s_waitcnt lgkmcnt(2)
ds_read_b128 v[56:59], v2 offset:59392
v_smfmac_f32_16x16x64_bf16 v[28:31], v[4:7], v[64:71], v1
ds_read_b128 v[60:63], v2 offset:60416
v_smfmac_f32_16x16x64_bf16 v[32:35], v[8:11], v[208:215], v1
ds_read_b128 v[64:67], v2 offset:32768
s_nop 0
v_cvt_pk_bf16_f32 v28, v28, v29
v_bfi_b32 v28, 1, s45, v28
v_cvt_pk_bf16_f32 v29, v30, v31
v_smfmac_f32_16x16x64_bf16 v[32:35], v[12:15], v[216:223], v1
buffer_store_dwordx2 v[28:29], v44, s[4:7], s39 offen
v_smfmac_f32_16x16x64_bf16 v[40:43], v[12:15], v[248:255], v1
ds_read_b128 v[68:71], v2 offset:33792
s_waitcnt vmcnt(2)
v_smfmac_f32_16x16x64_bf16 v[32:35], v[4:7], v[16:23], v1
s_waitcnt lgkmcnt(2)
v_smfmac_f32_16x16x64_bf16 v[36:39], v[12:15], v[232:239], v1
ds_read_b128 v[16:19], v2 offset:61440
ds_read_b128 v[20:23], v2 offset:62464
v_cvt_pk_bf16_f32 v32, v32, v33
v_bfi_b32 v32, 1, s45, v32
v_cvt_pk_bf16_f32 v33, v34, v35
v_smfmac_f32_16x16x64_bf16 v[36:39], v[8:11], v[48:55], v1
buffer_store_dwordx2 v[32:33], v44, s[4:7], s40 offen
s_waitcnt lgkmcnt(2)
v_smfmac_f32_16x16x64_bf16 v[36:39], v[4:7], v[64:71], v1
s_nop 6
v_cvt_pk_bf16_f32 v36, v36, v37
v_cvt_pk_bf16_f32 v37, v38, v39
s_waitcnt lgkmcnt(0)
v_bfi_b32 v36, 1, s45, v36
v_smfmac_f32_16x16x64_bf16 v[40:43], v[8:11], v[16:23], v1
buffer_store_dwordx2 v[36:37], v44, s[4:7], s41 offen
v_smfmac_f32_16x16x64_bf16 v[40:43], v[4:7], v[56:63], v1
s_nop 6
v_cvt_pk_bf16_f32 v40, v40, v41
v_bfi_b32 v40, 1, s45, v40
v_cvt_pk_bf16_f32 v41, v42, v43
buffer_store_dwordx2 v[40:41], v44, s[4:7], s42 offen
s_barrier
buffer_load_dwordx4 v[24:27], v0, s[4:7], s43 offen offset:0 sc1
buffer_load_dwordx4 v[28:31], v0, s[4:7], s43 offen offset:1024 sc1
buffer_load_dwordx4 v[32:35], v0, s[4:7], s43 offen offset:2048 sc1
buffer_load_dwordx4 v[36:39], v0, s[4:7], s43 offen offset:3072 sc1
buffer_load_dwordx4 v[48:51], v0, s[4:7], s60 offen offset:0
buffer_load_dwordx4 v[52:55], v0, s[4:7], s60 offen offset:1024
buffer_load_dwordx4 v[56:59], v0, s[4:7], s60 offen offset:2048
buffer_load_dwordx4 v[60:63], v0, s[4:7], s60 offen offset:3072
v_lshlrev_b32 v23, v0, s58
v_cndmask_b32 v16, 0, v23, s[12:13]
v_cndmask_b32 v17, 0, v23, s[14:15]
v_cndmask_b32 v18, 0, v23, s[16:17]
v_cndmask_b32 v19, 0, v23, s[18:19]
v_and_b32 v45, 0x30, v0
v_lshrrev_b32 v46, 8, v0
v_lshl_or_b32 v45, v46, 2, v45
v_bfe_u32 v46, v0, 6, 1
v_lshl_or_b32 v45, v46, 7, v45
v_cndmask_b32 v45, v45, 2.0, s[98:99]
v_cndmask_b32 v20, 0, v23, s[90:91]
v_cndmask_b32 v21, 0, v23, s[92:93]
v_cndmask_b32 v22, 0, v23, s[94:95]
v_cndmask_b32 v23, 0, v23, s[96:97]
s_add_u32 s33, s33, 16384
s_bitset0_b32 s33, 16
s_waitcnt vmcnt(7)
v_mfma_f32_16x16x32_bf16 v[40:43], v[24:27], v[16:19], 0
s_waitcnt vmcnt(6)
v_mfma_f32_16x16x32_bf16 v[40:43], v[28:31], v[16:19], v[40:43]
v_bitop3_b32 v46, v24, v28, s45 bitop3:0x7e
s_waitcnt vmcnt(5)
v_mfma_f32_16x16x32_bf16 v[40:43], v[32:35], v[16:19], v[40:43]
s_waitcnt vmcnt(4)
v_mfma_f32_16x16x32_bf16 v[40:43], v[36:39], v[16:19], v[40:43]
v_bitop3_b32 v47, v32, v36, s45 bitop3:0x7e
v_bitop3_b32 v46, v46, v47, 1 bitop3:0xa8
v_cmp_ne_u32 vcc, 0, v46
v_mov_b64 v[24:25], 0
v_mov_b64 v[26:27], 0
v_mov_b64 v[28:29], 0
v_mov_b64 v[30:31], 0
v_permlane32_swap_b32 v40, v41
v_permlane32_swap_b32 v42, v43
v_add_f32 v40, v40, v41
v_add_f32 v41, v42, v43
v_cvt_pk_bf16_f32 v42, v40, v41
s_cbranch_vccnz k_r1_176
k_ok1_177:
buffer_store_dword v42, v45, s[4:7], s44 offen
s_barrier
buffer_load_dwordx4 v[4:7], v0, s[4:7], s33 offen offset:1024 sc1
buffer_load_dwordx4 v[8:11], v0, s[4:7], s33 offen offset:0 sc1
s_add_u32 s34, s33, 3072
s_add_u32 s35, s33, 7168
s_add_u32 s36, s36, 524288
s_add_u32 s37, s37, 10240
s_add_u32 s59, s59, 10240
v_mov_b64 v[32:33], 0
v_mov_b64 v[34:35], 0
v_mov_b64 v[36:37], 0
v_mov_b64 v[38:39], 0
v_mov_b64 v[40:41], 0
v_mov_b64 v[42:43], 0
v_mov_b64 v[44:45], 0
v_mov_b64 v[46:47], 0
s_add_u32 s44, s44, 16384
s_bitset0_b32 s44, 16
s_sub_u32 s45, s45, 1
s_add_u32 s31, s31, 1
ds_read_b128 v[64:67], v0 offset:24576
ds_read_b128 v[68:71], v0 offset:25600
buffer_load_dwordx4 v[12:15], v0, s[4:7], s34 offen offset:0 sc1
s_cmp_lg_u32 s31, s47
s_cbranch_scc1 k_T0_165
s_branch k_done_175
k_cold2_167:
s_barrier
buffer_load_dwordx4 v[48:51], v0, s[4:7], s60 offen offset:0
buffer_load_dwordx4 v[52:55], v0, s[4:7], s60 offen offset:1024
buffer_load_dwordx4 v[56:59], v0, s[4:7], s60 offen offset:2048
buffer_load_dwordx4 v[60:63], v0, s[4:7], s60 offen offset:3072
ds_read_b128 v[64:67], v0 offset:24576
ds_read_b128 v[68:71], v0 offset:25600
k_cold_166:
buffer_load_dwordx4 v[4:7], v0, s[4:7], s33 offen offset:1024 sc1
buffer_load_dwordx4 v[8:11], v0, s[4:7], s33 offen offset:0 sc1
buffer_load_dwordx4 v[12:15], v0, s[4:7], s34 offen offset:0 sc1
s_sub_u32 s32, s32, 1
s_cmp_gt_i32 s32, 0
s_cbranch_scc0 k_okC_168
v_mov_b64 v[24:25], 0
v_mov_b64 v[26:27], 0
v_mov_b64 v[28:29], 0
v_mov_b64 v[30:31], 0
v_mov_b64 v[32:33], 0
v_mov_b64 v[34:35], 0
v_mov_b64 v[36:37], 0
v_mov_b64 v[38:39], 0
v_mov_b64 v[40:41], 0
v_mov_b64 v[42:43], 0
v_mov_b64 v[44:45], 0
v_mov_b64 v[46:47], 0
s_branch k_T0_165
k_coldA_169:
buffer_load_dwordx4 v[12:15], v0, s[4:7], s34 offen offset:0 sc1
s_sub_u32 s32, s32, 1
s_cmp_gt_i32 s32, 0
s_waitcnt vmcnt(0)
v_cmp_u_f32 vcc, v12, v12
ds_write_b128 v0, v[12:15] offset:1024
s_waitcnt lgkmcnt(0)
s_cbranch_vccz k_okA_170
s_cbranch_scc1 k_coldA_169
s_branch k_okA_170
k_coldB_171:
buffer_load_dwordx4 v[16:19], v0, s[4:7], s35 offen offset:0 sc1
s_sub_u32 s32, s32, 1
s_cmp_gt_i32 s32, 0
s_waitcnt vmcnt(0)
v_cmp_u_f32 vcc, v16, v16
ds_write_b128 v0, v[16:19] offset:5120
s_waitcnt lgkmcnt(0)
s_cbranch_vccz k_okB_172
s_cbranch_scc1 k_coldB_171
s_branch k_okB_172
k_r1_176:
buffer_load_dwordx4 v[24:27], v0, s[4:7], s43 offen offset:0 sc1
buffer_load_dwordx4 v[28:31], v0, s[4:7], s43 offen offset:1024 sc1
buffer_load_dwordx4 v[32:35], v0, s[4:7], s43 offen offset:2048 sc1
buffer_load_dwordx4 v[36:39], v0, s[4:7], s43 offen offset:3072 sc1
s_sub_u32 s32, s32, 1
s_cmp_gt_i32 s32, 0
s_waitcnt vmcnt(3)
v_mfma_f32_16x16x32_bf16 v[40:43], v[24:27], v[16:19], 0
s_waitcnt vmcnt(2)
v_mfma_f32_16x16x32_bf16 v[40:43], v[28:31], v[16:19], v[40:43]
v_bitop3_b32 v46, v24, v28, s45 bitop3:0x7e
s_waitcnt vmcnt(1)
v_mfma_f32_16x16x32_bf16 v[40:43], v[32:35], v[16:19], v[40:43]
s_waitcnt vmcnt(0)
v_mfma_f32_16x16x32_bf16 v[40:43], v[36:39], v[16:19], v[40:43]
v_bitop3_b32 v47, v32, v36, s45 bitop3:0x7e
v_bitop3_b32 v46, v46, v47, 1 bitop3:0xa8
v_cmp_ne_u32 vcc, 0, v46
v_mov_b64 v[24:25], 0
v_mov_b64 v[26:27], 0
v_mov_b64 v[28:29], 0
v_mov_b64 v[30:31], 0
v_permlane32_swap_b32 v40, v41
v_permlane32_swap_b32 v42, v43
v_add_f32 v40, v40, v41
v_add_f32 v41, v42, v43
v_cvt_pk_bf16_f32 v42, v40, v41
s_cbranch_vccz k_ok1_177
s_cbranch_scc1 k_r1_176
s_branch k_ok1_177
k_slow_173:
ds_read_b128 v[24:27], v0 offset:0
ds_read_b128 v[28:31], v0 offset:1024
v_mov_b32 v46, 0xff7fffff
s_add_u32 s48, s36, 0xfffff000
buffer_load_dwordx4 v[32:35], v0, s[4:7], s48 offen offset:0 sc1
buffer_load_dwordx4 v[36:39], v0, s[4:7], s48 offen offset:1024 sc1
s_waitcnt vmcnt(1) lgkmcnt(1)
v_mfma_f32_16x16x32_bf16 v[4:7], v[32:35], v[24:27], 0
s_waitcnt vmcnt(0) lgkmcnt(0)
v_mfma_f32_16x16x32_bf16 v[4:7], v[36:39], v[28:31], v[4:7]
v_mov_b64 v[8:9], s[56:57]
s_nop 5
v_permlane32_swap_b32 v4, v6
v_permlane32_swap_b32 v5, v7
v_add_f32_dpp v8, v6, v4 row_ror:8 row_mask:0xf bank_mask:0x3
s_nop 0
v_add_f32_dpp v9, v7, v5 row_ror:8 row_mask:0xf bank_mask:0x3
v_max3_f32 v46, v46, v8, v9
s_add_u32 s48, s36, 0x0
buffer_load_dwordx4 v[32:35], v0, s[4:7], s48 offen offset:0 sc1
buffer_load_dwordx4 v[36:39], v0, s[4:7], s48 offen offset:1024 sc1
s_waitcnt vmcnt(1)
v_mfma_f32_16x16x32_bf16 v[4:7], v[32:35], v[24:27], 0
s_waitcnt vmcnt(0)
v_mfma_f32_16x16x32_bf16 v[4:7], v[36:39], v[28:31], v[4:7]
v_mov_b64 v[10:11], s[56:57]
s_nop 5
v_permlane32_swap_b32 v4, v6
v_permlane32_swap_b32 v5, v7
v_add_f32_dpp v10, v6, v4 row_ror:8 row_mask:0xf bank_mask:0x3
s_nop 0
v_add_f32_dpp v11, v7, v5 row_ror:8 row_mask:0xf bank_mask:0x3
v_max3_f32 v46, v46, v10, v11
s_add_u32 s48, s36, 0x1000
buffer_load_dwordx4 v[32:35], v0, s[4:7], s48 offen offset:0 sc1
buffer_load_dwordx4 v[36:39], v0, s[4:7], s48 offen offset:1024 sc1
s_waitcnt vmcnt(1)
v_mfma_f32_16x16x32_bf16 v[4:7], v[32:35], v[24:27], 0
s_waitcnt vmcnt(0)
v_mfma_f32_16x16x32_bf16 v[4:7], v[36:39], v[28:31], v[4:7]
v_mov_b64 v[12:13], s[56:57]
s_nop 5
v_permlane32_swap_b32 v4, v6
v_permlane32_swap_b32 v5, v7
v_add_f32_dpp v12, v6, v4 row_ror:8 row_mask:0xf bank_mask:0x3
s_nop 0
v_add_f32_dpp v13, v7, v5 row_ror:8 row_mask:0xf bank_mask:0x3
v_max3_f32 v46, v46, v12, v13
s_add_u32 s48, s36, 0x2000
buffer_load_dwordx4 v[32:35], v0, s[4:7], s48 offen offset:0 sc1
buffer_load_dwordx4 v[36:39], v0, s[4:7], s48 offen offset:1024 sc1
s_waitcnt vmcnt(1)
v_mfma_f32_16x16x32_bf16 v[4:7], v[32:35], v[24:27], 0
s_waitcnt vmcnt(0)
v_mfma_f32_16x16x32_bf16 v[4:7], v[36:39], v[28:31], v[4:7]
v_mov_b64 v[14:15], s[56:57]
s_nop 5
v_permlane32_swap_b32 v4, v6
v_permlane32_swap_b32 v5, v7
v_add_f32_dpp v14, v6, v4 row_ror:8 row_mask:0xf bank_mask:0x3
s_nop 0
v_add_f32_dpp v15, v7, v5 row_ror:8 row_mask:0xf bank_mask:0x3
v_max3_f32 v46, v46, v14, v15
ds_read_b128 v[32:35], v0 offset:2048
ds_read_b128 v[36:39], v0 offset:3072
s_waitcnt lgkmcnt(1)
v_mfma_f32_16x16x32_bf16 v[4:7], v[32:35], v[24:27], 0
s_waitcnt lgkmcnt(0)
v_mfma_f32_16x16x32_bf16 v[4:7], v[36:39], v[28:31], v[4:7]
v_mov_b64 v[44:45], s[56:57]
s_nop 5
v_permlane32_swap_b32 v4, v6
v_permlane32_swap_b32 v5, v7
v_add_f32_dpp v44, v6, v4 row_ror:8 row_mask:0xf bank_mask:0x3
s_nop 0
v_add_f32_dpp v45, v7, v5 row_ror:8 row_mask:0xf bank_mask:0x3
v_max3_f32 v46, v46, v44, v45
buffer_load_dwordx4 v[32:35], v0, s[4:7], s36 offen offset:2048 sc1
buffer_load_dwordx4 v[36:39], v0, s[4:7], s36 offen offset:3072 sc1
v_mov_b32 v47, v46
s_nop 1
v_permlane32_swap_b32 v46, v47
v_max_f32 v46, v46, v47
v_mov_b32 v47, v46
s_nop 1
v_permlane16_swap_b32 v46, v47
v_max_f32 v46, v46, v47
v_sub_f32 v8, v8, v46
v_exp_f32 v8, v8
v_sub_f32 v9, v9, v46
v_exp_f32 v9, v9
v_sub_f32 v10, v10, v46
v_exp_f32 v10, v10
v_sub_f32 v11, v11, v46
v_exp_f32 v11, v11
v_sub_f32 v12, v12, v46
v_exp_f32 v12, v12
v_sub_f32 v13, v13, v46
v_exp_f32 v13, v13
v_sub_f32 v14, v14, v46
v_exp_f32 v14, v14
v_sub_f32 v15, v15, v46
v_exp_f32 v15, v15
v_sub_f32 v44, v44, v46
v_exp_f32 v44, v44
v_sub_f32 v45, v45, v46
v_exp_f32 v45, v45
v_cvt_pk_bf16_f32 v4, v8, v9
v_cvt_pk_bf16_f32 v5, v10, v11
v_cvt_pk_bf16_f32 v6, v12, v13
v_cvt_pk_bf16_f32 v7, v14, v15
v_mov_b32_dpp v8, v4 row_ror:8 row_mask:0xf bank_mask:0xf
v_mov_b32_dpp v9, v5 row_ror:8 row_mask:0xf bank_mask:0xf
v_mov_b32_dpp v10, v6 row_ror:8 row_mask:0xf bank_mask:0xf
v_mov_b32_dpp v11, v7 row_ror:8 row_mask:0xf bank_mask:0xf
v_cvt_pk_bf16_f32 v24, v44, v45
v_cvt_pk_bf16_f32 v25, v44, v45
s_nop 0
v_mov_b32_dpp v26, v24 row_ror:8 row_mask:0xf bank_mask:0xf
v_mov_b32_dpp v27, v24 row_ror:8 row_mask:0xf bank_mask:0xf
v_mov_b64 v[28:29], s[52:53]
v_mov_b64 v[30:31], s[52:53]
s_nop 1
v_mfma_f32_16x16x32_bf16 v[44:47], v[28:31], v[4:7], 0
s_waitcnt vmcnt(1)
v_mfma_f32_16x16x32_bf16 v[12:15], v[32:35], v[4:7], 0
s_waitcnt vmcnt(0)
v_mfma_f32_16x16x32_bf16 v[12:15], v[36:39], v[8:11], v[12:15]
v_mfma_f32_16x16x32_bf16 v[12:15], v[40:43], v[24:27], v[12:15]
v_mov_b64 v[28:29], s[54:55]
s_nop 1
v_mfma_f32_16x16x16_bf16 v[44:47], v[28:29], v[24:25], v[44:47]
s_nop 6
v_rcp_f32 v4, v44
s_nop 1
v_rcp_f32_dpp v4, v44 row_ror:8 row_mask:0xf bank_mask:0xc
s_nop 0
v_mul_f32 v12, v4, v12
v_mul_f32 v13, v4, v13
v_mul_f32 v14, v4, v14
v_mul_f32 v15, v4, v15
v_cvt_pk_bf16_f32 v44, v12, v13
v_cvt_pk_bf16_f32 v45, v14, v15
v_and_b32 v12, 0xffffff7f, v0
v_and_or_b32 v8, v1, 8, v12
ds_write_b64 v8, v[44:45] offset:6272
v_mov_b32_dpp v46, v44 row_ror:8 row_mask:0xf bank_mask:0xf
v_mov_b32_dpp v47, v45 row_ror:8 row_mask:0xf bank_mask:0xf
v_mov_b64 v[24:25], 0
v_mov_b64 v[26:27], 0
v_mov_b64 v[28:29], 0
v_mov_b64 v[30:31], 0
v_mov_b64 v[32:33], 0
v_mov_b64 v[34:35], 0
v_mov_b64 v[36:37], 0
v_mov_b64 v[38:39], 0
s_waitcnt lgkmcnt(0)
s_branch k_okS_174
k_done_175:
buffer_load_dwordx4 v[16:19], v0, s[4:7], s35 offen offset:0 sc1
k_xs_181:
s_waitcnt vmcnt(1)
v_cmp_u_f32 vcc, v4, v12
s_waitcnt vmcnt(0)
v_cmp_u_f32 s[66:67], v16, v16
s_or_b64 vcc, vcc, s[66:67]
s_cbranch_vccz k_xd_182
buffer_load_dwordx4 v[4:7], v0, s[4:7], s33 offen offset:1024 sc1
buffer_load_dwordx4 v[8:11], v0, s[4:7], s33 offen offset:0 sc1
buffer_load_dwordx4 v[12:15], v0, s[4:7], s34 offen offset:0 sc1
buffer_load_dwordx4 v[16:19], v0, s[4:7], s35 offen offset:0 sc1
s_sub_u32 s32, s32, 1
s_cmp_gt_i32 s32, 0
s_cbranch_scc1 k_xs_181
k_xd_182:
s_waitcnt vmcnt(3)
buffer_store_dwordx4 v[4:7], v0, s[8:11], s37 offen offset:0 sc1
s_waitcnt vmcnt(2)
buffer_store_dwordx4 v[12:15], v0, s[8:11], s37 offen offset:2048 sc1
s_waitcnt vmcnt(2)
buffer_store_dwordx4 v[16:19], v0, s[8:11], s59 offen offset:2048 sc1
s_add_u32 s31, s31, 1
s_branch k_jn_164
k_far_163:
s_branch k_cold2_185
k_T0_183:
s_waitcnt vmcnt(2)
v_smfmac_f32_16x16x64_bf16 v[40:43], v[4:7], v[48:55], v1
s_waitcnt vmcnt(1)
v_cmp_u_f32 vcc, v4, v8
v_smfmac_f32_16x16x64_bf16 v[24:27], v[8:11], a[24:31], v1
v_smfmac_f32_16x16x64_bf16 v[28:31], v[8:11], a[32:39], v1
s_cbranch_vccnz k_cold_184
k_okC_186:
s_waitcnt vmcnt(1)
v_smfmac_f32_16x16x64_bf16 v[36:39], v[8:11], a[40:47], v1
s_waitcnt lgkmcnt(0)
ds_read_b128 v[48:51], v0 offset:34816
v_smfmac_f32_16x16x64_bf16 v[32:35], v[4:7], v[64:71], v1
ds_read_b128 v[52:55], v0 offset:35840
ds_read_b128 v[64:67], v0 offset:22528
v_smfmac_f32_16x16x64_bf16 v[44:47], v[4:7], v[56:63], v1
ds_read_b128 v[68:71], v0 offset:23552
v_smfmac_f32_16x16x64_bf16 v[28:31], v[4:7], a[8:15], v1
v_smfmac_f32_16x16x64_bf16 v[24:27], v[4:7], a[0:7], v1
ds_read_b128 v[56:59], v2 offset:30720
v_smfmac_f32_16x16x64_bf16 v[36:39], v[4:7], a[16:23], v1
ds_read_b128 v[60:63], v2 offset:31744
s_waitcnt lgkmcnt(4)
v_smfmac_f32_16x16x64_bf16 v[40:43], v[8:11], v[48:55], v1
s_waitcnt vmcnt(0)
ds_write_b128 v0, v[12:15] offset:1024
s_waitcnt lgkmcnt(3)
v_smfmac_f32_16x16x64_bf16 v[32:35], v[8:11], v[64:71], v1
buffer_load_dwordx4 v[16:19], v0, s[4:7], s35 offen offset:0 sc1
v_cmp_u_f32 vcc, v12, v12
s_waitcnt lgkmcnt(1)
v_smfmac_f32_16x16x64_bf16 v[44:47], v[8:11], v[56:63], v1
ds_read_b128 v[56:59], v2 offset:53248
ds_read_b128 v[60:63], v2 offset:54272
ds_read_b128 v[64:67], v0 offset:28672
s_cbranch_vccnz k_coldA_187
k_okA_188:
v_smfmac_f32_16x16x64_bf16 v[36:39], v[12:15], a[64:71], v1
ds_read_b128 v[68:71], v0 offset:29696
s_waitcnt lgkmcnt(4)
v_smfmac_f32_16x16x64_bf16 v[40:43], v[12:15], a[72:79], v1
s_barrier
v_smfmac_f32_16x16x64_bf16 v[28:31], v[12:15], a[56:63], v1
ds_read_b128 v[8:11], v0 offset:2048
buffer_load_dwordx4 v[48:51], v0, s[4:7], s36 offen offset:0 sc1
s_waitcnt lgkmcnt(3)
v_smfmac_f32_16x16x64_bf16 v[44:47], v[12:15], v[56:63], v1
ds_read_b128 v[56:59], v2 offset:55296
v_smfmac_f32_16x16x64_bf16 v[24:27], v[12:15], a[48:55], v1
ds_read_b128 v[60:63], v2 offset:56320
s_waitcnt lgkmcnt(3)
v_smfmac_f32_16x16x64_bf16 v[32:35], v[12:15], v[64:71], v1
buffer_load_dwordx4 v[52:55], v0, s[4:7], s36 offen offset:1024 sc1
s_waitcnt lgkmcnt(2)
v_smfmac_f32_16x16x64_bf16 v[24:27], v[8:11], a[80:87], v1
ds_read_b128 v[64:67], v0 offset:30720
ds_read_b128 v[68:71], v0 offset:31744
v_smfmac_f32_16x16x64_bf16 v[36:39], v[8:11], a[96:103], v1
buffer_store_dwordx4 v[4:7], v0, s[8:11], s37 offen offset:0 sc1
s_waitcnt lgkmcnt(2)
s_nop 0
ds_read_b128 v[4:7], v0 offset:3072
v_smfmac_f32_16x16x64_bf16 v[44:47], v[8:11], v[56:63], v1
ds_read_b128 v[56:59], v2 offset:57344
ds_read_b128 v[60:63], v2 offset:58368
v_smfmac_f32_16x16x64_bf16 v[28:31], v[8:11], a[88:95], v1
buffer_store_dwordx4 v[12:15], v0, s[8:11], s37 offen offset:2048 sc1
v_smfmac_f32_16x16x64_bf16 v[40:43], v[8:11], a[104:111], v1
s_waitcnt lgkmcnt(3)
s_waitcnt lgkmcnt(2)
v_smfmac_f32_16x16x64_bf16 v[32:35], v[8:11], v[64:71], v1
ds_read_b128 v[64:67], v0 offset:32768
ds_read_b128 v[12:15], v0 offset:0
v_smfmac_f32_16x16x64_bf16 v[36:39], v[4:7], a[128:135], v1
s_waitcnt lgkmcnt(2)
v_smfmac_f32_16x16x64_bf16 v[44:47], v[4:7], v[56:63], v1
ds_read_b128 v[68:71], v0 offset:33792
buffer_load_dwordx4 v[56:59], v0, s[4:7], s36 offen offset:2048 sc1
v_smfmac_f32_16x16x64_bf16 v[28:31], v[4:7], a[120:127], v1
v_smfmac_f32_16x16x64_bf16 v[24:27], v[4:7], a[112:119], v1
s_waitcnt vmcnt(5)
ds_write_b128 v0, v[16:19] offset:5120
v_smfmac_f32_16x16x64_bf16 v[40:43], v[4:7], a[136:143], v1
s_waitcnt lgkmcnt(1)
buffer_load_dwordx4 v[60:63], v0, s[4:7], s36 offen offset:3072 sc1
v_cmp_u_f32 vcc, v16, v16
v_smfmac_f32_16x16x64_bf16 v[32:35], v[4:7], v[64:71], v1
ds_read_b128 v[64:67], v0 offset:26624
ds_read_b128 v[68:71], v0 offset:27648
v_smfmac_f32_16x16x64_bf16 v[28:31], v[12:15], a[152:159], v1
v_smfmac_f32_16x16x64_bf16 v[24:27], v[12:15], a[144:151], v1
s_cbranch_vccnz k_coldB_189
k_okB_190:
v_smfmac_f32_16x16x64_bf16 v[36:39], v[12:15], a[160:167], v1
s_waitcnt lgkmcnt(2)
buffer_store_dwordx4 v[16:19], v0, s[8:11], s59 offen offset:2048 sc1
s_barrier
ds_read_b128 v[4:7], v0 offset:7168
v_smfmac_f32_16x16x64_bf16 v[44:47], v[12:15], a[176:183], v1
ds_read_b128 v[8:11], v0 offset:6144
s_waitcnt lgkmcnt(2)
v_smfmac_f32_16x16x64_bf16 v[32:35], v[12:15], v[64:71], v1
ds_read_b128 v[64:67], v2 offset:36864
ds_read_b128 v[68:71], v2 offset:37888
v_smfmac_f32_16x16x64_bf16 v[24:27], v[16:19], a[184:191], v1
v_smfmac_f32_16x16x64_bf16 v[40:43], v[12:15], a[168:175], v1
s_waitcnt lgkmcnt(3)
ds_read_b128 v[12:15], v0 offset:4096
v_smfmac_f32_16x16x64_bf16 v[24:27], v[4:7], a[208:215], v1
s_waitcnt lgkmcnt(3)
v_smfmac_f32_16x16x64_bf16 v[28:31], v[4:7], a[216:223], v1
v_smfmac_f32_16x16x64_bf16 v[28:31], v[8:11], a[200:207], v1
s_waitcnt lgkmcnt(1)
v_smfmac_f32_16x16x64_bf16 v[24:27], v[8:11], v[64:71], v1
ds_read_b128 v[64:67], v2 offset:38912
s_waitcnt lgkmcnt(1)
v_smfmac_f32_16x16x64_bf16 v[24:27], v[12:15], a[224:231], v1
ds_read_b128 v[68:71], v2 offset:39936
v_smfmac_f32_16x16x64_bf16 v[28:31], v[12:15], a[232:239], v1
v_smfmac_f32_16x16x64_bf16 v[28:31], v[16:19], a[192:199], v1
v_cvt_pk_bf16_f32 v24, v24, v25
v_cvt_pk_bf16_f32 v25, v26, v27
v_smfmac_f32_16x16x64_bf16 v[32:35], v[4:7], v[80:87], v1
v_cvt_pk_bf16_f32 v26, v28, v29
v_cvt_pk_bf16_f32 v27, v30, v31
v_smfmac_f32_16x16x64_bf16 v[32:35], v[8:11], a[248:255], v1
s_waitcnt lgkmcnt(0)
v_mfma_f32_16x16x32_bf16 v[28:31], v[24:27], v[20:23], 0
v_and_b32 v26, 0xffffff7f, v0
v_smfmac_f32_16x16x64_bf16 v[32:35], v[16:19], v[64:71], v1
v_and_or_b32 v26, v1, 8, v26
v_mul_f32 v28, s51, v28
v_mul_f32 v29, s51, v29
v_mul_f32 v31, s51, v31
v_cvt_pk_bf16_f32 v24, v28, v29
v_mul_f32 v30, s51, v30
v_cvt_pk_bf16_f32 v25, v30, v31
v_smfmac_f32_16x16x64_bf16 v[32:35], v[12:15], v[96:103], v1
ds_write_b64 v26, v[24:25] offset:128
v_smfmac_f32_16x16x64_bf16 v[36:39], v[8:11], v[72:79], v1
v_cvt_pk_bf16_f32 v32, v32, v33
v_smfmac_f32_16x16x64_bf16 v[36:39], v[16:19], a[240:247], v1
buffer_load_dwordx4 v[64:67], v0, s[4:7], s61 offen offset:0
v_cvt_pk_bf16_f32 v33, v34, v35
v_smfmac_f32_16x16x64_bf16 v[36:39], v[12:15], v[104:111], v1
s_waitcnt lgkmcnt(0)
v_smfmac_f32_16x16x64_bf16 v[36:39], v[4:7], v[88:95], v1
s_barrier
ds_read_b128 v[24:27], v0 offset:0
v_smfmac_f32_16x16x64_bf16 v[40:43], v[4:7], v[144:151], v1
ds_read_b128 v[28:31], v0 offset:1024
s_nop 0
v_cvt_pk_bf16_f32 v34, v36, v37
v_cvt_pk_bf16_f32 v35, v38, v39
s_nop 1
v_mfma_f32_16x16x32_bf16 v[36:39], v[32:35], v[20:23], 0
s_waitcnt vmcnt(6)
buffer_load_dwordx4 v[68:71], v0, s[4:7], s61 offen offset:1024
v_and_b32 v34, 0xffffff7f, v0
v_and_or_b32 v34, v1, 8, v34
s_waitcnt lgkmcnt(1)
v_mfma_f32_16x16x32_bf16 v[48:51], v[48:51], v[24:27], 0
v_cvt_pk_bf16_f32 v32, v36, v37
s_waitcnt lgkmcnt(0)
v_mfma_f32_16x16x32_bf16 v[48:51], v[52:55], v[28:31], v[48:51]
v_mov_b64 v[52:53], s[56:57]
v_cvt_pk_bf16_f32 v33, v38, v39
v_smfmac_f32_16x16x64_bf16 v[44:47], v[4:7], v[152:159], v1
ds_write_b64 v34, v[32:33] offset:2176
v_permlane32_swap_b32 v48, v50
v_permlane32_swap_b32 v49, v51
v_add_f32_dpp v52, v50, v48 row_ror:8 row_mask:0xf bank_mask:0x3
v_exp_f32 v52, v52
v_add_f32_dpp v53, v51, v49 row_ror:8 row_mask:0xf bank_mask:0x3
v_exp_f32 v53, v53
s_nop 0
v_cvt_pk_bf16_f32 v48, v52, v53
v_smfmac_f32_16x16x64_bf16 v[44:47], v[16:19], v[120:127], v1
ds_write_b32 v0, v48 offset:4100
v_smfmac_f32_16x16x64_bf16 v[44:47], v[12:15], v[168:175], v1
buffer_load_dwordx4 v[48:51], v0, s[4:7], s61 offen offset:2048
v_smfmac_f32_16x16x64_bf16 v[40:43], v[12:15], v[160:167], v1
s_waitcnt lgkmcnt(1)
v_xor_b32 v12, 0x80, v0
v_smfmac_f32_16x16x64_bf16 v[40:43], v[8:11], v[128:135], v1
s_waitcnt lgkmcnt(0)
s_barrier
ds_read_b128 v[32:35], v0 offset:2048
v_mov_b64 v[22:23], s[52:53]
v_smfmac_f32_16x16x64_bf16 v[40:43], v[16:19], v[112:119], v1
ds_read_b128 v[36:39], v0 offset:3072
ds_read_b128 v[16:19], v0 offset:4096
buffer_load_dwordx4 v[52:55], v0, s[4:7], s61 offen offset:3072
v_smfmac_f32_16x16x64_bf16 v[44:47], v[8:11], v[136:143], v1
ds_read_b128 v[12:15], v12 offset:4096
v_cvt_pk_bf16_f32 v40, v40, v41
v_mov_b64 v[20:21], s[52:53]
s_waitcnt lgkmcnt(3)
v_mfma_f32_16x16x32_bf16 v[24:27], v[32:35], v[24:27], 0
v_cvt_pk_bf16_f32 v41, v42, v43
s_waitcnt lgkmcnt(2)
v_mfma_f32_16x16x32_bf16 v[24:27], v[36:39], v[28:31], v[24:27]
s_waitcnt vmcnt(5)
s_waitcnt lgkmcnt(1)
v_mfma_f32_16x16x32_bf16 v[8:11], v[56:59], v[16:19], 0
buffer_load_dwordx4 v[56:59], v0, s[4:7], s62 offen offset:0
v_mov_b64 v[28:29], s[56:57]
v_cvt_pk_bf16_f32 v43, v46, v47
v_cvt_pk_bf16_f32 v42, v44, v45
v_permlane32_swap_b32 v25, v27
v_permlane32_swap_b32 v24, v26
v_mfma_f32_16x16x32_bf16 v[4:7], v[20:23], v[16:19], 0
s_waitcnt lgkmcnt(0)
v_add_f32_dpp v28, v26, v24 row_ror:8 row_mask:0xf bank_mask:0x3
v_add_f32_dpp v29, v27, v25 row_ror:8 row_mask:0xf bank_mask:0x3
v_exp_f32 v28, v28
v_mfma_f32_16x16x32_bf16 v[8:11], v[60:63], v[12:15], v[8:11]
buffer_load_dwordx4 v[60:63], v0, s[4:7], s62 offen offset:1024
v_exp_f32 v29, v29
v_permlane32_swap_b32 v42, v43
v_cvt_pk_bf16_f32 v24, v28, v29
v_mov_b64 v[44:45], s[54:55]
v_cvt_pk_bf16_f32 v25, v28, v29
v_mov_b32_dpp v26, v24 row_ror:8 row_mask:0xf bank_mask:0xf
v_mov_b32_dpp v27, v24 row_ror:8 row_mask:0xf bank_mask:0xf
v_mfma_f32_16x16x16_bf16 v[4:7], v[44:45], v[24:25], v[4:7]
v_permlane32_swap_b32 v40, v41
v_mov_b64 v[36:37], 0
v_mov_b64 v[38:39], 0
v_mov_b64 v[30:31], 0
v_mfma_f32_16x16x32_bf16 v[8:11], v[40:43], v[24:27], v[8:11]
buffer_load_dwordx4 v[16:19], v0, s[4:7], s62 offen offset:2048
v_rcp_f32 v6, v4
v_and_b32 v12, 0xffffff7f, v0
v_and_or_b32 v13, v1, 8, v12
v_rcp_f32_dpp v6, v4 row_ror:8 row_mask:0xf bank_mask:0xc
v_mov_b64 v[26:27], 0
v_pk_mul_f32 v[8:9], v[8:9], v[6:7] op_sel_hi:[1,0]
v_cvt_pk_bf16_f32 v44, v8, v9
v_pk_mul_f32 v[10:11], v[10:11], v[6:7] op_sel_hi:[1,0]
v_cvt_pk_bf16_f32 v45, v10, v11
s_waitcnt vmcnt(5)
ds_write_b64 v13, v[44:45] offset:6272
buffer_load_dwordx4 v[20:23], v0, s[4:7], s62 offen offset:3072
v_add_u32 v6, 0xd4800000, v6
v_cmp_lt_u32 vcc, 0x28000000, v6
v_mov_b64 v[34:35], 0
v_mov_b32_dpp v46, v44 row_ror:8 row_mask:0xf bank_mask:0xf
v_mov_b32_dpp v47, v45 row_ror:8 row_mask:0xf bank_mask:0xf
v_mov_b64 v[28:29], 0
v_mov_b64 v[32:33], 0
s_cbranch_vccnz k_slow_191
k_okS_192:
v_smfmac_f32_16x16x64_bf16 v[36:39], v[44:47], v[224:231], v1
s_waitcnt lgkmcnt(0)
s_barrier
ds_read_b128 v[8:11], v12 offset:7296
v_smfmac_f32_16x16x64_bf16 v[32:35], v[44:47], v[200:207], v1
s_waitcnt vmcnt(4)
ds_read_b128 v[4:7], v12 offset:7168
v_mov_b64 v[24:25], 0
v_smfmac_f32_16x16x64_bf16 v[28:31], v[44:47], v[48:55], v1
ds_read_b128 v[12:15], v12 offset:6144
ds_read_b128 v[48:51], v2 offset:28672
v_smfmac_f32_16x16x64_bf16 v[24:27], v[44:47], v[64:71], v1
ds_read_b128 v[52:55], v2 offset:29696
v_mov_b64 v[42:43], 0
s_waitcnt lgkmcnt(4)
v_smfmac_f32_16x16x64_bf16 v[24:27], v[8:11], v[184:191], v1
s_waitcnt lgkmcnt(3)
v_mov_b64 v[40:41], 0
v_smfmac_f32_16x16x64_bf16 v[24:27], v[4:7], v[176:183], v1
s_waitcnt lgkmcnt(2)
ds_read_b128 v[64:67], v2 offset:63488
v_smfmac_f32_16x16x64_bf16 v[24:27], v[12:15], v[192:199], v1
ds_read_b128 v[68:71], v2 offset:64512
v_smfmac_f32_16x16x64_bf16 v[40:43], v[44:47], v[240:247], v1
s_waitcnt vmcnt(2)
s_waitcnt lgkmcnt(2)
v_lshrrev_b32 v44, 16, v1
v_cvt_pk_bf16_f32 v24, v24, v25
v_bfi_b32 v24, 1, s45, v24
v_cvt_pk_bf16_f32 v25, v26, v27
v_smfmac_f32_16x16x64_bf16 v[28:31], v[8:11], v[48:55], v1
buffer_store_dwordx2 v[24:25], v44, s[4:7], s38 offen sc1
ds_read_b128 v[48:51], v2 offset:34816
ds_read_b128 v[52:55], v2 offset:35840
v_smfmac_f32_16x16x64_bf16 v[28:31], v[12:15], v[56:63], v1
s_waitcnt lgkmcnt(2)
ds_read_b128 v[56:59], v2 offset:59392
v_smfmac_f32_16x16x64_bf16 v[28:31], v[4:7], v[64:71], v1
ds_read_b128 v[60:63], v2 offset:60416
v_smfmac_f32_16x16x64_bf16 v[32:35], v[8:11], v[208:215], v1
ds_read_b128 v[64:67], v2 offset:32768
s_nop 0
v_cvt_pk_bf16_f32 v28, v28, v29
v_bfi_b32 v28, 1, s45, v28
v_cvt_pk_bf16_f32 v29, v30, v31
v_smfmac_f32_16x16x64_bf16 v[32:35], v[12:15], v[216:223], v1
buffer_store_dwordx2 v[28:29], v44, s[4:7], s39 offen sc1
v_smfmac_f32_16x16x64_bf16 v[40:43], v[12:15], v[248:255], v1
ds_read_b128 v[68:71], v2 offset:33792
s_waitcnt vmcnt(2)
v_smfmac_f32_16x16x64_bf16 v[32:35], v[4:7], v[16:23], v1
s_waitcnt lgkmcnt(2)
v_smfmac_f32_16x16x64_bf16 v[36:39], v[12:15], v[232:239], v1
ds_read_b128 v[16:19], v2 offset:61440
ds_read_b128 v[20:23], v2 offset:62464
v_cvt_pk_bf16_f32 v32, v32, v33
v_bfi_b32 v32, 1, s45, v32
v_cvt_pk_bf16_f32 v33, v34, v35
v_smfmac_f32_16x16x64_bf16 v[36:39], v[8:11], v[48:55], v1
buffer_store_dwordx2 v[32:33], v44, s[4:7], s40 offen sc1
s_waitcnt lgkmcnt(2)
v_smfmac_f32_16x16x64_bf16 v[36:39], v[4:7], v[64:71], v1
s_nop 6
v_cvt_pk_bf16_f32 v36, v36, v37
v_cvt_pk_bf16_f32 v37, v38, v39
s_waitcnt lgkmcnt(0)
v_bfi_b32 v36, 1, s45, v36
v_smfmac_f32_16x16x64_bf16 v[40:43], v[8:11], v[16:23], v1
buffer_store_dwordx2 v[36:37], v44, s[4:7], s41 offen sc1
v_smfmac_f32_16x16x64_bf16 v[40:43], v[4:7], v[56:63], v1
s_nop 6
v_cvt_pk_bf16_f32 v40, v40, v41
v_bfi_b32 v40, 1, s45, v40
v_cvt_pk_bf16_f32 v41, v42, v43
buffer_store_dwordx2 v[40:41], v44, s[4:7], s42 offen sc1
s_barrier
buffer_load_dwordx4 v[24:27], v0, s[4:7], s43 offen offset:0 sc1
buffer_load_dwordx4 v[28:31], v0, s[4:7], s43 offen offset:1024 sc1
buffer_load_dwordx4 v[32:35], v0, s[4:7], s43 offen offset:2048 sc1
buffer_load_dwordx4 v[36:39], v0, s[4:7], s43 offen offset:3072 sc1
buffer_load_dwordx4 v[48:51], v0, s[4:7], s60 offen offset:0
buffer_load_dwordx4 v[52:55], v0, s[4:7], s60 offen offset:1024
buffer_load_dwordx4 v[56:59], v0, s[4:7], s60 offen offset:2048
buffer_load_dwordx4 v[60:63], v0, s[4:7], s60 offen offset:3072
v_lshlrev_b32 v23, v0, s58
v_cndmask_b32 v16, 0, v23, s[12:13]
v_cndmask_b32 v17, 0, v23, s[14:15]
v_cndmask_b32 v18, 0, v23, s[16:17]
v_cndmask_b32 v19, 0, v23, s[18:19]
v_and_b32 v45, 0x30, v0
v_lshrrev_b32 v46, 8, v0
v_lshl_or_b32 v45, v46, 2, v45
v_bfe_u32 v46, v0, 6, 1
v_lshl_or_b32 v45, v46, 7, v45
v_cndmask_b32 v45, v45, 2.0, s[98:99]
v_cndmask_b32 v20, 0, v23, s[90:91]
v_cndmask_b32 v21, 0, v23, s[92:93]
v_cndmask_b32 v22, 0, v23, s[94:95]
v_cndmask_b32 v23, 0, v23, s[96:97]
s_add_u32 s33, s33, 16384
s_bitset0_b32 s33, 16
s_waitcnt vmcnt(7)
v_mfma_f32_16x16x32_bf16 v[40:43], v[24:27], v[16:19], 0
s_waitcnt vmcnt(6)
v_mfma_f32_16x16x32_bf16 v[40:43], v[28:31], v[16:19], v[40:43]
v_bitop3_b32 v46, v24, v28, s45 bitop3:0x7e
s_waitcnt vmcnt(5)
v_mfma_f32_16x16x32_bf16 v[40:43], v[32:35], v[16:19], v[40:43]
s_waitcnt vmcnt(4)
v_mfma_f32_16x16x32_bf16 v[40:43], v[36:39], v[16:19], v[40:43]
v_bitop3_b32 v47, v32, v36, s45 bitop3:0x7e
v_bitop3_b32 v46, v46, v47, 1 bitop3:0xa8
v_cmp_ne_u32 vcc, 0, v46
v_mov_b64 v[24:25], 0
v_mov_b64 v[26:27], 0
v_mov_b64 v[28:29], 0
v_mov_b64 v[30:31], 0
v_permlane32_swap_b32 v40, v41
v_permlane32_swap_b32 v42, v43
v_add_f32 v40, v40, v41
v_add_f32 v41, v42, v43
v_cvt_pk_bf16_f32 v42, v40, v41
s_cbranch_vccnz k_r1_194
k_ok1_195:
buffer_store_dword v42, v45, s[4:7], s44 offen sc1
s_barrier
buffer_load_dwordx4 v[4:7], v0, s[4:7], s33 offen offset:1024 sc1
buffer_load_dwordx4 v[8:11], v0, s[4:7], s33 offen offset:0 sc1
s_add_u32 s34, s33, 3072
s_add_u32 s35, s33, 7168
s_add_u32 s36, s36, 524288
s_add_u32 s37, s37, 10240
s_add_u32 s59, s59, 10240
v_mov_b64 v[32:33], 0
v_mov_b64 v[34:35], 0
v_mov_b64 v[36:37], 0
v_mov_b64 v[38:39], 0
v_mov_b64 v[40:41], 0
v_mov_b64 v[42:43], 0
v_mov_b64 v[44:45], 0
v_mov_b64 v[46:47], 0
s_add_u32 s44, s44, 16384
s_bitset0_b32 s44, 16
s_sub_u32 s45, s45, 1
s_add_u32 s31, s31, 1
ds_read_b128 v[64:67], v0 offset:24576
ds_read_b128 v[68:71], v0 offset:25600
buffer_load_dwordx4 v[12:15], v0, s[4:7], s34 offen offset:0 sc1
s_cmp_lg_u32 s31, s47
s_cbranch_scc1 k_T0_183
s_branch k_done_193
k_cold2_185:
s_barrier
buffer_load_dwordx4 v[48:51], v0, s[4:7], s60 offen offset:0
buffer_load_dwordx4 v[52:55], v0, s[4:7], s60 offen offset:1024
buffer_load_dwordx4 v[56:59], v0, s[4:7], s60 offen offset:2048
buffer_load_dwordx4 v[60:63], v0, s[4:7], s60 offen offset:3072
ds_read_b128 v[64:67], v0 offset:24576
ds_read_b128 v[68:71], v0 offset:25600
k_cold_184:
buffer_load_dwordx4 v[4:7], v0, s[4:7], s33 offen offset:1024 sc1
buffer_load_dwordx4 v[8:11], v0, s[4:7], s33 offen offset:0 sc1
buffer_load_dwordx4 v[12:15], v0, s[4:7], s34 offen offset:0 sc1
s_sub_u32 s32, s32, 1
s_cmp_gt_i32 s32, 0
s_cbranch_scc0 k_okC_186
v_mov_b64 v[24:25], 0
v_mov_b64 v[26:27], 0
v_mov_b64 v[28:29], 0
v_mov_b64 v[30:31], 0
v_mov_b64 v[32:33], 0
v_mov_b64 v[34:35], 0
v_mov_b64 v[36:37], 0
v_mov_b64 v[38:39], 0
v_mov_b64 v[40:41], 0
v_mov_b64 v[42:43], 0
v_mov_b64 v[44:45], 0
v_mov_b64 v[46:47], 0
s_branch k_T0_183
k_coldA_187:
buffer_load_dwordx4 v[12:15], v0, s[4:7], s34 offen offset:0 sc1
s_sub_u32 s32, s32, 1
s_cmp_gt_i32 s32, 0
s_waitcnt vmcnt(0)
v_cmp_u_f32 vcc, v12, v12
ds_write_b128 v0, v[12:15] offset:1024
s_waitcnt lgkmcnt(0)
s_cbranch_vccz k_okA_188
s_cbranch_scc1 k_coldA_187
s_branch k_okA_188
k_coldB_189:
buffer_load_dwordx4 v[16:19], v0, s[4:7], s35 offen offset:0 sc1
s_sub_u32 s32, s32, 1
s_cmp_gt_i32 s32, 0
s_waitcnt vmcnt(0)
v_cmp_u_f32 vcc, v16, v16
ds_write_b128 v0, v[16:19] offset:5120
s_waitcnt lgkmcnt(0)
s_cbranch_vccz k_okB_190
s_cbranch_scc1 k_coldB_189
s_branch k_okB_190
k_r1_194:
buffer_load_dwordx4 v[24:27], v0, s[4:7], s43 offen offset:0 sc1
buffer_load_dwordx4 v[28:31], v0, s[4:7], s43 offen offset:1024 sc1
buffer_load_dwordx4 v[32:35], v0, s[4:7], s43 offen offset:2048 sc1
buffer_load_dwordx4 v[36:39], v0, s[4:7], s43 offen offset:3072 sc1
s_sub_u32 s32, s32, 1
s_cmp_gt_i32 s32, 0
s_waitcnt vmcnt(3)
v_mfma_f32_16x16x32_bf16 v[40:43], v[24:27], v[16:19], 0
s_waitcnt vmcnt(2)
v_mfma_f32_16x16x32_bf16 v[40:43], v[28:31], v[16:19], v[40:43]
v_bitop3_b32 v46, v24, v28, s45 bitop3:0x7e
s_waitcnt vmcnt(1)
v_mfma_f32_16x16x32_bf16 v[40:43], v[32:35], v[16:19], v[40:43]
s_waitcnt vmcnt(0)
v_mfma_f32_16x16x32_bf16 v[40:43], v[36:39], v[16:19], v[40:43]
v_bitop3_b32 v47, v32, v36, s45 bitop3:0x7e
v_bitop3_b32 v46, v46, v47, 1 bitop3:0xa8
v_cmp_ne_u32 vcc, 0, v46
v_mov_b64 v[24:25], 0
v_mov_b64 v[26:27], 0
v_mov_b64 v[28:29], 0
v_mov_b64 v[30:31], 0
v_permlane32_swap_b32 v40, v41
v_permlane32_swap_b32 v42, v43
v_add_f32 v40, v40, v41
v_add_f32 v41, v42, v43
v_cvt_pk_bf16_f32 v42, v40, v41
s_cbranch_vccz k_ok1_195
s_cbranch_scc1 k_r1_194
s_branch k_ok1_195
k_slow_191:
ds_read_b128 v[24:27], v0 offset:0
ds_read_b128 v[28:31], v0 offset:1024
v_mov_b32 v46, 0xff7fffff
s_add_u32 s48, s36, 0xfffff000
buffer_load_dwordx4 v[32:35], v0, s[4:7], s48 offen offset:0 sc1
buffer_load_dwordx4 v[36:39], v0, s[4:7], s48 offen offset:1024 sc1
s_waitcnt vmcnt(1) lgkmcnt(1)
v_mfma_f32_16x16x32_bf16 v[4:7], v[32:35], v[24:27], 0
s_waitcnt vmcnt(0) lgkmcnt(0)
v_mfma_f32_16x16x32_bf16 v[4:7], v[36:39], v[28:31], v[4:7]
v_mov_b64 v[8:9], s[56:57]
s_nop 5
v_permlane32_swap_b32 v4, v6
v_permlane32_swap_b32 v5, v7
v_add_f32_dpp v8, v6, v4 row_ror:8 row_mask:0xf bank_mask:0x3
s_nop 0
v_add_f32_dpp v9, v7, v5 row_ror:8 row_mask:0xf bank_mask:0x3
v_max3_f32 v46, v46, v8, v9
s_add_u32 s48, s36, 0x0
buffer_load_dwordx4 v[32:35], v0, s[4:7], s48 offen offset:0 sc1
buffer_load_dwordx4 v[36:39], v0, s[4:7], s48 offen offset:1024 sc1
s_waitcnt vmcnt(1)
v_mfma_f32_16x16x32_bf16 v[4:7], v[32:35], v[24:27], 0
s_waitcnt vmcnt(0)
v_mfma_f32_16x16x32_bf16 v[4:7], v[36:39], v[28:31], v[4:7]
v_mov_b64 v[10:11], s[56:57]
s_nop 5
v_permlane32_swap_b32 v4, v6
v_permlane32_swap_b32 v5, v7
v_add_f32_dpp v10, v6, v4 row_ror:8 row_mask:0xf bank_mask:0x3
s_nop 0
v_add_f32_dpp v11, v7, v5 row_ror:8 row_mask:0xf bank_mask:0x3
v_max3_f32 v46, v46, v10, v11
s_add_u32 s48, s36, 0x1000
buffer_load_dwordx4 v[32:35], v0, s[4:7], s48 offen offset:0 sc1
buffer_load_dwordx4 v[36:39], v0, s[4:7], s48 offen offset:1024 sc1
s_waitcnt vmcnt(1)
v_mfma_f32_16x16x32_bf16 v[4:7], v[32:35], v[24:27], 0
s_waitcnt vmcnt(0)
v_mfma_f32_16x16x32_bf16 v[4:7], v[36:39], v[28:31], v[4:7]
v_mov_b64 v[12:13], s[56:57]
s_nop 5
v_permlane32_swap_b32 v4, v6
v_permlane32_swap_b32 v5, v7
v_add_f32_dpp v12, v6, v4 row_ror:8 row_mask:0xf bank_mask:0x3
s_nop 0
v_add_f32_dpp v13, v7, v5 row_ror:8 row_mask:0xf bank_mask:0x3
v_max3_f32 v46, v46, v12, v13
s_add_u32 s48, s36, 0x2000
buffer_load_dwordx4 v[32:35], v0, s[4:7], s48 offen offset:0 sc1
buffer_load_dwordx4 v[36:39], v0, s[4:7], s48 offen offset:1024 sc1
s_waitcnt vmcnt(1)
v_mfma_f32_16x16x32_bf16 v[4:7], v[32:35], v[24:27], 0
s_waitcnt vmcnt(0)
v_mfma_f32_16x16x32_bf16 v[4:7], v[36:39], v[28:31], v[4:7]
v_mov_b64 v[14:15], s[56:57]
s_nop 5
v_permlane32_swap_b32 v4, v6
v_permlane32_swap_b32 v5, v7
v_add_f32_dpp v14, v6, v4 row_ror:8 row_mask:0xf bank_mask:0x3
s_nop 0
v_add_f32_dpp v15, v7, v5 row_ror:8 row_mask:0xf bank_mask:0x3
v_max3_f32 v46, v46, v14, v15
ds_read_b128 v[32:35], v0 offset:2048
ds_read_b128 v[36:39], v0 offset:3072
s_waitcnt lgkmcnt(1)
v_mfma_f32_16x16x32_bf16 v[4:7], v[32:35], v[24:27], 0
s_waitcnt lgkmcnt(0)
v_mfma_f32_16x16x32_bf16 v[4:7], v[36:39], v[28:31], v[4:7]
v_mov_b64 v[44:45], s[56:57]
s_nop 5
v_permlane32_swap_b32 v4, v6
v_permlane32_swap_b32 v5, v7
v_add_f32_dpp v44, v6, v4 row_ror:8 row_mask:0xf bank_mask:0x3
s_nop 0
v_add_f32_dpp v45, v7, v5 row_ror:8 row_mask:0xf bank_mask:0x3
v_max3_f32 v46, v46, v44, v45
buffer_load_dwordx4 v[32:35], v0, s[4:7], s36 offen offset:2048 sc1
buffer_load_dwordx4 v[36:39], v0, s[4:7], s36 offen offset:3072 sc1
v_mov_b32 v47, v46
s_nop 1
v_permlane32_swap_b32 v46, v47
v_max_f32 v46, v46, v47
v_mov_b32 v47, v46
s_nop 1
v_permlane16_swap_b32 v46, v47
v_max_f32 v46, v46, v47
v_sub_f32 v8, v8, v46
v_exp_f32 v8, v8
v_sub_f32 v9, v9, v46
v_exp_f32 v9, v9
v_sub_f32 v10, v10, v46
v_exp_f32 v10, v10
v_sub_f32 v11, v11, v46
v_exp_f32 v11, v11
v_sub_f32 v12, v12, v46
v_exp_f32 v12, v12
v_sub_f32 v13, v13, v46
v_exp_f32 v13, v13
v_sub_f32 v14, v14, v46
v_exp_f32 v14, v14
v_sub_f32 v15, v15, v46
v_exp_f32 v15, v15
v_sub_f32 v44, v44, v46
v_exp_f32 v44, v44
v_sub_f32 v45, v45, v46
v_exp_f32 v45, v45
v_cvt_pk_bf16_f32 v4, v8, v9
v_cvt_pk_bf16_f32 v5, v10, v11
v_cvt_pk_bf16_f32 v6, v12, v13
v_cvt_pk_bf16_f32 v7, v14, v15
v_mov_b32_dpp v8, v4 row_ror:8 row_mask:0xf bank_mask:0xf
v_mov_b32_dpp v9, v5 row_ror:8 row_mask:0xf bank_mask:0xf
v_mov_b32_dpp v10, v6 row_ror:8 row_mask:0xf bank_mask:0xf
v_mov_b32_dpp v11, v7 row_ror:8 row_mask:0xf bank_mask:0xf
v_cvt_pk_bf16_f32 v24, v44, v45
v_cvt_pk_bf16_f32 v25, v44, v45
s_nop 0
v_mov_b32_dpp v26, v24 row_ror:8 row_mask:0xf bank_mask:0xf
v_mov_b32_dpp v27, v24 row_ror:8 row_mask:0xf bank_mask:0xf
v_mov_b64 v[28:29], s[52:53]
v_mov_b64 v[30:31], s[52:53]
s_nop 1
v_mfma_f32_16x16x32_bf16 v[44:47], v[28:31], v[4:7], 0
s_waitcnt vmcnt(1)
v_mfma_f32_16x16x32_bf16 v[12:15], v[32:35], v[4:7], 0
s_waitcnt vmcnt(0)
v_mfma_f32_16x16x32_bf16 v[12:15], v[36:39], v[8:11], v[12:15]
v_mfma_f32_16x16x32_bf16 v[12:15], v[40:43], v[24:27], v[12:15]
v_mov_b64 v[28:29], s[54:55]
s_nop 1
v_mfma_f32_16x16x16_bf16 v[44:47], v[28:29], v[24:25], v[44:47]
s_nop 6
v_rcp_f32 v4, v44
s_nop 1
v_rcp_f32_dpp v4, v44 row_ror:8 row_mask:0xf bank_mask:0xc
s_nop 0
v_mul_f32 v12, v4, v12
v_mul_f32 v13, v4, v13
v_mul_f32 v14, v4, v14
v_mul_f32 v15, v4, v15
v_cvt_pk_bf16_f32 v44, v12, v13
v_cvt_pk_bf16_f32 v45, v14, v15
v_and_b32 v12, 0xffffff7f, v0
v_and_or_b32 v8, v1, 8, v12
ds_write_b64 v8, v[44:45] offset:6272
v_mov_b32_dpp v46, v44 row_ror:8 row_mask:0xf bank_mask:0xf
v_mov_b32_dpp v47, v45 row_ror:8 row_mask:0xf bank_mask:0xf
v_mov_b64 v[24:25], 0
v_mov_b64 v[26:27], 0
v_mov_b64 v[28:29], 0
v_mov_b64 v[30:31], 0
v_mov_b64 v[32:33], 0
v_mov_b64 v[34:35], 0
v_mov_b64 v[36:37], 0
v_mov_b64 v[38:39], 0
s_waitcnt lgkmcnt(0)
s_branch k_okS_192
k_done_193:
buffer_load_dwordx4 v[16:19], v0, s[4:7], s35 offen offset:0 sc1
k_xs_199:
s_waitcnt vmcnt(1)
v_cmp_u_f32 vcc, v4, v12
s_waitcnt vmcnt(0)
v_cmp_u_f32 s[66:67], v16, v16
s_or_b64 vcc, vcc, s[66:67]
s_cbranch_vccz k_xd_200
buffer_load_dwordx4 v[4:7], v0, s[4:7], s33 offen offset:1024 sc1
buffer_load_dwordx4 v[8:11], v0, s[4:7], s33 offen offset:0 sc1
buffer_load_dwordx4 v[12:15], v0, s[4:7], s34 offen offset:0 sc1
buffer_load_dwordx4 v[16:19], v0, s[4:7], s35 offen offset:0 sc1
s_sub_u32 s32, s32, 1
s_cmp_gt_i32 s32, 0
s_cbranch_scc1 k_xs_199
k_xd_200:
s_waitcnt vmcnt(3)
buffer_store_dwordx4 v[4:7], v0, s[8:11], s37 offen offset:0 sc1
s_waitcnt vmcnt(2)
buffer_store_dwordx4 v[12:15], v0, s[8:11], s37 offen offset:2048 sc1
s_waitcnt vmcnt(2)
buffer_store_dwordx4 v[16:19], v0, s[8:11], s59 offen offset:2048 sc1
s_add_u32 s31, s31, 1
k_jn_164:
s_cmp_lt_u32 s31, 128
s_cbranch_scc1 k_lay_162
s_add_u32 s30, s30, 112
s_waitcnt vmcnt(0) lgkmcnt(0)
s_barrier
s_branch k_fin_7
k_w2_113:
v_lshrrev_b32 v12, 3, v0
v_lshlrev_b32 v10, 13, v12
v_bfe_u32 v12, v0, 1, 2
v_lshrrev_b32 v13, 4, v0
v_xor_b32 v12, v12, v13
v_lshl_add_u32 v10, v12, 5, v10
v_and_b32 v14, 1, v0
v_lshl_add_u32 v10, v14, 4, v10
v_mul_u32_u24 v11, 1280, v13
v_bfe_u32 v12, v0, 1, 3
v_and_b32 v13, 1, v13
v_lshlrev_b32 v13, 1, v13
v_xor_b32 v12, v12, v13
v_xor_b32 v12, 4, v12
v_lshl_add_u32 v11, v12, 5, v11
v_lshl_add_u32 v11, v14, 4, v11
v_bfe_u32 v12, v0, 5, 1
v_lshlrev_b32 v12, 4, v12
v_bfe_u32 v13, v0, 4, 1
v_lshl_add_u32 v12, v13, 1, v12
v_bfe_u32 v13, v0, 2, 1
v_lshl_add_u32 v12, v13, 2, v12
v_bfe_u32 v13, v0, 3, 1
v_mul_u32_u24 v15, 4224, v13
v_add_u32 v12, v13, v12
v_bfe_u32 v13, v12, 1, 2
v_xor_b32 v13, 2, v13
v_lshlrev_b32 v13, 5, v13
v_lshl_add_u32 v4, v12, 7, v13
v_and_b32 v14, 3, v0
v_lshl_add_u32 v4, v14, 3, v4
v_add_u32 v5, 0x10000, v4
v_add_u32 v6, 0x20000, v4
v_bfe_u32 v12, v0, 4, 1
v_lshlrev_b32 v13, 4, v12
v_lshlrev_b32 v12, 2, v12
v_bfe_u32 v8, v0, 5, 1
v_lshl_add_u32 v13, v8, 2, v13
v_bfe_u32 v8, v0, 2, 1
v_add_u32 v13, v8, v13
v_lshl_add_u32 v12, v8, 1, v12
v_bfe_u32 v8, v0, 3, 1
v_add_u32 v8, 4, v8
v_xor_b32 v12, v12, v8
v_lshlrev_b32 v12, 5, v12
v_lshl_add_u32 v7, v13, 8, v12
v_lshl_add_u32 v7, v14, 3, v7
v_add_u32 v8, 0x10000, v7
v_add_u32 v9, 0x20000, v7
v_lshlrev_b32 v0, 4, v0
v_add_u32 v2, 65536, v0
s_lshl_b32 s49, s30, 8
s_mul_i32 s50, s30, 163840
s_mul_i32 s60, s30, 131072
s_add_u32 s60, s60, 120651776
s_add_u32 s61, s60, 4096
s_add_u32 s62, s60, 8192
s_mov_b32 m0, 4096
s_add_u32 s48, s49, 262144
buffer_load_dwordx4 v10, s[8:11], s48 offen lds
s_mov_b32 m0, 5120
s_add_u32 s48, s49, 327680
buffer_load_dwordx4 v10, s[8:11], s48 offen lds
s_mov_b32 m0, 12288
s_add_u32 s48, s49, 262272
buffer_load_dwordx4 v10, s[8:11], s48 offen lds
s_mov_b32 m0, 13312
s_add_u32 s48, s49, 327808
buffer_load_dwordx4 v10, s[8:11], s48 offen lds
s_mov_b32 m0, 20480
s_add_u32 s48, s49, 262272
buffer_load_dwordx4 v10, s[12:15], s48 offen lds
s_mov_b32 m0, 21504
s_add_u32 s48, s49, 327808
buffer_load_dwordx4 v10, s[12:15], s48 offen lds
s_mov_b32 m0, 28672
s_add_u32 s48, s49, 262144
buffer_load_dwordx4 v10, s[16:19], s48 offen lds
s_mov_b32 m0, 29696
s_add_u32 s48, s49, 327680
buffer_load_dwordx4 v10, s[16:19], s48 offen lds
s_mov_b32 m0, 36864
s_add_u32 s48, s49, 262272
buffer_load_dwordx4 v10, s[16:19], s48 offen lds
s_mov_b32 m0, 37888
s_add_u32 s48, s49, 327808
buffer_load_dwordx4 v10, s[16:19], s48 offen lds
s_mov_b32 m0, 45056
s_add_u32 s48, s49, 786432
buffer_load_dwordx4 v10, s[8:11], s48 offen lds
s_mov_b32 m0, 46080
s_add_u32 s48, s49, 851968
buffer_load_dwordx4 v10, s[8:11], s48 offen lds
s_mov_b32 m0, 53248
s_add_u32 s48, s49, 786560
buffer_load_dwordx4 v10, s[8:11], s48 offen lds
s_mov_b32 m0, 54272
s_add_u32 s48, s49, 852096
buffer_load_dwordx4 v10, s[8:11], s48 offen lds
s_mov_b32 m0, 61440
s_add_u32 s48, s49, 786560
buffer_load_dwordx4 v10, s[12:15], s48 offen lds
s_mov_b32 m0, 62464
s_add_u32 s48, s49, 852096
buffer_load_dwordx4 v10, s[12:15], s48 offen lds
s_mov_b32 m0, 69632
s_add_u32 s48, s49, 786432
buffer_load_dwordx4 v10, s[16:19], s48 offen lds
s_mov_b32 m0, 70656
s_add_u32 s48, s49, 851968
buffer_load_dwordx4 v10, s[16:19], s48 offen lds
s_mov_b32 m0, 77824
s_add_u32 s48, s49, 786560
buffer_load_dwordx4 v10, s[16:19], s48 offen lds
s_mov_b32 m0, 78848
s_add_u32 s48, s49, 852096
buffer_load_dwordx4 v10, s[16:19], s48 offen lds
s_mov_b32 m0, 86016
s_add_u32 s48, s49, 1310720
buffer_load_dwordx4 v10, s[8:11], s48 offen lds
s_mov_b32 m0, 87040
s_add_u32 s48, s49, 1376256
buffer_load_dwordx4 v10, s[8:11], s48 offen lds
s_mov_b32 m0, 94208
s_add_u32 s48, s49, 1310848
buffer_load_dwordx4 v10, s[8:11], s48 offen lds
s_mov_b32 m0, 95232
s_add_u32 s48, s49, 1376384
buffer_load_dwordx4 v10, s[8:11], s48 offen lds
s_mov_b32 m0, 102400
s_add_u32 s48, s49, 1310848
buffer_load_dwordx4 v10, s[12:15], s48 offen lds
s_mov_b32 m0, 103424
s_add_u32 s48, s49, 1376384
buffer_load_dwordx4 v10, s[12:15], s48 offen lds
s_mov_b32 m0, 110592
s_add_u32 s48, s49, 1310720
buffer_load_dwordx4 v10, s[16:19], s48 offen lds
s_mov_b32 m0, 111616
s_add_u32 s48, s49, 1376256
buffer_load_dwordx4 v10, s[16:19], s48 offen lds
s_mov_b32 m0, 118784
s_add_u32 s48, s49, 1835008
buffer_load_dwordx4 v10, s[8:11], s48 offen lds
s_mov_b32 m0, 119808
s_add_u32 s48, s49, 1900544
buffer_load_dwordx4 v10, s[8:11], s48 offen lds
s_mov_b32 m0, 126976
s_add_u32 s48, s49, 1835136
buffer_load_dwordx4 v10, s[8:11], s48 offen lds
s_mov_b32 m0, 128000
s_add_u32 s48, s49, 1900672
buffer_load_dwordx4 v10, s[8:11], s48 offen lds
s_waitcnt vmcnt(24)
s_barrier
s_mov_b32 m0, 135168
s_add_u32 s48, s49, 1835136
buffer_load_dwordx4 v10, s[12:15], s48 offen lds
s_mov_b32 m0, 136192
s_add_u32 s48, s49, 1900672
buffer_load_dwordx4 v10, s[12:15], s48 offen lds
s_mov_b32 m0, 143360
s_add_u32 s48, s49, 1835008
buffer_load_dwordx4 v10, s[16:19], s48 offen lds
s_mov_b32 m0, 144384
s_add_u32 s48, s49, 1900544
buffer_load_dwordx4 v10, s[16:19], s48 offen lds
s_mov_b32 m0, 151552
s_add_u32 s48, s49, 2359296
buffer_load_dwordx4 v10, s[8:11], s48 offen lds
s_mov_b32 m0, 152576
s_add_u32 s48, s49, 2424832
buffer_load_dwordx4 v10, s[8:11], s48 offen lds
s_mov_b32 m0, 159744
s_add_u32 s48, s49, 2359424
buffer_load_dwordx4 v10, s[8:11], s48 offen lds
s_mov_b32 m0, 160768
s_add_u32 s48, s49, 2424960
buffer_load_dwordx4 v10, s[8:11], s48 offen lds
ds_read_b64_tr_b16 a[0:1], v4 offset:0
ds_read_b64_tr_b16 a[2:3], v4 offset:1024
ds_read_b64_tr_b16 a[4:5], v4 offset:4096
ds_read_b64_tr_b16 a[6:7], v4 offset:5120
ds_read_b64_tr_b16 a[8:9], v4 offset:8192
ds_read_b64_tr_b16 a[10:11], v4 offset:9216
ds_read_b64_tr_b16 a[12:13], v4 offset:12288
ds_read_b64_tr_b16 a[14:15], v4 offset:13312
ds_read_b64_tr_b16 a[16:17], v4 offset:16384
ds_read_b64_tr_b16 a[18:19], v4 offset:17408
ds_read_b64_tr_b16 a[20:21], v4 offset:20480
ds_read_b64_tr_b16 a[22:23], v4 offset:21504
ds_read_b64_tr_b16 v[40:41], v4 offset:24576
ds_read_b64_tr_b16 v[42:43], v4 offset:25600
ds_read_b64_tr_b16 v[44:45], v4 offset:28672
ds_read_b64_tr_b16 v[46:47], v4 offset:29696
s_waitcnt lgkmcnt(0)
buffer_store_dwordx4 v[40:43], v0, s[4:7], s60 offen offset:0
buffer_store_dwordx4 v[44:47], v0, s[4:7], s60 offen offset:1024
s_waitcnt vmcnt(26)
s_barrier
s_mov_b32 m0, 4096
s_add_u32 s48, s49, 2359424
buffer_load_dwordx4 v10, s[12:15], s48 offen lds
s_mov_b32 m0, 5120
s_add_u32 s48, s49, 2424960
buffer_load_dwordx4 v10, s[12:15], s48 offen lds
s_mov_b32 m0, 12288
s_add_u32 s48, s49, 2359296
buffer_load_dwordx4 v10, s[16:19], s48 offen lds
s_mov_b32 m0, 13312
s_add_u32 s48, s49, 2424832
buffer_load_dwordx4 v10, s[16:19], s48 offen lds
s_mov_b32 m0, 20480
s_add_u32 s48, s49, 2883584
buffer_load_dwordx4 v10, s[8:11], s48 offen lds
s_mov_b32 m0, 21504
s_add_u32 s48, s49, 2949120
buffer_load_dwordx4 v10, s[8:11], s48 offen lds
s_mov_b32 m0, 28672
s_add_u32 s48, s49, 2883712
buffer_load_dwordx4 v10, s[8:11], s48 offen lds
s_mov_b32 m0, 29696
s_add_u32 s48, s49, 2949248
buffer_load_dwordx4 v10, s[8:11], s48 offen lds
ds_read_b64_tr_b16 v[16:17], v4 offset:32768
ds_read_b64_tr_b16 v[18:19], v4 offset:33792
ds_read_b64_tr_b16 v[20:21], v4 offset:36864
ds_read_b64_tr_b16 v[22:23], v4 offset:37888
ds_read_b64_tr_b16 a[24:25], v4 offset:40960
ds_read_b64_tr_b16 a[26:27], v4 offset:41984
ds_read_b64_tr_b16 a[28:29], v4 offset:45056
ds_read_b64_tr_b16 a[30:31], v4 offset:46080
ds_read_b64_tr_b16 a[32:33], v4 offset:49152
ds_read_b64_tr_b16 a[34:35], v4 offset:50176
ds_read_b64_tr_b16 a[36:37], v4 offset:53248
ds_read_b64_tr_b16 a[38:39], v4 offset:54272
ds_read_b64_tr_b16 a[40:41], v4 offset:57344
ds_read_b64_tr_b16 a[42:43], v4 offset:58368
ds_read_b64_tr_b16 a[44:45], v4 offset:61440
ds_read_b64_tr_b16 a[46:47], v4 offset:62464
s_waitcnt lgkmcnt(0)
buffer_store_dwordx4 v[16:19], v0, s[4:7], s60 offen offset:2048
buffer_store_dwordx4 v[20:23], v0, s[4:7], s60 offen offset:3072
s_waitcnt vmcnt(28)
s_barrier
s_mov_b32 m0, 36864
s_add_u32 s48, s49, 2883712
buffer_load_dwordx4 v10, s[12:15], s48 offen lds
s_mov_b32 m0, 37888
s_add_u32 s48, s49, 2949248
buffer_load_dwordx4 v10, s[12:15], s48 offen lds
s_mov_b32 m0, 45056
s_add_u32 s48, s49, 2883584
buffer_load_dwordx4 v10, s[16:19], s48 offen lds
s_mov_b32 m0, 46080
s_add_u32 s48, s49, 2949120
buffer_load_dwordx4 v10, s[16:19], s48 offen lds
s_mov_b32 m0, 53248
s_add_u32 s48, s49, 3408000
buffer_load_dwordx4 v10, s[8:11], s48 offen lds
s_mov_b32 m0, 54272
s_add_u32 s48, s49, 3473536
buffer_load_dwordx4 v10, s[8:11], s48 offen lds
s_mov_b32 m0, 61440
s_add_u32 s48, s49, 3932160
buffer_load_dwordx4 v10, s[8:11], s48 offen lds
s_mov_b32 m0, 62464
s_add_u32 s48, s49, 3997696
buffer_load_dwordx4 v10, s[8:11], s48 offen lds
ds_read_b64_tr_b16 a[176:177], v5 offset:0
ds_read_b64_tr_b16 a[178:179], v5 offset:1024
ds_read_b64_tr_b16 a[180:181], v5 offset:4096
ds_read_b64_tr_b16 a[182:183], v5 offset:5120
ds_read_b64_tr_b16 v[224:225], v5 offset:8192
ds_read_b64_tr_b16 v[226:227], v5 offset:9216
ds_read_b64_tr_b16 v[228:229], v5 offset:12288
ds_read_b64_tr_b16 v[230:231], v5 offset:13312
ds_read_b64_tr_b16 a[112:113], v5 offset:16384
ds_read_b64_tr_b16 a[114:115], v5 offset:17408
ds_read_b64_tr_b16 a[116:117], v5 offset:20480
ds_read_b64_tr_b16 a[118:119], v5 offset:21504
ds_read_b64_tr_b16 a[120:121], v5 offset:24576
ds_read_b64_tr_b16 a[122:123], v5 offset:25600
ds_read_b64_tr_b16 a[124:125], v5 offset:28672
ds_read_b64_tr_b16 a[126:127], v5 offset:29696
s_waitcnt lgkmcnt(0)
s_waitcnt vmcnt(28)
s_barrier
s_mov_b32 m0, 69632
s_add_u32 s48, s49, 3932288
buffer_load_dwordx4 v10, s[8:11], s48 offen lds
s_mov_b32 m0, 70656
s_add_u32 s48, s49, 3997824
buffer_load_dwordx4 v10, s[8:11], s48 offen lds
s_mov_b32 m0, 77824
s_add_u32 s48, s49, 4456448
buffer_load_dwordx4 v10, s[8:11], s48 offen lds
s_mov_b32 m0, 78848
s_add_u32 s48, s49, 4521984
buffer_load_dwordx4 v10, s[8:11], s48 offen lds
s_mov_b32 m0, 86016
s_add_u32 s48, s49, 4456576
buffer_load_dwordx4 v10, s[8:11], s48 offen lds
s_mov_b32 m0, 87040
s_add_u32 s48, s49, 4522112
buffer_load_dwordx4 v10, s[8:11], s48 offen lds
s_mov_b32 m0, 94208
s_add_u32 s48, s49, 4980736
buffer_load_dwordx4 v10, s[8:11], s48 offen lds
s_mov_b32 m0, 95232
s_add_u32 s48, s49, 5046272
buffer_load_dwordx4 v10, s[8:11], s48 offen lds
ds_read_b64_tr_b16 a[128:129], v5 offset:32768
ds_read_b64_tr_b16 a[130:131], v5 offset:33792
ds_read_b64_tr_b16 a[132:133], v5 offset:36864
ds_read_b64_tr_b16 a[134:135], v5 offset:37888
ds_read_b64_tr_b16 a[136:137], v5 offset:40960
ds_read_b64_tr_b16 a[138:139], v5 offset:41984
ds_read_b64_tr_b16 a[140:141], v5 offset:45056
ds_read_b64_tr_b16 a[142:143], v5 offset:46080
ds_read_b64_tr_b16 a[144:145], v5 offset:49152
ds_read_b64_tr_b16 a[146:147], v5 offset:50176
ds_read_b64_tr_b16 a[148:149], v5 offset:53248
ds_read_b64_tr_b16 a[150:151], v5 offset:54272
ds_read_b64_tr_b16 a[152:153], v5 offset:57344
ds_read_b64_tr_b16 a[154:155], v5 offset:58368
ds_read_b64_tr_b16 a[156:157], v5 offset:61440
ds_read_b64_tr_b16 a[158:159], v5 offset:62464
s_waitcnt lgkmcnt(0)
s_waitcnt vmcnt(28)
s_barrier
s_mov_b32 m0, 102400
s_add_u32 s48, s49, 4980864
buffer_load_dwordx4 v10, s[8:11], s48 offen lds
s_mov_b32 m0, 103424
s_add_u32 s48, s49, 5046400
buffer_load_dwordx4 v10, s[8:11], s48 offen lds
s_mov_b32 m0, 110592
s_add_u32 s48, s49, 3407872
buffer_load_dwordx4 v10, s[12:15], s48 offen lds
s_mov_b32 m0, 111616
s_add_u32 s48, s49, 3473408
buffer_load_dwordx4 v10, s[12:15], s48 offen lds
s_mov_b32 m0, 118784
s_add_u32 s48, s49, 3408000
buffer_load_dwordx4 v10, s[12:15], s48 offen lds
s_mov_b32 m0, 119808
s_add_u32 s48, s49, 3473536
buffer_load_dwordx4 v10, s[12:15], s48 offen lds
s_mov_b32 m0, 126976
s_add_u32 s48, s49, 3932160
buffer_load_dwordx4 v10, s[12:15], s48 offen lds
s_mov_b32 m0, 128000
s_add_u32 s48, s49, 3997696
buffer_load_dwordx4 v10, s[12:15], s48 offen lds
ds_read_b64_tr_b16 a[160:161], v6 offset:0
ds_read_b64_tr_b16 a[162:163], v6 offset:1024
ds_read_b64_tr_b16 a[164:165], v6 offset:4096
ds_read_b64_tr_b16 a[166:167], v6 offset:5120
ds_read_b64_tr_b16 a[168:169], v6 offset:8192
ds_read_b64_tr_b16 a[170:171], v6 offset:9216
ds_read_b64_tr_b16 a[172:173], v6 offset:12288
ds_read_b64_tr_b16 a[174:175], v6 offset:13312
ds_read_b64_tr_b16 a[48:49], v6 offset:16384
ds_read_b64_tr_b16 a[50:51], v6 offset:17408
ds_read_b64_tr_b16 a[52:53], v6 offset:20480
ds_read_b64_tr_b16 a[54:55], v6 offset:21504
ds_read_b64_tr_b16 a[56:57], v6 offset:24576
ds_read_b64_tr_b16 a[58:59], v6 offset:25600
ds_read_b64_tr_b16 a[60:61], v6 offset:28672
ds_read_b64_tr_b16 a[62:63], v6 offset:29696
s_waitcnt lgkmcnt(0)
s_waitcnt vmcnt(26)
s_barrier
s_mov_b32 m0, 135168
s_add_u32 s48, s49, 3932288
buffer_load_dwordx4 v10, s[12:15], s48 offen lds
s_mov_b32 m0, 136192
s_add_u32 s48, s49, 3997824
buffer_load_dwordx4 v10, s[12:15], s48 offen lds
s_mov_b32 m0, 143360
s_add_u32 s48, s49, 4456448
buffer_load_dwordx4 v10, s[12:15], s48 offen lds
s_mov_b32 m0, 144384
s_add_u32 s48, s49, 4521984
buffer_load_dwordx4 v10, s[12:15], s48 offen lds
s_mov_b32 m0, 151552
s_add_u32 s48, s49, 4456576
buffer_load_dwordx4 v10, s[12:15], s48 offen lds
s_mov_b32 m0, 152576
s_add_u32 s48, s49, 4522112
buffer_load_dwordx4 v10, s[12:15], s48 offen lds
s_mov_b32 m0, 159744
s_add_u32 s48, s49, 4980736
buffer_load_dwordx4 v10, s[12:15], s48 offen lds
s_mov_b32 m0, 160768
s_add_u32 s48, s49, 5046272
buffer_load_dwordx4 v10, s[12:15], s48 offen lds
ds_read_b64_tr_b16 a[64:65], v4 offset:0
ds_read_b64_tr_b16 a[66:67], v4 offset:1024
ds_read_b64_tr_b16 a[68:69], v4 offset:4096
ds_read_b64_tr_b16 a[70:71], v4 offset:5120
ds_read_b64_tr_b16 a[72:73], v4 offset:8192
ds_read_b64_tr_b16 a[74:75], v4 offset:9216
ds_read_b64_tr_b16 a[76:77], v4 offset:12288
ds_read_b64_tr_b16 a[78:79], v4 offset:13312
ds_read_b64_tr_b16 a[80:81], v4 offset:16384
ds_read_b64_tr_b16 a[82:83], v4 offset:17408
ds_read_b64_tr_b16 a[84:85], v4 offset:20480
ds_read_b64_tr_b16 a[86:87], v4 offset:21504
ds_read_b64_tr_b16 a[88:89], v4 offset:24576
ds_read_b64_tr_b16 a[90:91], v4 offset:25600
ds_read_b64_tr_b16 a[92:93], v4 offset:28672
ds_read_b64_tr_b16 a[94:95], v4 offset:29696
s_waitcnt lgkmcnt(0)
s_waitcnt vmcnt(24)
s_barrier
s_mov_b32 m0, 4096
s_add_u32 s48, s49, 4980864
buffer_load_dwordx4 v10, s[12:15], s48 offen lds
s_mov_b32 m0, 5120
s_add_u32 s48, s49, 5046400
buffer_load_dwordx4 v10, s[12:15], s48 offen lds
s_mov_b32 m0, 12288
s_add_u32 s48, s49, 3407872
buffer_load_dwordx4 v10, s[16:19], s48 offen lds
s_mov_b32 m0, 13312
s_add_u32 s48, s49, 3473408
buffer_load_dwordx4 v10, s[16:19], s48 offen lds
s_mov_b32 m0, 20480
s_add_u32 s48, s49, 3408000
buffer_load_dwordx4 v10, s[16:19], s48 offen lds
s_mov_b32 m0, 21504
s_add_u32 s48, s49, 3473536
buffer_load_dwordx4 v10, s[16:19], s48 offen lds
s_mov_b32 m0, 28672
s_add_u32 s48, s49, 3932160
buffer_load_dwordx4 v10, s[16:19], s48 offen lds
s_mov_b32 m0, 29696
s_add_u32 s48, s49, 3997696
buffer_load_dwordx4 v10, s[16:19], s48 offen lds
ds_read_b64_tr_b16 a[96:97], v4 offset:32768
ds_read_b64_tr_b16 a[98:99], v4 offset:33792
ds_read_b64_tr_b16 a[100:101], v4 offset:36864
ds_read_b64_tr_b16 a[102:103], v4 offset:37888
ds_read_b64_tr_b16 a[104:105], v4 offset:40960
ds_read_b64_tr_b16 a[106:107], v4 offset:41984
ds_read_b64_tr_b16 a[108:109], v4 offset:45056
ds_read_b64_tr_b16 a[110:111], v4 offset:46080
ds_read_b64_tr_b16 a[216:217], v4 offset:49152
ds_read_b64_tr_b16 a[218:219], v4 offset:50176
ds_read_b64_tr_b16 a[220:221], v4 offset:53248
ds_read_b64_tr_b16 a[222:223], v4 offset:54272
ds_read_b64_tr_b16 a[224:225], v4 offset:57344
ds_read_b64_tr_b16 a[226:227], v4 offset:58368
ds_read_b64_tr_b16 a[228:229], v4 offset:61440
ds_read_b64_tr_b16 a[230:231], v4 offset:62464
s_waitcnt lgkmcnt(0)
s_waitcnt vmcnt(24)
s_barrier
s_mov_b32 m0, 36864
s_add_u32 s48, s49, 3932288
buffer_load_dwordx4 v10, s[16:19], s48 offen lds
s_mov_b32 m0, 37888
s_add_u32 s48, s49, 3997824
buffer_load_dwordx4 v10, s[16:19], s48 offen lds
s_mov_b32 m0, 45056
s_add_u32 s48, s49, 4456448
buffer_load_dwordx4 v10, s[16:19], s48 offen lds
s_mov_b32 m0, 46080
s_add_u32 s48, s49, 4521984
buffer_load_dwordx4 v10, s[16:19], s48 offen lds
s_mov_b32 m0, 53248
s_add_u32 s48, s49, 4456576
buffer_load_dwordx4 v10, s[16:19], s48 offen lds
s_mov_b32 m0, 54272
s_add_u32 s48, s49, 4522112
buffer_load_dwordx4 v10, s[16:19], s48 offen lds
s_mov_b32 m0, 61440
s_add_u32 s48, s49, 4980736
buffer_load_dwordx4 v10, s[16:19], s48 offen lds
s_mov_b32 m0, 62464
s_add_u32 s48, s49, 5046272
buffer_load_dwordx4 v10, s[16:19], s48 offen lds
ds_read_b64_tr_b16 a[232:233], v5 offset:0
ds_read_b64_tr_b16 a[234:235], v5 offset:1024
ds_read_b64_tr_b16 a[236:237], v5 offset:4096
ds_read_b64_tr_b16 a[238:239], v5 offset:5120
ds_read_b64_tr_b16 a[184:185], v5 offset:8192
ds_read_b64_tr_b16 a[186:187], v5 offset:9216
ds_read_b64_tr_b16 a[188:189], v5 offset:12288
ds_read_b64_tr_b16 a[190:191], v5 offset:13312
ds_read_b64_tr_b16 a[192:193], v5 offset:16384
ds_read_b64_tr_b16 a[194:195], v5 offset:17408
ds_read_b64_tr_b16 a[196:197], v5 offset:20480
ds_read_b64_tr_b16 a[198:199], v5 offset:21504
ds_read_b64_tr_b16 v[248:249], v5 offset:24576
ds_read_b64_tr_b16 v[250:251], v5 offset:25600
ds_read_b64_tr_b16 v[252:253], v5 offset:28672
ds_read_b64_tr_b16 v[254:255], v5 offset:29696
s_waitcnt lgkmcnt(0)
s_waitcnt vmcnt(24)
s_barrier
s_mov_b32 m0, 69632
s_add_u32 s48, s49, 4980864
buffer_load_dwordx4 v10, s[16:19], s48 offen lds
s_mov_b32 m0, 70656
s_add_u32 s48, s49, 5046400
buffer_load_dwordx4 v10, s[16:19], s48 offen lds
s_mov_b32 m0, 77824
s_add_u32 s48, s50, 81920
buffer_load_dwordx4 v11, s[20:23], s48 offen lds
s_mov_b32 m0, 78848
s_add_u32 s48, s50, 87040
buffer_load_dwordx4 v11, s[20:23], s48 offen lds
s_mov_b32 m0, 86016
s_add_u32 s48, s50, 102400
buffer_load_dwordx4 v11, s[20:23], s48 offen lds
s_mov_b32 m0, 87040
s_add_u32 s48, s50, 107520
buffer_load_dwordx4 v11, s[20:23], s48 offen lds
s_mov_b32 m0, 94208
s_add_u32 s48, s50, 122880
buffer_load_dwordx4 v11, s[20:23], s48 offen lds
s_mov_b32 m0, 95232
s_add_u32 s48, s50, 128000
buffer_load_dwordx4 v11, s[20:23], s48 offen lds
ds_read_b64_tr_b16 a[200:201], v5 offset:32768
ds_read_b64_tr_b16 a[202:203], v5 offset:33792
ds_read_b64_tr_b16 a[204:205], v5 offset:36864
ds_read_b64_tr_b16 a[206:207], v5 offset:37888
ds_read_b64_tr_b16 v[80:81], v5 offset:40960
ds_read_b64_tr_b16 v[82:83], v5 offset:41984
ds_read_b64_tr_b16 v[84:85], v5 offset:45056
ds_read_b64_tr_b16 v[86:87], v5 offset:46080
ds_read_b64_tr_b16 v[88:89], v5 offset:49152
ds_read_b64_tr_b16 v[90:91], v5 offset:50176
ds_read_b64_tr_b16 v[92:93], v5 offset:53248
ds_read_b64_tr_b16 v[94:95], v5 offset:54272
ds_read_b64_tr_b16 v[96:97], v5 offset:57344
ds_read_b64_tr_b16 v[98:99], v5 offset:58368
ds_read_b64_tr_b16 v[100:101], v5 offset:61440
ds_read_b64_tr_b16 v[102:103], v5 offset:62464
s_waitcnt lgkmcnt(0)
s_waitcnt vmcnt(24)
s_barrier
s_mov_b32 m0, 102400
s_add_u32 s48, s50, 143360
buffer_load_dwordx4 v11, s[20:23], s48 offen lds
s_mov_b32 m0, 103424
s_add_u32 s48, s50, 148480
buffer_load_dwordx4 v11, s[20:23], s48 offen lds
s_mov_b32 m0, 110592
s_add_u32 s48, s50, 82176
buffer_load_dwordx4 v11, s[20:23], s48 offen lds
s_mov_b32 m0, 111616
s_add_u32 s48, s50, 87296
buffer_load_dwordx4 v11, s[20:23], s48 offen lds
s_mov_b32 m0, 118784
s_add_u32 s48, s50, 102656
buffer_load_dwordx4 v11, s[20:23], s48 offen lds
s_mov_b32 m0, 119808
s_add_u32 s48, s50, 107776
buffer_load_dwordx4 v11, s[20:23], s48 offen lds
s_mov_b32 m0, 126976
s_add_u32 s48, s50, 123136
buffer_load_dwordx4 v11, s[20:23], s48 offen lds
s_mov_b32 m0, 128000
s_add_u32 s48, s50, 128256
buffer_load_dwordx4 v11, s[20:23], s48 offen lds
ds_read_b64_tr_b16 v[104:105], v6 offset:0
ds_read_b64_tr_b16 v[106:107], v6 offset:1024
ds_read_b64_tr_b16 v[108:109], v6 offset:4096
ds_read_b64_tr_b16 v[110:111], v6 offset:5120
ds_read_b64_tr_b16 v[240:241], v6 offset:8192
ds_read_b64_tr_b16 v[242:243], v6 offset:9216
ds_read_b64_tr_b16 v[244:245], v6 offset:12288
ds_read_b64_tr_b16 v[246:247], v6 offset:13312
ds_read_b64_tr_b16 a[240:241], v6 offset:16384
ds_read_b64_tr_b16 a[242:243], v6 offset:17408
ds_read_b64_tr_b16 a[244:245], v6 offset:20480
ds_read_b64_tr_b16 a[246:247], v6 offset:21504
ds_read_b64_tr_b16 a[248:249], v6 offset:24576
ds_read_b64_tr_b16 a[250:251], v6 offset:25600
ds_read_b64_tr_b16 a[252:253], v6 offset:28672
ds_read_b64_tr_b16 a[254:255], v6 offset:29696
s_waitcnt lgkmcnt(0)
s_waitcnt vmcnt(24)
s_barrier
s_mov_b32 m0, 135168
s_add_u32 s48, s50, 143616
buffer_load_dwordx4 v11, s[20:23], s48 offen lds
s_mov_b32 m0, 136192
s_add_u32 s48, s50, 148736
buffer_load_dwordx4 v11, s[20:23], s48 offen lds
s_mov_b32 m0, 143360
s_add_u32 s48, s50, 82432
buffer_load_dwordx4 v11, s[20:23], s48 offen lds
s_mov_b32 m0, 144384
s_add_u32 s48, s50, 87552
buffer_load_dwordx4 v11, s[20:23], s48 offen lds
s_mov_b32 m0, 151552
s_add_u32 s48, s50, 102912
buffer_load_dwordx4 v11, s[20:23], s48 offen lds
s_mov_b32 m0, 152576
s_add_u32 s48, s50, 108032
buffer_load_dwordx4 v11, s[20:23], s48 offen lds
s_mov_b32 m0, 159744
s_add_u32 s48, s50, 123392
buffer_load_dwordx4 v11, s[20:23], s48 offen lds
s_mov_b32 m0, 160768
s_add_u32 s48, s50, 128512
buffer_load_dwordx4 v11, s[20:23], s48 offen lds
ds_read_b64_tr_b16 v[72:73], v4 offset:0
ds_read_b64_tr_b16 v[74:75], v4 offset:1024
ds_read_b64_tr_b16 v[76:77], v4 offset:4096
ds_read_b64_tr_b16 v[78:79], v4 offset:5120
ds_read_b64_tr_b16 v[144:145], v4 offset:8192
ds_read_b64_tr_b16 v[146:147], v4 offset:9216
ds_read_b64_tr_b16 v[148:149], v4 offset:12288
ds_read_b64_tr_b16 v[150:151], v4 offset:13312
ds_read_b64_tr_b16 v[152:153], v4 offset:16384
ds_read_b64_tr_b16 v[154:155], v4 offset:17408
ds_read_b64_tr_b16 v[156:157], v4 offset:20480
ds_read_b64_tr_b16 v[158:159], v4 offset:21504
ds_read_b64_tr_b16 v[160:161], v4 offset:24576
ds_read_b64_tr_b16 v[162:163], v4 offset:25600
ds_read_b64_tr_b16 v[164:165], v4 offset:28672
ds_read_b64_tr_b16 v[166:167], v4 offset:29696
s_waitcnt lgkmcnt(0)
s_waitcnt vmcnt(24)
s_barrier
s_mov_b32 m0, 4096
s_add_u32 s48, s50, 143872
buffer_load_dwordx4 v11, s[20:23], s48 offen lds
s_mov_b32 m0, 5120
s_add_u32 s48, s50, 148992
buffer_load_dwordx4 v11, s[20:23], s48 offen lds
s_mov_b32 m0, 12288
s_add_u32 s48, s49, 262144
buffer_load_dwordx4 v10, s[12:15], s48 offen lds
s_mov_b32 m0, 13312
s_add_u32 s48, s49, 327680
buffer_load_dwordx4 v10, s[12:15], s48 offen lds
s_mov_b32 m0, 20480
s_add_u32 s48, s49, 786432
buffer_load_dwordx4 v10, s[12:15], s48 offen lds
s_mov_b32 m0, 21504
s_add_u32 s48, s49, 851968
buffer_load_dwordx4 v10, s[12:15], s48 offen lds
s_mov_b32 m0, 28672
s_add_u32 s48, s49, 1310720
buffer_load_dwordx4 v10, s[12:15], s48 offen lds
s_mov_b32 m0, 29696
s_add_u32 s48, s49, 1376256
buffer_load_dwordx4 v10, s[12:15], s48 offen lds
ds_read_b64_tr_b16 v[168:169], v4 offset:32768
ds_read_b64_tr_b16 v[170:171], v4 offset:33792
ds_read_b64_tr_b16 v[172:173], v4 offset:36864
ds_read_b64_tr_b16 v[174:175], v4 offset:37888
ds_read_b64_tr_b16 v[112:113], v4 offset:40960
ds_read_b64_tr_b16 v[114:115], v4 offset:41984
ds_read_b64_tr_b16 v[116:117], v4 offset:45056
ds_read_b64_tr_b16 v[118:119], v4 offset:46080
ds_read_b64_tr_b16 v[120:121], v4 offset:49152
ds_read_b64_tr_b16 v[122:123], v4 offset:50176
ds_read_b64_tr_b16 v[124:125], v4 offset:53248
ds_read_b64_tr_b16 v[126:127], v4 offset:54272
ds_read_b64_tr_b16 v[128:129], v4 offset:57344
ds_read_b64_tr_b16 v[130:131], v4 offset:58368
ds_read_b64_tr_b16 v[132:133], v4 offset:61440
ds_read_b64_tr_b16 v[134:135], v4 offset:62464
s_waitcnt lgkmcnt(0)
s_waitcnt vmcnt(24)
s_barrier
s_mov_b32 m0, 36864
s_add_u32 s48, s49, 1835008
buffer_load_dwordx4 v10, s[12:15], s48 offen lds
s_mov_b32 m0, 37888
s_add_u32 s48, s49, 1900544
buffer_load_dwordx4 v10, s[12:15], s48 offen lds
s_mov_b32 m0, 45056
s_add_u32 s48, s49, 2359296
buffer_load_dwordx4 v10, s[12:15], s48 offen lds
s_mov_b32 m0, 46080
s_add_u32 s48, s49, 2424832
buffer_load_dwordx4 v10, s[12:15], s48 offen lds
s_mov_b32 m0, 53248
s_add_u32 s48, s49, 2883584
buffer_load_dwordx4 v10, s[12:15], s48 offen lds
s_mov_b32 m0, 54272
s_add_u32 s48, s49, 2949120
buffer_load_dwordx4 v10, s[12:15], s48 offen lds
s_mov_b32 m0, 61440
s_add_u32 s48, s49, 1310848
buffer_load_dwordx4 v10, s[16:19], s48 offen lds
s_mov_b32 m0, 62464
s_add_u32 s48, s49, 1376384
buffer_load_dwordx4 v10, s[16:19], s48 offen lds
ds_read_b64_tr_b16 v[136:137], v5 offset:0
ds_read_b64_tr_b16 v[138:139], v5 offset:1024
ds_read_b64_tr_b16 v[140:141], v5 offset:4096
ds_read_b64_tr_b16 v[142:143], v5 offset:5120
ds_read_b64_tr_b16 v[184:185], v8 offset:8192
ds_read_b64_tr_b16 v[186:187], v8 offset:8704
ds_read_b64_tr_b16 v[188:189], v8 offset:10240
ds_read_b64_tr_b16 v[190:191], v8 offset:10752
ds_read_b64_tr_b16 v[192:193], v8 offset:16384
ds_read_b64_tr_b16 v[194:195], v8 offset:16896
ds_read_b64_tr_b16 v[196:197], v8 offset:18432
ds_read_b64_tr_b16 v[198:199], v8 offset:18944
v_xor_b32 v12, v15, v8
ds_read_b64_tr_b16 v[40:41], v12 offset:24576
ds_read_b64_tr_b16 v[42:43], v12 offset:25088
ds_read_b64_tr_b16 v[44:45], v12 offset:26624
ds_read_b64_tr_b16 v[46:47], v12 offset:27136
s_waitcnt lgkmcnt(0)
buffer_store_dwordx4 v[40:43], v0, s[4:7], s61 offen offset:0
buffer_store_dwordx4 v[44:47], v0, s[4:7], s61 offen offset:1024
s_waitcnt vmcnt(26)
s_barrier
s_mov_b32 m0, 69632
s_add_u32 s48, s49, 1835136
buffer_load_dwordx4 v10, s[16:19], s48 offen lds
s_mov_b32 m0, 70656
s_add_u32 s48, s49, 1900672
buffer_load_dwordx4 v10, s[16:19], s48 offen lds
s_mov_b32 m0, 77824
s_add_u32 s48, s49, 2359424
buffer_load_dwordx4 v10, s[16:19], s48 offen lds
s_mov_b32 m0, 78848
s_add_u32 s48, s49, 2424960
buffer_load_dwordx4 v10, s[16:19], s48 offen lds
s_mov_b32 m0, 86016
s_add_u32 s48, s49, 2883712
buffer_load_dwordx4 v10, s[16:19], s48 offen lds
s_mov_b32 m0, 87040
s_add_u32 s48, s49, 2949248
buffer_load_dwordx4 v10, s[16:19], s48 offen lds
s_mov_b32 m0, 94208
s_add_u32 s48, s50, 82688
buffer_load_dwordx4 v11, s[20:23], s48 offen lds
s_mov_b32 m0, 95232
s_add_u32 s48, s50, 87808
buffer_load_dwordx4 v11, s[20:23], s48 offen lds
ds_read_b64_tr_b16 v[176:177], v8 offset:32768
ds_read_b64_tr_b16 v[178:179], v8 offset:33280
ds_read_b64_tr_b16 v[180:181], v8 offset:34816
ds_read_b64_tr_b16 v[182:183], v8 offset:35328
ds_read_b64_tr_b16 v[232:233], v8 offset:40960
ds_read_b64_tr_b16 v[234:235], v8 offset:41472
ds_read_b64_tr_b16 v[236:237], v8 offset:43008
ds_read_b64_tr_b16 v[238:239], v8 offset:43520
ds_read_b64_tr_b16 v[32:33], v8 offset:49152
ds_read_b64_tr_b16 v[34:35], v8 offset:49664
ds_read_b64_tr_b16 v[36:37], v8 offset:51200
ds_read_b64_tr_b16 v[38:39], v8 offset:51712
v_xor_b32 v12, v15, v8
ds_read_b64_tr_b16 v[40:41], v12 offset:57344
ds_read_b64_tr_b16 v[42:43], v12 offset:57856
ds_read_b64_tr_b16 v[44:45], v12 offset:59392
ds_read_b64_tr_b16 v[46:47], v12 offset:59904
s_waitcnt lgkmcnt(0)
buffer_store_dwordx4 v[32:35], v0, s[4:7], s62 offen offset:0
buffer_store_dwordx4 v[36:39], v0, s[4:7], s62 offen offset:1024
buffer_store_dwordx4 v[40:43], v0, s[4:7], s61 offen offset:2048
buffer_store_dwordx4 v[44:47], v0, s[4:7], s61 offen offset:3072
s_waitcnt vmcnt(30)
s_barrier
s_mov_b32 m0, 102400
s_add_u32 s48, s50, 103168
buffer_load_dwordx4 v11, s[20:23], s48 offen lds
s_mov_b32 m0, 103424
s_add_u32 s48, s50, 108288
buffer_load_dwordx4 v11, s[20:23], s48 offen lds
s_mov_b32 m0, 110592
s_add_u32 s48, s50, 123648
buffer_load_dwordx4 v11, s[20:23], s48 offen lds
s_mov_b32 m0, 111616
s_add_u32 s48, s50, 128768
buffer_load_dwordx4 v11, s[20:23], s48 offen lds
s_mov_b32 m0, 118784
s_add_u32 s48, s50, 144128
buffer_load_dwordx4 v11, s[20:23], s48 offen lds
s_mov_b32 m0, 119808
s_add_u32 s48, s50, 149248
buffer_load_dwordx4 v11, s[20:23], s48 offen lds
s_mov_b32 m0, 126976
s_add_u32 s48, s50, 82944
buffer_load_dwordx4 v11, s[20:23], s48 offen lds
s_mov_b32 m0, 128000
s_add_u32 s48, s50, 88064
buffer_load_dwordx4 v11, s[20:23], s48 offen lds
ds_read_b64_tr_b16 a[208:209], v9 offset:0
ds_read_b64_tr_b16 a[210:211], v9 offset:512
ds_read_b64_tr_b16 a[212:213], v9 offset:2048
ds_read_b64_tr_b16 a[214:215], v9 offset:2560
ds_read_b64_tr_b16 v[208:209], v9 offset:8192
ds_read_b64_tr_b16 v[210:211], v9 offset:8704
ds_read_b64_tr_b16 v[212:213], v9 offset:10240
ds_read_b64_tr_b16 v[214:215], v9 offset:10752
ds_read_b64_tr_b16 v[216:217], v9 offset:16384
ds_read_b64_tr_b16 v[218:219], v9 offset:16896
ds_read_b64_tr_b16 v[220:221], v9 offset:18432
ds_read_b64_tr_b16 v[222:223], v9 offset:18944
v_xor_b32 v12, v15, v9
ds_read_b64_tr_b16 v[200:201], v12 offset:24576
ds_read_b64_tr_b16 v[202:203], v12 offset:25088
ds_read_b64_tr_b16 v[204:205], v12 offset:26624
ds_read_b64_tr_b16 v[206:207], v12 offset:27136
s_waitcnt lgkmcnt(0)
s_waitcnt vmcnt(36)
s_barrier
s_mov_b32 m0, 135168
s_add_u32 s48, s50, 103424
buffer_load_dwordx4 v11, s[20:23], s48 offen lds
s_mov_b32 m0, 136192
s_add_u32 s48, s50, 108544
buffer_load_dwordx4 v11, s[20:23], s48 offen lds
s_mov_b32 m0, 143360
s_add_u32 s48, s50, 123904
buffer_load_dwordx4 v11, s[20:23], s48 offen lds
s_mov_b32 m0, 144384
s_add_u32 s48, s50, 129024
buffer_load_dwordx4 v11, s[20:23], s48 offen lds
s_mov_b32 m0, 151552
s_add_u32 s48, s50, 144384
buffer_load_dwordx4 v11, s[20:23], s48 offen lds
s_mov_b32 m0, 152576
s_add_u32 s48, s50, 149504
buffer_load_dwordx4 v11, s[20:23], s48 offen lds
s_mov_b32 m0, 159744
s_add_u32 s48, s49, 3407872
buffer_load_dwordx4 v10, s[8:11], s48 offen lds
s_mov_b32 m0, 160768
s_add_u32 s48, s49, 3473408
buffer_load_dwordx4 v10, s[8:11], s48 offen lds
ds_read_b64_tr_b16 v[16:17], v7 offset:0
ds_read_b64_tr_b16 v[18:19], v7 offset:512
ds_read_b64_tr_b16 v[20:21], v7 offset:2048
ds_read_b64_tr_b16 v[22:23], v7 offset:2560
s_waitcnt lgkmcnt(0)
buffer_store_dwordx4 v[16:19], v0, s[4:7], s62 offen offset:2048
buffer_store_dwordx4 v[20:23], v0, s[4:7], s62 offen offset:3072
s_waitcnt vmcnt(32)
s_barrier
ds_read_b64_tr_b16 v[16:17], v4 offset:8192
ds_read_b64_tr_b16 v[18:19], v4 offset:9216
ds_read_b64_tr_b16 v[20:21], v4 offset:12288
ds_read_b64_tr_b16 v[22:23], v4 offset:13312
ds_read_b64_tr_b16 v[24:25], v4 offset:16384
ds_read_b64_tr_b16 v[26:27], v4 offset:17408
ds_read_b64_tr_b16 v[28:29], v4 offset:20480
ds_read_b64_tr_b16 v[30:31], v4 offset:21504
ds_read_b64_tr_b16 v[32:33], v4 offset:24576
ds_read_b64_tr_b16 v[34:35], v4 offset:25600
ds_read_b64_tr_b16 v[36:37], v4 offset:28672
ds_read_b64_tr_b16 v[38:39], v4 offset:29696
ds_read_b64_tr_b16 v[40:41], v4 offset:32768
ds_read_b64_tr_b16 v[42:43], v4 offset:33792
ds_read_b64_tr_b16 v[44:45], v4 offset:36864
ds_read_b64_tr_b16 v[46:47], v4 offset:37888
ds_read_b64_tr_b16 v[48:49], v4 offset:40960
ds_read_b64_tr_b16 v[50:51], v4 offset:41984
ds_read_b64_tr_b16 v[52:53], v4 offset:45056
ds_read_b64_tr_b16 v[54:55], v4 offset:46080
ds_read_b64_tr_b16 v[56:57], v4 offset:49152
ds_read_b64_tr_b16 v[58:59], v4 offset:50176
ds_read_b64_tr_b16 v[60:61], v4 offset:53248
ds_read_b64_tr_b16 v[62:63], v4 offset:54272
ds_read_b64_tr_b16 v[64:65], v4 offset:57344
ds_read_b64_tr_b16 v[66:67], v4 offset:58368
ds_read_b64_tr_b16 v[68:69], v4 offset:61440
ds_read_b64_tr_b16 v[70:71], v4 offset:62464
s_waitcnt lgkmcnt(0)
s_barrier
ds_write_b128 v0, v[16:19] offset:36864
ds_write_b128 v0, v[20:23] offset:37888
ds_write_b128 v0, v[24:27] offset:38912
ds_write_b128 v0, v[28:31] offset:39936
ds_write_b128 v0, v[32:35] offset:40960
ds_write_b128 v0, v[36:39] offset:41984
ds_write_b128 v0, v[40:43] offset:43008
ds_write_b128 v0, v[44:47] offset:44032
ds_write_b128 v0, v[48:51] offset:45056
ds_write_b128 v0, v[52:55] offset:46080
ds_write_b128 v0, v[56:59] offset:47104
ds_write_b128 v0, v[60:63] offset:48128
ds_write_b128 v0, v[64:67] offset:49152
ds_write_b128 v0, v[68:71] offset:50176
s_waitcnt lgkmcnt(0)
s_waitcnt vmcnt(8)
s_barrier
ds_read_b64_tr_b16 v[16:17], v8 offset:24576
ds_read_b64_tr_b16 v[18:19], v8 offset:25088
ds_read_b64_tr_b16 v[20:21], v8 offset:26624
ds_read_b64_tr_b16 v[22:23], v8 offset:27136
ds_read_b64_tr_b16 v[24:25], v8 offset:32768
ds_read_b64_tr_b16 v[26:27], v8 offset:33280
ds_read_b64_tr_b16 v[28:29], v8 offset:34816
ds_read_b64_tr_b16 v[30:31], v8 offset:35328
v_xor_b32 v12, v15, v8
ds_read_b64_tr_b16 v[32:33], v12 offset:40960
ds_read_b64_tr_b16 v[34:35], v12 offset:41472
ds_read_b64_tr_b16 v[36:37], v12 offset:43008
ds_read_b64_tr_b16 v[38:39], v12 offset:43520
ds_read_b64_tr_b16 v[40:41], v8 offset:49152
ds_read_b64_tr_b16 v[42:43], v8 offset:49664
ds_read_b64_tr_b16 v[44:45], v8 offset:51200
ds_read_b64_tr_b16 v[46:47], v8 offset:51712
ds_read_b64_tr_b16 v[48:49], v8 offset:57344
ds_read_b64_tr_b16 v[50:51], v8 offset:57856
ds_read_b64_tr_b16 v[52:53], v8 offset:59392
ds_read_b64_tr_b16 v[54:55], v8 offset:59904
ds_read_b64_tr_b16 v[56:57], v9 offset:0
ds_read_b64_tr_b16 v[58:59], v9 offset:512
ds_read_b64_tr_b16 v[60:61], v9 offset:2048
ds_read_b64_tr_b16 v[62:63], v9 offset:2560
s_waitcnt lgkmcnt(0)
s_barrier
ds_write_b128 v2, v[16:19] offset:24576
ds_write_b128 v2, v[20:23] offset:25600
ds_write_b128 v2, v[232:235] offset:26624
ds_write_b128 v2, v[236:239] offset:27648
ds_write_b128 v2, v[224:227] offset:28672
ds_write_b128 v2, v[228:231] offset:29696
ds_write_b128 v2, v[40:43] offset:30720
ds_write_b128 v2, v[44:47] offset:31744
ds_write_b128 v2, v[48:51] offset:32768
ds_write_b128 v2, v[52:55] offset:33792
ds_write_b128 v2, v[248:251] offset:34816
ds_write_b128 v2, v[252:255] offset:35840
s_waitcnt lgkmcnt(0)
v_mov_b32 v232, v24
v_mov_b32 v233, v25
v_mov_b32 v234, v26
v_mov_b32 v235, v27
v_mov_b32 v236, v28
v_mov_b32 v237, v29
v_mov_b32 v238, v30
v_mov_b32 v239, v31
v_mov_b32 v224, v32
v_mov_b32 v225, v33
v_mov_b32 v226, v34
v_mov_b32 v227, v35
v_mov_b32 v228, v36
v_mov_b32 v229, v37
v_mov_b32 v230, v38
v_mov_b32 v231, v39
v_mov_b32 v248, v56
v_mov_b32 v249, v57
v_mov_b32 v250, v58
v_mov_b32 v251, v59
v_mov_b32 v252, v60
v_mov_b32 v253, v61
v_mov_b32 v254, v62
v_mov_b32 v255, v63
s_waitcnt vmcnt(2)
s_barrier
ds_read_b64_tr_b16 v[16:17], v5 offset:0
ds_read_b64_tr_b16 v[18:19], v5 offset:1024
ds_read_b64_tr_b16 v[20:21], v5 offset:4096
ds_read_b64_tr_b16 v[22:23], v5 offset:5120
ds_read_b64_tr_b16 v[24:25], v5 offset:8192
ds_read_b64_tr_b16 v[26:27], v5 offset:9216
ds_read_b64_tr_b16 v[28:29], v5 offset:12288
ds_read_b64_tr_b16 v[30:31], v5 offset:13312
ds_read_b64_tr_b16 v[32:33], v5 offset:16384
ds_read_b64_tr_b16 v[34:35], v5 offset:17408
ds_read_b64_tr_b16 v[36:37], v5 offset:20480
ds_read_b64_tr_b16 v[38:39], v5 offset:21504
v_xor_b32 v12, v15, v9
ds_read_b64_tr_b16 v[40:41], v12 offset:8192
ds_read_b64_tr_b16 v[42:43], v12 offset:8704
ds_read_b64_tr_b16 v[44:45], v12 offset:10240
ds_read_b64_tr_b16 v[46:47], v12 offset:10752
ds_read_b64_tr_b16 v[48:49], v9 offset:16384
ds_read_b64_tr_b16 v[50:51], v9 offset:16896
ds_read_b64_tr_b16 v[52:53], v9 offset:18432
ds_read_b64_tr_b16 v[54:55], v9 offset:18944
ds_read_b64_tr_b16 v[56:57], v6 offset:24576
ds_read_b64_tr_b16 v[58:59], v6 offset:25600
ds_read_b64_tr_b16 v[60:61], v6 offset:28672
ds_read_b64_tr_b16 v[62:63], v6 offset:29696
s_waitcnt lgkmcnt(0)
s_barrier
ds_write_b128 v2, a[176:179] offset:0
ds_write_b128 v2, a[180:183] offset:1024
ds_write_b128 v2, v[24:27] offset:2048
ds_write_b128 v2, v[28:31] offset:3072
ds_write_b128 v2, v[32:35] offset:4096
ds_write_b128 v2, v[36:39] offset:5120
ds_write_b128 v2, v[240:243] offset:6144
ds_write_b128 v2, v[244:247] offset:7168
ds_write_b128 v2, v[48:51] offset:8192
ds_write_b128 v2, v[52:55] offset:9216
ds_write_b128 v2, a[208:211] offset:10240
ds_write_b128 v2, a[212:215] offset:11264
s_waitcnt lgkmcnt(0)
v_accvgpr_write_b32 a176, v16
v_accvgpr_write_b32 a177, v17
v_accvgpr_write_b32 a178, v18
v_accvgpr_write_b32 a179, v19
v_accvgpr_write_b32 a180, v20
v_accvgpr_write_b32 a181, v21
v_accvgpr_write_b32 a182, v22
v_accvgpr_write_b32 a183, v23
v_mov_b32 v240, v40
v_mov_b32 v241, v41
v_mov_b32 v242, v42
v_mov_b32 v243, v43
v_mov_b32 v244, v44
v_mov_b32 v245, v45
v_mov_b32 v246, v46
v_mov_b32 v247, v47
v_accvgpr_write_b32 a208, v56
v_accvgpr_write_b32 a209, v57
v_accvgpr_write_b32 a210, v58
v_accvgpr_write_b32 a211, v59
v_accvgpr_write_b32 a212, v60
v_accvgpr_write_b32 a213, v61
v_accvgpr_write_b32 a214, v62
v_accvgpr_write_b32 a215, v63
s_mov_b32 s90, 0x300003
s_mov_b32 s91, 0x300003
s_mov_b32 s12, 0x3030303
s_mov_b32 s13, 0x3030303
s_mov_b32 s92, 0xc0000c
s_mov_b32 s93, 0xc0000c
s_mov_b32 s14, 0xc0c0c0c
s_mov_b32 s15, 0xc0c0c0c
s_mov_b32 s94, 0x30000300
s_mov_b32 s95, 0x30000300
s_mov_b32 s16, 0x30303030
s_mov_b32 s17, 0x30303030
s_mov_b32 s96, 0xc0000c00
s_mov_b32 s97, 0xc0000c00
s_mov_b32 s18, 0xc0c0c0c0
s_mov_b32 s19, 0xc0c0c0c0
s_mov_b32 s98, 0xff00ff00
s_mov_b32 s99, 0xff00ff00
v_mov_b32 v1, 0x4444
v_mov_b32 v4, 0xeeee
v_cndmask_b32 v1, v1, v4, s[98:99]
v_lshrrev_b32 v4, 8, v0
v_lshl_or_b32 v1, v4, 28, v1
v_bfe_u32 v4, v0, 4, 4
v_lshl_or_b32 v1, v4, 19, v1
s_mov_b32 s51, 0x3e0293ee
s_mov_b32 s52, 0x3f803f80
s_mov_b32 s53, 0x3f803f80
s_mov_b32 s54, 0x3f003f00
s_mov_b32 s55, 0x3f003f00
s_mov_b32 s56, 0xff800000
s_mov_b32 s57, 0xff800000
s_mov_b32 s58, 0x3f80
s_mov_b32 s8, s4
s_mov_b32 s9, s5
s_cmp_eq_u32 s30, 30
s_cselect_b32 s10, s6, 0
s_mov_b32 s31, 0
s_mov_b32 s45, -2
s_lshl_b32 s46, s30, 6
s_add_u32 s46, s46, 222330880
s_mov_b32 s20, s4
s_mov_b32 s21, s5
s_cmp_lt_u32 s30, 10
s_cselect_b32 s22, s6, 0
v_mov_b32 v3, -1
s_lshl_b32 s48, s30, 7
s_and_b32 s49, s30, 31
s_lshl_b32 s49, s49, 12
s_add_u32 s43, s49, 119734272
v_mov_b64 v[12:13], -1
s_add_u32 s38, s48, 119570432
s_add_u32 s39, s48, 119635968
s_add_u32 s40, s48, 119701504
s_add_u32 s41, s48, 119767040
s_add_u32 s42, s48, 119832576
v_lshrrev_b32 v4, 16, v1
buffer_store_dwordx2 v[12:13], v4, s[4:7], s38 offen sc1
buffer_store_dwordx2 v[12:13], v4, s[4:7], s39 offen sc1
buffer_store_dwordx2 v[12:13], v4, s[4:7], s40 offen sc1
buffer_store_dwordx2 v[12:13], v4, s[4:7], s41 offen sc1
buffer_store_dwordx2 v[12:13], v4, s[4:7], s42 offen sc1
s_cmp_lg_u32 s3, 0
s_cbranch_scc1 k_wdd_202
v_mov_b32 v8, 192
k_wd_201:
global_load_dword v9, v8, s[28:29] sc1
s_waitcnt vmcnt(0)
v_readfirstlane_b32 s48, v9
s_cmp_ge_u32 s48, 32
s_cbranch_scc1 k_wdd_202
s_sleep 2
s_sub_u32 s32, s32, 1
s_cmp_gt_i32 s32, 0
s_cbranch_scc1 k_wd_201
k_wdd_202:
s_barrier
k_lay_203:
s_add_u32 s47, s31, 63
s_mov_b32 s33, 120324096
s_mov_b32 s34, 120328192
s_mov_b32 s35, 120332288
s_mul_i32 s48, s31, 655360
s_lshl_b32 s36, s30, 14
s_add_u32 s36, s36, s48
s_add_u32 s36, s36, 8192
v_mov_b32 v12, -1
s_and_b32 s48, s30, 31
s_add_u32 s48, s48, 48
s_lshr_b32 s49, s48, 1
s_and_b32 s48, s48, 1
s_lshl_b32 s44, s49, 8
s_lshl_b32 s50, s48, 6
s_add_u32 s44, s44, s50
s_add_u32 s44, s44, s33
s_mul_i32 s48, s48, 5120
s_lshl_b32 s49, s49, 5
s_add_u32 s48, s48, s49
v_lshrrev_b32 v8, 4, v0
v_and_b32 v9, 3, v8
v_mul_u32_u24 v9, 1280, v9
v_bfe_u32 v10, v8, 2, 1
v_lshl_add_u32 v9, v10, 1, v9
v_bfe_u32 v10, v8, 4, 1
v_lshl_add_u32 v9, v10, 4, v9
v_bfe_u32 v10, v8, 5, 1
v_lshl_add_u32 v9, v10, 2, v9
buffer_load_ushort v10, v9, s[24:27], s48 offen
buffer_load_ushort v11, v9, s[24:27], s48 offen offset:8
v_and_b32 v45, 0x30, v0
v_lshrrev_b32 v46, 8, v0
v_lshl_or_b32 v45, v46, 2, v45
v_bfe_u32 v46, v0, 6, 1
v_lshl_or_b32 v45, v46, 7, v45
v_cndmask_b32 v45, v45, 2.0, s[98:99]
s_waitcnt vmcnt(0)
v_lshl_or_b32 v10, v11, 16, v10
s_lshl_b32 s63, s30, 10
s_add_u32 s63, s63, 120356864
s_lshl_b32 s37, s31, 14
s_add_u32 s37, s37, 117442560
s_add_u32 s59, s37, 4096
s_waitcnt vmcnt(0)
s_barrier
s_barrier
buffer_store_dword v10, v45, s[4:7], s44 offen sc1
s_add_u32 s44, s44, 16384
buffer_store_dword v12, v45, s[4:7], s44 offen sc1
v_mov_b32 v8, 160
global_load_dword v9, v8, s[28:29] sc1
s_waitcnt vmcnt(0)
v_readfirstlane_b32 s64, v9
s_cmp_gt_u32 s64, 0xffff
s_cselect_b32 s64, 0x10000, 0
s_waitcnt vmcnt(0)
s_barrier
s_barrier
v_lshlrev_b32 v23, v0, s58
v_cndmask_b32 v20, 0, v23, s[90:91]
v_cndmask_b32 v21, 0, v23, s[92:93]
v_cndmask_b32 v22, 0, v23, s[94:95]
v_cndmask_b32 v23, 0, v23, s[96:97]
s_cmp_lg_u32 s64, 0
s_cbranch_scc1 k_far_204
s_branch k_cold2_208
k_T0_206:
s_waitcnt vmcnt(2)
v_smfmac_f32_16x16x64_bf16 v[40:43], v[4:7], v[48:55], v1
s_waitcnt vmcnt(1)
v_cmp_u_f32 vcc, v4, v8
v_smfmac_f32_16x16x64_bf16 v[24:27], v[8:11], a[24:31], v1
v_smfmac_f32_16x16x64_bf16 v[28:31], v[8:11], a[32:39], v1
s_cbranch_vccnz k_cold_207
k_okC_209:
s_waitcnt vmcnt(1)
v_smfmac_f32_16x16x64_bf16 v[36:39], v[8:11], a[40:47], v1
s_waitcnt lgkmcnt(0)
ds_read_b128 v[48:51], v2 offset:0
v_smfmac_f32_16x16x64_bf16 v[32:35], v[4:7], v[64:71], v1
ds_read_b128 v[52:55], v2 offset:1024
ds_read_b128 v[64:67], v0 offset:38912
v_smfmac_f32_16x16x64_bf16 v[44:47], v[4:7], v[56:63], v1
ds_read_b128 v[68:71], v0 offset:39936
v_smfmac_f32_16x16x64_bf16 v[28:31], v[4:7], a[8:15], v1
v_smfmac_f32_16x16x64_bf16 v[24:27], v[4:7], a[0:7], v1
ds_read_b128 v[56:59], v2 offset:28672
v_smfmac_f32_16x16x64_bf16 v[36:39], v[4:7], a[16:23], v1
ds_read_b128 v[60:63], v2 offset:29696
s_waitcnt lgkmcnt(4)
v_smfmac_f32_16x16x64_bf16 v[40:43], v[8:11], v[48:55], v1
s_waitcnt vmcnt(0)
ds_write_b128 v0, v[12:15] offset:2048
s_waitcnt lgkmcnt(3)
v_smfmac_f32_16x16x64_bf16 v[32:35], v[8:11], v[64:71], v1
buffer_load_dwordx4 v[16:19], v0, s[4:7], s35 offen offset:0 sc1
v_cmp_u_f32 vcc, v12, v12
s_waitcnt lgkmcnt(1)
v_smfmac_f32_16x16x64_bf16 v[44:47], v[8:11], v[56:63], v1
ds_read_b128 v[56:59], v2 offset:2048
ds_read_b128 v[60:63], v2 offset:3072
ds_read_b128 v[64:67], v0 offset:45056
s_cbranch_vccnz k_coldA_210
k_okA_211:
v_smfmac_f32_16x16x64_bf16 v[36:39], v[12:15], a[64:71], v1
ds_read_b128 v[68:71], v0 offset:46080
s_waitcnt lgkmcnt(4)
v_smfmac_f32_16x16x64_bf16 v[40:43], v[12:15], a[72:79], v1
s_barrier
v_smfmac_f32_16x16x64_bf16 v[28:31], v[12:15], a[56:63], v1
ds_read_b128 v[8:11], v0 offset:3072
buffer_load_dwordx4 v[48:51], v0, s[4:7], s36 offen offset:0 sc1
s_waitcnt lgkmcnt(3)
v_smfmac_f32_16x16x64_bf16 v[44:47], v[12:15], v[56:63], v1
ds_read_b128 v[56:59], v2 offset:4096
v_smfmac_f32_16x16x64_bf16 v[24:27], v[12:15], a[48:55], v1
ds_read_b128 v[60:63], v2 offset:5120
s_waitcnt lgkmcnt(3)
v_smfmac_f32_16x16x64_bf16 v[32:35], v[12:15], v[64:71], v1
buffer_load_dwordx4 v[52:55], v0, s[4:7], s36 offen offset:1024 sc1
s_waitcnt lgkmcnt(2)
v_smfmac_f32_16x16x64_bf16 v[24:27], v[8:11], a[80:87], v1
ds_read_b128 v[64:67], v0 offset:47104
ds_read_b128 v[68:71], v0 offset:48128
v_smfmac_f32_16x16x64_bf16 v[36:39], v[8:11], a[96:103], v1
buffer_store_dword v3, v0, s[20:23], s63 offen
s_waitcnt lgkmcnt(2)
ds_read_b128 v[4:7], v0 offset:0
v_smfmac_f32_16x16x64_bf16 v[44:47], v[8:11], v[56:63], v1
ds_read_b128 v[56:59], v0 offset:49152
ds_read_b128 v[60:63], v0 offset:50176
v_smfmac_f32_16x16x64_bf16 v[28:31], v[8:11], a[88:95], v1
buffer_store_dwordx4 v[12:15], v0, s[8:11], s37 offen offset:2048 sc1
v_smfmac_f32_16x16x64_bf16 v[40:43], v[8:11], a[104:111], v1
s_waitcnt lgkmcnt(3)
s_waitcnt lgkmcnt(2)
v_smfmac_f32_16x16x64_bf16 v[32:35], v[8:11], v[64:71], v1
ds_read_b128 v[64:67], v0 offset:40960
ds_read_b128 v[12:15], v0 offset:1024
v_smfmac_f32_16x16x64_bf16 v[36:39], v[4:7], a[128:135], v1
s_waitcnt lgkmcnt(2)
v_smfmac_f32_16x16x64_bf16 v[44:47], v[4:7], v[56:63], v1
ds_read_b128 v[68:71], v0 offset:41984
buffer_load_dwordx4 v[56:59], v0, s[4:7], s36 offen offset:2048 sc1
v_smfmac_f32_16x16x64_bf16 v[28:31], v[4:7], a[120:127], v1
v_smfmac_f32_16x16x64_bf16 v[24:27], v[4:7], a[112:119], v1
s_waitcnt vmcnt(5)
ds_write_b128 v0, v[16:19] offset:6144
v_smfmac_f32_16x16x64_bf16 v[40:43], v[4:7], a[136:143], v1
s_waitcnt lgkmcnt(1)
buffer_load_dwordx4 v[60:63], v0, s[4:7], s36 offen offset:3072 sc1
v_cmp_u_f32 vcc, v16, v16
v_smfmac_f32_16x16x64_bf16 v[32:35], v[4:7], v[64:71], v1
ds_read_b128 v[64:67], v0 offset:43008
ds_read_b128 v[68:71], v0 offset:44032
v_smfmac_f32_16x16x64_bf16 v[28:31], v[12:15], a[152:159], v1
v_smfmac_f32_16x16x64_bf16 v[24:27], v[12:15], a[144:151], v1
s_cbranch_vccnz k_coldB_212
k_okB_213:
v_smfmac_f32_16x16x64_bf16 v[36:39], v[12:15], a[160:167], v1
s_waitcnt lgkmcnt(2)
buffer_store_dwordx4 v[16:19], v0, s[8:11], s59 offen offset:2048 sc1
s_barrier
ds_read_b128 v[4:7], v0 offset:4096
v_smfmac_f32_16x16x64_bf16 v[44:47], v[12:15], a[176:183], v1
ds_read_b128 v[8:11], v0 offset:7168
s_waitcnt lgkmcnt(2)
v_smfmac_f32_16x16x64_bf16 v[32:35], v[12:15], v[64:71], v1
ds_read_b128 v[64:67], v2 offset:34816
ds_read_b128 v[68:71], v2 offset:35840
v_smfmac_f32_16x16x64_bf16 v[24:27], v[16:19], a[184:191], v1
v_smfmac_f32_16x16x64_bf16 v[40:43], v[12:15], a[168:175], v1
s_waitcnt lgkmcnt(3)
ds_read_b128 v[12:15], v0 offset:5120
v_smfmac_f32_16x16x64_bf16 v[24:27], v[4:7], a[208:215], v1
s_waitcnt lgkmcnt(3)
v_smfmac_f32_16x16x64_bf16 v[28:31], v[4:7], a[216:223], v1
v_smfmac_f32_16x16x64_bf16 v[28:31], v[8:11], a[200:207], v1
s_waitcnt lgkmcnt(1)
v_smfmac_f32_16x16x64_bf16 v[24:27], v[8:11], v[64:71], v1
ds_read_b128 v[64:67], v2 offset:6144
s_waitcnt lgkmcnt(1)
v_smfmac_f32_16x16x64_bf16 v[24:27], v[12:15], a[224:231], v1
ds_read_b128 v[68:71], v2 offset:7168
v_smfmac_f32_16x16x64_bf16 v[28:31], v[12:15], a[232:239], v1
v_smfmac_f32_16x16x64_bf16 v[28:31], v[16:19], a[192:199], v1
v_cvt_pk_bf16_f32 v24, v24, v25
v_cvt_pk_bf16_f32 v25, v26, v27
v_smfmac_f32_16x16x64_bf16 v[32:35], v[4:7], v[80:87], v1
v_cvt_pk_bf16_f32 v26, v28, v29
v_cvt_pk_bf16_f32 v27, v30, v31
v_smfmac_f32_16x16x64_bf16 v[32:35], v[8:11], a[248:255], v1
s_waitcnt lgkmcnt(0)
v_mfma_f32_16x16x32_bf16 v[28:31], v[24:27], v[20:23], 0
v_and_b32 v26, 0xffffff7f, v0
v_smfmac_f32_16x16x64_bf16 v[32:35], v[16:19], v[64:71], v1
v_and_or_b32 v26, v1, 8, v26
v_mul_f32 v28, s51, v28
v_mul_f32 v29, s51, v29
v_mul_f32 v31, s51, v31
v_cvt_pk_bf16_f32 v24, v28, v29
v_mul_f32 v30, s51, v30
v_cvt_pk_bf16_f32 v25, v30, v31
v_smfmac_f32_16x16x64_bf16 v[32:35], v[12:15], v[96:103], v1
ds_write_b64 v26, v[24:25] offset:1024
v_smfmac_f32_16x16x64_bf16 v[36:39], v[8:11], v[72:79], v1
v_cvt_pk_bf16_f32 v32, v32, v33
v_smfmac_f32_16x16x64_bf16 v[36:39], v[16:19], a[240:247], v1
buffer_load_dwordx4 v[64:67], v0, s[4:7], s61 offen offset:0
v_cvt_pk_bf16_f32 v33, v34, v35
v_smfmac_f32_16x16x64_bf16 v[36:39], v[12:15], v[104:111], v1
s_waitcnt lgkmcnt(0)
v_smfmac_f32_16x16x64_bf16 v[36:39], v[4:7], v[88:95], v1
s_barrier
ds_read_b128 v[24:27], v0 offset:0
v_smfmac_f32_16x16x64_bf16 v[40:43], v[4:7], v[144:151], v1
ds_read_b128 v[28:31], v0 offset:1024
s_nop 0
v_cvt_pk_bf16_f32 v34, v36, v37
v_cvt_pk_bf16_f32 v35, v38, v39
s_nop 1
v_mfma_f32_16x16x32_bf16 v[36:39], v[32:35], v[20:23], 0
s_waitcnt vmcnt(6)
buffer_load_dwordx4 v[68:71], v0, s[4:7], s61 offen offset:1024
v_and_b32 v34, 0xffffff7f, v0
v_and_or_b32 v34, v1, 8, v34
s_waitcnt lgkmcnt(1)
v_mfma_f32_16x16x32_bf16 v[48:51], v[48:51], v[24:27], 0
v_cvt_pk_bf16_f32 v32, v36, v37
s_waitcnt lgkmcnt(0)
v_mfma_f32_16x16x32_bf16 v[48:51], v[52:55], v[28:31], v[48:51]
v_mov_b64 v[52:53], s[56:57]
v_cvt_pk_bf16_f32 v33, v38, v39
v_smfmac_f32_16x16x64_bf16 v[44:47], v[4:7], v[152:159], v1
ds_write_b64 v34, v[32:33] offset:3072
v_permlane32_swap_b32 v48, v50
v_permlane32_swap_b32 v49, v51
v_add_f32_dpp v52, v50, v48 row_ror:8 row_mask:0xf bank_mask:0x3
v_exp_f32 v52, v52
v_add_f32_dpp v53, v51, v49 row_ror:8 row_mask:0xf bank_mask:0x3
v_exp_f32 v53, v53
s_nop 0
v_cvt_pk_bf16_f32 v48, v52, v53
v_smfmac_f32_16x16x64_bf16 v[44:47], v[16:19], v[120:127], v1
ds_write_b32 v0, v48 offset:4104
v_smfmac_f32_16x16x64_bf16 v[44:47], v[12:15], v[168:175], v1
buffer_load_dwordx4 v[48:51], v0, s[4:7], s61 offen offset:2048
v_smfmac_f32_16x16x64_bf16 v[40:43], v[12:15], v[160:167], v1
s_waitcnt lgkmcnt(1)
v_xor_b32 v12, 0x80, v0
v_smfmac_f32_16x16x64_bf16 v[40:43], v[8:11], v[128:135], v1
s_waitcnt lgkmcnt(0)
s_barrier
ds_read_b128 v[32:35], v0 offset:2048
v_mov_b64 v[22:23], s[52:53]
v_smfmac_f32_16x16x64_bf16 v[40:43], v[16:19], v[112:119], v1
ds_read_b128 v[36:39], v0 offset:3072
ds_read_b128 v[16:19], v0 offset:4096
buffer_load_dwordx4 v[52:55], v0, s[4:7], s61 offen offset:3072
v_smfmac_f32_16x16x64_bf16 v[44:47], v[8:11], v[136:143], v1
ds_read_b128 v[12:15], v12 offset:4096
v_cvt_pk_bf16_f32 v40, v40, v41
v_mov_b64 v[20:21], s[52:53]
s_waitcnt lgkmcnt(3)
v_mfma_f32_16x16x32_bf16 v[24:27], v[32:35], v[24:27], 0
v_cvt_pk_bf16_f32 v41, v42, v43
s_waitcnt lgkmcnt(2)
v_mfma_f32_16x16x32_bf16 v[24:27], v[36:39], v[28:31], v[24:27]
s_waitcnt vmcnt(5)
s_waitcnt lgkmcnt(1)
v_mfma_f32_16x16x32_bf16 v[8:11], v[56:59], v[16:19], 0
buffer_load_dwordx4 v[56:59], v0, s[4:7], s62 offen offset:0
v_mov_b64 v[28:29], s[56:57]
v_cvt_pk_bf16_f32 v43, v46, v47
v_cvt_pk_bf16_f32 v42, v44, v45
v_permlane32_swap_b32 v25, v27
v_permlane32_swap_b32 v24, v26
v_mfma_f32_16x16x32_bf16 v[4:7], v[20:23], v[16:19], 0
s_waitcnt lgkmcnt(0)
v_add_f32_dpp v28, v26, v24 row_ror:8 row_mask:0xf bank_mask:0x3
v_add_f32_dpp v29, v27, v25 row_ror:8 row_mask:0xf bank_mask:0x3
v_exp_f32 v28, v28
v_mfma_f32_16x16x32_bf16 v[8:11], v[60:63], v[12:15], v[8:11]
buffer_load_dwordx4 v[60:63], v0, s[4:7], s62 offen offset:1024
v_exp_f32 v29, v29
v_permlane32_swap_b32 v42, v43
v_cvt_pk_bf16_f32 v24, v28, v29
v_mov_b64 v[44:45], s[54:55]
v_cvt_pk_bf16_f32 v25, v28, v29
v_mov_b32_dpp v26, v24 row_ror:8 row_mask:0xf bank_mask:0xf
v_mov_b32_dpp v27, v24 row_ror:8 row_mask:0xf bank_mask:0xf
v_mfma_f32_16x16x16_bf16 v[4:7], v[44:45], v[24:25], v[4:7]
v_permlane32_swap_b32 v40, v41
v_mov_b64 v[36:37], 0
v_mov_b64 v[38:39], 0
v_mov_b64 v[30:31], 0
v_mfma_f32_16x16x32_bf16 v[8:11], v[40:43], v[24:27], v[8:11]
buffer_load_dwordx4 v[16:19], v0, s[4:7], s62 offen offset:2048
v_rcp_f32 v6, v4
v_and_b32 v12, 0xffffff7f, v0
v_and_or_b32 v13, v1, 8, v12
v_rcp_f32_dpp v6, v4 row_ror:8 row_mask:0xf bank_mask:0xc
v_mov_b64 v[26:27], 0
v_pk_mul_f32 v[8:9], v[8:9], v[6:7] op_sel_hi:[1,0]
v_cvt_pk_bf16_f32 v44, v8, v9
v_pk_mul_f32 v[10:11], v[10:11], v[6:7] op_sel_hi:[1,0]
v_cvt_pk_bf16_f32 v45, v10, v11
s_waitcnt vmcnt(5)
ds_write_b64 v13, v[44:45] offset:7168
buffer_load_dwordx4 v[20:23], v0, s[4:7], s62 offen offset:3072
v_add_u32 v6, 0xd4800000, v6
v_cmp_lt_u32 vcc, 0x28000000, v6
v_mov_b64 v[34:35], 0
v_mov_b32_dpp v46, v44 row_ror:8 row_mask:0xf bank_mask:0xf
v_mov_b32_dpp v47, v45 row_ror:8 row_mask:0xf bank_mask:0xf
v_mov_b64 v[28:29], 0
v_mov_b64 v[32:33], 0
s_cbranch_vccnz k_slow_214
k_okS_215:
v_smfmac_f32_16x16x64_bf16 v[36:39], v[44:47], v[224:231], v1
s_waitcnt lgkmcnt(0)
s_barrier
ds_read_b128 v[8:11], v12 offset:6144
v_smfmac_f32_16x16x64_bf16 v[32:35], v[44:47], v[200:207], v1
s_waitcnt vmcnt(4)
ds_read_b128 v[4:7], v12 offset:7296
v_mov_b64 v[24:25], 0
v_smfmac_f32_16x16x64_bf16 v[28:31], v[44:47], v[48:55], v1
ds_read_b128 v[12:15], v12 offset:6272
ds_read_b128 v[48:51], v2 offset:26624
v_smfmac_f32_16x16x64_bf16 v[24:27], v[44:47], v[64:71], v1
ds_read_b128 v[52:55], v2 offset:27648
v_mov_b64 v[42:43], 0
s_waitcnt lgkmcnt(4)
v_smfmac_f32_16x16x64_bf16 v[24:27], v[8:11], v[184:191], v1
s_waitcnt lgkmcnt(3)
v_mov_b64 v[40:41], 0
v_smfmac_f32_16x16x64_bf16 v[24:27], v[4:7], v[176:183], v1
s_waitcnt lgkmcnt(2)
ds_read_b128 v[64:67], v2 offset:10240
v_smfmac_f32_16x16x64_bf16 v[24:27], v[12:15], v[192:199], v1
ds_read_b128 v[68:71], v2 offset:11264
v_smfmac_f32_16x16x64_bf16 v[40:43], v[44:47], v[240:247], v1
s_waitcnt vmcnt(2)
s_waitcnt lgkmcnt(2)
v_lshrrev_b32 v44, 16, v1
v_cvt_pk_bf16_f32 v24, v24, v25
v_bfi_b32 v24, 1, s45, v24
v_cvt_pk_bf16_f32 v25, v26, v27
v_smfmac_f32_16x16x64_bf16 v[28:31], v[8:11], v[48:55], v1
buffer_store_dwordx2 v[24:25], v44, s[4:7], s38 offen
ds_read_b128 v[48:51], v2 offset:24576
ds_read_b128 v[52:55], v2 offset:25600
v_smfmac_f32_16x16x64_bf16 v[28:31], v[12:15], v[56:63], v1
s_waitcnt lgkmcnt(2)
ds_read_b128 v[56:59], v2 offset:8192
v_smfmac_f32_16x16x64_bf16 v[28:31], v[4:7], v[64:71], v1
ds_read_b128 v[60:63], v2 offset:9216
v_smfmac_f32_16x16x64_bf16 v[32:35], v[8:11], v[208:215], v1
ds_read_b128 v[64:67], v2 offset:30720
s_nop 0
v_cvt_pk_bf16_f32 v28, v28, v29
v_bfi_b32 v28, 1, s45, v28
v_cvt_pk_bf16_f32 v29, v30, v31
v_smfmac_f32_16x16x64_bf16 v[32:35], v[12:15], v[216:223], v1
buffer_store_dwordx2 v[28:29], v44, s[4:7], s39 offen
v_smfmac_f32_16x16x64_bf16 v[40:43], v[12:15], v[248:255], v1
ds_read_b128 v[68:71], v2 offset:31744
s_waitcnt vmcnt(2)
v_smfmac_f32_16x16x64_bf16 v[32:35], v[4:7], v[16:23], v1
s_waitcnt lgkmcnt(2)
v_smfmac_f32_16x16x64_bf16 v[36:39], v[12:15], v[232:239], v1
ds_read_b128 v[16:19], v2 offset:32768
ds_read_b128 v[20:23], v2 offset:33792
v_cvt_pk_bf16_f32 v32, v32, v33
v_bfi_b32 v32, 1, s45, v32
v_cvt_pk_bf16_f32 v33, v34, v35
v_smfmac_f32_16x16x64_bf16 v[36:39], v[8:11], v[48:55], v1
buffer_store_dwordx2 v[32:33], v44, s[4:7], s40 offen
s_waitcnt lgkmcnt(2)
v_smfmac_f32_16x16x64_bf16 v[36:39], v[4:7], v[64:71], v1
s_nop 6
v_cvt_pk_bf16_f32 v36, v36, v37
v_cvt_pk_bf16_f32 v37, v38, v39
s_waitcnt lgkmcnt(0)
v_bfi_b32 v36, 1, s45, v36
v_smfmac_f32_16x16x64_bf16 v[40:43], v[8:11], v[16:23], v1
buffer_store_dwordx2 v[36:37], v44, s[4:7], s41 offen
v_smfmac_f32_16x16x64_bf16 v[40:43], v[4:7], v[56:63], v1
s_nop 6
v_cvt_pk_bf16_f32 v40, v40, v41
v_bfi_b32 v40, 1, s45, v40
v_cvt_pk_bf16_f32 v41, v42, v43
buffer_store_dwordx2 v[40:41], v44, s[4:7], s42 offen
s_barrier
v_lshlrev_b32 v23, v0, s58
v_cndmask_b32 v16, 0, v23, s[12:13]
v_cndmask_b32 v17, 0, v23, s[14:15]
v_cndmask_b32 v18, 0, v23, s[16:17]
v_cndmask_b32 v19, 0, v23, s[18:19]
v_and_b32 v45, 0x30, v0
v_lshrrev_b32 v46, 8, v0
v_lshl_or_b32 v45, v46, 2, v45
v_bfe_u32 v46, v0, 6, 1
v_lshl_or_b32 v45, v46, 7, v45
v_cndmask_b32 v45, v45, 2.0, s[98:99]
buffer_load_dwordx4 v[48:51], v0, s[4:7], s60 offen offset:0
buffer_load_dwordx4 v[52:55], v0, s[4:7], s60 offen offset:1024
buffer_load_dwordx4 v[56:59], v0, s[4:7], s60 offen offset:2048
buffer_load_dwordx4 v[60:63], v0, s[4:7], s60 offen offset:3072
v_cndmask_b32 v20, 0, v23, s[90:91]
v_cndmask_b32 v21, 0, v23, s[92:93]
v_cndmask_b32 v22, 0, v23, s[94:95]
v_cndmask_b32 v23, 0, v23, s[96:97]
s_waitcnt vmcnt(4)
buffer_load_dwordx4 v[24:27], v0, s[4:7], s43 offen offset:0 sc1
buffer_load_dwordx4 v[28:31], v0, s[4:7], s43 offen offset:1024 sc1
buffer_load_dwordx4 v[32:35], v0, s[4:7], s43 offen offset:2048 sc1
buffer_load_dwordx4 v[36:39], v0, s[4:7], s43 offen offset:3072 sc1
s_add_u32 s33, s33, 16384
s_bitset0_b32 s33, 16
s_waitcnt vmcnt(3)
v_mfma_f32_16x16x32_bf16 v[40:43], v[24:27], v[16:19], 0
s_waitcnt vmcnt(2)
v_mfma_f32_16x16x32_bf16 v[40:43], v[28:31], v[16:19], v[40:43]
v_bitop3_b32 v46, v24, v28, s45 bitop3:0x7e
s_waitcnt vmcnt(1)
v_mfma_f32_16x16x32_bf16 v[40:43], v[32:35], v[16:19], v[40:43]
s_waitcnt vmcnt(0)
v_mfma_f32_16x16x32_bf16 v[40:43], v[36:39], v[16:19], v[40:43]
v_bitop3_b32 v47, v32, v36, s45 bitop3:0x7e
v_bitop3_b32 v46, v46, v47, 1 bitop3:0xa8
v_cmp_ne_u32 vcc, 0, v46
v_mov_b64 v[24:25], 0
v_mov_b64 v[26:27], 0
v_mov_b64 v[28:29], 0
v_mov_b64 v[30:31], 0
v_permlane32_swap_b32 v40, v41
v_permlane32_swap_b32 v42, v43
v_add_f32 v40, v40, v41
v_add_f32 v41, v42, v43
v_cvt_pk_bf16_f32 v42, v40, v41
s_cbranch_vccnz k_r1_217
k_ok1_218:
buffer_store_dword v42, v45, s[4:7], s44 offen
s_barrier
buffer_load_dwordx4 v[4:7], v0, s[4:7], s33 offen offset:0 sc1
buffer_load_dwordx4 v[8:11], v0, s[4:7], s33 offen offset:1024 sc1
s_add_u32 s34, s33, 4096
s_add_u32 s35, s33, 8192
s_add_u32 s36, s36, 524288
s_add_u32 s37, s37, 10240
s_add_u32 s59, s59, 10240
s_add_u32 s63, s63, 16384
s_bitset0_b32 s63, 16
v_mov_b64 v[32:33], 0
v_mov_b64 v[34:35], 0
v_mov_b64 v[36:37], 0
v_mov_b64 v[38:39], 0
v_mov_b64 v[40:41], 0
v_mov_b64 v[42:43], 0
v_mov_b64 v[44:45], 0
v_mov_b64 v[46:47], 0
s_add_u32 s44, s44, 16384
s_bitset0_b32 s44, 16
s_sub_u32 s45, s45, 1
s_add_u32 s31, s31, 1
ds_read_b128 v[64:67], v0 offset:36864
ds_read_b128 v[68:71], v0 offset:37888
buffer_load_dwordx4 v[12:15], v0, s[4:7], s34 offen offset:0 sc1
s_cmp_lg_u32 s31, s47
s_cbranch_scc1 k_T0_206
s_branch k_done_216
k_cold2_208:
s_barrier
buffer_load_dwordx4 v[48:51], v0, s[4:7], s60 offen offset:0
buffer_load_dwordx4 v[52:55], v0, s[4:7], s60 offen offset:1024
buffer_load_dwordx4 v[56:59], v0, s[4:7], s60 offen offset:2048
buffer_load_dwordx4 v[60:63], v0, s[4:7], s60 offen offset:3072
ds_read_b128 v[64:67], v0 offset:36864
ds_read_b128 v[68:71], v0 offset:37888
k_cold_207:
buffer_load_dwordx4 v[4:7], v0, s[4:7], s33 offen offset:0 sc1
buffer_load_dwordx4 v[8:11], v0, s[4:7], s33 offen offset:1024 sc1
buffer_load_dwordx4 v[12:15], v0, s[4:7], s34 offen offset:0 sc1
s_sub_u32 s32, s32, 1
s_cmp_gt_i32 s32, 0
s_cbranch_scc0 k_okC_209
v_mov_b64 v[24:25], 0
v_mov_b64 v[26:27], 0
v_mov_b64 v[28:29], 0
v_mov_b64 v[30:31], 0
v_mov_b64 v[32:33], 0
v_mov_b64 v[34:35], 0
v_mov_b64 v[36:37], 0
v_mov_b64 v[38:39], 0
v_mov_b64 v[40:41], 0
v_mov_b64 v[42:43], 0
v_mov_b64 v[44:45], 0
v_mov_b64 v[46:47], 0
s_branch k_T0_206
k_coldA_210:
buffer_load_dwordx4 v[12:15], v0, s[4:7], s34 offen offset:0 sc1
s_sub_u32 s32, s32, 1
s_cmp_gt_i32 s32, 0
s_waitcnt vmcnt(0)
v_cmp_u_f32 vcc, v12, v12
ds_write_b128 v0, v[12:15] offset:2048
s_waitcnt lgkmcnt(0)
s_cbranch_vccz k_okA_211
s_cbranch_scc1 k_coldA_210
s_branch k_okA_211
k_coldB_212:
buffer_load_dwordx4 v[16:19], v0, s[4:7], s35 offen offset:0 sc1
s_sub_u32 s32, s32, 1
s_cmp_gt_i32 s32, 0
s_waitcnt vmcnt(0)
v_cmp_u_f32 vcc, v16, v16
ds_write_b128 v0, v[16:19] offset:6144
s_waitcnt lgkmcnt(0)
s_cbranch_vccz k_okB_213
s_cbranch_scc1 k_coldB_212
s_branch k_okB_213
k_r1_217:
buffer_load_dwordx4 v[24:27], v0, s[4:7], s43 offen offset:0 sc1
buffer_load_dwordx4 v[28:31], v0, s[4:7], s43 offen offset:1024 sc1
buffer_load_dwordx4 v[32:35], v0, s[4:7], s43 offen offset:2048 sc1
buffer_load_dwordx4 v[36:39], v0, s[4:7], s43 offen offset:3072 sc1
s_sub_u32 s32, s32, 1
s_cmp_gt_i32 s32, 0
s_waitcnt vmcnt(3)
v_mfma_f32_16x16x32_bf16 v[40:43], v[24:27], v[16:19], 0
s_waitcnt vmcnt(2)
v_mfma_f32_16x16x32_bf16 v[40:43], v[28:31], v[16:19], v[40:43]
v_bitop3_b32 v46, v24, v28, s45 bitop3:0x7e
s_waitcnt vmcnt(1)
v_mfma_f32_16x16x32_bf16 v[40:43], v[32:35], v[16:19], v[40:43]
s_waitcnt vmcnt(0)
v_mfma_f32_16x16x32_bf16 v[40:43], v[36:39], v[16:19], v[40:43]
v_bitop3_b32 v47, v32, v36, s45 bitop3:0x7e
v_bitop3_b32 v46, v46, v47, 1 bitop3:0xa8
v_cmp_ne_u32 vcc, 0, v46
v_mov_b64 v[24:25], 0
v_mov_b64 v[26:27], 0
v_mov_b64 v[28:29], 0
v_mov_b64 v[30:31], 0
v_permlane32_swap_b32 v40, v41
v_permlane32_swap_b32 v42, v43
v_add_f32 v40, v40, v41
v_add_f32 v41, v42, v43
v_cvt_pk_bf16_f32 v42, v40, v41
s_cbranch_vccz k_ok1_218
s_cbranch_scc1 k_r1_217
s_branch k_ok1_218
k_slow_214:
ds_read_b128 v[24:27], v0 offset:0
ds_read_b128 v[28:31], v0 offset:1024
v_mov_b32 v46, 0xff7fffff
s_add_u32 s48, s36, 0xffffe000
buffer_load_dwordx4 v[32:35], v0, s[4:7], s48 offen offset:0 sc1
buffer_load_dwordx4 v[36:39], v0, s[4:7], s48 offen offset:1024 sc1
s_waitcnt vmcnt(1) lgkmcnt(1)
v_mfma_f32_16x16x32_bf16 v[4:7], v[32:35], v[24:27], 0
s_waitcnt vmcnt(0) lgkmcnt(0)
v_mfma_f32_16x16x32_bf16 v[4:7], v[36:39], v[28:31], v[4:7]
v_mov_b64 v[8:9], s[56:57]
s_nop 5
v_permlane32_swap_b32 v4, v6
v_permlane32_swap_b32 v5, v7
v_add_f32_dpp v8, v6, v4 row_ror:8 row_mask:0xf bank_mask:0x3
s_nop 0
v_add_f32_dpp v9, v7, v5 row_ror:8 row_mask:0xf bank_mask:0x3
v_max3_f32 v46, v46, v8, v9
s_add_u32 s48, s36, 0xfffff000
buffer_load_dwordx4 v[32:35], v0, s[4:7], s48 offen offset:0 sc1
buffer_load_dwordx4 v[36:39], v0, s[4:7], s48 offen offset:1024 sc1
s_waitcnt vmcnt(1)
v_mfma_f32_16x16x32_bf16 v[4:7], v[32:35], v[24:27], 0
s_waitcnt vmcnt(0)
v_mfma_f32_16x16x32_bf16 v[4:7], v[36:39], v[28:31], v[4:7]
v_mov_b64 v[10:11], s[56:57]
s_nop 5
v_permlane32_swap_b32 v4, v6
v_permlane32_swap_b32 v5, v7
v_add_f32_dpp v10, v6, v4 row_ror:8 row_mask:0xf bank_mask:0x3
s_nop 0
v_add_f32_dpp v11, v7, v5 row_ror:8 row_mask:0xf bank_mask:0x3
v_max3_f32 v46, v46, v10, v11
s_add_u32 s48, s36, 0x0
buffer_load_dwordx4 v[32:35], v0, s[4:7], s48 offen offset:0 sc1
buffer_load_dwordx4 v[36:39], v0, s[4:7], s48 offen offset:1024 sc1
s_waitcnt vmcnt(1)
v_mfma_f32_16x16x32_bf16 v[4:7], v[32:35], v[24:27], 0
s_waitcnt vmcnt(0)
v_mfma_f32_16x16x32_bf16 v[4:7], v[36:39], v[28:31], v[4:7]
v_mov_b64 v[12:13], s[56:57]
s_nop 5
v_permlane32_swap_b32 v4, v6
v_permlane32_swap_b32 v5, v7
v_add_f32_dpp v12, v6, v4 row_ror:8 row_mask:0xf bank_mask:0x3
s_nop 0
v_add_f32_dpp v13, v7, v5 row_ror:8 row_mask:0xf bank_mask:0x3
v_max3_f32 v46, v46, v12, v13
s_add_u32 s48, s36, 0x1000
buffer_load_dwordx4 v[32:35], v0, s[4:7], s48 offen offset:0 sc1
buffer_load_dwordx4 v[36:39], v0, s[4:7], s48 offen offset:1024 sc1
s_waitcnt vmcnt(1)
v_mfma_f32_16x16x32_bf16 v[4:7], v[32:35], v[24:27], 0
s_waitcnt vmcnt(0)
v_mfma_f32_16x16x32_bf16 v[4:7], v[36:39], v[28:31], v[4:7]
v_mov_b64 v[14:15], s[56:57]
s_nop 5
v_permlane32_swap_b32 v4, v6
v_permlane32_swap_b32 v5, v7
v_add_f32_dpp v14, v6, v4 row_ror:8 row_mask:0xf bank_mask:0x3
s_nop 0
v_add_f32_dpp v15, v7, v5 row_ror:8 row_mask:0xf bank_mask:0x3
v_max3_f32 v46, v46, v14, v15
ds_read_b128 v[32:35], v0 offset:2048
ds_read_b128 v[36:39], v0 offset:3072
s_waitcnt lgkmcnt(1)
v_mfma_f32_16x16x32_bf16 v[4:7], v[32:35], v[24:27], 0
s_waitcnt lgkmcnt(0)
v_mfma_f32_16x16x32_bf16 v[4:7], v[36:39], v[28:31], v[4:7]
v_mov_b64 v[44:45], s[56:57]
s_nop 5
v_permlane32_swap_b32 v4, v6
v_permlane32_swap_b32 v5, v7
v_add_f32_dpp v44, v6, v4 row_ror:8 row_mask:0xf bank_mask:0x3
s_nop 0
v_add_f32_dpp v45, v7, v5 row_ror:8 row_mask:0xf bank_mask:0x3
v_max3_f32 v46, v46, v44, v45
buffer_load_dwordx4 v[32:35], v0, s[4:7], s36 offen offset:2048 sc1
buffer_load_dwordx4 v[36:39], v0, s[4:7], s36 offen offset:3072 sc1
v_mov_b32 v47, v46
s_nop 1
v_permlane32_swap_b32 v46, v47
v_max_f32 v46, v46, v47
v_mov_b32 v47, v46
s_nop 1
v_permlane16_swap_b32 v46, v47
v_max_f32 v46, v46, v47
v_sub_f32 v8, v8, v46
v_exp_f32 v8, v8
v_sub_f32 v9, v9, v46
v_exp_f32 v9, v9
v_sub_f32 v10, v10, v46
v_exp_f32 v10, v10
v_sub_f32 v11, v11, v46
v_exp_f32 v11, v11
v_sub_f32 v12, v12, v46
v_exp_f32 v12, v12
v_sub_f32 v13, v13, v46
v_exp_f32 v13, v13
v_sub_f32 v14, v14, v46
v_exp_f32 v14, v14
v_sub_f32 v15, v15, v46
v_exp_f32 v15, v15
v_sub_f32 v44, v44, v46
v_exp_f32 v44, v44
v_sub_f32 v45, v45, v46
v_exp_f32 v45, v45
v_cvt_pk_bf16_f32 v4, v8, v9
v_cvt_pk_bf16_f32 v5, v10, v11
v_cvt_pk_bf16_f32 v6, v12, v13
v_cvt_pk_bf16_f32 v7, v14, v15
v_mov_b32_dpp v8, v4 row_ror:8 row_mask:0xf bank_mask:0xf
v_mov_b32_dpp v9, v5 row_ror:8 row_mask:0xf bank_mask:0xf
v_mov_b32_dpp v10, v6 row_ror:8 row_mask:0xf bank_mask:0xf
v_mov_b32_dpp v11, v7 row_ror:8 row_mask:0xf bank_mask:0xf
v_cvt_pk_bf16_f32 v24, v44, v45
v_cvt_pk_bf16_f32 v25, v44, v45
s_nop 0
v_mov_b32_dpp v26, v24 row_ror:8 row_mask:0xf bank_mask:0xf
v_mov_b32_dpp v27, v24 row_ror:8 row_mask:0xf bank_mask:0xf
v_mov_b64 v[28:29], s[52:53]
v_mov_b64 v[30:31], s[52:53]
s_nop 1
v_mfma_f32_16x16x32_bf16 v[44:47], v[28:31], v[4:7], 0
s_waitcnt vmcnt(1)
v_mfma_f32_16x16x32_bf16 v[12:15], v[32:35], v[4:7], 0
s_waitcnt vmcnt(0)
v_mfma_f32_16x16x32_bf16 v[12:15], v[36:39], v[8:11], v[12:15]
v_mfma_f32_16x16x32_bf16 v[12:15], v[40:43], v[24:27], v[12:15]
v_mov_b64 v[28:29], s[54:55]
s_nop 1
v_mfma_f32_16x16x16_bf16 v[44:47], v[28:29], v[24:25], v[44:47]
s_nop 6
v_rcp_f32 v4, v44
s_nop 1
v_rcp_f32_dpp v4, v44 row_ror:8 row_mask:0xf bank_mask:0xc
s_nop 0
v_mul_f32 v12, v4, v12
v_mul_f32 v13, v4, v13
v_mul_f32 v14, v4, v14
v_mul_f32 v15, v4, v15
v_cvt_pk_bf16_f32 v44, v12, v13
v_cvt_pk_bf16_f32 v45, v14, v15
v_and_b32 v12, 0xffffff7f, v0
v_and_or_b32 v8, v1, 8, v12
ds_write_b64 v8, v[44:45] offset:7168
v_mov_b32_dpp v46, v44 row_ror:8 row_mask:0xf bank_mask:0xf
v_mov_b32_dpp v47, v45 row_ror:8 row_mask:0xf bank_mask:0xf
v_mov_b64 v[24:25], 0
v_mov_b64 v[26:27], 0
v_mov_b64 v[28:29], 0
v_mov_b64 v[30:31], 0
v_mov_b64 v[32:33], 0
v_mov_b64 v[34:35], 0
v_mov_b64 v[36:37], 0
v_mov_b64 v[38:39], 0
s_waitcnt lgkmcnt(0)
s_branch k_okS_215
k_done_216:
buffer_load_dwordx4 v[16:19], v0, s[4:7], s35 offen offset:0 sc1
k_xs_222:
s_waitcnt vmcnt(1)
v_cmp_u_f32 vcc, v4, v12
s_waitcnt vmcnt(0)
v_cmp_u_f32 s[66:67], v16, v16
s_or_b64 vcc, vcc, s[66:67]
s_cbranch_vccz k_xd_223
buffer_load_dwordx4 v[4:7], v0, s[4:7], s33 offen offset:0 sc1
buffer_load_dwordx4 v[8:11], v0, s[4:7], s33 offen offset:1024 sc1
buffer_load_dwordx4 v[12:15], v0, s[4:7], s34 offen offset:0 sc1
buffer_load_dwordx4 v[16:19], v0, s[4:7], s35 offen offset:0 sc1
s_sub_u32 s32, s32, 1
s_cmp_gt_i32 s32, 0
s_cbranch_scc1 k_xs_222
k_xd_223:
s_waitcnt vmcnt(1)
buffer_store_dwordx4 v[12:15], v0, s[8:11], s37 offen offset:2048 sc1
s_waitcnt vmcnt(1)
buffer_store_dwordx4 v[16:19], v0, s[8:11], s59 offen offset:2048 sc1
s_add_u32 s31, s31, 1
s_branch k_jn_205
k_far_204:
s_branch k_cold2_226
k_T0_224:
s_waitcnt vmcnt(2)
v_smfmac_f32_16x16x64_bf16 v[40:43], v[4:7], v[48:55], v1
s_waitcnt vmcnt(1)
v_cmp_u_f32 vcc, v4, v8
v_smfmac_f32_16x16x64_bf16 v[24:27], v[8:11], a[24:31], v1
v_smfmac_f32_16x16x64_bf16 v[28:31], v[8:11], a[32:39], v1
s_cbranch_vccnz k_cold_225
k_okC_227:
s_waitcnt vmcnt(1)
v_smfmac_f32_16x16x64_bf16 v[36:39], v[8:11], a[40:47], v1
s_waitcnt lgkmcnt(0)
ds_read_b128 v[48:51], v2 offset:0
v_smfmac_f32_16x16x64_bf16 v[32:35], v[4:7], v[64:71], v1
ds_read_b128 v[52:55], v2 offset:1024
ds_read_b128 v[64:67], v0 offset:38912
v_smfmac_f32_16x16x64_bf16 v[44:47], v[4:7], v[56:63], v1
ds_read_b128 v[68:71], v0 offset:39936
v_smfmac_f32_16x16x64_bf16 v[28:31], v[4:7], a[8:15], v1
v_smfmac_f32_16x16x64_bf16 v[24:27], v[4:7], a[0:7], v1
ds_read_b128 v[56:59], v2 offset:28672
v_smfmac_f32_16x16x64_bf16 v[36:39], v[4:7], a[16:23], v1
ds_read_b128 v[60:63], v2 offset:29696
s_waitcnt lgkmcnt(4)
v_smfmac_f32_16x16x64_bf16 v[40:43], v[8:11], v[48:55], v1
s_waitcnt vmcnt(0)
ds_write_b128 v0, v[12:15] offset:2048
s_waitcnt lgkmcnt(3)
v_smfmac_f32_16x16x64_bf16 v[32:35], v[8:11], v[64:71], v1
buffer_load_dwordx4 v[16:19], v0, s[4:7], s35 offen offset:0 sc1
v_cmp_u_f32 vcc, v12, v12
s_waitcnt lgkmcnt(1)
v_smfmac_f32_16x16x64_bf16 v[44:47], v[8:11], v[56:63], v1
ds_read_b128 v[56:59], v2 offset:2048
ds_read_b128 v[60:63], v2 offset:3072
ds_read_b128 v[64:67], v0 offset:45056
s_cbranch_vccnz k_coldA_228
k_okA_229:
v_smfmac_f32_16x16x64_bf16 v[36:39], v[12:15], a[64:71], v1
ds_read_b128 v[68:71], v0 offset:46080
s_waitcnt lgkmcnt(4)
v_smfmac_f32_16x16x64_bf16 v[40:43], v[12:15], a[72:79], v1
s_barrier
v_smfmac_f32_16x16x64_bf16 v[28:31], v[12:15], a[56:63], v1
ds_read_b128 v[8:11], v0 offset:3072
buffer_load_dwordx4 v[48:51], v0, s[4:7], s36 offen offset:0 sc1
s_waitcnt lgkmcnt(3)
v_smfmac_f32_16x16x64_bf16 v[44:47], v[12:15], v[56:63], v1
ds_read_b128 v[56:59], v2 offset:4096
v_smfmac_f32_16x16x64_bf16 v[24:27], v[12:15], a[48:55], v1
ds_read_b128 v[60:63], v2 offset:5120
s_waitcnt lgkmcnt(3)
v_smfmac_f32_16x16x64_bf16 v[32:35], v[12:15], v[64:71], v1
buffer_load_dwordx4 v[52:55], v0, s[4:7], s36 offen offset:1024 sc1
s_waitcnt lgkmcnt(2)
v_smfmac_f32_16x16x64_bf16 v[24:27], v[8:11], a[80:87], v1
ds_read_b128 v[64:67], v0 offset:47104
ds_read_b128 v[68:71], v0 offset:48128
v_smfmac_f32_16x16x64_bf16 v[36:39], v[8:11], a[96:103], v1
buffer_store_dword v3, v0, s[20:23], s63 offen sc1
s_waitcnt lgkmcnt(2)
ds_read_b128 v[4:7], v0 offset:0
v_smfmac_f32_16x16x64_bf16 v[44:47], v[8:11], v[56:63], v1
ds_read_b128 v[56:59], v0 offset:49152
ds_read_b128 v[60:63], v0 offset:50176
v_smfmac_f32_16x16x64_bf16 v[28:31], v[8:11], a[88:95], v1
buffer_store_dwordx4 v[12:15], v0, s[8:11], s37 offen offset:2048 sc1
v_smfmac_f32_16x16x64_bf16 v[40:43], v[8:11], a[104:111], v1
s_waitcnt lgkmcnt(3)
s_waitcnt lgkmcnt(2)
v_smfmac_f32_16x16x64_bf16 v[32:35], v[8:11], v[64:71], v1
ds_read_b128 v[64:67], v0 offset:40960
ds_read_b128 v[12:15], v0 offset:1024
v_smfmac_f32_16x16x64_bf16 v[36:39], v[4:7], a[128:135], v1
s_waitcnt lgkmcnt(2)
v_smfmac_f32_16x16x64_bf16 v[44:47], v[4:7], v[56:63], v1
ds_read_b128 v[68:71], v0 offset:41984
buffer_load_dwordx4 v[56:59], v0, s[4:7], s36 offen offset:2048 sc1
v_smfmac_f32_16x16x64_bf16 v[28:31], v[4:7], a[120:127], v1
v_smfmac_f32_16x16x64_bf16 v[24:27], v[4:7], a[112:119], v1
s_waitcnt vmcnt(5)
ds_write_b128 v0, v[16:19] offset:6144
v_smfmac_f32_16x16x64_bf16 v[40:43], v[4:7], a[136:143], v1
s_waitcnt lgkmcnt(1)
buffer_load_dwordx4 v[60:63], v0, s[4:7], s36 offen offset:3072 sc1
v_cmp_u_f32 vcc, v16, v16
v_smfmac_f32_16x16x64_bf16 v[32:35], v[4:7], v[64:71], v1
ds_read_b128 v[64:67], v0 offset:43008
ds_read_b128 v[68:71], v0 offset:44032
v_smfmac_f32_16x16x64_bf16 v[28:31], v[12:15], a[152:159], v1
v_smfmac_f32_16x16x64_bf16 v[24:27], v[12:15], a[144:151], v1
s_cbranch_vccnz k_coldB_230
k_okB_231:
v_smfmac_f32_16x16x64_bf16 v[36:39], v[12:15], a[160:167], v1
s_waitcnt lgkmcnt(2)
buffer_store_dwordx4 v[16:19], v0, s[8:11], s59 offen offset:2048 sc1
s_barrier
ds_read_b128 v[4:7], v0 offset:4096
v_smfmac_f32_16x16x64_bf16 v[44:47], v[12:15], a[176:183], v1
ds_read_b128 v[8:11], v0 offset:7168
s_waitcnt lgkmcnt(2)
v_smfmac_f32_16x16x64_bf16 v[32:35], v[12:15], v[64:71], v1
ds_read_b128 v[64:67], v2 offset:34816
ds_read_b128 v[68:71], v2 offset:35840
v_smfmac_f32_16x16x64_bf16 v[24:27], v[16:19], a[184:191], v1
v_smfmac_f32_16x16x64_bf16 v[40:43], v[12:15], a[168:175], v1
s_waitcnt lgkmcnt(3)
ds_read_b128 v[12:15], v0 offset:5120
v_smfmac_f32_16x16x64_bf16 v[24:27], v[4:7], a[208:215], v1
s_waitcnt lgkmcnt(3)
v_smfmac_f32_16x16x64_bf16 v[28:31], v[4:7], a[216:223], v1
v_smfmac_f32_16x16x64_bf16 v[28:31], v[8:11], a[200:207], v1
s_waitcnt lgkmcnt(1)
v_smfmac_f32_16x16x64_bf16 v[24:27], v[8:11], v[64:71], v1
ds_read_b128 v[64:67], v2 offset:6144
s_waitcnt lgkmcnt(1)
v_smfmac_f32_16x16x64_bf16 v[24:27], v[12:15], a[224:231], v1
ds_read_b128 v[68:71], v2 offset:7168
v_smfmac_f32_16x16x64_bf16 v[28:31], v[12:15], a[232:239], v1
v_smfmac_f32_16x16x64_bf16 v[28:31], v[16:19], a[192:199], v1
v_cvt_pk_bf16_f32 v24, v24, v25
v_cvt_pk_bf16_f32 v25, v26, v27
v_smfmac_f32_16x16x64_bf16 v[32:35], v[4:7], v[80:87], v1
v_cvt_pk_bf16_f32 v26, v28, v29
v_cvt_pk_bf16_f32 v27, v30, v31
v_smfmac_f32_16x16x64_bf16 v[32:35], v[8:11], a[248:255], v1
s_waitcnt lgkmcnt(0)
v_mfma_f32_16x16x32_bf16 v[28:31], v[24:27], v[20:23], 0
v_and_b32 v26, 0xffffff7f, v0
v_smfmac_f32_16x16x64_bf16 v[32:35], v[16:19], v[64:71], v1
v_and_or_b32 v26, v1, 8, v26
v_mul_f32 v28, s51, v28
v_mul_f32 v29, s51, v29
v_mul_f32 v31, s51, v31
v_cvt_pk_bf16_f32 v24, v28, v29
v_mul_f32 v30, s51, v30
v_cvt_pk_bf16_f32 v25, v30, v31
v_smfmac_f32_16x16x64_bf16 v[32:35], v[12:15], v[96:103], v1
ds_write_b64 v26, v[24:25] offset:1024
v_smfmac_f32_16x16x64_bf16 v[36:39], v[8:11], v[72:79], v1
v_cvt_pk_bf16_f32 v32, v32, v33
v_smfmac_f32_16x16x64_bf16 v[36:39], v[16:19], a[240:247], v1
buffer_load_dwordx4 v[64:67], v0, s[4:7], s61 offen offset:0
v_cvt_pk_bf16_f32 v33, v34, v35
v_smfmac_f32_16x16x64_bf16 v[36:39], v[12:15], v[104:111], v1
s_waitcnt lgkmcnt(0)
v_smfmac_f32_16x16x64_bf16 v[36:39], v[4:7], v[88:95], v1
s_barrier
ds_read_b128 v[24:27], v0 offset:0
v_smfmac_f32_16x16x64_bf16 v[40:43], v[4:7], v[144:151], v1
ds_read_b128 v[28:31], v0 offset:1024
s_nop 0
v_cvt_pk_bf16_f32 v34, v36, v37
v_cvt_pk_bf16_f32 v35, v38, v39
s_nop 1
v_mfma_f32_16x16x32_bf16 v[36:39], v[32:35], v[20:23], 0
s_waitcnt vmcnt(6)
buffer_load_dwordx4 v[68:71], v0, s[4:7], s61 offen offset:1024
v_and_b32 v34, 0xffffff7f, v0
v_and_or_b32 v34, v1, 8, v34
s_waitcnt lgkmcnt(1)
v_mfma_f32_16x16x32_bf16 v[48:51], v[48:51], v[24:27], 0
v_cvt_pk_bf16_f32 v32, v36, v37
s_waitcnt lgkmcnt(0)
v_mfma_f32_16x16x32_bf16 v[48:51], v[52:55], v[28:31], v[48:51]
v_mov_b64 v[52:53], s[56:57]
v_cvt_pk_bf16_f32 v33, v38, v39
v_smfmac_f32_16x16x64_bf16 v[44:47], v[4:7], v[152:159], v1
ds_write_b64 v34, v[32:33] offset:3072
v_permlane32_swap_b32 v48, v50
v_permlane32_swap_b32 v49, v51
v_add_f32_dpp v52, v50, v48 row_ror:8 row_mask:0xf bank_mask:0x3
v_exp_f32 v52, v52
v_add_f32_dpp v53, v51, v49 row_ror:8 row_mask:0xf bank_mask:0x3
v_exp_f32 v53, v53
s_nop 0
v_cvt_pk_bf16_f32 v48, v52, v53
v_smfmac_f32_16x16x64_bf16 v[44:47], v[16:19], v[120:127], v1
ds_write_b32 v0, v48 offset:4104
v_smfmac_f32_16x16x64_bf16 v[44:47], v[12:15], v[168:175], v1
buffer_load_dwordx4 v[48:51], v0, s[4:7], s61 offen offset:2048
v_smfmac_f32_16x16x64_bf16 v[40:43], v[12:15], v[160:167], v1
s_waitcnt lgkmcnt(1)
v_xor_b32 v12, 0x80, v0
v_smfmac_f32_16x16x64_bf16 v[40:43], v[8:11], v[128:135], v1
s_waitcnt lgkmcnt(0)
s_barrier
ds_read_b128 v[32:35], v0 offset:2048
v_mov_b64 v[22:23], s[52:53]
v_smfmac_f32_16x16x64_bf16 v[40:43], v[16:19], v[112:119], v1
ds_read_b128 v[36:39], v0 offset:3072
ds_read_b128 v[16:19], v0 offset:4096
buffer_load_dwordx4 v[52:55], v0, s[4:7], s61 offen offset:3072
v_smfmac_f32_16x16x64_bf16 v[44:47], v[8:11], v[136:143], v1
ds_read_b128 v[12:15], v12 offset:4096
v_cvt_pk_bf16_f32 v40, v40, v41
v_mov_b64 v[20:21], s[52:53]
s_waitcnt lgkmcnt(3)
v_mfma_f32_16x16x32_bf16 v[24:27], v[32:35], v[24:27], 0
v_cvt_pk_bf16_f32 v41, v42, v43
s_waitcnt lgkmcnt(2)
v_mfma_f32_16x16x32_bf16 v[24:27], v[36:39], v[28:31], v[24:27]
s_waitcnt vmcnt(5)
s_waitcnt lgkmcnt(1)
v_mfma_f32_16x16x32_bf16 v[8:11], v[56:59], v[16:19], 0
buffer_load_dwordx4 v[56:59], v0, s[4:7], s62 offen offset:0
v_mov_b64 v[28:29], s[56:57]
v_cvt_pk_bf16_f32 v43, v46, v47
v_cvt_pk_bf16_f32 v42, v44, v45
v_permlane32_swap_b32 v25, v27
v_permlane32_swap_b32 v24, v26
v_mfma_f32_16x16x32_bf16 v[4:7], v[20:23], v[16:19], 0
s_waitcnt lgkmcnt(0)
v_add_f32_dpp v28, v26, v24 row_ror:8 row_mask:0xf bank_mask:0x3
v_add_f32_dpp v29, v27, v25 row_ror:8 row_mask:0xf bank_mask:0x3
v_exp_f32 v28, v28
v_mfma_f32_16x16x32_bf16 v[8:11], v[60:63], v[12:15], v[8:11]
buffer_load_dwordx4 v[60:63], v0, s[4:7], s62 offen offset:1024
v_exp_f32 v29, v29
v_permlane32_swap_b32 v42, v43
v_cvt_pk_bf16_f32 v24, v28, v29
v_mov_b64 v[44:45], s[54:55]
v_cvt_pk_bf16_f32 v25, v28, v29
v_mov_b32_dpp v26, v24 row_ror:8 row_mask:0xf bank_mask:0xf
v_mov_b32_dpp v27, v24 row_ror:8 row_mask:0xf bank_mask:0xf
v_mfma_f32_16x16x16_bf16 v[4:7], v[44:45], v[24:25], v[4:7]
v_permlane32_swap_b32 v40, v41
v_mov_b64 v[36:37], 0
v_mov_b64 v[38:39], 0
v_mov_b64 v[30:31], 0
v_mfma_f32_16x16x32_bf16 v[8:11], v[40:43], v[24:27], v[8:11]
buffer_load_dwordx4 v[16:19], v0, s[4:7], s62 offen offset:2048
v_rcp_f32 v6, v4
v_and_b32 v12, 0xffffff7f, v0
v_and_or_b32 v13, v1, 8, v12
v_rcp_f32_dpp v6, v4 row_ror:8 row_mask:0xf bank_mask:0xc
v_mov_b64 v[26:27], 0
v_pk_mul_f32 v[8:9], v[8:9], v[6:7] op_sel_hi:[1,0]
v_cvt_pk_bf16_f32 v44, v8, v9
v_pk_mul_f32 v[10:11], v[10:11], v[6:7] op_sel_hi:[1,0]
v_cvt_pk_bf16_f32 v45, v10, v11
s_waitcnt vmcnt(5)
ds_write_b64 v13, v[44:45] offset:7168
buffer_load_dwordx4 v[20:23], v0, s[4:7], s62 offen offset:3072
v_add_u32 v6, 0xd4800000, v6
v_cmp_lt_u32 vcc, 0x28000000, v6
v_mov_b64 v[34:35], 0
v_mov_b32_dpp v46, v44 row_ror:8 row_mask:0xf bank_mask:0xf
v_mov_b32_dpp v47, v45 row_ror:8 row_mask:0xf bank_mask:0xf
v_mov_b64 v[28:29], 0
v_mov_b64 v[32:33], 0
s_cbranch_vccnz k_slow_232
k_okS_233:
v_smfmac_f32_16x16x64_bf16 v[36:39], v[44:47], v[224:231], v1
s_waitcnt lgkmcnt(0)
s_barrier
ds_read_b128 v[8:11], v12 offset:6144
v_smfmac_f32_16x16x64_bf16 v[32:35], v[44:47], v[200:207], v1
s_waitcnt vmcnt(4)
ds_read_b128 v[4:7], v12 offset:7296
v_mov_b64 v[24:25], 0
v_smfmac_f32_16x16x64_bf16 v[28:31], v[44:47], v[48:55], v1
ds_read_b128 v[12:15], v12 offset:6272
ds_read_b128 v[48:51], v2 offset:26624
v_smfmac_f32_16x16x64_bf16 v[24:27], v[44:47], v[64:71], v1
ds_read_b128 v[52:55], v2 offset:27648
v_mov_b64 v[42:43], 0
s_waitcnt lgkmcnt(4)
v_smfmac_f32_16x16x64_bf16 v[24:27], v[8:11], v[184:191], v1
s_waitcnt lgkmcnt(3)
v_mov_b64 v[40:41], 0
v_smfmac_f32_16x16x64_bf16 v[24:27], v[4:7], v[176:183], v1
s_waitcnt lgkmcnt(2)
ds_read_b128 v[64:67], v2 offset:10240
v_smfmac_f32_16x16x64_bf16 v[24:27], v[12:15], v[192:199], v1
ds_read_b128 v[68:71], v2 offset:11264
v_smfmac_f32_16x16x64_bf16 v[40:43], v[44:47], v[240:247], v1
s_waitcnt vmcnt(2)
s_waitcnt lgkmcnt(2)
v_lshrrev_b32 v44, 16, v1
v_cvt_pk_bf16_f32 v24, v24, v25
v_bfi_b32 v24, 1, s45, v24
v_cvt_pk_bf16_f32 v25, v26, v27
v_smfmac_f32_16x16x64_bf16 v[28:31], v[8:11], v[48:55], v1
buffer_store_dwordx2 v[24:25], v44, s[4:7], s38 offen sc1
ds_read_b128 v[48:51], v2 offset:24576
ds_read_b128 v[52:55], v2 offset:25600
v_smfmac_f32_16x16x64_bf16 v[28:31], v[12:15], v[56:63], v1
s_waitcnt lgkmcnt(2)
ds_read_b128 v[56:59], v2 offset:8192
v_smfmac_f32_16x16x64_bf16 v[28:31], v[4:7], v[64:71], v1
ds_read_b128 v[60:63], v2 offset:9216
v_smfmac_f32_16x16x64_bf16 v[32:35], v[8:11], v[208:215], v1
ds_read_b128 v[64:67], v2 offset:30720
s_nop 0
v_cvt_pk_bf16_f32 v28, v28, v29
v_bfi_b32 v28, 1, s45, v28
v_cvt_pk_bf16_f32 v29, v30, v31
v_smfmac_f32_16x16x64_bf16 v[32:35], v[12:15], v[216:223], v1
buffer_store_dwordx2 v[28:29], v44, s[4:7], s39 offen sc1
v_smfmac_f32_16x16x64_bf16 v[40:43], v[12:15], v[248:255], v1
ds_read_b128 v[68:71], v2 offset:31744
s_waitcnt vmcnt(2)
v_smfmac_f32_16x16x64_bf16 v[32:35], v[4:7], v[16:23], v1
s_waitcnt lgkmcnt(2)
v_smfmac_f32_16x16x64_bf16 v[36:39], v[12:15], v[232:239], v1
ds_read_b128 v[16:19], v2 offset:32768
ds_read_b128 v[20:23], v2 offset:33792
v_cvt_pk_bf16_f32 v32, v32, v33
v_bfi_b32 v32, 1, s45, v32
v_cvt_pk_bf16_f32 v33, v34, v35
v_smfmac_f32_16x16x64_bf16 v[36:39], v[8:11], v[48:55], v1
buffer_store_dwordx2 v[32:33], v44, s[4:7], s40 offen sc1
s_waitcnt lgkmcnt(2)
v_smfmac_f32_16x16x64_bf16 v[36:39], v[4:7], v[64:71], v1
s_nop 6
v_cvt_pk_bf16_f32 v36, v36, v37
v_cvt_pk_bf16_f32 v37, v38, v39
s_waitcnt lgkmcnt(0)
v_bfi_b32 v36, 1, s45, v36
v_smfmac_f32_16x16x64_bf16 v[40:43], v[8:11], v[16:23], v1
buffer_store_dwordx2 v[36:37], v44, s[4:7], s41 offen sc1
v_smfmac_f32_16x16x64_bf16 v[40:43], v[4:7], v[56:63], v1
s_nop 6
v_cvt_pk_bf16_f32 v40, v40, v41
v_bfi_b32 v40, 1, s45, v40
v_cvt_pk_bf16_f32 v41, v42, v43
buffer_store_dwordx2 v[40:41], v44, s[4:7], s42 offen sc1
s_barrier
v_lshlrev_b32 v23, v0, s58
v_cndmask_b32 v16, 0, v23, s[12:13]
v_cndmask_b32 v17, 0, v23, s[14:15]
v_cndmask_b32 v18, 0, v23, s[16:17]
v_cndmask_b32 v19, 0, v23, s[18:19]
v_and_b32 v45, 0x30, v0
v_lshrrev_b32 v46, 8, v0
v_lshl_or_b32 v45, v46, 2, v45
v_bfe_u32 v46, v0, 6, 1
v_lshl_or_b32 v45, v46, 7, v45
v_cndmask_b32 v45, v45, 2.0, s[98:99]
buffer_load_dwordx4 v[48:51], v0, s[4:7], s60 offen offset:0
buffer_load_dwordx4 v[52:55], v0, s[4:7], s60 offen offset:1024
buffer_load_dwordx4 v[56:59], v0, s[4:7], s60 offen offset:2048
buffer_load_dwordx4 v[60:63], v0, s[4:7], s60 offen offset:3072
v_cndmask_b32 v20, 0, v23, s[90:91]
v_cndmask_b32 v21, 0, v23, s[92:93]
v_cndmask_b32 v22, 0, v23, s[94:95]
v_cndmask_b32 v23, 0, v23, s[96:97]
s_waitcnt vmcnt(4)
buffer_load_dwordx4 v[24:27], v0, s[4:7], s43 offen offset:0 sc1
buffer_load_dwordx4 v[28:31], v0, s[4:7], s43 offen offset:1024 sc1
buffer_load_dwordx4 v[32:35], v0, s[4:7], s43 offen offset:2048 sc1
buffer_load_dwordx4 v[36:39], v0, s[4:7], s43 offen offset:3072 sc1
s_add_u32 s33, s33, 16384
s_bitset0_b32 s33, 16
s_waitcnt vmcnt(3)
v_mfma_f32_16x16x32_bf16 v[40:43], v[24:27], v[16:19], 0
s_waitcnt vmcnt(2)
v_mfma_f32_16x16x32_bf16 v[40:43], v[28:31], v[16:19], v[40:43]
v_bitop3_b32 v46, v24, v28, s45 bitop3:0x7e
s_waitcnt vmcnt(1)
v_mfma_f32_16x16x32_bf16 v[40:43], v[32:35], v[16:19], v[40:43]
s_waitcnt vmcnt(0)
v_mfma_f32_16x16x32_bf16 v[40:43], v[36:39], v[16:19], v[40:43]
v_bitop3_b32 v47, v32, v36, s45 bitop3:0x7e
v_bitop3_b32 v46, v46, v47, 1 bitop3:0xa8
v_cmp_ne_u32 vcc, 0, v46
v_mov_b64 v[24:25], 0
v_mov_b64 v[26:27], 0
v_mov_b64 v[28:29], 0
v_mov_b64 v[30:31], 0
v_permlane32_swap_b32 v40, v41
v_permlane32_swap_b32 v42, v43
v_add_f32 v40, v40, v41
v_add_f32 v41, v42, v43
v_cvt_pk_bf16_f32 v42, v40, v41
s_cbranch_vccnz k_r1_235
k_ok1_236:
buffer_store_dword v42, v45, s[4:7], s44 offen sc1
s_barrier
buffer_load_dwordx4 v[4:7], v0, s[4:7], s33 offen offset:0 sc1
buffer_load_dwordx4 v[8:11], v0, s[4:7], s33 offen offset:1024 sc1
s_add_u32 s34, s33, 4096
s_add_u32 s35, s33, 8192
s_add_u32 s36, s36, 524288
s_add_u32 s37, s37, 10240
s_add_u32 s59, s59, 10240
s_add_u32 s63, s63, 16384
s_bitset0_b32 s63, 16
v_mov_b64 v[32:33], 0
v_mov_b64 v[34:35], 0
v_mov_b64 v[36:37], 0
v_mov_b64 v[38:39], 0
v_mov_b64 v[40:41], 0
v_mov_b64 v[42:43], 0
v_mov_b64 v[44:45], 0
v_mov_b64 v[46:47], 0
s_add_u32 s44, s44, 16384
s_bitset0_b32 s44, 16
s_sub_u32 s45, s45, 1
s_add_u32 s31, s31, 1
ds_read_b128 v[64:67], v0 offset:36864
ds_read_b128 v[68:71], v0 offset:37888
buffer_load_dwordx4 v[12:15], v0, s[4:7], s34 offen offset:0 sc1
s_cmp_lg_u32 s31, s47
s_cbranch_scc1 k_T0_224
s_branch k_done_234
k_cold2_226:
s_barrier
buffer_load_dwordx4 v[48:51], v0, s[4:7], s60 offen offset:0
buffer_load_dwordx4 v[52:55], v0, s[4:7], s60 offen offset:1024
buffer_load_dwordx4 v[56:59], v0, s[4:7], s60 offen offset:2048
buffer_load_dwordx4 v[60:63], v0, s[4:7], s60 offen offset:3072
ds_read_b128 v[64:67], v0 offset:36864
ds_read_b128 v[68:71], v0 offset:37888
k_cold_225:
buffer_load_dwordx4 v[4:7], v0, s[4:7], s33 offen offset:0 sc1
buffer_load_dwordx4 v[8:11], v0, s[4:7], s33 offen offset:1024 sc1
buffer_load_dwordx4 v[12:15], v0, s[4:7], s34 offen offset:0 sc1
s_sub_u32 s32, s32, 1
s_cmp_gt_i32 s32, 0
s_cbranch_scc0 k_okC_227
v_mov_b64 v[24:25], 0
v_mov_b64 v[26:27], 0
v_mov_b64 v[28:29], 0
v_mov_b64 v[30:31], 0
v_mov_b64 v[32:33], 0
v_mov_b64 v[34:35], 0
v_mov_b64 v[36:37], 0
v_mov_b64 v[38:39], 0
v_mov_b64 v[40:41], 0
v_mov_b64 v[42:43], 0
v_mov_b64 v[44:45], 0
v_mov_b64 v[46:47], 0
s_branch k_T0_224
k_coldA_228:
buffer_load_dwordx4 v[12:15], v0, s[4:7], s34 offen offset:0 sc1
s_sub_u32 s32, s32, 1
s_cmp_gt_i32 s32, 0
s_waitcnt vmcnt(0)
v_cmp_u_f32 vcc, v12, v12
ds_write_b128 v0, v[12:15] offset:2048
s_waitcnt lgkmcnt(0)
s_cbranch_vccz k_okA_229
s_cbranch_scc1 k_coldA_228
s_branch k_okA_229
k_coldB_230:
buffer_load_dwordx4 v[16:19], v0, s[4:7], s35 offen offset:0 sc1
s_sub_u32 s32, s32, 1
s_cmp_gt_i32 s32, 0
s_waitcnt vmcnt(0)
v_cmp_u_f32 vcc, v16, v16
ds_write_b128 v0, v[16:19] offset:6144
s_waitcnt lgkmcnt(0)
s_cbranch_vccz k_okB_231
s_cbranch_scc1 k_coldB_230
s_branch k_okB_231
k_r1_235:
buffer_load_dwordx4 v[24:27], v0, s[4:7], s43 offen offset:0 sc1
buffer_load_dwordx4 v[28:31], v0, s[4:7], s43 offen offset:1024 sc1
buffer_load_dwordx4 v[32:35], v0, s[4:7], s43 offen offset:2048 sc1
buffer_load_dwordx4 v[36:39], v0, s[4:7], s43 offen offset:3072 sc1
s_sub_u32 s32, s32, 1
s_cmp_gt_i32 s32, 0
s_waitcnt vmcnt(3)
v_mfma_f32_16x16x32_bf16 v[40:43], v[24:27], v[16:19], 0
s_waitcnt vmcnt(2)
v_mfma_f32_16x16x32_bf16 v[40:43], v[28:31], v[16:19], v[40:43]
v_bitop3_b32 v46, v24, v28, s45 bitop3:0x7e
s_waitcnt vmcnt(1)
v_mfma_f32_16x16x32_bf16 v[40:43], v[32:35], v[16:19], v[40:43]
s_waitcnt vmcnt(0)
v_mfma_f32_16x16x32_bf16 v[40:43], v[36:39], v[16:19], v[40:43]
v_bitop3_b32 v47, v32, v36, s45 bitop3:0x7e
v_bitop3_b32 v46, v46, v47, 1 bitop3:0xa8
v_cmp_ne_u32 vcc, 0, v46
v_mov_b64 v[24:25], 0
v_mov_b64 v[26:27], 0
v_mov_b64 v[28:29], 0
v_mov_b64 v[30:31], 0
v_permlane32_swap_b32 v40, v41
v_permlane32_swap_b32 v42, v43
v_add_f32 v40, v40, v41
v_add_f32 v41, v42, v43
v_cvt_pk_bf16_f32 v42, v40, v41
s_cbranch_vccz k_ok1_236
s_cbranch_scc1 k_r1_235
s_branch k_ok1_236
k_slow_232:
ds_read_b128 v[24:27], v0 offset:0
ds_read_b128 v[28:31], v0 offset:1024
v_mov_b32 v46, 0xff7fffff
s_add_u32 s48, s36, 0xffffe000
buffer_load_dwordx4 v[32:35], v0, s[4:7], s48 offen offset:0 sc1
buffer_load_dwordx4 v[36:39], v0, s[4:7], s48 offen offset:1024 sc1
s_waitcnt vmcnt(1) lgkmcnt(1)
v_mfma_f32_16x16x32_bf16 v[4:7], v[32:35], v[24:27], 0
s_waitcnt vmcnt(0) lgkmcnt(0)
v_mfma_f32_16x16x32_bf16 v[4:7], v[36:39], v[28:31], v[4:7]
v_mov_b64 v[8:9], s[56:57]
s_nop 5
v_permlane32_swap_b32 v4, v6
v_permlane32_swap_b32 v5, v7
v_add_f32_dpp v8, v6, v4 row_ror:8 row_mask:0xf bank_mask:0x3
s_nop 0
v_add_f32_dpp v9, v7, v5 row_ror:8 row_mask:0xf bank_mask:0x3
v_max3_f32 v46, v46, v8, v9
s_add_u32 s48, s36, 0xfffff000
buffer_load_dwordx4 v[32:35], v0, s[4:7], s48 offen offset:0 sc1
buffer_load_dwordx4 v[36:39], v0, s[4:7], s48 offen offset:1024 sc1
s_waitcnt vmcnt(1)
v_mfma_f32_16x16x32_bf16 v[4:7], v[32:35], v[24:27], 0
s_waitcnt vmcnt(0)
v_mfma_f32_16x16x32_bf16 v[4:7], v[36:39], v[28:31], v[4:7]
v_mov_b64 v[10:11], s[56:57]
s_nop 5
v_permlane32_swap_b32 v4, v6
v_permlane32_swap_b32 v5, v7
v_add_f32_dpp v10, v6, v4 row_ror:8 row_mask:0xf bank_mask:0x3
s_nop 0
v_add_f32_dpp v11, v7, v5 row_ror:8 row_mask:0xf bank_mask:0x3
v_max3_f32 v46, v46, v10, v11
s_add_u32 s48, s36, 0x0
buffer_load_dwordx4 v[32:35], v0, s[4:7], s48 offen offset:0 sc1
buffer_load_dwordx4 v[36:39], v0, s[4:7], s48 offen offset:1024 sc1
s_waitcnt vmcnt(1)
v_mfma_f32_16x16x32_bf16 v[4:7], v[32:35], v[24:27], 0
s_waitcnt vmcnt(0)
v_mfma_f32_16x16x32_bf16 v[4:7], v[36:39], v[28:31], v[4:7]
v_mov_b64 v[12:13], s[56:57]
s_nop 5
v_permlane32_swap_b32 v4, v6
v_permlane32_swap_b32 v5, v7
v_add_f32_dpp v12, v6, v4 row_ror:8 row_mask:0xf bank_mask:0x3
s_nop 0
v_add_f32_dpp v13, v7, v5 row_ror:8 row_mask:0xf bank_mask:0x3
v_max3_f32 v46, v46, v12, v13
s_add_u32 s48, s36, 0x1000
buffer_load_dwordx4 v[32:35], v0, s[4:7], s48 offen offset:0 sc1
buffer_load_dwordx4 v[36:39], v0, s[4:7], s48 offen offset:1024 sc1
s_waitcnt vmcnt(1)
v_mfma_f32_16x16x32_bf16 v[4:7], v[32:35], v[24:27], 0
s_waitcnt vmcnt(0)
v_mfma_f32_16x16x32_bf16 v[4:7], v[36:39], v[28:31], v[4:7]
v_mov_b64 v[14:15], s[56:57]
s_nop 5
v_permlane32_swap_b32 v4, v6
v_permlane32_swap_b32 v5, v7
v_add_f32_dpp v14, v6, v4 row_ror:8 row_mask:0xf bank_mask:0x3
s_nop 0
v_add_f32_dpp v15, v7, v5 row_ror:8 row_mask:0xf bank_mask:0x3
v_max3_f32 v46, v46, v14, v15
ds_read_b128 v[32:35], v0 offset:2048
ds_read_b128 v[36:39], v0 offset:3072
s_waitcnt lgkmcnt(1)
v_mfma_f32_16x16x32_bf16 v[4:7], v[32:35], v[24:27], 0
s_waitcnt lgkmcnt(0)
v_mfma_f32_16x16x32_bf16 v[4:7], v[36:39], v[28:31], v[4:7]
v_mov_b64 v[44:45], s[56:57]
s_nop 5
v_permlane32_swap_b32 v4, v6
v_permlane32_swap_b32 v5, v7
v_add_f32_dpp v44, v6, v4 row_ror:8 row_mask:0xf bank_mask:0x3
s_nop 0
v_add_f32_dpp v45, v7, v5 row_ror:8 row_mask:0xf bank_mask:0x3
v_max3_f32 v46, v46, v44, v45
buffer_load_dwordx4 v[32:35], v0, s[4:7], s36 offen offset:2048 sc1
buffer_load_dwordx4 v[36:39], v0, s[4:7], s36 offen offset:3072 sc1
v_mov_b32 v47, v46
s_nop 1
v_permlane32_swap_b32 v46, v47
v_max_f32 v46, v46, v47
v_mov_b32 v47, v46
s_nop 1
v_permlane16_swap_b32 v46, v47
v_max_f32 v46, v46, v47
v_sub_f32 v8, v8, v46
v_exp_f32 v8, v8
v_sub_f32 v9, v9, v46
v_exp_f32 v9, v9
v_sub_f32 v10, v10, v46
v_exp_f32 v10, v10
v_sub_f32 v11, v11, v46
v_exp_f32 v11, v11
v_sub_f32 v12, v12, v46
v_exp_f32 v12, v12
v_sub_f32 v13, v13, v46
v_exp_f32 v13, v13
v_sub_f32 v14, v14, v46
v_exp_f32 v14, v14
v_sub_f32 v15, v15, v46
v_exp_f32 v15, v15
v_sub_f32 v44, v44, v46
v_exp_f32 v44, v44
v_sub_f32 v45, v45, v46
v_exp_f32 v45, v45
v_cvt_pk_bf16_f32 v4, v8, v9
v_cvt_pk_bf16_f32 v5, v10, v11
v_cvt_pk_bf16_f32 v6, v12, v13
v_cvt_pk_bf16_f32 v7, v14, v15
v_mov_b32_dpp v8, v4 row_ror:8 row_mask:0xf bank_mask:0xf
v_mov_b32_dpp v9, v5 row_ror:8 row_mask:0xf bank_mask:0xf
v_mov_b32_dpp v10, v6 row_ror:8 row_mask:0xf bank_mask:0xf
v_mov_b32_dpp v11, v7 row_ror:8 row_mask:0xf bank_mask:0xf
v_cvt_pk_bf16_f32 v24, v44, v45
v_cvt_pk_bf16_f32 v25, v44, v45
s_nop 0
v_mov_b32_dpp v26, v24 row_ror:8 row_mask:0xf bank_mask:0xf
v_mov_b32_dpp v27, v24 row_ror:8 row_mask:0xf bank_mask:0xf
v_mov_b64 v[28:29], s[52:53]
v_mov_b64 v[30:31], s[52:53]
s_nop 1
v_mfma_f32_16x16x32_bf16 v[44:47], v[28:31], v[4:7], 0
s_waitcnt vmcnt(1)
v_mfma_f32_16x16x32_bf16 v[12:15], v[32:35], v[4:7], 0
s_waitcnt vmcnt(0)
v_mfma_f32_16x16x32_bf16 v[12:15], v[36:39], v[8:11], v[12:15]
v_mfma_f32_16x16x32_bf16 v[12:15], v[40:43], v[24:27], v[12:15]
v_mov_b64 v[28:29], s[54:55]
s_nop 1
v_mfma_f32_16x16x16_bf16 v[44:47], v[28:29], v[24:25], v[44:47]
s_nop 6
v_rcp_f32 v4, v44
s_nop 1
v_rcp_f32_dpp v4, v44 row_ror:8 row_mask:0xf bank_mask:0xc
s_nop 0
v_mul_f32 v12, v4, v12
v_mul_f32 v13, v4, v13
v_mul_f32 v14, v4, v14
v_mul_f32 v15, v4, v15
v_cvt_pk_bf16_f32 v44, v12, v13
v_cvt_pk_bf16_f32 v45, v14, v15
v_and_b32 v12, 0xffffff7f, v0
v_and_or_b32 v8, v1, 8, v12
ds_write_b64 v8, v[44:45] offset:7168
v_mov_b32_dpp v46, v44 row_ror:8 row_mask:0xf bank_mask:0xf
v_mov_b32_dpp v47, v45 row_ror:8 row_mask:0xf bank_mask:0xf
v_mov_b64 v[24:25], 0
v_mov_b64 v[26:27], 0
v_mov_b64 v[28:29], 0
v_mov_b64 v[30:31], 0
v_mov_b64 v[32:33], 0
v_mov_b64 v[34:35], 0
v_mov_b64 v[36:37], 0
v_mov_b64 v[38:39], 0
s_waitcnt lgkmcnt(0)
s_branch k_okS_233
k_done_234:
buffer_load_dwordx4 v[16:19], v0, s[4:7], s35 offen offset:0 sc1
k_xs_240:
s_waitcnt vmcnt(1)
v_cmp_u_f32 vcc, v4, v12
s_waitcnt vmcnt(0)
v_cmp_u_f32 s[66:67], v16, v16
s_or_b64 vcc, vcc, s[66:67]
s_cbranch_vccz k_xd_241
buffer_load_dwordx4 v[4:7], v0, s[4:7], s33 offen offset:0 sc1
buffer_load_dwordx4 v[8:11], v0, s[4:7], s33 offen offset:1024 sc1
buffer_load_dwordx4 v[12:15], v0, s[4:7], s34 offen offset:0 sc1
buffer_load_dwordx4 v[16:19], v0, s[4:7], s35 offen offset:0 sc1
s_sub_u32 s32, s32, 1
s_cmp_gt_i32 s32, 0
s_cbranch_scc1 k_xs_240
k_xd_241:
s_waitcnt vmcnt(1)
buffer_store_dwordx4 v[12:15], v0, s[8:11], s37 offen offset:2048 sc1
s_waitcnt vmcnt(1)
buffer_store_dwordx4 v[16:19], v0, s[8:11], s59 offen offset:2048 sc1
s_add_u32 s31, s31, 1
k_jn_205:
s_cmp_lt_u32 s31, 128
s_cbranch_scc1 k_lay_203
s_add_u32 s30, s30, 112
s_waitcnt vmcnt(0) lgkmcnt(0)
s_barrier
s_branch k_fin_7
k_w3_114:
v_lshrrev_b32 v12, 3, v0
v_lshlrev_b32 v10, 13, v12
v_bfe_u32 v12, v0, 1, 2
v_lshrrev_b32 v13, 4, v0
v_xor_b32 v12, v12, v13
v_lshl_add_u32 v10, v12, 5, v10
v_and_b32 v14, 1, v0
v_lshl_add_u32 v10, v14, 4, v10
v_mul_u32_u24 v11, 1280, v13
v_bfe_u32 v12, v0, 1, 3
v_and_b32 v13, 1, v13
v_lshlrev_b32 v13, 1, v13
v_xor_b32 v12, v12, v13
v_xor_b32 v12, 4, v12
v_lshl_add_u32 v11, v12, 5, v11
v_lshl_add_u32 v11, v14, 4, v11
v_bfe_u32 v12, v0, 5, 1
v_lshlrev_b32 v12, 4, v12
v_bfe_u32 v13, v0, 4, 1
v_lshl_add_u32 v12, v13, 1, v12
v_bfe_u32 v13, v0, 2, 1
v_lshl_add_u32 v12, v13, 2, v12
v_bfe_u32 v13, v0, 3, 1
v_mul_u32_u24 v15, 4224, v13
v_add_u32 v12, v13, v12
v_bfe_u32 v13, v12, 1, 2
v_xor_b32 v13, 3, v13
v_lshlrev_b32 v13, 5, v13
v_lshl_add_u32 v4, v12, 7, v13
v_and_b32 v14, 3, v0
v_lshl_add_u32 v4, v14, 3, v4
v_add_u32 v5, 0x10000, v4
v_add_u32 v6, 0x20000, v4
v_bfe_u32 v12, v0, 4, 1
v_lshlrev_b32 v13, 4, v12
v_lshlrev_b32 v12, 2, v12
v_bfe_u32 v8, v0, 5, 1
v_lshl_add_u32 v13, v8, 2, v13
v_bfe_u32 v8, v0, 2, 1
v_add_u32 v13, v8, v13
v_lshl_add_u32 v12, v8, 1, v12
v_bfe_u32 v8, v0, 3, 1
v_add_u32 v8, 6, v8
v_xor_b32 v12, v12, v8
v_lshlrev_b32 v12, 5, v12
v_lshl_add_u32 v7, v13, 8, v12
v_lshl_add_u32 v7, v14, 3, v7
v_add_u32 v8, 0x10000, v7
v_add_u32 v9, 0x20000, v7
v_lshlrev_b32 v0, 4, v0
v_add_u32 v2, 65536, v0
s_lshl_b32 s49, s30, 8
s_mul_i32 s50, s30, 163840
s_mul_i32 s60, s30, 131072
s_add_u32 s60, s60, 120684544
s_add_u32 s61, s60, 4096
s_add_u32 s62, s60, 8192
s_mov_b32 m0, 6144
s_add_u32 s48, s49, 393216
buffer_load_dwordx4 v10, s[8:11], s48 offen lds
s_mov_b32 m0, 7168
s_add_u32 s48, s49, 458752
buffer_load_dwordx4 v10, s[8:11], s48 offen lds
s_mov_b32 m0, 14336
s_add_u32 s48, s49, 393344
buffer_load_dwordx4 v10, s[8:11], s48 offen lds
s_mov_b32 m0, 15360
s_add_u32 s48, s49, 458880
buffer_load_dwordx4 v10, s[8:11], s48 offen lds
s_mov_b32 m0, 22528
s_add_u32 s48, s49, 393344
buffer_load_dwordx4 v10, s[12:15], s48 offen lds
s_mov_b32 m0, 23552
s_add_u32 s48, s49, 458880
buffer_load_dwordx4 v10, s[12:15], s48 offen lds
s_mov_b32 m0, 30720
s_add_u32 s48, s49, 393216
buffer_load_dwordx4 v10, s[16:19], s48 offen lds
s_mov_b32 m0, 31744
s_add_u32 s48, s49, 458752
buffer_load_dwordx4 v10, s[16:19], s48 offen lds
s_mov_b32 m0, 38912
s_add_u32 s48, s49, 393344
buffer_load_dwordx4 v10, s[16:19], s48 offen lds
s_mov_b32 m0, 39936
s_add_u32 s48, s49, 458880
buffer_load_dwordx4 v10, s[16:19], s48 offen lds
s_mov_b32 m0, 47104
s_add_u32 s48, s49, 917504
buffer_load_dwordx4 v10, s[8:11], s48 offen lds
s_mov_b32 m0, 48128
s_add_u32 s48, s49, 983040
buffer_load_dwordx4 v10, s[8:11], s48 offen lds
s_mov_b32 m0, 55296
s_add_u32 s48, s49, 917632
buffer_load_dwordx4 v10, s[8:11], s48 offen lds
s_mov_b32 m0, 56320
s_add_u32 s48, s49, 983168
buffer_load_dwordx4 v10, s[8:11], s48 offen lds
s_mov_b32 m0, 63488
s_add_u32 s48, s49, 917632
buffer_load_dwordx4 v10, s[12:15], s48 offen lds
s_mov_b32 m0, 64512
s_add_u32 s48, s49, 983168
buffer_load_dwordx4 v10, s[12:15], s48 offen lds
s_mov_b32 m0, 71680
s_add_u32 s48, s49, 917504
buffer_load_dwordx4 v10, s[16:19], s48 offen lds
s_mov_b32 m0, 72704
s_add_u32 s48, s49, 983040
buffer_load_dwordx4 v10, s[16:19], s48 offen lds
s_mov_b32 m0, 79872
s_add_u32 s48, s49, 917632
buffer_load_dwordx4 v10, s[16:19], s48 offen lds
s_mov_b32 m0, 80896
s_add_u32 s48, s49, 983168
buffer_load_dwordx4 v10, s[16:19], s48 offen lds
s_mov_b32 m0, 88064
s_add_u32 s48, s49, 1441792
buffer_load_dwordx4 v10, s[8:11], s48 offen lds
s_mov_b32 m0, 89088
s_add_u32 s48, s49, 1507328
buffer_load_dwordx4 v10, s[8:11], s48 offen lds
s_mov_b32 m0, 96256
s_add_u32 s48, s49, 1441920
buffer_load_dwordx4 v10, s[8:11], s48 offen lds
s_mov_b32 m0, 97280
s_add_u32 s48, s49, 1507456
buffer_load_dwordx4 v10, s[8:11], s48 offen lds
s_mov_b32 m0, 104448
s_add_u32 s48, s49, 1441920
buffer_load_dwordx4 v10, s[12:15], s48 offen lds
s_mov_b32 m0, 105472
s_add_u32 s48, s49, 1507456
buffer_load_dwordx4 v10, s[12:15], s48 offen lds
s_mov_b32 m0, 112640
s_add_u32 s48, s49, 1441792
buffer_load_dwordx4 v10, s[16:19], s48 offen lds
s_mov_b32 m0, 113664
s_add_u32 s48, s49, 1507328
buffer_load_dwordx4 v10, s[16:19], s48 offen lds
s_mov_b32 m0, 120832
s_add_u32 s48, s49, 1966080
buffer_load_dwordx4 v10, s[8:11], s48 offen lds
s_mov_b32 m0, 121856
s_add_u32 s48, s49, 2031616
buffer_load_dwordx4 v10, s[8:11], s48 offen lds
s_mov_b32 m0, 129024
s_add_u32 s48, s49, 1966208
buffer_load_dwordx4 v10, s[8:11], s48 offen lds
s_mov_b32 m0, 130048
s_add_u32 s48, s49, 2031744
buffer_load_dwordx4 v10, s[8:11], s48 offen lds
s_waitcnt vmcnt(24)
s_barrier
s_mov_b32 m0, 137216
s_add_u32 s48, s49, 1966208
buffer_load_dwordx4 v10, s[12:15], s48 offen lds
s_mov_b32 m0, 138240
s_add_u32 s48, s49, 2031744
buffer_load_dwordx4 v10, s[12:15], s48 offen lds
s_mov_b32 m0, 145408
s_add_u32 s48, s49, 1966080
buffer_load_dwordx4 v10, s[16:19], s48 offen lds
s_mov_b32 m0, 146432
s_add_u32 s48, s49, 2031616
buffer_load_dwordx4 v10, s[16:19], s48 offen lds
s_mov_b32 m0, 153600
s_add_u32 s48, s49, 2490368
buffer_load_dwordx4 v10, s[8:11], s48 offen lds
s_mov_b32 m0, 154624
s_add_u32 s48, s49, 2555904
buffer_load_dwordx4 v10, s[8:11], s48 offen lds
s_mov_b32 m0, 161792
s_add_u32 s48, s49, 2490496
buffer_load_dwordx4 v10, s[8:11], s48 offen lds
s_mov_b32 m0, 162816
s_add_u32 s48, s49, 2556032
buffer_load_dwordx4 v10, s[8:11], s48 offen lds
ds_read_b64_tr_b16 a[24:25], v4 offset:0
ds_read_b64_tr_b16 a[26:27], v4 offset:1024
ds_read_b64_tr_b16 a[28:29], v4 offset:4096
ds_read_b64_tr_b16 a[30:31], v4 offset:5120
ds_read_b64_tr_b16 a[32:33], v4 offset:8192
ds_read_b64_tr_b16 a[34:35], v4 offset:9216
ds_read_b64_tr_b16 a[36:37], v4 offset:12288
ds_read_b64_tr_b16 a[38:39], v4 offset:13312
ds_read_b64_tr_b16 a[40:41], v4 offset:16384
ds_read_b64_tr_b16 a[42:43], v4 offset:17408
ds_read_b64_tr_b16 a[44:45], v4 offset:20480
ds_read_b64_tr_b16 a[46:47], v4 offset:21504
ds_read_b64_tr_b16 a[176:177], v4 offset:24576
ds_read_b64_tr_b16 a[178:179], v4 offset:25600
ds_read_b64_tr_b16 a[180:181], v4 offset:28672
ds_read_b64_tr_b16 a[182:183], v4 offset:29696
s_waitcnt lgkmcnt(0)
s_waitcnt vmcnt(24)
s_barrier
s_mov_b32 m0, 6144
s_add_u32 s48, s49, 2490496
buffer_load_dwordx4 v10, s[12:15], s48 offen lds
s_mov_b32 m0, 7168
s_add_u32 s48, s49, 2556032
buffer_load_dwordx4 v10, s[12:15], s48 offen lds
s_mov_b32 m0, 14336
s_add_u32 s48, s49, 2490368
buffer_load_dwordx4 v10, s[16:19], s48 offen lds
s_mov_b32 m0, 15360
s_add_u32 s48, s49, 2555904
buffer_load_dwordx4 v10, s[16:19], s48 offen lds
s_mov_b32 m0, 22528
s_add_u32 s48, s49, 3014656
buffer_load_dwordx4 v10, s[8:11], s48 offen lds
s_mov_b32 m0, 23552
s_add_u32 s48, s49, 3080192
buffer_load_dwordx4 v10, s[8:11], s48 offen lds
s_mov_b32 m0, 30720
s_add_u32 s48, s49, 3014784
buffer_load_dwordx4 v10, s[8:11], s48 offen lds
s_mov_b32 m0, 31744
s_add_u32 s48, s49, 3080320
buffer_load_dwordx4 v10, s[8:11], s48 offen lds
ds_read_b64_tr_b16 v[224:225], v4 offset:32768
ds_read_b64_tr_b16 v[226:227], v4 offset:33792
ds_read_b64_tr_b16 v[228:229], v4 offset:36864
ds_read_b64_tr_b16 v[230:231], v4 offset:37888
ds_read_b64_tr_b16 a[0:1], v4 offset:40960
ds_read_b64_tr_b16 a[2:3], v4 offset:41984
ds_read_b64_tr_b16 a[4:5], v4 offset:45056
ds_read_b64_tr_b16 a[6:7], v4 offset:46080
ds_read_b64_tr_b16 a[8:9], v4 offset:49152
ds_read_b64_tr_b16 a[10:11], v4 offset:50176
ds_read_b64_tr_b16 a[12:13], v4 offset:53248
ds_read_b64_tr_b16 a[14:15], v4 offset:54272
ds_read_b64_tr_b16 a[16:17], v4 offset:57344
ds_read_b64_tr_b16 a[18:19], v4 offset:58368
ds_read_b64_tr_b16 a[20:21], v4 offset:61440
ds_read_b64_tr_b16 a[22:23], v4 offset:62464
s_waitcnt lgkmcnt(0)
s_waitcnt vmcnt(24)
s_barrier
s_mov_b32 m0, 38912
s_add_u32 s48, s49, 3014784
buffer_load_dwordx4 v10, s[12:15], s48 offen lds
s_mov_b32 m0, 39936
s_add_u32 s48, s49, 3080320
buffer_load_dwordx4 v10, s[12:15], s48 offen lds
s_mov_b32 m0, 47104
s_add_u32 s48, s49, 3014656
buffer_load_dwordx4 v10, s[16:19], s48 offen lds
s_mov_b32 m0, 48128
s_add_u32 s48, s49, 3080192
buffer_load_dwordx4 v10, s[16:19], s48 offen lds
s_mov_b32 m0, 55296
s_add_u32 s48, s49, 3539072
buffer_load_dwordx4 v10, s[8:11], s48 offen lds
s_mov_b32 m0, 56320
s_add_u32 s48, s49, 3604608
buffer_load_dwordx4 v10, s[8:11], s48 offen lds
s_mov_b32 m0, 63488
s_add_u32 s48, s49, 4063232
buffer_load_dwordx4 v10, s[8:11], s48 offen lds
s_mov_b32 m0, 64512
s_add_u32 s48, s49, 4128768
buffer_load_dwordx4 v10, s[8:11], s48 offen lds
ds_read_b64_tr_b16 v[16:17], v5 offset:0
ds_read_b64_tr_b16 v[18:19], v5 offset:1024
ds_read_b64_tr_b16 v[20:21], v5 offset:4096
ds_read_b64_tr_b16 v[22:23], v5 offset:5120
ds_read_b64_tr_b16 v[24:25], v5 offset:8192
ds_read_b64_tr_b16 v[26:27], v5 offset:9216
ds_read_b64_tr_b16 v[28:29], v5 offset:12288
ds_read_b64_tr_b16 v[30:31], v5 offset:13312
ds_read_b64_tr_b16 a[80:81], v5 offset:16384
ds_read_b64_tr_b16 a[82:83], v5 offset:17408
ds_read_b64_tr_b16 a[84:85], v5 offset:20480
ds_read_b64_tr_b16 a[86:87], v5 offset:21504
ds_read_b64_tr_b16 a[88:89], v5 offset:24576
ds_read_b64_tr_b16 a[90:91], v5 offset:25600
ds_read_b64_tr_b16 a[92:93], v5 offset:28672
ds_read_b64_tr_b16 a[94:95], v5 offset:29696
s_waitcnt lgkmcnt(0)
buffer_store_dwordx4 v[16:19], v0, s[4:7], s60 offen offset:0
buffer_store_dwordx4 v[20:23], v0, s[4:7], s60 offen offset:1024
buffer_store_dwordx4 v[24:27], v0, s[4:7], s60 offen offset:2048
buffer_store_dwordx4 v[28:31], v0, s[4:7], s60 offen offset:3072
s_waitcnt vmcnt(28)
s_barrier
s_mov_b32 m0, 71680
s_add_u32 s48, s49, 4063360
buffer_load_dwordx4 v10, s[8:11], s48 offen lds
s_mov_b32 m0, 72704
s_add_u32 s48, s49, 4128896
buffer_load_dwordx4 v10, s[8:11], s48 offen lds
s_mov_b32 m0, 79872
s_add_u32 s48, s49, 4587520
buffer_load_dwordx4 v10, s[8:11], s48 offen lds
s_mov_b32 m0, 80896
s_add_u32 s48, s49, 4653056
buffer_load_dwordx4 v10, s[8:11], s48 offen lds
s_mov_b32 m0, 88064
s_add_u32 s48, s49, 4587648
buffer_load_dwordx4 v10, s[8:11], s48 offen lds
s_mov_b32 m0, 89088
s_add_u32 s48, s49, 4653184
buffer_load_dwordx4 v10, s[8:11], s48 offen lds
s_mov_b32 m0, 96256
s_add_u32 s48, s49, 5111808
buffer_load_dwordx4 v10, s[8:11], s48 offen lds
s_mov_b32 m0, 97280
s_add_u32 s48, s49, 5177344
buffer_load_dwordx4 v10, s[8:11], s48 offen lds
ds_read_b64_tr_b16 a[96:97], v5 offset:32768
ds_read_b64_tr_b16 a[98:99], v5 offset:33792
ds_read_b64_tr_b16 a[100:101], v5 offset:36864
ds_read_b64_tr_b16 a[102:103], v5 offset:37888
ds_read_b64_tr_b16 a[104:105], v5 offset:40960
ds_read_b64_tr_b16 a[106:107], v5 offset:41984
ds_read_b64_tr_b16 a[108:109], v5 offset:45056
ds_read_b64_tr_b16 a[110:111], v5 offset:46080
ds_read_b64_tr_b16 a[112:113], v5 offset:49152
ds_read_b64_tr_b16 a[114:115], v5 offset:50176
ds_read_b64_tr_b16 a[116:117], v5 offset:53248
ds_read_b64_tr_b16 a[118:119], v5 offset:54272
ds_read_b64_tr_b16 a[120:121], v5 offset:57344
ds_read_b64_tr_b16 a[122:123], v5 offset:58368
ds_read_b64_tr_b16 a[124:125], v5 offset:61440
ds_read_b64_tr_b16 a[126:127], v5 offset:62464
s_waitcnt lgkmcnt(0)
s_waitcnt vmcnt(28)
s_barrier
s_mov_b32 m0, 104448
s_add_u32 s48, s49, 5111936
buffer_load_dwordx4 v10, s[8:11], s48 offen lds
s_mov_b32 m0, 105472
s_add_u32 s48, s49, 5177472
buffer_load_dwordx4 v10, s[8:11], s48 offen lds
s_mov_b32 m0, 112640
s_add_u32 s48, s49, 3538944
buffer_load_dwordx4 v10, s[12:15], s48 offen lds
s_mov_b32 m0, 113664
s_add_u32 s48, s49, 3604480
buffer_load_dwordx4 v10, s[12:15], s48 offen lds
s_mov_b32 m0, 120832
s_add_u32 s48, s49, 3539072
buffer_load_dwordx4 v10, s[12:15], s48 offen lds
s_mov_b32 m0, 121856
s_add_u32 s48, s49, 3604608
buffer_load_dwordx4 v10, s[12:15], s48 offen lds
s_mov_b32 m0, 129024
s_add_u32 s48, s49, 4063232
buffer_load_dwordx4 v10, s[12:15], s48 offen lds
s_mov_b32 m0, 130048
s_add_u32 s48, s49, 4128768
buffer_load_dwordx4 v10, s[12:15], s48 offen lds
ds_read_b64_tr_b16 a[128:129], v6 offset:0
ds_read_b64_tr_b16 a[130:131], v6 offset:1024
ds_read_b64_tr_b16 a[132:133], v6 offset:4096
ds_read_b64_tr_b16 a[134:135], v6 offset:5120
ds_read_b64_tr_b16 a[136:137], v6 offset:8192
ds_read_b64_tr_b16 a[138:139], v6 offset:9216
ds_read_b64_tr_b16 a[140:141], v6 offset:12288
ds_read_b64_tr_b16 a[142:143], v6 offset:13312
ds_read_b64_tr_b16 a[144:145], v6 offset:16384
ds_read_b64_tr_b16 a[146:147], v6 offset:17408
ds_read_b64_tr_b16 a[148:149], v6 offset:20480
ds_read_b64_tr_b16 a[150:151], v6 offset:21504
ds_read_b64_tr_b16 a[152:153], v6 offset:24576
ds_read_b64_tr_b16 a[154:155], v6 offset:25600
ds_read_b64_tr_b16 a[156:157], v6 offset:28672
ds_read_b64_tr_b16 a[158:159], v6 offset:29696
s_waitcnt lgkmcnt(0)
s_waitcnt vmcnt(28)
s_barrier
s_mov_b32 m0, 137216
s_add_u32 s48, s49, 4063360
buffer_load_dwordx4 v10, s[12:15], s48 offen lds
s_mov_b32 m0, 138240
s_add_u32 s48, s49, 4128896
buffer_load_dwordx4 v10, s[12:15], s48 offen lds
s_mov_b32 m0, 145408
s_add_u32 s48, s49, 4587520
buffer_load_dwordx4 v10, s[12:15], s48 offen lds
s_mov_b32 m0, 146432
s_add_u32 s48, s49, 4653056
buffer_load_dwordx4 v10, s[12:15], s48 offen lds
s_mov_b32 m0, 153600
s_add_u32 s48, s49, 4587648
buffer_load_dwordx4 v10, s[12:15], s48 offen lds
s_mov_b32 m0, 154624
s_add_u32 s48, s49, 4653184
buffer_load_dwordx4 v10, s[12:15], s48 offen lds
s_mov_b32 m0, 161792
s_add_u32 s48, s49, 5111808
buffer_load_dwordx4 v10, s[12:15], s48 offen lds
s_mov_b32 m0, 162816
s_add_u32 s48, s49, 5177344
buffer_load_dwordx4 v10, s[12:15], s48 offen lds
ds_read_b64_tr_b16 a[160:161], v4 offset:0
ds_read_b64_tr_b16 a[162:163], v4 offset:1024
ds_read_b64_tr_b16 a[164:165], v4 offset:4096
ds_read_b64_tr_b16 a[166:167], v4 offset:5120
ds_read_b64_tr_b16 a[168:169], v4 offset:8192
ds_read_b64_tr_b16 a[170:171], v4 offset:9216
ds_read_b64_tr_b16 a[172:173], v4 offset:12288
ds_read_b64_tr_b16 a[174:175], v4 offset:13312
ds_read_b64_tr_b16 a[48:49], v4 offset:16384
ds_read_b64_tr_b16 a[50:51], v4 offset:17408
ds_read_b64_tr_b16 a[52:53], v4 offset:20480
ds_read_b64_tr_b16 a[54:55], v4 offset:21504
ds_read_b64_tr_b16 a[56:57], v4 offset:24576
ds_read_b64_tr_b16 a[58:59], v4 offset:25600
ds_read_b64_tr_b16 a[60:61], v4 offset:28672
ds_read_b64_tr_b16 a[62:63], v4 offset:29696
s_waitcnt lgkmcnt(0)
s_waitcnt vmcnt(28)
s_barrier
s_mov_b32 m0, 6144
s_add_u32 s48, s49, 5111936
buffer_load_dwordx4 v10, s[12:15], s48 offen lds
s_mov_b32 m0, 7168
s_add_u32 s48, s49, 5177472
buffer_load_dwordx4 v10, s[12:15], s48 offen lds
s_mov_b32 m0, 14336
s_add_u32 s48, s49, 3538944
buffer_load_dwordx4 v10, s[16:19], s48 offen lds
s_mov_b32 m0, 15360
s_add_u32 s48, s49, 3604480
buffer_load_dwordx4 v10, s[16:19], s48 offen lds
s_mov_b32 m0, 22528
s_add_u32 s48, s49, 3539072
buffer_load_dwordx4 v10, s[16:19], s48 offen lds
s_mov_b32 m0, 23552
s_add_u32 s48, s49, 3604608
buffer_load_dwordx4 v10, s[16:19], s48 offen lds
s_mov_b32 m0, 30720
s_add_u32 s48, s49, 4063232
buffer_load_dwordx4 v10, s[16:19], s48 offen lds
s_mov_b32 m0, 31744
s_add_u32 s48, s49, 4128768
buffer_load_dwordx4 v10, s[16:19], s48 offen lds
ds_read_b64_tr_b16 a[64:65], v4 offset:32768
ds_read_b64_tr_b16 a[66:67], v4 offset:33792
ds_read_b64_tr_b16 a[68:69], v4 offset:36864
ds_read_b64_tr_b16 a[70:71], v4 offset:37888
ds_read_b64_tr_b16 a[72:73], v4 offset:40960
ds_read_b64_tr_b16 a[74:75], v4 offset:41984
ds_read_b64_tr_b16 a[76:77], v4 offset:45056
ds_read_b64_tr_b16 a[78:79], v4 offset:46080
ds_read_b64_tr_b16 a[200:201], v4 offset:49152
ds_read_b64_tr_b16 a[202:203], v4 offset:50176
ds_read_b64_tr_b16 a[204:205], v4 offset:53248
ds_read_b64_tr_b16 a[206:207], v4 offset:54272
ds_read_b64_tr_b16 a[208:209], v4 offset:57344
ds_read_b64_tr_b16 a[210:211], v4 offset:58368
ds_read_b64_tr_b16 a[212:213], v4 offset:61440
ds_read_b64_tr_b16 a[214:215], v4 offset:62464
s_waitcnt lgkmcnt(0)
s_waitcnt vmcnt(24)
s_barrier
s_mov_b32 m0, 38912
s_add_u32 s48, s49, 4063360
buffer_load_dwordx4 v10, s[16:19], s48 offen lds
s_mov_b32 m0, 39936
s_add_u32 s48, s49, 4128896
buffer_load_dwordx4 v10, s[16:19], s48 offen lds
s_mov_b32 m0, 47104
s_add_u32 s48, s49, 4587520
buffer_load_dwordx4 v10, s[16:19], s48 offen lds
s_mov_b32 m0, 48128
s_add_u32 s48, s49, 4653056
buffer_load_dwordx4 v10, s[16:19], s48 offen lds
s_mov_b32 m0, 55296
s_add_u32 s48, s49, 4587648
buffer_load_dwordx4 v10, s[16:19], s48 offen lds
s_mov_b32 m0, 56320
s_add_u32 s48, s49, 4653184
buffer_load_dwordx4 v10, s[16:19], s48 offen lds
s_mov_b32 m0, 63488
s_add_u32 s48, s49, 5111808
buffer_load_dwordx4 v10, s[16:19], s48 offen lds
s_mov_b32 m0, 64512
s_add_u32 s48, s49, 5177344
buffer_load_dwordx4 v10, s[16:19], s48 offen lds
ds_read_b64_tr_b16 a[216:217], v5 offset:0
ds_read_b64_tr_b16 a[218:219], v5 offset:1024
ds_read_b64_tr_b16 a[220:221], v5 offset:4096
ds_read_b64_tr_b16 a[222:223], v5 offset:5120
ds_read_b64_tr_b16 a[224:225], v5 offset:8192
ds_read_b64_tr_b16 a[226:227], v5 offset:9216
ds_read_b64_tr_b16 a[228:229], v5 offset:12288
ds_read_b64_tr_b16 a[230:231], v5 offset:13312
ds_read_b64_tr_b16 a[232:233], v5 offset:16384
ds_read_b64_tr_b16 a[234:235], v5 offset:17408
ds_read_b64_tr_b16 a[236:237], v5 offset:20480
ds_read_b64_tr_b16 a[238:239], v5 offset:21504
ds_read_b64_tr_b16 a[184:185], v5 offset:24576
ds_read_b64_tr_b16 a[186:187], v5 offset:25600
ds_read_b64_tr_b16 a[188:189], v5 offset:28672
ds_read_b64_tr_b16 a[190:191], v5 offset:29696
s_waitcnt lgkmcnt(0)
s_waitcnt vmcnt(24)
s_barrier
s_mov_b32 m0, 71680
s_add_u32 s48, s49, 5111936
buffer_load_dwordx4 v10, s[16:19], s48 offen lds
s_mov_b32 m0, 72704
s_add_u32 s48, s49, 5177472
buffer_load_dwordx4 v10, s[16:19], s48 offen lds
s_mov_b32 m0, 79872
s_add_u32 s48, s50, 92160
buffer_load_dwordx4 v11, s[20:23], s48 offen lds
s_mov_b32 m0, 80896
s_add_u32 s48, s50, 97280
buffer_load_dwordx4 v11, s[20:23], s48 offen lds
s_mov_b32 m0, 88064
s_add_u32 s48, s50, 112640
buffer_load_dwordx4 v11, s[20:23], s48 offen lds
s_mov_b32 m0, 89088
s_add_u32 s48, s50, 117760
buffer_load_dwordx4 v11, s[20:23], s48 offen lds
s_mov_b32 m0, 96256
s_add_u32 s48, s50, 133120
buffer_load_dwordx4 v11, s[20:23], s48 offen lds
s_mov_b32 m0, 97280
s_add_u32 s48, s50, 138240
buffer_load_dwordx4 v11, s[20:23], s48 offen lds
ds_read_b64_tr_b16 a[192:193], v5 offset:32768
ds_read_b64_tr_b16 a[194:195], v5 offset:33792
ds_read_b64_tr_b16 a[196:197], v5 offset:36864
ds_read_b64_tr_b16 a[198:199], v5 offset:37888
ds_read_b64_tr_b16 a[248:249], v5 offset:40960
ds_read_b64_tr_b16 a[250:251], v5 offset:41984
ds_read_b64_tr_b16 a[252:253], v5 offset:45056
ds_read_b64_tr_b16 a[254:255], v5 offset:46080
ds_read_b64_tr_b16 v[72:73], v5 offset:49152
ds_read_b64_tr_b16 v[74:75], v5 offset:50176
ds_read_b64_tr_b16 v[76:77], v5 offset:53248
ds_read_b64_tr_b16 v[78:79], v5 offset:54272
ds_read_b64_tr_b16 v[80:81], v5 offset:57344
ds_read_b64_tr_b16 v[82:83], v5 offset:58368
ds_read_b64_tr_b16 v[84:85], v5 offset:61440
ds_read_b64_tr_b16 v[86:87], v5 offset:62464
s_waitcnt lgkmcnt(0)
s_waitcnt vmcnt(24)
s_barrier
s_mov_b32 m0, 104448
s_add_u32 s48, s50, 153600
buffer_load_dwordx4 v11, s[20:23], s48 offen lds
s_mov_b32 m0, 105472
s_add_u32 s48, s50, 158720
buffer_load_dwordx4 v11, s[20:23], s48 offen lds
s_mov_b32 m0, 112640
s_add_u32 s48, s50, 92416
buffer_load_dwordx4 v11, s[20:23], s48 offen lds
s_mov_b32 m0, 113664
s_add_u32 s48, s50, 97536
buffer_load_dwordx4 v11, s[20:23], s48 offen lds
s_mov_b32 m0, 120832
s_add_u32 s48, s50, 112896
buffer_load_dwordx4 v11, s[20:23], s48 offen lds
s_mov_b32 m0, 121856
s_add_u32 s48, s50, 118016
buffer_load_dwordx4 v11, s[20:23], s48 offen lds
s_mov_b32 m0, 129024
s_add_u32 s48, s50, 133376
buffer_load_dwordx4 v11, s[20:23], s48 offen lds
s_mov_b32 m0, 130048
s_add_u32 s48, s50, 138496
buffer_load_dwordx4 v11, s[20:23], s48 offen lds
ds_read_b64_tr_b16 v[88:89], v6 offset:0
ds_read_b64_tr_b16 v[90:91], v6 offset:1024
ds_read_b64_tr_b16 v[92:93], v6 offset:4096
ds_read_b64_tr_b16 v[94:95], v6 offset:5120
ds_read_b64_tr_b16 v[96:97], v6 offset:8192
ds_read_b64_tr_b16 v[98:99], v6 offset:9216
ds_read_b64_tr_b16 v[100:101], v6 offset:12288
ds_read_b64_tr_b16 v[102:103], v6 offset:13312
ds_read_b64_tr_b16 v[104:105], v6 offset:16384
ds_read_b64_tr_b16 v[106:107], v6 offset:17408
ds_read_b64_tr_b16 v[108:109], v6 offset:20480
ds_read_b64_tr_b16 v[110:111], v6 offset:21504
ds_read_b64_tr_b16 v[248:249], v6 offset:24576
ds_read_b64_tr_b16 v[250:251], v6 offset:25600
ds_read_b64_tr_b16 v[252:253], v6 offset:28672
ds_read_b64_tr_b16 v[254:255], v6 offset:29696
s_waitcnt lgkmcnt(0)
s_waitcnt vmcnt(24)
s_barrier
s_mov_b32 m0, 137216
s_add_u32 s48, s50, 153856
buffer_load_dwordx4 v11, s[20:23], s48 offen lds
s_mov_b32 m0, 138240
s_add_u32 s48, s50, 158976
buffer_load_dwordx4 v11, s[20:23], s48 offen lds
s_mov_b32 m0, 145408
s_add_u32 s48, s50, 92672
buffer_load_dwordx4 v11, s[20:23], s48 offen lds
s_mov_b32 m0, 146432
s_add_u32 s48, s50, 97792
buffer_load_dwordx4 v11, s[20:23], s48 offen lds
s_mov_b32 m0, 153600
s_add_u32 s48, s50, 113152
buffer_load_dwordx4 v11, s[20:23], s48 offen lds
s_mov_b32 m0, 154624
s_add_u32 s48, s50, 118272
buffer_load_dwordx4 v11, s[20:23], s48 offen lds
s_mov_b32 m0, 161792
s_add_u32 s48, s50, 133632
buffer_load_dwordx4 v11, s[20:23], s48 offen lds
s_mov_b32 m0, 162816
s_add_u32 s48, s50, 138752
buffer_load_dwordx4 v11, s[20:23], s48 offen lds
ds_read_b64_tr_b16 a[240:241], v4 offset:0
ds_read_b64_tr_b16 a[242:243], v4 offset:1024
ds_read_b64_tr_b16 a[244:245], v4 offset:4096
ds_read_b64_tr_b16 a[246:247], v4 offset:5120
ds_read_b64_tr_b16 v[128:129], v4 offset:8192
ds_read_b64_tr_b16 v[130:131], v4 offset:9216
ds_read_b64_tr_b16 v[132:133], v4 offset:12288
ds_read_b64_tr_b16 v[134:135], v4 offset:13312
ds_read_b64_tr_b16 v[136:137], v4 offset:16384
ds_read_b64_tr_b16 v[138:139], v4 offset:17408
ds_read_b64_tr_b16 v[140:141], v4 offset:20480
ds_read_b64_tr_b16 v[142:143], v4 offset:21504
ds_read_b64_tr_b16 v[144:145], v4 offset:24576
ds_read_b64_tr_b16 v[146:147], v4 offset:25600
ds_read_b64_tr_b16 v[148:149], v4 offset:28672
ds_read_b64_tr_b16 v[150:151], v4 offset:29696
s_waitcnt lgkmcnt(0)
s_waitcnt vmcnt(24)
s_barrier
s_mov_b32 m0, 6144
s_add_u32 s48, s50, 154112
buffer_load_dwordx4 v11, s[20:23], s48 offen lds
s_mov_b32 m0, 7168
s_add_u32 s48, s50, 159232
buffer_load_dwordx4 v11, s[20:23], s48 offen lds
s_mov_b32 m0, 14336
s_add_u32 s48, s49, 393216
buffer_load_dwordx4 v10, s[12:15], s48 offen lds
s_mov_b32 m0, 15360
s_add_u32 s48, s49, 458752
buffer_load_dwordx4 v10, s[12:15], s48 offen lds
s_mov_b32 m0, 22528
s_add_u32 s48, s49, 917504
buffer_load_dwordx4 v10, s[12:15], s48 offen lds
s_mov_b32 m0, 23552
s_add_u32 s48, s49, 983040
buffer_load_dwordx4 v10, s[12:15], s48 offen lds
s_mov_b32 m0, 30720
s_add_u32 s48, s49, 1441792
buffer_load_dwordx4 v10, s[12:15], s48 offen lds
s_mov_b32 m0, 31744
s_add_u32 s48, s49, 1507328
buffer_load_dwordx4 v10, s[12:15], s48 offen lds
ds_read_b64_tr_b16 v[152:153], v4 offset:32768
ds_read_b64_tr_b16 v[154:155], v4 offset:33792
ds_read_b64_tr_b16 v[156:157], v4 offset:36864
ds_read_b64_tr_b16 v[158:159], v4 offset:37888
ds_read_b64_tr_b16 v[160:161], v4 offset:40960
ds_read_b64_tr_b16 v[162:163], v4 offset:41984
ds_read_b64_tr_b16 v[164:165], v4 offset:45056
ds_read_b64_tr_b16 v[166:167], v4 offset:46080
ds_read_b64_tr_b16 v[168:169], v4 offset:49152
ds_read_b64_tr_b16 v[170:171], v4 offset:50176
ds_read_b64_tr_b16 v[172:173], v4 offset:53248
ds_read_b64_tr_b16 v[174:175], v4 offset:54272
ds_read_b64_tr_b16 v[112:113], v4 offset:57344
ds_read_b64_tr_b16 v[114:115], v4 offset:58368
ds_read_b64_tr_b16 v[116:117], v4 offset:61440
ds_read_b64_tr_b16 v[118:119], v4 offset:62464
s_waitcnt lgkmcnt(0)
s_waitcnt vmcnt(24)
s_barrier
s_mov_b32 m0, 38912
s_add_u32 s48, s49, 1966080
buffer_load_dwordx4 v10, s[12:15], s48 offen lds
s_mov_b32 m0, 39936
s_add_u32 s48, s49, 2031616
buffer_load_dwordx4 v10, s[12:15], s48 offen lds
s_mov_b32 m0, 47104
s_add_u32 s48, s49, 2490368
buffer_load_dwordx4 v10, s[12:15], s48 offen lds
s_mov_b32 m0, 48128
s_add_u32 s48, s49, 2555904
buffer_load_dwordx4 v10, s[12:15], s48 offen lds
s_mov_b32 m0, 55296
s_add_u32 s48, s49, 3014656
buffer_load_dwordx4 v10, s[12:15], s48 offen lds
s_mov_b32 m0, 56320
s_add_u32 s48, s49, 3080192
buffer_load_dwordx4 v10, s[12:15], s48 offen lds
s_mov_b32 m0, 63488
s_add_u32 s48, s49, 1441920
buffer_load_dwordx4 v10, s[16:19], s48 offen lds
s_mov_b32 m0, 64512
s_add_u32 s48, s49, 1507456
buffer_load_dwordx4 v10, s[16:19], s48 offen lds
ds_read_b64_tr_b16 v[120:121], v5 offset:0
ds_read_b64_tr_b16 v[122:123], v5 offset:1024
ds_read_b64_tr_b16 v[124:125], v5 offset:4096
ds_read_b64_tr_b16 v[126:127], v5 offset:5120
ds_read_b64_tr_b16 v[176:177], v8 offset:8192
ds_read_b64_tr_b16 v[178:179], v8 offset:8704
ds_read_b64_tr_b16 v[180:181], v8 offset:10240
ds_read_b64_tr_b16 v[182:183], v8 offset:10752
ds_read_b64_tr_b16 v[184:185], v8 offset:16384
ds_read_b64_tr_b16 v[186:187], v8 offset:16896
ds_read_b64_tr_b16 v[188:189], v8 offset:18432
ds_read_b64_tr_b16 v[190:191], v8 offset:18944
ds_read_b64_tr_b16 v[192:193], v8 offset:24576
ds_read_b64_tr_b16 v[194:195], v8 offset:25088
ds_read_b64_tr_b16 v[196:197], v8 offset:26624
ds_read_b64_tr_b16 v[198:199], v8 offset:27136
s_waitcnt lgkmcnt(0)
s_waitcnt vmcnt(24)
s_barrier
s_mov_b32 m0, 71680
s_add_u32 s48, s49, 1966208
buffer_load_dwordx4 v10, s[16:19], s48 offen lds
s_mov_b32 m0, 72704
s_add_u32 s48, s49, 2031744
buffer_load_dwordx4 v10, s[16:19], s48 offen lds
s_mov_b32 m0, 79872
s_add_u32 s48, s49, 2490496
buffer_load_dwordx4 v10, s[16:19], s48 offen lds
s_mov_b32 m0, 80896
s_add_u32 s48, s49, 2556032
buffer_load_dwordx4 v10, s[16:19], s48 offen lds
s_mov_b32 m0, 88064
s_add_u32 s48, s49, 3014784
buffer_load_dwordx4 v10, s[16:19], s48 offen lds
s_mov_b32 m0, 89088
s_add_u32 s48, s49, 3080320
buffer_load_dwordx4 v10, s[16:19], s48 offen lds
s_mov_b32 m0, 96256
s_add_u32 s48, s50, 92928
buffer_load_dwordx4 v11, s[20:23], s48 offen lds
s_mov_b32 m0, 97280
s_add_u32 s48, s50, 98048
buffer_load_dwordx4 v11, s[20:23], s48 offen lds
v_xor_b32 v12, v15, v8
ds_read_b64_tr_b16 v[16:17], v12 offset:32768
ds_read_b64_tr_b16 v[18:19], v12 offset:33280
ds_read_b64_tr_b16 v[20:21], v12 offset:34816
ds_read_b64_tr_b16 v[22:23], v12 offset:35328
ds_read_b64_tr_b16 v[240:241], v8 offset:40960
ds_read_b64_tr_b16 v[242:243], v8 offset:41472
ds_read_b64_tr_b16 v[244:245], v8 offset:43008
ds_read_b64_tr_b16 v[246:247], v8 offset:43520
ds_read_b64_tr_b16 v[232:233], v8 offset:49152
ds_read_b64_tr_b16 v[234:235], v8 offset:49664
ds_read_b64_tr_b16 v[236:237], v8 offset:51200
ds_read_b64_tr_b16 v[238:239], v8 offset:51712
ds_read_b64_tr_b16 v[40:41], v8 offset:57344
ds_read_b64_tr_b16 v[42:43], v8 offset:57856
ds_read_b64_tr_b16 v[44:45], v8 offset:59392
ds_read_b64_tr_b16 v[46:47], v8 offset:59904
s_waitcnt lgkmcnt(0)
buffer_store_dwordx4 v[16:19], v0, s[4:7], s61 offen offset:0
buffer_store_dwordx4 v[20:23], v0, s[4:7], s61 offen offset:1024
buffer_store_dwordx4 v[40:43], v0, s[4:7], s62 offen offset:0
buffer_store_dwordx4 v[44:47], v0, s[4:7], s62 offen offset:1024
s_waitcnt vmcnt(28)
s_barrier
s_mov_b32 m0, 104448
s_add_u32 s48, s50, 113408
buffer_load_dwordx4 v11, s[20:23], s48 offen lds
s_mov_b32 m0, 105472
s_add_u32 s48, s50, 118528
buffer_load_dwordx4 v11, s[20:23], s48 offen lds
s_mov_b32 m0, 112640
s_add_u32 s48, s50, 133888
buffer_load_dwordx4 v11, s[20:23], s48 offen lds
s_mov_b32 m0, 113664
s_add_u32 s48, s50, 139008
buffer_load_dwordx4 v11, s[20:23], s48 offen lds
s_mov_b32 m0, 120832
s_add_u32 s48, s50, 154368
buffer_load_dwordx4 v11, s[20:23], s48 offen lds
s_mov_b32 m0, 121856
s_add_u32 s48, s50, 159488
buffer_load_dwordx4 v11, s[20:23], s48 offen lds
s_mov_b32 m0, 129024
s_add_u32 s48, s50, 93184
buffer_load_dwordx4 v11, s[20:23], s48 offen lds
s_mov_b32 m0, 130048
s_add_u32 s48, s50, 98304
buffer_load_dwordx4 v11, s[20:23], s48 offen lds
v_xor_b32 v12, v15, v9
ds_read_b64_tr_b16 v[16:17], v12 offset:0
ds_read_b64_tr_b16 v[18:19], v12 offset:512
ds_read_b64_tr_b16 v[20:21], v12 offset:2048
ds_read_b64_tr_b16 v[22:23], v12 offset:2560
ds_read_b64_tr_b16 v[24:25], v9 offset:8192
ds_read_b64_tr_b16 v[26:27], v9 offset:8704
ds_read_b64_tr_b16 v[28:29], v9 offset:10240
ds_read_b64_tr_b16 v[30:31], v9 offset:10752
ds_read_b64_tr_b16 v[208:209], v9 offset:16384
ds_read_b64_tr_b16 v[210:211], v9 offset:16896
ds_read_b64_tr_b16 v[212:213], v9 offset:18432
ds_read_b64_tr_b16 v[214:215], v9 offset:18944
ds_read_b64_tr_b16 v[216:217], v9 offset:24576
ds_read_b64_tr_b16 v[218:219], v9 offset:25088
ds_read_b64_tr_b16 v[220:221], v9 offset:26624
ds_read_b64_tr_b16 v[222:223], v9 offset:27136
s_waitcnt lgkmcnt(0)
buffer_store_dwordx4 v[16:19], v0, s[4:7], s61 offen offset:2048
buffer_store_dwordx4 v[20:23], v0, s[4:7], s61 offen offset:3072
buffer_store_dwordx4 v[24:27], v0, s[4:7], s62 offen offset:2048
buffer_store_dwordx4 v[28:31], v0, s[4:7], s62 offen offset:3072
s_waitcnt vmcnt(38)
s_barrier
s_mov_b32 m0, 137216
s_add_u32 s48, s50, 113664
buffer_load_dwordx4 v11, s[20:23], s48 offen lds
s_mov_b32 m0, 138240
s_add_u32 s48, s50, 118784
buffer_load_dwordx4 v11, s[20:23], s48 offen lds
s_mov_b32 m0, 145408
s_add_u32 s48, s50, 134144
buffer_load_dwordx4 v11, s[20:23], s48 offen lds
s_mov_b32 m0, 146432
s_add_u32 s48, s50, 139264
buffer_load_dwordx4 v11, s[20:23], s48 offen lds
s_mov_b32 m0, 153600
s_add_u32 s48, s50, 154624
buffer_load_dwordx4 v11, s[20:23], s48 offen lds
s_mov_b32 m0, 154624
s_add_u32 s48, s50, 159744
buffer_load_dwordx4 v11, s[20:23], s48 offen lds
s_mov_b32 m0, 161792
s_add_u32 s48, s49, 3538944
buffer_load_dwordx4 v10, s[8:11], s48 offen lds
s_mov_b32 m0, 162816
s_add_u32 s48, s49, 3604480
buffer_load_dwordx4 v10, s[8:11], s48 offen lds
v_xor_b32 v12, v15, v7
ds_read_b64_tr_b16 v[200:201], v12 offset:0
ds_read_b64_tr_b16 v[202:203], v12 offset:512
ds_read_b64_tr_b16 v[204:205], v12 offset:2048
ds_read_b64_tr_b16 v[206:207], v12 offset:2560
s_waitcnt lgkmcnt(0)
s_waitcnt vmcnt(32)
s_barrier
ds_read_b64_tr_b16 v[16:17], v4 offset:8192
ds_read_b64_tr_b16 v[18:19], v4 offset:9216
ds_read_b64_tr_b16 v[20:21], v4 offset:12288
ds_read_b64_tr_b16 v[22:23], v4 offset:13312
ds_read_b64_tr_b16 v[24:25], v4 offset:16384
ds_read_b64_tr_b16 v[26:27], v4 offset:17408
ds_read_b64_tr_b16 v[28:29], v4 offset:20480
ds_read_b64_tr_b16 v[30:31], v4 offset:21504
ds_read_b64_tr_b16 v[32:33], v4 offset:24576
ds_read_b64_tr_b16 v[34:35], v4 offset:25600
ds_read_b64_tr_b16 v[36:37], v4 offset:28672
ds_read_b64_tr_b16 v[38:39], v4 offset:29696
ds_read_b64_tr_b16 v[40:41], v4 offset:32768
ds_read_b64_tr_b16 v[42:43], v4 offset:33792
ds_read_b64_tr_b16 v[44:45], v4 offset:36864
ds_read_b64_tr_b16 v[46:47], v4 offset:37888
ds_read_b64_tr_b16 v[48:49], v4 offset:40960
ds_read_b64_tr_b16 v[50:51], v4 offset:41984
ds_read_b64_tr_b16 v[52:53], v4 offset:45056
ds_read_b64_tr_b16 v[54:55], v4 offset:46080
ds_read_b64_tr_b16 v[56:57], v4 offset:49152
ds_read_b64_tr_b16 v[58:59], v4 offset:50176
ds_read_b64_tr_b16 v[60:61], v4 offset:53248
ds_read_b64_tr_b16 v[62:63], v4 offset:54272
ds_read_b64_tr_b16 v[64:65], v4 offset:57344
ds_read_b64_tr_b16 v[66:67], v4 offset:58368
ds_read_b64_tr_b16 v[68:69], v4 offset:61440
ds_read_b64_tr_b16 v[70:71], v4 offset:62464
s_waitcnt lgkmcnt(0)
s_barrier
ds_write_b128 v0, v[16:19] offset:51200
ds_write_b128 v0, v[20:23] offset:52224
ds_write_b128 v0, v[24:27] offset:53248
ds_write_b128 v0, v[28:31] offset:54272
ds_write_b128 v0, v[32:35] offset:55296
ds_write_b128 v0, v[36:39] offset:56320
ds_write_b128 v0, v[40:43] offset:57344
ds_write_b128 v0, v[44:47] offset:58368
ds_write_b128 v0, v[48:51] offset:59392
ds_write_b128 v0, v[52:55] offset:60416
ds_write_b128 v0, v[56:59] offset:61440
ds_write_b128 v0, v[60:63] offset:62464
ds_write_b128 v0, v[64:67] offset:63488
ds_write_b128 v0, v[68:71] offset:64512
s_waitcnt lgkmcnt(0)
s_waitcnt vmcnt(6)
s_barrier
ds_read_b64_tr_b16 v[16:17], v8 offset:24576
ds_read_b64_tr_b16 v[18:19], v8 offset:25088
ds_read_b64_tr_b16 v[20:21], v8 offset:26624
ds_read_b64_tr_b16 v[22:23], v8 offset:27136
ds_read_b64_tr_b16 v[24:25], v8 offset:32768
ds_read_b64_tr_b16 v[26:27], v8 offset:33280
ds_read_b64_tr_b16 v[28:29], v8 offset:34816
ds_read_b64_tr_b16 v[30:31], v8 offset:35328
ds_read_b64_tr_b16 v[32:33], v8 offset:40960
ds_read_b64_tr_b16 v[34:35], v8 offset:41472
ds_read_b64_tr_b16 v[36:37], v8 offset:43008
ds_read_b64_tr_b16 v[38:39], v8 offset:43520
v_xor_b32 v12, v15, v8
ds_read_b64_tr_b16 v[40:41], v12 offset:49152
ds_read_b64_tr_b16 v[42:43], v12 offset:49664
ds_read_b64_tr_b16 v[44:45], v12 offset:51200
ds_read_b64_tr_b16 v[46:47], v12 offset:51712
ds_read_b64_tr_b16 v[48:49], v8 offset:57344
ds_read_b64_tr_b16 v[50:51], v8 offset:57856
ds_read_b64_tr_b16 v[52:53], v8 offset:59392
ds_read_b64_tr_b16 v[54:55], v8 offset:59904
ds_read_b64_tr_b16 v[56:57], v9 offset:0
ds_read_b64_tr_b16 v[58:59], v9 offset:512
ds_read_b64_tr_b16 v[60:61], v9 offset:2048
ds_read_b64_tr_b16 v[62:63], v9 offset:2560
s_waitcnt lgkmcnt(0)
s_barrier
ds_write_b128 v2, v[16:19] offset:36864
ds_write_b128 v2, v[20:23] offset:37888
ds_write_b128 v2, v[24:27] offset:38912
ds_write_b128 v2, v[28:31] offset:39936
ds_write_b128 v2, v[232:235] offset:40960
ds_write_b128 v2, v[236:239] offset:41984
ds_write_b128 v2, v[224:227] offset:43008
ds_write_b128 v2, v[228:231] offset:44032
ds_write_b128 v2, v[48:51] offset:45056
ds_write_b128 v2, v[52:55] offset:46080
ds_write_b128 v2, v[56:59] offset:47104
ds_write_b128 v2, v[60:63] offset:48128
s_waitcnt lgkmcnt(0)
v_mov_b32 v232, v32
v_mov_b32 v233, v33
v_mov_b32 v234, v34
v_mov_b32 v235, v35
v_mov_b32 v236, v36
v_mov_b32 v237, v37
v_mov_b32 v238, v38
v_mov_b32 v239, v39
v_mov_b32 v224, v40
v_mov_b32 v225, v41
v_mov_b32 v226, v42
v_mov_b32 v227, v43
v_mov_b32 v228, v44
v_mov_b32 v229, v45
v_mov_b32 v230, v46
v_mov_b32 v231, v47
s_waitcnt vmcnt(0)
s_barrier
ds_read_b64_tr_b16 v[16:17], v5 offset:0
ds_read_b64_tr_b16 v[18:19], v5 offset:1024
ds_read_b64_tr_b16 v[20:21], v5 offset:4096
ds_read_b64_tr_b16 v[22:23], v5 offset:5120
ds_read_b64_tr_b16 v[24:25], v5 offset:8192
ds_read_b64_tr_b16 v[26:27], v5 offset:9216
ds_read_b64_tr_b16 v[28:29], v5 offset:12288
ds_read_b64_tr_b16 v[30:31], v5 offset:13312
ds_read_b64_tr_b16 v[32:33], v5 offset:16384
ds_read_b64_tr_b16 v[34:35], v5 offset:17408
ds_read_b64_tr_b16 v[36:37], v5 offset:20480
ds_read_b64_tr_b16 v[38:39], v5 offset:21504
ds_read_b64_tr_b16 v[40:41], v9 offset:8192
ds_read_b64_tr_b16 v[42:43], v9 offset:8704
ds_read_b64_tr_b16 v[44:45], v9 offset:10240
ds_read_b64_tr_b16 v[46:47], v9 offset:10752
v_xor_b32 v12, v15, v9
ds_read_b64_tr_b16 v[48:49], v12 offset:16384
ds_read_b64_tr_b16 v[50:51], v12 offset:16896
ds_read_b64_tr_b16 v[52:53], v12 offset:18432
ds_read_b64_tr_b16 v[54:55], v12 offset:18944
ds_read_b64_tr_b16 v[56:57], v6 offset:24576
ds_read_b64_tr_b16 v[58:59], v6 offset:25600
ds_read_b64_tr_b16 v[60:61], v6 offset:28672
ds_read_b64_tr_b16 v[62:63], v6 offset:29696
s_waitcnt lgkmcnt(0)
s_barrier
ds_write_b128 v2, v[16:19] offset:12288
ds_write_b128 v2, v[20:23] offset:13312
ds_write_b128 v2, a[176:179] offset:14336
ds_write_b128 v2, a[180:183] offset:15360
ds_write_b128 v2, v[32:35] offset:16384
ds_write_b128 v2, v[36:39] offset:17408
ds_write_b128 v2, v[248:251] offset:18432
ds_write_b128 v2, v[252:255] offset:19456
ds_write_b128 v2, v[240:243] offset:20480
ds_write_b128 v2, v[244:247] offset:21504
ds_write_b128 v2, v[56:59] offset:22528
ds_write_b128 v2, v[60:63] offset:23552
s_waitcnt lgkmcnt(0)
v_accvgpr_write_b32 a176, v24
v_accvgpr_write_b32 a177, v25
v_accvgpr_write_b32 a178, v26
v_accvgpr_write_b32 a179, v27
v_accvgpr_write_b32 a180, v28
v_accvgpr_write_b32 a181, v29
v_accvgpr_write_b32 a182, v30
v_accvgpr_write_b32 a183, v31
v_mov_b32 v248, v40
v_mov_b32 v249, v41
v_mov_b32 v250, v42
v_mov_b32 v251, v43
v_mov_b32 v252, v44
v_mov_b32 v253, v45
v_mov_b32 v254, v46
v_mov_b32 v255, v47
v_mov_b32 v240, v48
v_mov_b32 v241, v49
v_mov_b32 v242, v50
v_mov_b32 v243, v51
v_mov_b32 v244, v52
v_mov_b32 v245, v53
v_mov_b32 v246, v54
v_mov_b32 v247, v55
s_mov_b32 s90, 0x300003
s_mov_b32 s91, 0x300003
s_mov_b32 s12, 0x3030303
s_mov_b32 s13, 0x3030303
s_mov_b32 s92, 0xc0000c
s_mov_b32 s93, 0xc0000c
s_mov_b32 s14, 0xc0c0c0c
s_mov_b32 s15, 0xc0c0c0c
s_mov_b32 s94, 0x30000300
s_mov_b32 s95, 0x30000300
s_mov_b32 s16, 0x30303030
s_mov_b32 s17, 0x30303030
s_mov_b32 s96, 0xc0000c00
s_mov_b32 s97, 0xc0000c00
s_mov_b32 s18, 0xc0c0c0c0
s_mov_b32 s19, 0xc0c0c0c0
s_mov_b32 s98, 0xff00ff00
s_mov_b32 s99, 0xff00ff00
v_mov_b32 v1, 0x4444
v_mov_b32 v4, 0xeeee
v_cndmask_b32 v1, v1, v4, s[98:99]
v_lshrrev_b32 v4, 8, v0
v_lshl_or_b32 v1, v4, 28, v1
v_bfe_u32 v4, v0, 4, 4
v_lshl_or_b32 v1, v4, 19, v1
s_mov_b32 s51, 0x3e0293ee
s_mov_b32 s52, 0x3f803f80
s_mov_b32 s53, 0x3f803f80
s_mov_b32 s54, 0x3f003f00
s_mov_b32 s55, 0x3f003f00
s_mov_b32 s56, 0xff800000
s_mov_b32 s57, 0xff800000
s_mov_b32 s58, 0x3f80
s_mov_b32 s8, s4
s_mov_b32 s9, s5
s_cmp_eq_u32 s30, 31
s_cselect_b32 s10, s6, 0
s_mov_b32 s31, 0
s_mov_b32 s45, -2
s_lshl_b32 s46, s30, 6
s_add_u32 s46, s46, 222330880
s_lshl_b32 s48, s30, 7
s_and_b32 s49, s30, 31
s_lshl_b32 s49, s49, 12
s_add_u32 s43, s49, 119537664
v_mov_b64 v[12:13], -1
s_add_u32 s38, s48, 119586816
s_add_u32 s39, s48, 119652352
s_add_u32 s40, s48, 119717888
s_add_u32 s41, s48, 119783424
s_add_u32 s42, s48, 119848960
v_lshrrev_b32 v4, 16, v1
buffer_store_dwordx2 v[12:13], v4, s[4:7], s38 offen sc1
buffer_store_dwordx2 v[12:13], v4, s[4:7], s39 offen sc1
buffer_store_dwordx2 v[12:13], v4, s[4:7], s40 offen sc1
buffer_store_dwordx2 v[12:13], v4, s[4:7], s41 offen sc1
buffer_store_dwordx2 v[12:13], v4, s[4:7], s42 offen sc1
s_cmp_lg_u32 s3, 0
s_cbranch_scc1 k_wdd_243
v_mov_b32 v8, 192
k_wd_242:
global_load_dword v9, v8, s[28:29] sc1
s_waitcnt vmcnt(0)
v_readfirstlane_b32 s48, v9
s_cmp_ge_u32 s48, 32
s_cbranch_scc1 k_wdd_243
s_sleep 2
s_sub_u32 s32, s32, 1
s_cmp_gt_i32 s32, 0
s_cbranch_scc1 k_wd_242
k_wdd_243:
s_barrier
k_lay_244:
s_add_u32 s47, s31, 63
s_mov_b32 s33, 120324096
s_mov_b32 s34, 120329216
s_mov_b32 s35, 120333312
s_mul_i32 s48, s31, 655360
s_lshl_b32 s36, s30, 14
s_add_u32 s36, s36, s48
s_add_u32 s36, s36, 12288
v_mov_b32 v12, -1
s_lshl_b32 s63, s30, 10
s_add_u32 s63, s63, 120356864
s_lshl_b32 s37, s31, 14
s_add_u32 s37, s37, 117443584
s_add_u32 s59, s37, 4096
s_waitcnt vmcnt(0)
s_barrier
s_barrier
v_mov_b32 v8, 160
global_load_dword v9, v8, s[28:29] sc1
s_waitcnt vmcnt(0)
v_readfirstlane_b32 s64, v9
s_cmp_gt_u32 s64, 0xffff
s_cselect_b32 s64, 0x10000, 0
s_waitcnt vmcnt(0)
s_barrier
s_barrier
v_lshlrev_b32 v23, v0, s58
v_cndmask_b32 v20, 0, v23, s[90:91]
v_cndmask_b32 v21, 0, v23, s[92:93]
v_cndmask_b32 v22, 0, v23, s[94:95]
v_cndmask_b32 v23, 0, v23, s[96:97]
s_cmp_lg_u32 s64, 0
s_cbranch_scc1 k_far_245
s_mov_b32 s66, 0
k_fl2_261:
buffer_load_dwordx2 v[46:47], off, s[4:7], s46 sc1
s_waitcnt vmcnt(0)
v_min_u32 v46, v46, v47
v_cmp_lt_u32 vcc, s31, v46
v_mov_b64 v[46:47], 0
s_cbranch_vccnz k_cold2_249
s_sub_u32 s32, s32, 1
s_cmp_gt_i32 s32, 0
s_cbranch_scc1 k_fl2_261
s_branch k_cold2_249
k_T0_247:
s_waitcnt vmcnt(2)
v_smfmac_f32_16x16x64_bf16 v[40:43], v[4:7], v[48:55], v1
s_waitcnt vmcnt(1)
v_cmp_u_f32 vcc, v4, v8
v_smfmac_f32_16x16x64_bf16 v[24:27], v[8:11], a[24:31], v1
v_smfmac_f32_16x16x64_bf16 v[28:31], v[8:11], a[32:39], v1
s_cbranch_vccnz k_cold_248
k_okC_250:
s_waitcnt vmcnt(1)
v_smfmac_f32_16x16x64_bf16 v[36:39], v[8:11], a[40:47], v1
s_waitcnt lgkmcnt(0)
ds_read_b128 v[48:51], v2 offset:14336
v_smfmac_f32_16x16x64_bf16 v[32:35], v[4:7], v[64:71], v1
ds_read_b128 v[52:55], v2 offset:15360
ds_read_b128 v[64:67], v0 offset:51200
v_smfmac_f32_16x16x64_bf16 v[44:47], v[4:7], v[56:63], v1
ds_read_b128 v[68:71], v0 offset:52224
v_smfmac_f32_16x16x64_bf16 v[28:31], v[4:7], a[8:15], v1
v_smfmac_f32_16x16x64_bf16 v[24:27], v[4:7], a[0:7], v1
ds_read_b128 v[56:59], v2 offset:43008
v_smfmac_f32_16x16x64_bf16 v[36:39], v[4:7], a[16:23], v1
ds_read_b128 v[60:63], v2 offset:44032
s_waitcnt lgkmcnt(4)
v_smfmac_f32_16x16x64_bf16 v[40:43], v[8:11], v[48:55], v1
s_waitcnt vmcnt(0)
ds_write_b128 v0, v[12:15] offset:3072
s_waitcnt lgkmcnt(3)
v_smfmac_f32_16x16x64_bf16 v[32:35], v[8:11], v[64:71], v1
buffer_load_dwordx4 v[16:19], v0, s[4:7], s35 offen offset:0 sc1
v_cmp_u_f32 vcc, v12, v12
s_waitcnt lgkmcnt(1)
v_smfmac_f32_16x16x64_bf16 v[44:47], v[8:11], v[56:63], v1
ds_read_b128 v[56:59], v2 offset:16384
ds_read_b128 v[60:63], v2 offset:17408
ds_read_b128 v[64:67], v0 offset:61440
s_cbranch_vccnz k_coldA_251
k_okA_252:
v_smfmac_f32_16x16x64_bf16 v[36:39], v[12:15], a[64:71], v1
ds_read_b128 v[68:71], v0 offset:62464
s_waitcnt lgkmcnt(4)
v_smfmac_f32_16x16x64_bf16 v[40:43], v[12:15], a[72:79], v1
s_barrier
v_smfmac_f32_16x16x64_bf16 v[28:31], v[12:15], a[56:63], v1
ds_read_b128 v[8:11], v0 offset:0
buffer_load_dwordx4 v[48:51], v0, s[4:7], s36 offen offset:0 sc1
s_waitcnt lgkmcnt(3)
v_smfmac_f32_16x16x64_bf16 v[44:47], v[12:15], v[56:63], v1
ds_read_b128 v[56:59], v0 offset:63488
v_smfmac_f32_16x16x64_bf16 v[24:27], v[12:15], a[48:55], v1
ds_read_b128 v[60:63], v0 offset:64512
s_waitcnt lgkmcnt(3)
v_smfmac_f32_16x16x64_bf16 v[32:35], v[12:15], v[64:71], v1
buffer_load_dwordx4 v[52:55], v0, s[4:7], s36 offen offset:1024 sc1
s_waitcnt lgkmcnt(2)
v_smfmac_f32_16x16x64_bf16 v[24:27], v[8:11], a[80:87], v1
ds_read_b128 v[64:67], v0 offset:55296
ds_read_b128 v[68:71], v0 offset:56320
v_smfmac_f32_16x16x64_bf16 v[36:39], v[8:11], a[96:103], v1
s_waitcnt lgkmcnt(2)
ds_read_b128 v[4:7], v0 offset:1024
v_smfmac_f32_16x16x64_bf16 v[44:47], v[8:11], v[56:63], v1
ds_read_b128 v[56:59], v2 offset:12288
ds_read_b128 v[60:63], v2 offset:13312
v_smfmac_f32_16x16x64_bf16 v[28:31], v[8:11], a[88:95], v1
buffer_store_dwordx4 v[12:15], v0, s[8:11], s37 offen offset:2048 sc1
v_smfmac_f32_16x16x64_bf16 v[40:43], v[8:11], a[104:111], v1
s_waitcnt lgkmcnt(3)
s_waitcnt lgkmcnt(2)
v_smfmac_f32_16x16x64_bf16 v[32:35], v[8:11], v[64:71], v1
ds_read_b128 v[64:67], v0 offset:57344
ds_read_b128 v[12:15], v0 offset:2048
v_smfmac_f32_16x16x64_bf16 v[36:39], v[4:7], a[128:135], v1
s_waitcnt lgkmcnt(2)
v_smfmac_f32_16x16x64_bf16 v[44:47], v[4:7], v[56:63], v1
ds_read_b128 v[68:71], v0 offset:58368
buffer_load_dwordx4 v[56:59], v0, s[4:7], s36 offen offset:2048 sc1
v_smfmac_f32_16x16x64_bf16 v[28:31], v[4:7], a[120:127], v1
v_smfmac_f32_16x16x64_bf16 v[24:27], v[4:7], a[112:119], v1
s_waitcnt vmcnt(4)
ds_write_b128 v0, v[16:19] offset:7168
v_smfmac_f32_16x16x64_bf16 v[40:43], v[4:7], a[136:143], v1
s_waitcnt lgkmcnt(1)
buffer_load_dwordx4 v[60:63], v0, s[4:7], s36 offen offset:3072 sc1
v_cmp_u_f32 vcc, v16, v16
v_smfmac_f32_16x16x64_bf16 v[32:35], v[4:7], v[64:71], v1
ds_read_b128 v[64:67], v0 offset:59392
ds_read_b128 v[68:71], v0 offset:60416
v_smfmac_f32_16x16x64_bf16 v[28:31], v[12:15], a[152:159], v1
v_smfmac_f32_16x16x64_bf16 v[24:27], v[12:15], a[144:151], v1
s_cbranch_vccnz k_coldB_253
k_okB_254:
v_smfmac_f32_16x16x64_bf16 v[36:39], v[12:15], a[160:167], v1
s_waitcnt lgkmcnt(2)
buffer_store_dwordx4 v[16:19], v0, s[8:11], s59 offen offset:2048 sc1
s_barrier
ds_read_b128 v[4:7], v0 offset:5120
v_smfmac_f32_16x16x64_bf16 v[44:47], v[12:15], a[176:183], v1
ds_read_b128 v[8:11], v0 offset:4096
s_waitcnt lgkmcnt(2)
v_smfmac_f32_16x16x64_bf16 v[32:35], v[12:15], v[64:71], v1
ds_read_b128 v[64:67], v2 offset:22528
ds_read_b128 v[68:71], v2 offset:23552
v_smfmac_f32_16x16x64_bf16 v[24:27], v[16:19], a[184:191], v1
v_smfmac_f32_16x16x64_bf16 v[40:43], v[12:15], a[168:175], v1
s_waitcnt lgkmcnt(3)
ds_read_b128 v[12:15], v0 offset:6144
v_smfmac_f32_16x16x64_bf16 v[24:27], v[4:7], a[208:215], v1
s_waitcnt lgkmcnt(3)
v_smfmac_f32_16x16x64_bf16 v[28:31], v[4:7], a[216:223], v1
v_smfmac_f32_16x16x64_bf16 v[28:31], v[8:11], a[200:207], v1
s_waitcnt lgkmcnt(1)
v_smfmac_f32_16x16x64_bf16 v[24:27], v[8:11], v[64:71], v1
ds_read_b128 v[64:67], v2 offset:18432
s_waitcnt lgkmcnt(1)
v_smfmac_f32_16x16x64_bf16 v[24:27], v[12:15], a[224:231], v1
ds_read_b128 v[68:71], v2 offset:19456
v_smfmac_f32_16x16x64_bf16 v[28:31], v[12:15], a[232:239], v1
v_smfmac_f32_16x16x64_bf16 v[28:31], v[16:19], a[192:199], v1
v_cvt_pk_bf16_f32 v24, v24, v25
v_cvt_pk_bf16_f32 v25, v26, v27
v_smfmac_f32_16x16x64_bf16 v[32:35], v[4:7], v[80:87], v1
v_cvt_pk_bf16_f32 v26, v28, v29
v_cvt_pk_bf16_f32 v27, v30, v31
v_smfmac_f32_16x16x64_bf16 v[32:35], v[8:11], a[248:255], v1
s_waitcnt lgkmcnt(0)
v_mfma_f32_16x16x32_bf16 v[28:31], v[24:27], v[20:23], 0
v_and_b32 v26, 0xffffff7f, v0
v_smfmac_f32_16x16x64_bf16 v[32:35], v[16:19], v[64:71], v1
v_and_or_b32 v26, v1, 8, v26
v_mul_f32 v28, s51, v28
v_mul_f32 v29, s51, v29
v_mul_f32 v31, s51, v31
v_cvt_pk_bf16_f32 v24, v28, v29
v_mul_f32 v30, s51, v30
v_cvt_pk_bf16_f32 v25, v30, v31
v_smfmac_f32_16x16x64_bf16 v[32:35], v[12:15], v[96:103], v1
ds_write_b64 v26, v[24:25] offset:1152
v_smfmac_f32_16x16x64_bf16 v[36:39], v[8:11], v[72:79], v1
v_cvt_pk_bf16_f32 v32, v32, v33
v_smfmac_f32_16x16x64_bf16 v[36:39], v[16:19], a[240:247], v1
buffer_load_dwordx4 v[64:67], v0, s[4:7], s61 offen offset:0
v_cvt_pk_bf16_f32 v33, v34, v35
v_smfmac_f32_16x16x64_bf16 v[36:39], v[12:15], v[104:111], v1
s_waitcnt lgkmcnt(0)
v_smfmac_f32_16x16x64_bf16 v[36:39], v[4:7], v[88:95], v1
s_barrier
ds_read_b128 v[24:27], v0 offset:0
v_smfmac_f32_16x16x64_bf16 v[40:43], v[4:7], v[144:151], v1
ds_read_b128 v[28:31], v0 offset:1024
s_nop 0
v_cvt_pk_bf16_f32 v34, v36, v37
v_cvt_pk_bf16_f32 v35, v38, v39
s_nop 1
v_mfma_f32_16x16x32_bf16 v[36:39], v[32:35], v[20:23], 0
s_waitcnt vmcnt(5)
buffer_load_dwordx4 v[68:71], v0, s[4:7], s61 offen offset:1024
v_and_b32 v34, 0xffffff7f, v0
v_and_or_b32 v34, v1, 8, v34
s_waitcnt lgkmcnt(1)
v_mfma_f32_16x16x32_bf16 v[48:51], v[48:51], v[24:27], 0
v_cvt_pk_bf16_f32 v32, v36, v37
s_waitcnt lgkmcnt(0)
v_mfma_f32_16x16x32_bf16 v[48:51], v[52:55], v[28:31], v[48:51]
v_mov_b64 v[52:53], s[56:57]
v_cvt_pk_bf16_f32 v33, v38, v39
v_smfmac_f32_16x16x64_bf16 v[44:47], v[4:7], v[152:159], v1
ds_write_b64 v34, v[32:33] offset:3200
v_permlane32_swap_b32 v48, v50
v_permlane32_swap_b32 v49, v51
v_add_f32_dpp v52, v50, v48 row_ror:8 row_mask:0xf bank_mask:0x3
v_exp_f32 v52, v52
v_add_f32_dpp v53, v51, v49 row_ror:8 row_mask:0xf bank_mask:0x3
v_exp_f32 v53, v53
s_nop 0
v_cvt_pk_bf16_f32 v48, v52, v53
v_smfmac_f32_16x16x64_bf16 v[44:47], v[16:19], v[120:127], v1
ds_write_b32 v0, v48 offset:4108
v_smfmac_f32_16x16x64_bf16 v[44:47], v[12:15], v[168:175], v1
buffer_load_dwordx4 v[48:51], v0, s[4:7], s61 offen offset:2048
v_smfmac_f32_16x16x64_bf16 v[40:43], v[12:15], v[160:167], v1
s_waitcnt lgkmcnt(1)
v_xor_b32 v12, 0x80, v0
v_smfmac_f32_16x16x64_bf16 v[40:43], v[8:11], v[128:135], v1
s_waitcnt lgkmcnt(0)
s_barrier
ds_read_b128 v[32:35], v0 offset:2048
v_mov_b64 v[22:23], s[52:53]
v_smfmac_f32_16x16x64_bf16 v[40:43], v[16:19], v[112:119], v1
ds_read_b128 v[36:39], v0 offset:3072
ds_read_b128 v[16:19], v0 offset:4096
buffer_load_dwordx4 v[52:55], v0, s[4:7], s61 offen offset:3072
v_smfmac_f32_16x16x64_bf16 v[44:47], v[8:11], v[136:143], v1
ds_read_b128 v[12:15], v12 offset:4096
v_cvt_pk_bf16_f32 v40, v40, v41
v_mov_b64 v[20:21], s[52:53]
s_waitcnt lgkmcnt(3)
v_mfma_f32_16x16x32_bf16 v[24:27], v[32:35], v[24:27], 0
v_cvt_pk_bf16_f32 v41, v42, v43
s_waitcnt lgkmcnt(2)
v_mfma_f32_16x16x32_bf16 v[24:27], v[36:39], v[28:31], v[24:27]
s_waitcnt vmcnt(5)
s_waitcnt lgkmcnt(1)
v_mfma_f32_16x16x32_bf16 v[8:11], v[56:59], v[16:19], 0
buffer_load_dwordx4 v[56:59], v0, s[4:7], s62 offen offset:0
v_mov_b64 v[28:29], s[56:57]
v_cvt_pk_bf16_f32 v43, v46, v47
v_cvt_pk_bf16_f32 v42, v44, v45
v_permlane32_swap_b32 v25, v27
v_permlane32_swap_b32 v24, v26
v_mfma_f32_16x16x32_bf16 v[4:7], v[20:23], v[16:19], 0
s_waitcnt lgkmcnt(0)
v_add_f32_dpp v28, v26, v24 row_ror:8 row_mask:0xf bank_mask:0x3
v_add_f32_dpp v29, v27, v25 row_ror:8 row_mask:0xf bank_mask:0x3
v_exp_f32 v28, v28
v_mfma_f32_16x16x32_bf16 v[8:11], v[60:63], v[12:15], v[8:11]
buffer_load_dwordx4 v[60:63], v0, s[4:7], s62 offen offset:1024
v_exp_f32 v29, v29
v_permlane32_swap_b32 v42, v43
v_cvt_pk_bf16_f32 v24, v28, v29
v_mov_b64 v[44:45], s[54:55]
v_cvt_pk_bf16_f32 v25, v28, v29
v_mov_b32_dpp v26, v24 row_ror:8 row_mask:0xf bank_mask:0xf
v_mov_b32_dpp v27, v24 row_ror:8 row_mask:0xf bank_mask:0xf
v_mfma_f32_16x16x16_bf16 v[4:7], v[44:45], v[24:25], v[4:7]
v_permlane32_swap_b32 v40, v41
v_mov_b64 v[36:37], 0
v_mov_b64 v[38:39], 0
v_mov_b64 v[30:31], 0
v_mfma_f32_16x16x32_bf16 v[8:11], v[40:43], v[24:27], v[8:11]
buffer_load_dwordx4 v[16:19], v0, s[4:7], s62 offen offset:2048
v_rcp_f32 v6, v4
v_and_b32 v12, 0xffffff7f, v0
v_and_or_b32 v13, v1, 8, v12
v_rcp_f32_dpp v6, v4 row_ror:8 row_mask:0xf bank_mask:0xc
v_mov_b64 v[26:27], 0
v_pk_mul_f32 v[8:9], v[8:9], v[6:7] op_sel_hi:[1,0]
v_cvt_pk_bf16_f32 v44, v8, v9
v_pk_mul_f32 v[10:11], v[10:11], v[6:7] op_sel_hi:[1,0]
v_cvt_pk_bf16_f32 v45, v10, v11
s_waitcnt vmcnt(5)
ds_write_b64 v13, v[44:45] offset:7296
buffer_load_dwordx4 v[20:23], v0, s[4:7], s62 offen offset:3072
v_add_u32 v6, 0xd4800000, v6
v_cmp_lt_u32 vcc, 0x28000000, v6
v_mov_b64 v[34:35], 0
v_mov_b32_dpp v46, v44 row_ror:8 row_mask:0xf bank_mask:0xf
v_mov_b32_dpp v47, v45 row_ror:8 row_mask:0xf bank_mask:0xf
v_mov_b64 v[28:29], 0
v_mov_b64 v[32:33], 0
s_cbranch_vccnz k_slow_255
k_okS_256:
v_smfmac_f32_16x16x64_bf16 v[36:39], v[44:47], v[224:231], v1
s_waitcnt lgkmcnt(0)
s_barrier
ds_read_b128 v[8:11], v12 offset:6272
v_smfmac_f32_16x16x64_bf16 v[32:35], v[44:47], v[200:207], v1
s_waitcnt vmcnt(4)
ds_read_b128 v[4:7], v12 offset:6144
v_mov_b64 v[24:25], 0
v_smfmac_f32_16x16x64_bf16 v[28:31], v[44:47], v[48:55], v1
ds_read_b128 v[12:15], v12 offset:7168
ds_read_b128 v[48:51], v2 offset:40960
v_smfmac_f32_16x16x64_bf16 v[24:27], v[44:47], v[64:71], v1
ds_read_b128 v[52:55], v2 offset:41984
v_mov_b64 v[42:43], 0
s_waitcnt lgkmcnt(4)
v_smfmac_f32_16x16x64_bf16 v[24:27], v[8:11], v[184:191], v1
s_waitcnt lgkmcnt(3)
v_mov_b64 v[40:41], 0
v_smfmac_f32_16x16x64_bf16 v[24:27], v[4:7], v[176:183], v1
s_waitcnt lgkmcnt(2)
ds_read_b128 v[64:67], v2 offset:20480
v_smfmac_f32_16x16x64_bf16 v[24:27], v[12:15], v[192:199], v1
ds_read_b128 v[68:71], v2 offset:21504
v_smfmac_f32_16x16x64_bf16 v[40:43], v[44:47], v[240:247], v1
s_waitcnt vmcnt(2)
s_waitcnt lgkmcnt(2)
v_lshrrev_b32 v44, 16, v1
v_cvt_pk_bf16_f32 v24, v24, v25
v_bfi_b32 v24, 1, s45, v24
v_cvt_pk_bf16_f32 v25, v26, v27
v_smfmac_f32_16x16x64_bf16 v[28:31], v[8:11], v[48:55], v1
buffer_store_dwordx2 v[24:25], v44, s[4:7], s38 offen
ds_read_b128 v[48:51], v2 offset:38912
ds_read_b128 v[52:55], v2 offset:39936
v_smfmac_f32_16x16x64_bf16 v[28:31], v[12:15], v[56:63], v1
s_waitcnt lgkmcnt(2)
ds_read_b128 v[56:59], v2 offset:45056
v_smfmac_f32_16x16x64_bf16 v[28:31], v[4:7], v[64:71], v1
ds_read_b128 v[60:63], v2 offset:46080
v_smfmac_f32_16x16x64_bf16 v[32:35], v[8:11], v[208:215], v1
ds_read_b128 v[64:67], v2 offset:36864
s_nop 0
v_cvt_pk_bf16_f32 v28, v28, v29
v_bfi_b32 v28, 1, s45, v28
v_cvt_pk_bf16_f32 v29, v30, v31
v_smfmac_f32_16x16x64_bf16 v[32:35], v[12:15], v[216:223], v1
buffer_store_dwordx2 v[28:29], v44, s[4:7], s39 offen
v_smfmac_f32_16x16x64_bf16 v[40:43], v[12:15], v[248:255], v1
ds_read_b128 v[68:71], v2 offset:37888
s_waitcnt vmcnt(2)
v_smfmac_f32_16x16x64_bf16 v[32:35], v[4:7], v[16:23], v1
s_waitcnt lgkmcnt(2)
v_smfmac_f32_16x16x64_bf16 v[36:39], v[12:15], v[232:239], v1
ds_read_b128 v[16:19], v2 offset:47104
ds_read_b128 v[20:23], v2 offset:48128
v_cvt_pk_bf16_f32 v32, v32, v33
v_bfi_b32 v32, 1, s45, v32
v_cvt_pk_bf16_f32 v33, v34, v35
v_smfmac_f32_16x16x64_bf16 v[36:39], v[8:11], v[48:55], v1
buffer_store_dwordx2 v[32:33], v44, s[4:7], s40 offen
s_waitcnt lgkmcnt(2)
v_smfmac_f32_16x16x64_bf16 v[36:39], v[4:7], v[64:71], v1
s_nop 6
v_cvt_pk_bf16_f32 v36, v36, v37
v_cvt_pk_bf16_f32 v37, v38, v39
s_waitcnt lgkmcnt(0)
v_bfi_b32 v36, 1, s45, v36
v_smfmac_f32_16x16x64_bf16 v[40:43], v[8:11], v[16:23], v1
buffer_store_dwordx2 v[36:37], v44, s[4:7], s41 offen
v_smfmac_f32_16x16x64_bf16 v[40:43], v[4:7], v[56:63], v1
s_nop 6
v_cvt_pk_bf16_f32 v40, v40, v41
v_bfi_b32 v40, 1, s45, v40
v_cvt_pk_bf16_f32 v41, v42, v43
buffer_store_dwordx2 v[40:41], v44, s[4:7], s42 offen
s_barrier
buffer_load_dwordx4 v[48:51], v0, s[4:7], s60 offen offset:0
buffer_load_dwordx4 v[52:55], v0, s[4:7], s60 offen offset:1024
buffer_load_dwordx4 v[56:59], v0, s[4:7], s60 offen offset:2048
buffer_load_dwordx4 v[60:63], v0, s[4:7], s60 offen offset:3072
s_add_u32 s31, s31, 1
s_min_u32 s66, s66, s67
s_cmp_gt_u32 s66, s31
s_cbranch_scc0 k_fl_260
k_okF_262:
s_buffer_load_dwordx2 s[66:67], s[4:7], s46 glc
s_add_u32 s33, s33, 16384
s_bitset0_b32 s33, 16
s_barrier
buffer_load_dwordx4 v[4:7], v0, s[4:7], s33 offen offset:1024 sc1
buffer_load_dwordx4 v[8:11], v0, s[4:7], s33 offen offset:0 sc1
s_add_u32 s34, s33, 5120
s_add_u32 s35, s33, 9216
s_add_u32 s36, s36, 524288
s_add_u32 s37, s37, 10240
s_add_u32 s59, s59, 10240
v_mov_b64 v[32:33], 0
v_mov_b64 v[34:35], 0
v_mov_b64 v[36:37], 0
v_mov_b64 v[38:39], 0
v_mov_b64 v[40:41], 0
v_mov_b64 v[42:43], 0
v_mov_b64 v[44:45], 0
v_mov_b64 v[46:47], 0
s_sub_u32 s45, s45, 1
v_mov_b64 v[24:25], 0
v_mov_b64 v[26:27], 0
v_mov_b64 v[28:29], 0
v_mov_b64 v[30:31], 0
v_lshlrev_b32 v23, v0, s58
v_cndmask_b32 v20, 0, v23, s[90:91]
v_cndmask_b32 v21, 0, v23, s[92:93]
v_cndmask_b32 v22, 0, v23, s[94:95]
v_cndmask_b32 v23, 0, v23, s[96:97]
ds_read_b128 v[64:67], v0 offset:53248
ds_read_b128 v[68:71], v0 offset:54272
buffer_load_dwordx4 v[12:15], v0, s[4:7], s34 offen offset:0 sc1
s_cmp_lg_u32 s31, s47
s_cbranch_scc1 k_T0_247
s_branch k_done_257
k_cold2_249:
s_barrier
buffer_load_dwordx4 v[48:51], v0, s[4:7], s60 offen offset:0
buffer_load_dwordx4 v[52:55], v0, s[4:7], s60 offen offset:1024
buffer_load_dwordx4 v[56:59], v0, s[4:7], s60 offen offset:2048
buffer_load_dwordx4 v[60:63], v0, s[4:7], s60 offen offset:3072
ds_read_b128 v[64:67], v0 offset:53248
ds_read_b128 v[68:71], v0 offset:54272
k_cold_248:
buffer_load_dwordx4 v[4:7], v0, s[4:7], s33 offen offset:1024 sc1
buffer_load_dwordx4 v[8:11], v0, s[4:7], s33 offen offset:0 sc1
buffer_load_dwordx4 v[12:15], v0, s[4:7], s34 offen offset:0 sc1
s_sub_u32 s32, s32, 1
s_cmp_gt_i32 s32, 0
s_cbranch_scc0 k_okC_250
v_mov_b64 v[24:25], 0
v_mov_b64 v[26:27], 0
v_mov_b64 v[28:29], 0
v_mov_b64 v[30:31], 0
v_mov_b64 v[32:33], 0
v_mov_b64 v[34:35], 0
v_mov_b64 v[36:37], 0
v_mov_b64 v[38:39], 0
v_mov_b64 v[40:41], 0
v_mov_b64 v[42:43], 0
v_mov_b64 v[44:45], 0
v_mov_b64 v[46:47], 0
s_branch k_T0_247
k_coldA_251:
buffer_load_dwordx4 v[12:15], v0, s[4:7], s34 offen offset:0 sc1
s_sub_u32 s32, s32, 1
s_cmp_gt_i32 s32, 0
s_waitcnt vmcnt(0)
v_cmp_u_f32 vcc, v12, v12
ds_write_b128 v0, v[12:15] offset:3072
s_waitcnt lgkmcnt(0)
s_cbranch_vccz k_okA_252
s_cbranch_scc1 k_coldA_251
s_branch k_okA_252
k_coldB_253:
buffer_load_dwordx4 v[16:19], v0, s[4:7], s35 offen offset:0 sc1
s_sub_u32 s32, s32, 1
s_cmp_gt_i32 s32, 0
s_waitcnt vmcnt(0)
v_cmp_u_f32 vcc, v16, v16
ds_write_b128 v0, v[16:19] offset:7168
s_waitcnt lgkmcnt(0)
s_cbranch_vccz k_okB_254
s_cbranch_scc1 k_coldB_253
s_branch k_okB_254
k_fl_260:
buffer_load_dwordx2 v[46:47], off, s[4:7], s46 sc1
s_waitcnt vmcnt(0)
v_min_u32 v46, v46, v47
v_cmp_lt_u32 vcc, s31, v46
v_mov_b64 v[46:47], 0
s_cbranch_vccnz k_okF_262
s_sub_u32 s32, s32, 1
s_cmp_gt_i32 s32, 0
s_cbranch_scc1 k_fl_260
s_branch k_okF_262
k_slow_255:
ds_read_b128 v[24:27], v0 offset:0
ds_read_b128 v[28:31], v0 offset:1024
v_mov_b32 v46, 0xff7fffff
s_add_u32 s48, s36, 0xffffd000
buffer_load_dwordx4 v[32:35], v0, s[4:7], s48 offen offset:0 sc1
buffer_load_dwordx4 v[36:39], v0, s[4:7], s48 offen offset:1024 sc1
s_waitcnt vmcnt(1) lgkmcnt(1)
v_mfma_f32_16x16x32_bf16 v[4:7], v[32:35], v[24:27], 0
s_waitcnt vmcnt(0) lgkmcnt(0)
v_mfma_f32_16x16x32_bf16 v[4:7], v[36:39], v[28:31], v[4:7]
v_mov_b64 v[8:9], s[56:57]
s_nop 5
v_permlane32_swap_b32 v4, v6
v_permlane32_swap_b32 v5, v7
v_add_f32_dpp v8, v6, v4 row_ror:8 row_mask:0xf bank_mask:0x3
s_nop 0
v_add_f32_dpp v9, v7, v5 row_ror:8 row_mask:0xf bank_mask:0x3
v_max3_f32 v46, v46, v8, v9
s_add_u32 s48, s36, 0xffffe000
buffer_load_dwordx4 v[32:35], v0, s[4:7], s48 offen offset:0 sc1
buffer_load_dwordx4 v[36:39], v0, s[4:7], s48 offen offset:1024 sc1
s_waitcnt vmcnt(1)
v_mfma_f32_16x16x32_bf16 v[4:7], v[32:35], v[24:27], 0
s_waitcnt vmcnt(0)
v_mfma_f32_16x16x32_bf16 v[4:7], v[36:39], v[28:31], v[4:7]
v_mov_b64 v[10:11], s[56:57]
s_nop 5
v_permlane32_swap_b32 v4, v6
v_permlane32_swap_b32 v5, v7
v_add_f32_dpp v10, v6, v4 row_ror:8 row_mask:0xf bank_mask:0x3
s_nop 0
v_add_f32_dpp v11, v7, v5 row_ror:8 row_mask:0xf bank_mask:0x3
v_max3_f32 v46, v46, v10, v11
s_add_u32 s48, s36, 0xfffff000
buffer_load_dwordx4 v[32:35], v0, s[4:7], s48 offen offset:0 sc1
buffer_load_dwordx4 v[36:39], v0, s[4:7], s48 offen offset:1024 sc1
s_waitcnt vmcnt(1)
v_mfma_f32_16x16x32_bf16 v[4:7], v[32:35], v[24:27], 0
s_waitcnt vmcnt(0)
v_mfma_f32_16x16x32_bf16 v[4:7], v[36:39], v[28:31], v[4:7]
v_mov_b64 v[12:13], s[56:57]
s_nop 5
v_permlane32_swap_b32 v4, v6
v_permlane32_swap_b32 v5, v7
v_add_f32_dpp v12, v6, v4 row_ror:8 row_mask:0xf bank_mask:0x3
s_nop 0
v_add_f32_dpp v13, v7, v5 row_ror:8 row_mask:0xf bank_mask:0x3
v_max3_f32 v46, v46, v12, v13
s_add_u32 s48, s36, 0x0
buffer_load_dwordx4 v[32:35], v0, s[4:7], s48 offen offset:0 sc1
buffer_load_dwordx4 v[36:39], v0, s[4:7], s48 offen offset:1024 sc1
s_waitcnt vmcnt(1)
v_mfma_f32_16x16x32_bf16 v[4:7], v[32:35], v[24:27], 0
s_waitcnt vmcnt(0)
v_mfma_f32_16x16x32_bf16 v[4:7], v[36:39], v[28:31], v[4:7]
v_mov_b64 v[14:15], s[56:57]
s_nop 5
v_permlane32_swap_b32 v4, v6
v_permlane32_swap_b32 v5, v7
v_add_f32_dpp v14, v6, v4 row_ror:8 row_mask:0xf bank_mask:0x3
s_nop 0
v_add_f32_dpp v15, v7, v5 row_ror:8 row_mask:0xf bank_mask:0x3
v_max3_f32 v46, v46, v14, v15
ds_read_b128 v[32:35], v0 offset:2048
ds_read_b128 v[36:39], v0 offset:3072
s_waitcnt lgkmcnt(1)
v_mfma_f32_16x16x32_bf16 v[4:7], v[32:35], v[24:27], 0
s_waitcnt lgkmcnt(0)
v_mfma_f32_16x16x32_bf16 v[4:7], v[36:39], v[28:31], v[4:7]
v_mov_b64 v[44:45], s[56:57]
s_nop 5
v_permlane32_swap_b32 v4, v6
v_permlane32_swap_b32 v5, v7
v_add_f32_dpp v44, v6, v4 row_ror:8 row_mask:0xf bank_mask:0x3
s_nop 0
v_add_f32_dpp v45, v7, v5 row_ror:8 row_mask:0xf bank_mask:0x3
v_max3_f32 v46, v46, v44, v45
buffer_load_dwordx4 v[32:35], v0, s[4:7], s36 offen offset:2048 sc1
buffer_load_dwordx4 v[36:39], v0, s[4:7], s36 offen offset:3072 sc1
v_mov_b32 v47, v46
s_nop 1
v_permlane32_swap_b32 v46, v47
v_max_f32 v46, v46, v47
v_mov_b32 v47, v46
s_nop 1
v_permlane16_swap_b32 v46, v47
v_max_f32 v46, v46, v47
v_sub_f32 v8, v8, v46
v_exp_f32 v8, v8
v_sub_f32 v9, v9, v46
v_exp_f32 v9, v9
v_sub_f32 v10, v10, v46
v_exp_f32 v10, v10
v_sub_f32 v11, v11, v46
v_exp_f32 v11, v11
v_sub_f32 v12, v12, v46
v_exp_f32 v12, v12
v_sub_f32 v13, v13, v46
v_exp_f32 v13, v13
v_sub_f32 v14, v14, v46
v_exp_f32 v14, v14
v_sub_f32 v15, v15, v46
v_exp_f32 v15, v15
v_sub_f32 v44, v44, v46
v_exp_f32 v44, v44
v_sub_f32 v45, v45, v46
v_exp_f32 v45, v45
v_cvt_pk_bf16_f32 v4, v8, v9
v_cvt_pk_bf16_f32 v5, v10, v11
v_cvt_pk_bf16_f32 v6, v12, v13
v_cvt_pk_bf16_f32 v7, v14, v15
v_mov_b32_dpp v8, v4 row_ror:8 row_mask:0xf bank_mask:0xf
v_mov_b32_dpp v9, v5 row_ror:8 row_mask:0xf bank_mask:0xf
v_mov_b32_dpp v10, v6 row_ror:8 row_mask:0xf bank_mask:0xf
v_mov_b32_dpp v11, v7 row_ror:8 row_mask:0xf bank_mask:0xf
v_cvt_pk_bf16_f32 v24, v44, v45
v_cvt_pk_bf16_f32 v25, v44, v45
s_nop 0
v_mov_b32_dpp v26, v24 row_ror:8 row_mask:0xf bank_mask:0xf
v_mov_b32_dpp v27, v24 row_ror:8 row_mask:0xf bank_mask:0xf
v_mov_b64 v[28:29], s[52:53]
v_mov_b64 v[30:31], s[52:53]
s_nop 1
v_mfma_f32_16x16x32_bf16 v[44:47], v[28:31], v[4:7], 0
s_waitcnt vmcnt(1)
v_mfma_f32_16x16x32_bf16 v[12:15], v[32:35], v[4:7], 0
s_waitcnt vmcnt(0)
v_mfma_f32_16x16x32_bf16 v[12:15], v[36:39], v[8:11], v[12:15]
v_mfma_f32_16x16x32_bf16 v[12:15], v[40:43], v[24:27], v[12:15]
v_mov_b64 v[28:29], s[54:55]
s_nop 1
v_mfma_f32_16x16x16_bf16 v[44:47], v[28:29], v[24:25], v[44:47]
s_nop 6
v_rcp_f32 v4, v44
s_nop 1
v_rcp_f32_dpp v4, v44 row_ror:8 row_mask:0xf bank_mask:0xc
s_nop 0
v_mul_f32 v12, v4, v12
v_mul_f32 v13, v4, v13
v_mul_f32 v14, v4, v14
v_mul_f32 v15, v4, v15
v_cvt_pk_bf16_f32 v44, v12, v13
v_cvt_pk_bf16_f32 v45, v14, v15
v_and_b32 v12, 0xffffff7f, v0
v_and_or_b32 v8, v1, 8, v12
ds_write_b64 v8, v[44:45] offset:7296
v_mov_b32_dpp v46, v44 row_ror:8 row_mask:0xf bank_mask:0xf
v_mov_b32_dpp v47, v45 row_ror:8 row_mask:0xf bank_mask:0xf
v_mov_b64 v[24:25], 0
v_mov_b64 v[26:27], 0
v_mov_b64 v[28:29], 0
v_mov_b64 v[30:31], 0
v_mov_b64 v[32:33], 0
v_mov_b64 v[34:35], 0
v_mov_b64 v[36:37], 0
v_mov_b64 v[38:39], 0
s_waitcnt lgkmcnt(0)
s_branch k_okS_256
k_done_257:
buffer_load_dwordx4 v[16:19], v0, s[4:7], s35 offen offset:0 sc1
k_xs_263:
s_waitcnt vmcnt(1)
v_cmp_u_f32 vcc, v4, v12
s_waitcnt vmcnt(0)
v_cmp_u_f32 s[66:67], v16, v16
s_or_b64 vcc, vcc, s[66:67]
s_cbranch_vccz k_xd_264
buffer_load_dwordx4 v[4:7], v0, s[4:7], s33 offen offset:1024 sc1
buffer_load_dwordx4 v[8:11], v0, s[4:7], s33 offen offset:0 sc1
buffer_load_dwordx4 v[12:15], v0, s[4:7], s34 offen offset:0 sc1
buffer_load_dwordx4 v[16:19], v0, s[4:7], s35 offen offset:0 sc1
s_sub_u32 s32, s32, 1
s_cmp_gt_i32 s32, 0
s_cbranch_scc1 k_xs_263
k_xd_264:
s_waitcnt vmcnt(1)
buffer_store_dwordx4 v[12:15], v0, s[8:11], s37 offen offset:2048 sc1
s_waitcnt vmcnt(1)
buffer_store_dwordx4 v[16:19], v0, s[8:11], s59 offen offset:2048 sc1
s_add_u32 s31, s31, 1
s_branch k_jn_246
k_far_245:
s_mov_b32 s66, 0
k_fl2_279:
buffer_load_dwordx2 v[46:47], off, s[4:7], s46 sc1
s_waitcnt vmcnt(0)
v_min_u32 v46, v46, v47
v_cmp_lt_u32 vcc, s31, v46
v_mov_b64 v[46:47], 0
s_cbranch_vccnz k_cold2_267
s_sub_u32 s32, s32, 1
s_cmp_gt_i32 s32, 0
s_cbranch_scc1 k_fl2_279
s_branch k_cold2_267
k_T0_265:
s_waitcnt vmcnt(2)
v_smfmac_f32_16x16x64_bf16 v[40:43], v[4:7], v[48:55], v1
s_waitcnt vmcnt(1)
v_cmp_u_f32 vcc, v4, v8
v_smfmac_f32_16x16x64_bf16 v[24:27], v[8:11], a[24:31], v1
v_smfmac_f32_16x16x64_bf16 v[28:31], v[8:11], a[32:39], v1
s_cbranch_vccnz k_cold_266
k_okC_268:
s_waitcnt vmcnt(1)
v_smfmac_f32_16x16x64_bf16 v[36:39], v[8:11], a[40:47], v1
s_waitcnt lgkmcnt(0)
ds_read_b128 v[48:51], v2 offset:14336
v_smfmac_f32_16x16x64_bf16 v[32:35], v[4:7], v[64:71], v1
ds_read_b128 v[52:55], v2 offset:15360
ds_read_b128 v[64:67], v0 offset:51200
v_smfmac_f32_16x16x64_bf16 v[44:47], v[4:7], v[56:63], v1
ds_read_b128 v[68:71], v0 offset:52224
v_smfmac_f32_16x16x64_bf16 v[28:31], v[4:7], a[8:15], v1
v_smfmac_f32_16x16x64_bf16 v[24:27], v[4:7], a[0:7], v1
ds_read_b128 v[56:59], v2 offset:43008
v_smfmac_f32_16x16x64_bf16 v[36:39], v[4:7], a[16:23], v1
ds_read_b128 v[60:63], v2 offset:44032
s_waitcnt lgkmcnt(4)
v_smfmac_f32_16x16x64_bf16 v[40:43], v[8:11], v[48:55], v1
s_waitcnt vmcnt(0)
ds_write_b128 v0, v[12:15] offset:3072
s_waitcnt lgkmcnt(3)
v_smfmac_f32_16x16x64_bf16 v[32:35], v[8:11], v[64:71], v1
buffer_load_dwordx4 v[16:19], v0, s[4:7], s35 offen offset:0 sc1
v_cmp_u_f32 vcc, v12, v12
s_waitcnt lgkmcnt(1)
v_smfmac_f32_16x16x64_bf16 v[44:47], v[8:11], v[56:63], v1
ds_read_b128 v[56:59], v2 offset:16384
ds_read_b128 v[60:63], v2 offset:17408
ds_read_b128 v[64:67], v0 offset:61440
s_cbranch_vccnz k_coldA_269
k_okA_270:
v_smfmac_f32_16x16x64_bf16 v[36:39], v[12:15], a[64:71], v1
ds_read_b128 v[68:71], v0 offset:62464
s_waitcnt lgkmcnt(4)
v_smfmac_f32_16x16x64_bf16 v[40:43], v[12:15], a[72:79], v1
s_barrier
v_smfmac_f32_16x16x64_bf16 v[28:31], v[12:15], a[56:63], v1
ds_read_b128 v[8:11], v0 offset:0
buffer_load_dwordx4 v[48:51], v0, s[4:7], s36 offen offset:0 sc1
s_waitcnt lgkmcnt(3)
v_smfmac_f32_16x16x64_bf16 v[44:47], v[12:15], v[56:63], v1
ds_read_b128 v[56:59], v0 offset:63488
v_smfmac_f32_16x16x64_bf16 v[24:27], v[12:15], a[48:55], v1
ds_read_b128 v[60:63], v0 offset:64512
s_waitcnt lgkmcnt(3)
v_smfmac_f32_16x16x64_bf16 v[32:35], v[12:15], v[64:71], v1
buffer_load_dwordx4 v[52:55], v0, s[4:7], s36 offen offset:1024 sc1
s_waitcnt lgkmcnt(2)
v_smfmac_f32_16x16x64_bf16 v[24:27], v[8:11], a[80:87], v1
ds_read_b128 v[64:67], v0 offset:55296
ds_read_b128 v[68:71], v0 offset:56320
v_smfmac_f32_16x16x64_bf16 v[36:39], v[8:11], a[96:103], v1
s_waitcnt lgkmcnt(2)
ds_read_b128 v[4:7], v0 offset:1024
v_smfmac_f32_16x16x64_bf16 v[44:47], v[8:11], v[56:63], v1
ds_read_b128 v[56:59], v2 offset:12288
ds_read_b128 v[60:63], v2 offset:13312
v_smfmac_f32_16x16x64_bf16 v[28:31], v[8:11], a[88:95], v1
buffer_store_dwordx4 v[12:15], v0, s[8:11], s37 offen offset:2048 sc1
v_smfmac_f32_16x16x64_bf16 v[40:43], v[8:11], a[104:111], v1
s_waitcnt lgkmcnt(3)
s_waitcnt lgkmcnt(2)
v_smfmac_f32_16x16x64_bf16 v[32:35], v[8:11], v[64:71], v1
ds_read_b128 v[64:67], v0 offset:57344
ds_read_b128 v[12:15], v0 offset:2048
v_smfmac_f32_16x16x64_bf16 v[36:39], v[4:7], a[128:135], v1
s_waitcnt lgkmcnt(2)
v_smfmac_f32_16x16x64_bf16 v[44:47], v[4:7], v[56:63], v1
ds_read_b128 v[68:71], v0 offset:58368
buffer_load_dwordx4 v[56:59], v0, s[4:7], s36 offen offset:2048 sc1
v_smfmac_f32_16x16x64_bf16 v[28:31], v[4:7], a[120:127], v1
v_smfmac_f32_16x16x64_bf16 v[24:27], v[4:7], a[112:119], v1
s_waitcnt vmcnt(4)
ds_write_b128 v0, v[16:19] offset:7168
v_smfmac_f32_16x16x64_bf16 v[40:43], v[4:7], a[136:143], v1
s_waitcnt lgkmcnt(1)
buffer_load_dwordx4 v[60:63], v0, s[4:7], s36 offen offset:3072 sc1
v_cmp_u_f32 vcc, v16, v16
v_smfmac_f32_16x16x64_bf16 v[32:35], v[4:7], v[64:71], v1
ds_read_b128 v[64:67], v0 offset:59392
ds_read_b128 v[68:71], v0 offset:60416
v_smfmac_f32_16x16x64_bf16 v[28:31], v[12:15], a[152:159], v1
v_smfmac_f32_16x16x64_bf16 v[24:27], v[12:15], a[144:151], v1
s_cbranch_vccnz k_coldB_271
k_okB_272:
v_smfmac_f32_16x16x64_bf16 v[36:39], v[12:15], a[160:167], v1
s_waitcnt lgkmcnt(2)
buffer_store_dwordx4 v[16:19], v0, s[8:11], s59 offen offset:2048 sc1
s_barrier
ds_read_b128 v[4:7], v0 offset:5120
v_smfmac_f32_16x16x64_bf16 v[44:47], v[12:15], a[176:183], v1
ds_read_b128 v[8:11], v0 offset:4096
s_waitcnt lgkmcnt(2)
v_smfmac_f32_16x16x64_bf16 v[32:35], v[12:15], v[64:71], v1
ds_read_b128 v[64:67], v2 offset:22528
ds_read_b128 v[68:71], v2 offset:23552
v_smfmac_f32_16x16x64_bf16 v[24:27], v[16:19], a[184:191], v1
v_smfmac_f32_16x16x64_bf16 v[40:43], v[12:15], a[168:175], v1
s_waitcnt lgkmcnt(3)
ds_read_b128 v[12:15], v0 offset:6144
v_smfmac_f32_16x16x64_bf16 v[24:27], v[4:7], a[208:215], v1
s_waitcnt lgkmcnt(3)
v_smfmac_f32_16x16x64_bf16 v[28:31], v[4:7], a[216:223], v1
v_smfmac_f32_16x16x64_bf16 v[28:31], v[8:11], a[200:207], v1
s_waitcnt lgkmcnt(1)
v_smfmac_f32_16x16x64_bf16 v[24:27], v[8:11], v[64:71], v1
ds_read_b128 v[64:67], v2 offset:18432
s_waitcnt lgkmcnt(1)
v_smfmac_f32_16x16x64_bf16 v[24:27], v[12:15], a[224:231], v1
ds_read_b128 v[68:71], v2 offset:19456
v_smfmac_f32_16x16x64_bf16 v[28:31], v[12:15], a[232:239], v1
v_smfmac_f32_16x16x64_bf16 v[28:31], v[16:19], a[192:199], v1
v_cvt_pk_bf16_f32 v24, v24, v25
v_cvt_pk_bf16_f32 v25, v26, v27
v_smfmac_f32_16x16x64_bf16 v[32:35], v[4:7], v[80:87], v1
v_cvt_pk_bf16_f32 v26, v28, v29
v_cvt_pk_bf16_f32 v27, v30, v31
v_smfmac_f32_16x16x64_bf16 v[32:35], v[8:11], a[248:255], v1
s_waitcnt lgkmcnt(0)
v_mfma_f32_16x16x32_bf16 v[28:31], v[24:27], v[20:23], 0
v_and_b32 v26, 0xffffff7f, v0
v_smfmac_f32_16x16x64_bf16 v[32:35], v[16:19], v[64:71], v1
v_and_or_b32 v26, v1, 8, v26
v_mul_f32 v28, s51, v28
v_mul_f32 v29, s51, v29
v_mul_f32 v31, s51, v31
v_cvt_pk_bf16_f32 v24, v28, v29
v_mul_f32 v30, s51, v30
v_cvt_pk_bf16_f32 v25, v30, v31
v_smfmac_f32_16x16x64_bf16 v[32:35], v[12:15], v[96:103], v1
ds_write_b64 v26, v[24:25] offset:1152
v_smfmac_f32_16x16x64_bf16 v[36:39], v[8:11], v[72:79], v1
v_cvt_pk_bf16_f32 v32, v32, v33
v_smfmac_f32_16x16x64_bf16 v[36:39], v[16:19], a[240:247], v1
buffer_load_dwordx4 v[64:67], v0, s[4:7], s61 offen offset:0
v_cvt_pk_bf16_f32 v33, v34, v35
v_smfmac_f32_16x16x64_bf16 v[36:39], v[12:15], v[104:111], v1
s_waitcnt lgkmcnt(0)
v_smfmac_f32_16x16x64_bf16 v[36:39], v[4:7], v[88:95], v1
s_barrier
ds_read_b128 v[24:27], v0 offset:0
v_smfmac_f32_16x16x64_bf16 v[40:43], v[4:7], v[144:151], v1
ds_read_b128 v[28:31], v0 offset:1024
s_nop 0
v_cvt_pk_bf16_f32 v34, v36, v37
v_cvt_pk_bf16_f32 v35, v38, v39
s_nop 1
v_mfma_f32_16x16x32_bf16 v[36:39], v[32:35], v[20:23], 0
s_waitcnt vmcnt(5)
buffer_load_dwordx4 v[68:71], v0, s[4:7], s61 offen offset:1024
v_and_b32 v34, 0xffffff7f, v0
v_and_or_b32 v34, v1, 8, v34
s_waitcnt lgkmcnt(1)
v_mfma_f32_16x16x32_bf16 v[48:51], v[48:51], v[24:27], 0
v_cvt_pk_bf16_f32 v32, v36, v37
s_waitcnt lgkmcnt(0)
v_mfma_f32_16x16x32_bf16 v[48:51], v[52:55], v[28:31], v[48:51]
v_mov_b64 v[52:53], s[56:57]
v_cvt_pk_bf16_f32 v33, v38, v39
v_smfmac_f32_16x16x64_bf16 v[44:47], v[4:7], v[152:159], v1
ds_write_b64 v34, v[32:33] offset:3200
v_permlane32_swap_b32 v48, v50
v_permlane32_swap_b32 v49, v51
v_add_f32_dpp v52, v50, v48 row_ror:8 row_mask:0xf bank_mask:0x3
v_exp_f32 v52, v52
v_add_f32_dpp v53, v51, v49 row_ror:8 row_mask:0xf bank_mask:0x3
v_exp_f32 v53, v53
s_nop 0
v_cvt_pk_bf16_f32 v48, v52, v53
v_smfmac_f32_16x16x64_bf16 v[44:47], v[16:19], v[120:127], v1
ds_write_b32 v0, v48 offset:4108
v_smfmac_f32_16x16x64_bf16 v[44:47], v[12:15], v[168:175], v1
buffer_load_dwordx4 v[48:51], v0, s[4:7], s61 offen offset:2048
v_smfmac_f32_16x16x64_bf16 v[40:43], v[12:15], v[160:167], v1
s_waitcnt lgkmcnt(1)
v_xor_b32 v12, 0x80, v0
v_smfmac_f32_16x16x64_bf16 v[40:43], v[8:11], v[128:135], v1
s_waitcnt lgkmcnt(0)
s_barrier
ds_read_b128 v[32:35], v0 offset:2048
v_mov_b64 v[22:23], s[52:53]
v_smfmac_f32_16x16x64_bf16 v[40:43], v[16:19], v[112:119], v1
ds_read_b128 v[36:39], v0 offset:3072
ds_read_b128 v[16:19], v0 offset:4096
buffer_load_dwordx4 v[52:55], v0, s[4:7], s61 offen offset:3072
v_smfmac_f32_16x16x64_bf16 v[44:47], v[8:11], v[136:143], v1
ds_read_b128 v[12:15], v12 offset:4096
v_cvt_pk_bf16_f32 v40, v40, v41
v_mov_b64 v[20:21], s[52:53]
s_waitcnt lgkmcnt(3)
v_mfma_f32_16x16x32_bf16 v[24:27], v[32:35], v[24:27], 0
v_cvt_pk_bf16_f32 v41, v42, v43
s_waitcnt lgkmcnt(2)
v_mfma_f32_16x16x32_bf16 v[24:27], v[36:39], v[28:31], v[24:27]
s_waitcnt vmcnt(5)
s_waitcnt lgkmcnt(1)
v_mfma_f32_16x16x32_bf16 v[8:11], v[56:59], v[16:19], 0
buffer_load_dwordx4 v[56:59], v0, s[4:7], s62 offen offset:0
v_mov_b64 v[28:29], s[56:57]
v_cvt_pk_bf16_f32 v43, v46, v47
v_cvt_pk_bf16_f32 v42, v44, v45
v_permlane32_swap_b32 v25, v27
v_permlane32_swap_b32 v24, v26
v_mfma_f32_16x16x32_bf16 v[4:7], v[20:23], v[16:19], 0
s_waitcnt lgkmcnt(0)
v_add_f32_dpp v28, v26, v24 row_ror:8 row_mask:0xf bank_mask:0x3
v_add_f32_dpp v29, v27, v25 row_ror:8 row_mask:0xf bank_mask:0x3
v_exp_f32 v28, v28
v_mfma_f32_16x16x32_bf16 v[8:11], v[60:63], v[12:15], v[8:11]
buffer_load_dwordx4 v[60:63], v0, s[4:7], s62 offen offset:1024
v_exp_f32 v29, v29
v_permlane32_swap_b32 v42, v43
v_cvt_pk_bf16_f32 v24, v28, v29
v_mov_b64 v[44:45], s[54:55]
v_cvt_pk_bf16_f32 v25, v28, v29
v_mov_b32_dpp v26, v24 row_ror:8 row_mask:0xf bank_mask:0xf
v_mov_b32_dpp v27, v24 row_ror:8 row_mask:0xf bank_mask:0xf
v_mfma_f32_16x16x16_bf16 v[4:7], v[44:45], v[24:25], v[4:7]
v_permlane32_swap_b32 v40, v41
v_mov_b64 v[36:37], 0
v_mov_b64 v[38:39], 0
v_mov_b64 v[30:31], 0
v_mfma_f32_16x16x32_bf16 v[8:11], v[40:43], v[24:27], v[8:11]
buffer_load_dwordx4 v[16:19], v0, s[4:7], s62 offen offset:2048
v_rcp_f32 v6, v4
v_and_b32 v12, 0xffffff7f, v0
v_and_or_b32 v13, v1, 8, v12
v_rcp_f32_dpp v6, v4 row_ror:8 row_mask:0xf bank_mask:0xc
v_mov_b64 v[26:27], 0
v_pk_mul_f32 v[8:9], v[8:9], v[6:7] op_sel_hi:[1,0]
v_cvt_pk_bf16_f32 v44, v8, v9
v_pk_mul_f32 v[10:11], v[10:11], v[6:7] op_sel_hi:[1,0]
v_cvt_pk_bf16_f32 v45, v10, v11
s_waitcnt vmcnt(5)
ds_write_b64 v13, v[44:45] offset:7296
buffer_load_dwordx4 v[20:23], v0, s[4:7], s62 offen offset:3072
v_add_u32 v6, 0xd4800000, v6
v_cmp_lt_u32 vcc, 0x28000000, v6
v_mov_b64 v[34:35], 0
v_mov_b32_dpp v46, v44 row_ror:8 row_mask:0xf bank_mask:0xf
v_mov_b32_dpp v47, v45 row_ror:8 row_mask:0xf bank_mask:0xf
v_mov_b64 v[28:29], 0
v_mov_b64 v[32:33], 0
s_cbranch_vccnz k_slow_273
k_okS_274:
v_smfmac_f32_16x16x64_bf16 v[36:39], v[44:47], v[224:231], v1
s_waitcnt lgkmcnt(0)
s_barrier
ds_read_b128 v[8:11], v12 offset:6272
v_smfmac_f32_16x16x64_bf16 v[32:35], v[44:47], v[200:207], v1
s_waitcnt vmcnt(4)
ds_read_b128 v[4:7], v12 offset:6144
v_mov_b64 v[24:25], 0
v_smfmac_f32_16x16x64_bf16 v[28:31], v[44:47], v[48:55], v1
ds_read_b128 v[12:15], v12 offset:7168
ds_read_b128 v[48:51], v2 offset:40960
v_smfmac_f32_16x16x64_bf16 v[24:27], v[44:47], v[64:71], v1
ds_read_b128 v[52:55], v2 offset:41984
v_mov_b64 v[42:43], 0
s_waitcnt lgkmcnt(4)
v_smfmac_f32_16x16x64_bf16 v[24:27], v[8:11], v[184:191], v1
s_waitcnt lgkmcnt(3)
v_mov_b64 v[40:41], 0
v_smfmac_f32_16x16x64_bf16 v[24:27], v[4:7], v[176:183], v1
s_waitcnt lgkmcnt(2)
ds_read_b128 v[64:67], v2 offset:20480
v_smfmac_f32_16x16x64_bf16 v[24:27], v[12:15], v[192:199], v1
ds_read_b128 v[68:71], v2 offset:21504
v_smfmac_f32_16x16x64_bf16 v[40:43], v[44:47], v[240:247], v1
s_waitcnt vmcnt(2)
s_waitcnt lgkmcnt(2)
v_lshrrev_b32 v44, 16, v1
v_cvt_pk_bf16_f32 v24, v24, v25
v_bfi_b32 v24, 1, s45, v24
v_cvt_pk_bf16_f32 v25, v26, v27
v_smfmac_f32_16x16x64_bf16 v[28:31], v[8:11], v[48:55], v1
buffer_store_dwordx2 v[24:25], v44, s[4:7], s38 offen sc1
ds_read_b128 v[48:51], v2 offset:38912
ds_read_b128 v[52:55], v2 offset:39936
v_smfmac_f32_16x16x64_bf16 v[28:31], v[12:15], v[56:63], v1
s_waitcnt lgkmcnt(2)
ds_read_b128 v[56:59], v2 offset:45056
v_smfmac_f32_16x16x64_bf16 v[28:31], v[4:7], v[64:71], v1
ds_read_b128 v[60:63], v2 offset:46080
v_smfmac_f32_16x16x64_bf16 v[32:35], v[8:11], v[208:215], v1
ds_read_b128 v[64:67], v2 offset:36864
s_nop 0
v_cvt_pk_bf16_f32 v28, v28, v29
v_bfi_b32 v28, 1, s45, v28
v_cvt_pk_bf16_f32 v29, v30, v31
v_smfmac_f32_16x16x64_bf16 v[32:35], v[12:15], v[216:223], v1
buffer_store_dwordx2 v[28:29], v44, s[4:7], s39 offen sc1
v_smfmac_f32_16x16x64_bf16 v[40:43], v[12:15], v[248:255], v1
ds_read_b128 v[68:71], v2 offset:37888
s_waitcnt vmcnt(2)
v_smfmac_f32_16x16x64_bf16 v[32:35], v[4:7], v[16:23], v1
s_waitcnt lgkmcnt(2)
v_smfmac_f32_16x16x64_bf16 v[36:39], v[12:15], v[232:239], v1
ds_read_b128 v[16:19], v2 offset:47104
ds_read_b128 v[20:23], v2 offset:48128
v_cvt_pk_bf16_f32 v32, v32, v33
v_bfi_b32 v32, 1, s45, v32
v_cvt_pk_bf16_f32 v33, v34, v35
v_smfmac_f32_16x16x64_bf16 v[36:39], v[8:11], v[48:55], v1
buffer_store_dwordx2 v[32:33], v44, s[4:7], s40 offen sc1
s_waitcnt lgkmcnt(2)
v_smfmac_f32_16x16x64_bf16 v[36:39], v[4:7], v[64:71], v1
s_nop 6
v_cvt_pk_bf16_f32 v36, v36, v37
v_cvt_pk_bf16_f32 v37, v38, v39
s_waitcnt lgkmcnt(0)
v_bfi_b32 v36, 1, s45, v36
v_smfmac_f32_16x16x64_bf16 v[40:43], v[8:11], v[16:23], v1
buffer_store_dwordx2 v[36:37], v44, s[4:7], s41 offen sc1
v_smfmac_f32_16x16x64_bf16 v[40:43], v[4:7], v[56:63], v1
s_nop 6
v_cvt_pk_bf16_f32 v40, v40, v41
v_bfi_b32 v40, 1, s45, v40
v_cvt_pk_bf16_f32 v41, v42, v43
buffer_store_dwordx2 v[40:41], v44, s[4:7], s42 offen sc1
s_barrier
buffer_load_dwordx4 v[48:51], v0, s[4:7], s60 offen offset:0
buffer_load_dwordx4 v[52:55], v0, s[4:7], s60 offen offset:1024
buffer_load_dwordx4 v[56:59], v0, s[4:7], s60 offen offset:2048
buffer_load_dwordx4 v[60:63], v0, s[4:7], s60 offen offset:3072
s_add_u32 s31, s31, 1
s_min_u32 s66, s66, s67
s_cmp_gt_u32 s66, s31
s_cbranch_scc0 k_fl_278
k_okF_280:
s_buffer_load_dwordx2 s[66:67], s[4:7], s46 glc
s_add_u32 s33, s33, 16384
s_bitset0_b32 s33, 16
s_barrier
buffer_load_dwordx4 v[4:7], v0, s[4:7], s33 offen offset:1024 sc1
buffer_load_dwordx4 v[8:11], v0, s[4:7], s33 offen offset:0 sc1
s_add_u32 s34, s33, 5120
s_add_u32 s35, s33, 9216
s_add_u32 s36, s36, 524288
s_add_u32 s37, s37, 10240
s_add_u32 s59, s59, 10240
v_mov_b64 v[32:33], 0
v_mov_b64 v[34:35], 0
v_mov_b64 v[36:37], 0
v_mov_b64 v[38:39], 0
v_mov_b64 v[40:41], 0
v_mov_b64 v[42:43], 0
v_mov_b64 v[44:45], 0
v_mov_b64 v[46:47], 0
s_sub_u32 s45, s45, 1
v_mov_b64 v[24:25], 0
v_mov_b64 v[26:27], 0
v_mov_b64 v[28:29], 0
v_mov_b64 v[30:31], 0
v_lshlrev_b32 v23, v0, s58
v_cndmask_b32 v20, 0, v23, s[90:91]
v_cndmask_b32 v21, 0, v23, s[92:93]
v_cndmask_b32 v22, 0, v23, s[94:95]
v_cndmask_b32 v23, 0, v23, s[96:97]
ds_read_b128 v[64:67], v0 offset:53248
ds_read_b128 v[68:71], v0 offset:54272
buffer_load_dwordx4 v[12:15], v0, s[4:7], s34 offen offset:0 sc1
s_cmp_lg_u32 s31, s47
s_cbranch_scc1 k_T0_265
s_branch k_done_275
k_cold2_267:
s_barrier
buffer_load_dwordx4 v[48:51], v0, s[4:7], s60 offen offset:0
buffer_load_dwordx4 v[52:55], v0, s[4:7], s60 offen offset:1024
buffer_load_dwordx4 v[56:59], v0, s[4:7], s60 offen offset:2048
buffer_load_dwordx4 v[60:63], v0, s[4:7], s60 offen offset:3072
ds_read_b128 v[64:67], v0 offset:53248
ds_read_b128 v[68:71], v0 offset:54272
k_cold_266:
buffer_load_dwordx4 v[4:7], v0, s[4:7], s33 offen offset:1024 sc1
buffer_load_dwordx4 v[8:11], v0, s[4:7], s33 offen offset:0 sc1
buffer_load_dwordx4 v[12:15], v0, s[4:7], s34 offen offset:0 sc1
s_sub_u32 s32, s32, 1
s_cmp_gt_i32 s32, 0
s_cbranch_scc0 k_okC_268
v_mov_b64 v[24:25], 0
v_mov_b64 v[26:27], 0
v_mov_b64 v[28:29], 0
v_mov_b64 v[30:31], 0
v_mov_b64 v[32:33], 0
v_mov_b64 v[34:35], 0
v_mov_b64 v[36:37], 0
v_mov_b64 v[38:39], 0
v_mov_b64 v[40:41], 0
v_mov_b64 v[42:43], 0
v_mov_b64 v[44:45], 0
v_mov_b64 v[46:47], 0
s_branch k_T0_265
k_coldA_269:
buffer_load_dwordx4 v[12:15], v0, s[4:7], s34 offen offset:0 sc1
s_sub_u32 s32, s32, 1
s_cmp_gt_i32 s32, 0
s_waitcnt vmcnt(0)
v_cmp_u_f32 vcc, v12, v12
ds_write_b128 v0, v[12:15] offset:3072
s_waitcnt lgkmcnt(0)
s_cbranch_vccz k_okA_270
s_cbranch_scc1 k_coldA_269
s_branch k_okA_270
k_coldB_271:
buffer_load_dwordx4 v[16:19], v0, s[4:7], s35 offen offset:0 sc1
s_sub_u32 s32, s32, 1
s_cmp_gt_i32 s32, 0
s_waitcnt vmcnt(0)
v_cmp_u_f32 vcc, v16, v16
ds_write_b128 v0, v[16:19] offset:7168
s_waitcnt lgkmcnt(0)
s_cbranch_vccz k_okB_272
s_cbranch_scc1 k_coldB_271
s_branch k_okB_272
k_fl_278:
buffer_load_dwordx2 v[46:47], off, s[4:7], s46 sc1
s_waitcnt vmcnt(0)
v_min_u32 v46, v46, v47
v_cmp_lt_u32 vcc, s31, v46
v_mov_b64 v[46:47], 0
s_cbranch_vccnz k_okF_280
s_sub_u32 s32, s32, 1
s_cmp_gt_i32 s32, 0
s_cbranch_scc1 k_fl_278
s_branch k_okF_280
k_slow_273:
ds_read_b128 v[24:27], v0 offset:0
ds_read_b128 v[28:31], v0 offset:1024
v_mov_b32 v46, 0xff7fffff
s_add_u32 s48, s36, 0xffffd000
buffer_load_dwordx4 v[32:35], v0, s[4:7], s48 offen offset:0 sc1
buffer_load_dwordx4 v[36:39], v0, s[4:7], s48 offen offset:1024 sc1
s_waitcnt vmcnt(1) lgkmcnt(1)
v_mfma_f32_16x16x32_bf16 v[4:7], v[32:35], v[24:27], 0
s_waitcnt vmcnt(0) lgkmcnt(0)
v_mfma_f32_16x16x32_bf16 v[4:7], v[36:39], v[28:31], v[4:7]
v_mov_b64 v[8:9], s[56:57]
s_nop 5
v_permlane32_swap_b32 v4, v6
v_permlane32_swap_b32 v5, v7
v_add_f32_dpp v8, v6, v4 row_ror:8 row_mask:0xf bank_mask:0x3
s_nop 0
v_add_f32_dpp v9, v7, v5 row_ror:8 row_mask:0xf bank_mask:0x3
v_max3_f32 v46, v46, v8, v9
s_add_u32 s48, s36, 0xffffe000
buffer_load_dwordx4 v[32:35], v0, s[4:7], s48 offen offset:0 sc1
buffer_load_dwordx4 v[36:39], v0, s[4:7], s48 offen offset:1024 sc1
s_waitcnt vmcnt(1)
v_mfma_f32_16x16x32_bf16 v[4:7], v[32:35], v[24:27], 0
s_waitcnt vmcnt(0)
v_mfma_f32_16x16x32_bf16 v[4:7], v[36:39], v[28:31], v[4:7]
v_mov_b64 v[10:11], s[56:57]
s_nop 5
v_permlane32_swap_b32 v4, v6
v_permlane32_swap_b32 v5, v7
v_add_f32_dpp v10, v6, v4 row_ror:8 row_mask:0xf bank_mask:0x3
s_nop 0
v_add_f32_dpp v11, v7, v5 row_ror:8 row_mask:0xf bank_mask:0x3
v_max3_f32 v46, v46, v10, v11
s_add_u32 s48, s36, 0xfffff000
buffer_load_dwordx4 v[32:35], v0, s[4:7], s48 offen offset:0 sc1
buffer_load_dwordx4 v[36:39], v0, s[4:7], s48 offen offset:1024 sc1
s_waitcnt vmcnt(1)
v_mfma_f32_16x16x32_bf16 v[4:7], v[32:35], v[24:27], 0
s_waitcnt vmcnt(0)
v_mfma_f32_16x16x32_bf16 v[4:7], v[36:39], v[28:31], v[4:7]
v_mov_b64 v[12:13], s[56:57]
s_nop 5
v_permlane32_swap_b32 v4, v6
v_permlane32_swap_b32 v5, v7
v_add_f32_dpp v12, v6, v4 row_ror:8 row_mask:0xf bank_mask:0x3
s_nop 0
v_add_f32_dpp v13, v7, v5 row_ror:8 row_mask:0xf bank_mask:0x3
v_max3_f32 v46, v46, v12, v13
s_add_u32 s48, s36, 0x0
buffer_load_dwordx4 v[32:35], v0, s[4:7], s48 offen offset:0 sc1
buffer_load_dwordx4 v[36:39], v0, s[4:7], s48 offen offset:1024 sc1
s_waitcnt vmcnt(1)
v_mfma_f32_16x16x32_bf16 v[4:7], v[32:35], v[24:27], 0
s_waitcnt vmcnt(0)
v_mfma_f32_16x16x32_bf16 v[4:7], v[36:39], v[28:31], v[4:7]
v_mov_b64 v[14:15], s[56:57]
s_nop 5
v_permlane32_swap_b32 v4, v6
v_permlane32_swap_b32 v5, v7
v_add_f32_dpp v14, v6, v4 row_ror:8 row_mask:0xf bank_mask:0x3
s_nop 0
v_add_f32_dpp v15, v7, v5 row_ror:8 row_mask:0xf bank_mask:0x3
v_max3_f32 v46, v46, v14, v15
ds_read_b128 v[32:35], v0 offset:2048
ds_read_b128 v[36:39], v0 offset:3072
s_waitcnt lgkmcnt(1)
v_mfma_f32_16x16x32_bf16 v[4:7], v[32:35], v[24:27], 0
s_waitcnt lgkmcnt(0)
v_mfma_f32_16x16x32_bf16 v[4:7], v[36:39], v[28:31], v[4:7]
v_mov_b64 v[44:45], s[56:57]
s_nop 5
v_permlane32_swap_b32 v4, v6
v_permlane32_swap_b32 v5, v7
v_add_f32_dpp v44, v6, v4 row_ror:8 row_mask:0xf bank_mask:0x3
s_nop 0
v_add_f32_dpp v45, v7, v5 row_ror:8 row_mask:0xf bank_mask:0x3
v_max3_f32 v46, v46, v44, v45
buffer_load_dwordx4 v[32:35], v0, s[4:7], s36 offen offset:2048 sc1
buffer_load_dwordx4 v[36:39], v0, s[4:7], s36 offen offset:3072 sc1
v_mov_b32 v47, v46
s_nop 1
v_permlane32_swap_b32 v46, v47
v_max_f32 v46, v46, v47
v_mov_b32 v47, v46
s_nop 1
v_permlane16_swap_b32 v46, v47
v_max_f32 v46, v46, v47
v_sub_f32 v8, v8, v46
v_exp_f32 v8, v8
v_sub_f32 v9, v9, v46
v_exp_f32 v9, v9
v_sub_f32 v10, v10, v46
v_exp_f32 v10, v10
v_sub_f32 v11, v11, v46
v_exp_f32 v11, v11
v_sub_f32 v12, v12, v46
v_exp_f32 v12, v12
v_sub_f32 v13, v13, v46
v_exp_f32 v13, v13
v_sub_f32 v14, v14, v46
v_exp_f32 v14, v14
v_sub_f32 v15, v15, v46
v_exp_f32 v15, v15
v_sub_f32 v44, v44, v46
v_exp_f32 v44, v44
v_sub_f32 v45, v45, v46
v_exp_f32 v45, v45
v_cvt_pk_bf16_f32 v4, v8, v9
v_cvt_pk_bf16_f32 v5, v10, v11
v_cvt_pk_bf16_f32 v6, v12, v13
v_cvt_pk_bf16_f32 v7, v14, v15
v_mov_b32_dpp v8, v4 row_ror:8 row_mask:0xf bank_mask:0xf
v_mov_b32_dpp v9, v5 row_ror:8 row_mask:0xf bank_mask:0xf
v_mov_b32_dpp v10, v6 row_ror:8 row_mask:0xf bank_mask:0xf
v_mov_b32_dpp v11, v7 row_ror:8 row_mask:0xf bank_mask:0xf
v_cvt_pk_bf16_f32 v24, v44, v45
v_cvt_pk_bf16_f32 v25, v44, v45
s_nop 0
v_mov_b32_dpp v26, v24 row_ror:8 row_mask:0xf bank_mask:0xf
v_mov_b32_dpp v27, v24 row_ror:8 row_mask:0xf bank_mask:0xf
v_mov_b64 v[28:29], s[52:53]
v_mov_b64 v[30:31], s[52:53]
s_nop 1
v_mfma_f32_16x16x32_bf16 v[44:47], v[28:31], v[4:7], 0
s_waitcnt vmcnt(1)
v_mfma_f32_16x16x32_bf16 v[12:15], v[32:35], v[4:7], 0
s_waitcnt vmcnt(0)
v_mfma_f32_16x16x32_bf16 v[12:15], v[36:39], v[8:11], v[12:15]
v_mfma_f32_16x16x32_bf16 v[12:15], v[40:43], v[24:27], v[12:15]
v_mov_b64 v[28:29], s[54:55]
s_nop 1
v_mfma_f32_16x16x16_bf16 v[44:47], v[28:29], v[24:25], v[44:47]
s_nop 6
v_rcp_f32 v4, v44
s_nop 1
v_rcp_f32_dpp v4, v44 row_ror:8 row_mask:0xf bank_mask:0xc
s_nop 0
v_mul_f32 v12, v4, v12
v_mul_f32 v13, v4, v13
v_mul_f32 v14, v4, v14
v_mul_f32 v15, v4, v15
v_cvt_pk_bf16_f32 v44, v12, v13
v_cvt_pk_bf16_f32 v45, v14, v15
v_and_b32 v12, 0xffffff7f, v0
v_and_or_b32 v8, v1, 8, v12
ds_write_b64 v8, v[44:45] offset:7296
v_mov_b32_dpp v46, v44 row_ror:8 row_mask:0xf bank_mask:0xf
v_mov_b32_dpp v47, v45 row_ror:8 row_mask:0xf bank_mask:0xf
v_mov_b64 v[24:25], 0
v_mov_b64 v[26:27], 0
v_mov_b64 v[28:29], 0
v_mov_b64 v[30:31], 0
v_mov_b64 v[32:33], 0
v_mov_b64 v[34:35], 0
v_mov_b64 v[36:37], 0
v_mov_b64 v[38:39], 0
s_waitcnt lgkmcnt(0)
s_branch k_okS_274
k_done_275:
buffer_load_dwordx4 v[16:19], v0, s[4:7], s35 offen offset:0 sc1
k_xs_281:
s_waitcnt vmcnt(1)
v_cmp_u_f32 vcc, v4, v12
s_waitcnt vmcnt(0)
v_cmp_u_f32 s[66:67], v16, v16
s_or_b64 vcc, vcc, s[66:67]
s_cbranch_vccz k_xd_282
buffer_load_dwordx4 v[4:7], v0, s[4:7], s33 offen offset:1024 sc1
buffer_load_dwordx4 v[8:11], v0, s[4:7], s33 offen offset:0 sc1
buffer_load_dwordx4 v[12:15], v0, s[4:7], s34 offen offset:0 sc1
buffer_load_dwordx4 v[16:19], v0, s[4:7], s35 offen offset:0 sc1
s_sub_u32 s32, s32, 1
s_cmp_gt_i32 s32, 0
s_cbranch_scc1 k_xs_281
k_xd_282:
s_waitcnt vmcnt(1)
buffer_store_dwordx4 v[12:15], v0, s[8:11], s37 offen offset:2048 sc1
s_waitcnt vmcnt(1)
buffer_store_dwordx4 v[16:19], v0, s[8:11], s59 offen offset:2048 sc1
s_add_u32 s31, s31, 1
k_jn_246:
s_cmp_lt_u32 s31, 128
s_cbranch_scc1 k_lay_244
s_add_u32 s30, s30, 112
s_waitcnt vmcnt(0) lgkmcnt(0)
s_barrier
s_branch k_fin_7
.section .rodata,"a"
.p2align 6
.amdhsa_kernel interleave_layers__memory_aug_recurrent_mem_tr__spectral_gfnet__prompt_kernel
  .amdhsa_next_free_vgpr 512
  .amdhsa_next_free_sgpr 102
  .amdhsa_accum_offset 256
  .amdhsa_group_segment_fixed_size 0
  .amdhsa_kernarg_size 104
  .amdhsa_user_sgpr_count 2
  .amdhsa_user_sgpr_kernarg_segment_ptr 1
  .amdhsa_system_sgpr_workgroup_id_x 1
  .amdhsa_float_denorm_mode_32 3
.end_amdhsa_kernel
```

```asm
; @launch grid=(256,1,1) block=(256,1,1) lds=163840
.amdgcn_target "amdgcn-amd-amdhsa--gfx950"
.text
.globl interleave_layers__memory_aug_recurrent_mem_tr__spectral_gfnet__prompt_kernel
.p2align 8
.type interleave_layers__memory_aug_recurrent_mem_tr__spectral_gfnet__prompt_kernel,@function
interleave_layers__memory_aug_recurrent_mem_tr__spectral_gfnet__prompt_kernel:
s_load_dwordx2 s[72:73], s[0:1], 8
s_load_dwordx4 s[76:79], s[0:1], 16
s_load_dwordx4 s[80:83], s[0:1], 32
s_load_dwordx2 s[28:29], s[0:1], 88
s_load_dwordx2 s[74:75], s[0:1], 96
v_lshrrev_b32 v1, 6, v0
v_and_b32 v0, 63, v0
v_readfirstlane_b32 s3, v1
s_waitcnt lgkmcnt(0)
s_mov_b32 s4, s74
s_mov_b32 s5, s75
s_mov_b32 s6, 268435456
s_mov_b32 s7, 0x20000
s_mov_b32 s8, s76
s_mov_b32 s9, s77
s_mov_b32 s10, 5242880
s_mov_b32 s11, 0x20000
s_mov_b32 s12, s78
s_mov_b32 s13, s79
s_mov_b32 s14, 5242880
s_mov_b32 s15, 0x20000
s_mov_b32 s16, s80
s_mov_b32 s17, s81
s_mov_b32 s18, 5242880
s_mov_b32 s19, 0x20000
s_mov_b32 s20, s82
s_mov_b32 s21, s83
s_mov_b32 s22, 5242880
s_mov_b32 s23, 0x20000
s_mov_b32 s24, s72
s_mov_b32 s25, s73
s_mov_b32 s26, 10240
s_mov_b32 s27, 0x20000
s_mov_b32 s32, 400000
s_getreg_b32 s52, hwreg(HW_REG_XCC_ID, 0, 4)
s_cmp_lg_u32 s3, 0
s_cbranch_scc1 k_skip_1
s_mov_b32 s55, s52
s_mov_b32 s54, 400
v_mov_b32 v4, 0
s_mov_b64 exec, 0xff
v_mov_b32 v4, 30
v_writelane_b32 v4, 32, 0
v_writelane_b32 v4, 28, 7
v_lshlrev_b32 v5, 2, v0
v_mov_b32 v2, 1
k_clm_9:
s_mov_b64 exec, 1
s_lshl_b32 s53, s52, 2
v_mov_b32 v1, s53
global_atomic_add v3, v1, v2, s[28:29] sc0 sc1
v_readlane_b32 s53, v4, s52
s_nop 3
s_waitcnt vmcnt(0)
v_cmp_gt_u32 vcc, s53, v3
s_cbranch_vccnz k_got_11
s_mov_b64 exec, 0xff
k_spr_10:
global_load_dword v6, v5, s[28:29] sc1
v_mov_b32 v3, 99
s_waitcnt vmcnt(0)
v_cmp_lt_u32 vcc, v6, v4
s_cbranch_vccz k_got_11
s_sub_u32 s54, s54, 1
s_cmp_gt_i32 s54, 0
s_cbranch_scc1 k_spr_10
s_ff1_i32_b32 s52, vcc_lo
s_branch k_clm_9
k_got_11:
s_mov_b64 exec, 1
s_cmp_lg_u32 s52, s55
s_cselect_b32 s53, 0x10000, 0
v_lshl_or_b32 v3, s52, 8, v3
v_or_b32 v3, s53, v3
v_mov_b32 v1, 0
ds_write_b32 v1, v3
s_mov_b64 exec, -1
s_waitcnt lgkmcnt(0)
k_skip_1:
s_barrier
v_mov_b32 v1, 0
ds_read_b32 v2, v1
s_waitcnt lgkmcnt(0)
v_readfirstlane_b32 s53, v2
s_barrier
s_and_b32 s30, s53, 255
s_bfe_u32 s52, s53, 0x80008
s_and_b32 s64, s53, 0x10000
s_cmp_gt_u32 s30, 31
s_cbranch_scc1 k_end_2
s_cmp_eq_u32 s52, 0
s_cbranch_scc1 k_team_3
v_lshlrev_b32 v0, 4, v0
s_cmp_gt_u32 s52, 4
s_cbranch_scc1 k_nb_8
s_mul_i32 s53, s52, 20
s_add_u32 s53, s53, s30
s_sub_u32 s53, s53, 20
s_cmp_lt_u32 s30, 20
s_cmov_b32 s30, s53
s_cbranch_scc1 k_o_4
s_mul_i32 s53, s52, 10
s_add_u32 s30, s30, s53
s_sub_u32 s30, s30, 30
s_branch k_p_6
k_nb_8:
s_mul_i32 s53, s52, 11
s_add_u32 s53, s53, s30
s_sub_u32 s53, s53, 74
s_cmp_ge_u32 s30, 19
s_cmov_b32 s30, s53
s_cbranch_scc1 k_at_5
s_mul_i32 s53, s52, 19
s_add_u32 s30, s30, s53
s_sub_u32 s30, s30, 55
s_cmp_lt_u32 s30, 96
s_cbranch_scc1 k_p_6
s_mov_b32 s30, 31
s_branch k_at_5
k_end_2:
s_endpgm
k_at_5:
s_lshl_b32 s52, s30, 2
s_add_u32 s52, s52, s3
s_lshl_b32 s52, s52, 9
s_add_u32 s52, s52, 222298112
v_mov_b64 v[2:3], 0
v_lshrrev_b32 v1, 1, v0
buffer_store_dwordx2 v[2:3], v1, s[4:7], s52 offen sc1
s_lshl_b32 s47, s30, 2
s_add_u32 s47, s47, s3
v_bfe_u32 v6, v0, 4, 5
v_lshrrev_b32 v2, 9, v0
v_bfe_u32 v8, v6, 2, 1
s_mov_b32 s56, 0x3acccccd
v_bfe_u32 v9, v6, 3, 1
v_and_b32 v1, 0x13, v6
v_lshl_add_u32 v1, v8, 3, v1
v_lshl_add_u32 v1, v9, 2, v1
k_gt_12:
s_mul_i32 s52, s47, 1639
s_lshr_b32 s52, s52, 16
s_mul_i32 s53, s52, 40
s_sub_u32 s53, s47, s53
s_lshl_b32 s52, s52, 5
s_lshl_b32 s53, s53, 1
v_add_u32 v3, s52, v1
v_add_u32 v6, s53, v2
v_and_b32 v4, 1, v3
v_cvt_f32_u32 v4, v4
v_mul_f32 v4, 0.5, v4
v_mul_f32 v4, 0.5, v4
v_cmp_gt_u32 vcc, 2, v3
s_nop 1
v_cndmask_b32 v4, v4, 0, vcc
v_mov_b32 v5, 0x3d64f92e
v_mov_b32 v8, 0x3d21e89b
v_cndmask_b32 v5, v5, v8, vcc
v_cmp_eq_u32 vcc, 0, v3
v_lshrrev_b32 v3, 1, v3
v_mov_b32 v8, 320
v_cndmask_b32 v3, v3, v8, vcc
v_lshlrev_b32 v6, 3, v6
v_mul_u32_u24 v6, v6, v3
v_cvt_f32_u32 v6, v6
v_cvt_f32_u32 v3, v3
v_fma_f32 v8, v6, s56, v4
v_add_f32 v6, v6, v3
v_fract_f32 v8, v8
v_cos_f32 v8, v8
v_fma_f32 v9, v6, s56, v4
v_add_f32 v6, v6, v3
v_fract_f32 v9, v9
v_cos_f32 v9, v9
v_fma_f32 v10, v6, s56, v4
v_add_f32 v6, v6, v3
v_fract_f32 v10, v10
v_cos_f32 v10, v10
v_fma_f32 v11, v6, s56, v4
v_add_f32 v6, v6, v3
v_fract_f32 v11, v11
v_cos_f32 v11, v11
v_fma_f32 v12, v6, s56, v4
v_add_f32 v6, v6, v3
v_fract_f32 v12, v12
v_cos_f32 v12, v12
v_fma_f32 v13, v6, s56, v4
v_add_f32 v6, v6, v3
v_fract_f32 v13, v13
v_cos_f32 v13, v13
v_fma_f32 v14, v6, s56, v4
v_add_f32 v6, v6, v3
v_fract_f32 v14, v14
v_cos_f32 v14, v14
v_fma_f32 v15, v6, s56, v4
v_add_f32 v6, v6, v3
v_fract_f32 v15, v15
v_cos_f32 v15, v15
v_mul_f32 v8, v5, v8
v_mul_f32 v9, v5, v9
v_mul_f32 v10, v5, v10
v_mul_f32 v11, v5, v11
v_mul_f32 v12, v5, v12
v_mul_f32 v13, v5, v13
v_mul_f32 v14, v5, v14
v_mul_f32 v15, v5, v15
v_cvt_pk_bf16_f32 v16, v8, v9
v_cvt_pk_bf16_f32 v17, v10, v11
v_cvt_pk_bf16_f32 v18, v12, v13
v_cvt_pk_bf16_f32 v19, v14, v15
s_lshl_b32 s52, s47, 10
s_add_u32 s52, s52, 213909504
buffer_store_dwordx4 v[16:19], v0, s[4:7], s52 offen sc1
s_add_u32 s47, s47, 128
s_cmp_lt_u32 s47, 800
s_cbranch_scc1 k_gt_12
s_waitcnt vmcnt(0)
s_barrier
s_cmp_lg_u32 s3, 0
s_cbranch_scc1 k_sd_14
s_mov_b64 exec, 1
v_mov_b32 v2, 128
v_mov_b32 v3, 1
global_atomic_add v2, v3, s[28:29] sc1
s_mov_b64 exec, -1
k_sd_14:
s_lshl_b32 s47, s30, 2
s_add_u32 s47, s47, s3
v_bfe_u32 v6, v0, 4, 5
v_lshrrev_b32 v2, 9, v0
v_bfe_u32 v8, v6, 2, 1
s_mov_b32 s56, 0x3acccccd
v_lshrrev_b32 v9, 3, v6
v_and_b32 v1, 3, v6
v_lshl_add_u32 v1, v8, 4, v1
v_lshl_add_u32 v1, v9, 2, v1
k_gt_15:
s_mul_i32 s52, s47, 1639
s_lshr_b32 s52, s52, 16
s_mul_i32 s53, s52, 40
s_sub_u32 s53, s47, s53
s_lshl_b32 s52, s52, 5
s_lshl_b32 s53, s53, 1
v_add_u32 v3, s52, v1
v_add_u32 v6, s53, v2
v_cmp_eq_u32 vcc, 0, v6
v_lshlrev_b32 v6, 2, v6
v_mul_u32_u24 v6, v6, v3
v_cvt_f32_u32 v6, v6
v_lshlrev_b32 v4, 31, v3
v_cvt_f32_u32 v3, v3
v_mul_f32 v8, s56, v6
v_add_f32 v6, v6, v3
v_fract_f32 v8, v8
v_sin_f32 v9, v8
v_cos_f32 v8, v8
v_mul_f32 v10, s56, v6
v_add_f32 v6, v6, v3
v_fract_f32 v10, v10
v_sin_f32 v11, v10
v_cos_f32 v10, v10
v_mul_f32 v12, s56, v6
v_add_f32 v6, v6, v3
v_fract_f32 v12, v12
v_sin_f32 v13, v12
v_cos_f32 v12, v12
v_mul_f32 v14, s56, v6
v_add_f32 v6, v6, v3
v_fract_f32 v14, v14
v_sin_f32 v15, v14
v_cos_f32 v14, v14
v_mul_f32 v8, 0x3d64f92e, v8
v_mul_f32 v9, 0xbd64f92e, v9
v_mul_f32 v10, 0x3d64f92e, v10
v_mul_f32 v11, 0xbd64f92e, v11
v_mul_f32 v12, 0x3d64f92e, v12
v_mul_f32 v13, 0xbd64f92e, v13
v_mul_f32 v14, 0x3d64f92e, v14
v_mul_f32 v15, 0xbd64f92e, v15
v_mov_b32 v5, 0x3d21e89b
v_xor_b32 v4, v4, v5
v_cndmask_b32 v8, v8, v4, vcc
v_cndmask_b32 v9, v9, v5, vcc
v_cvt_pk_bf16_f32 v16, v8, v9
v_cvt_pk_bf16_f32 v17, v10, v11
v_cvt_pk_bf16_f32 v18, v12, v13
v_cvt_pk_bf16_f32 v19, v14, v15
s_lshl_b32 s52, s47, 10
s_add_u32 s52, s52, 214958080
buffer_store_dwordx4 v[16:19], v0, s[4:7], s52 offen sc1
s_add_u32 s47, s47, 128
s_cmp_lt_u32 s47, 800
s_cbranch_scc1 k_gt_15
s_lshl_b32 s52, s30, 2
s_add_u32 s52, s52, s3
s_lshr_b32 s53, s52, 6
s_mul_i32 s53, s53, 393216
s_mul_i32 s52, s52, 10240
s_add_u32 s52, s52, s53
s_add_u32 s52, s52, 117440512
v_mov_b64 v[4:5], -1
v_mov_b64 v[6:7], -1
buffer_store_dwordx4 v[4:7], v0, s[4:7], s52 offen offset:0 sc1
buffer_store_dwordx4 v[4:7], v0, s[4:7], s52 offen offset:1024 sc1
buffer_store_dwordx4 v[4:7], v0, s[4:7], s52 offen offset:2048 sc1
buffer_store_dwordx4 v[4:7], v0, s[4:7], s52 offen offset:3072 sc1
s_add_u32 s52, s52, 4096
buffer_store_dwordx4 v[4:7], v0, s[4:7], s52 offen offset:0 sc1
buffer_store_dwordx4 v[4:7], v0, s[4:7], s52 offen offset:1024 sc1
buffer_store_dwordx4 v[4:7], v0, s[4:7], s52 offen offset:2048 sc1
buffer_store_dwordx4 v[4:7], v0, s[4:7], s52 offen offset:3072 sc1
s_add_u32 s52, s52, 4096
buffer_store_dwordx4 v[4:7], v0, s[4:7], s52 offen offset:0 sc1
buffer_store_dwordx4 v[4:7], v0, s[4:7], s52 offen offset:1024 sc1
s_waitcnt vmcnt(0)
s_barrier
s_cmp_lg_u32 s3, 0
s_cbranch_scc1 k_sd_17
s_mov_b64 exec, 1
v_mov_b32 v2, 192
v_mov_b32 v3, 1
global_atomic_add v2, v3, s[28:29] sc1
s_mov_b64 exec, -1
k_sd_17:
v_lshrrev_b32 v1, 8, v0
v_and_b32 v2, 0xf0, v0
v_lshl_add_u32 v8, v1, 13, v2
v_bfe_u32 v2, v0, 6, 4
v_and_b32 v3, 7, v2
v_xor_b32 v3, s3, v3
v_lshlrev_b32 v3, 5, v3
v_lshl_add_u32 v16, v2, 10, v3
v_bfe_u32 v2, v0, 4, 2
v_lshl_add_u32 v16, v2, 3, v16
v_xor_b32 v19, 0x80, v16
v_xor_b32 v9, 32, v8
v_xor_b32 v10, 64, v8
v_xor_b32 v11, 96, v8
v_xor_b32 v12, 128, v8
v_xor_b32 v13, 160, v8
v_xor_b32 v14, 192, v8
v_xor_b32 v15, 224, v8
v_add_u32 v17, 65536, v16
v_add_u32 v18, 131072, v16
v_add_u32 v20, 65536, v19
v_add_u32 v21, 131072, v19
s_mul_i32 s52, s3, 1310720
s_lshl_b32 s53, s30, 8
s_add_u32 s52, s52, s53
s_mul_i32 s53, s3, 40960
s_add_u32 m0, s53, 0
s_add_u32 s54, s52, 0
buffer_load_dwordx4 v8, s[12:15], s54 offen lds
s_add_u32 m0, s53, 1024
s_add_u32 s54, s52, 32768
buffer_load_dwordx4 v9, s[12:15], s54 offen lds
s_add_u32 m0, s53, 2048
s_add_u32 s54, s52, 65536
buffer_load_dwordx4 v10, s[12:15], s54 offen lds
s_add_u32 m0, s53, 3072
s_add_u32 s54, s52, 98304
buffer_load_dwordx4 v11, s[12:15], s54 offen lds
s_add_u32 m0, s53, 4096
s_add_u32 s54, s52, 131072
buffer_load_dwordx4 v12, s[12:15], s54 offen lds
s_add_u32 m0, s53, 5120
s_add_u32 s54, s52, 163840
buffer_load_dwordx4 v13, s[12:15], s54 offen lds
s_add_u32 m0, s53, 6144
s_add_u32 s54, s52, 196608
buffer_load_dwordx4 v14, s[12:15], s54 offen lds
s_add_u32 m0, s53, 7168
s_add_u32 s54, s52, 229376
buffer_load_dwordx4 v15, s[12:15], s54 offen lds
s_add_u32 m0, s53, 8192
s_add_u32 s54, s52, 262144
buffer_load_dwordx4 v8, s[12:15], s54 offen lds
s_add_u32 m0, s53, 9216
s_add_u32 s54, s52, 294912
buffer_load_dwordx4 v9, s[12:15], s54 offen lds
s_add_u32 m0, s53, 10240
s_add_u32 s54, s52, 327680
buffer_load_dwordx4 v10, s[12:15], s54 offen lds
s_add_u32 m0, s53, 11264
s_add_u32 s54, s52, 360448
buffer_load_dwordx4 v11, s[12:15], s54 offen lds
s_add_u32 m0, s53, 12288
s_add_u32 s54, s52, 393216
buffer_load_dwordx4 v12, s[12:15], s54 offen lds
s_add_u32 m0, s53, 13312
s_add_u32 s54, s52, 425984
buffer_load_dwordx4 v13, s[12:15], s54 offen lds
s_add_u32 m0, s53, 14336
s_add_u32 s54, s52, 458752
buffer_load_dwordx4 v14, s[12:15], s54 offen lds
s_add_u32 m0, s53, 15360
s_add_u32 s54, s52, 491520
buffer_load_dwordx4 v15, s[12:15], s54 offen lds
s_add_u32 m0, s53, 16384
s_add_u32 s54, s52, 524288
buffer_load_dwordx4 v8, s[12:15], s54 offen lds
s_add_u32 m0, s53, 17408
s_add_u32 s54, s52, 557056
buffer_load_dwordx4 v9, s[12:15], s54 offen lds
s_add_u32 m0, s53, 18432
s_add_u32 s54, s52, 589824
buffer_load_dwordx4 v10, s[12:15], s54 offen lds
s_add_u32 m0, s53, 19456
s_add_u32 s54, s52, 622592
buffer_load_dwordx4 v11, s[12:15], s54 offen lds
s_add_u32 m0, s53, 20480
s_add_u32 s54, s52, 655360
buffer_load_dwordx4 v12, s[12:15], s54 offen lds
s_add_u32 m0, s53, 21504
s_add_u32 s54, s52, 688128
buffer_load_dwordx4 v13, s[12:15], s54 offen lds
s_add_u32 m0, s53, 22528
s_add_u32 s54, s52, 720896
buffer_load_dwordx4 v14, s[12:15], s54 offen lds
s_add_u32 m0, s53, 23552
s_add_u32 s54, s52, 753664
buffer_load_dwordx4 v15, s[12:15], s54 offen lds
s_add_u32 m0, s53, 24576
s_add_u32 s54, s52, 786432
buffer_load_dwordx4 v8, s[12:15], s54 offen lds
s_add_u32 m0, s53, 25600
s_add_u32 s54, s52, 819200
buffer_load_dwordx4 v9, s[12:15], s54 offen lds
s_add_u32 m0, s53, 26624
s_add_u32 s54, s52, 851968
buffer_load_dwordx4 v10, s[12:15], s54 offen lds
s_add_u32 m0, s53, 27648
s_add_u32 s54, s52, 884736
buffer_load_dwordx4 v11, s[12:15], s54 offen lds
s_add_u32 m0, s53, 28672
s_add_u32 s54, s52, 917504
buffer_load_dwordx4 v12, s[12:15], s54 offen lds
s_add_u32 m0, s53, 29696
s_add_u32 s54, s52, 950272
buffer_load_dwordx4 v13, s[12:15], s54 offen lds
s_add_u32 m0, s53, 30720
s_add_u32 s54, s52, 983040
buffer_load_dwordx4 v14, s[12:15], s54 offen lds
s_add_u32 m0, s53, 31744
s_add_u32 s54, s52, 1015808
buffer_load_dwordx4 v15, s[12:15], s54 offen lds
s_add_u32 m0, s53, 32768
s_add_u32 s54, s52, 1048576
buffer_load_dwordx4 v8, s[12:15], s54 offen lds
s_add_u32 m0, s53, 33792
s_add_u32 s54, s52, 1081344
buffer_load_dwordx4 v9, s[12:15], s54 offen lds
s_add_u32 m0, s53, 34816
s_add_u32 s54, s52, 1114112
buffer_load_dwordx4 v10, s[12:15], s54 offen lds
s_add_u32 m0, s53, 35840
s_add_u32 s54, s52, 1146880
buffer_load_dwordx4 v11, s[12:15], s54 offen lds
s_add_u32 m0, s53, 36864
s_add_u32 s54, s52, 1179648
buffer_load_dwordx4 v12, s[12:15], s54 offen lds
s_add_u32 m0, s53, 37888
s_add_u32 s54, s52, 1212416
buffer_load_dwordx4 v13, s[12:15], s54 offen lds
s_add_u32 m0, s53, 38912
s_add_u32 s54, s52, 1245184
buffer_load_dwordx4 v14, s[12:15], s54 offen lds
s_add_u32 m0, s53, 39936
s_add_u32 s54, s52, 1277952
buffer_load_dwordx4 v15, s[12:15], s54 offen lds
s_waitcnt vmcnt(0)
s_barrier
ds_read_b64_tr_b16 a[0:1], v16 offset:0
ds_read_b64_tr_b16 a[2:3], v16 offset:512
ds_read_b64_tr_b16 a[4:5], v19 offset:0
ds_read_b64_tr_b16 a[6:7], v19 offset:512
ds_read_b64_tr_b16 a[16:17], v16 offset:256
ds_read_b64_tr_b16 a[18:19], v16 offset:768
ds_read_b64_tr_b16 a[20:21], v19 offset:256
ds_read_b64_tr_b16 a[22:23], v19 offset:768
ds_read_b64_tr_b16 a[32:33], v16 offset:16384
ds_read_b64_tr_b16 a[34:35], v16 offset:16896
ds_read_b64_tr_b16 a[36:37], v19 offset:16384
ds_read_b64_tr_b16 a[38:39], v19 offset:16896
ds_read_b64_tr_b16 a[48:49], v16 offset:16640
ds_read_b64_tr_b16 a[50:51], v16 offset:17152
ds_read_b64_tr_b16 a[52:53], v19 offset:16640
ds_read_b64_tr_b16 a[54:55], v19 offset:17152
ds_read_b64_tr_b16 a[64:65], v16 offset:32768
ds_read_b64_tr_b16 a[66:67], v16 offset:33280
ds_read_b64_tr_b16 a[68:69], v19 offset:32768
ds_read_b64_tr_b16 a[70:71], v19 offset:33280
ds_read_b64_tr_b16 a[80:81], v16 offset:33024
ds_read_b64_tr_b16 a[82:83], v16 offset:33536
ds_read_b64_tr_b16 a[84:85], v19 offset:33024
ds_read_b64_tr_b16 a[86:87], v19 offset:33536
ds_read_b64_tr_b16 a[96:97], v16 offset:49152
ds_read_b64_tr_b16 a[98:99], v16 offset:49664
ds_read_b64_tr_b16 a[100:101], v19 offset:49152
ds_read_b64_tr_b16 a[102:103], v19 offset:49664
ds_read_b64_tr_b16 a[112:113], v16 offset:49408
ds_read_b64_tr_b16 a[114:115], v16 offset:49920
ds_read_b64_tr_b16 a[116:117], v19 offset:49408
ds_read_b64_tr_b16 a[118:119], v19 offset:49920
ds_read_b64_tr_b16 a[128:129], v17 offset:0
ds_read_b64_tr_b16 a[130:131], v17 offset:512
ds_read_b64_tr_b16 a[132:133], v20 offset:0
ds_read_b64_tr_b16 a[134:135], v20 offset:512
ds_read_b64_tr_b16 a[144:145], v17 offset:256
ds_read_b64_tr_b16 a[146:147], v17 offset:768
ds_read_b64_tr_b16 a[148:149], v20 offset:256
ds_read_b64_tr_b16 a[150:151], v20 offset:768
ds_read_b64_tr_b16 a[160:161], v17 offset:16384
ds_read_b64_tr_b16 a[162:163], v17 offset:16896
ds_read_b64_tr_b16 a[164:165], v20 offset:16384
ds_read_b64_tr_b16 a[166:167], v20 offset:16896
ds_read_b64_tr_b16 a[176:177], v17 offset:16640
ds_read_b64_tr_b16 a[178:179], v17 offset:17152
ds_read_b64_tr_b16 a[180:181], v20 offset:16640
ds_read_b64_tr_b16 a[182:183], v20 offset:17152
ds_read_b64_tr_b16 a[192:193], v17 offset:32768
ds_read_b64_tr_b16 a[194:195], v17 offset:33280
ds_read_b64_tr_b16 a[196:197], v20 offset:32768
ds_read_b64_tr_b16 a[198:199], v20 offset:33280
ds_read_b64_tr_b16 a[208:209], v17 offset:33024
ds_read_b64_tr_b16 a[210:211], v17 offset:33536
ds_read_b64_tr_b16 a[212:213], v20 offset:33024
ds_read_b64_tr_b16 a[214:215], v20 offset:33536
ds_read_b64_tr_b16 a[224:225], v17 offset:49152
ds_read_b64_tr_b16 a[226:227], v17 offset:49664
ds_read_b64_tr_b16 a[228:229], v20 offset:49152
ds_read_b64_tr_b16 a[230:231], v20 offset:49664
ds_read_b64_tr_b16 a[240:241], v17 offset:49408
ds_read_b64_tr_b16 a[242:243], v17 offset:49920
ds_read_b64_tr_b16 a[244:245], v20 offset:49408
ds_read_b64_tr_b16 a[246:247], v20 offset:49920
ds_read_b64_tr_b16 v[192:193], v18 offset:0
ds_read_b64_tr_b16 v[194:195], v18 offset:512
ds_read_b64_tr_b16 v[196:197], v21 offset:0
ds_read_b64_tr_b16 v[198:199], v21 offset:512
ds_read_b64_tr_b16 v[208:209], v18 offset:256
ds_read_b64_tr_b16 v[210:211], v18 offset:768
ds_read_b64_tr_b16 v[212:213], v21 offset:256
ds_read_b64_tr_b16 v[214:215], v21 offset:768
ds_read_b64_tr_b16 v[224:225], v18 offset:16384
ds_read_b64_tr_b16 v[226:227], v18 offset:16896
ds_read_b64_tr_b16 v[228:229], v21 offset:16384
ds_read_b64_tr_b16 v[230:231], v21 offset:16896
ds_read_b64_tr_b16 v[240:241], v18 offset:16640
ds_read_b64_tr_b16 v[242:243], v18 offset:17152
ds_read_b64_tr_b16 v[244:245], v21 offset:16640
ds_read_b64_tr_b16 v[246:247], v21 offset:17152
s_waitcnt lgkmcnt(0)
s_barrier
s_mul_i32 s52, s3, 1310720
s_lshl_b32 s53, s30, 8
s_add_u32 s52, s52, s53
s_mul_i32 s53, s3, 40960
s_add_u32 m0, s53, 0
s_add_u32 s54, s52, 0
buffer_load_dwordx4 v8, s[16:19], s54 offen lds
s_add_u32 m0, s53, 1024
s_add_u32 s54, s52, 32768
buffer_load_dwordx4 v9, s[16:19], s54 offen lds
s_add_u32 m0, s53, 2048
s_add_u32 s54, s52, 65536
buffer_load_dwordx4 v10, s[16:19], s54 offen lds
s_add_u32 m0, s53, 3072
s_add_u32 s54, s52, 98304
buffer_load_dwordx4 v11, s[16:19], s54 offen lds
s_add_u32 m0, s53, 4096
s_add_u32 s54, s52, 131072
buffer_load_dwordx4 v12, s[16:19], s54 offen lds
s_add_u32 m0, s53, 5120
s_add_u32 s54, s52, 163840
buffer_load_dwordx4 v13, s[16:19], s54 offen lds
s_add_u32 m0, s53, 6144
s_add_u32 s54, s52, 196608
buffer_load_dwordx4 v14, s[16:19], s54 offen lds
s_add_u32 m0, s53, 7168
s_add_u32 s54, s52, 229376
buffer_load_dwordx4 v15, s[16:19], s54 offen lds
s_add_u32 m0, s53, 8192
s_add_u32 s54, s52, 262144
buffer_load_dwordx4 v8, s[16:19], s54 offen lds
s_add_u32 m0, s53, 9216
s_add_u32 s54, s52, 294912
buffer_load_dwordx4 v9, s[16:19], s54 offen lds
s_add_u32 m0, s53, 10240
s_add_u32 s54, s52, 327680
buffer_load_dwordx4 v10, s[16:19], s54 offen lds
s_add_u32 m0, s53, 11264
s_add_u32 s54, s52, 360448
buffer_load_dwordx4 v11, s[16:19], s54 offen lds
s_add_u32 m0, s53, 12288
s_add_u32 s54, s52, 393216
buffer_load_dwordx4 v12, s[16:19], s54 offen lds
s_add_u32 m0, s53, 13312
s_add_u32 s54, s52, 425984
buffer_load_dwordx4 v13, s[16:19], s54 offen lds
s_add_u32 m0, s53, 14336
s_add_u32 s54, s52, 458752
buffer_load_dwordx4 v14, s[16:19], s54 offen lds
s_add_u32 m0, s53, 15360
s_add_u32 s54, s52, 491520
buffer_load_dwordx4 v15, s[16:19], s54 offen lds
s_add_u32 m0, s53, 16384
s_add_u32 s54, s52, 524288
buffer_load_dwordx4 v8, s[16:19], s54 offen lds
s_add_u32 m0, s53, 17408
s_add_u32 s54, s52, 557056
buffer_load_dwordx4 v9, s[16:19], s54 offen lds
s_add_u32 m0, s53, 18432
s_add_u32 s54, s52, 589824
buffer_load_dwordx4 v10, s[16:19], s54 offen lds
s_add_u32 m0, s53, 19456
s_add_u32 s54, s52, 622592
buffer_load_dwordx4 v11, s[16:19], s54 offen lds
s_add_u32 m0, s53, 20480
s_add_u32 s54, s52, 655360
buffer_load_dwordx4 v12, s[16:19], s54 offen lds
s_add_u32 m0, s53, 21504
s_add_u32 s54, s52, 688128
buffer_load_dwordx4 v13, s[16:19], s54 offen lds
s_add_u32 m0, s53, 22528
s_add_u32 s54, s52, 720896
buffer_load_dwordx4 v14, s[16:19], s54 offen lds
s_add_u32 m0, s53, 23552
s_add_u32 s54, s52, 753664
buffer_load_dwordx4 v15, s[16:19], s54 offen lds
s_add_u32 m0, s53, 24576
s_add_u32 s54, s52, 786432
buffer_load_dwordx4 v8, s[16:19], s54 offen lds
s_add_u32 m0, s53, 25600
s_add_u32 s54, s52, 819200
buffer_load_dwordx4 v9, s[16:19], s54 offen lds
s_add_u32 m0, s53, 26624
s_add_u32 s54, s52, 851968
buffer_load_dwordx4 v10, s[16:19], s54 offen lds
s_add_u32 m0, s53, 27648
s_add_u32 s54, s52, 884736
buffer_load_dwordx4 v11, s[16:19], s54 offen lds
s_add_u32 m0, s53, 28672
s_add_u32 s54, s52, 917504
buffer_load_dwordx4 v12, s[16:19], s54 offen lds
s_add_u32 m0, s53, 29696
s_add_u32 s54, s52, 950272
buffer_load_dwordx4 v13, s[16:19], s54 offen lds
s_add_u32 m0, s53, 30720
s_add_u32 s54, s52, 983040
buffer_load_dwordx4 v14, s[16:19], s54 offen lds
s_add_u32 m0, s53, 31744
s_add_u32 s54, s52, 1015808
buffer_load_dwordx4 v15, s[16:19], s54 offen lds
s_add_u32 m0, s53, 32768
s_add_u32 s54, s52, 1048576
buffer_load_dwordx4 v8, s[16:19], s54 offen lds
s_add_u32 m0, s53, 33792
s_add_u32 s54, s52, 1081344
buffer_load_dwordx4 v9, s[16:19], s54 offen lds
s_add_u32 m0, s53, 34816
s_add_u32 s54, s52, 1114112
buffer_load_dwordx4 v10, s[16:19], s54 offen lds
s_add_u32 m0, s53, 35840
s_add_u32 s54, s52, 1146880
buffer_load_dwordx4 v11, s[16:19], s54 offen lds
s_add_u32 m0, s53, 36864
s_add_u32 s54, s52, 1179648
buffer_load_dwordx4 v12, s[16:19], s54 offen lds
s_add_u32 m0, s53, 37888
s_add_u32 s54, s52, 1212416
buffer_load_dwordx4 v13, s[16:19], s54 offen lds
s_add_u32 m0, s53, 38912
s_add_u32 s54, s52, 1245184
buffer_load_dwordx4 v14, s[16:19], s54 offen lds
s_add_u32 m0, s53, 39936
s_add_u32 s54, s52, 1277952
buffer_load_dwordx4 v15, s[16:19], s54 offen lds
s_waitcnt vmcnt(0)
s_barrier
ds_read_b64_tr_b16 a[8:9], v16 offset:0
ds_read_b64_tr_b16 a[10:11], v16 offset:512
ds_read_b64_tr_b16 a[12:13], v19 offset:0
ds_read_b64_tr_b16 a[14:15], v19 offset:512
ds_read_b64_tr_b16 a[24:25], v16 offset:256
ds_read_b64_tr_b16 a[26:27], v16 offset:768
ds_read_b64_tr_b16 a[28:29], v19 offset:256
ds_read_b64_tr_b16 a[30:31], v19 offset:768
ds_read_b64_tr_b16 a[40:41], v16 offset:16384
ds_read_b64_tr_b16 a[42:43], v16 offset:16896
ds_read_b64_tr_b16 a[44:45], v19 offset:16384
ds_read_b64_tr_b16 a[46:47], v19 offset:16896
ds_read_b64_tr_b16 a[56:57], v16 offset:16640
ds_read_b64_tr_b16 a[58:59], v16 offset:17152
ds_read_b64_tr_b16 a[60:61], v19 offset:16640
ds_read_b64_tr_b16 a[62:63], v19 offset:17152
ds_read_b64_tr_b16 a[72:73], v16 offset:32768
ds_read_b64_tr_b16 a[74:75], v16 offset:33280
ds_read_b64_tr_b16 a[76:77], v19 offset:32768
ds_read_b64_tr_b16 a[78:79], v19 offset:33280
ds_read_b64_tr_b16 a[88:89], v16 offset:33024
ds_read_b64_tr_b16 a[90:91], v16 offset:33536
ds_read_b64_tr_b16 a[92:93], v19 offset:33024
ds_read_b64_tr_b16 a[94:95], v19 offset:33536
ds_read_b64_tr_b16 a[104:105], v16 offset:49152
ds_read_b64_tr_b16 a[106:107], v16 offset:49664
ds_read_b64_tr_b16 a[108:109], v19 offset:49152
ds_read_b64_tr_b16 a[110:111], v19 offset:49664
ds_read_b64_tr_b16 a[120:121], v16 offset:49408
ds_read_b64_tr_b16 a[122:123], v16 offset:49920
ds_read_b64_tr_b16 a[124:125], v19 offset:49408
ds_read_b64_tr_b16 a[126:127], v19 offset:49920
ds_read_b64_tr_b16 a[136:137], v17 offset:0
ds_read_b64_tr_b16 a[138:139], v17 offset:512
ds_read_b64_tr_b16 a[140:141], v20 offset:0
ds_read_b64_tr_b16 a[142:143], v20 offset:512
ds_read_b64_tr_b16 a[152:153], v17 offset:256
ds_read_b64_tr_b16 a[154:155], v17 offset:768
ds_read_b64_tr_b16 a[156:157], v20 offset:256
ds_read_b64_tr_b16 a[158:159], v20 offset:768
ds_read_b64_tr_b16 a[168:169], v17 offset:16384
ds_read_b64_tr_b16 a[170:171], v17 offset:16896
ds_read_b64_tr_b16 a[172:173], v20 offset:16384
ds_read_b64_tr_b16 a[174:175], v20 offset:16896
ds_read_b64_tr_b16 a[184:185], v17 offset:16640
ds_read_b64_tr_b16 a[186:187], v17 offset:17152
ds_read_b64_tr_b16 a[188:189], v20 offset:16640
ds_read_b64_tr_b16 a[190:191], v20 offset:17152
ds_read_b64_tr_b16 a[200:201], v17 offset:32768
ds_read_b64_tr_b16 a[202:203], v17 offset:33280
ds_read_b64_tr_b16 a[204:205], v20 offset:32768
ds_read_b64_tr_b16 a[206:207], v20 offset:33280
ds_read_b64_tr_b16 a[216:217], v17 offset:33024
ds_read_b64_tr_b16 a[218:219], v17 offset:33536
ds_read_b64_tr_b16 a[220:221], v20 offset:33024
ds_read_b64_tr_b16 a[222:223], v20 offset:33536
ds_read_b64_tr_b16 a[232:233], v17 offset:49152
ds_read_b64_tr_b16 a[234:235], v17 offset:49664
ds_read_b64_tr_b16 a[236:237], v20 offset:49152
ds_read_b64_tr_b16 a[238:239], v20 offset:49664
ds_read_b64_tr_b16 a[248:249], v17 offset:49408
ds_read_b64_tr_b16 a[250:251], v17 offset:49920
ds_read_b64_tr_b16 a[252:253], v20 offset:49408
ds_read_b64_tr_b16 a[254:255], v20 offset:49920
ds_read_b64_tr_b16 v[200:201], v18 offset:0
ds_read_b64_tr_b16 v[202:203], v18 offset:512
ds_read_b64_tr_b16 v[204:205], v21 offset:0
ds_read_b64_tr_b16 v[206:207], v21 offset:512
ds_read_b64_tr_b16 v[216:217], v18 offset:256
ds_read_b64_tr_b16 v[218:219], v18 offset:768
ds_read_b64_tr_b16 v[220:221], v21 offset:256
ds_read_b64_tr_b16 v[222:223], v21 offset:768
ds_read_b64_tr_b16 v[232:233], v18 offset:16384
ds_read_b64_tr_b16 v[234:235], v18 offset:16896
ds_read_b64_tr_b16 v[236:237], v21 offset:16384
ds_read_b64_tr_b16 v[238:239], v21 offset:16896
ds_read_b64_tr_b16 v[248:249], v18 offset:16640
ds_read_b64_tr_b16 v[250:251], v18 offset:17152
ds_read_b64_tr_b16 v[252:253], v21 offset:16640
ds_read_b64_tr_b16 v[254:255], v21 offset:17152
s_waitcnt lgkmcnt(0)
s_barrier
s_and_b32 s47, s3, 1
s_lshr_b32 s52, s3, 1
s_add_u32 s50, s52, 1
v_lshrrev_b32 v20, 9, v0
v_mov_b32 v21, 0xff800000
v_cmp_eq_u32 vcc, s52, v20
s_lshl_b32 s46, s52, 10
s_lshl_b32 s53, s47, 7
s_add_u32 s46, s46, s53
s_add_u32 s46, s46, 117440512
s_lshl_b32 s53, s52, 5
s_add_u32 s53, s53, s30
s_lshl_b32 s44, s53, 14
s_add_u32 s44, s44, 0
s_lshl_b32 s53, s53, 13
s_lshl_b32 s45, s47, 10
s_add_u32 s45, s45, s53
s_add_u32 s45, s45, 125829120
s_lshl_b32 s48, s3, 17
s_lshl_b32 s53, s30, 11
s_add_u32 s48, s48, s53
s_add_u32 s48, s48, 159383552
s_lshl_b32 s56, s30, 6
s_add_u32 s56, s56, 222330880
s_lshl_b32 s57, s3, 8
s_lshl_b32 s53, s30, 2
s_add_u32 s57, s57, s53
s_add_u32 s57, s57, 222339072
s_mov_b32 s58, 0x3e0293ee
v_cndmask_b32 v156, v21, 0, vcc
v_cndmask_b32 v157, v21, 0, vcc
v_cndmask_b32 v158, v21, 0, vcc
v_cndmask_b32 v159, v21, 0, vcc
v_bfe_u32 v20, v0, 7, 1
v_and_b32 v1, 0x370, v0
v_mul_u32_u24 v23, 10240, v20
v_add_u32 v23, v23, v1
v_lshl_add_u32 v1, v20, 16, v1
v_and_b32 v16, 0x350, v0
v_lshl_add_u32 v16, v20, 5, v16
v_bfe_u32 v20, v0, 5, 1
v_lshl_add_u32 v16, v20, 12, v16
v_add_u32 v17, 8192, v16
s_lshl_b32 s52, s3, 10
v_add_u32 v155, s52, v0
v_mov_b32 v2, 2146435072
v_cmp_eq_u32 vcc, 0, v0
s_nop 1
v_cndmask_b32 v2, v2, 0, vcc
v_bfe_u32 v20, v0, 4, 4
s_lshl_b32 s52, s47, 4
v_add_u32 v20, s52, v20
v_lshrrev_b32 v22, 8, v0
v_lshlrev_b32 v22, 2, v22
v_sub_u32 v20, v20, v22
v_add_u32 v3, 4096, v0
v_add_u32 v18, 8192, v0
v_add_u32 v19, 12288, v0
v_cmp_le_i32 vcc, 0, v20
s_nop 1
v_cndmask_b32 v4, v21, 0, vcc
v_cmp_le_i32 vcc, 1, v20
s_nop 1
v_cndmask_b32 v5, v21, 0, vcc
v_cmp_le_i32 vcc, 2, v20
s_nop 1
v_cndmask_b32 v6, v21, 0, vcc
v_cmp_le_i32 vcc, 3, v20
s_nop 1
v_cndmask_b32 v7, v21, 0, vcc
v_cmp_le_i32 vcc, 16, v20
s_nop 1
v_cndmask_b32 v8, v21, 0, vcc
v_cmp_le_i32 vcc, 17, v20
s_nop 1
v_cndmask_b32 v9, v21, 0, vcc
v_cmp_le_i32 vcc, 18, v20
s_nop 1
v_cndmask_b32 v10, v21, 0, vcc
v_cmp_le_i32 vcc, 19, v20
s_nop 1
v_cndmask_b32 v11, v21, 0, vcc
v_mov_b32 v12, 0x3f803f80
v_mov_b32 v13, 0x3f803f80
v_mov_b32 v14, 0x3f803f80
v_mov_b32 v15, 0x3f803f80
s_cmp_lg_u32 s3, 0
s_cbranch_scc1 k_wdd_19
v_mov_b32 v20, 192
k_wd_18:
global_load_dword v21, v20, s[28:29] sc1
s_waitcnt vmcnt(0)
v_readfirstlane_b32 s52, v21
s_cmp_ge_u32 s52, 32
s_cbranch_scc1 k_wdd_19
s_sleep 2
s_sub_u32 s32, s32, 1
s_cmp_gt_i32 s32, 0
s_cbranch_scc1 k_wd_18
k_wdd_19:
s_barrier
v_mov_b32 v154, 0
k_top_20:
s_waitcnt vmcnt(0)
buffer_store_dword v154, v2, s[4:7], s57 offen sc1
s_cmp_gt_u32 s50, 128
s_cbranch_scc1 k_out_27
k_ck_21:
buffer_load_dwordx3 v[20:22], off, s[4:7], s56 sc1
s_waitcnt vmcnt(0)
v_min3_u32 v20, v20, v21, v22
v_cmp_le_u32 vcc, s50, v20
s_cbranch_vccnz k_cd_22
s_sleep 4
s_sub_u32 s32, s32, 1
s_cmp_gt_i32 s32, 0
s_cbranch_scc1 k_ck_21
k_cd_22:
s_add_u32 s52, s46, 4096
s_add_u32 s53, s46, 8192
buffer_load_dwordx4 v[160:163], v23, s[4:7], s46 offen offset:0 sc1
buffer_load_dwordx4 v[164:167], v23, s[4:7], s46 offen offset:2048 sc1
buffer_load_dwordx4 v[168:171], v23, s[4:7], s52 offen offset:0 sc1
buffer_load_dwordx4 v[172:175], v23, s[4:7], s52 offen offset:2048 sc1
buffer_load_dwordx4 v[176:179], v23, s[4:7], s53 offen offset:0 sc1
buffer_load_dwordx4 v[24:27], v0, s[4:7], s45 offen offset:0 sc1
buffer_load_dwordx4 v[40:43], v16, s[4:7], s44 offen offset:0 sc1
buffer_load_dwordx4 v[44:47], v17, s[4:7], s44 offen offset:0 sc1
buffer_load_dwordx4 v[28:31], v0, s[4:7], s45 offen offset:2048 sc1
buffer_load_dwordx4 v[48:51], v16, s[4:7], s44 offen offset:128 sc1
buffer_load_dwordx4 v[52:55], v17, s[4:7], s44 offen offset:128 sc1
buffer_load_dwordx4 v[32:35], v3, s[4:7], s45 offen offset:0 sc1
buffer_load_dwordx4 v[56:59], v16, s[4:7], s44 offen offset:1024 sc1
buffer_load_dwordx4 v[60:63], v17, s[4:7], s44 offen offset:1024 sc1
buffer_load_dwordx4 v[36:39], v3, s[4:7], s45 offen offset:2048 sc1
buffer_load_dwordx4 v[64:67], v16, s[4:7], s44 offen offset:1152 sc1
buffer_load_dwordx4 v[68:71], v17, s[4:7], s44 offen offset:1152 sc1
buffer_load_dwordx4 v[72:75], v0, s[4:7], s44 offen offset:2048 sc1
buffer_load_dwordx4 v[76:79], v0, s[4:7], s44 offen offset:3072 sc1
buffer_load_dwordx4 v[80:83], v3, s[4:7], s44 offen offset:2048 sc1
buffer_load_dwordx4 v[84:87], v3, s[4:7], s44 offen offset:3072 sc1
buffer_load_dwordx4 v[88:91], v18, s[4:7], s44 offen offset:2048 sc1
buffer_load_dwordx4 v[92:95], v18, s[4:7], s44 offen offset:3072 sc1
buffer_load_dwordx4 v[96:99], v19, s[4:7], s44 offen offset:2048 sc1
buffer_load_dwordx4 v[100:103], v19, s[4:7], s44 offen offset:3072 sc1
s_waitcnt vmcnt(22)
v_max3_u32 v20, v160, v164, v168
s_waitcnt vmcnt(20)
v_max3_u32 v20, v20, v172, v176
v_cmp_eq_u32 vcc, -1, v20
buffer_store_dword v154, v2, s[4:7], s57 offen sc1
s_cbranch_vccz k_pmd_25
s_add_u32 s52, s46, 10240
k_pr_23:
buffer_load_dword v20, off, s[4:7], s52 sc1
s_waitcnt vmcnt(0)
v_cmp_eq_u32 vcc, -1, v20
s_cbranch_vccz k_pm_24
s_sleep 2
s_sub_u32 s32, s32, 1
s_cmp_gt_i32 s32, 0
s_cbranch_scc1 k_pr_23
k_pm_24:
s_add_u32 s52, s46, 4096
s_add_u32 s53, s46, 8192
buffer_load_dwordx4 v[160:163], v23, s[4:7], s46 offen offset:0 sc1
buffer_load_dwordx4 v[164:167], v23, s[4:7], s46 offen offset:2048 sc1
buffer_load_dwordx4 v[168:171], v23, s[4:7], s52 offen offset:0 sc1
buffer_load_dwordx4 v[172:175], v23, s[4:7], s52 offen offset:2048 sc1
buffer_load_dwordx4 v[176:179], v23, s[4:7], s53 offen offset:0 sc1
s_waitcnt vmcnt(2)
v_max3_u32 v20, v160, v164, v168
s_waitcnt vmcnt(0)
v_max3_u32 v20, v20, v172, v176
v_cmp_eq_u32 vcc, -1, v20
s_cbranch_vccz k_pmd_25
s_sleep 2
s_sub_u32 s32, s32, 1
s_cmp_gt_i32 s32, 0
s_cbranch_scc1 k_pm_24
k_pmd_25:
ds_write_b128 v155, v[160:163] offset:0
ds_write_b128 v155, v[164:167] offset:4096
ds_write_b128 v155, v[168:171] offset:8192
ds_write_b128 v155, v[172:175] offset:12288
ds_write_b128 v155, v[176:179] offset:16384
s_waitcnt lgkmcnt(0)
s_barrier
ds_read_b128 v[160:163], v0 offset:0
ds_read_b128 v[164:167], v0 offset:1024
ds_read_b128 v[168:171], v0 offset:2048
ds_read_b128 v[172:175], v0 offset:3072
buffer_load_dwordx3 v[20:22], off, s[4:7], s56 sc1
s_waitcnt lgkmcnt(3)
v_mfma_f32_16x16x32_bf16 v[104:107], a[0:3], v[160:163], 0
ds_read_b128 v[176:179], v0 offset:4096
v_mfma_f32_16x16x32_bf16 v[108:111], a[4:7], v[160:163], 0
v_mfma_f32_16x16x32_bf16 v[112:115], v[160:163], a[8:11], 0
v_mfma_f32_16x16x32_bf16 v[116:119], v[160:163], a[12:15], 0
s_waitcnt lgkmcnt(3)
v_mfma_f32_16x16x32_bf16 v[104:107], a[16:19], v[164:167], v[104:107]
ds_read_b128 v[180:183], v0 offset:5120
v_mfma_f32_16x16x32_bf16 v[108:111], a[20:23], v[164:167], v[108:111]
v_mfma_f32_16x16x32_bf16 v[112:115], v[164:167], a[24:27], v[112:115]
v_mfma_f32_16x16x32_bf16 v[116:119], v[164:167], a[28:31], v[116:119]
s_waitcnt lgkmcnt(3)
v_mfma_f32_16x16x32_bf16 v[104:107], a[32:35], v[168:171], v[104:107]
ds_read_b128 v[184:187], v0 offset:6144
v_mfma_f32_16x16x32_bf16 v[108:111], a[36:39], v[168:171], v[108:111]
v_mfma_f32_16x16x32_bf16 v[112:115], v[168:171], a[40:43], v[112:115]
v_mfma_f32_16x16x32_bf16 v[116:119], v[168:171], a[44:47], v[116:119]
s_waitcnt lgkmcnt(3)
v_mfma_f32_16x16x32_bf16 v[104:107], a[48:51], v[172:175], v[104:107]
ds_read_b128 v[188:191], v0 offset:7168
v_mfma_f32_16x16x32_bf16 v[108:111], a[52:55], v[172:175], v[108:111]
v_mfma_f32_16x16x32_bf16 v[112:115], v[172:175], a[56:59], v[112:115]
v_mfma_f32_16x16x32_bf16 v[116:119], v[172:175], a[60:63], v[116:119]
s_waitcnt lgkmcnt(3)
v_mfma_f32_16x16x32_bf16 v[104:107], a[64:67], v[176:179], v[104:107]
ds_read_b128 v[160:163], v0 offset:8192
v_mfma_f32_16x16x32_bf16 v[108:111], a[68:71], v[176:179], v[108:111]
v_mfma_f32_16x16x32_bf16 v[112:115], v[176:179], a[72:75], v[112:115]
v_mfma_f32_16x16x32_bf16 v[116:119], v[176:179], a[76:79], v[116:119]
s_waitcnt lgkmcnt(3)
v_mfma_f32_16x16x32_bf16 v[104:107], a[80:83], v[180:183], v[104:107]
ds_read_b128 v[164:167], v0 offset:9216
v_mfma_f32_16x16x32_bf16 v[108:111], a[84:87], v[180:183], v[108:111]
v_mfma_f32_16x16x32_bf16 v[112:115], v[180:183], a[88:91], v[112:115]
v_mfma_f32_16x16x32_bf16 v[116:119], v[180:183], a[92:95], v[116:119]
s_waitcnt lgkmcnt(3)
v_mfma_f32_16x16x32_bf16 v[104:107], a[96:99], v[184:187], v[104:107]
ds_read_b128 v[168:171], v0 offset:10240
v_mfma_f32_16x16x32_bf16 v[108:111], a[100:103], v[184:187], v[108:111]
v_mfma_f32_16x16x32_bf16 v[112:115], v[184:187], a[104:107], v[112:115]
v_mfma_f32_16x16x32_bf16 v[116:119], v[184:187], a[108:111], v[116:119]
s_waitcnt lgkmcnt(3)
v_mfma_f32_16x16x32_bf16 v[104:107], a[112:115], v[188:191], v[104:107]
ds_read_b128 v[172:175], v0 offset:11264
v_mfma_f32_16x16x32_bf16 v[108:111], a[116:119], v[188:191], v[108:111]
v_mfma_f32_16x16x32_bf16 v[112:115], v[188:191], a[120:123], v[112:115]
v_mfma_f32_16x16x32_bf16 v[116:119], v[188:191], a[124:127], v[116:119]
s_waitcnt lgkmcnt(3)
v_mfma_f32_16x16x32_bf16 v[104:107], a[128:131], v[160:163], v[104:107]
ds_read_b128 v[176:179], v0 offset:12288
v_mfma_f32_16x16x32_bf16 v[108:111], a[132:135], v[160:163], v[108:111]
v_mfma_f32_16x16x32_bf16 v[112:115], v[160:163], a[136:139], v[112:115]
v_mfma_f32_16x16x32_bf16 v[116:119], v[160:163], a[140:143], v[116:119]
s_waitcnt lgkmcnt(3)
v_mfma_f32_16x16x32_bf16 v[104:107], a[144:147], v[164:167], v[104:107]
ds_read_b128 v[180:183], v0 offset:13312
v_mfma_f32_16x16x32_bf16 v[108:111], a[148:151], v[164:167], v[108:111]
v_mfma_f32_16x16x32_bf16 v[112:115], v[164:167], a[152:155], v[112:115]
v_mfma_f32_16x16x32_bf16 v[116:119], v[164:167], a[156:159], v[116:119]
s_waitcnt lgkmcnt(3)
v_mfma_f32_16x16x32_bf16 v[104:107], a[160:163], v[168:171], v[104:107]
ds_read_b128 v[184:187], v0 offset:14336
v_mfma_f32_16x16x32_bf16 v[108:111], a[164:167], v[168:171], v[108:111]
v_mfma_f32_16x16x32_bf16 v[112:115], v[168:171], a[168:171], v[112:115]
v_mfma_f32_16x16x32_bf16 v[116:119], v[168:171], a[172:175], v[116:119]
s_waitcnt lgkmcnt(3)
v_mfma_f32_16x16x32_bf16 v[104:107], a[176:179], v[172:175], v[104:107]
ds_read_b128 v[188:191], v0 offset:15360
v_mfma_f32_16x16x32_bf16 v[108:111], a[180:183], v[172:175], v[108:111]
v_mfma_f32_16x16x32_bf16 v[112:115], v[172:175], a[184:187], v[112:115]
v_mfma_f32_16x16x32_bf16 v[116:119], v[172:175], a[188:191], v[116:119]
s_waitcnt lgkmcnt(3)
v_mfma_f32_16x16x32_bf16 v[104:107], a[192:195], v[176:179], v[104:107]
ds_read_b128 v[160:163], v0 offset:16384
v_mfma_f32_16x16x32_bf16 v[108:111], a[196:199], v[176:179], v[108:111]
v_mfma_f32_16x16x32_bf16 v[112:115], v[176:179], a[200:203], v[112:115]
v_mfma_f32_16x16x32_bf16 v[116:119], v[176:179], a[204:207], v[116:119]
s_waitcnt lgkmcnt(3)
v_mfma_f32_16x16x32_bf16 v[104:107], a[208:211], v[180:183], v[104:107]
ds_read_b128 v[164:167], v0 offset:17408
v_mfma_f32_16x16x32_bf16 v[108:111], a[212:215], v[180:183], v[108:111]
v_mfma_f32_16x16x32_bf16 v[112:115], v[180:183], a[216:219], v[112:115]
v_mfma_f32_16x16x32_bf16 v[116:119], v[180:183], a[220:223], v[116:119]
s_waitcnt lgkmcnt(3)
v_mfma_f32_16x16x32_bf16 v[104:107], a[224:227], v[184:187], v[104:107]
ds_read_b128 v[168:171], v0 offset:18432
v_mfma_f32_16x16x32_bf16 v[108:111], a[228:231], v[184:187], v[108:111]
v_mfma_f32_16x16x32_bf16 v[112:115], v[184:187], a[232:235], v[112:115]
v_mfma_f32_16x16x32_bf16 v[116:119], v[184:187], a[236:239], v[116:119]
s_waitcnt lgkmcnt(3)
v_mfma_f32_16x16x32_bf16 v[104:107], a[240:243], v[188:191], v[104:107]
ds_read_b128 v[172:175], v0 offset:19456
v_mfma_f32_16x16x32_bf16 v[108:111], a[244:247], v[188:191], v[108:111]
v_mfma_f32_16x16x32_bf16 v[112:115], v[188:191], a[248:251], v[112:115]
v_mfma_f32_16x16x32_bf16 v[116:119], v[188:191], a[252:255], v[116:119]
s_waitcnt lgkmcnt(3)
v_mfma_f32_16x16x32_bf16 v[104:107], v[192:195], v[160:163], v[104:107]
v_mfma_f32_16x16x32_bf16 v[108:111], v[196:199], v[160:163], v[108:111]
v_mfma_f32_16x16x32_bf16 v[112:115], v[160:163], v[200:203], v[112:115]
v_mfma_f32_16x16x32_bf16 v[116:119], v[160:163], v[204:207], v[116:119]
s_waitcnt lgkmcnt(2)
v_mfma_f32_16x16x32_bf16 v[104:107], v[208:211], v[164:167], v[104:107]
v_mfma_f32_16x16x32_bf16 v[108:111], v[212:215], v[164:167], v[108:111]
v_mfma_f32_16x16x32_bf16 v[112:115], v[164:167], v[216:219], v[112:115]
v_mfma_f32_16x16x32_bf16 v[116:119], v[164:167], v[220:223], v[116:119]
s_waitcnt lgkmcnt(1)
v_mfma_f32_16x16x32_bf16 v[104:107], v[224:227], v[168:171], v[104:107]
v_mfma_f32_16x16x32_bf16 v[108:111], v[228:231], v[168:171], v[108:111]
v_mfma_f32_16x16x32_bf16 v[112:115], v[168:171], v[232:235], v[112:115]
v_mfma_f32_16x16x32_bf16 v[116:119], v[168:171], v[236:239], v[116:119]
s_waitcnt lgkmcnt(0)
v_mfma_f32_16x16x32_bf16 v[104:107], v[240:243], v[172:175], v[104:107]
v_mfma_f32_16x16x32_bf16 v[108:111], v[244:247], v[172:175], v[108:111]
v_mfma_f32_16x16x32_bf16 v[112:115], v[172:175], v[248:251], v[112:115]
v_mfma_f32_16x16x32_bf16 v[116:119], v[172:175], v[252:255], v[116:119]
v_cvt_pk_bf16_f32 v104, v104, v105
v_cvt_pk_bf16_f32 v105, v106, v107
v_cvt_pk_bf16_f32 v106, v108, v109
v_cvt_pk_bf16_f32 v107, v110, v111
ds_write_b128 v155, v[104:107] offset:20480
v_cvt_pk_bf16_f32 v112, v112, v113
v_cvt_pk_bf16_f32 v113, v114, v115
v_cvt_pk_bf16_f32 v114, v116, v117
v_cvt_pk_bf16_f32 v115, v118, v119
ds_write_b128 v155, v[112:115] offset:24576
s_waitcnt vmcnt(20)
v_mfma_f32_16x16x32_bf16 v[136:139], v[40:43], v[24:27], v[4:7]
s_waitcnt vmcnt(19)
v_mfma_f32_16x16x32_bf16 v[140:143], v[44:47], v[24:27], v[8:11]
s_waitcnt vmcnt(17)
v_mfma_f32_16x16x32_bf16 v[136:139], v[48:51], v[28:31], v[136:139]
s_waitcnt vmcnt(16)
v_mfma_f32_16x16x32_bf16 v[140:143], v[52:55], v[28:31], v[140:143]
s_waitcnt lgkmcnt(0)
s_barrier
ds_read_b128 v[104:107], v0 offset:20480
ds_read_b128 v[108:111], v0 offset:21504
ds_read_b128 v[112:115], v0 offset:22528
ds_read_b128 v[116:119], v0 offset:23552
ds_read_b128 v[120:123], v0 offset:24576
ds_read_b128 v[124:127], v0 offset:25600
ds_read_b128 v[128:131], v0 offset:26624
ds_read_b128 v[132:135], v0 offset:27648
s_waitcnt vmcnt(14)
v_mfma_f32_16x16x32_bf16 v[136:139], v[56:59], v[32:35], v[136:139]
s_waitcnt vmcnt(13)
v_mfma_f32_16x16x32_bf16 v[140:143], v[60:63], v[32:35], v[140:143]
s_waitcnt vmcnt(11)
v_mfma_f32_16x16x32_bf16 v[136:139], v[64:67], v[36:39], v[136:139]
s_waitcnt vmcnt(10)
v_mfma_f32_16x16x32_bf16 v[140:143], v[68:71], v[36:39], v[140:143]
s_waitcnt lgkmcnt(7)
v_mfma_f32_16x16x32_bf16 v[144:147], v[104:107], v[24:27], v[156:159]
s_waitcnt lgkmcnt(6)
v_mfma_f32_16x16x32_bf16 v[144:147], v[108:111], v[28:31], v[144:147]
s_waitcnt lgkmcnt(5)
v_mfma_f32_16x16x32_bf16 v[144:147], v[112:115], v[32:35], v[144:147]
s_waitcnt lgkmcnt(4)
v_mfma_f32_16x16x32_bf16 v[144:147], v[116:119], v[36:39], v[144:147]
v_max3_f32 v44, v136, v137, v138
v_max3_f32 v44, v44, v139, v140
v_max3_f32 v44, v44, v141, v142
s_nop 2
v_max3_f32 v44, v44, v143, v144
v_max3_f32 v44, v44, v145, v146
v_max_f32 v44, v44, v147
v_mov_b32 v45, v44
s_nop 1
v_permlane32_swap_b32 v44, v45
v_max_f32 v44, v44, v45
v_mov_b32 v45, v44
s_nop 1
v_permlane16_swap_b32 v44, v45
v_max_f32 v44, v44, v45
v_mul_f32 v44, s58, v44
v_fma_f32 v136, v136, s58, -v44
v_exp_f32 v136, v136
v_fma_f32 v137, v137, s58, -v44
v_exp_f32 v137, v137
v_fma_f32 v138, v138, s58, -v44
v_exp_f32 v138, v138
v_fma_f32 v139, v139, s58, -v44
v_exp_f32 v139, v139
v_fma_f32 v140, v140, s58, -v44
v_exp_f32 v140, v140
v_fma_f32 v141, v141, s58, -v44
v_exp_f32 v141, v141
v_fma_f32 v142, v142, s58, -v44
v_exp_f32 v142, v142
v_fma_f32 v143, v143, s58, -v44
v_exp_f32 v143, v143
v_fma_f32 v144, v144, s58, -v44
v_exp_f32 v144, v144
v_fma_f32 v145, v145, s58, -v44
v_exp_f32 v145, v145
v_fma_f32 v146, v146, s58, -v44
v_exp_f32 v146, v146
v_fma_f32 v147, v147, s58, -v44
v_exp_f32 v147, v147
v_cvt_pk_bf16_f32 v148, v136, v137
v_cvt_pk_bf16_f32 v149, v138, v139
v_cvt_pk_bf16_f32 v150, v140, v141
v_cvt_pk_bf16_f32 v151, v142, v143
v_cvt_pk_bf16_f32 v152, v144, v145
v_cvt_pk_bf16_f32 v153, v146, v147
v_mfma_f32_16x16x32_bf16 v[40:43], v[12:15], v[148:151], 0
s_waitcnt vmcnt(9)
v_mfma_f32_16x16x32_bf16 v[160:163], v[72:75], v[148:151], 0
s_waitcnt vmcnt(8)
v_mfma_f32_16x16x32_bf16 v[164:167], v[76:79], v[148:151], 0
v_mfma_f32_16x16x16_bf16 v[40:43], v[12:13], v[152:153], v[40:43]
s_waitcnt vmcnt(7)
v_mfma_f32_16x16x32_bf16 v[168:171], v[80:83], v[148:151], 0
s_waitcnt vmcnt(6)
v_mfma_f32_16x16x32_bf16 v[172:175], v[84:87], v[148:151], 0
s_waitcnt vmcnt(5)
v_mfma_f32_16x16x32_bf16 v[176:179], v[88:91], v[148:151], 0
s_waitcnt vmcnt(4)
v_mfma_f32_16x16x32_bf16 v[180:183], v[92:95], v[148:151], 0
s_waitcnt vmcnt(3)
v_mfma_f32_16x16x32_bf16 v[184:187], v[96:99], v[148:151], 0
s_waitcnt vmcnt(2)
v_mfma_f32_16x16x32_bf16 v[188:191], v[100:103], v[148:151], 0
v_rcp_f32 v40, v40
s_waitcnt lgkmcnt(3)
v_mfma_f32_16x16x16_bf16 v[160:163], v[120:121], v[152:153], v[160:163]
v_mfma_f32_16x16x16_bf16 v[164:167], v[122:123], v[152:153], v[164:167]
s_waitcnt lgkmcnt(2)
v_mfma_f32_16x16x16_bf16 v[168:171], v[124:125], v[152:153], v[168:171]
v_mfma_f32_16x16x16_bf16 v[172:175], v[126:127], v[152:153], v[172:175]
s_waitcnt lgkmcnt(1)
v_mfma_f32_16x16x16_bf16 v[176:179], v[128:129], v[152:153], v[176:179]
v_mfma_f32_16x16x16_bf16 v[180:183], v[130:131], v[152:153], v[180:183]
s_waitcnt lgkmcnt(0)
v_mfma_f32_16x16x16_bf16 v[184:187], v[132:133], v[152:153], v[184:187]
v_mfma_f32_16x16x16_bf16 v[188:191], v[134:135], v[152:153], v[188:191]
v_mul_f32 v160, v40, v160
v_mul_f32 v161, v40, v161
v_mul_f32 v162, v40, v162
v_mul_f32 v163, v40, v163
v_mul_f32 v164, v40, v164
v_mul_f32 v165, v40, v165
v_mul_f32 v166, v40, v166
v_mul_f32 v167, v40, v167
v_cvt_pk_bf16_f32 v104, v160, v161
v_cvt_pk_bf16_f32 v105, v162, v163
v_cvt_pk_bf16_f32 v106, v164, v165
v_cvt_pk_bf16_f32 v107, v166, v167
buffer_store_dwordx4 v[104:107], v1, s[4:7], s48 offen offset:0 sc1
v_mul_f32 v168, v40, v168
v_mul_f32 v169, v40, v169
v_mul_f32 v170, v40, v170
v_mul_f32 v171, v40, v171
v_mul_f32 v172, v40, v172
v_mul_f32 v173, v40, v173
v_mul_f32 v174, v40, v174
v_mul_f32 v175, v40, v175
v_cvt_pk_bf16_f32 v108, v168, v169
v_cvt_pk_bf16_f32 v109, v170, v171
v_cvt_pk_bf16_f32 v110, v172, v173
v_cvt_pk_bf16_f32 v111, v174, v175
buffer_store_dwordx4 v[108:111], v1, s[4:7], s48 offen offset:128 sc1
v_mul_f32 v176, v40, v176
v_mul_f32 v177, v40, v177
v_mul_f32 v178, v40, v178
v_mul_f32 v179, v40, v179
v_mul_f32 v180, v40, v180
v_mul_f32 v181, v40, v181
v_mul_f32 v182, v40, v182
v_mul_f32 v183, v40, v183
v_cvt_pk_bf16_f32 v112, v176, v177
v_cvt_pk_bf16_f32 v113, v178, v179
v_cvt_pk_bf16_f32 v114, v180, v181
v_cvt_pk_bf16_f32 v115, v182, v183
buffer_store_dwordx4 v[112:115], v1, s[4:7], s48 offen offset:1024 sc1
v_mul_f32 v184, v40, v184
v_mul_f32 v185, v40, v185
v_mul_f32 v186, v40, v186
v_mul_f32 v187, v40, v187
v_mul_f32 v188, v40, v188
v_mul_f32 v189, v40, v189
v_mul_f32 v190, v40, v190
v_mul_f32 v191, v40, v191
v_cvt_pk_bf16_f32 v116, v184, v185
v_cvt_pk_bf16_f32 v117, v186, v187
v_cvt_pk_bf16_f32 v118, v188, v189
v_cvt_pk_bf16_f32 v119, v190, v191
buffer_store_dwordx4 v[116:119], v1, s[4:7], s48 offen offset:1152 sc1
v_mov_b32 v154, s50
s_add_u32 s44, s44, 1048576
s_add_u32 s45, s45, 524288
s_add_u32 s46, s46, 20480
s_add_u32 s48, s48, 524288
s_add_u32 s50, s50, 2
s_sub_u32 s52, s50, 65
s_cmp_lt_u32 s52, 2
s_cbranch_scc0 k_nosw_26
s_add_u32 s44, s44, 8388608
s_add_u32 s48, s48, 1048576
s_add_u32 s46, s46, 393216
k_nosw_26:
s_waitcnt vmcnt(4)
v_min3_u32 v20, v20, v21, v22
v_cmp_le_u32 vcc, s50, v20
s_cbranch_vccnz k_cd_22
s_branch k_top_20
k_out_27:
s_waitcnt vmcnt(0) lgkmcnt(0)
s_barrier
s_add_u32 s30, s30, 80
s_branch k_fin_7
k_p_6:
s_mul_i32 s57, s30, 21846
s_lshr_b32 s57, s57, 16
s_mul_i32 s52, s57, 3
s_sub_u32 s58, s30, s52
s_cmp_eq_u32 s58, 1
s_cselect_b32 s12, s16, s12
s_cselect_b32 s13, s17, s13
s_cmp_eq_u32 s58, 2
s_cselect_b32 s12, s8, s12
s_cselect_b32 s13, s9, s13
v_lshrrev_b32 v1, 8, v0
v_and_b32 v2, 0xf0, v0
v_lshlrev_b32 v3, 5, v1
v_xor_b32 v2, v2, v3
v_lshl_add_u32 v1, v1, 13, v2
s_mul_i32 s52, s3, 1310720
s_lshl_b32 s53, s57, 8
s_add_u32 s52, s52, s53
s_mul_i32 s53, s3, 40960
s_add_u32 m0, s53, 0
s_add_u32 s54, s52, 0
buffer_load_dwordx4 v1, s[12:15], s54 offen lds
s_add_u32 m0, s53, 1024
s_add_u32 s54, s52, 32768
buffer_load_dwordx4 v1, s[12:15], s54 offen lds
s_add_u32 m0, s53, 2048
s_add_u32 s54, s52, 65536
buffer_load_dwordx4 v1, s[12:15], s54 offen lds
s_add_u32 m0, s53, 3072
s_add_u32 s54, s52, 98304
buffer_load_dwordx4 v1, s[12:15], s54 offen lds
s_add_u32 m0, s53, 4096
s_add_u32 s54, s52, 131072
buffer_load_dwordx4 v1, s[12:15], s54 offen lds
s_add_u32 m0, s53, 5120
s_add_u32 s54, s52, 163840
buffer_load_dwordx4 v1, s[12:15], s54 offen lds
s_add_u32 m0, s53, 6144
s_add_u32 s54, s52, 196608
buffer_load_dwordx4 v1, s[12:15], s54 offen lds
s_add_u32 m0, s53, 7168
s_add_u32 s54, s52, 229376
buffer_load_dwordx4 v1, s[12:15], s54 offen lds
s_add_u32 m0, s53, 8192
s_add_u32 s54, s52, 262144
buffer_load_dwordx4 v1, s[12:15], s54 offen lds
s_add_u32 m0, s53, 9216
s_add_u32 s54, s52, 294912
buffer_load_dwordx4 v1, s[12:15], s54 offen lds
s_add_u32 m0, s53, 10240
s_add_u32 s54, s52, 327680
buffer_load_dwordx4 v1, s[12:15], s54 offen lds
s_add_u32 m0, s53, 11264
s_add_u32 s54, s52, 360448
buffer_load_dwordx4 v1, s[12:15], s54 offen lds
s_add_u32 m0, s53, 12288
s_add_u32 s54, s52, 393216
buffer_load_dwordx4 v1, s[12:15], s54 offen lds
s_add_u32 m0, s53, 13312
s_add_u32 s54, s52, 425984
buffer_load_dwordx4 v1, s[12:15], s54 offen lds
s_add_u32 m0, s53, 14336
s_add_u32 s54, s52, 458752
buffer_load_dwordx4 v1, s[12:15], s54 offen lds
s_add_u32 m0, s53, 15360
s_add_u32 s54, s52, 491520
buffer_load_dwordx4 v1, s[12:15], s54 offen lds
s_add_u32 m0, s53, 16384
s_add_u32 s54, s52, 524288
buffer_load_dwordx4 v1, s[12:15], s54 offen lds
s_add_u32 m0, s53, 17408
s_add_u32 s54, s52, 557056
buffer_load_dwordx4 v1, s[12:15], s54 offen lds
s_add_u32 m0, s53, 18432
s_add_u32 s54, s52, 589824
buffer_load_dwordx4 v1, s[12:15], s54 offen lds
s_add_u32 m0, s53, 19456
s_add_u32 s54, s52, 622592
buffer_load_dwordx4 v1, s[12:15], s54 offen lds
s_add_u32 m0, s53, 20480
s_add_u32 s54, s52, 655360
buffer_load_dwordx4 v1, s[12:15], s54 offen lds
s_add_u32 m0, s53, 21504
s_add_u32 s54, s52, 688128
buffer_load_dwordx4 v1, s[12:15], s54 offen lds
s_add_u32 m0, s53, 22528
s_add_u32 s54, s52, 720896
buffer_load_dwordx4 v1, s[12:15], s54 offen lds
s_add_u32 m0, s53, 23552
s_add_u32 s54, s52, 753664
buffer_load_dwordx4 v1, s[12:15], s54 offen lds
s_add_u32 m0, s53, 24576
s_add_u32 s54, s52, 786432
buffer_load_dwordx4 v1, s[12:15], s54 offen lds
s_add_u32 m0, s53, 25600
s_add_u32 s54, s52, 819200
buffer_load_dwordx4 v1, s[12:15], s54 offen lds
s_add_u32 m0, s53, 26624
s_add_u32 s54, s52, 851968
buffer_load_dwordx4 v1, s[12:15], s54 offen lds
s_add_u32 m0, s53, 27648
s_add_u32 s54, s52, 884736
buffer_load_dwordx4 v1, s[12:15], s54 offen lds
s_add_u32 m0, s53, 28672
s_add_u32 s54, s52, 917504
buffer_load_dwordx4 v1, s[12:15], s54 offen lds
s_add_u32 m0, s53, 29696
s_add_u32 s54, s52, 950272
buffer_load_dwordx4 v1, s[12:15], s54 offen lds
s_add_u32 m0, s53, 30720
s_add_u32 s54, s52, 983040
buffer_load_dwordx4 v1, s[12:15], s54 offen lds
s_add_u32 m0, s53, 31744
s_add_u32 s54, s52, 1015808
buffer_load_dwordx4 v1, s[12:15], s54 offen lds
s_add_u32 m0, s53, 32768
s_add_u32 s54, s52, 1048576
buffer_load_dwordx4 v1, s[12:15], s54 offen lds
s_add_u32 m0, s53, 33792
s_add_u32 s54, s52, 1081344
buffer_load_dwordx4 v1, s[12:15], s54 offen lds
s_add_u32 m0, s53, 34816
s_add_u32 s54, s52, 1114112
buffer_load_dwordx4 v1, s[12:15], s54 offen lds
s_add_u32 m0, s53, 35840
s_add_u32 s54, s52, 1146880
buffer_load_dwordx4 v1, s[12:15], s54 offen lds
s_add_u32 m0, s53, 36864
s_add_u32 s54, s52, 1179648
buffer_load_dwordx4 v1, s[12:15], s54 offen lds
s_add_u32 m0, s53, 37888
s_add_u32 s54, s52, 1212416
buffer_load_dwordx4 v1, s[12:15], s54 offen lds
s_add_u32 m0, s53, 38912
s_add_u32 s54, s52, 1245184
buffer_load_dwordx4 v1, s[12:15], s54 offen lds
s_add_u32 m0, s53, 39936
s_add_u32 s54, s52, 1277952
buffer_load_dwordx4 v1, s[12:15], s54 offen lds
v_bfe_u32 v2, v0, 8, 1
v_bfe_u32 v3, v0, 5, 1
s_cmp_eq_u32 s58, 1
s_cselect_b32 s52, 7, 4
s_cselect_b32 s53, 4, 7
v_lshlrev_b32 v2, s52, v2
v_lshlrev_b32 v3, s53, v3
v_add_u32 v2, v2, v3
v_bfe_u32 v3, v0, 4, 1
v_lshl_add_u32 v2, v3, 3, v2
v_bfe_u32 v3, v0, 6, 2
v_xor_b32 v4, s3, v3
v_lshl_add_u32 v2, v4, 5, v2
v_lshl_add_u32 v2, v3, 8, v2
v_lshrrev_b32 v3, 9, v0
v_lshl_add_u32 v2, v3, 11, v2
v_add_u32 v3, 0x10000, v2
v_add_u32 v4, 0x20000, v2
s_waitcnt vmcnt(0)
s_barrier
ds_read_b64_tr_b16 v[96:97], v2 offset:0
ds_read_b64_tr_b16 v[98:99], v2 offset:1024
ds_read_b64_tr_b16 v[100:101], v2 offset:4096
ds_read_b64_tr_b16 v[102:103], v2 offset:5120
ds_read_b64_tr_b16 v[104:105], v2 offset:8192
ds_read_b64_tr_b16 v[106:107], v2 offset:9216
ds_read_b64_tr_b16 v[108:109], v2 offset:12288
ds_read_b64_tr_b16 v[110:111], v2 offset:13312
ds_read_b64_tr_b16 v[112:113], v2 offset:16384
ds_read_b64_tr_b16 v[114:115], v2 offset:17408
ds_read_b64_tr_b16 v[116:117], v2 offset:20480
ds_read_b64_tr_b16 v[118:119], v2 offset:21504
ds_read_b64_tr_b16 v[120:121], v2 offset:24576
ds_read_b64_tr_b16 v[122:123], v2 offset:25600
ds_read_b64_tr_b16 v[124:125], v2 offset:28672
ds_read_b64_tr_b16 v[126:127], v2 offset:29696
ds_read_b64_tr_b16 v[128:129], v2 offset:32768
ds_read_b64_tr_b16 v[130:131], v2 offset:33792
ds_read_b64_tr_b16 v[132:133], v2 offset:36864
ds_read_b64_tr_b16 v[134:135], v2 offset:37888
ds_read_b64_tr_b16 v[136:137], v2 offset:40960
ds_read_b64_tr_b16 v[138:139], v2 offset:41984
ds_read_b64_tr_b16 v[140:141], v2 offset:45056
ds_read_b64_tr_b16 v[142:143], v2 offset:46080
ds_read_b64_tr_b16 v[144:145], v2 offset:49152
ds_read_b64_tr_b16 v[146:147], v2 offset:50176
ds_read_b64_tr_b16 v[148:149], v2 offset:53248
ds_read_b64_tr_b16 v[150:151], v2 offset:54272
ds_read_b64_tr_b16 v[152:153], v2 offset:57344
ds_read_b64_tr_b16 v[154:155], v2 offset:58368
ds_read_b64_tr_b16 v[156:157], v2 offset:61440
ds_read_b64_tr_b16 v[158:159], v2 offset:62464
ds_read_b64_tr_b16 v[160:161], v3 offset:0
ds_read_b64_tr_b16 v[162:163], v3 offset:1024
ds_read_b64_tr_b16 v[164:165], v3 offset:4096
ds_read_b64_tr_b16 v[166:167], v3 offset:5120
ds_read_b64_tr_b16 v[168:169], v3 offset:8192
ds_read_b64_tr_b16 v[170:171], v3 offset:9216
ds_read_b64_tr_b16 v[172:173], v3 offset:12288
ds_read_b64_tr_b16 v[174:175], v3 offset:13312
ds_read_b64_tr_b16 v[176:177], v3 offset:16384
ds_read_b64_tr_b16 v[178:179], v3 offset:17408
ds_read_b64_tr_b16 v[180:181], v3 offset:20480
ds_read_b64_tr_b16 v[182:183], v3 offset:21504
ds_read_b64_tr_b16 v[184:185], v3 offset:24576
ds_read_b64_tr_b16 v[186:187], v3 offset:25600
ds_read_b64_tr_b16 v[188:189], v3 offset:28672
ds_read_b64_tr_b16 v[190:191], v3 offset:29696
ds_read_b64_tr_b16 v[192:193], v3 offset:32768
ds_read_b64_tr_b16 v[194:195], v3 offset:33792
ds_read_b64_tr_b16 v[196:197], v3 offset:36864
ds_read_b64_tr_b16 v[198:199], v3 offset:37888
ds_read_b64_tr_b16 v[200:201], v3 offset:40960
ds_read_b64_tr_b16 v[202:203], v3 offset:41984
ds_read_b64_tr_b16 v[204:205], v3 offset:45056
ds_read_b64_tr_b16 v[206:207], v3 offset:46080
ds_read_b64_tr_b16 v[208:209], v3 offset:49152
ds_read_b64_tr_b16 v[210:211], v3 offset:50176
ds_read_b64_tr_b16 v[212:213], v3 offset:53248
ds_read_b64_tr_b16 v[214:215], v3 offset:54272
ds_read_b64_tr_b16 v[216:217], v3 offset:57344
ds_read_b64_tr_b16 v[218:219], v3 offset:58368
ds_read_b64_tr_b16 v[220:221], v3 offset:61440
ds_read_b64_tr_b16 v[222:223], v3 offset:62464
ds_read_b64_tr_b16 v[224:225], v4 offset:0
ds_read_b64_tr_b16 v[226:227], v4 offset:1024
ds_read_b64_tr_b16 v[228:229], v4 offset:4096
ds_read_b64_tr_b16 v[230:231], v4 offset:5120
ds_read_b64_tr_b16 v[232:233], v4 offset:8192
ds_read_b64_tr_b16 v[234:235], v4 offset:9216
ds_read_b64_tr_b16 v[236:237], v4 offset:12288
ds_read_b64_tr_b16 v[238:239], v4 offset:13312
ds_read_b64_tr_b16 v[240:241], v4 offset:16384
ds_read_b64_tr_b16 v[242:243], v4 offset:17408
ds_read_b64_tr_b16 v[244:245], v4 offset:20480
ds_read_b64_tr_b16 v[246:247], v4 offset:21504
ds_read_b64_tr_b16 v[248:249], v4 offset:24576
ds_read_b64_tr_b16 v[250:251], v4 offset:25600
ds_read_b64_tr_b16 v[252:253], v4 offset:28672
ds_read_b64_tr_b16 v[254:255], v4 offset:29696
s_waitcnt lgkmcnt(0)
s_cmp_lg_u32 s3, 0
s_cbranch_scc1 k_wdd_29
v_mov_b32 v2, 128
k_wd_28:
global_load_dword v3, v2, s[28:29] sc1
s_waitcnt vmcnt(0)
v_readfirstlane_b32 s52, v3
s_cmp_ge_u32 s52, 32
s_cbranch_scc1 k_wdd_29
s_sleep 2
s_sub_u32 s32, s32, 1
s_cmp_gt_i32 s32, 0
s_cbranch_scc1 k_wd_28
k_wdd_29:
s_barrier
v_accvgpr_write_b32 a0, v96
v_accvgpr_write_b32 a1, v97
v_accvgpr_write_b32 a2, v98
v_accvgpr_write_b32 a3, v99
v_accvgpr_write_b32 a4, v100
v_accvgpr_write_b32 a5, v101
v_accvgpr_write_b32 a6, v102
v_accvgpr_write_b32 a7, v103
v_accvgpr_write_b32 a8, v104
v_accvgpr_write_b32 a9, v105
v_accvgpr_write_b32 a10, v106
v_accvgpr_write_b32 a11, v107
v_accvgpr_write_b32 a12, v108
v_accvgpr_write_b32 a13, v109
v_accvgpr_write_b32 a14, v110
v_accvgpr_write_b32 a15, v111
v_accvgpr_write_b32 a16, v112
v_accvgpr_write_b32 a17, v113
v_accvgpr_write_b32 a18, v114
v_accvgpr_write_b32 a19, v115
v_accvgpr_write_b32 a20, v116
v_accvgpr_write_b32 a21, v117
v_accvgpr_write_b32 a22, v118
v_accvgpr_write_b32 a23, v119
v_accvgpr_write_b32 a24, v120
v_accvgpr_write_b32 a25, v121
v_accvgpr_write_b32 a26, v122
v_accvgpr_write_b32 a27, v123
v_accvgpr_write_b32 a28, v124
v_accvgpr_write_b32 a29, v125
v_accvgpr_write_b32 a30, v126
v_accvgpr_write_b32 a31, v127
v_accvgpr_write_b32 a32, v128
v_accvgpr_write_b32 a33, v129
v_accvgpr_write_b32 a34, v130
v_accvgpr_write_b32 a35, v131
v_accvgpr_write_b32 a36, v132
v_accvgpr_write_b32 a37, v133
v_accvgpr_write_b32 a38, v134
v_accvgpr_write_b32 a39, v135
v_accvgpr_write_b32 a40, v136
v_accvgpr_write_b32 a41, v137
v_accvgpr_write_b32 a42, v138
v_accvgpr_write_b32 a43, v139
v_accvgpr_write_b32 a44, v140
v_accvgpr_write_b32 a45, v141
v_accvgpr_write_b32 a46, v142
v_accvgpr_write_b32 a47, v143
v_accvgpr_write_b32 a48, v144
v_accvgpr_write_b32 a49, v145
v_accvgpr_write_b32 a50, v146
v_accvgpr_write_b32 a51, v147
v_accvgpr_write_b32 a52, v148
v_accvgpr_write_b32 a53, v149
v_accvgpr_write_b32 a54, v150
v_accvgpr_write_b32 a55, v151
v_accvgpr_write_b32 a56, v152
v_accvgpr_write_b32 a57, v153
v_accvgpr_write_b32 a58, v154
v_accvgpr_write_b32 a59, v155
v_accvgpr_write_b32 a60, v156
v_accvgpr_write_b32 a61, v157
v_accvgpr_write_b32 a62, v158
v_accvgpr_write_b32 a63, v159
v_accvgpr_write_b32 a64, v160
v_accvgpr_write_b32 a65, v161
v_accvgpr_write_b32 a66, v162
v_accvgpr_write_b32 a67, v163
v_accvgpr_write_b32 a68, v164
v_accvgpr_write_b32 a69, v165
v_accvgpr_write_b32 a70, v166
v_accvgpr_write_b32 a71, v167
v_accvgpr_write_b32 a72, v168
v_accvgpr_write_b32 a73, v169
v_accvgpr_write_b32 a74, v170
v_accvgpr_write_b32 a75, v171
v_accvgpr_write_b32 a76, v172
v_accvgpr_write_b32 a77, v173
v_accvgpr_write_b32 a78, v174
v_accvgpr_write_b32 a79, v175
v_accvgpr_write_b32 a80, v176
v_accvgpr_write_b32 a81, v177
v_accvgpr_write_b32 a82, v178
v_accvgpr_write_b32 a83, v179
v_accvgpr_write_b32 a84, v180
v_accvgpr_write_b32 a85, v181
v_accvgpr_write_b32 a86, v182
v_accvgpr_write_b32 a87, v183
v_accvgpr_write_b32 a88, v184
v_accvgpr_write_b32 a89, v185
v_accvgpr_write_b32 a90, v186
v_accvgpr_write_b32 a91, v187
v_accvgpr_write_b32 a92, v188
v_accvgpr_write_b32 a93, v189
v_accvgpr_write_b32 a94, v190
v_accvgpr_write_b32 a95, v191
v_accvgpr_write_b32 a96, v192
v_accvgpr_write_b32 a97, v193
v_accvgpr_write_b32 a98, v194
v_accvgpr_write_b32 a99, v195
v_accvgpr_write_b32 a100, v196
v_accvgpr_write_b32 a101, v197
v_accvgpr_write_b32 a102, v198
v_accvgpr_write_b32 a103, v199
v_accvgpr_write_b32 a104, v200
v_accvgpr_write_b32 a105, v201
v_accvgpr_write_b32 a106, v202
v_accvgpr_write_b32 a107, v203
v_accvgpr_write_b32 a108, v204
v_accvgpr_write_b32 a109, v205
v_accvgpr_write_b32 a110, v206
v_accvgpr_write_b32 a111, v207
v_accvgpr_write_b32 a112, v208
v_accvgpr_write_b32 a113, v209
v_accvgpr_write_b32 a114, v210
v_accvgpr_write_b32 a115, v211
v_accvgpr_write_b32 a116, v212
v_accvgpr_write_b32 a117, v213
v_accvgpr_write_b32 a118, v214
v_accvgpr_write_b32 a119, v215
v_accvgpr_write_b32 a120, v216
v_accvgpr_write_b32 a121, v217
v_accvgpr_write_b32 a122, v218
v_accvgpr_write_b32 a123, v219
v_accvgpr_write_b32 a124, v220
v_accvgpr_write_b32 a125, v221
v_accvgpr_write_b32 a126, v222
v_accvgpr_write_b32 a127, v223
v_accvgpr_write_b32 a128, v224
v_accvgpr_write_b32 a129, v225
v_accvgpr_write_b32 a130, v226
v_accvgpr_write_b32 a131, v227
v_accvgpr_write_b32 a132, v228
v_accvgpr_write_b32 a133, v229
v_accvgpr_write_b32 a134, v230
v_accvgpr_write_b32 a135, v231
v_accvgpr_write_b32 a136, v232
v_accvgpr_write_b32 a137, v233
v_accvgpr_write_b32 a138, v234
v_accvgpr_write_b32 a139, v235
v_accvgpr_write_b32 a140, v236
v_accvgpr_write_b32 a141, v237
v_accvgpr_write_b32 a142, v238
v_accvgpr_write_b32 a143, v239
v_accvgpr_write_b32 a144, v240
v_accvgpr_write_b32 a145, v241
v_accvgpr_write_b32 a146, v242
v_accvgpr_write_b32 a147, v243
v_accvgpr_write_b32 a148, v244
v_accvgpr_write_b32 a149, v245
v_accvgpr_write_b32 a150, v246
v_accvgpr_write_b32 a151, v247
v_accvgpr_write_b32 a152, v248
v_accvgpr_write_b32 a153, v249
v_accvgpr_write_b32 a154, v250
v_accvgpr_write_b32 a155, v251
v_accvgpr_write_b32 a156, v252
v_accvgpr_write_b32 a157, v253
v_accvgpr_write_b32 a158, v254
v_accvgpr_write_b32 a159, v255
s_cmp_lg_u32 s3, 0
s_cbranch_scc1 k_wdd_31
v_mov_b32 v2, 64
k_wd_30:
global_load_dword v3, v2, s[28:29] sc1
s_waitcnt vmcnt(0)
v_readfirstlane_b32 s52, v3
s_cmp_ge_u32 s52, 80
s_cbranch_scc1 k_wdd_31
s_sleep 2
s_sub_u32 s32, s32, 1
s_cmp_gt_i32 s32, 0
s_cbranch_scc1 k_wd_30
k_wdd_31:
s_barrier
v_bfe_u32 v72, v0, 8, 1
v_and_b32 v1, 0xf0, v0
v_lshl_add_u32 v1, v72, 10, v1
v_and_b32 v2, 0x50, v0
v_lshl_add_u32 v2, v72, 13, v2
v_bfe_u32 v72, v0, 7, 1
v_lshl_add_u32 v2, v72, 5, v2
v_bfe_u32 v72, v0, 5, 1
v_lshl_add_u32 v2, v72, 12, v2
s_cmp_eq_u32 s58, 0
s_cselect_b64 vcc, -1, 0
v_cndmask_b32 v1, v1, v2, vcc
v_lshrrev_b32 v72, 9, v0
v_lshl_add_u32 v1, v72, 8, v1
s_lshl_b32 s52, s3, 10
v_add_u32 v73, s52, v0
v_mov_b32 v2, 2146435072
v_cmp_eq_u32 vcc, 0, v73
s_nop 1
v_cndmask_b32 v2, v2, 0, vcc
v_mov_b32 v3, -1
v_and_b32 v7, 0x1f0, v0
v_lshrrev_b32 v28, 2, v7
v_lshlrev_b32 v7, 1, v7
v_add_u32 v7, 122880, v7
s_lshl_b32 s52, s3, 3
v_lshl_add_u32 v6, v72, 2, v7
v_add_u32 v6, s52, v6
s_lshl_b32 s52, s3, 7
s_add_u32 s52, s52, 124928
v_add_u32 v28, s52, v28
v_lshlrev_b32 v29, 4, v72
v_add_u32 v29, s52, v29
s_mov_b32 s51, 0
s_mov_b32 s50, 0
s_branch k_l0_35
k_lay_32:
s_mov_b32 s54, 222306304
s_waitcnt vmcnt(0) lgkmcnt(0)
s_cmp_lg_u32 s3, 0
s_cbranch_scc1 k_w8d_37
v_lshlrev_b32 v8, 2, v0
k_w8_36:
buffer_load_dword v9, v8, s[4:7], s54 offen sc1
buffer_load_dword v10, v8, s[4:7], s54 offen offset:1024 sc1
s_waitcnt vmcnt(0)
v_and_b32 v9, v9, v10
v_cmp_eq_u32 vcc, 0, v9
s_cbranch_vccz k_w8d_37
s_sleep 1
s_sub_u32 s32, s32, 1
s_cmp_gt_i32 s32, 0
s_cbranch_scc1 k_w8_36
k_w8d_37:
s_barrier
k_l0_35:
s_mul_i32 s52, s3, 10240
v_add_u32 v5, s52, v0
s_mul_i32 s46, s51, 114294784
s_add_u32 s46, s46, s52
s_add_u32 s46, s46, 83886080
s_lshl_b32 s52, s57, 2
s_add_u32 s52, s52, s3
s_cmp_eq_u32 s58, 2
s_cselect_b32 s53, 11, 12
s_mov_b32 s49, 524288
s_cmov_b32 s49, 262144
s_lshl_b32 s48, s52, s53
s_lshr_b32 s52, s3, 1
s_mul_i32 s52, s52, 768
s_mul_i32 s53, s3, 3968
s_sub_u32 s52, s53, s52
s_cmp_eq_u32 s58, 0
s_cselect_b32 s52, s52, 0
s_sub_u32 s48, s48, s52
s_cmp_eq_u32 s58, 2
s_mov_b32 s52, 41943040
s_cmov_b32 s52, 16777216
s_cselect_b32 s53, 125829120, 0
s_mul_i32 s52, s52, s51
s_add_u32 s48, s48, s52
s_add_u32 s48, s48, s53
s_lshl_b32 s60, s57, 6
s_lshl_b32 s52, s58, 2
s_add_u32 s60, s60, s52
s_add_u32 s60, s60, 222330880
s_mov_b32 s61, 0x3acccccd
s_cmp_eq_u32 s58, 1
s_cbranch_scc1 k_isv_33
s_mul_i32 s45, s3, 10240
s_mov_b32 s44, 0
v_mov_b32 v64, v0
s_add_u32 m0, s45, 0
s_add_u32 s55, s46, 0
buffer_load_dwordx4 v0, s[4:7], s55 offen offset:0 sc1 lds
buffer_load_dwordx4 v0, s[4:7], s55 offen offset:1024 sc1 lds
buffer_load_dwordx4 v0, s[4:7], s55 offen offset:2048 sc1 lds
buffer_load_dwordx4 v0, s[4:7], s55 offen offset:3072 sc1 lds
s_add_u32 m0, s45, 4096
s_add_u32 s55, s46, 4096
buffer_load_dwordx4 v0, s[4:7], s55 offen offset:0 sc1 lds
buffer_load_dwordx4 v0, s[4:7], s55 offen offset:1024 sc1 lds
buffer_load_dwordx4 v0, s[4:7], s55 offen offset:2048 sc1 lds
buffer_load_dwordx4 v0, s[4:7], s55 offen offset:3072 sc1 lds
s_add_u32 m0, s45, 8192
s_add_u32 s55, s46, 8192
buffer_load_dwordx4 v0, s[4:7], s55 offen offset:0 sc1 lds
buffer_load_dwordx4 v0, s[4:7], s55 offen offset:1024 sc1 lds
s_add_u32 s45, s45, 40960
s_cmp_ge_u32 s45, 122880
s_cselect_b32 s55, 122880, 0
s_sub_u32 s45, s45, s55
s_add_u32 s46, s46, 40960
s_add_u32 m0, s45, 0
s_add_u32 s55, s46, 0
buffer_load_dwordx4 v0, s[4:7], s55 offen offset:0 sc1 lds
buffer_load_dwordx4 v0, s[4:7], s55 offen offset:1024 sc1 lds
buffer_load_dwordx4 v0, s[4:7], s55 offen offset:2048 sc1 lds
buffer_load_dwordx4 v0, s[4:7], s55 offen offset:3072 sc1 lds
s_add_u32 m0, s45, 4096
s_add_u32 s55, s46, 4096
buffer_load_dwordx4 v0, s[4:7], s55 offen offset:0 sc1 lds
buffer_load_dwordx4 v0, s[4:7], s55 offen offset:1024 sc1 lds
buffer_load_dwordx4 v0, s[4:7], s55 offen offset:2048 sc1 lds
buffer_load_dwordx4 v0, s[4:7], s55 offen offset:3072 sc1 lds
s_add_u32 m0, s45, 8192
s_add_u32 s55, s46, 8192
buffer_load_dwordx4 v0, s[4:7], s55 offen offset:0 sc1 lds
buffer_load_dwordx4 v0, s[4:7], s55 offen offset:1024 sc1 lds
s_add_u32 s45, s45, 40960
s_cmp_ge_u32 s45, 122880
s_cselect_b32 s55, 122880, 0
s_sub_u32 s45, s45, s55
s_add_u32 s46, s46, 40960
s_waitcnt vmcnt(10)
s_barrier
ds_read_b128 v[8:11], v64 offset:0
ds_read_b128 v[12:15], v64 offset:1024
ds_read_b128 v[16:19], v64 offset:2048
ds_read_b128 v[20:23], v64 offset:3072
s_mov_b32 s59, 32
s_waitcnt lgkmcnt(3)
v_mfma_f32_32x32x16_bf16 v[32:47], a[0:3], v[8:11], 0
s_waitcnt lgkmcnt(2)
ds_read_b128 v[24:27], v64 offset:4096
v_mfma_f32_32x32x16_bf16 v[32:47], a[4:7], v[12:15], v[32:47]
s_waitcnt lgkmcnt(2)
ds_read_b128 v[8:11], v64 offset:5120
ds_read_b128 v[72:75], v5
v_mov_b32 v4, 0
ds_read_b128 v[76:79], v5 offset:1024
v_mfma_f32_32x32x16_bf16 v[32:47], a[8:11], v[16:19], v[32:47]
s_waitcnt lgkmcnt(4)
ds_read_b128 v[12:15], v64 offset:6144
s_waitcnt lgkmcnt(2)
v_and_b32 v72, v3, v72
v_dot2c_f32_bf16 v4, v72, v72
v_dot2c_f32_bf16 v4, v73, v73
v_dot2c_f32_bf16 v4, v74, v74
v_dot2c_f32_bf16 v4, v75, v75
v_mfma_f32_32x32x16_bf16 v[32:47], a[12:15], v[20:23], v[32:47]
ds_read_b128 v[16:19], v64 offset:7168
ds_read_b128 v[72:75], v5 offset:2048
s_waitcnt lgkmcnt(3)
v_dot2c_f32_bf16 v4, v76, v76
v_dot2c_f32_bf16 v4, v77, v77
v_dot2c_f32_bf16 v4, v78, v78
v_dot2c_f32_bf16 v4, v79, v79
v_mfma_f32_32x32x16_bf16 v[32:47], a[16:19], v[24:27], v[32:47]
ds_read_b128 v[20:23], v64 offset:8192
ds_read_b128 v[76:79], v5 offset:3072
s_waitcnt lgkmcnt(2)
v_dot2c_f32_bf16 v4, v72, v72
v_dot2c_f32_bf16 v4, v73, v73
v_dot2c_f32_bf16 v4, v74, v74
v_dot2c_f32_bf16 v4, v75, v75
v_mfma_f32_32x32x16_bf16 v[32:47], a[20:23], v[8:11], v[32:47]
ds_read_b128 v[24:27], v64 offset:9216
ds_read_b128 v[72:75], v5 offset:4096
s_waitcnt lgkmcnt(2)
v_dot2c_f32_bf16 v4, v76, v76
v_dot2c_f32_bf16 v4, v77, v77
v_dot2c_f32_bf16 v4, v78, v78
v_dot2c_f32_bf16 v4, v79, v79
v_mfma_f32_32x32x16_bf16 v[32:47], a[24:27], v[12:15], v[32:47]
ds_read_b128 v[8:11], v64 offset:10240
ds_read_b128 v[76:79], v5 offset:5120
s_waitcnt lgkmcnt(2)
v_dot2c_f32_bf16 v4, v72, v72
v_dot2c_f32_bf16 v4, v73, v73
v_dot2c_f32_bf16 v4, v74, v74
v_dot2c_f32_bf16 v4, v75, v75
v_mfma_f32_32x32x16_bf16 v[32:47], a[28:31], v[16:19], v[32:47]
ds_read_b128 v[12:15], v64 offset:11264
ds_read_b128 v[72:75], v5 offset:6144
s_waitcnt lgkmcnt(2)
v_dot2c_f32_bf16 v4, v76, v76
v_dot2c_f32_bf16 v4, v77, v77
v_dot2c_f32_bf16 v4, v78, v78
v_dot2c_f32_bf16 v4, v79, v79
v_mfma_f32_32x32x16_bf16 v[32:47], a[32:35], v[20:23], v[32:47]
ds_read_b128 v[16:19], v64 offset:12288
ds_read_b128 v[76:79], v5 offset:7168
s_waitcnt lgkmcnt(2)
v_dot2c_f32_bf16 v4, v72, v72
v_dot2c_f32_bf16 v4, v73, v73
v_dot2c_f32_bf16 v4, v74, v74
v_dot2c_f32_bf16 v4, v75, v75
v_mfma_f32_32x32x16_bf16 v[32:47], a[36:39], v[24:27], v[32:47]
ds_read_b128 v[20:23], v64 offset:13312
ds_read_b128 v[72:75], v5 offset:8192
s_waitcnt lgkmcnt(2)
v_dot2c_f32_bf16 v4, v76, v76
v_dot2c_f32_bf16 v4, v77, v77
v_dot2c_f32_bf16 v4, v78, v78
v_dot2c_f32_bf16 v4, v79, v79
v_mfma_f32_32x32x16_bf16 v[32:47], a[40:43], v[8:11], v[32:47]
ds_read_b128 v[24:27], v64 offset:14336
ds_read_b128 v[76:79], v5 offset:9216
s_waitcnt lgkmcnt(2)
v_dot2c_f32_bf16 v4, v72, v72
v_dot2c_f32_bf16 v4, v73, v73
v_dot2c_f32_bf16 v4, v74, v74
v_dot2c_f32_bf16 v4, v75, v75
v_mfma_f32_32x32x16_bf16 v[32:47], a[44:47], v[12:15], v[32:47]
ds_read_b128 v[8:11], v64 offset:15360
s_waitcnt lgkmcnt(1)
v_dot2c_f32_bf16 v4, v76, v76
v_dot2c_f32_bf16 v4, v77, v77
v_dot2c_f32_bf16 v4, v78, v78
v_dot2c_f32_bf16 v4, v79, v79
s_nop 2
ds_write_b32 v6, v4 offset:0
v_mfma_f32_32x32x16_bf16 v[32:47], a[48:51], v[16:19], v[32:47]
ds_read_b128 v[12:15], v64 offset:16384
s_add_u32 m0, s45, 0
s_add_u32 s55, s46, 0
buffer_load_dwordx4 v0, s[4:7], s55 offen offset:0 sc1 lds
buffer_load_dwordx4 v0, s[4:7], s55 offen offset:1024 sc1 lds
v_mfma_f32_32x32x16_bf16 v[32:47], a[52:55], v[20:23], v[32:47]
ds_read_b128 v[16:19], v64 offset:17408
buffer_load_dwordx4 v0, s[4:7], s55 offen offset:2048 sc1 lds
buffer_load_dwordx4 v0, s[4:7], s55 offen offset:3072 sc1 lds
v_mfma_f32_32x32x16_bf16 v[32:47], a[56:59], v[24:27], v[32:47]
s_waitcnt lgkmcnt(3)
ds_read_b128 v[20:23], v64 offset:18432
s_add_u32 m0, s45, 4096
s_add_u32 s55, s46, 4096
buffer_load_dwordx4 v0, s[4:7], s55 offen offset:0 sc1 lds
buffer_load_dwordx4 v0, s[4:7], s55 offen offset:1024 sc1 lds
v_mfma_f32_32x32x16_bf16 v[32:47], a[60:63], v[8:11], v[32:47]
s_waitcnt lgkmcnt(2)
ds_read_b128 v[24:27], v64 offset:19456
buffer_load_dwordx4 v0, s[4:7], s55 offen offset:2048 sc1 lds
buffer_load_dwordx4 v0, s[4:7], s55 offen offset:3072 sc1 lds
v_mfma_f32_32x32x16_bf16 v[32:47], a[64:67], v[12:15], v[32:47]
s_waitcnt lgkmcnt(2)
ds_read_b128 v[8:11], v64 offset:20480
s_add_u32 m0, s45, 8192
s_add_u32 s55, s46, 8192
buffer_load_dwordx4 v0, s[4:7], s55 offen offset:0 sc1 lds
buffer_load_dwordx4 v0, s[4:7], s55 offen offset:1024 sc1 lds
v_mfma_f32_32x32x16_bf16 v[32:47], a[68:71], v[16:19], v[32:47]
s_waitcnt lgkmcnt(2)
ds_read_b128 v[12:15], v64 offset:21504
s_add_u32 s45, s45, 40960
s_cmp_ge_u32 s45, 122880
s_cselect_b32 s55, 122880, 0
s_sub_u32 s45, s45, s55
s_add_u32 s46, s46, 40960
v_mfma_f32_32x32x16_bf16 v[32:47], a[72:75], v[20:23], v[32:47]
s_waitcnt lgkmcnt(2)
ds_read_b128 v[16:19], v64 offset:22528
v_mfma_f32_32x32x16_bf16 v[32:47], a[76:79], v[24:27], v[32:47]
s_waitcnt lgkmcnt(2)
ds_read_b128 v[20:23], v64 offset:23552
v_mfma_f32_32x32x16_bf16 v[32:47], a[80:83], v[8:11], v[32:47]
s_waitcnt lgkmcnt(2)
ds_read_b128 v[24:27], v64 offset:24576
v_mfma_f32_32x32x16_bf16 v[32:47], a[84:87], v[12:15], v[32:47]
s_waitcnt lgkmcnt(2)
ds_read_b128 v[8:11], v64 offset:25600
v_mfma_f32_32x32x16_bf16 v[32:47], a[88:91], v[16:19], v[32:47]
s_waitcnt lgkmcnt(2)
ds_read_b128 v[12:15], v64 offset:26624
v_mfma_f32_32x32x16_bf16 v[32:47], a[92:95], v[20:23], v[32:47]
s_waitcnt lgkmcnt(2)
ds_read_b128 v[16:19], v64 offset:27648
v_mfma_f32_32x32x16_bf16 v[32:47], a[96:99], v[24:27], v[32:47]
s_waitcnt lgkmcnt(2)
ds_read_b128 v[20:23], v64 offset:28672
v_mfma_f32_32x32x16_bf16 v[32:47], a[100:103], v[8:11], v[32:47]
s_waitcnt lgkmcnt(2)
ds_read_b128 v[24:27], v64 offset:29696
v_mfma_f32_32x32x16_bf16 v[32:47], a[104:107], v[12:15], v[32:47]
s_waitcnt lgkmcnt(2)
ds_read_b128 v[8:11], v64 offset:30720
v_mfma_f32_32x32x16_bf16 v[32:47], a[108:111], v[16:19], v[32:47]
s_waitcnt lgkmcnt(2)
ds_read_b128 v[12:15], v64 offset:31744
v_mfma_f32_32x32x16_bf16 v[32:47], a[112:115], v[20:23], v[32:47]
s_waitcnt lgkmcnt(2)
ds_read_b128 v[16:19], v64 offset:32768
v_mfma_f32_32x32x16_bf16 v[32:47], a[116:119], v[24:27], v[32:47]
s_waitcnt lgkmcnt(2)
ds_read_b128 v[20:23], v64 offset:33792
v_mfma_f32_32x32x16_bf16 v[32:47], a[120:123], v[8:11], v[32:47]
s_waitcnt lgkmcnt(2)
ds_read_b128 v[24:27], v64 offset:34816
v_mfma_f32_32x32x16_bf16 v[32:47], a[124:127], v[12:15], v[32:47]
s_waitcnt lgkmcnt(2)
ds_read_b128 v[8:11], v64 offset:35840
v_mfma_f32_32x32x16_bf16 v[32:47], a[128:131], v[16:19], v[32:47]
s_waitcnt lgkmcnt(2)
ds_read_b128 v[12:15], v64 offset:36864
v_mfma_f32_32x32x16_bf16 v[32:47], a[132:135], v[20:23], v[32:47]
s_waitcnt lgkmcnt(2)
ds_read_b128 v[16:19], v64 offset:37888
v_mfma_f32_32x32x16_bf16 v[32:47], a[136:139], v[24:27], v[32:47]
s_waitcnt lgkmcnt(2)
ds_read_b128 v[20:23], v64 offset:38912
v_mfma_f32_32x32x16_bf16 v[32:47], a[140:143], v[8:11], v[32:47]
s_waitcnt lgkmcnt(2)
ds_read_b128 v[24:27], v64 offset:39936
v_mfma_f32_32x32x16_bf16 v[32:47], a[144:147], v[12:15], v[32:47]
s_add_u32 s44, s44, 1
s_cmp_eq_u32 s44, 3
s_mov_b32 s56, 40960
s_cmov_b32 s56, -81920
s_cselect_b32 s44, 0, s44
v_add_u32 v64, s56, v64
v_add_u32 v5, s56, v5
s_waitcnt vmcnt(10) lgkmcnt(2)
s_barrier
ds_read_b128 v[8:11], v64 offset:0
v_mfma_f32_32x32x16_bf16 v[32:47], a[148:151], v[16:19], v[32:47]
s_waitcnt lgkmcnt(2)
ds_read_b128 v[12:15], v64 offset:1024
v_mfma_f32_32x32x16_bf16 v[32:47], a[152:155], v[20:23], v[32:47]
s_waitcnt lgkmcnt(2)
ds_read_b128 v[16:19], v64 offset:2048
v_mfma_f32_32x32x16_bf16 v[32:47], a[156:159], v[24:27], v[32:47]
s_waitcnt lgkmcnt(2)
ds_read_b128 v[20:23], v64 offset:3072
ds_read_b128 v[80:83], v7 offset:0
ds_read_b128 v[84:87], v7 offset:16
v_mov_b32 v88, 0x3727c5ac
s_waitcnt lgkmcnt(0)
v_add_f32 v80, v80, v84
v_add_f32 v81, v81, v85
v_add_f32 v82, v82, v86
v_add_f32 v83, v83, v87
v_add_f32 v80, v80, v81
v_add_f32 v82, v82, v83
v_add_f32 v80, v80, v82
v_fma_f32 v80, v80, s61, v88
v_rsq_f32 v80, v80
s_nop 0
v_mul_f32 v32, v80, v32
v_mul_f32 v33, v80, v33
v_cvt_pk_bf16_f32 v32, v32, v33
v_mul_f32 v34, v80, v34
v_mul_f32 v35, v80, v35
v_cvt_pk_bf16_f32 v33, v34, v35
v_mul_f32 v36, v80, v36
v_mul_f32 v37, v80, v37
v_cvt_pk_bf16_f32 v34, v36, v37
v_mul_f32 v38, v80, v38
v_mul_f32 v39, v80, v39
v_cvt_pk_bf16_f32 v35, v38, v39
v_mul_f32 v40, v80, v40
v_mul_f32 v41, v80, v41
v_cvt_pk_bf16_f32 v36, v40, v41
v_mul_f32 v42, v80, v42
v_mul_f32 v43, v80, v43
v_cvt_pk_bf16_f32 v37, v42, v43
v_mul_f32 v44, v80, v44
v_mul_f32 v45, v80, v45
v_cvt_pk_bf16_f32 v38, v44, v45
v_mul_f32 v46, v80, v46
v_mul_f32 v47, v80, v47
v_cvt_pk_bf16_f32 v39, v46, v47
buffer_store_dwordx4 v[32:35], v1, s[4:7], s48 offen offset:0 sc1
buffer_store_dwordx4 v[36:39], v1, s[4:7], s48 offen offset:512 sc1
s_add_u32 s48, s48, s49
s_waitcnt vmcnt(0)
s_barrier
s_add_u32 s50, s50, 1
v_mov_b32 v4, s50
buffer_store_dword v4, v2, s[4:7], s60 offen sc1
v_mfma_f32_32x32x16_bf16 v[48:63], a[0:3], v[8:11], 0
ds_read_b128 v[24:27], v64 offset:4096
v_mfma_f32_32x32x16_bf16 v[48:63], a[4:7], v[12:15], v[48:63]
ds_read_b128 v[8:11], v64 offset:5120
ds_read_b128 v[72:75], v5
v_mov_b32 v4, 0
ds_read_b128 v[76:79], v5 offset:1024
v_mfma_f32_32x32x16_bf16 v[48:63], a[8:11], v[16:19], v[48:63]
ds_read_b128 v[12:15], v64 offset:6144
s_waitcnt lgkmcnt(2)
v_and_b32 v72, v3, v72
v_dot2c_f32_bf16 v4, v72, v72
v_dot2c_f32_bf16 v4, v73, v73
v_dot2c_f32_bf16 v4, v74, v74
v_dot2c_f32_bf16 v4, v75, v75
v_mfma_f32_32x32x16_bf16 v[48:63], a[12:15], v[20:23], v[48:63]
ds_read_b128 v[16:19], v64 offset:7168
ds_read_b128 v[72:75], v5 offset:2048
s_waitcnt lgkmcnt(3)
v_dot2c_f32_bf16 v4, v76, v76
v_dot2c_f32_bf16 v4, v77, v77
v_dot2c_f32_bf16 v4, v78, v78
v_dot2c_f32_bf16 v4, v79, v79
v_mfma_f32_32x32x16_bf16 v[48:63], a[16:19], v[24:27], v[48:63]
ds_read_b128 v[20:23], v64 offset:8192
ds_read_b128 v[76:79], v5 offset:3072
s_waitcnt lgkmcnt(2)
v_dot2c_f32_bf16 v4, v72, v72
v_dot2c_f32_bf16 v4, v73, v73
v_dot2c_f32_bf16 v4, v74, v74
v_dot2c_f32_bf16 v4, v75, v75
v_mfma_f32_32x32x16_bf16 v[48:63], a[20:23], v[8:11], v[48:63]
ds_read_b128 v[24:27], v64 offset:9216
ds_read_b128 v[72:75], v5 offset:4096
s_waitcnt lgkmcnt(2)
v_dot2c_f32_bf16 v4, v76, v76
v_dot2c_f32_bf16 v4, v77, v77
v_dot2c_f32_bf16 v4, v78, v78
v_dot2c_f32_bf16 v4, v79, v79
v_mfma_f32_32x32x16_bf16 v[48:63], a[24:27], v[12:15], v[48:63]
ds_read_b128 v[8:11], v64 offset:10240
ds_read_b128 v[76:79], v5 offset:5120
s_waitcnt lgkmcnt(2)
v_dot2c_f32_bf16 v4, v72, v72
v_dot2c_f32_bf16 v4, v73, v73
v_dot2c_f32_bf16 v4, v74, v74
v_dot2c_f32_bf16 v4, v75, v75
v_mfma_f32_32x32x16_bf16 v[48:63], a[28:31], v[16:19], v[48:63]
ds_read_b128 v[12:15], v64 offset:11264
ds_read_b128 v[72:75], v5 offset:6144
s_waitcnt lgkmcnt(2)
v_dot2c_f32_bf16 v4, v76, v76
v_dot2c_f32_bf16 v4, v77, v77
v_dot2c_f32_bf16 v4, v78, v78
v_dot2c_f32_bf16 v4, v79, v79
v_mfma_f32_32x32x16_bf16 v[48:63], a[32:35], v[20:23], v[48:63]
ds_read_b128 v[16:19], v64 offset:12288
ds_read_b128 v[76:79], v5 offset:7168
s_waitcnt lgkmcnt(2)
v_dot2c_f32_bf16 v4, v72, v72
v_dot2c_f32_bf16 v4, v73, v73
v_dot2c_f32_bf16 v4, v74, v74
v_dot2c_f32_bf16 v4, v75, v75
v_mfma_f32_32x32x16_bf16 v[48:63], a[36:39], v[24:27], v[48:63]
ds_read_b128 v[20:23], v64 offset:13312
ds_read_b128 v[72:75], v5 offset:8192
s_waitcnt lgkmcnt(2)
v_dot2c_f32_bf16 v4, v76, v76
v_dot2c_f32_bf16 v4, v77, v77
v_dot2c_f32_bf16 v4, v78, v78
v_dot2c_f32_bf16 v4, v79, v79
v_mfma_f32_32x32x16_bf16 v[48:63], a[40:43], v[8:11], v[48:63]
ds_read_b128 v[24:27], v64 offset:14336
ds_read_b128 v[76:79], v5 offset:9216
s_waitcnt lgkmcnt(2)
v_dot2c_f32_bf16 v4, v72, v72
v_dot2c_f32_bf16 v4, v73, v73
v_dot2c_f32_bf16 v4, v74, v74
v_dot2c_f32_bf16 v4, v75, v75
v_mfma_f32_32x32x16_bf16 v[48:63], a[44:47], v[12:15], v[48:63]
ds_read_b128 v[8:11], v64 offset:15360
s_waitcnt lgkmcnt(1)
v_dot2c_f32_bf16 v4, v76, v76
v_dot2c_f32_bf16 v4, v77, v77
v_dot2c_f32_bf16 v4, v78, v78
v_dot2c_f32_bf16 v4, v79, v79
s_nop 2
ds_write_b32 v6, v4 offset:1024
v_mfma_f32_32x32x16_bf16 v[48:63], a[48:51], v[16:19], v[48:63]
ds_read_b128 v[12:15], v64 offset:16384
s_add_u32 m0, s45, 0
s_add_u32 s55, s46, 0
buffer_load_dwordx4 v0, s[4:7], s55 offen offset:0 sc1 lds
buffer_load_dwordx4 v0, s[4:7], s55 offen offset:1024 sc1 lds
v_mfma_f32_32x32x16_bf16 v[48:63], a[52:55], v[20:23], v[48:63]
ds_read_b128 v[16:19], v64 offset:17408
buffer_load_dwordx4 v0, s[4:7], s55 offen offset:2048 sc1 lds
buffer_load_dwordx4 v0, s[4:7], s55 offen offset:3072 sc1 lds
v_mfma_f32_32x32x16_bf16 v[48:63], a[56:59], v[24:27], v[48:63]
s_waitcnt lgkmcnt(3)
ds_read_b128 v[20:23], v64 offset:18432
s_add_u32 m0, s45, 4096
s_add_u32 s55, s46, 4096
buffer_load_dwordx4 v0, s[4:7], s55 offen offset:0 sc1 lds
buffer_load_dwordx4 v0, s[4:7], s55 offen offset:1024 sc1 lds
v_mfma_f32_32x32x16_bf16 v[48:63], a[60:63], v[8:11], v[48:63]
s_waitcnt lgkmcnt(2)
ds_read_b128 v[24:27], v64 offset:19456
buffer_load_dwordx4 v0, s[4:7], s55 offen offset:2048 sc1 lds
buffer_load_dwordx4 v0, s[4:7], s55 offen offset:3072 sc1 lds
v_mfma_f32_32x32x16_bf16 v[48:63], a[64:67], v[12:15], v[48:63]
s_waitcnt lgkmcnt(2)
ds_read_b128 v[8:11], v64 offset:20480
s_add_u32 m0, s45, 8192
s_add_u32 s55, s46, 8192
buffer_load_dwordx4 v0, s[4:7], s55 offen offset:0 sc1 lds
buffer_load_dwordx4 v0, s[4:7], s55 offen offset:1024 sc1 lds
v_mfma_f32_32x32x16_bf16 v[48:63], a[68:71], v[16:19], v[48:63]
s_waitcnt lgkmcnt(2)
ds_read_b128 v[12:15], v64 offset:21504
s_add_u32 s45, s45, 40960
s_cmp_ge_u32 s45, 122880
s_cselect_b32 s55, 122880, 0
s_sub_u32 s45, s45, s55
s_add_u32 s46, s46, 40960
v_mfma_f32_32x32x16_bf16 v[48:63], a[72:75], v[20:23], v[48:63]
s_waitcnt lgkmcnt(2)
ds_read_b128 v[16:19], v64 offset:22528
v_mfma_f32_32x32x16_bf16 v[48:63], a[76:79], v[24:27], v[48:63]
s_waitcnt lgkmcnt(2)
ds_read_b128 v[20:23], v64 offset:23552
v_mfma_f32_32x32x16_bf16 v[48:63], a[80:83], v[8:11], v[48:63]
s_waitcnt lgkmcnt(2)
ds_read_b128 v[24:27], v64 offset:24576
v_mfma_f32_32x32x16_bf16 v[48:63], a[84:87], v[12:15], v[48:63]
s_waitcnt lgkmcnt(2)
ds_read_b128 v[8:11], v64 offset:25600
v_mfma_f32_32x32x16_bf16 v[48:63], a[88:91], v[16:19], v[48:63]
s_waitcnt lgkmcnt(2)
ds_read_b128 v[12:15], v64 offset:26624
v_mfma_f32_32x32x16_bf16 v[48:63], a[92:95], v[20:23], v[48:63]
s_waitcnt lgkmcnt(2)
ds_read_b128 v[16:19], v64 offset:27648
v_mfma_f32_32x32x16_bf16 v[48:63], a[96:99], v[24:27], v[48:63]
s_waitcnt lgkmcnt(2)
ds_read_b128 v[20:23], v64 offset:28672
v_mfma_f32_32x32x16_bf16 v[48:63], a[100:103], v[8:11], v[48:63]
s_waitcnt lgkmcnt(2)
ds_read_b128 v[24:27], v64 offset:29696
v_mfma_f32_32x32x16_bf16 v[48:63], a[104:107], v[12:15], v[48:63]
s_waitcnt lgkmcnt(2)
ds_read_b128 v[8:11], v64 offset:30720
v_mfma_f32_32x32x16_bf16 v[48:63], a[108:111], v[16:19], v[48:63]
s_waitcnt lgkmcnt(2)
ds_read_b128 v[12:15], v64 offset:31744
v_mfma_f32_32x32x16_bf16 v[48:63], a[112:115], v[20:23], v[48:63]
s_waitcnt lgkmcnt(2)
ds_read_b128 v[16:19], v64 offset:32768
v_mfma_f32_32x32x16_bf16 v[48:63], a[116:119], v[24:27], v[48:63]
s_waitcnt lgkmcnt(2)
ds_read_b128 v[20:23], v64 offset:33792
v_mfma_f32_32x32x16_bf16 v[48:63], a[120:123], v[8:11], v[48:63]
s_waitcnt lgkmcnt(2)
ds_read_b128 v[24:27], v64 offset:34816
v_mfma_f32_32x32x16_bf16 v[48:63], a[124:127], v[12:15], v[48:63]
s_waitcnt lgkmcnt(2)
ds_read_b128 v[8:11], v64 offset:35840
v_mfma_f32_32x32x16_bf16 v[48:63], a[128:131], v[16:19], v[48:63]
s_waitcnt lgkmcnt(2)
ds_read_b128 v[12:15], v64 offset:36864
v_mfma_f32_32x32x16_bf16 v[48:63], a[132:135], v[20:23], v[48:63]
s_waitcnt lgkmcnt(2)
ds_read_b128 v[16:19], v64 offset:37888
v_mfma_f32_32x32x16_bf16 v[48:63], a[136:139], v[24:27], v[48:63]
s_waitcnt lgkmcnt(2)
ds_read_b128 v[20:23], v64 offset:38912
v_mfma_f32_32x32x16_bf16 v[48:63], a[140:143], v[8:11], v[48:63]
s_waitcnt lgkmcnt(2)
ds_read_b128 v[24:27], v64 offset:39936
v_mfma_f32_32x32x16_bf16 v[48:63], a[144:147], v[12:15], v[48:63]
s_add_u32 s44, s44, 1
s_cmp_eq_u32 s44, 3
s_mov_b32 s56, 40960
s_cmov_b32 s56, -81920
s_cselect_b32 s44, 0, s44
v_add_u32 v64, s56, v64
v_add_u32 v5, s56, v5
s_waitcnt vmcnt(10) lgkmcnt(2)
s_barrier
ds_read_b128 v[8:11], v64 offset:0
v_mfma_f32_32x32x16_bf16 v[48:63], a[148:151], v[16:19], v[48:63]
s_waitcnt lgkmcnt(2)
ds_read_b128 v[12:15], v64 offset:1024
v_mfma_f32_32x32x16_bf16 v[48:63], a[152:155], v[20:23], v[48:63]
s_waitcnt lgkmcnt(2)
ds_read_b128 v[16:19], v64 offset:2048
v_mfma_f32_32x32x16_bf16 v[48:63], a[156:159], v[24:27], v[48:63]
s_waitcnt lgkmcnt(2)
ds_read_b128 v[20:23], v64 offset:3072
s_branch k_sm_40
k_st_38:
v_mfma_f32_32x32x16_bf16 v[48:63], a[0:3], v[8:11], 0
s_waitcnt lgkmcnt(2)
ds_read_b128 v[24:27], v64 offset:4096
v_mfma_f32_32x32x16_bf16 v[48:63], a[4:7], v[12:15], v[48:63]
s_waitcnt lgkmcnt(2)
ds_read_b128 v[8:11], v64 offset:5120
ds_read_b128 v[80:83], v7 offset:0
ds_read_b128 v[84:87], v7 offset:16
v_mov_b32 v88, 0x3727c5ac
v_mfma_f32_32x32x16_bf16 v[48:63], a[8:11], v[16:19], v[48:63]
s_waitcnt lgkmcnt(4)
ds_read_b128 v[12:15], v64 offset:6144
s_waitcnt lgkmcnt(1)
v_add_f32 v80, v80, v84
v_add_f32 v81, v81, v85
v_add_f32 v82, v82, v86
v_add_f32 v83, v83, v87
v_add_f32 v80, v80, v81
v_add_f32 v82, v82, v83
v_add_f32 v80, v80, v82
v_mfma_f32_32x32x16_bf16 v[48:63], a[12:15], v[20:23], v[48:63]
ds_read_b128 v[16:19], v64 offset:7168
v_fma_f32 v80, v80, s61, v88
v_rsq_f32 v80, v80
s_nop 0
v_mul_f32 v32, v80, v32
v_mul_f32 v33, v80, v33
v_cvt_pk_bf16_f32 v32, v32, v33
v_mfma_f32_32x32x16_bf16 v[48:63], a[16:19], v[24:27], v[48:63]
ds_read_b128 v[20:23], v64 offset:8192
v_mul_f32 v34, v80, v34
v_mul_f32 v35, v80, v35
v_cvt_pk_bf16_f32 v33, v34, v35
v_mul_f32 v36, v80, v36
v_mul_f32 v37, v80, v37
v_cvt_pk_bf16_f32 v34, v36, v37
v_mfma_f32_32x32x16_bf16 v[48:63], a[20:23], v[8:11], v[48:63]
s_waitcnt lgkmcnt(2)
ds_read_b128 v[24:27], v64 offset:9216
v_mul_f32 v38, v80, v38
v_mul_f32 v39, v80, v39
v_cvt_pk_bf16_f32 v35, v38, v39
v_mul_f32 v40, v80, v40
v_mul_f32 v41, v80, v41
v_cvt_pk_bf16_f32 v36, v40, v41
v_mfma_f32_32x32x16_bf16 v[48:63], a[24:27], v[12:15], v[48:63]
s_waitcnt lgkmcnt(2)
ds_read_b128 v[8:11], v64 offset:10240
v_mul_f32 v42, v80, v42
v_mul_f32 v43, v80, v43
v_cvt_pk_bf16_f32 v37, v42, v43
v_mul_f32 v44, v80, v44
v_mul_f32 v45, v80, v45
v_cvt_pk_bf16_f32 v38, v44, v45
v_mfma_f32_32x32x16_bf16 v[48:63], a[28:31], v[16:19], v[48:63]
s_waitcnt lgkmcnt(2)
ds_read_b128 v[12:15], v64 offset:11264
v_mul_f32 v46, v80, v46
v_mul_f32 v47, v80, v47
v_cvt_pk_bf16_f32 v39, v46, v47
buffer_store_dwordx4 v[32:35], v1, s[4:7], s48 offen offset:0 sc1
v_mfma_f32_32x32x16_bf16 v[48:63], a[32:35], v[20:23], v[48:63]
s_waitcnt lgkmcnt(2)
ds_read_b128 v[16:19], v64 offset:12288
buffer_store_dwordx4 v[36:39], v1, s[4:7], s48 offen offset:512 sc1
s_add_u32 s48, s48, s49
v_mfma_f32_32x32x16_bf16 v[48:63], a[36:39], v[24:27], v[48:63]
s_waitcnt lgkmcnt(2)
ds_read_b128 v[20:23], v64 offset:13312
ds_read_b128 v[72:75], v5
v_mov_b32 v4, 0
ds_read_b128 v[76:79], v5 offset:1024
v_mfma_f32_32x32x16_bf16 v[48:63], a[40:43], v[8:11], v[48:63]
s_waitcnt lgkmcnt(4)
ds_read_b128 v[24:27], v64 offset:14336
s_waitcnt lgkmcnt(2)
v_and_b32 v72, v3, v72
v_dot2c_f32_bf16 v4, v72, v72
v_dot2c_f32_bf16 v4, v73, v73
v_dot2c_f32_bf16 v4, v74, v74
v_dot2c_f32_bf16 v4, v75, v75
v_mfma_f32_32x32x16_bf16 v[48:63], a[44:47], v[12:15], v[48:63]
ds_read_b128 v[8:11], v64 offset:15360
ds_read_b128 v[72:75], v5 offset:2048
s_waitcnt lgkmcnt(3)
v_dot2c_f32_bf16 v4, v76, v76
v_dot2c_f32_bf16 v4, v77, v77
v_dot2c_f32_bf16 v4, v78, v78
v_dot2c_f32_bf16 v4, v79, v79
v_mfma_f32_32x32x16_bf16 v[48:63], a[48:51], v[16:19], v[48:63]
ds_read_b128 v[12:15], v64 offset:16384
ds_read_b128 v[76:79], v5 offset:3072
s_waitcnt lgkmcnt(2)
v_dot2c_f32_bf16 v4, v72, v72
v_dot2c_f32_bf16 v4, v73, v73
v_dot2c_f32_bf16 v4, v74, v74
v_dot2c_f32_bf16 v4, v75, v75
v_mfma_f32_32x32x16_bf16 v[48:63], a[52:55], v[20:23], v[48:63]
ds_read_b128 v[16:19], v64 offset:17408
ds_read_b128 v[72:75], v5 offset:4096
s_waitcnt lgkmcnt(2)
v_dot2c_f32_bf16 v4, v76, v76
v_dot2c_f32_bf16 v4, v77, v77
v_dot2c_f32_bf16 v4, v78, v78
v_dot2c_f32_bf16 v4, v79, v79
v_mfma_f32_32x32x16_bf16 v[48:63], a[56:59], v[24:27], v[48:63]
ds_read_b128 v[20:23], v64 offset:18432
ds_read_b128 v[76:79], v5 offset:5120
s_waitcnt lgkmcnt(2)
v_dot2c_f32_bf16 v4, v72, v72
v_dot2c_f32_bf16 v4, v73, v73
v_dot2c_f32_bf16 v4, v74, v74
v_dot2c_f32_bf16 v4, v75, v75
v_mfma_f32_32x32x16_bf16 v[48:63], a[60:63], v[8:11], v[48:63]
ds_read_b128 v[24:27], v64 offset:19456
ds_read_b128 v[72:75], v5 offset:6144
s_waitcnt lgkmcnt(2)
v_dot2c_f32_bf16 v4, v76, v76
v_dot2c_f32_bf16 v4, v77, v77
v_dot2c_f32_bf16 v4, v78, v78
v_dot2c_f32_bf16 v4, v79, v79
v_mfma_f32_32x32x16_bf16 v[48:63], a[64:67], v[12:15], v[48:63]
ds_read_b128 v[8:11], v64 offset:20480
ds_read_b128 v[76:79], v5 offset:7168
s_waitcnt lgkmcnt(2)
v_dot2c_f32_bf16 v4, v72, v72
v_dot2c_f32_bf16 v4, v73, v73
v_dot2c_f32_bf16 v4, v74, v74
v_dot2c_f32_bf16 v4, v75, v75
v_mfma_f32_32x32x16_bf16 v[48:63], a[68:71], v[16:19], v[48:63]
ds_read_b128 v[12:15], v64 offset:21504
ds_read_b128 v[72:75], v5 offset:8192
s_waitcnt lgkmcnt(2)
v_dot2c_f32_bf16 v4, v76, v76
v_dot2c_f32_bf16 v4, v77, v77
v_dot2c_f32_bf16 v4, v78, v78
v_dot2c_f32_bf16 v4, v79, v79
v_mfma_f32_32x32x16_bf16 v[48:63], a[72:75], v[20:23], v[48:63]
ds_read_b128 v[16:19], v64 offset:22528
ds_read_b128 v[76:79], v5 offset:9216
s_waitcnt lgkmcnt(2)
v_dot2c_f32_bf16 v4, v72, v72
v_dot2c_f32_bf16 v4, v73, v73
v_dot2c_f32_bf16 v4, v74, v74
v_dot2c_f32_bf16 v4, v75, v75
v_mfma_f32_32x32x16_bf16 v[48:63], a[76:79], v[24:27], v[48:63]
ds_read_b128 v[20:23], v64 offset:23552
s_waitcnt lgkmcnt(1)
v_dot2c_f32_bf16 v4, v76, v76
v_dot2c_f32_bf16 v4, v77, v77
v_dot2c_f32_bf16 v4, v78, v78
v_dot2c_f32_bf16 v4, v79, v79
s_nop 2
ds_write_b32 v6, v4 offset:1024
v_mfma_f32_32x32x16_bf16 v[48:63], a[80:83], v[8:11], v[48:63]
ds_read_b128 v[24:27], v64 offset:24576
s_add_u32 m0, s45, 0
s_add_u32 s55, s46, 0
buffer_load_dwordx4 v0, s[4:7], s55 offen offset:0 sc1 lds
buffer_load_dwordx4 v0, s[4:7], s55 offen offset:1024 sc1 lds
v_mfma_f32_32x32x16_bf16 v[48:63], a[84:87], v[12:15], v[48:63]
ds_read_b128 v[8:11], v64 offset:25600
buffer_load_dwordx4 v0, s[4:7], s55 offen offset:2048 sc1 lds
buffer_load_dwordx4 v0, s[4:7], s55 offen offset:3072 sc1 lds
v_mfma_f32_32x32x16_bf16 v[48:63], a[88:91], v[16:19], v[48:63]
s_waitcnt lgkmcnt(3)
ds_read_b128 v[12:15], v64 offset:26624
s_add_u32 m0, s45, 4096
s_add_u32 s55, s46, 4096
buffer_load_dwordx4 v0, s[4:7], s55 offen offset:0 sc1 lds
buffer_load_dwordx4 v0, s[4:7], s55 offen offset:1024 sc1 lds
v_mfma_f32_32x32x16_bf16 v[48:63], a[92:95], v[20:23], v[48:63]
s_waitcnt lgkmcnt(2)
ds_read_b128 v[16:19], v64 offset:27648
buffer_load_dwordx4 v0, s[4:7], s55 offen offset:2048 sc1 lds
buffer_load_dwordx4 v0, s[4:7], s55 offen offset:3072 sc1 lds
v_mfma_f32_32x32x16_bf16 v[48:63], a[96:99], v[24:27], v[48:63]
s_waitcnt lgkmcnt(2)
ds_read_b128 v[20:23], v64 offset:28672
s_add_u32 m0, s45, 8192
s_add_u32 s55, s46, 8192
buffer_load_dwordx4 v0, s[4:7], s55 offen offset:0 sc1 lds
buffer_load_dwordx4 v0, s[4:7], s55 offen offset:1024 sc1 lds
v_mfma_f32_32x32x16_bf16 v[48:63], a[100:103], v[8:11], v[48:63]
s_waitcnt lgkmcnt(2)
ds_read_b128 v[24:27], v64 offset:29696
s_add_u32 s45, s45, 40960
s_cmp_ge_u32 s45, 122880
s_cselect_b32 s55, 122880, 0
s_sub_u32 s45, s45, s55
s_add_u32 s46, s46, 40960
v_mfma_f32_32x32x16_bf16 v[48:63], a[104:107], v[12:15], v[48:63]
s_waitcnt lgkmcnt(2)
ds_read_b128 v[8:11], v64 offset:30720
v_mfma_f32_32x32x16_bf16 v[48:63], a[108:111], v[16:19], v[48:63]
s_waitcnt lgkmcnt(2)
ds_read_b128 v[12:15], v64 offset:31744
v_mfma_f32_32x32x16_bf16 v[48:63], a[112:115], v[20:23], v[48:63]
s_waitcnt lgkmcnt(2)
ds_read_b128 v[16:19], v64 offset:32768
v_mfma_f32_32x32x16_bf16 v[48:63], a[116:119], v[24:27], v[48:63]
s_waitcnt lgkmcnt(2)
ds_read_b128 v[20:23], v64 offset:33792
v_mfma_f32_32x32x16_bf16 v[48:63], a[120:123], v[8:11], v[48:63]
s_waitcnt lgkmcnt(2)
ds_read_b128 v[24:27], v64 offset:34816
v_mfma_f32_32x32x16_bf16 v[48:63], a[124:127], v[12:15], v[48:63]
s_waitcnt lgkmcnt(2)
ds_read_b128 v[8:11], v64 offset:35840
v_mfma_f32_32x32x16_bf16 v[48:63], a[128:131], v[16:19], v[48:63]
s_waitcnt lgkmcnt(2)
ds_read_b128 v[12:15], v64 offset:36864
v_mfma_f32_32x32x16_bf16 v[48:63], a[132:135], v[20:23], v[48:63]
s_waitcnt lgkmcnt(2)
ds_read_b128 v[16:19], v64 offset:37888
v_mfma_f32_32x32x16_bf16 v[48:63], a[136:139], v[24:27], v[48:63]
s_waitcnt lgkmcnt(2)
ds_read_b128 v[20:23], v64 offset:38912
v_mfma_f32_32x32x16_bf16 v[48:63], a[140:143], v[8:11], v[48:63]
s_waitcnt lgkmcnt(2)
ds_read_b128 v[24:27], v64 offset:39936
v_mfma_f32_32x32x16_bf16 v[48:63], a[144:147], v[12:15], v[48:63]
s_add_u32 s44, s44, 1
s_cmp_eq_u32 s44, 3
s_mov_b32 s56, 40960
s_cmov_b32 s56, -81920
s_cselect_b32 s44, 0, s44
v_add_u32 v64, s56, v64
v_add_u32 v5, s56, v5
s_waitcnt vmcnt(10) lgkmcnt(2)
s_barrier
s_add_u32 s50, s50, 1
v_mov_b32 v4, s50
buffer_store_dword v4, v2, s[4:7], s60 offen sc1
ds_read_b128 v[8:11], v64 offset:0
v_mfma_f32_32x32x16_bf16 v[48:63], a[148:151], v[16:19], v[48:63]
s_waitcnt lgkmcnt(2)
ds_read_b128 v[12:15], v64 offset:1024
v_mfma_f32_32x32x16_bf16 v[48:63], a[152:155], v[20:23], v[48:63]
s_waitcnt lgkmcnt(2)
ds_read_b128 v[16:19], v64 offset:2048
v_mfma_f32_32x32x16_bf16 v[48:63], a[156:159], v[24:27], v[48:63]
s_waitcnt lgkmcnt(2)
ds_read_b128 v[20:23], v64 offset:3072
k_sm_40:
s_sub_u32 s59, s59, 1
s_cmp_eq_u32 s59, 0
s_cbranch_scc1 k_so_39
v_mfma_f32_32x32x16_bf16 v[32:47], a[0:3], v[8:11], 0
s_waitcnt lgkmcnt(2)
ds_read_b128 v[24:27], v64 offset:4096
v_mfma_f32_32x32x16_bf16 v[32:47], a[4:7], v[12:15], v[32:47]
s_waitcnt lgkmcnt(2)
ds_read_b128 v[8:11], v64 offset:5120
ds_read_b128 v[80:83], v7 offset:1024
ds_read_b128 v[84:87], v7 offset:1040
v_mov_b32 v88, 0x3727c5ac
v_mfma_f32_32x32x16_bf16 v[32:47], a[8:11], v[16:19], v[32:47]
s_waitcnt lgkmcnt(4)
ds_read_b128 v[12:15], v64 offset:6144
s_waitcnt lgkmcnt(1)
v_add_f32 v80, v80, v84
v_add_f32 v81, v81, v85
v_add_f32 v82, v82, v86
v_add_f32 v83, v83, v87
v_add_f32 v80, v80, v81
v_add_f32 v82, v82, v83
v_add_f32 v80, v80, v82
v_mfma_f32_32x32x16_bf16 v[32:47], a[12:15], v[20:23], v[32:47]
ds_read_b128 v[16:19], v64 offset:7168
v_fma_f32 v80, v80, s61, v88
v_rsq_f32 v80, v80
s_nop 0
v_mul_f32 v48, v80, v48
v_mul_f32 v49, v80, v49
v_cvt_pk_bf16_f32 v48, v48, v49
v_mfma_f32_32x32x16_bf16 v[32:47], a[16:19], v[24:27], v[32:47]
ds_read_b128 v[20:23], v64 offset:8192
v_mul_f32 v50, v80, v50
v_mul_f32 v51, v80, v51
v_cvt_pk_bf16_f32 v49, v50, v51
v_mul_f32 v52, v80, v52
v_mul_f32 v53, v80, v53
v_cvt_pk_bf16_f32 v50, v52, v53
v_mfma_f32_32x32x16_bf16 v[32:47], a[20:23], v[8:11], v[32:47]
s_waitcnt lgkmcnt(2)
ds_read_b128 v[24:27], v64 offset:9216
v_mul_f32 v54, v80, v54
v_mul_f32 v55, v80, v55
v_cvt_pk_bf16_f32 v51, v54, v55
v_mul_f32 v56, v80, v56
v_mul_f32 v57, v80, v57
v_cvt_pk_bf16_f32 v52, v56, v57
v_mfma_f32_32x32x16_bf16 v[32:47], a[24:27], v[12:15], v[32:47]
s_waitcnt lgkmcnt(2)
ds_read_b128 v[8:11], v64 offset:10240
v_mul_f32 v58, v80, v58
v_mul_f32 v59, v80, v59
v_cvt_pk_bf16_f32 v53, v58, v59
v_mul_f32 v60, v80, v60
v_mul_f32 v61, v80, v61
v_cvt_pk_bf16_f32 v54, v60, v61
v_mfma_f32_32x32x16_bf16 v[32:47], a[28:31], v[16:19], v[32:47]
s_waitcnt lgkmcnt(2)
ds_read_b128 v[12:15], v64 offset:11264
v_mul_f32 v62, v80, v62
v_mul_f32 v63, v80, v63
v_cvt_pk_bf16_f32 v55, v62, v63
buffer_store_dwordx4 v[48:51], v1, s[4:7], s48 offen offset:0 sc1
v_mfma_f32_32x32x16_bf16 v[32:47], a[32:35], v[20:23], v[32:47]
s_waitcnt lgkmcnt(2)
ds_read_b128 v[16:19], v64 offset:12288
buffer_store_dwordx4 v[52:55], v1, s[4:7], s48 offen offset:512 sc1
s_add_u32 s48, s48, s49
v_mfma_f32_32x32x16_bf16 v[32:47], a[36:39], v[24:27], v[32:47]
s_waitcnt lgkmcnt(2)
ds_read_b128 v[20:23], v64 offset:13312
ds_read_b128 v[72:75], v5
v_mov_b32 v4, 0
ds_read_b128 v[76:79], v5 offset:1024
v_mfma_f32_32x32x16_bf16 v[32:47], a[40:43], v[8:11], v[32:47]
s_waitcnt lgkmcnt(4)
ds_read_b128 v[24:27], v64 offset:14336
s_waitcnt lgkmcnt(2)
v_and_b32 v72, v3, v72
v_dot2c_f32_bf16 v4, v72, v72
v_dot2c_f32_bf16 v4, v73, v73
v_dot2c_f32_bf16 v4, v74, v74
v_dot2c_f32_bf16 v4, v75, v75
v_mfma_f32_32x32x16_bf16 v[32:47], a[44:47], v[12:15], v[32:47]
ds_read_b128 v[8:11], v64 offset:15360
ds_read_b128 v[72:75], v5 offset:2048
s_waitcnt lgkmcnt(3)
v_dot2c_f32_bf16 v4, v76, v76
v_dot2c_f32_bf16 v4, v77, v77
v_dot2c_f32_bf16 v4, v78, v78
v_dot2c_f32_bf16 v4, v79, v79
v_mfma_f32_32x32x16_bf16 v[32:47], a[48:51], v[16:19], v[32:47]
ds_read_b128 v[12:15], v64 offset:16384
ds_read_b128 v[76:79], v5 offset:3072
s_waitcnt lgkmcnt(2)
v_dot2c_f32_bf16 v4, v72, v72
v_dot2c_f32_bf16 v4, v73, v73
v_dot2c_f32_bf16 v4, v74, v74
v_dot2c_f32_bf16 v4, v75, v75
v_mfma_f32_32x32x16_bf16 v[32:47], a[52:55], v[20:23], v[32:47]
ds_read_b128 v[16:19], v64 offset:17408
ds_read_b128 v[72:75], v5 offset:4096
s_waitcnt lgkmcnt(2)
v_dot2c_f32_bf16 v4, v76, v76
v_dot2c_f32_bf16 v4, v77, v77
v_dot2c_f32_bf16 v4, v78, v78
v_dot2c_f32_bf16 v4, v79, v79
v_mfma_f32_32x32x16_bf16 v[32:47], a[56:59], v[24:27], v[32:47]
ds_read_b128 v[20:23], v64 offset:18432
ds_read_b128 v[76:79], v5 offset:5120
s_waitcnt lgkmcnt(2)
v_dot2c_f32_bf16 v4, v72, v72
v_dot2c_f32_bf16 v4, v73, v73
v_dot2c_f32_bf16 v4, v74, v74
v_dot2c_f32_bf16 v4, v75, v75
v_mfma_f32_32x32x16_bf16 v[32:47], a[60:63], v[8:11], v[32:47]
ds_read_b128 v[24:27], v64 offset:19456
ds_read_b128 v[72:75], v5 offset:6144
s_waitcnt lgkmcnt(2)
v_dot2c_f32_bf16 v4, v76, v76
v_dot2c_f32_bf16 v4, v77, v77
v_dot2c_f32_bf16 v4, v78, v78
v_dot2c_f32_bf16 v4, v79, v79
v_mfma_f32_32x32x16_bf16 v[32:47], a[64:67], v[12:15], v[32:47]
ds_read_b128 v[8:11], v64 offset:20480
ds_read_b128 v[76:79], v5 offset:7168
s_waitcnt lgkmcnt(2)
v_dot2c_f32_bf16 v4, v72, v72
v_dot2c_f32_bf16 v4, v73, v73
v_dot2c_f32_bf16 v4, v74, v74
v_dot2c_f32_bf16 v4, v75, v75
v_mfma_f32_32x32x16_bf16 v[32:47], a[68:71], v[16:19], v[32:47]
ds_read_b128 v[12:15], v64 offset:21504
ds_read_b128 v[72:75], v5 offset:8192
s_waitcnt lgkmcnt(2)
v_dot2c_f32_bf16 v4, v76, v76
v_dot2c_f32_bf16 v4, v77, v77
v_dot2c_f32_bf16 v4, v78, v78
v_dot2c_f32_bf16 v4, v79, v79
v_mfma_f32_32x32x16_bf16 v[32:47], a[72:75], v[20:23], v[32:47]
ds_read_b128 v[16:19], v64 offset:22528
ds_read_b128 v[76:79], v5 offset:9216
s_waitcnt lgkmcnt(2)
v_dot2c_f32_bf16 v4, v72, v72
v_dot2c_f32_bf16 v4, v73, v73
v_dot2c_f32_bf16 v4, v74, v74
v_dot2c_f32_bf16 v4, v75, v75
v_mfma_f32_32x32x16_bf16 v[32:47], a[76:79], v[24:27], v[32:47]
ds_read_b128 v[20:23], v64 offset:23552
s_waitcnt lgkmcnt(1)
v_dot2c_f32_bf16 v4, v76, v76
v_dot2c_f32_bf16 v4, v77, v77
v_dot2c_f32_bf16 v4, v78, v78
v_dot2c_f32_bf16 v4, v79, v79
s_nop 2
ds_write_b32 v6, v4 offset:0
v_mfma_f32_32x32x16_bf16 v[32:47], a[80:83], v[8:11], v[32:47]
ds_read_b128 v[24:27], v64 offset:24576
s_add_u32 m0, s45, 0
s_add_u32 s55, s46, 0
buffer_load_dwordx4 v0, s[4:7], s55 offen offset:0 sc1 lds
buffer_load_dwordx4 v0, s[4:7], s55 offen offset:1024 sc1 lds
v_mfma_f32_32x32x16_bf16 v[32:47], a[84:87], v[12:15], v[32:47]
ds_read_b128 v[8:11], v64 offset:25600
buffer_load_dwordx4 v0, s[4:7], s55 offen offset:2048 sc1 lds
buffer_load_dwordx4 v0, s[4:7], s55 offen offset:3072 sc1 lds
v_mfma_f32_32x32x16_bf16 v[32:47], a[88:91], v[16:19], v[32:47]
s_waitcnt lgkmcnt(3)
ds_read_b128 v[12:15], v64 offset:26624
s_add_u32 m0, s45, 4096
s_add_u32 s55, s46, 4096
buffer_load_dwordx4 v0, s[4:7], s55 offen offset:0 sc1 lds
buffer_load_dwordx4 v0, s[4:7], s55 offen offset:1024 sc1 lds
v_mfma_f32_32x32x16_bf16 v[32:47], a[92:95], v[20:23], v[32:47]
s_waitcnt lgkmcnt(2)
ds_read_b128 v[16:19], v64 offset:27648
buffer_load_dwordx4 v0, s[4:7], s55 offen offset:2048 sc1 lds
buffer_load_dwordx4 v0, s[4:7], s55 offen offset:3072 sc1 lds
v_mfma_f32_32x32x16_bf16 v[32:47], a[96:99], v[24:27], v[32:47]
s_waitcnt lgkmcnt(2)
ds_read_b128 v[20:23], v64 offset:28672
s_add_u32 m0, s45, 8192
s_add_u32 s55, s46, 8192
buffer_load_dwordx4 v0, s[4:7], s55 offen offset:0 sc1 lds
buffer_load_dwordx4 v0, s[4:7], s55 offen offset:1024 sc1 lds
v_mfma_f32_32x32x16_bf16 v[32:47], a[100:103], v[8:11], v[32:47]
s_waitcnt lgkmcnt(2)
ds_read_b128 v[24:27], v64 offset:29696
s_add_u32 s45, s45, 40960
s_cmp_ge_u32 s45, 122880
s_cselect_b32 s55, 122880, 0
s_sub_u32 s45, s45, s55
s_add_u32 s46, s46, 40960
v_mfma_f32_32x32x16_bf16 v[32:47], a[104:107], v[12:15], v[32:47]
s_waitcnt lgkmcnt(2)
ds_read_b128 v[8:11], v64 offset:30720
v_mfma_f32_32x32x16_bf16 v[32:47], a[108:111], v[16:19], v[32:47]
s_waitcnt lgkmcnt(2)
ds_read_b128 v[12:15], v64 offset:31744
v_mfma_f32_32x32x16_bf16 v[32:47], a[112:115], v[20:23], v[32:47]
s_waitcnt lgkmcnt(2)
ds_read_b128 v[16:19], v64 offset:32768
v_mfma_f32_32x32x16_bf16 v[32:47], a[116:119], v[24:27], v[32:47]
s_waitcnt lgkmcnt(2)
ds_read_b128 v[20:23], v64 offset:33792
v_mfma_f32_32x32x16_bf16 v[32:47], a[120:123], v[8:11], v[32:47]
s_waitcnt lgkmcnt(2)
ds_read_b128 v[24:27], v64 offset:34816
v_mfma_f32_32x32x16_bf16 v[32:47], a[124:127], v[12:15], v[32:47]
s_waitcnt lgkmcnt(2)
ds_read_b128 v[8:11], v64 offset:35840
v_mfma_f32_32x32x16_bf16 v[32:47], a[128:131], v[16:19], v[32:47]
s_waitcnt lgkmcnt(2)
ds_read_b128 v[12:15], v64 offset:36864
v_mfma_f32_32x32x16_bf16 v[32:47], a[132:135], v[20:23], v[32:47]
s_waitcnt lgkmcnt(2)
ds_read_b128 v[16:19], v64 offset:37888
v_mfma_f32_32x32x16_bf16 v[32:47], a[136:139], v[24:27], v[32:47]
s_waitcnt lgkmcnt(2)
ds_read_b128 v[20:23], v64 offset:38912
v_mfma_f32_32x32x16_bf16 v[32:47], a[140:143], v[8:11], v[32:47]
s_waitcnt lgkmcnt(2)
ds_read_b128 v[24:27], v64 offset:39936
v_mfma_f32_32x32x16_bf16 v[32:47], a[144:147], v[12:15], v[32:47]
s_add_u32 s44, s44, 1
s_cmp_eq_u32 s44, 3
s_mov_b32 s56, 40960
s_cmov_b32 s56, -81920
s_cselect_b32 s44, 0, s44
v_add_u32 v64, s56, v64
v_add_u32 v5, s56, v5
s_waitcnt vmcnt(10) lgkmcnt(2)
s_barrier
s_add_u32 s50, s50, 1
v_mov_b32 v4, s50
buffer_store_dword v4, v2, s[4:7], s60 offen sc1
ds_read_b128 v[8:11], v64 offset:0
v_mfma_f32_32x32x16_bf16 v[32:47], a[148:151], v[16:19], v[32:47]
s_waitcnt lgkmcnt(2)
ds_read_b128 v[12:15], v64 offset:1024
v_mfma_f32_32x32x16_bf16 v[32:47], a[152:155], v[20:23], v[32:47]
s_waitcnt lgkmcnt(2)
ds_read_b128 v[16:19], v64 offset:2048
v_mfma_f32_32x32x16_bf16 v[32:47], a[156:159], v[24:27], v[32:47]
s_waitcnt lgkmcnt(2)
ds_read_b128 v[20:23], v64 offset:3072
s_branch k_st_38
k_so_39:
ds_read_b128 v[80:83], v7 offset:1024
ds_read_b128 v[84:87], v7 offset:1040
v_mov_b32 v88, 0x3727c5ac
s_waitcnt lgkmcnt(0)
v_add_f32 v80, v80, v84
v_add_f32 v81, v81, v85
v_add_f32 v82, v82, v86
v_add_f32 v83, v83, v87
v_add_f32 v80, v80, v81
v_add_f32 v82, v82, v83
v_add_f32 v80, v80, v82
v_fma_f32 v80, v80, s61, v88
v_rsq_f32 v80, v80
s_nop 0
v_mul_f32 v48, v80, v48
v_mul_f32 v49, v80, v49
v_cvt_pk_bf16_f32 v48, v48, v49
v_mul_f32 v50, v80, v50
v_mul_f32 v51, v80, v51
v_cvt_pk_bf16_f32 v49, v50, v51
v_mul_f32 v52, v80, v52
v_mul_f32 v53, v80, v53
v_cvt_pk_bf16_f32 v50, v52, v53
v_mul_f32 v54, v80, v54
v_mul_f32 v55, v80, v55
v_cvt_pk_bf16_f32 v51, v54, v55
v_mul_f32 v56, v80, v56
v_mul_f32 v57, v80, v57
v_cvt_pk_bf16_f32 v52, v56, v57
v_mul_f32 v58, v80, v58
v_mul_f32 v59, v80, v59
v_cvt_pk_bf16_f32 v53, v58, v59
v_mul_f32 v60, v80, v60
v_mul_f32 v61, v80, v61
v_cvt_pk_bf16_f32 v54, v60, v61
v_mul_f32 v62, v80, v62
v_mul_f32 v63, v80, v63
v_cvt_pk_bf16_f32 v55, v62, v63
buffer_store_dwordx4 v[48:51], v1, s[4:7], s48 offen offset:0 sc1
buffer_store_dwordx4 v[52:55], v1, s[4:7], s48 offen offset:512 sc1
s_add_u32 s48, s48, s49
s_branch k_join_34
k_isv_33:
s_mul_i32 s45, s3, 10240
s_mov_b32 s44, 0
v_mov_b32 v64, v0
s_add_u32 m0, s45, 0
s_add_u32 s55, s46, 0
buffer_load_dwordx4 v0, s[4:7], s55 offen offset:0 sc1 lds
buffer_load_dwordx4 v0, s[4:7], s55 offen offset:1024 sc1 lds
buffer_load_dwordx4 v0, s[4:7], s55 offen offset:2048 sc1 lds
buffer_load_dwordx4 v0, s[4:7], s55 offen offset:3072 sc1 lds
s_add_u32 m0, s45, 4096
s_add_u32 s55, s46, 4096
buffer_load_dwordx4 v0, s[4:7], s55 offen offset:0 sc1 lds
buffer_load_dwordx4 v0, s[4:7], s55 offen offset:1024 sc1 lds
buffer_load_dwordx4 v0, s[4:7], s55 offen offset:2048 sc1 lds
buffer_load_dwordx4 v0, s[4:7], s55 offen offset:3072 sc1 lds
s_add_u32 m0, s45, 8192
s_add_u32 s55, s46, 8192
buffer_load_dwordx4 v0, s[4:7], s55 offen offset:0 sc1 lds
buffer_load_dwordx4 v0, s[4:7], s55 offen offset:1024 sc1 lds
s_add_u32 s45, s45, 40960
s_cmp_ge_u32 s45, 122880
s_cselect_b32 s55, 122880, 0
s_sub_u32 s45, s45, s55
s_add_u32 s46, s46, 40960
s_add_u32 m0, s45, 0
s_add_u32 s55, s46, 0
buffer_load_dwordx4 v0, s[4:7], s55 offen offset:0 sc1 lds
buffer_load_dwordx4 v0, s[4:7], s55 offen offset:1024 sc1 lds
buffer_load_dwordx4 v0, s[4:7], s55 offen offset:2048 sc1 lds
buffer_load_dwordx4 v0, s[4:7], s55 offen offset:3072 sc1 lds
s_add_u32 m0, s45, 4096
s_add_u32 s55, s46, 4096
buffer_load_dwordx4 v0, s[4:7], s55 offen offset:0 sc1 lds
buffer_load_dwordx4 v0, s[4:7], s55 offen offset:1024 sc1 lds
buffer_load_dwordx4 v0, s[4:7], s55 offen offset:2048 sc1 lds
buffer_load_dwordx4 v0, s[4:7], s55 offen offset:3072 sc1 lds
s_add_u32 m0, s45, 8192
s_add_u32 s55, s46, 8192
buffer_load_dwordx4 v0, s[4:7], s55 offen offset:0 sc1 lds
buffer_load_dwordx4 v0, s[4:7], s55 offen offset:1024 sc1 lds
s_add_u32 s45, s45, 40960
s_cmp_ge_u32 s45, 122880
s_cselect_b32 s55, 122880, 0
s_sub_u32 s45, s45, s55
s_add_u32 s46, s46, 40960
s_waitcnt vmcnt(10)
s_barrier
ds_read_b128 v[8:11], v64 offset:0
ds_read_b128 v[12:15], v64 offset:1024
ds_read_b128 v[16:19], v64 offset:2048
ds_read_b128 v[20:23], v64 offset:3072
s_mov_b32 s59, 32
s_waitcnt lgkmcnt(3)
v_mfma_f32_32x32x16_bf16 v[32:47], v[8:11], a[0:3], 0
s_waitcnt lgkmcnt(2)
ds_read_b128 v[24:27], v64 offset:4096
v_mfma_f32_32x32x16_bf16 v[32:47], v[12:15], a[4:7], v[32:47]
s_waitcnt lgkmcnt(2)
ds_read_b128 v[8:11], v64 offset:5120
ds_read_b128 v[72:75], v5
v_mov_b32 v4, 0
ds_read_b128 v[76:79], v5 offset:1024
v_mfma_f32_32x32x16_bf16 v[32:47], v[16:19], a[8:11], v[32:47]
s_waitcnt lgkmcnt(4)
ds_read_b128 v[12:15], v64 offset:6144
s_waitcnt lgkmcnt(2)
v_and_b32 v72, v3, v72
v_dot2c_f32_bf16 v4, v72, v72
v_dot2c_f32_bf16 v4, v73, v73
v_dot2c_f32_bf16 v4, v74, v74
v_dot2c_f32_bf16 v4, v75, v75
v_mfma_f32_32x32x16_bf16 v[32:47], v[20:23], a[12:15], v[32:47]
ds_read_b128 v[16:19], v64 offset:7168
ds_read_b128 v[72:75], v5 offset:2048
s_waitcnt lgkmcnt(3)
v_dot2c_f32_bf16 v4, v76, v76
v_dot2c_f32_bf16 v4, v77, v77
v_dot2c_f32_bf16 v4, v78, v78
v_dot2c_f32_bf16 v4, v79, v79
v_mfma_f32_32x32x16_bf16 v[32:47], v[24:27], a[16:19], v[32:47]
ds_read_b128 v[20:23], v64 offset:8192
ds_read_b128 v[76:79], v5 offset:3072
s_waitcnt lgkmcnt(2)
v_dot2c_f32_bf16 v4, v72, v72
v_dot2c_f32_bf16 v4, v73, v73
v_dot2c_f32_bf16 v4, v74, v74
v_dot2c_f32_bf16 v4, v75, v75
v_mfma_f32_32x32x16_bf16 v[32:47], v[8:11], a[20:23], v[32:47]
ds_read_b128 v[24:27], v64 offset:9216
ds_read_b128 v[72:75], v5 offset:4096
s_waitcnt lgkmcnt(2)
v_dot2c_f32_bf16 v4, v76, v76
v_dot2c_f32_bf16 v4, v77, v77
v_dot2c_f32_bf16 v4, v78, v78
v_dot2c_f32_bf16 v4, v79, v79
v_mfma_f32_32x32x16_bf16 v[32:47], v[12:15], a[24:27], v[32:47]
ds_read_b128 v[8:11], v64 offset:10240
ds_read_b128 v[76:79], v5 offset:5120
s_waitcnt lgkmcnt(2)
v_dot2c_f32_bf16 v4, v72, v72
v_dot2c_f32_bf16 v4, v73, v73
v_dot2c_f32_bf16 v4, v74, v74
v_dot2c_f32_bf16 v4, v75, v75
v_mfma_f32_32x32x16_bf16 v[32:47], v[16:19], a[28:31], v[32:47]
ds_read_b128 v[12:15], v64 offset:11264
ds_read_b128 v[72:75], v5 offset:6144
s_waitcnt lgkmcnt(2)
v_dot2c_f32_bf16 v4, v76, v76
v_dot2c_f32_bf16 v4, v77, v77
v_dot2c_f32_bf16 v4, v78, v78
v_dot2c_f32_bf16 v4, v79, v79
v_mfma_f32_32x32x16_bf16 v[32:47], v[20:23], a[32:35], v[32:47]
ds_read_b128 v[16:19], v64 offset:12288
ds_read_b128 v[76:79], v5 offset:7168
s_waitcnt lgkmcnt(2)
v_dot2c_f32_bf16 v4, v72, v72
v_dot2c_f32_bf16 v4, v73, v73
v_dot2c_f32_bf16 v4, v74, v74
v_dot2c_f32_bf16 v4, v75, v75
v_mfma_f32_32x32x16_bf16 v[32:47], v[24:27], a[36:39], v[32:47]
ds_read_b128 v[20:23], v64 offset:13312
ds_read_b128 v[72:75], v5 offset:8192
s_waitcnt lgkmcnt(2)
v_dot2c_f32_bf16 v4, v76, v76
v_dot2c_f32_bf16 v4, v77, v77
v_dot2c_f32_bf16 v4, v78, v78
v_dot2c_f32_bf16 v4, v79, v79
v_mfma_f32_32x32x16_bf16 v[32:47], v[8:11], a[40:43], v[32:47]
ds_read_b128 v[24:27], v64 offset:14336
ds_read_b128 v[76:79], v5 offset:9216
s_waitcnt lgkmcnt(2)
v_dot2c_f32_bf16 v4, v72, v72
v_dot2c_f32_bf16 v4, v73, v73
v_dot2c_f32_bf16 v4, v74, v74
v_dot2c_f32_bf16 v4, v75, v75
v_mfma_f32_32x32x16_bf16 v[32:47], v[12:15], a[44:47], v[32:47]
ds_read_b128 v[8:11], v64 offset:15360
s_waitcnt lgkmcnt(1)
v_dot2c_f32_bf16 v4, v76, v76
v_dot2c_f32_bf16 v4, v77, v77
v_dot2c_f32_bf16 v4, v78, v78
v_dot2c_f32_bf16 v4, v79, v79
s_nop 2
ds_write_b32 v6, v4 offset:0
v_mfma_f32_32x32x16_bf16 v[32:47], v[16:19], a[48:51], v[32:47]
ds_read_b128 v[12:15], v64 offset:16384
s_add_u32 m0, s45, 0
s_add_u32 s55, s46, 0
buffer_load_dwordx4 v0, s[4:7], s55 offen offset:0 sc1 lds
buffer_load_dwordx4 v0, s[4:7], s55 offen offset:1024 sc1 lds
v_mfma_f32_32x32x16_bf16 v[32:47], v[20:23], a[52:55], v[32:47]
ds_read_b128 v[16:19], v64 offset:17408
buffer_load_dwordx4 v0, s[4:7], s55 offen offset:2048 sc1 lds
buffer_load_dwordx4 v0, s[4:7], s55 offen offset:3072 sc1 lds
v_mfma_f32_32x32x16_bf16 v[32:47], v[24:27], a[56:59], v[32:47]
s_waitcnt lgkmcnt(3)
ds_read_b128 v[20:23], v64 offset:18432
s_add_u32 m0, s45, 4096
s_add_u32 s55, s46, 4096
buffer_load_dwordx4 v0, s[4:7], s55 offen offset:0 sc1 lds
buffer_load_dwordx4 v0, s[4:7], s55 offen offset:1024 sc1 lds
v_mfma_f32_32x32x16_bf16 v[32:47], v[8:11], a[60:63], v[32:47]
s_waitcnt lgkmcnt(2)
ds_read_b128 v[24:27], v64 offset:19456
buffer_load_dwordx4 v0, s[4:7], s55 offen offset:2048 sc1 lds
buffer_load_dwordx4 v0, s[4:7], s55 offen offset:3072 sc1 lds
v_mfma_f32_32x32x16_bf16 v[32:47], v[12:15], a[64:67], v[32:47]
s_waitcnt lgkmcnt(2)
ds_read_b128 v[8:11], v64 offset:20480
s_add_u32 m0, s45, 8192
s_add_u32 s55, s46, 8192
buffer_load_dwordx4 v0, s[4:7], s55 offen offset:0 sc1 lds
buffer_load_dwordx4 v0, s[4:7], s55 offen offset:1024 sc1 lds
v_mfma_f32_32x32x16_bf16 v[32:47], v[16:19], a[68:71], v[32:47]
s_waitcnt lgkmcnt(2)
ds_read_b128 v[12:15], v64 offset:21504
s_add_u32 s45, s45, 40960
s_cmp_ge_u32 s45, 122880
s_cselect_b32 s55, 122880, 0
s_sub_u32 s45, s45, s55
s_add_u32 s46, s46, 40960
v_mfma_f32_32x32x16_bf16 v[32:47], v[20:23], a[72:75], v[32:47]
s_waitcnt lgkmcnt(2)
ds_read_b128 v[16:19], v64 offset:22528
v_mfma_f32_32x32x16_bf16 v[32:47], v[24:27], a[76:79], v[32:47]
s_waitcnt lgkmcnt(2)
ds_read_b128 v[20:23], v64 offset:23552
v_mfma_f32_32x32x16_bf16 v[32:47], v[8:11], a[80:83], v[32:47]
s_waitcnt lgkmcnt(2)
ds_read_b128 v[24:27], v64 offset:24576
v_mfma_f32_32x32x16_bf16 v[32:47], v[12:15], a[84:87], v[32:47]
s_waitcnt lgkmcnt(2)
ds_read_b128 v[8:11], v64 offset:25600
v_mfma_f32_32x32x16_bf16 v[32:47], v[16:19], a[88:91], v[32:47]
s_waitcnt lgkmcnt(2)
ds_read_b128 v[12:15], v64 offset:26624
v_mfma_f32_32x32x16_bf16 v[32:47], v[20:23], a[92:95], v[32:47]
s_waitcnt lgkmcnt(2)
ds_read_b128 v[16:19], v64 offset:27648
v_mfma_f32_32x32x16_bf16 v[32:47], v[24:27], a[96:99], v[32:47]
s_waitcnt lgkmcnt(2)
ds_read_b128 v[20:23], v64 offset:28672
v_mfma_f32_32x32x16_bf16 v[32:47], v[8:11], a[100:103], v[32:47]
s_waitcnt lgkmcnt(2)
ds_read_b128 v[24:27], v64 offset:29696
v_mfma_f32_32x32x16_bf16 v[32:47], v[12:15], a[104:107], v[32:47]
s_waitcnt lgkmcnt(2)
ds_read_b128 v[8:11], v64 offset:30720
v_mfma_f32_32x32x16_bf16 v[32:47], v[16:19], a[108:111], v[32:47]
s_waitcnt lgkmcnt(2)
ds_read_b128 v[12:15], v64 offset:31744
v_mfma_f32_32x32x16_bf16 v[32:47], v[20:23], a[112:115], v[32:47]
s_waitcnt lgkmcnt(2)
ds_read_b128 v[16:19], v64 offset:32768
v_mfma_f32_32x32x16_bf16 v[32:47], v[24:27], a[116:119], v[32:47]
s_waitcnt lgkmcnt(2)
ds_read_b128 v[20:23], v64 offset:33792
v_mfma_f32_32x32x16_bf16 v[32:47], v[8:11], a[120:123], v[32:47]
s_waitcnt lgkmcnt(2)
ds_read_b128 v[24:27], v64 offset:34816
v_mfma_f32_32x32x16_bf16 v[32:47], v[12:15], a[124:127], v[32:47]
s_waitcnt lgkmcnt(2)
ds_read_b128 v[8:11], v64 offset:35840
v_mfma_f32_32x32x16_bf16 v[32:47], v[16:19], a[128:131], v[32:47]
s_waitcnt lgkmcnt(2)
ds_read_b128 v[12:15], v64 offset:36864
v_mfma_f32_32x32x16_bf16 v[32:47], v[20:23], a[132:135], v[32:47]
s_waitcnt lgkmcnt(2)
ds_read_b128 v[16:19], v64 offset:37888
v_mfma_f32_32x32x16_bf16 v[32:47], v[24:27], a[136:139], v[32:47]
s_waitcnt lgkmcnt(2)
ds_read_b128 v[20:23], v64 offset:38912
v_mfma_f32_32x32x16_bf16 v[32:47], v[8:11], a[140:143], v[32:47]
s_waitcnt lgkmcnt(2)
ds_read_b128 v[24:27], v64 offset:39936
v_mfma_f32_32x32x16_bf16 v[32:47], v[12:15], a[144:147], v[32:47]
s_add_u32 s44, s44, 1
s_cmp_eq_u32 s44, 3
s_mov_b32 s56, 40960
s_cmov_b32 s56, -81920
s_cselect_b32 s44, 0, s44
v_add_u32 v64, s56, v64
v_add_u32 v5, s56, v5
s_waitcnt vmcnt(10) lgkmcnt(2)
s_barrier
ds_read_b128 v[8:11], v64 offset:0
v_mfma_f32_32x32x16_bf16 v[32:47], v[16:19], a[148:151], v[32:47]
s_waitcnt lgkmcnt(2)
ds_read_b128 v[12:15], v64 offset:1024
v_mfma_f32_32x32x16_bf16 v[32:47], v[20:23], a[152:155], v[32:47]
s_waitcnt lgkmcnt(2)
ds_read_b128 v[16:19], v64 offset:2048
v_mfma_f32_32x32x16_bf16 v[32:47], v[24:27], a[156:159], v[32:47]
s_waitcnt lgkmcnt(2)
ds_read_b128 v[20:23], v64 offset:3072
ds_read_b128 v[80:83], v7 offset:0
ds_read_b128 v[84:87], v7 offset:16
v_mov_b32 v88, 0x3727c5ac
s_waitcnt lgkmcnt(0)
v_add_f32 v80, v80, v84
v_add_f32 v81, v81, v85
v_add_f32 v82, v82, v86
v_add_f32 v83, v83, v87
v_add_f32 v80, v80, v81
v_add_f32 v82, v82, v83
v_add_f32 v80, v80, v82
v_fma_f32 v80, v80, s61, v88
v_rsq_f32 v80, v80
ds_write_b32 v28, v80
ds_read_b128 v[80:83], v29 offset:0
ds_read_b128 v[84:87], v29 offset:32
ds_read_b128 v[88:91], v29 offset:64
ds_read_b128 v[92:95], v29 offset:96
s_waitcnt lgkmcnt(3)
v_mul_f32 v80, v80, v32
v_mul_f32 v81, v81, v33
v_mul_f32 v82, v82, v34
v_mul_f32 v83, v83, v35
s_waitcnt lgkmcnt(2)
v_mul_f32 v84, v84, v36
v_mul_f32 v85, v85, v37
v_mul_f32 v86, v86, v38
v_mul_f32 v87, v87, v39
s_waitcnt lgkmcnt(1)
v_mul_f32 v88, v88, v40
v_mul_f32 v89, v89, v41
v_mul_f32 v90, v90, v42
v_mul_f32 v91, v91, v43
s_waitcnt lgkmcnt(0)
v_mul_f32 v92, v92, v44
v_mul_f32 v93, v93, v45
v_mul_f32 v94, v94, v46
v_mul_f32 v95, v95, v47
v_cvt_pk_bf16_f32 v32, v80, v81
v_cvt_pk_bf16_f32 v33, v82, v83
v_cvt_pk_bf16_f32 v36, v84, v85
v_cvt_pk_bf16_f32 v37, v86, v87
v_cvt_pk_bf16_f32 v34, v88, v89
v_cvt_pk_bf16_f32 v35, v90, v91
v_cvt_pk_bf16_f32 v38, v92, v93
v_cvt_pk_bf16_f32 v39, v94, v95
buffer_store_dwordx4 v[32:35], v1, s[4:7], s48 offen offset:2048 sc1
buffer_store_dwordx4 v[36:39], v1, s[4:7], s48 offen offset:2560 sc1
s_add_u32 s48, s48, s49
s_waitcnt vmcnt(0)
s_barrier
s_add_u32 s50, s50, 1
v_mov_b32 v4, s50
buffer_store_dword v4, v2, s[4:7], s60 offen sc1
v_mfma_f32_32x32x16_bf16 v[48:63], v[8:11], a[0:3], 0
ds_read_b128 v[24:27], v64 offset:4096
v_mfma_f32_32x32x16_bf16 v[48:63], v[12:15], a[4:7], v[48:63]
ds_read_b128 v[8:11], v64 offset:5120
ds_read_b128 v[72:75], v5
v_mov_b32 v4, 0
ds_read_b128 v[76:79], v5 offset:1024
v_mfma_f32_32x32x16_bf16 v[48:63], v[16:19], a[8:11], v[48:63]
ds_read_b128 v[12:15], v64 offset:6144
s_waitcnt lgkmcnt(2)
v_and_b32 v72, v3, v72
v_dot2c_f32_bf16 v4, v72, v72
v_dot2c_f32_bf16 v4, v73, v73
v_dot2c_f32_bf16 v4, v74, v74
v_dot2c_f32_bf16 v4, v75, v75
v_mfma_f32_32x32x16_bf16 v[48:63], v[20:23], a[12:15], v[48:63]
ds_read_b128 v[16:19], v64 offset:7168
ds_read_b128 v[72:75], v5 offset:2048
s_waitcnt lgkmcnt(3)
v_dot2c_f32_bf16 v4, v76, v76
v_dot2c_f32_bf16 v4, v77, v77
v_dot2c_f32_bf16 v4, v78, v78
v_dot2c_f32_bf16 v4, v79, v79
v_mfma_f32_32x32x16_bf16 v[48:63], v[24:27], a[16:19], v[48:63]
ds_read_b128 v[20:23], v64 offset:8192
ds_read_b128 v[76:79], v5 offset:3072
s_waitcnt lgkmcnt(2)
v_dot2c_f32_bf16 v4, v72, v72
v_dot2c_f32_bf16 v4, v73, v73
v_dot2c_f32_bf16 v4, v74, v74
v_dot2c_f32_bf16 v4, v75, v75
v_mfma_f32_32x32x16_bf16 v[48:63], v[8:11], a[20:23], v[48:63]
ds_read_b128 v[24:27], v64 offset:9216
ds_read_b128 v[72:75], v5 offset:4096
s_waitcnt lgkmcnt(2)
v_dot2c_f32_bf16 v4, v76, v76
v_dot2c_f32_bf16 v4, v77, v77
v_dot2c_f32_bf16 v4, v78, v78
v_dot2c_f32_bf16 v4, v79, v79
v_mfma_f32_32x32x16_bf16 v[48:63], v[12:15], a[24:27], v[48:63]
ds_read_b128 v[8:11], v64 offset:10240
ds_read_b128 v[76:79], v5 offset:5120
s_waitcnt lgkmcnt(2)
v_dot2c_f32_bf16 v4, v72, v72
v_dot2c_f32_bf16 v4, v73, v73
v_dot2c_f32_bf16 v4, v74, v74
v_dot2c_f32_bf16 v4, v75, v75
v_mfma_f32_32x32x16_bf16 v[48:63], v[16:19], a[28:31], v[48:63]
ds_read_b128 v[12:15], v64 offset:11264
ds_read_b128 v[72:75], v5 offset:6144
s_waitcnt lgkmcnt(2)
v_dot2c_f32_bf16 v4, v76, v76
v_dot2c_f32_bf16 v4, v77, v77
v_dot2c_f32_bf16 v4, v78, v78
v_dot2c_f32_bf16 v4, v79, v79
v_mfma_f32_32x32x16_bf16 v[48:63], v[20:23], a[32:35], v[48:63]
ds_read_b128 v[16:19], v64 offset:12288
ds_read_b128 v[76:79], v5 offset:7168
s_waitcnt lgkmcnt(2)
v_dot2c_f32_bf16 v4, v72, v72
v_dot2c_f32_bf16 v4, v73, v73
v_dot2c_f32_bf16 v4, v74, v74
v_dot2c_f32_bf16 v4, v75, v75
v_mfma_f32_32x32x16_bf16 v[48:63], v[24:27], a[36:39], v[48:63]
ds_read_b128 v[20:23], v64 offset:13312
ds_read_b128 v[72:75], v5 offset:8192
s_waitcnt lgkmcnt(2)
v_dot2c_f32_bf16 v4, v76, v76
v_dot2c_f32_bf16 v4, v77, v77
v_dot2c_f32_bf16 v4, v78, v78
v_dot2c_f32_bf16 v4, v79, v79
v_mfma_f32_32x32x16_bf16 v[48:63], v[8:11], a[40:43], v[48:63]
ds_read_b128 v[24:27], v64 offset:14336
ds_read_b128 v[76:79], v5 offset:9216
s_waitcnt lgkmcnt(2)
v_dot2c_f32_bf16 v4, v72, v72
v_dot2c_f32_bf16 v4, v73, v73
v_dot2c_f32_bf16 v4, v74, v74
v_dot2c_f32_bf16 v4, v75, v75
v_mfma_f32_32x32x16_bf16 v[48:63], v[12:15], a[44:47], v[48:63]
ds_read_b128 v[8:11], v64 offset:15360
s_waitcnt lgkmcnt(1)
v_dot2c_f32_bf16 v4, v76, v76
v_dot2c_f32_bf16 v4, v77, v77
v_dot2c_f32_bf16 v4, v78, v78
v_dot2c_f32_bf16 v4, v79, v79
s_nop 2
ds_write_b32 v6, v4 offset:1024
v_mfma_f32_32x32x16_bf16 v[48:63], v[16:19], a[48:51], v[48:63]
ds_read_b128 v[12:15], v64 offset:16384
s_add_u32 m0, s45, 0
s_add_u32 s55, s46, 0
buffer_load_dwordx4 v0, s[4:7], s55 offen offset:0 sc1 lds
buffer_load_dwordx4 v0, s[4:7], s55 offen offset:1024 sc1 lds
v_mfma_f32_32x32x16_bf16 v[48:63], v[20:23], a[52:55], v[48:63]
ds_read_b128 v[16:19], v64 offset:17408
buffer_load_dwordx4 v0, s[4:7], s55 offen offset:2048 sc1 lds
buffer_load_dwordx4 v0, s[4:7], s55 offen offset:3072 sc1 lds
v_mfma_f32_32x32x16_bf16 v[48:63], v[24:27], a[56:59], v[48:63]
s_waitcnt lgkmcnt(3)
ds_read_b128 v[20:23], v64 offset:18432
s_add_u32 m0, s45, 4096
s_add_u32 s55, s46, 4096
buffer_load_dwordx4 v0, s[4:7], s55 offen offset:0 sc1 lds
buffer_load_dwordx4 v0, s[4:7], s55 offen offset:1024 sc1 lds
v_mfma_f32_32x32x16_bf16 v[48:63], v[8:11], a[60:63], v[48:63]
s_waitcnt lgkmcnt(2)
ds_read_b128 v[24:27], v64 offset:19456
buffer_load_dwordx4 v0, s[4:7], s55 offen offset:2048 sc1 lds
buffer_load_dwordx4 v0, s[4:7], s55 offen offset:3072 sc1 lds
v_mfma_f32_32x32x16_bf16 v[48:63], v[12:15], a[64:67], v[48:63]
s_waitcnt lgkmcnt(2)
ds_read_b128 v[8:11], v64 offset:20480
s_add_u32 m0, s45, 8192
s_add_u32 s55, s46, 8192
buffer_load_dwordx4 v0, s[4:7], s55 offen offset:0 sc1 lds
buffer_load_dwordx4 v0, s[4:7], s55 offen offset:1024 sc1 lds
v_mfma_f32_32x32x16_bf16 v[48:63], v[16:19], a[68:71], v[48:63]
s_waitcnt lgkmcnt(2)
ds_read_b128 v[12:15], v64 offset:21504
s_add_u32 s45, s45, 40960
s_cmp_ge_u32 s45, 122880
s_cselect_b32 s55, 122880, 0
s_sub_u32 s45, s45, s55
s_add_u32 s46, s46, 40960
v_mfma_f32_32x32x16_bf16 v[48:63], v[20:23], a[72:75], v[48:63]
s_waitcnt lgkmcnt(2)
ds_read_b128 v[16:19], v64 offset:22528
v_mfma_f32_32x32x16_bf16 v[48:63], v[24:27], a[76:79], v[48:63]
s_waitcnt lgkmcnt(2)
ds_read_b128 v[20:23], v64 offset:23552
v_mfma_f32_32x32x16_bf16 v[48:63], v[8:11], a[80:83], v[48:63]
s_waitcnt lgkmcnt(2)
ds_read_b128 v[24:27], v64 offset:24576
v_mfma_f32_32x32x16_bf16 v[48:63], v[12:15], a[84:87], v[48:63]
s_waitcnt lgkmcnt(2)
ds_read_b128 v[8:11], v64 offset:25600
v_mfma_f32_32x32x16_bf16 v[48:63], v[16:19], a[88:91], v[48:63]
s_waitcnt lgkmcnt(2)
ds_read_b128 v[12:15], v64 offset:26624
v_mfma_f32_32x32x16_bf16 v[48:63], v[20:23], a[92:95], v[48:63]
s_waitcnt lgkmcnt(2)
ds_read_b128 v[16:19], v64 offset:27648
v_mfma_f32_32x32x16_bf16 v[48:63], v[24:27], a[96:99], v[48:63]
s_waitcnt lgkmcnt(2)
ds_read_b128 v[20:23], v64 offset:28672
v_mfma_f32_32x32x16_bf16 v[48:63], v[8:11], a[100:103], v[48:63]
s_waitcnt lgkmcnt(2)
ds_read_b128 v[24:27], v64 offset:29696
v_mfma_f32_32x32x16_bf16 v[48:63], v[12:15], a[104:107], v[48:63]
s_waitcnt lgkmcnt(2)
ds_read_b128 v[8:11], v64 offset:30720
v_mfma_f32_32x32x16_bf16 v[48:63], v[16:19], a[108:111], v[48:63]
s_waitcnt lgkmcnt(2)
ds_read_b128 v[12:15], v64 offset:31744
v_mfma_f32_32x32x16_bf16 v[48:63], v[20:23], a[112:115], v[48:63]
s_waitcnt lgkmcnt(2)
ds_read_b128 v[16:19], v64 offset:32768
v_mfma_f32_32x32x16_bf16 v[48:63], v[24:27], a[116:119], v[48:63]
s_waitcnt lgkmcnt(2)
ds_read_b128 v[20:23], v64 offset:33792
v_mfma_f32_32x32x16_bf16 v[48:63], v[8:11], a[120:123], v[48:63]
s_waitcnt lgkmcnt(2)
ds_read_b128 v[24:27], v64 offset:34816
v_mfma_f32_32x32x16_bf16 v[48:63], v[12:15], a[124:127], v[48:63]
s_waitcnt lgkmcnt(2)
ds_read_b128 v[8:11], v64 offset:35840
v_mfma_f32_32x32x16_bf16 v[48:63], v[16:19], a[128:131], v[48:63]
s_waitcnt lgkmcnt(2)
ds_read_b128 v[12:15], v64 offset:36864
v_mfma_f32_32x32x16_bf16 v[48:63], v[20:23], a[132:135], v[48:63]
s_waitcnt lgkmcnt(2)
ds_read_b128 v[16:19], v64 offset:37888
v_mfma_f32_32x32x16_bf16 v[48:63], v[24:27], a[136:139], v[48:63]
s_waitcnt lgkmcnt(2)
ds_read_b128 v[20:23], v64 offset:38912
v_mfma_f32_32x32x16_bf16 v[48:63], v[8:11], a[140:143], v[48:63]
s_waitcnt lgkmcnt(2)
ds_read_b128 v[24:27], v64 offset:39936
v_mfma_f32_32x32x16_bf16 v[48:63], v[12:15], a[144:147], v[48:63]
s_add_u32 s44, s44, 1
s_cmp_eq_u32 s44, 3
s_mov_b32 s56, 40960
s_cmov_b32 s56, -81920
s_cselect_b32 s44, 0, s44
v_add_u32 v64, s56, v64
v_add_u32 v5, s56, v5
s_waitcnt vmcnt(10) lgkmcnt(2)
s_barrier
ds_read_b128 v[8:11], v64 offset:0
v_mfma_f32_32x32x16_bf16 v[48:63], v[16:19], a[148:151], v[48:63]
s_waitcnt lgkmcnt(2)
ds_read_b128 v[12:15], v64 offset:1024
v_mfma_f32_32x32x16_bf16 v[48:63], v[20:23], a[152:155], v[48:63]
s_waitcnt lgkmcnt(2)
ds_read_b128 v[16:19], v64 offset:2048
v_mfma_f32_32x32x16_bf16 v[48:63], v[24:27], a[156:159], v[48:63]
s_waitcnt lgkmcnt(2)
ds_read_b128 v[20:23], v64 offset:3072
s_branch k_sm_43
k_st_41:
v_mfma_f32_32x32x16_bf16 v[48:63], v[8:11], a[0:3], 0
s_waitcnt lgkmcnt(2)
ds_read_b128 v[24:27], v64 offset:4096
v_mfma_f32_32x32x16_bf16 v[48:63], v[12:15], a[4:7], v[48:63]
s_waitcnt lgkmcnt(2)
ds_read_b128 v[8:11], v64 offset:5120
ds_read_b128 v[80:83], v7 offset:0
ds_read_b128 v[84:87], v7 offset:16
v_mov_b32 v88, 0x3727c5ac
v_mfma_f32_32x32x16_bf16 v[48:63], v[16:19], a[8:11], v[48:63]
s_waitcnt lgkmcnt(4)
ds_read_b128 v[12:15], v64 offset:6144
s_waitcnt lgkmcnt(1)
v_add_f32 v80, v80, v84
v_add_f32 v81, v81, v85
v_add_f32 v82, v82, v86
v_add_f32 v83, v83, v87
v_add_f32 v80, v80, v81
v_add_f32 v82, v82, v83
v_add_f32 v80, v80, v82
v_mfma_f32_32x32x16_bf16 v[48:63], v[20:23], a[12:15], v[48:63]
ds_read_b128 v[16:19], v64 offset:7168
v_fma_f32 v80, v80, s61, v88
v_rsq_f32 v80, v80
ds_write_b32 v28, v80
v_mfma_f32_32x32x16_bf16 v[48:63], v[24:27], a[16:19], v[48:63]
ds_read_b128 v[20:23], v64 offset:8192
ds_read_b128 v[80:83], v29 offset:0
ds_read_b128 v[84:87], v29 offset:32
ds_read_b128 v[88:91], v29 offset:64
ds_read_b128 v[92:95], v29 offset:96
v_mfma_f32_32x32x16_bf16 v[48:63], v[8:11], a[20:23], v[48:63]
s_waitcnt lgkmcnt(7)
ds_read_b128 v[24:27], v64 offset:9216
s_waitcnt lgkmcnt(4)
v_mul_f32 v80, v80, v32
v_mul_f32 v81, v81, v33
v_mul_f32 v82, v82, v34
v_mul_f32 v83, v83, v35
v_mfma_f32_32x32x16_bf16 v[48:63], v[12:15], a[24:27], v[48:63]
ds_read_b128 v[8:11], v64 offset:10240
s_waitcnt lgkmcnt(4)
v_mul_f32 v84, v84, v36
v_mul_f32 v85, v85, v37
v_mul_f32 v86, v86, v38
v_mul_f32 v87, v87, v39
v_mfma_f32_32x32x16_bf16 v[48:63], v[16:19], a[28:31], v[48:63]
ds_read_b128 v[12:15], v64 offset:11264
s_waitcnt lgkmcnt(4)
v_mul_f32 v88, v88, v40
v_mul_f32 v89, v89, v41
v_mul_f32 v90, v90, v42
v_mul_f32 v91, v91, v43
v_mfma_f32_32x32x16_bf16 v[48:63], v[20:23], a[32:35], v[48:63]
s_waitcnt lgkmcnt(2)
ds_read_b128 v[16:19], v64 offset:12288
v_mul_f32 v92, v92, v44
v_mul_f32 v93, v93, v45
v_mul_f32 v94, v94, v46
v_mul_f32 v95, v95, v47
v_mfma_f32_32x32x16_bf16 v[48:63], v[24:27], a[36:39], v[48:63]
s_waitcnt lgkmcnt(2)
ds_read_b128 v[20:23], v64 offset:13312
v_cvt_pk_bf16_f32 v32, v80, v81
v_cvt_pk_bf16_f32 v33, v82, v83
v_mfma_f32_32x32x16_bf16 v[48:63], v[8:11], a[40:43], v[48:63]
s_waitcnt lgkmcnt(2)
ds_read_b128 v[24:27], v64 offset:14336
v_cvt_pk_bf16_f32 v36, v84, v85
v_cvt_pk_bf16_f32 v37, v86, v87
v_mfma_f32_32x32x16_bf16 v[48:63], v[12:15], a[44:47], v[48:63]
s_waitcnt lgkmcnt(2)
ds_read_b128 v[8:11], v64 offset:15360
v_cvt_pk_bf16_f32 v34, v88, v89
v_cvt_pk_bf16_f32 v35, v90, v91
v_mfma_f32_32x32x16_bf16 v[48:63], v[16:19], a[48:51], v[48:63]
s_waitcnt lgkmcnt(2)
ds_read_b128 v[12:15], v64 offset:16384
v_cvt_pk_bf16_f32 v38, v92, v93
v_cvt_pk_bf16_f32 v39, v94, v95
v_mfma_f32_32x32x16_bf16 v[48:63], v[20:23], a[52:55], v[48:63]
s_waitcnt lgkmcnt(2)
ds_read_b128 v[16:19], v64 offset:17408
buffer_store_dwordx4 v[32:35], v1, s[4:7], s48 offen offset:2048 sc1
buffer_store_dwordx4 v[36:39], v1, s[4:7], s48 offen offset:2560 sc1
v_mfma_f32_32x32x16_bf16 v[48:63], v[24:27], a[56:59], v[48:63]
s_waitcnt lgkmcnt(2)
ds_read_b128 v[20:23], v64 offset:18432
s_add_u32 s48, s48, s49
ds_read_b128 v[72:75], v5
v_mov_b32 v4, 0
v_mfma_f32_32x32x16_bf16 v[48:63], v[8:11], a[60:63], v[48:63]
s_waitcnt lgkmcnt(3)
ds_read_b128 v[24:27], v64 offset:19456
ds_read_b128 v[76:79], v5 offset:1024
s_waitcnt lgkmcnt(2)
v_and_b32 v72, v3, v72
v_mfma_f32_32x32x16_bf16 v[48:63], v[12:15], a[64:67], v[48:63]
ds_read_b128 v[8:11], v64 offset:20480
v_dot2c_f32_bf16 v4, v72, v72
v_dot2c_f32_bf16 v4, v73, v73
v_dot2c_f32_bf16 v4, v74, v74
v_dot2c_f32_bf16 v4, v75, v75
ds_read_b128 v[72:75], v5 offset:2048
v_mfma_f32_32x32x16_bf16 v[48:63], v[16:19], a[68:71], v[48:63]
ds_read_b128 v[12:15], v64 offset:21504
s_waitcnt lgkmcnt(3)
v_dot2c_f32_bf16 v4, v76, v76
v_dot2c_f32_bf16 v4, v77, v77
v_dot2c_f32_bf16 v4, v78, v78
v_dot2c_f32_bf16 v4, v79, v79
ds_read_b128 v[76:79], v5 offset:3072
v_mfma_f32_32x32x16_bf16 v[48:63], v[20:23], a[72:75], v[48:63]
ds_read_b128 v[16:19], v64 offset:22528
s_waitcnt lgkmcnt(3)
v_dot2c_f32_bf16 v4, v72, v72
v_dot2c_f32_bf16 v4, v73, v73
v_dot2c_f32_bf16 v4, v74, v74
v_dot2c_f32_bf16 v4, v75, v75
ds_read_b128 v[72:75], v5 offset:4096
v_mfma_f32_32x32x16_bf16 v[48:63], v[24:27], a[76:79], v[48:63]
ds_read_b128 v[20:23], v64 offset:23552
s_waitcnt lgkmcnt(3)
v_dot2c_f32_bf16 v4, v76, v76
v_dot2c_f32_bf16 v4, v77, v77
v_dot2c_f32_bf16 v4, v78, v78
v_dot2c_f32_bf16 v4, v79, v79
ds_read_b128 v[76:79], v5 offset:5120
v_mfma_f32_32x32x16_bf16 v[48:63], v[8:11], a[80:83], v[48:63]
ds_read_b128 v[24:27], v64 offset:24576
s_waitcnt lgkmcnt(3)
v_dot2c_f32_bf16 v4, v72, v72
v_dot2c_f32_bf16 v4, v73, v73
v_dot2c_f32_bf16 v4, v74, v74
v_dot2c_f32_bf16 v4, v75, v75
ds_read_b128 v[72:75], v5 offset:6144
v_mfma_f32_32x32x16_bf16 v[48:63], v[12:15], a[84:87], v[48:63]
ds_read_b128 v[8:11], v64 offset:25600
s_waitcnt lgkmcnt(3)
v_dot2c_f32_bf16 v4, v76, v76
v_dot2c_f32_bf16 v4, v77, v77
v_dot2c_f32_bf16 v4, v78, v78
v_dot2c_f32_bf16 v4, v79, v79
ds_read_b128 v[76:79], v5 offset:7168
v_mfma_f32_32x32x16_bf16 v[48:63], v[16:19], a[88:91], v[48:63]
ds_read_b128 v[12:15], v64 offset:26624
s_waitcnt lgkmcnt(3)
v_dot2c_f32_bf16 v4, v72, v72
v_dot2c_f32_bf16 v4, v73, v73
v_dot2c_f32_bf16 v4, v74, v74
v_dot2c_f32_bf16 v4, v75, v75
ds_read_b128 v[72:75], v5 offset:8192
v_mfma_f32_32x32x16_bf16 v[48:63], v[20:23], a[92:95], v[48:63]
ds_read_b128 v[16:19], v64 offset:27648
s_waitcnt lgkmcnt(3)
v_dot2c_f32_bf16 v4, v76, v76
v_dot2c_f32_bf16 v4, v77, v77
v_dot2c_f32_bf16 v4, v78, v78
v_dot2c_f32_bf16 v4, v79, v79
ds_read_b128 v[76:79], v5 offset:9216
v_mfma_f32_32x32x16_bf16 v[48:63], v[24:27], a[96:99], v[48:63]
ds_read_b128 v[20:23], v64 offset:28672
s_waitcnt lgkmcnt(3)
v_dot2c_f32_bf16 v4, v72, v72
v_dot2c_f32_bf16 v4, v73, v73
v_dot2c_f32_bf16 v4, v74, v74
v_dot2c_f32_bf16 v4, v75, v75
s_waitcnt lgkmcnt(1)
v_dot2c_f32_bf16 v4, v76, v76
v_dot2c_f32_bf16 v4, v77, v77
v_dot2c_f32_bf16 v4, v78, v78
v_dot2c_f32_bf16 v4, v79, v79
v_mfma_f32_32x32x16_bf16 v[48:63], v[8:11], a[100:103], v[48:63]
ds_read_b128 v[24:27], v64 offset:29696
ds_write_b32 v6, v4 offset:1024
s_add_u32 m0, s45, 0
s_add_u32 s55, s46, 0
buffer_load_dwordx4 v0, s[4:7], s55 offen offset:0 sc1 lds
v_mfma_f32_32x32x16_bf16 v[48:63], v[12:15], a[104:107], v[48:63]
ds_read_b128 v[8:11], v64 offset:30720
buffer_load_dwordx4 v0, s[4:7], s55 offen offset:1024 sc1 lds
buffer_load_dwordx4 v0, s[4:7], s55 offen offset:2048 sc1 lds
v_mfma_f32_32x32x16_bf16 v[48:63], v[16:19], a[108:111], v[48:63]
s_waitcnt lgkmcnt(3)
ds_read_b128 v[12:15], v64 offset:31744
buffer_load_dwordx4 v0, s[4:7], s55 offen offset:3072 sc1 lds
s_add_u32 m0, s45, 4096
s_add_u32 s55, s46, 4096
buffer_load_dwordx4 v0, s[4:7], s55 offen offset:0 sc1 lds
v_mfma_f32_32x32x16_bf16 v[48:63], v[20:23], a[112:115], v[48:63]
s_waitcnt lgkmcnt(3)
ds_read_b128 v[16:19], v64 offset:32768
buffer_load_dwordx4 v0, s[4:7], s55 offen offset:1024 sc1 lds
buffer_load_dwordx4 v0, s[4:7], s55 offen offset:2048 sc1 lds
v_mfma_f32_32x32x16_bf16 v[48:63], v[24:27], a[116:119], v[48:63]
s_waitcnt lgkmcnt(2)
ds_read_b128 v[20:23], v64 offset:33792
buffer_load_dwordx4 v0, s[4:7], s55 offen offset:3072 sc1 lds
s_add_u32 m0, s45, 8192
s_add_u32 s55, s46, 8192
buffer_load_dwordx4 v0, s[4:7], s55 offen offset:0 sc1 lds
v_mfma_f32_32x32x16_bf16 v[48:63], v[8:11], a[120:123], v[48:63]
s_waitcnt lgkmcnt(2)
ds_read_b128 v[24:27], v64 offset:34816
buffer_load_dwordx4 v0, s[4:7], s55 offen offset:1024 sc1 lds
s_add_u32 s45, s45, 40960
s_cmp_ge_u32 s45, 122880
s_cselect_b32 s55, 122880, 0
s_sub_u32 s45, s45, s55
v_mfma_f32_32x32x16_bf16 v[48:63], v[12:15], a[124:127], v[48:63]
s_waitcnt lgkmcnt(2)
ds_read_b128 v[8:11], v64 offset:35840
s_add_u32 s46, s46, 40960
v_mfma_f32_32x32x16_bf16 v[48:63], v[16:19], a[128:131], v[48:63]
s_waitcnt lgkmcnt(2)
ds_read_b128 v[12:15], v64 offset:36864
v_mfma_f32_32x32x16_bf16 v[48:63], v[20:23], a[132:135], v[48:63]
s_waitcnt lgkmcnt(2)
ds_read_b128 v[16:19], v64 offset:37888
v_mfma_f32_32x32x16_bf16 v[48:63], v[24:27], a[136:139], v[48:63]
s_waitcnt lgkmcnt(2)
ds_read_b128 v[20:23], v64 offset:38912
v_mfma_f32_32x32x16_bf16 v[48:63], v[8:11], a[140:143], v[48:63]
s_waitcnt lgkmcnt(2)
ds_read_b128 v[24:27], v64 offset:39936
v_mfma_f32_32x32x16_bf16 v[48:63], v[12:15], a[144:147], v[48:63]
s_add_u32 s44, s44, 1
s_cmp_eq_u32 s44, 3
s_mov_b32 s56, 40960
s_cmov_b32 s56, -81920
s_cselect_b32 s44, 0, s44
v_add_u32 v64, s56, v64
v_add_u32 v5, s56, v5
s_waitcnt vmcnt(10) lgkmcnt(2)
s_barrier
s_add_u32 s50, s50, 1
v_mov_b32 v4, s50
buffer_store_dword v4, v2, s[4:7], s60 offen sc1
ds_read_b128 v[8:11], v64 offset:0
v_mfma_f32_32x32x16_bf16 v[48:63], v[16:19], a[148:151], v[48:63]
s_waitcnt lgkmcnt(2)
ds_read_b128 v[12:15], v64 offset:1024
v_mfma_f32_32x32x16_bf16 v[48:63], v[20:23], a[152:155], v[48:63]
s_waitcnt lgkmcnt(2)
ds_read_b128 v[16:19], v64 offset:2048
v_mfma_f32_32x32x16_bf16 v[48:63], v[24:27], a[156:159], v[48:63]
s_waitcnt lgkmcnt(2)
ds_read_b128 v[20:23], v64 offset:3072
k_sm_43:
s_sub_u32 s59, s59, 1
s_cmp_eq_u32 s59, 0
s_cbranch_scc1 k_so_42
v_mfma_f32_32x32x16_bf16 v[32:47], v[8:11], a[0:3], 0
s_waitcnt lgkmcnt(2)
ds_read_b128 v[24:27], v64 offset:4096
v_mfma_f32_32x32x16_bf16 v[32:47], v[12:15], a[4:7], v[32:47]
s_waitcnt lgkmcnt(2)
ds_read_b128 v[8:11], v64 offset:5120
ds_read_b128 v[80:83], v7 offset:1024
ds_read_b128 v[84:87], v7 offset:1040
v_mov_b32 v88, 0x3727c5ac
v_mfma_f32_32x32x16_bf16 v[32:47], v[16:19], a[8:11], v[32:47]
s_waitcnt lgkmcnt(4)
ds_read_b128 v[12:15], v64 offset:6144
s_waitcnt lgkmcnt(1)
v_add_f32 v80, v80, v84
v_add_f32 v81, v81, v85
v_add_f32 v82, v82, v86
v_add_f32 v83, v83, v87
v_add_f32 v80, v80, v81
v_add_f32 v82, v82, v83
v_add_f32 v80, v80, v82
v_mfma_f32_32x32x16_bf16 v[32:47], v[20:23], a[12:15], v[32:47]
ds_read_b128 v[16:19], v64 offset:7168
v_fma_f32 v80, v80, s61, v88
v_rsq_f32 v80, v80
ds_write_b32 v28, v80
v_mfma_f32_32x32x16_bf16 v[32:47], v[24:27], a[16:19], v[32:47]
ds_read_b128 v[20:23], v64 offset:8192
ds_read_b128 v[80:83], v29 offset:0
ds_read_b128 v[84:87], v29 offset:32
ds_read_b128 v[88:91], v29 offset:64
ds_read_b128 v[92:95], v29 offset:96
v_mfma_f32_32x32x16_bf16 v[32:47], v[8:11], a[20:23], v[32:47]
s_waitcnt lgkmcnt(7)
ds_read_b128 v[24:27], v64 offset:9216
s_waitcnt lgkmcnt(4)
v_mul_f32 v80, v80, v48
v_mul_f32 v81, v81, v49
v_mul_f32 v82, v82, v50
v_mul_f32 v83, v83, v51
v_mfma_f32_32x32x16_bf16 v[32:47], v[12:15], a[24:27], v[32:47]
ds_read_b128 v[8:11], v64 offset:10240
s_waitcnt lgkmcnt(4)
v_mul_f32 v84, v84, v52
v_mul_f32 v85, v85, v53
v_mul_f32 v86, v86, v54
v_mul_f32 v87, v87, v55
v_mfma_f32_32x32x16_bf16 v[32:47], v[16:19], a[28:31], v[32:47]
ds_read_b128 v[12:15], v64 offset:11264
s_waitcnt lgkmcnt(4)
v_mul_f32 v88, v88, v56
v_mul_f32 v89, v89, v57
v_mul_f32 v90, v90, v58
v_mul_f32 v91, v91, v59
v_mfma_f32_32x32x16_bf16 v[32:47], v[20:23], a[32:35], v[32:47]
s_waitcnt lgkmcnt(2)
ds_read_b128 v[16:19], v64 offset:12288
v_mul_f32 v92, v92, v60
v_mul_f32 v93, v93, v61
v_mul_f32 v94, v94, v62
v_mul_f32 v95, v95, v63
v_mfma_f32_32x32x16_bf16 v[32:47], v[24:27], a[36:39], v[32:47]
s_waitcnt lgkmcnt(2)
ds_read_b128 v[20:23], v64 offset:13312
v_cvt_pk_bf16_f32 v48, v80, v81
v_cvt_pk_bf16_f32 v49, v82, v83
v_mfma_f32_32x32x16_bf16 v[32:47], v[8:11], a[40:43], v[32:47]
s_waitcnt lgkmcnt(2)
ds_read_b128 v[24:27], v64 offset:14336
v_cvt_pk_bf16_f32 v52, v84, v85
v_cvt_pk_bf16_f32 v53, v86, v87
v_mfma_f32_32x32x16_bf16 v[32:47], v[12:15], a[44:47], v[32:47]
s_waitcnt lgkmcnt(2)
ds_read_b128 v[8:11], v64 offset:15360
v_cvt_pk_bf16_f32 v50, v88, v89
v_cvt_pk_bf16_f32 v51, v90, v91
v_mfma_f32_32x32x16_bf16 v[32:47], v[16:19], a[48:51], v[32:47]
s_waitcnt lgkmcnt(2)
ds_read_b128 v[12:15], v64 offset:16384
v_cvt_pk_bf16_f32 v54, v92, v93
v_cvt_pk_bf16_f32 v55, v94, v95
v_mfma_f32_32x32x16_bf16 v[32:47], v[20:23], a[52:55], v[32:47]
s_waitcnt lgkmcnt(2)
ds_read_b128 v[16:19], v64 offset:17408
buffer_store_dwordx4 v[48:51], v1, s[4:7], s48 offen offset:2048 sc1
buffer_store_dwordx4 v[52:55], v1, s[4:7], s48 offen offset:2560 sc1
v_mfma_f32_32x32x16_bf16 v[32:47], v[24:27], a[56:59], v[32:47]
s_waitcnt lgkmcnt(2)
ds_read_b128 v[20:23], v64 offset:18432
s_add_u32 s48, s48, s49
ds_read_b128 v[72:75], v5
v_mov_b32 v4, 0
v_mfma_f32_32x32x16_bf16 v[32:47], v[8:11], a[60:63], v[32:47]
s_waitcnt lgkmcnt(3)
ds_read_b128 v[24:27], v64 offset:19456
ds_read_b128 v[76:79], v5 offset:1024
s_waitcnt lgkmcnt(2)
v_and_b32 v72, v3, v72
v_mfma_f32_32x32x16_bf16 v[32:47], v[12:15], a[64:67], v[32:47]
ds_read_b128 v[8:11], v64 offset:20480
v_dot2c_f32_bf16 v4, v72, v72
v_dot2c_f32_bf16 v4, v73, v73
v_dot2c_f32_bf16 v4, v74, v74
v_dot2c_f32_bf16 v4, v75, v75
ds_read_b128 v[72:75], v5 offset:2048
v_mfma_f32_32x32x16_bf16 v[32:47], v[16:19], a[68:71], v[32:47]
ds_read_b128 v[12:15], v64 offset:21504
s_waitcnt lgkmcnt(3)
v_dot2c_f32_bf16 v4, v76, v76
v_dot2c_f32_bf16 v4, v77, v77
v_dot2c_f32_bf16 v4, v78, v78
v_dot2c_f32_bf16 v4, v79, v79
ds_read_b128 v[76:79], v5 offset:3072
v_mfma_f32_32x32x16_bf16 v[32:47], v[20:23], a[72:75], v[32:47]
ds_read_b128 v[16:19], v64 offset:22528
s_waitcnt lgkmcnt(3)
v_dot2c_f32_bf16 v4, v72, v72
v_dot2c_f32_bf16 v4, v73, v73
v_dot2c_f32_bf16 v4, v74, v74
v_dot2c_f32_bf16 v4, v75, v75
ds_read_b128 v[72:75], v5 offset:4096
v_mfma_f32_32x32x16_bf16 v[32:47], v[24:27], a[76:79], v[32:47]
ds_read_b128 v[20:23], v64 offset:23552
s_waitcnt lgkmcnt(3)
v_dot2c_f32_bf16 v4, v76, v76
v_dot2c_f32_bf16 v4, v77, v77
v_dot2c_f32_bf16 v4, v78, v78
v_dot2c_f32_bf16 v4, v79, v79
ds_read_b128 v[76:79], v5 offset:5120
v_mfma_f32_32x32x16_bf16 v[32:47], v[8:11], a[80:83], v[32:47]
ds_read_b128 v[24:27], v64 offset:24576
s_waitcnt lgkmcnt(3)
v_dot2c_f32_bf16 v4, v72, v72
v_dot2c_f32_bf16 v4, v73, v73
v_dot2c_f32_bf16 v4, v74, v74
v_dot2c_f32_bf16 v4, v75, v75
ds_read_b128 v[72:75], v5 offset:6144
v_mfma_f32_32x32x16_bf16 v[32:47], v[12:15], a[84:87], v[32:47]
ds_read_b128 v[8:11], v64 offset:25600
s_waitcnt lgkmcnt(3)
v_dot2c_f32_bf16 v4, v76, v76
v_dot2c_f32_bf16 v4, v77, v77
v_dot2c_f32_bf16 v4, v78, v78
v_dot2c_f32_bf16 v4, v79, v79
ds_read_b128 v[76:79], v5 offset:7168
v_mfma_f32_32x32x16_bf16 v[32:47], v[16:19], a[88:91], v[32:47]
ds_read_b128 v[12:15], v64 offset:26624
s_waitcnt lgkmcnt(3)
v_dot2c_f32_bf16 v4, v72, v72
v_dot2c_f32_bf16 v4, v73, v73
v_dot2c_f32_bf16 v4, v74, v74
v_dot2c_f32_bf16 v4, v75, v75
ds_read_b128 v[72:75], v5 offset:8192
v_mfma_f32_32x32x16_bf16 v[32:47], v[20:23], a[92:95], v[32:47]
ds_read_b128 v[16:19], v64 offset:27648
s_waitcnt lgkmcnt(3)
v_dot2c_f32_bf16 v4, v76, v76
v_dot2c_f32_bf16 v4, v77, v77
v_dot2c_f32_bf16 v4, v78, v78
v_dot2c_f32_bf16 v4, v79, v79
ds_read_b128 v[76:79], v5 offset:9216
v_mfma_f32_32x32x16_bf16 v[32:47], v[24:27], a[96:99], v[32:47]
ds_read_b128 v[20:23], v64 offset:28672
s_waitcnt lgkmcnt(3)
v_dot2c_f32_bf16 v4, v72, v72
v_dot2c_f32_bf16 v4, v73, v73
v_dot2c_f32_bf16 v4, v74, v74
v_dot2c_f32_bf16 v4, v75, v75
s_waitcnt lgkmcnt(1)
v_dot2c_f32_bf16 v4, v76, v76
v_dot2c_f32_bf16 v4, v77, v77
v_dot2c_f32_bf16 v4, v78, v78
v_dot2c_f32_bf16 v4, v79, v79
v_mfma_f32_32x32x16_bf16 v[32:47], v[8:11], a[100:103], v[32:47]
ds_read_b128 v[24:27], v64 offset:29696
ds_write_b32 v6, v4 offset:0
s_add_u32 m0, s45, 0
s_add_u32 s55, s46, 0
buffer_load_dwordx4 v0, s[4:7], s55 offen offset:0 sc1 lds
v_mfma_f32_32x32x16_bf16 v[32:47], v[12:15], a[104:107], v[32:47]
ds_read_b128 v[8:11], v64 offset:30720
buffer_load_dwordx4 v0, s[4:7], s55 offen offset:1024 sc1 lds
buffer_load_dwordx4 v0, s[4:7], s55 offen offset:2048 sc1 lds
v_mfma_f32_32x32x16_bf16 v[32:47], v[16:19], a[108:111], v[32:47]
s_waitcnt lgkmcnt(3)
ds_read_b128 v[12:15], v64 offset:31744
buffer_load_dwordx4 v0, s[4:7], s55 offen offset:3072 sc1 lds
s_add_u32 m0, s45, 4096
s_add_u32 s55, s46, 4096
buffer_load_dwordx4 v0, s[4:7], s55 offen offset:0 sc1 lds
v_mfma_f32_32x32x16_bf16 v[32:47], v[20:23], a[112:115], v[32:47]
s_waitcnt lgkmcnt(3)
ds_read_b128 v[16:19], v64 offset:32768
buffer_load_dwordx4 v0, s[4:7], s55 offen offset:1024 sc1 lds
buffer_load_dwordx4 v0, s[4:7], s55 offen offset:2048 sc1 lds
v_mfma_f32_32x32x16_bf16 v[32:47], v[24:27], a[116:119], v[32:47]
s_waitcnt lgkmcnt(2)
ds_read_b128 v[20:23], v64 offset:33792
buffer_load_dwordx4 v0, s[4:7], s55 offen offset:3072 sc1 lds
s_add_u32 m0, s45, 8192
s_add_u32 s55, s46, 8192
buffer_load_dwordx4 v0, s[4:7], s55 offen offset:0 sc1 lds
v_mfma_f32_32x32x16_bf16 v[32:47], v[8:11], a[120:123], v[32:47]
s_waitcnt lgkmcnt(2)
ds_read_b128 v[24:27], v64 offset:34816
buffer_load_dwordx4 v0, s[4:7], s55 offen offset:1024 sc1 lds
s_add_u32 s45, s45, 40960
s_cmp_ge_u32 s45, 122880
s_cselect_b32 s55, 122880, 0
s_sub_u32 s45, s45, s55
v_mfma_f32_32x32x16_bf16 v[32:47], v[12:15], a[124:127], v[32:47]
s_waitcnt lgkmcnt(2)
ds_read_b128 v[8:11], v64 offset:35840
s_add_u32 s46, s46, 40960
v_mfma_f32_32x32x16_bf16 v[32:47], v[16:19], a[128:131], v[32:47]
s_waitcnt lgkmcnt(2)
ds_read_b128 v[12:15], v64 offset:36864
v_mfma_f32_32x32x16_bf16 v[32:47], v[20:23], a[132:135], v[32:47]
s_waitcnt lgkmcnt(2)
ds_read_b128 v[16:19], v64 offset:37888
v_mfma_f32_32x32x16_bf16 v[32:47], v[24:27], a[136:139], v[32:47]
s_waitcnt lgkmcnt(2)
ds_read_b128 v[20:23], v64 offset:38912
v_mfma_f32_32x32x16_bf16 v[32:47], v[8:11], a[140:143], v[32:47]
s_waitcnt lgkmcnt(2)
ds_read_b128 v[24:27], v64 offset:39936
v_mfma_f32_32x32x16_bf16 v[32:47], v[12:15], a[144:147], v[32:47]
s_add_u32 s44, s44, 1
s_cmp_eq_u32 s44, 3
s_mov_b32 s56, 40960
s_cmov_b32 s56, -81920
s_cselect_b32 s44, 0, s44
v_add_u32 v64, s56, v64
v_add_u32 v5, s56, v5
s_waitcnt vmcnt(10) lgkmcnt(2)
s_barrier
s_add_u32 s50, s50, 1
v_mov_b32 v4, s50
buffer_store_dword v4, v2, s[4:7], s60 offen sc1
ds_read_b128 v[8:11], v64 offset:0
v_mfma_f32_32x32x16_bf16 v[32:47], v[16:19], a[148:151], v[32:47]
s_waitcnt lgkmcnt(2)
ds_read_b128 v[12:15], v64 offset:1024
v_mfma_f32_32x32x16_bf16 v[32:47], v[20:23], a[152:155], v[32:47]
s_waitcnt lgkmcnt(2)
ds_read_b128 v[16:19], v64 offset:2048
v_mfma_f32_32x32x16_bf16 v[32:47], v[24:27], a[156:159], v[32:47]
s_waitcnt lgkmcnt(2)
ds_read_b128 v[20:23], v64 offset:3072
s_branch k_st_41
k_so_42:
ds_read_b128 v[80:83], v7 offset:1024
ds_read_b128 v[84:87], v7 offset:1040
v_mov_b32 v88, 0x3727c5ac
s_waitcnt lgkmcnt(0)
v_add_f32 v80, v80, v84
v_add_f32 v81, v81, v85
v_add_f32 v82, v82, v86
v_add_f32 v83, v83, v87
v_add_f32 v80, v80, v81
v_add_f32 v82, v82, v83
v_add_f32 v80, v80, v82
v_fma_f32 v80, v80, s61, v88
v_rsq_f32 v80, v80
ds_write_b32 v28, v80
ds_read_b128 v[80:83], v29 offset:0
ds_read_b128 v[84:87], v29 offset:32
ds_read_b128 v[88:91], v29 offset:64
ds_read_b128 v[92:95], v29 offset:96
s_waitcnt lgkmcnt(3)
v_mul_f32 v80, v80, v48
v_mul_f32 v81, v81, v49
v_mul_f32 v82, v82, v50
v_mul_f32 v83, v83, v51
s_waitcnt lgkmcnt(2)
v_mul_f32 v84, v84, v52
v_mul_f32 v85, v85, v53
v_mul_f32 v86, v86, v54
v_mul_f32 v87, v87, v55
s_waitcnt lgkmcnt(1)
v_mul_f32 v88, v88, v56
v_mul_f32 v89, v89, v57
v_mul_f32 v90, v90, v58
v_mul_f32 v91, v91, v59
s_waitcnt lgkmcnt(0)
v_mul_f32 v92, v92, v60
v_mul_f32 v93, v93, v61
v_mul_f32 v94, v94, v62
v_mul_f32 v95, v95, v63
v_cvt_pk_bf16_f32 v48, v80, v81
v_cvt_pk_bf16_f32 v49, v82, v83
v_cvt_pk_bf16_f32 v52, v84, v85
v_cvt_pk_bf16_f32 v53, v86, v87
v_cvt_pk_bf16_f32 v50, v88, v89
v_cvt_pk_bf16_f32 v51, v90, v91
v_cvt_pk_bf16_f32 v54, v92, v93
v_cvt_pk_bf16_f32 v55, v94, v95
buffer_store_dwordx4 v[48:51], v1, s[4:7], s48 offen offset:2048 sc1
buffer_store_dwordx4 v[52:55], v1, s[4:7], s48 offen offset:2560 sc1
s_add_u32 s48, s48, s49
k_join_34:
s_waitcnt vmcnt(0) lgkmcnt(0)
s_barrier
s_add_u32 s50, s50, 1
v_mov_b32 v4, s50
buffer_store_dword v4, v2, s[4:7], s60 offen sc1
s_cmp_lg_u32 s51, 0
s_cbranch_scc1 k_nxt_44
s_mul_i32 s46, s3, 10240
s_add_u32 s46, s46, 213909504
s_mul_i32 s45, s3, 10240
s_mov_b32 s44, 0
v_mov_b32 v64, v0
s_add_u32 m0, s45, 0
s_add_u32 s55, s46, 0
buffer_load_dwordx4 v0, s[4:7], s55 offen offset:0 sc1 lds
buffer_load_dwordx4 v0, s[4:7], s55 offen offset:1024 sc1 lds
buffer_load_dwordx4 v0, s[4:7], s55 offen offset:2048 sc1 lds
buffer_load_dwordx4 v0, s[4:7], s55 offen offset:3072 sc1 lds
s_add_u32 m0, s45, 4096
s_add_u32 s55, s46, 4096
buffer_load_dwordx4 v0, s[4:7], s55 offen offset:0 sc1 lds
buffer_load_dwordx4 v0, s[4:7], s55 offen offset:1024 sc1 lds
buffer_load_dwordx4 v0, s[4:7], s55 offen offset:2048 sc1 lds
buffer_load_dwordx4 v0, s[4:7], s55 offen offset:3072 sc1 lds
s_add_u32 m0, s45, 8192
s_add_u32 s55, s46, 8192
buffer_load_dwordx4 v0, s[4:7], s55 offen offset:0 sc1 lds
buffer_load_dwordx4 v0, s[4:7], s55 offen offset:1024 sc1 lds
s_add_u32 s45, s45, 40960
s_cmp_ge_u32 s45, 122880
s_cselect_b32 s55, 122880, 0
s_sub_u32 s45, s45, s55
s_add_u32 s46, s46, 40960
s_add_u32 m0, s45, 0
s_add_u32 s55, s46, 0
buffer_load_dwordx4 v0, s[4:7], s55 offen offset:0 sc1 lds
buffer_load_dwordx4 v0, s[4:7], s55 offen offset:1024 sc1 lds
buffer_load_dwordx4 v0, s[4:7], s55 offen offset:2048 sc1 lds
buffer_load_dwordx4 v0, s[4:7], s55 offen offset:3072 sc1 lds
s_add_u32 m0, s45, 4096
s_add_u32 s55, s46, 4096
buffer_load_dwordx4 v0, s[4:7], s55 offen offset:0 sc1 lds
buffer_load_dwordx4 v0, s[4:7], s55 offen offset:1024 sc1 lds
buffer_load_dwordx4 v0, s[4:7], s55 offen offset:2048 sc1 lds
buffer_load_dwordx4 v0, s[4:7], s55 offen offset:3072 sc1 lds
s_add_u32 m0, s45, 8192
s_add_u32 s55, s46, 8192
buffer_load_dwordx4 v0, s[4:7], s55 offen offset:0 sc1 lds
buffer_load_dwordx4 v0, s[4:7], s55 offen offset:1024 sc1 lds
s_add_u32 s45, s45, 40960
s_cmp_ge_u32 s45, 122880
s_cselect_b32 s55, 122880, 0
s_sub_u32 s45, s45, s55
s_add_u32 s46, s46, 40960
s_waitcnt vmcnt(10)
s_barrier
ds_read_b128 v[8:11], v64 offset:0
ds_read_b128 v[12:15], v64 offset:1024
ds_read_b128 v[16:19], v64 offset:2048
ds_read_b128 v[20:23], v64 offset:3072
v_mov_b32 v30, 0xffff
v_cmp_gt_u32 vcc, 512, v0
s_nop 1
v_cndmask_b32 v30, -1, v30, vcc
s_waitcnt lgkmcnt(3)
v_mfma_f32_32x32x16_bf16 v[32:47], v[8:11], v[96:99], 0
s_waitcnt lgkmcnt(2)
ds_read_b128 v[24:27], v64 offset:4096
v_mfma_f32_32x32x16_bf16 v[32:47], v[12:15], v[100:103], v[32:47]
s_waitcnt lgkmcnt(2)
ds_read_b128 v[8:11], v64 offset:5120
s_add_u32 m0, s45, 0
s_add_u32 s55, s46, 0
buffer_load_dwordx4 v0, s[4:7], s55 offen offset:0 sc1 lds
buffer_load_dwordx4 v0, s[4:7], s55 offen offset:1024 sc1 lds
v_mfma_f32_32x32x16_bf16 v[32:47], v[16:19], v[104:107], v[32:47]
s_waitcnt lgkmcnt(2)
ds_read_b128 v[12:15], v64 offset:6144
buffer_load_dwordx4 v0, s[4:7], s55 offen offset:2048 sc1 lds
buffer_load_dwordx4 v0, s[4:7], s55 offen offset:3072 sc1 lds
v_mfma_f32_32x32x16_bf16 v[32:47], v[20:23], v[108:111], v[32:47]
s_waitcnt lgkmcnt(2)
ds_read_b128 v[16:19], v64 offset:7168
s_add_u32 m0, s45, 4096
s_add_u32 s55, s46, 4096
buffer_load_dwordx4 v0, s[4:7], s55 offen offset:0 sc1 lds
buffer_load_dwordx4 v0, s[4:7], s55 offen offset:1024 sc1 lds
v_mfma_f32_32x32x16_bf16 v[32:47], v[24:27], v[112:115], v[32:47]
s_waitcnt lgkmcnt(2)
ds_read_b128 v[20:23], v64 offset:8192
buffer_load_dwordx4 v0, s[4:7], s55 offen offset:2048 sc1 lds
buffer_load_dwordx4 v0, s[4:7], s55 offen offset:3072 sc1 lds
v_mfma_f32_32x32x16_bf16 v[32:47], v[8:11], v[116:119], v[32:47]
s_waitcnt lgkmcnt(2)
ds_read_b128 v[24:27], v64 offset:9216
s_add_u32 m0, s45, 8192
s_add_u32 s55, s46, 8192
buffer_load_dwordx4 v0, s[4:7], s55 offen offset:0 sc1 lds
buffer_load_dwordx4 v0, s[4:7], s55 offen offset:1024 sc1 lds
v_mfma_f32_32x32x16_bf16 v[32:47], v[12:15], v[120:123], v[32:47]
s_waitcnt lgkmcnt(2)
ds_read_b128 v[8:11], v64 offset:10240
s_add_u32 s45, s45, 40960
s_cmp_ge_u32 s45, 122880
s_cselect_b32 s55, 122880, 0
s_sub_u32 s45, s45, s55
s_add_u32 s46, s46, 40960
v_mfma_f32_32x32x16_bf16 v[32:47], v[16:19], v[124:127], v[32:47]
s_waitcnt lgkmcnt(2)
ds_read_b128 v[12:15], v64 offset:11264
v_mfma_f32_32x32x16_bf16 v[32:47], v[20:23], v[128:131], v[32:47]
s_waitcnt lgkmcnt(2)
ds_read_b128 v[16:19], v64 offset:12288
v_mfma_f32_32x32x16_bf16 v[32:47], v[24:27], v[132:135], v[32:47]
s_waitcnt lgkmcnt(2)
ds_read_b128 v[20:23], v64 offset:13312
v_mfma_f32_32x32x16_bf16 v[32:47], v[8:11], v[136:139], v[32:47]
s_waitcnt lgkmcnt(2)
ds_read_b128 v[24:27], v64 offset:14336
v_mfma_f32_32x32x16_bf16 v[32:47], v[12:15], v[140:143], v[32:47]
s_waitcnt lgkmcnt(2)
ds_read_b128 v[8:11], v64 offset:15360
v_mfma_f32_32x32x16_bf16 v[32:47], v[16:19], v[144:147], v[32:47]
s_waitcnt lgkmcnt(2)
ds_read_b128 v[12:15], v64 offset:16384
v_mfma_f32_32x32x16_bf16 v[32:47], v[20:23], v[148:151], v[32:47]
s_waitcnt lgkmcnt(2)
ds_read_b128 v[16:19], v64 offset:17408
v_mfma_f32_32x32x16_bf16 v[32:47], v[24:27], v[152:155], v[32:47]
s_waitcnt lgkmcnt(2)
ds_read_b128 v[20:23], v64 offset:18432
v_mfma_f32_32x32x16_bf16 v[32:47], v[8:11], v[156:159], v[32:47]
s_waitcnt lgkmcnt(2)
ds_read_b128 v[24:27], v64 offset:19456
v_mfma_f32_32x32x16_bf16 v[32:47], v[12:15], v[160:163], v[32:47]
s_waitcnt lgkmcnt(2)
ds_read_b128 v[8:11], v64 offset:20480
v_mfma_f32_32x32x16_bf16 v[32:47], v[16:19], v[164:167], v[32:47]
s_waitcnt lgkmcnt(2)
ds_read_b128 v[12:15], v64 offset:21504
v_mfma_f32_32x32x16_bf16 v[32:47], v[20:23], v[168:171], v[32:47]
s_waitcnt lgkmcnt(2)
ds_read_b128 v[16:19], v64 offset:22528
v_mfma_f32_32x32x16_bf16 v[32:47], v[24:27], v[172:175], v[32:47]
s_waitcnt lgkmcnt(2)
ds_read_b128 v[20:23], v64 offset:23552
v_mfma_f32_32x32x16_bf16 v[32:47], v[8:11], v[176:179], v[32:47]
s_waitcnt lgkmcnt(2)
ds_read_b128 v[24:27], v64 offset:24576
v_mfma_f32_32x32x16_bf16 v[32:47], v[12:15], v[180:183], v[32:47]
s_waitcnt lgkmcnt(2)
ds_read_b128 v[8:11], v64 offset:25600
v_mfma_f32_32x32x16_bf16 v[32:47], v[16:19], v[184:187], v[32:47]
s_waitcnt lgkmcnt(2)
ds_read_b128 v[12:15], v64 offset:26624
v_mfma_f32_32x32x16_bf16 v[32:47], v[20:23], v[188:191], v[32:47]
s_waitcnt lgkmcnt(2)
ds_read_b128 v[16:19], v64 offset:27648
v_mfma_f32_32x32x16_bf16 v[32:47], v[24:27], v[192:195], v[32:47]
s_waitcnt lgkmcnt(2)
ds_read_b128 v[20:23], v64 offset:28672
v_mfma_f32_32x32x16_bf16 v[32:47], v[8:11], v[196:199], v[32:47]
s_waitcnt lgkmcnt(2)
ds_read_b128 v[24:27], v64 offset:29696
v_mfma_f32_32x32x16_bf16 v[32:47], v[12:15], v[200:203], v[32:47]
s_waitcnt lgkmcnt(2)
ds_read_b128 v[8:11], v64 offset:30720
v_mfma_f32_32x32x16_bf16 v[32:47], v[16:19], v[204:207], v[32:47]
s_waitcnt lgkmcnt(2)
ds_read_b128 v[12:15], v64 offset:31744
v_mfma_f32_32x32x16_bf16 v[32:47], v[20:23], v[208:211], v[32:47]
s_waitcnt lgkmcnt(2)
ds_read_b128 v[16:19], v64 offset:32768
v_mfma_f32_32x32x16_bf16 v[32:47], v[24:27], v[212:215], v[32:47]
s_waitcnt lgkmcnt(2)
ds_read_b128 v[20:23], v64 offset:33792
v_mfma_f32_32x32x16_bf16 v[32:47], v[8:11], v[216:219], v[32:47]
s_waitcnt lgkmcnt(2)
ds_read_b128 v[24:27], v64 offset:34816
v_mfma_f32_32x32x16_bf16 v[32:47], v[12:15], v[220:223], v[32:47]
s_waitcnt lgkmcnt(2)
ds_read_b128 v[8:11], v64 offset:35840
v_mfma_f32_32x32x16_bf16 v[32:47], v[16:19], v[224:227], v[32:47]
s_waitcnt lgkmcnt(2)
ds_read_b128 v[12:15], v64 offset:36864
v_mfma_f32_32x32x16_bf16 v[32:47], v[20:23], v[228:231], v[32:47]
s_waitcnt lgkmcnt(2)
ds_read_b128 v[16:19], v64 offset:37888
v_mfma_f32_32x32x16_bf16 v[32:47], v[24:27], v[232:235], v[32:47]
s_waitcnt lgkmcnt(2)
ds_read_b128 v[20:23], v64 offset:38912
v_mfma_f32_32x32x16_bf16 v[32:47], v[8:11], v[236:239], v[32:47]
s_waitcnt lgkmcnt(2)
ds_read_b128 v[24:27], v64 offset:39936
v_mfma_f32_32x32x16_bf16 v[32:47], v[12:15], v[240:243], v[32:47]
s_add_u32 s44, s44, 1
s_cmp_eq_u32 s44, 3
s_mov_b32 s56, 40960
s_cmov_b32 s56, -81920
s_cselect_b32 s44, 0, s44
v_add_u32 v64, s56, v64
s_waitcnt vmcnt(10) lgkmcnt(2)
s_barrier
ds_read_b128 v[8:11], v64 offset:0
v_mfma_f32_32x32x16_bf16 v[32:47], v[16:19], v[244:247], v[32:47]
s_waitcnt lgkmcnt(2)
ds_read_b128 v[12:15], v64 offset:1024
v_mfma_f32_32x32x16_bf16 v[32:47], v[20:23], v[248:251], v[32:47]
s_waitcnt lgkmcnt(2)
ds_read_b128 v[16:19], v64 offset:2048
v_mfma_f32_32x32x16_bf16 v[32:47], v[24:27], v[252:255], v[32:47]
s_waitcnt lgkmcnt(2)
ds_read_b128 v[20:23], v64 offset:3072
v_mfma_f32_32x32x16_bf16 v[48:63], v[8:11], v[96:99], 0
s_waitcnt lgkmcnt(2)
ds_read_b128 v[24:27], v64 offset:4096
v_mfma_f32_32x32x16_bf16 v[48:63], v[12:15], v[100:103], v[48:63]
s_waitcnt lgkmcnt(2)
ds_read_b128 v[8:11], v64 offset:5120
v_cvt_pk_bf16_f32 v32, v32, v33
v_cvt_pk_bf16_f32 v33, v34, v35
v_mfma_f32_32x32x16_bf16 v[48:63], v[16:19], v[104:107], v[48:63]
s_waitcnt lgkmcnt(2)
ds_read_b128 v[12:15], v64 offset:6144
v_cvt_pk_bf16_f32 v34, v36, v37
v_cvt_pk_bf16_f32 v35, v38, v39
v_mfma_f32_32x32x16_bf16 v[48:63], v[20:23], v[108:111], v[48:63]
s_waitcnt lgkmcnt(2)
ds_read_b128 v[16:19], v64 offset:7168
v_cvt_pk_bf16_f32 v36, v40, v41
v_cvt_pk_bf16_f32 v37, v42, v43
v_mfma_f32_32x32x16_bf16 v[48:63], v[24:27], v[112:115], v[48:63]
s_waitcnt lgkmcnt(2)
ds_read_b128 v[20:23], v64 offset:8192
v_cvt_pk_bf16_f32 v38, v44, v45
v_cvt_pk_bf16_f32 v39, v46, v47
v_mfma_f32_32x32x16_bf16 v[48:63], v[8:11], v[116:119], v[48:63]
s_waitcnt lgkmcnt(2)
ds_read_b128 v[24:27], v64 offset:9216
v_and_b32 v32, v30, v32
v_accvgpr_write_b32 a0, v32
v_mfma_f32_32x32x16_bf16 v[48:63], v[12:15], v[120:123], v[48:63]
s_waitcnt lgkmcnt(2)
ds_read_b128 v[8:11], v64 offset:10240
v_accvgpr_write_b32 a1, v33
v_accvgpr_write_b32 a2, v34
v_mfma_f32_32x32x16_bf16 v[48:63], v[16:19], v[124:127], v[48:63]
s_waitcnt lgkmcnt(2)
ds_read_b128 v[12:15], v64 offset:11264
v_accvgpr_write_b32 a3, v35
v_accvgpr_write_b32 a4, v36
v_mfma_f32_32x32x16_bf16 v[48:63], v[20:23], v[128:131], v[48:63]
s_waitcnt lgkmcnt(2)
ds_read_b128 v[16:19], v64 offset:12288
v_accvgpr_write_b32 a5, v37
v_accvgpr_write_b32 a6, v38
v_mfma_f32_32x32x16_bf16 v[48:63], v[24:27], v[132:135], v[48:63]
s_waitcnt lgkmcnt(2)
ds_read_b128 v[20:23], v64 offset:13312
v_accvgpr_write_b32 a7, v39
s_add_u32 m0, s45, 0
s_add_u32 s55, s46, 0
buffer_load_dwordx4 v0, s[4:7], s55 offen offset:0 sc1 lds
v_mfma_f32_32x32x16_bf16 v[48:63], v[8:11], v[136:139], v[48:63]
s_waitcnt lgkmcnt(2)
ds_read_b128 v[24:27], v64 offset:14336
buffer_load_dwordx4 v0, s[4:7], s55 offen offset:1024 sc1 lds
buffer_load_dwordx4 v0, s[4:7], s55 offen offset:2048 sc1 lds
v_mfma_f32_32x32x16_bf16 v[48:63], v[12:15], v[140:143], v[48:63]
s_waitcnt lgkmcnt(2)
ds_read_b128 v[8:11], v64 offset:15360
buffer_load_dwordx4 v0, s[4:7], s55 offen offset:3072 sc1 lds
s_add_u32 m0, s45, 4096
s_add_u32 s55, s46, 4096
buffer_load_dwordx4 v0, s[4:7], s55 offen offset:0 sc1 lds
v_mfma_f32_32x32x16_bf16 v[48:63], v[16:19], v[144:147], v[48:63]
s_waitcnt lgkmcnt(2)
ds_read_b128 v[12:15], v64 offset:16384
buffer_load_dwordx4 v0, s[4:7], s55 offen offset:1024 sc1 lds
buffer_load_dwordx4 v0, s[4:7], s55 offen offset:2048 sc1 lds
v_mfma_f32_32x32x16_bf16 v[48:63], v[20:23], v[148:151], v[48:63]
s_waitcnt lgkmcnt(2)
ds_read_b128 v[16:19], v64 offset:17408
buffer_load_dwordx4 v0, s[4:7], s55 offen offset:3072 sc1 lds
s_add_u32 m0, s45, 8192
s_add_u32 s55, s46, 8192
buffer_load_dwordx4 v0, s[4:7], s55 offen offset:0 sc1 lds
v_mfma_f32_32x32x16_bf16 v[48:63], v[24:27], v[152:155], v[48:63]
s_waitcnt lgkmcnt(2)
ds_read_b128 v[20:23], v64 offset:18432
buffer_load_dwordx4 v0, s[4:7], s55 offen offset:1024 sc1 lds
s_add_u32 s45, s45, 40960
s_cmp_ge_u32 s45, 122880
s_cselect_b32 s55, 122880, 0
s_sub_u32 s45, s45, s55
v_mfma_f32_32x32x16_bf16 v[48:63], v[8:11], v[156:159], v[48:63]
s_waitcnt lgkmcnt(2)
ds_read_b128 v[24:27], v64 offset:19456
s_add_u32 s46, s46, 40960
v_mfma_f32_32x32x16_bf16 v[48:63], v[12:15], v[160:163], v[48:63]
s_waitcnt lgkmcnt(2)
ds_read_b128 v[8:11], v64 offset:20480
v_mfma_f32_32x32x16_bf16 v[48:63], v[16:19], v[164:167], v[48:63]
s_waitcnt lgkmcnt(2)
ds_read_b128 v[12:15], v64 offset:21504
v_mfma_f32_32x32x16_bf16 v[48:63], v[20:23], v[168:171], v[48:63]
s_waitcnt lgkmcnt(2)
ds_read_b128 v[16:19], v64 offset:22528
v_mfma_f32_32x32x16_bf16 v[48:63], v[24:27], v[172:175], v[48:63]
s_waitcnt lgkmcnt(2)
ds_read_b128 v[20:23], v64 offset:23552
v_mfma_f32_32x32x16_bf16 v[48:63], v[8:11], v[176:179], v[48:63]
s_waitcnt lgkmcnt(2)
ds_read_b128 v[24:27], v64 offset:24576
v_mfma_f32_32x32x16_bf16 v[48:63], v[12:15], v[180:183], v[48:63]
s_waitcnt lgkmcnt(2)
ds_read_b128 v[8:11], v64 offset:25600
v_mfma_f32_32x32x16_bf16 v[48:63], v[16:19], v[184:187], v[48:63]
s_waitcnt lgkmcnt(2)
ds_read_b128 v[12:15], v64 offset:26624
v_mfma_f32_32x32x16_bf16 v[48:63], v[20:23], v[188:191], v[48:63]
s_waitcnt lgkmcnt(2)
ds_read_b128 v[16:19], v64 offset:27648
v_mfma_f32_32x32x16_bf16 v[48:63], v[24:27], v[192:195], v[48:63]
s_waitcnt lgkmcnt(2)
ds_read_b128 v[20:23], v64 offset:28672
v_mfma_f32_32x32x16_bf16 v[48:63], v[8:11], v[196:199], v[48:63]
s_waitcnt lgkmcnt(2)
ds_read_b128 v[24:27], v64 offset:29696
v_mfma_f32_32x32x16_bf16 v[48:63], v[12:15], v[200:203], v[48:63]
s_waitcnt lgkmcnt(2)
ds_read_b128 v[8:11], v64 offset:30720
v_mfma_f32_32x32x16_bf16 v[48:63], v[16:19], v[204:207], v[48:63]
s_waitcnt lgkmcnt(2)
ds_read_b128 v[12:15], v64 offset:31744
v_mfma_f32_32x32x16_bf16 v[48:63], v[20:23], v[208:211], v[48:63]
s_waitcnt lgkmcnt(2)
ds_read_b128 v[16:19], v64 offset:32768
v_mfma_f32_32x32x16_bf16 v[48:63], v[24:27], v[212:215], v[48:63]
s_waitcnt lgkmcnt(2)
ds_read_b128 v[20:23], v64 offset:33792
v_mfma_f32_32x32x16_bf16 v[48:63], v[8:11], v[216:219], v[48:63]
s_waitcnt lgkmcnt(2)
ds_read_b128 v[24:27], v64 offset:34816
v_mfma_f32_32x32x16_bf16 v[48:63], v[12:15], v[220:223], v[48:63]
s_waitcnt lgkmcnt(2)
ds_read_b128 v[8:11], v64 offset:35840
v_mfma_f32_32x32x16_bf16 v[48:63], v[16:19], v[224:227], v[48:63]
s_waitcnt lgkmcnt(2)
ds_read_b128 v[12:15], v64 offset:36864
v_mfma_f32_32x32x16_bf16 v[48:63], v[20:23], v[228:231], v[48:63]
s_waitcnt lgkmcnt(2)
ds_read_b128 v[16:19], v64 offset:37888
v_mfma_f32_32x32x16_bf16 v[48:63], v[24:27], v[232:235], v[48:63]
s_waitcnt lgkmcnt(2)
ds_read_b128 v[20:23], v64 offset:38912
v_mfma_f32_32x32x16_bf16 v[48:63], v[8:11], v[236:239], v[48:63]
s_waitcnt lgkmcnt(2)
ds_read_b128 v[24:27], v64 offset:39936
v_mfma_f32_32x32x16_bf16 v[48:63], v[12:15], v[240:243], v[48:63]
s_add_u32 s44, s44, 1
s_cmp_eq_u32 s44, 3
s_mov_b32 s56, 40960
s_cmov_b32 s56, -81920
s_cselect_b32 s44, 0, s44
v_add_u32 v64, s56, v64
s_waitcnt vmcnt(10) lgkmcnt(2)
s_barrier
ds_read_b128 v[8:11], v64 offset:0
v_mfma_f32_32x32x16_bf16 v[48:63], v[16:19], v[244:247], v[48:63]
s_waitcnt lgkmcnt(2)
ds_read_b128 v[12:15], v64 offset:1024
v_mfma_f32_32x32x16_bf16 v[48:63], v[20:23], v[248:251], v[48:63]
s_waitcnt lgkmcnt(2)
ds_read_b128 v[16:19], v64 offset:2048
v_mfma_f32_32x32x16_bf16 v[48:63], v[24:27], v[252:255], v[48:63]
s_waitcnt lgkmcnt(2)
ds_read_b128 v[20:23], v64 offset:3072
v_mfma_f32_32x32x16_bf16 v[32:47], v[8:11], v[96:99], 0
s_waitcnt lgkmcnt(2)
ds_read_b128 v[24:27], v64 offset:4096
v_mfma_f32_32x32x16_bf16 v[32:47], v[12:15], v[100:103], v[32:47]
s_waitcnt lgkmcnt(2)
ds_read_b128 v[8:11], v64 offset:5120
v_cvt_pk_bf16_f32 v48, v48, v49
v_cvt_pk_bf16_f32 v49, v50, v51
v_mfma_f32_32x32x16_bf16 v[32:47], v[16:19], v[104:107], v[32:47]
s_waitcnt lgkmcnt(2)
ds_read_b128 v[12:15], v64 offset:6144
v_cvt_pk_bf16_f32 v50, v52, v53
v_cvt_pk_bf16_f32 v51, v54, v55
v_mfma_f32_32x32x16_bf16 v[32:47], v[20:23], v[108:111], v[32:47]
s_waitcnt lgkmcnt(2)
ds_read_b128 v[16:19], v64 offset:7168
v_cvt_pk_bf16_f32 v52, v56, v57
v_cvt_pk_bf16_f32 v53, v58, v59
v_mfma_f32_32x32x16_bf16 v[32:47], v[24:27], v[112:115], v[32:47]
s_waitcnt lgkmcnt(2)
ds_read_b128 v[20:23], v64 offset:8192
v_cvt_pk_bf16_f32 v54, v60, v61
v_cvt_pk_bf16_f32 v55, v62, v63
v_mfma_f32_32x32x16_bf16 v[32:47], v[8:11], v[116:119], v[32:47]
s_waitcnt lgkmcnt(2)
ds_read_b128 v[24:27], v64 offset:9216
v_accvgpr_write_b32 a8, v48
v_accvgpr_write_b32 a9, v49
v_mfma_f32_32x32x16_bf16 v[32:47], v[12:15], v[120:123], v[32:47]
s_waitcnt lgkmcnt(2)
ds_read_b128 v[8:11], v64 offset:10240
v_accvgpr_write_b32 a10, v50
v_accvgpr_write_b32 a11, v51
v_mfma_f32_32x32x16_bf16 v[32:47], v[16:19], v[124:127], v[32:47]
s_waitcnt lgkmcnt(2)
ds_read_b128 v[12:15], v64 offset:11264
v_accvgpr_write_b32 a12, v52
v_accvgpr_write_b32 a13, v53
v_mfma_f32_32x32x16_bf16 v[32:47], v[20:23], v[128:131], v[32:47]
s_waitcnt lgkmcnt(2)
ds_read_b128 v[16:19], v64 offset:12288
v_accvgpr_write_b32 a14, v54
v_accvgpr_write_b32 a15, v55
v_mfma_f32_32x32x16_bf16 v[32:47], v[24:27], v[132:135], v[32:47]
s_waitcnt lgkmcnt(2)
ds_read_b128 v[20:23], v64 offset:13312
s_add_u32 m0, s45, 0
s_add_u32 s55, s46, 0
buffer_load_dwordx4 v0, s[4:7], s55 offen offset:0 sc1 lds
buffer_load_dwordx4 v0, s[4:7], s55 offen offset:1024 sc1 lds
v_mfma_f32_32x32x16_bf16 v[32:47], v[8:11], v[136:139], v[32:47]
s_waitcnt lgkmcnt(2)
ds_read_b128 v[24:27], v64 offset:14336
buffer_load_dwordx4 v0, s[4:7], s55 offen offset:2048 sc1 lds
buffer_load_dwordx4 v0, s[4:7], s55 offen offset:3072 sc1 lds
v_mfma_f32_32x32x16_bf16 v[32:47], v[12:15], v[140:143], v[32:47]
s_waitcnt lgkmcnt(2)
ds_read_b128 v[8:11], v64 offset:15360
s_add_u32 m0, s45, 4096
s_add_u32 s55, s46, 4096
buffer_load_dwordx4 v0, s[4:7], s55 offen offset:0 sc1 lds
buffer_load_dwordx4 v0, s[4:7], s55 offen offset:1024 sc1 lds
v_mfma_f32_32x32x16_bf16 v[32:47], v[16:19], v[144:147], v[32:47]
s_waitcnt lgkmcnt(2)
ds_read_b128 v[12:15], v64 offset:16384
buffer_load_dwordx4 v0, s[4:7], s55 offen offset:2048 sc1 lds
buffer_load_dwordx4 v0, s[4:7], s55 offen offset:3072 sc1 lds
v_mfma_f32_32x32x16_bf16 v[32:47], v[20:23], v[148:151], v[32:47]
s_waitcnt lgkmcnt(2)
ds_read_b128 v[16:19], v64 offset:17408
s_add_u32 m0, s45, 8192
s_add_u32 s55, s46, 8192
buffer_load_dwordx4 v0, s[4:7], s55 offen offset:0 sc1 lds
buffer_load_dwordx4 v0, s[4:7], s55 offen offset:1024 sc1 lds
v_mfma_f32_32x32x16_bf16 v[32:47], v[24:27], v[152:155], v[32:47]
s_waitcnt lgkmcnt(2)
ds_read_b128 v[20:23], v64 offset:18432
s_add_u32 s45, s45, 40960
s_cmp_ge_u32 s45, 122880
s_cselect_b32 s55, 122880, 0
s_sub_u32 s45, s45, s55
s_add_u32 s46, s46, 40960
v_mfma_f32_32x32x16_bf16 v[32:47], v[8:11], v[156:159], v[32:47]
s_waitcnt lgkmcnt(2)
ds_read_b128 v[24:27], v64 offset:19456
v_mfma_f32_32x32x16_bf16 v[32:47], v[12:15], v[160:163], v[32:47]
s_waitcnt lgkmcnt(2)
ds_read_b128 v[8:11], v64 offset:20480
v_mfma_f32_32x32x16_bf16 v[32:47], v[16:19], v[164:167], v[32:47]
s_waitcnt lgkmcnt(2)
ds_read_b128 v[12:15], v64 offset:21504
v_mfma_f32_32x32x16_bf16 v[32:47], v[20:23], v[168:171], v[32:47]
s_waitcnt lgkmcnt(2)
ds_read_b128 v[16:19], v64 offset:22528
v_mfma_f32_32x32x16_bf16 v[32:47], v[24:27], v[172:175], v[32:47]
s_waitcnt lgkmcnt(2)
ds_read_b128 v[20:23], v64 offset:23552
v_mfma_f32_32x32x16_bf16 v[32:47], v[8:11], v[176:179], v[32:47]
s_waitcnt lgkmcnt(2)
ds_read_b128 v[24:27], v64 offset:24576
v_mfma_f32_32x32x16_bf16 v[32:47], v[12:15], v[180:183], v[32:47]
s_waitcnt lgkmcnt(2)
ds_read_b128 v[8:11], v64 offset:25600
v_mfma_f32_32x32x16_bf16 v[32:47], v[16:19], v[184:187], v[32:47]
s_waitcnt lgkmcnt(2)
ds_read_b128 v[12:15], v64 offset:26624
v_mfma_f32_32x32x16_bf16 v[32:47], v[20:23], v[188:191], v[32:47]
s_waitcnt lgkmcnt(2)
ds_read_b128 v[16:19], v64 offset:27648
v_mfma_f32_32x32x16_bf16 v[32:47], v[24:27], v[192:195], v[32:47]
s_waitcnt lgkmcnt(2)
ds_read_b128 v[20:23], v64 offset:28672
v_mfma_f32_32x32x16_bf16 v[32:47], v[8:11], v[196:199], v[32:47]
s_waitcnt lgkmcnt(2)
ds_read_b128 v[24:27], v64 offset:29696
v_mfma_f32_32x32x16_bf16 v[32:47], v[12:15], v[200:203], v[32:47]
s_waitcnt lgkmcnt(2)
ds_read_b128 v[8:11], v64 offset:30720
v_mfma_f32_32x32x16_bf16 v[32:47], v[16:19], v[204:207], v[32:47]
s_waitcnt lgkmcnt(2)
ds_read_b128 v[12:15], v64 offset:31744
v_mfma_f32_32x32x16_bf16 v[32:47], v[20:23], v[208:211], v[32:47]
s_waitcnt lgkmcnt(2)
ds_read_b128 v[16:19], v64 offset:32768
v_mfma_f32_32x32x16_bf16 v[32:47], v[24:27], v[212:215], v[32:47]
s_waitcnt lgkmcnt(2)
ds_read_b128 v[20:23], v64 offset:33792
v_mfma_f32_32x32x16_bf16 v[32:47], v[8:11], v[216:219], v[32:47]
s_waitcnt lgkmcnt(2)
ds_read_b128 v[24:27], v64 offset:34816
v_mfma_f32_32x32x16_bf16 v[32:47], v[12:15], v[220:223], v[32:47]
s_waitcnt lgkmcnt(2)
ds_read_b128 v[8:11], v64 offset:35840
v_mfma_f32_32x32x16_bf16 v[32:47], v[16:19], v[224:227], v[32:47]
s_waitcnt lgkmcnt(2)
ds_read_b128 v[12:15], v64 offset:36864
v_mfma_f32_32x32x16_bf16 v[32:47], v[20:23], v[228:231], v[32:47]
s_waitcnt lgkmcnt(2)
ds_read_b128 v[16:19], v64 offset:37888
v_mfma_f32_32x32x16_bf16 v[32:47], v[24:27], v[232:235], v[32:47]
s_waitcnt lgkmcnt(2)
ds_read_b128 v[20:23], v64 offset:38912
v_mfma_f32_32x32x16_bf16 v[32:47], v[8:11], v[236:239], v[32:47]
s_waitcnt lgkmcnt(2)
ds_read_b128 v[24:27], v64 offset:39936
v_mfma_f32_32x32x16_bf16 v[32:47], v[12:15], v[240:243], v[32:47]
s_add_u32 s44, s44, 1
s_cmp_eq_u32 s44, 3
s_mov_b32 s56, 40960
s_cmov_b32 s56, -81920
s_cselect_b32 s44, 0, s44
v_add_u32 v64, s56, v64
s_waitcnt vmcnt(10) lgkmcnt(2)
s_barrier
ds_read_b128 v[8:11], v64 offset:0
v_mfma_f32_32x32x16_bf16 v[32:47], v[16:19], v[244:247], v[32:47]
s_waitcnt lgkmcnt(2)
ds_read_b128 v[12:15], v64 offset:1024
v_mfma_f32_32x32x16_bf16 v[32:47], v[20:23], v[248:251], v[32:47]
s_waitcnt lgkmcnt(2)
ds_read_b128 v[16:19], v64 offset:2048
v_mfma_f32_32x32x16_bf16 v[32:47], v[24:27], v[252:255], v[32:47]
s_waitcnt lgkmcnt(2)
ds_read_b128 v[20:23], v64 offset:3072
v_mfma_f32_32x32x16_bf16 v[48:63], v[8:11], v[96:99], 0
s_waitcnt lgkmcnt(2)
ds_read_b128 v[24:27], v64 offset:4096
v_mfma_f32_32x32x16_bf16 v[48:63], v[12:15], v[100:103], v[48:63]
s_waitcnt lgkmcnt(2)
ds_read_b128 v[8:11], v64 offset:5120
v_cvt_pk_bf16_f32 v32, v32, v33
v_cvt_pk_bf16_f32 v33, v34, v35
v_mfma_f32_32x32x16_bf16 v[48:63], v[16:19], v[104:107], v[48:63]
s_waitcnt lgkmcnt(2)
ds_read_b128 v[12:15], v64 offset:6144
v_cvt_pk_bf16_f32 v34, v36, v37
v_cvt_pk_bf16_f32 v35, v38, v39
v_mfma_f32_32x32x16_bf16 v[48:63], v[20:23], v[108:111], v[48:63]
s_waitcnt lgkmcnt(2)
ds_read_b128 v[16:19], v64 offset:7168
v_cvt_pk_bf16_f32 v36, v40, v41
v_cvt_pk_bf16_f32 v37, v42, v43
v_mfma_f32_32x32x16_bf16 v[48:63], v[24:27], v[112:115], v[48:63]
s_waitcnt lgkmcnt(2)
ds_read_b128 v[20:23], v64 offset:8192
v_cvt_pk_bf16_f32 v38, v44, v45
v_cvt_pk_bf16_f32 v39, v46, v47
v_mfma_f32_32x32x16_bf16 v[48:63], v[8:11], v[116:119], v[48:63]
s_waitcnt lgkmcnt(2)
ds_read_b128 v[24:27], v64 offset:9216
v_accvgpr_write_b32 a16, v32
v_accvgpr_write_b32 a17, v33
v_mfma_f32_32x32x16_bf16 v[48:63], v[12:15], v[120:123], v[48:63]
s_waitcnt lgkmcnt(2)
ds_read_b128 v[8:11], v64 offset:10240
v_accvgpr_write_b32 a18, v34
v_accvgpr_write_b32 a19, v35
v_mfma_f32_32x32x16_bf16 v[48:63], v[16:19], v[124:127], v[48:63]
s_waitcnt lgkmcnt(2)
ds_read_b128 v[12:15], v64 offset:11264
v_accvgpr_write_b32 a20, v36
v_accvgpr_write_b32 a21, v37
v_mfma_f32_32x32x16_bf16 v[48:63], v[20:23], v[128:131], v[48:63]
s_waitcnt lgkmcnt(2)
ds_read_b128 v[16:19], v64 offset:12288
v_accvgpr_write_b32 a22, v38
v_accvgpr_write_b32 a23, v39
v_mfma_f32_32x32x16_bf16 v[48:63], v[24:27], v[132:135], v[48:63]
s_waitcnt lgkmcnt(2)
ds_read_b128 v[20:23], v64 offset:13312
s_add_u32 m0, s45, 0
s_add_u32 s55, s46, 0
buffer_load_dwordx4 v0, s[4:7], s55 offen offset:0 sc1 lds
buffer_load_dwordx4 v0, s[4:7], s55 offen offset:1024 sc1 lds
v_mfma_f32_32x32x16_bf16 v[48:63], v[8:11], v[136:139], v[48:63]
s_waitcnt lgkmcnt(2)
ds_read_b128 v[24:27], v64 offset:14336
buffer_load_dwordx4 v0, s[4:7], s55 offen offset:2048 sc1 lds
buffer_load_dwordx4 v0, s[4:7], s55 offen offset:3072 sc1 lds
v_mfma_f32_32x32x16_bf16 v[48:63], v[12:15], v[140:143], v[48:63]
s_waitcnt lgkmcnt(2)
ds_read_b128 v[8:11], v64 offset:15360
s_add_u32 m0, s45, 4096
s_add_u32 s55, s46, 4096
buffer_load_dwordx4 v0, s[4:7], s55 offen offset:0 sc1 lds
buffer_load_dwordx4 v0, s[4:7], s55 offen offset:1024 sc1 lds
v_mfma_f32_32x32x16_bf16 v[48:63], v[16:19], v[144:147], v[48:63]
s_waitcnt lgkmcnt(2)
ds_read_b128 v[12:15], v64 offset:16384
buffer_load_dwordx4 v0, s[4:7], s55 offen offset:2048 sc1 lds
buffer_load_dwordx4 v0, s[4:7], s55 offen offset:3072 sc1 lds
v_mfma_f32_32x32x16_bf16 v[48:63], v[20:23], v[148:151], v[48:63]
s_waitcnt lgkmcnt(2)
ds_read_b128 v[16:19], v64 offset:17408
s_add_u32 m0, s45, 8192
s_add_u32 s55, s46, 8192
buffer_load_dwordx4 v0, s[4:7], s55 offen offset:0 sc1 lds
buffer_load_dwordx4 v0, s[4:7], s55 offen offset:1024 sc1 lds
v_mfma_f32_32x32x16_bf16 v[48:63], v[24:27], v[152:155], v[48:63]
s_waitcnt lgkmcnt(2)
ds_read_b128 v[20:23], v64 offset:18432
s_add_u32 s45, s45, 40960
s_cmp_ge_u32 s45, 122880
s_cselect_b32 s55, 122880, 0
s_sub_u32 s45, s45, s55
s_add_u32 s46, s46, 40960
v_mfma_f32_32x32x16_bf16 v[48:63], v[8:11], v[156:159], v[48:63]
s_waitcnt lgkmcnt(2)
ds_read_b128 v[24:27], v64 offset:19456
v_mfma_f32_32x32x16_bf16 v[48:63], v[12:15], v[160:163], v[48:63]
s_waitcnt lgkmcnt(2)
ds_read_b128 v[8:11], v64 offset:20480
v_mfma_f32_32x32x16_bf16 v[48:63], v[16:19], v[164:167], v[48:63]
s_waitcnt lgkmcnt(2)
ds_read_b128 v[12:15], v64 offset:21504
v_mfma_f32_32x32x16_bf16 v[48:63], v[20:23], v[168:171], v[48:63]
s_waitcnt lgkmcnt(2)
ds_read_b128 v[16:19], v64 offset:22528
v_mfma_f32_32x32x16_bf16 v[48:63], v[24:27], v[172:175], v[48:63]
s_waitcnt lgkmcnt(2)
ds_read_b128 v[20:23], v64 offset:23552
v_mfma_f32_32x32x16_bf16 v[48:63], v[8:11], v[176:179], v[48:63]
s_waitcnt lgkmcnt(2)
ds_read_b128 v[24:27], v64 offset:24576
v_mfma_f32_32x32x16_bf16 v[48:63], v[12:15], v[180:183], v[48:63]
s_waitcnt lgkmcnt(2)
ds_read_b128 v[8:11], v64 offset:25600
v_mfma_f32_32x32x16_bf16 v[48:63], v[16:19], v[184:187], v[48:63]
s_waitcnt lgkmcnt(2)
ds_read_b128 v[12:15], v64 offset:26624
v_mfma_f32_32x32x16_bf16 v[48:63], v[20:23], v[188:191], v[48:63]
s_waitcnt lgkmcnt(2)
ds_read_b128 v[16:19], v64 offset:27648
v_mfma_f32_32x32x16_bf16 v[48:63], v[24:27], v[192:195], v[48:63]
s_waitcnt lgkmcnt(2)
ds_read_b128 v[20:23], v64 offset:28672
v_mfma_f32_32x32x16_bf16 v[48:63], v[8:11], v[196:199], v[48:63]
s_waitcnt lgkmcnt(2)
ds_read_b128 v[24:27], v64 offset:29696
v_mfma_f32_32x32x16_bf16 v[48:63], v[12:15], v[200:203], v[48:63]
s_waitcnt lgkmcnt(2)
ds_read_b128 v[8:11], v64 offset:30720
v_mfma_f32_32x32x16_bf16 v[48:63], v[16:19], v[204:207], v[48:63]
s_waitcnt lgkmcnt(2)
ds_read_b128 v[12:15], v64 offset:31744
v_mfma_f32_32x32x16_bf16 v[48:63], v[20:23], v[208:211], v[48:63]
s_waitcnt lgkmcnt(2)
ds_read_b128 v[16:19], v64 offset:32768
v_mfma_f32_32x32x16_bf16 v[48:63], v[24:27], v[212:215], v[48:63]
s_waitcnt lgkmcnt(2)
ds_read_b128 v[20:23], v64 offset:33792
v_mfma_f32_32x32x16_bf16 v[48:63], v[8:11], v[216:219], v[48:63]
s_waitcnt lgkmcnt(2)
ds_read_b128 v[24:27], v64 offset:34816
v_mfma_f32_32x32x16_bf16 v[48:63], v[12:15], v[220:223], v[48:63]
s_waitcnt lgkmcnt(2)
ds_read_b128 v[8:11], v64 offset:35840
v_mfma_f32_32x32x16_bf16 v[48:63], v[16:19], v[224:227], v[48:63]
s_waitcnt lgkmcnt(2)
ds_read_b128 v[12:15], v64 offset:36864
v_mfma_f32_32x32x16_bf16 v[48:63], v[20:23], v[228:231], v[48:63]
s_waitcnt lgkmcnt(2)
ds_read_b128 v[16:19], v64 offset:37888
v_mfma_f32_32x32x16_bf16 v[48:63], v[24:27], v[232:235], v[48:63]
s_waitcnt lgkmcnt(2)
ds_read_b128 v[20:23], v64 offset:38912
v_mfma_f32_32x32x16_bf16 v[48:63], v[8:11], v[236:239], v[48:63]
s_waitcnt lgkmcnt(2)
ds_read_b128 v[24:27], v64 offset:39936
v_mfma_f32_32x32x16_bf16 v[48:63], v[12:15], v[240:243], v[48:63]
s_add_u32 s44, s44, 1
s_cmp_eq_u32 s44, 3
s_mov_b32 s56, 40960
s_cmov_b32 s56, -81920
s_cselect_b32 s44, 0, s44
v_add_u32 v64, s56, v64
s_waitcnt vmcnt(10) lgkmcnt(2)
s_barrier
ds_read_b128 v[8:11], v64 offset:0
v_mfma_f32_32x32x16_bf16 v[48:63], v[16:19], v[244:247], v[48:63]
s_waitcnt lgkmcnt(2)
ds_read_b128 v[12:15], v64 offset:1024
v_mfma_f32_32x32x16_bf16 v[48:63], v[20:23], v[248:251], v[48:63]
s_waitcnt lgkmcnt(2)
ds_read_b128 v[16:19], v64 offset:2048
v_mfma_f32_32x32x16_bf16 v[48:63], v[24:27], v[252:255], v[48:63]
s_waitcnt lgkmcnt(2)
ds_read_b128 v[20:23], v64 offset:3072
v_mfma_f32_32x32x16_bf16 v[32:47], v[8:11], v[96:99], 0
s_waitcnt lgkmcnt(2)
ds_read_b128 v[24:27], v64 offset:4096
v_mfma_f32_32x32x16_bf16 v[32:47], v[12:15], v[100:103], v[32:47]
s_waitcnt lgkmcnt(2)
ds_read_b128 v[8:11], v64 offset:5120
v_cvt_pk_bf16_f32 v48, v48, v49
v_cvt_pk_bf16_f32 v49, v50, v51
v_mfma_f32_32x32x16_bf16 v[32:47], v[16:19], v[104:107], v[32:47]
s_waitcnt lgkmcnt(2)
ds_read_b128 v[12:15], v64 offset:6144
v_cvt_pk_bf16_f32 v50, v52, v53
v_cvt_pk_bf16_f32 v51, v54, v55
v_mfma_f32_32x32x16_bf16 v[32:47], v[20:23], v[108:111], v[32:47]
s_waitcnt lgkmcnt(2)
ds_read_b128 v[16:19], v64 offset:7168
v_cvt_pk_bf16_f32 v52, v56, v57
v_cvt_pk_bf16_f32 v53, v58, v59
v_mfma_f32_32x32x16_bf16 v[32:47], v[24:27], v[112:115], v[32:47]
s_waitcnt lgkmcnt(2)
ds_read_b128 v[20:23], v64 offset:8192
v_cvt_pk_bf16_f32 v54, v60, v61
v_cvt_pk_bf16_f32 v55, v62, v63
v_mfma_f32_32x32x16_bf16 v[32:47], v[8:11], v[116:119], v[32:47]
s_waitcnt lgkmcnt(2)
ds_read_b128 v[24:27], v64 offset:9216
v_accvgpr_write_b32 a24, v48
v_accvgpr_write_b32 a25, v49
v_mfma_f32_32x32x16_bf16 v[32:47], v[12:15], v[120:123], v[32:47]
s_waitcnt lgkmcnt(2)
ds_read_b128 v[8:11], v64 offset:10240
v_accvgpr_write_b32 a26, v50
v_accvgpr_write_b32 a27, v51
v_mfma_f32_32x32x16_bf16 v[32:47], v[16:19], v[124:127], v[32:47]
s_waitcnt lgkmcnt(2)
ds_read_b128 v[12:15], v64 offset:11264
v_accvgpr_write_b32 a28, v52
v_accvgpr_write_b32 a29, v53
v_mfma_f32_32x32x16_bf16 v[32:47], v[20:23], v[128:131], v[32:47]
s_waitcnt lgkmcnt(2)
ds_read_b128 v[16:19], v64 offset:12288
v_accvgpr_write_b32 a30, v54
v_accvgpr_write_b32 a31, v55
v_mfma_f32_32x32x16_bf16 v[32:47], v[24:27], v[132:135], v[32:47]
s_waitcnt lgkmcnt(2)
ds_read_b128 v[20:23], v64 offset:13312
s_add_u32 m0, s45, 0
s_add_u32 s55, s46, 0
buffer_load_dwordx4 v0, s[4:7], s55 offen offset:0 sc1 lds
buffer_load_dwordx4 v0, s[4:7], s55 offen offset:1024 sc1 lds
v_mfma_f32_32x32x16_bf16 v[32:47], v[8:11], v[136:139], v[32:47]
s_waitcnt lgkmcnt(2)
ds_read_b128 v[24:27], v64 offset:14336
buffer_load_dwordx4 v0, s[4:7], s55 offen offset:2048 sc1 lds
buffer_load_dwordx4 v0, s[4:7], s55 offen offset:3072 sc1 lds
v_mfma_f32_32x32x16_bf16 v[32:47], v[12:15], v[140:143], v[32:47]
s_waitcnt lgkmcnt(2)
ds_read_b128 v[8:11], v64 offset:15360
s_add_u32 m0, s45, 4096
s_add_u32 s55, s46, 4096
buffer_load_dwordx4 v0, s[4:7], s55 offen offset:0 sc1 lds
buffer_load_dwordx4 v0, s[4:7], s55 offen offset:1024 sc1 lds
v_mfma_f32_32x32x16_bf16 v[32:47], v[16:19], v[144:147], v[32:47]
s_waitcnt lgkmcnt(2)
ds_read_b128 v[12:15], v64 offset:16384
buffer_load_dwordx4 v0, s[4:7], s55 offen offset:2048 sc1 lds
buffer_load_dwordx4 v0, s[4:7], s55 offen offset:3072 sc1 lds
v_mfma_f32_32x32x16_bf16 v[32:47], v[20:23], v[148:151], v[32:47]
s_waitcnt lgkmcnt(2)
ds_read_b128 v[16:19], v64 offset:17408
s_add_u32 m0, s45, 8192
s_add_u32 s55, s46, 8192
buffer_load_dwordx4 v0, s[4:7], s55 offen offset:0 sc1 lds
buffer_load_dwordx4 v0, s[4:7], s55 offen offset:1024 sc1 lds
v_mfma_f32_32x32x16_bf16 v[32:47], v[24:27], v[152:155], v[32:47]
s_waitcnt lgkmcnt(2)
ds_read_b128 v[20:23], v64 offset:18432
s_add_u32 s45, s45, 40960
s_cmp_ge_u32 s45, 122880
s_cselect_b32 s55, 122880, 0
s_sub_u32 s45, s45, s55
s_add_u32 s46, s46, 40960
v_mfma_f32_32x32x16_bf16 v[32:47], v[8:11], v[156:159], v[32:47]
s_waitcnt lgkmcnt(2)
ds_read_b128 v[24:27], v64 offset:19456
v_mfma_f32_32x32x16_bf16 v[32:47], v[12:15], v[160:163], v[32:47]
s_waitcnt lgkmcnt(2)
ds_read_b128 v[8:11], v64 offset:20480
v_mfma_f32_32x32x16_bf16 v[32:47], v[16:19], v[164:167], v[32:47]
s_waitcnt lgkmcnt(2)
ds_read_b128 v[12:15], v64 offset:21504
v_mfma_f32_32x32x16_bf16 v[32:47], v[20:23], v[168:171], v[32:47]
s_waitcnt lgkmcnt(2)
ds_read_b128 v[16:19], v64 offset:22528
v_mfma_f32_32x32x16_bf16 v[32:47], v[24:27], v[172:175], v[32:47]
s_waitcnt lgkmcnt(2)
ds_read_b128 v[20:23], v64 offset:23552
v_mfma_f32_32x32x16_bf16 v[32:47], v[8:11], v[176:179], v[32:47]
s_waitcnt lgkmcnt(2)
ds_read_b128 v[24:27], v64 offset:24576
v_mfma_f32_32x32x16_bf16 v[32:47], v[12:15], v[180:183], v[32:47]
s_waitcnt lgkmcnt(2)
ds_read_b128 v[8:11], v64 offset:25600
v_mfma_f32_32x32x16_bf16 v[32:47], v[16:19], v[184:187], v[32:47]
s_waitcnt lgkmcnt(2)
ds_read_b128 v[12:15], v64 offset:26624
v_mfma_f32_32x32x16_bf16 v[32:47], v[20:23], v[188:191], v[32:47]
s_waitcnt lgkmcnt(2)
ds_read_b128 v[16:19], v64 offset:27648
v_mfma_f32_32x32x16_bf16 v[32:47], v[24:27], v[192:195], v[32:47]
s_waitcnt lgkmcnt(2)
ds_read_b128 v[20:23], v64 offset:28672
v_mfma_f32_32x32x16_bf16 v[32:47], v[8:11], v[196:199], v[32:47]
s_waitcnt lgkmcnt(2)
ds_read_b128 v[24:27], v64 offset:29696
v_mfma_f32_32x32x16_bf16 v[32:47], v[12:15], v[200:203], v[32:47]
s_waitcnt lgkmcnt(2)
ds_read_b128 v[8:11], v64 offset:30720
v_mfma_f32_32x32x16_bf16 v[32:47], v[16:19], v[204:207], v[32:47]
s_waitcnt lgkmcnt(2)
ds_read_b128 v[12:15], v64 offset:31744
v_mfma_f32_32x32x16_bf16 v[32:47], v[20:23], v[208:211], v[32:47]
s_waitcnt lgkmcnt(2)
ds_read_b128 v[16:19], v64 offset:32768
v_mfma_f32_32x32x16_bf16 v[32:47], v[24:27], v[212:215], v[32:47]
s_waitcnt lgkmcnt(2)
ds_read_b128 v[20:23], v64 offset:33792
v_mfma_f32_32x32x16_bf16 v[32:47], v[8:11], v[216:219], v[32:47]
s_waitcnt lgkmcnt(2)
ds_read_b128 v[24:27], v64 offset:34816
v_mfma_f32_32x32x16_bf16 v[32:47], v[12:15], v[220:223], v[32:47]
s_waitcnt lgkmcnt(2)
ds_read_b128 v[8:11], v64 offset:35840
v_mfma_f32_32x32x16_bf16 v[32:47], v[16:19], v[224:227], v[32:47]
s_waitcnt lgkmcnt(2)
ds_read_b128 v[12:15], v64 offset:36864
v_mfma_f32_32x32x16_bf16 v[32:47], v[20:23], v[228:231], v[32:47]
s_waitcnt lgkmcnt(2)
ds_read_b128 v[16:19], v64 offset:37888
v_mfma_f32_32x32x16_bf16 v[32:47], v[24:27], v[232:235], v[32:47]
s_waitcnt lgkmcnt(2)
ds_read_b128 v[20:23], v64 offset:38912
v_mfma_f32_32x32x16_bf16 v[32:47], v[8:11], v[236:239], v[32:47]
s_waitcnt lgkmcnt(2)
ds_read_b128 v[24:27], v64 offset:39936
v_mfma_f32_32x32x16_bf16 v[32:47], v[12:15], v[240:243], v[32:47]
s_add_u32 s44, s44, 1
s_cmp_eq_u32 s44, 3
s_mov_b32 s56, 40960
s_cmov_b32 s56, -81920
s_cselect_b32 s44, 0, s44
v_add_u32 v64, s56, v64
s_waitcnt vmcnt(10) lgkmcnt(2)
s_barrier
ds_read_b128 v[8:11], v64 offset:0
v_mfma_f32_32x32x16_bf16 v[32:47], v[16:19], v[244:247], v[32:47]
s_waitcnt lgkmcnt(2)
ds_read_b128 v[12:15], v64 offset:1024
v_mfma_f32_32x32x16_bf16 v[32:47], v[20:23], v[248:251], v[32:47]
s_waitcnt lgkmcnt(2)
ds_read_b128 v[16:19], v64 offset:2048
v_mfma_f32_32x32x16_bf16 v[32:47], v[24:27], v[252:255], v[32:47]
s_waitcnt lgkmcnt(2)
ds_read_b128 v[20:23], v64 offset:3072
v_mfma_f32_32x32x16_bf16 v[48:63], v[8:11], v[96:99], 0
s_waitcnt lgkmcnt(2)
ds_read_b128 v[24:27], v64 offset:4096
v_mfma_f32_32x32x16_bf16 v[48:63], v[12:15], v[100:103], v[48:63]
s_waitcnt lgkmcnt(2)
ds_read_b128 v[8:11], v64 offset:5120
v_cvt_pk_bf16_f32 v32, v32, v33
v_cvt_pk_bf16_f32 v33, v34, v35
v_mfma_f32_32x32x16_bf16 v[48:63], v[16:19], v[104:107], v[48:63]
s_waitcnt lgkmcnt(2)
ds_read_b128 v[12:15], v64 offset:6144
v_cvt_pk_bf16_f32 v34, v36, v37
v_cvt_pk_bf16_f32 v35, v38, v39
v_mfma_f32_32x32x16_bf16 v[48:63], v[20:23], v[108:111], v[48:63]
s_waitcnt lgkmcnt(2)
ds_read_b128 v[16:19], v64 offset:7168
v_cvt_pk_bf16_f32 v36, v40, v41
v_cvt_pk_bf16_f32 v37, v42, v43
v_mfma_f32_32x32x16_bf16 v[48:63], v[24:27], v[112:115], v[48:63]
s_waitcnt lgkmcnt(2)
ds_read_b128 v[20:23], v64 offset:8192
v_cvt_pk_bf16_f32 v38, v44, v45
v_cvt_pk_bf16_f32 v39, v46, v47
v_mfma_f32_32x32x16_bf16 v[48:63], v[8:11], v[116:119], v[48:63]
s_waitcnt lgkmcnt(2)
ds_read_b128 v[24:27], v64 offset:9216
v_accvgpr_write_b32 a32, v32
v_accvgpr_write_b32 a33, v33
v_mfma_f32_32x32x16_bf16 v[48:63], v[12:15], v[120:123], v[48:63]
s_waitcnt lgkmcnt(2)
ds_read_b128 v[8:11], v64 offset:10240
v_accvgpr_write_b32 a34, v34
v_accvgpr_write_b32 a35, v35
v_mfma_f32_32x32x16_bf16 v[48:63], v[16:19], v[124:127], v[48:63]
s_waitcnt lgkmcnt(2)
ds_read_b128 v[12:15], v64 offset:11264
v_accvgpr_write_b32 a36, v36
v_accvgpr_write_b32 a37, v37
v_mfma_f32_32x32x16_bf16 v[48:63], v[20:23], v[128:131], v[48:63]
s_waitcnt lgkmcnt(2)
ds_read_b128 v[16:19], v64 offset:12288
v_accvgpr_write_b32 a38, v38
v_accvgpr_write_b32 a39, v39
v_mfma_f32_32x32x16_bf16 v[48:63], v[24:27], v[132:135], v[48:63]
s_waitcnt lgkmcnt(2)
ds_read_b128 v[20:23], v64 offset:13312
s_add_u32 m0, s45, 0
s_add_u32 s55, s46, 0
buffer_load_dwordx4 v0, s[4:7], s55 offen offset:0 sc1 lds
buffer_load_dwordx4 v0, s[4:7], s55 offen offset:1024 sc1 lds
v_mfma_f32_32x32x16_bf16 v[48:63], v[8:11], v[136:139], v[48:63]
s_waitcnt lgkmcnt(2)
ds_read_b128 v[24:27], v64 offset:14336
buffer_load_dwordx4 v0, s[4:7], s55 offen offset:2048 sc1 lds
buffer_load_dwordx4 v0, s[4:7], s55 offen offset:3072 sc1 lds
v_mfma_f32_32x32x16_bf16 v[48:63], v[12:15], v[140:143], v[48:63]
s_waitcnt lgkmcnt(2)
ds_read_b128 v[8:11], v64 offset:15360
s_add_u32 m0, s45, 4096
s_add_u32 s55, s46, 4096
buffer_load_dwordx4 v0, s[4:7], s55 offen offset:0 sc1 lds
buffer_load_dwordx4 v0, s[4:7], s55 offen offset:1024 sc1 lds
v_mfma_f32_32x32x16_bf16 v[48:63], v[16:19], v[144:147], v[48:63]
s_waitcnt lgkmcnt(2)
ds_read_b128 v[12:15], v64 offset:16384
buffer_load_dwordx4 v0, s[4:7], s55 offen offset:2048 sc1 lds
buffer_load_dwordx4 v0, s[4:7], s55 offen offset:3072 sc1 lds
v_mfma_f32_32x32x16_bf16 v[48:63], v[20:23], v[148:151], v[48:63]
s_waitcnt lgkmcnt(2)
ds_read_b128 v[16:19], v64 offset:17408
s_add_u32 m0, s45, 8192
s_add_u32 s55, s46, 8192
buffer_load_dwordx4 v0, s[4:7], s55 offen offset:0 sc1 lds
buffer_load_dwordx4 v0, s[4:7], s55 offen offset:1024 sc1 lds
v_mfma_f32_32x32x16_bf16 v[48:63], v[24:27], v[152:155], v[48:63]
s_waitcnt lgkmcnt(2)
ds_read_b128 v[20:23], v64 offset:18432
s_add_u32 s45, s45, 40960
s_cmp_ge_u32 s45, 122880
s_cselect_b32 s55, 122880, 0
s_sub_u32 s45, s45, s55
s_add_u32 s46, s46, 40960
v_mfma_f32_32x32x16_bf16 v[48:63], v[8:11], v[156:159], v[48:63]
s_waitcnt lgkmcnt(2)
ds_read_b128 v[24:27], v64 offset:19456
v_mfma_f32_32x32x16_bf16 v[48:63], v[12:15], v[160:163], v[48:63]
s_waitcnt lgkmcnt(2)
ds_read_b128 v[8:11], v64 offset:20480
v_mfma_f32_32x32x16_bf16 v[48:63], v[16:19], v[164:167], v[48:63]
s_waitcnt lgkmcnt(2)
ds_read_b128 v[12:15], v64 offset:21504
v_mfma_f32_32x32x16_bf16 v[48:63], v[20:23], v[168:171], v[48:63]
s_waitcnt lgkmcnt(2)
ds_read_b128 v[16:19], v64 offset:22528
v_mfma_f32_32x32x16_bf16 v[48:63], v[24:27], v[172:175], v[48:63]
s_waitcnt lgkmcnt(2)
ds_read_b128 v[20:23], v64 offset:23552
v_mfma_f32_32x32x16_bf16 v[48:63], v[8:11], v[176:179], v[48:63]
s_waitcnt lgkmcnt(2)
ds_read_b128 v[24:27], v64 offset:24576
v_mfma_f32_32x32x16_bf16 v[48:63], v[12:15], v[180:183], v[48:63]
s_waitcnt lgkmcnt(2)
ds_read_b128 v[8:11], v64 offset:25600
v_mfma_f32_32x32x16_bf16 v[48:63], v[16:19], v[184:187], v[48:63]
s_waitcnt lgkmcnt(2)
ds_read_b128 v[12:15], v64 offset:26624
v_mfma_f32_32x32x16_bf16 v[48:63], v[20:23], v[188:191], v[48:63]
s_waitcnt lgkmcnt(2)
ds_read_b128 v[16:19], v64 offset:27648
v_mfma_f32_32x32x16_bf16 v[48:63], v[24:27], v[192:195], v[48:63]
s_waitcnt lgkmcnt(2)
ds_read_b128 v[20:23], v64 offset:28672
v_mfma_f32_32x32x16_bf16 v[48:63], v[8:11], v[196:199], v[48:63]
s_waitcnt lgkmcnt(2)
ds_read_b128 v[24:27], v64 offset:29696
v_mfma_f32_32x32x16_bf16 v[48:63], v[12:15], v[200:203], v[48:63]
s_waitcnt lgkmcnt(2)
ds_read_b128 v[8:11], v64 offset:30720
v_mfma_f32_32x32x16_bf16 v[48:63], v[16:19], v[204:207], v[48:63]
s_waitcnt lgkmcnt(2)
ds_read_b128 v[12:15], v64 offset:31744
v_mfma_f32_32x32x16_bf16 v[48:63], v[20:23], v[208:211], v[48:63]
s_waitcnt lgkmcnt(2)
ds_read_b128 v[16:19], v64 offset:32768
v_mfma_f32_32x32x16_bf16 v[48:63], v[24:27], v[212:215], v[48:63]
s_waitcnt lgkmcnt(2)
ds_read_b128 v[20:23], v64 offset:33792
v_mfma_f32_32x32x16_bf16 v[48:63], v[8:11], v[216:219], v[48:63]
s_waitcnt lgkmcnt(2)
ds_read_b128 v[24:27], v64 offset:34816
v_mfma_f32_32x32x16_bf16 v[48:63], v[12:15], v[220:223], v[48:63]
s_waitcnt lgkmcnt(2)
ds_read_b128 v[8:11], v64 offset:35840
v_mfma_f32_32x32x16_bf16 v[48:63], v[16:19], v[224:227], v[48:63]
s_waitcnt lgkmcnt(2)
ds_read_b128 v[12:15], v64 offset:36864
v_mfma_f32_32x32x16_bf16 v[48:63], v[20:23], v[228:231], v[48:63]
s_waitcnt lgkmcnt(2)
ds_read_b128 v[16:19], v64 offset:37888
v_mfma_f32_32x32x16_bf16 v[48:63], v[24:27], v[232:235], v[48:63]
s_waitcnt lgkmcnt(2)
ds_read_b128 v[20:23], v64 offset:38912
v_mfma_f32_32x32x16_bf16 v[48:63], v[8:11], v[236:239], v[48:63]
s_waitcnt lgkmcnt(2)
ds_read_b128 v[24:27], v64 offset:39936
v_mfma_f32_32x32x16_bf16 v[48:63], v[12:15], v[240:243], v[48:63]
s_add_u32 s44, s44, 1
s_cmp_eq_u32 s44, 3
s_mov_b32 s56, 40960
s_cmov_b32 s56, -81920
s_cselect_b32 s44, 0, s44
v_add_u32 v64, s56, v64
s_waitcnt vmcnt(10) lgkmcnt(2)
s_barrier
ds_read_b128 v[8:11], v64 offset:0
v_mfma_f32_32x32x16_bf16 v[48:63], v[16:19], v[244:247], v[48:63]
s_waitcnt lgkmcnt(2)
ds_read_b128 v[12:15], v64 offset:1024
v_mfma_f32_32x32x16_bf16 v[48:63], v[20:23], v[248:251], v[48:63]
s_waitcnt lgkmcnt(2)
ds_read_b128 v[16:19], v64 offset:2048
v_mfma_f32_32x32x16_bf16 v[48:63], v[24:27], v[252:255], v[48:63]
s_waitcnt lgkmcnt(2)
ds_read_b128 v[20:23], v64 offset:3072
v_mfma_f32_32x32x16_bf16 v[32:47], v[8:11], v[96:99], 0
s_waitcnt lgkmcnt(2)
ds_read_b128 v[24:27], v64 offset:4096
v_mfma_f32_32x32x16_bf16 v[32:47], v[12:15], v[100:103], v[32:47]
s_waitcnt lgkmcnt(2)
ds_read_b128 v[8:11], v64 offset:5120
v_cvt_pk_bf16_f32 v48, v48, v49
v_cvt_pk_bf16_f32 v49, v50, v51
v_mfma_f32_32x32x16_bf16 v[32:47], v[16:19], v[104:107], v[32:47]
s_waitcnt lgkmcnt(2)
ds_read_b128 v[12:15], v64 offset:6144
v_cvt_pk_bf16_f32 v50, v52, v53
v_cvt_pk_bf16_f32 v51, v54, v55
v_mfma_f32_32x32x16_bf16 v[32:47], v[20:23], v[108:111], v[32:47]
s_waitcnt lgkmcnt(2)
ds_read_b128 v[16:19], v64 offset:7168
v_cvt_pk_bf16_f32 v52, v56, v57
v_cvt_pk_bf16_f32 v53, v58, v59
v_mfma_f32_32x32x16_bf16 v[32:47], v[24:27], v[112:115], v[32:47]
s_waitcnt lgkmcnt(2)
ds_read_b128 v[20:23], v64 offset:8192
v_cvt_pk_bf16_f32 v54, v60, v61
v_cvt_pk_bf16_f32 v55, v62, v63
v_mfma_f32_32x32x16_bf16 v[32:47], v[8:11], v[116:119], v[32:47]
s_waitcnt lgkmcnt(2)
ds_read_b128 v[24:27], v64 offset:9216
v_accvgpr_write_b32 a40, v48
v_accvgpr_write_b32 a41, v49
v_mfma_f32_32x32x16_bf16 v[32:47], v[12:15], v[120:123], v[32:47]
s_waitcnt lgkmcnt(2)
ds_read_b128 v[8:11], v64 offset:10240
v_accvgpr_write_b32 a42, v50
v_accvgpr_write_b32 a43, v51
v_mfma_f32_32x32x16_bf16 v[32:47], v[16:19], v[124:127], v[32:47]
s_waitcnt lgkmcnt(2)
ds_read_b128 v[12:15], v64 offset:11264
v_accvgpr_write_b32 a44, v52
v_accvgpr_write_b32 a45, v53
v_mfma_f32_32x32x16_bf16 v[32:47], v[20:23], v[128:131], v[32:47]
s_waitcnt lgkmcnt(2)
ds_read_b128 v[16:19], v64 offset:12288
v_accvgpr_write_b32 a46, v54
v_accvgpr_write_b32 a47, v55
v_mfma_f32_32x32x16_bf16 v[32:47], v[24:27], v[132:135], v[32:47]
s_waitcnt lgkmcnt(2)
ds_read_b128 v[20:23], v64 offset:13312
s_add_u32 m0, s45, 0
s_add_u32 s55, s46, 0
buffer_load_dwordx4 v0, s[4:7], s55 offen offset:0 sc1 lds
buffer_load_dwordx4 v0, s[4:7], s55 offen offset:1024 sc1 lds
v_mfma_f32_32x32x16_bf16 v[32:47], v[8:11], v[136:139], v[32:47]
s_waitcnt lgkmcnt(2)
ds_read_b128 v[24:27], v64 offset:14336
buffer_load_dwordx4 v0, s[4:7], s55 offen offset:2048 sc1 lds
buffer_load_dwordx4 v0, s[4:7], s55 offen offset:3072 sc1 lds
v_mfma_f32_32x32x16_bf16 v[32:47], v[12:15], v[140:143], v[32:47]
s_waitcnt lgkmcnt(2)
ds_read_b128 v[8:11], v64 offset:15360
s_add_u32 m0, s45, 4096
s_add_u32 s55, s46, 4096
buffer_load_dwordx4 v0, s[4:7], s55 offen offset:0 sc1 lds
buffer_load_dwordx4 v0, s[4:7], s55 offen offset:1024 sc1 lds
v_mfma_f32_32x32x16_bf16 v[32:47], v[16:19], v[144:147], v[32:47]
s_waitcnt lgkmcnt(2)
ds_read_b128 v[12:15], v64 offset:16384
buffer_load_dwordx4 v0, s[4:7], s55 offen offset:2048 sc1 lds
buffer_load_dwordx4 v0, s[4:7], s55 offen offset:3072 sc1 lds
v_mfma_f32_32x32x16_bf16 v[32:47], v[20:23], v[148:151], v[32:47]
s_waitcnt lgkmcnt(2)
ds_read_b128 v[16:19], v64 offset:17408
s_add_u32 m0, s45, 8192
s_add_u32 s55, s46, 8192
buffer_load_dwordx4 v0, s[4:7], s55 offen offset:0 sc1 lds
buffer_load_dwordx4 v0, s[4:7], s55 offen offset:1024 sc1 lds
v_mfma_f32_32x32x16_bf16 v[32:47], v[24:27], v[152:155], v[32:47]
s_waitcnt lgkmcnt(2)
ds_read_b128 v[20:23], v64 offset:18432
s_add_u32 s45, s45, 40960
s_cmp_ge_u32 s45, 122880
s_cselect_b32 s55, 122880, 0
s_sub_u32 s45, s45, s55
s_add_u32 s46, s46, 40960
v_mfma_f32_32x32x16_bf16 v[32:47], v[8:11], v[156:159], v[32:47]
s_waitcnt lgkmcnt(2)
ds_read_b128 v[24:27], v64 offset:19456
v_mfma_f32_32x32x16_bf16 v[32:47], v[12:15], v[160:163], v[32:47]
s_waitcnt lgkmcnt(2)
ds_read_b128 v[8:11], v64 offset:20480
v_mfma_f32_32x32x16_bf16 v[32:47], v[16:19], v[164:167], v[32:47]
s_waitcnt lgkmcnt(2)
ds_read_b128 v[12:15], v64 offset:21504
v_mfma_f32_32x32x16_bf16 v[32:47], v[20:23], v[168:171], v[32:47]
s_waitcnt lgkmcnt(2)
ds_read_b128 v[16:19], v64 offset:22528
v_mfma_f32_32x32x16_bf16 v[32:47], v[24:27], v[172:175], v[32:47]
s_waitcnt lgkmcnt(2)
ds_read_b128 v[20:23], v64 offset:23552
v_mfma_f32_32x32x16_bf16 v[32:47], v[8:11], v[176:179], v[32:47]
s_waitcnt lgkmcnt(2)
ds_read_b128 v[24:27], v64 offset:24576
v_mfma_f32_32x32x16_bf16 v[32:47], v[12:15], v[180:183], v[32:47]
s_waitcnt lgkmcnt(2)
ds_read_b128 v[8:11], v64 offset:25600
v_mfma_f32_32x32x16_bf16 v[32:47], v[16:19], v[184:187], v[32:47]
s_waitcnt lgkmcnt(2)
ds_read_b128 v[12:15], v64 offset:26624
v_mfma_f32_32x32x16_bf16 v[32:47], v[20:23], v[188:191], v[32:47]
s_waitcnt lgkmcnt(2)
ds_read_b128 v[16:19], v64 offset:27648
v_mfma_f32_32x32x16_bf16 v[32:47], v[24:27], v[192:195], v[32:47]
s_waitcnt lgkmcnt(2)
ds_read_b128 v[20:23], v64 offset:28672
v_mfma_f32_32x32x16_bf16 v[32:47], v[8:11], v[196:199], v[32:47]
s_waitcnt lgkmcnt(2)
ds_read_b128 v[24:27], v64 offset:29696
v_mfma_f32_32x32x16_bf16 v[32:47], v[12:15], v[200:203], v[32:47]
s_waitcnt lgkmcnt(2)
ds_read_b128 v[8:11], v64 offset:30720
v_mfma_f32_32x32x16_bf16 v[32:47], v[16:19], v[204:207], v[32:47]
s_waitcnt lgkmcnt(2)
ds_read_b128 v[12:15], v64 offset:31744
v_mfma_f32_32x32x16_bf16 v[32:47], v[20:23], v[208:211], v[32:47]
s_waitcnt lgkmcnt(2)
ds_read_b128 v[16:19], v64 offset:32768
v_mfma_f32_32x32x16_bf16 v[32:47], v[24:27], v[212:215], v[32:47]
s_waitcnt lgkmcnt(2)
ds_read_b128 v[20:23], v64 offset:33792
v_mfma_f32_32x32x16_bf16 v[32:47], v[8:11], v[216:219], v[32:47]
s_waitcnt lgkmcnt(2)
ds_read_b128 v[24:27], v64 offset:34816
v_mfma_f32_32x32x16_bf16 v[32:47], v[12:15], v[220:223], v[32:47]
s_waitcnt lgkmcnt(2)
ds_read_b128 v[8:11], v64 offset:35840
v_mfma_f32_32x32x16_bf16 v[32:47], v[16:19], v[224:227], v[32:47]
s_waitcnt lgkmcnt(2)
ds_read_b128 v[12:15], v64 offset:36864
v_mfma_f32_32x32x16_bf16 v[32:47], v[20:23], v[228:231], v[32:47]
s_waitcnt lgkmcnt(2)
ds_read_b128 v[16:19], v64 offset:37888
v_mfma_f32_32x32x16_bf16 v[32:47], v[24:27], v[232:235], v[32:47]
s_waitcnt lgkmcnt(2)
ds_read_b128 v[20:23], v64 offset:38912
v_mfma_f32_32x32x16_bf16 v[32:47], v[8:11], v[236:239], v[32:47]
s_waitcnt lgkmcnt(2)
ds_read_b128 v[24:27], v64 offset:39936
v_mfma_f32_32x32x16_bf16 v[32:47], v[12:15], v[240:243], v[32:47]
s_add_u32 s44, s44, 1
s_cmp_eq_u32 s44, 3
s_mov_b32 s56, 40960
s_cmov_b32 s56, -81920
s_cselect_b32 s44, 0, s44
v_add_u32 v64, s56, v64
s_waitcnt vmcnt(10) lgkmcnt(2)
s_barrier
ds_read_b128 v[8:11], v64 offset:0
v_mfma_f32_32x32x16_bf16 v[32:47], v[16:19], v[244:247], v[32:47]
s_waitcnt lgkmcnt(2)
ds_read_b128 v[12:15], v64 offset:1024
v_mfma_f32_32x32x16_bf16 v[32:47], v[20:23], v[248:251], v[32:47]
s_waitcnt lgkmcnt(2)
ds_read_b128 v[16:19], v64 offset:2048
v_mfma_f32_32x32x16_bf16 v[32:47], v[24:27], v[252:255], v[32:47]
s_waitcnt lgkmcnt(2)
ds_read_b128 v[20:23], v64 offset:3072
v_mfma_f32_32x32x16_bf16 v[48:63], v[8:11], v[96:99], 0
s_waitcnt lgkmcnt(2)
ds_read_b128 v[24:27], v64 offset:4096
v_mfma_f32_32x32x16_bf16 v[48:63], v[12:15], v[100:103], v[48:63]
s_waitcnt lgkmcnt(2)
ds_read_b128 v[8:11], v64 offset:5120
v_cvt_pk_bf16_f32 v32, v32, v33
v_cvt_pk_bf16_f32 v33, v34, v35
v_mfma_f32_32x32x16_bf16 v[48:63], v[16:19], v[104:107], v[48:63]
s_waitcnt lgkmcnt(2)
ds_read_b128 v[12:15], v64 offset:6144
v_cvt_pk_bf16_f32 v34, v36, v37
v_cvt_pk_bf16_f32 v35, v38, v39
v_mfma_f32_32x32x16_bf16 v[48:63], v[20:23], v[108:111], v[48:63]
s_waitcnt lgkmcnt(2)
ds_read_b128 v[16:19], v64 offset:7168
v_cvt_pk_bf16_f32 v36, v40, v41
v_cvt_pk_bf16_f32 v37, v42, v43
v_mfma_f32_32x32x16_bf16 v[48:63], v[24:27], v[112:115], v[48:63]
s_waitcnt lgkmcnt(2)
ds_read_b128 v[20:23], v64 offset:8192
v_cvt_pk_bf16_f32 v38, v44, v45
v_cvt_pk_bf16_f32 v39, v46, v47
v_mfma_f32_32x32x16_bf16 v[48:63], v[8:11], v[116:119], v[48:63]
s_waitcnt lgkmcnt(2)
ds_read_b128 v[24:27], v64 offset:9216
v_accvgpr_write_b32 a48, v32
v_accvgpr_write_b32 a49, v33
v_mfma_f32_32x32x16_bf16 v[48:63], v[12:15], v[120:123], v[48:63]
s_waitcnt lgkmcnt(2)
ds_read_b128 v[8:11], v64 offset:10240
v_accvgpr_write_b32 a50, v34
v_accvgpr_write_b32 a51, v35
v_mfma_f32_32x32x16_bf16 v[48:63], v[16:19], v[124:127], v[48:63]
s_waitcnt lgkmcnt(2)
ds_read_b128 v[12:15], v64 offset:11264
v_accvgpr_write_b32 a52, v36
v_accvgpr_write_b32 a53, v37
v_mfma_f32_32x32x16_bf16 v[48:63], v[20:23], v[128:131], v[48:63]
s_waitcnt lgkmcnt(2)
ds_read_b128 v[16:19], v64 offset:12288
v_accvgpr_write_b32 a54, v38
v_accvgpr_write_b32 a55, v39
v_mfma_f32_32x32x16_bf16 v[48:63], v[24:27], v[132:135], v[48:63]
s_waitcnt lgkmcnt(2)
ds_read_b128 v[20:23], v64 offset:13312
s_add_u32 m0, s45, 0
s_add_u32 s55, s46, 0
buffer_load_dwordx4 v0, s[4:7], s55 offen offset:0 sc1 lds
buffer_load_dwordx4 v0, s[4:7], s55 offen offset:1024 sc1 lds
v_mfma_f32_32x32x16_bf16 v[48:63], v[8:11], v[136:139], v[48:63]
s_waitcnt lgkmcnt(2)
ds_read_b128 v[24:27], v64 offset:14336
buffer_load_dwordx4 v0, s[4:7], s55 offen offset:2048 sc1 lds
buffer_load_dwordx4 v0, s[4:7], s55 offen offset:3072 sc1 lds
v_mfma_f32_32x32x16_bf16 v[48:63], v[12:15], v[140:143], v[48:63]
s_waitcnt lgkmcnt(2)
ds_read_b128 v[8:11], v64 offset:15360
s_add_u32 m0, s45, 4096
s_add_u32 s55, s46, 4096
buffer_load_dwordx4 v0, s[4:7], s55 offen offset:0 sc1 lds
buffer_load_dwordx4 v0, s[4:7], s55 offen offset:1024 sc1 lds
v_mfma_f32_32x32x16_bf16 v[48:63], v[16:19], v[144:147], v[48:63]
s_waitcnt lgkmcnt(2)
ds_read_b128 v[12:15], v64 offset:16384
buffer_load_dwordx4 v0, s[4:7], s55 offen offset:2048 sc1 lds
buffer_load_dwordx4 v0, s[4:7], s55 offen offset:3072 sc1 lds
v_mfma_f32_32x32x16_bf16 v[48:63], v[20:23], v[148:151], v[48:63]
s_waitcnt lgkmcnt(2)
ds_read_b128 v[16:19], v64 offset:17408
s_add_u32 m0, s45, 8192
s_add_u32 s55, s46, 8192
buffer_load_dwordx4 v0, s[4:7], s55 offen offset:0 sc1 lds
buffer_load_dwordx4 v0, s[4:7], s55 offen offset:1024 sc1 lds
v_mfma_f32_32x32x16_bf16 v[48:63], v[24:27], v[152:155], v[48:63]
s_waitcnt lgkmcnt(2)
ds_read_b128 v[20:23], v64 offset:18432
s_add_u32 s45, s45, 40960
s_cmp_ge_u32 s45, 122880
s_cselect_b32 s55, 122880, 0
s_sub_u32 s45, s45, s55
s_add_u32 s46, s46, 40960
v_mfma_f32_32x32x16_bf16 v[48:63], v[8:11], v[156:159], v[48:63]
s_waitcnt lgkmcnt(2)
ds_read_b128 v[24:27], v64 offset:19456
v_mfma_f32_32x32x16_bf16 v[48:63], v[12:15], v[160:163], v[48:63]
s_waitcnt lgkmcnt(2)
ds_read_b128 v[8:11], v64 offset:20480
v_mfma_f32_32x32x16_bf16 v[48:63], v[16:19], v[164:167], v[48:63]
s_waitcnt lgkmcnt(2)
ds_read_b128 v[12:15], v64 offset:21504
v_mfma_f32_32x32x16_bf16 v[48:63], v[20:23], v[168:171], v[48:63]
s_waitcnt lgkmcnt(2)
ds_read_b128 v[16:19], v64 offset:22528
v_mfma_f32_32x32x16_bf16 v[48:63], v[24:27], v[172:175], v[48:63]
s_waitcnt lgkmcnt(2)
ds_read_b128 v[20:23], v64 offset:23552
v_mfma_f32_32x32x16_bf16 v[48:63], v[8:11], v[176:179], v[48:63]
s_waitcnt lgkmcnt(2)
ds_read_b128 v[24:27], v64 offset:24576
v_mfma_f32_32x32x16_bf16 v[48:63], v[12:15], v[180:183], v[48:63]
s_waitcnt lgkmcnt(2)
ds_read_b128 v[8:11], v64 offset:25600
v_mfma_f32_32x32x16_bf16 v[48:63], v[16:19], v[184:187], v[48:63]
s_waitcnt lgkmcnt(2)
ds_read_b128 v[12:15], v64 offset:26624
v_mfma_f32_32x32x16_bf16 v[48:63], v[20:23], v[188:191], v[48:63]
s_waitcnt lgkmcnt(2)
ds_read_b128 v[16:19], v64 offset:27648
v_mfma_f32_32x32x16_bf16 v[48:63], v[24:27], v[192:195], v[48:63]
s_waitcnt lgkmcnt(2)
ds_read_b128 v[20:23], v64 offset:28672
v_mfma_f32_32x32x16_bf16 v[48:63], v[8:11], v[196:199], v[48:63]
s_waitcnt lgkmcnt(2)
ds_read_b128 v[24:27], v64 offset:29696
v_mfma_f32_32x32x16_bf16 v[48:63], v[12:15], v[200:203], v[48:63]
s_waitcnt lgkmcnt(2)
ds_read_b128 v[8:11], v64 offset:30720
v_mfma_f32_32x32x16_bf16 v[48:63], v[16:19], v[204:207], v[48:63]
s_waitcnt lgkmcnt(2)
ds_read_b128 v[12:15], v64 offset:31744
v_mfma_f32_32x32x16_bf16 v[48:63], v[20:23], v[208:211], v[48:63]
s_waitcnt lgkmcnt(2)
ds_read_b128 v[16:19], v64 offset:32768
v_mfma_f32_32x32x16_bf16 v[48:63], v[24:27], v[212:215], v[48:63]
s_waitcnt lgkmcnt(2)
ds_read_b128 v[20:23], v64 offset:33792
v_mfma_f32_32x32x16_bf16 v[48:63], v[8:11], v[216:219], v[48:63]
s_waitcnt lgkmcnt(2)
ds_read_b128 v[24:27], v64 offset:34816
v_mfma_f32_32x32x16_bf16 v[48:63], v[12:15], v[220:223], v[48:63]
s_waitcnt lgkmcnt(2)
ds_read_b128 v[8:11], v64 offset:35840
v_mfma_f32_32x32x16_bf16 v[48:63], v[16:19], v[224:227], v[48:63]
s_waitcnt lgkmcnt(2)
ds_read_b128 v[12:15], v64 offset:36864
v_mfma_f32_32x32x16_bf16 v[48:63], v[20:23], v[228:231], v[48:63]
s_waitcnt lgkmcnt(2)
ds_read_b128 v[16:19], v64 offset:37888
v_mfma_f32_32x32x16_bf16 v[48:63], v[24:27], v[232:235], v[48:63]
s_waitcnt lgkmcnt(2)
ds_read_b128 v[20:23], v64 offset:38912
v_mfma_f32_32x32x16_bf16 v[48:63], v[8:11], v[236:239], v[48:63]
s_waitcnt lgkmcnt(2)
ds_read_b128 v[24:27], v64 offset:39936
v_mfma_f32_32x32x16_bf16 v[48:63], v[12:15], v[240:243], v[48:63]
s_add_u32 s44, s44, 1
s_cmp_eq_u32 s44, 3
s_mov_b32 s56, 40960
s_cmov_b32 s56, -81920
s_cselect_b32 s44, 0, s44
v_add_u32 v64, s56, v64
s_waitcnt vmcnt(10) lgkmcnt(2)
s_barrier
ds_read_b128 v[8:11], v64 offset:0
v_mfma_f32_32x32x16_bf16 v[48:63], v[16:19], v[244:247], v[48:63]
s_waitcnt lgkmcnt(2)
ds_read_b128 v[12:15], v64 offset:1024
v_mfma_f32_32x32x16_bf16 v[48:63], v[20:23], v[248:251], v[48:63]
s_waitcnt lgkmcnt(2)
ds_read_b128 v[16:19], v64 offset:2048
v_mfma_f32_32x32x16_bf16 v[48:63], v[24:27], v[252:255], v[48:63]
s_waitcnt lgkmcnt(2)
ds_read_b128 v[20:23], v64 offset:3072
v_mfma_f32_32x32x16_bf16 v[32:47], v[8:11], v[96:99], 0
s_waitcnt lgkmcnt(2)
ds_read_b128 v[24:27], v64 offset:4096
v_mfma_f32_32x32x16_bf16 v[32:47], v[12:15], v[100:103], v[32:47]
s_waitcnt lgkmcnt(2)
ds_read_b128 v[8:11], v64 offset:5120
v_cvt_pk_bf16_f32 v48, v48, v49
v_cvt_pk_bf16_f32 v49, v50, v51
v_mfma_f32_32x32x16_bf16 v[32:47], v[16:19], v[104:107], v[32:47]
s_waitcnt lgkmcnt(2)
ds_read_b128 v[12:15], v64 offset:6144
v_cvt_pk_bf16_f32 v50, v52, v53
v_cvt_pk_bf16_f32 v51, v54, v55
v_mfma_f32_32x32x16_bf16 v[32:47], v[20:23], v[108:111], v[32:47]
s_waitcnt lgkmcnt(2)
ds_read_b128 v[16:19], v64 offset:7168
v_cvt_pk_bf16_f32 v52, v56, v57
v_cvt_pk_bf16_f32 v53, v58, v59
v_mfma_f32_32x32x16_bf16 v[32:47], v[24:27], v[112:115], v[32:47]
s_waitcnt lgkmcnt(2)
ds_read_b128 v[20:23], v64 offset:8192
v_cvt_pk_bf16_f32 v54, v60, v61
v_cvt_pk_bf16_f32 v55, v62, v63
v_mfma_f32_32x32x16_bf16 v[32:47], v[8:11], v[116:119], v[32:47]
s_waitcnt lgkmcnt(2)
ds_read_b128 v[24:27], v64 offset:9216
v_accvgpr_write_b32 a56, v48
v_accvgpr_write_b32 a57, v49
v_mfma_f32_32x32x16_bf16 v[32:47], v[12:15], v[120:123], v[32:47]
s_waitcnt lgkmcnt(2)
ds_read_b128 v[8:11], v64 offset:10240
v_accvgpr_write_b32 a58, v50
v_accvgpr_write_b32 a59, v51
v_mfma_f32_32x32x16_bf16 v[32:47], v[16:19], v[124:127], v[32:47]
s_waitcnt lgkmcnt(2)
ds_read_b128 v[12:15], v64 offset:11264
v_accvgpr_write_b32 a60, v52
v_accvgpr_write_b32 a61, v53
v_mfma_f32_32x32x16_bf16 v[32:47], v[20:23], v[128:131], v[32:47]
s_waitcnt lgkmcnt(2)
ds_read_b128 v[16:19], v64 offset:12288
v_accvgpr_write_b32 a62, v54
v_accvgpr_write_b32 a63, v55
v_mfma_f32_32x32x16_bf16 v[32:47], v[24:27], v[132:135], v[32:47]
s_waitcnt lgkmcnt(2)
ds_read_b128 v[20:23], v64 offset:13312
s_add_u32 m0, s45, 0
s_add_u32 s55, s46, 0
buffer_load_dwordx4 v0, s[4:7], s55 offen offset:0 sc1 lds
buffer_load_dwordx4 v0, s[4:7], s55 offen offset:1024 sc1 lds
v_mfma_f32_32x32x16_bf16 v[32:47], v[8:11], v[136:139], v[32:47]
s_waitcnt lgkmcnt(2)
ds_read_b128 v[24:27], v64 offset:14336
buffer_load_dwordx4 v0, s[4:7], s55 offen offset:2048 sc1 lds
buffer_load_dwordx4 v0, s[4:7], s55 offen offset:3072 sc1 lds
v_mfma_f32_32x32x16_bf16 v[32:47], v[12:15], v[140:143], v[32:47]
s_waitcnt lgkmcnt(2)
ds_read_b128 v[8:11], v64 offset:15360
s_add_u32 m0, s45, 4096
s_add_u32 s55, s46, 4096
buffer_load_dwordx4 v0, s[4:7], s55 offen offset:0 sc1 lds
buffer_load_dwordx4 v0, s[4:7], s55 offen offset:1024 sc1 lds
v_mfma_f32_32x32x16_bf16 v[32:47], v[16:19], v[144:147], v[32:47]
s_waitcnt lgkmcnt(2)
ds_read_b128 v[12:15], v64 offset:16384
buffer_load_dwordx4 v0, s[4:7], s55 offen offset:2048 sc1 lds
buffer_load_dwordx4 v0, s[4:7], s55 offen offset:3072 sc1 lds
v_mfma_f32_32x32x16_bf16 v[32:47], v[20:23], v[148:151], v[32:47]
s_waitcnt lgkmcnt(2)
ds_read_b128 v[16:19], v64 offset:17408
s_add_u32 m0, s45, 8192
s_add_u32 s55, s46, 8192
buffer_load_dwordx4 v0, s[4:7], s55 offen offset:0 sc1 lds
buffer_load_dwordx4 v0, s[4:7], s55 offen offset:1024 sc1 lds
v_mfma_f32_32x32x16_bf16 v[32:47], v[24:27], v[152:155], v[32:47]
s_waitcnt lgkmcnt(2)
ds_read_b128 v[20:23], v64 offset:18432
s_add_u32 s45, s45, 40960
s_cmp_ge_u32 s45, 122880
s_cselect_b32 s55, 122880, 0
s_sub_u32 s45, s45, s55
s_add_u32 s46, s46, 40960
v_mfma_f32_32x32x16_bf16 v[32:47], v[8:11], v[156:159], v[32:47]
s_waitcnt lgkmcnt(2)
ds_read_b128 v[24:27], v64 offset:19456
v_mfma_f32_32x32x16_bf16 v[32:47], v[12:15], v[160:163], v[32:47]
s_waitcnt lgkmcnt(2)
ds_read_b128 v[8:11], v64 offset:20480
v_mfma_f32_32x32x16_bf16 v[32:47], v[16:19], v[164:167], v[32:47]
s_waitcnt lgkmcnt(2)
ds_read_b128 v[12:15], v64 offset:21504
v_mfma_f32_32x32x16_bf16 v[32:47], v[20:23], v[168:171], v[32:47]
s_waitcnt lgkmcnt(2)
ds_read_b128 v[16:19], v64 offset:22528
v_mfma_f32_32x32x16_bf16 v[32:47], v[24:27], v[172:175], v[32:47]
s_waitcnt lgkmcnt(2)
ds_read_b128 v[20:23], v64 offset:23552
v_mfma_f32_32x32x16_bf16 v[32:47], v[8:11], v[176:179], v[32:47]
s_waitcnt lgkmcnt(2)
ds_read_b128 v[24:27], v64 offset:24576
v_mfma_f32_32x32x16_bf16 v[32:47], v[12:15], v[180:183], v[32:47]
s_waitcnt lgkmcnt(2)
ds_read_b128 v[8:11], v64 offset:25600
v_mfma_f32_32x32x16_bf16 v[32:47], v[16:19], v[184:187], v[32:47]
s_waitcnt lgkmcnt(2)
ds_read_b128 v[12:15], v64 offset:26624
v_mfma_f32_32x32x16_bf16 v[32:47], v[20:23], v[188:191], v[32:47]
s_waitcnt lgkmcnt(2)
ds_read_b128 v[16:19], v64 offset:27648
v_mfma_f32_32x32x16_bf16 v[32:47], v[24:27], v[192:195], v[32:47]
s_waitcnt lgkmcnt(2)
ds_read_b128 v[20:23], v64 offset:28672
v_mfma_f32_32x32x16_bf16 v[32:47], v[8:11], v[196:199], v[32:47]
s_waitcnt lgkmcnt(2)
ds_read_b128 v[24:27], v64 offset:29696
v_mfma_f32_32x32x16_bf16 v[32:47], v[12:15], v[200:203], v[32:47]
s_waitcnt lgkmcnt(2)
ds_read_b128 v[8:11], v64 offset:30720
v_mfma_f32_32x32x16_bf16 v[32:47], v[16:19], v[204:207], v[32:47]
s_waitcnt lgkmcnt(2)
ds_read_b128 v[12:15], v64 offset:31744
v_mfma_f32_32x32x16_bf16 v[32:47], v[20:23], v[208:211], v[32:47]
s_waitcnt lgkmcnt(2)
ds_read_b128 v[16:19], v64 offset:32768
v_mfma_f32_32x32x16_bf16 v[32:47], v[24:27], v[212:215], v[32:47]
s_waitcnt lgkmcnt(2)
ds_read_b128 v[20:23], v64 offset:33792
v_mfma_f32_32x32x16_bf16 v[32:47], v[8:11], v[216:219], v[32:47]
s_waitcnt lgkmcnt(2)
ds_read_b128 v[24:27], v64 offset:34816
v_mfma_f32_32x32x16_bf16 v[32:47], v[12:15], v[220:223], v[32:47]
s_waitcnt lgkmcnt(2)
ds_read_b128 v[8:11], v64 offset:35840
v_mfma_f32_32x32x16_bf16 v[32:47], v[16:19], v[224:227], v[32:47]
s_waitcnt lgkmcnt(2)
ds_read_b128 v[12:15], v64 offset:36864
v_mfma_f32_32x32x16_bf16 v[32:47], v[20:23], v[228:231], v[32:47]
s_waitcnt lgkmcnt(2)
ds_read_b128 v[16:19], v64 offset:37888
v_mfma_f32_32x32x16_bf16 v[32:47], v[24:27], v[232:235], v[32:47]
s_waitcnt lgkmcnt(2)
ds_read_b128 v[20:23], v64 offset:38912
v_mfma_f32_32x32x16_bf16 v[32:47], v[8:11], v[236:239], v[32:47]
s_waitcnt lgkmcnt(2)
ds_read_b128 v[24:27], v64 offset:39936
v_mfma_f32_32x32x16_bf16 v[32:47], v[12:15], v[240:243], v[32:47]
s_add_u32 s44, s44, 1
s_cmp_eq_u32 s44, 3
s_mov_b32 s56, 40960
s_cmov_b32 s56, -81920
s_cselect_b32 s44, 0, s44
v_add_u32 v64, s56, v64
s_waitcnt vmcnt(10) lgkmcnt(2)
s_barrier
ds_read_b128 v[8:11], v64 offset:0
v_mfma_f32_32x32x16_bf16 v[32:47], v[16:19], v[244:247], v[32:47]
s_waitcnt lgkmcnt(2)
ds_read_b128 v[12:15], v64 offset:1024
v_mfma_f32_32x32x16_bf16 v[32:47], v[20:23], v[248:251], v[32:47]
s_waitcnt lgkmcnt(2)
ds_read_b128 v[16:19], v64 offset:2048
v_mfma_f32_32x32x16_bf16 v[32:47], v[24:27], v[252:255], v[32:47]
s_waitcnt lgkmcnt(2)
ds_read_b128 v[20:23], v64 offset:3072
v_mfma_f32_32x32x16_bf16 v[48:63], v[8:11], v[96:99], 0
s_waitcnt lgkmcnt(2)
ds_read_b128 v[24:27], v64 offset:4096
v_mfma_f32_32x32x16_bf16 v[48:63], v[12:15], v[100:103], v[48:63]
s_waitcnt lgkmcnt(2)
ds_read_b128 v[8:11], v64 offset:5120
v_cvt_pk_bf16_f32 v32, v32, v33
v_cvt_pk_bf16_f32 v33, v34, v35
v_mfma_f32_32x32x16_bf16 v[48:63], v[16:19], v[104:107], v[48:63]
s_waitcnt lgkmcnt(2)
ds_read_b128 v[12:15], v64 offset:6144
v_cvt_pk_bf16_f32 v34, v36, v37
v_cvt_pk_bf16_f32 v35, v38, v39
v_mfma_f32_32x32x16_bf16 v[48:63], v[20:23], v[108:111], v[48:63]
s_waitcnt lgkmcnt(2)
ds_read_b128 v[16:19], v64 offset:7168
v_cvt_pk_bf16_f32 v36, v40, v41
v_cvt_pk_bf16_f32 v37, v42, v43
v_mfma_f32_32x32x16_bf16 v[48:63], v[24:27], v[112:115], v[48:63]
s_waitcnt lgkmcnt(2)
ds_read_b128 v[20:23], v64 offset:8192
v_cvt_pk_bf16_f32 v38, v44, v45
v_cvt_pk_bf16_f32 v39, v46, v47
v_mfma_f32_32x32x16_bf16 v[48:63], v[8:11], v[116:119], v[48:63]
s_waitcnt lgkmcnt(2)
ds_read_b128 v[24:27], v64 offset:9216
v_accvgpr_write_b32 a64, v32
v_accvgpr_write_b32 a65, v33
v_mfma_f32_32x32x16_bf16 v[48:63], v[12:15], v[120:123], v[48:63]
s_waitcnt lgkmcnt(2)
ds_read_b128 v[8:11], v64 offset:10240
v_accvgpr_write_b32 a66, v34
v_accvgpr_write_b32 a67, v35
v_mfma_f32_32x32x16_bf16 v[48:63], v[16:19], v[124:127], v[48:63]
s_waitcnt lgkmcnt(2)
ds_read_b128 v[12:15], v64 offset:11264
v_accvgpr_write_b32 a68, v36
v_accvgpr_write_b32 a69, v37
v_mfma_f32_32x32x16_bf16 v[48:63], v[20:23], v[128:131], v[48:63]
s_waitcnt lgkmcnt(2)
ds_read_b128 v[16:19], v64 offset:12288
v_accvgpr_write_b32 a70, v38
v_accvgpr_write_b32 a71, v39
v_mfma_f32_32x32x16_bf16 v[48:63], v[24:27], v[132:135], v[48:63]
s_waitcnt lgkmcnt(2)
ds_read_b128 v[20:23], v64 offset:13312
s_add_u32 m0, s45, 0
s_add_u32 s55, s46, 0
buffer_load_dwordx4 v0, s[4:7], s55 offen offset:0 sc1 lds
buffer_load_dwordx4 v0, s[4:7], s55 offen offset:1024 sc1 lds
v_mfma_f32_32x32x16_bf16 v[48:63], v[8:11], v[136:139], v[48:63]
s_waitcnt lgkmcnt(2)
ds_read_b128 v[24:27], v64 offset:14336
buffer_load_dwordx4 v0, s[4:7], s55 offen offset:2048 sc1 lds
buffer_load_dwordx4 v0, s[4:7], s55 offen offset:3072 sc1 lds
v_mfma_f32_32x32x16_bf16 v[48:63], v[12:15], v[140:143], v[48:63]
s_waitcnt lgkmcnt(2)
ds_read_b128 v[8:11], v64 offset:15360
s_add_u32 m0, s45, 4096
s_add_u32 s55, s46, 4096
buffer_load_dwordx4 v0, s[4:7], s55 offen offset:0 sc1 lds
buffer_load_dwordx4 v0, s[4:7], s55 offen offset:1024 sc1 lds
v_mfma_f32_32x32x16_bf16 v[48:63], v[16:19], v[144:147], v[48:63]
s_waitcnt lgkmcnt(2)
ds_read_b128 v[12:15], v64 offset:16384
buffer_load_dwordx4 v0, s[4:7], s55 offen offset:2048 sc1 lds
buffer_load_dwordx4 v0, s[4:7], s55 offen offset:3072 sc1 lds
v_mfma_f32_32x32x16_bf16 v[48:63], v[20:23], v[148:151], v[48:63]
s_waitcnt lgkmcnt(2)
ds_read_b128 v[16:19], v64 offset:17408
s_add_u32 m0, s45, 8192
s_add_u32 s55, s46, 8192
buffer_load_dwordx4 v0, s[4:7], s55 offen offset:0 sc1 lds
buffer_load_dwordx4 v0, s[4:7], s55 offen offset:1024 sc1 lds
v_mfma_f32_32x32x16_bf16 v[48:63], v[24:27], v[152:155], v[48:63]
s_waitcnt lgkmcnt(2)
ds_read_b128 v[20:23], v64 offset:18432
s_add_u32 s45, s45, 40960
s_cmp_ge_u32 s45, 122880
s_cselect_b32 s55, 122880, 0
s_sub_u32 s45, s45, s55
s_add_u32 s46, s46, 40960
v_mfma_f32_32x32x16_bf16 v[48:63], v[8:11], v[156:159], v[48:63]
s_waitcnt lgkmcnt(2)
ds_read_b128 v[24:27], v64 offset:19456
v_mfma_f32_32x32x16_bf16 v[48:63], v[12:15], v[160:163], v[48:63]
s_waitcnt lgkmcnt(2)
ds_read_b128 v[8:11], v64 offset:20480
v_mfma_f32_32x32x16_bf16 v[48:63], v[16:19], v[164:167], v[48:63]
s_waitcnt lgkmcnt(2)
ds_read_b128 v[12:15], v64 offset:21504
v_mfma_f32_32x32x16_bf16 v[48:63], v[20:23], v[168:171], v[48:63]
s_waitcnt lgkmcnt(2)
ds_read_b128 v[16:19], v64 offset:22528
v_mfma_f32_32x32x16_bf16 v[48:63], v[24:27], v[172:175], v[48:63]
s_waitcnt lgkmcnt(2)
ds_read_b128 v[20:23], v64 offset:23552
v_mfma_f32_32x32x16_bf16 v[48:63], v[8:11], v[176:179], v[48:63]
s_waitcnt lgkmcnt(2)
ds_read_b128 v[24:27], v64 offset:24576
v_mfma_f32_32x32x16_bf16 v[48:63], v[12:15], v[180:183], v[48:63]
s_waitcnt lgkmcnt(2)
ds_read_b128 v[8:11], v64 offset:25600
v_mfma_f32_32x32x16_bf16 v[48:63], v[16:19], v[184:187], v[48:63]
s_waitcnt lgkmcnt(2)
ds_read_b128 v[12:15], v64 offset:26624
v_mfma_f32_32x32x16_bf16 v[48:63], v[20:23], v[188:191], v[48:63]
s_waitcnt lgkmcnt(2)
ds_read_b128 v[16:19], v64 offset:27648
v_mfma_f32_32x32x16_bf16 v[48:63], v[24:27], v[192:195], v[48:63]
s_waitcnt lgkmcnt(2)
ds_read_b128 v[20:23], v64 offset:28672
v_mfma_f32_32x32x16_bf16 v[48:63], v[8:11], v[196:199], v[48:63]
s_waitcnt lgkmcnt(2)
ds_read_b128 v[24:27], v64 offset:29696
v_mfma_f32_32x32x16_bf16 v[48:63], v[12:15], v[200:203], v[48:63]
s_waitcnt lgkmcnt(2)
ds_read_b128 v[8:11], v64 offset:30720
v_mfma_f32_32x32x16_bf16 v[48:63], v[16:19], v[204:207], v[48:63]
s_waitcnt lgkmcnt(2)
ds_read_b128 v[12:15], v64 offset:31744
v_mfma_f32_32x32x16_bf16 v[48:63], v[20:23], v[208:211], v[48:63]
s_waitcnt lgkmcnt(2)
ds_read_b128 v[16:19], v64 offset:32768
v_mfma_f32_32x32x16_bf16 v[48:63], v[24:27], v[212:215], v[48:63]
s_waitcnt lgkmcnt(2)
ds_read_b128 v[20:23], v64 offset:33792
v_mfma_f32_32x32x16_bf16 v[48:63], v[8:11], v[216:219], v[48:63]
s_waitcnt lgkmcnt(2)
ds_read_b128 v[24:27], v64 offset:34816
v_mfma_f32_32x32x16_bf16 v[48:63], v[12:15], v[220:223], v[48:63]
s_waitcnt lgkmcnt(2)
ds_read_b128 v[8:11], v64 offset:35840
v_mfma_f32_32x32x16_bf16 v[48:63], v[16:19], v[224:227], v[48:63]
s_waitcnt lgkmcnt(2)
ds_read_b128 v[12:15], v64 offset:36864
v_mfma_f32_32x32x16_bf16 v[48:63], v[20:23], v[228:231], v[48:63]
s_waitcnt lgkmcnt(2)
ds_read_b128 v[16:19], v64 offset:37888
v_mfma_f32_32x32x16_bf16 v[48:63], v[24:27], v[232:235], v[48:63]
s_waitcnt lgkmcnt(2)
ds_read_b128 v[20:23], v64 offset:38912
v_mfma_f32_32x32x16_bf16 v[48:63], v[8:11], v[236:239], v[48:63]
s_waitcnt lgkmcnt(2)
ds_read_b128 v[24:27], v64 offset:39936
v_mfma_f32_32x32x16_bf16 v[48:63], v[12:15], v[240:243], v[48:63]
s_add_u32 s44, s44, 1
s_cmp_eq_u32 s44, 3
s_mov_b32 s56, 40960
s_cmov_b32 s56, -81920
s_cselect_b32 s44, 0, s44
v_add_u32 v64, s56, v64
s_waitcnt vmcnt(10) lgkmcnt(2)
s_barrier
ds_read_b128 v[8:11], v64 offset:0
v_mfma_f32_32x32x16_bf16 v[48:63], v[16:19], v[244:247], v[48:63]
s_waitcnt lgkmcnt(2)
ds_read_b128 v[12:15], v64 offset:1024
v_mfma_f32_32x32x16_bf16 v[48:63], v[20:23], v[248:251], v[48:63]
s_waitcnt lgkmcnt(2)
ds_read_b128 v[16:19], v64 offset:2048
v_mfma_f32_32x32x16_bf16 v[48:63], v[24:27], v[252:255], v[48:63]
s_waitcnt lgkmcnt(2)
ds_read_b128 v[20:23], v64 offset:3072
v_mfma_f32_32x32x16_bf16 v[32:47], v[8:11], v[96:99], 0
s_waitcnt lgkmcnt(2)
ds_read_b128 v[24:27], v64 offset:4096
v_mfma_f32_32x32x16_bf16 v[32:47], v[12:15], v[100:103], v[32:47]
s_waitcnt lgkmcnt(2)
ds_read_b128 v[8:11], v64 offset:5120
v_cvt_pk_bf16_f32 v48, v48, v49
v_cvt_pk_bf16_f32 v49, v50, v51
v_mfma_f32_32x32x16_bf16 v[32:47], v[16:19], v[104:107], v[32:47]
s_waitcnt lgkmcnt(2)
ds_read_b128 v[12:15], v64 offset:6144
v_cvt_pk_bf16_f32 v50, v52, v53
v_cvt_pk_bf16_f32 v51, v54, v55
v_mfma_f32_32x32x16_bf16 v[32:47], v[20:23], v[108:111], v[32:47]
s_waitcnt lgkmcnt(2)
ds_read_b128 v[16:19], v64 offset:7168
v_cvt_pk_bf16_f32 v52, v56, v57
v_cvt_pk_bf16_f32 v53, v58, v59
v_mfma_f32_32x32x16_bf16 v[32:47], v[24:27], v[112:115], v[32:47]
s_waitcnt lgkmcnt(2)
ds_read_b128 v[20:23], v64 offset:8192
v_cvt_pk_bf16_f32 v54, v60, v61
v_cvt_pk_bf16_f32 v55, v62, v63
v_mfma_f32_32x32x16_bf16 v[32:47], v[8:11], v[116:119], v[32:47]
s_waitcnt lgkmcnt(2)
ds_read_b128 v[24:27], v64 offset:9216
v_accvgpr_write_b32 a72, v48
v_accvgpr_write_b32 a73, v49
v_mfma_f32_32x32x16_bf16 v[32:47], v[12:15], v[120:123], v[32:47]
s_waitcnt lgkmcnt(2)
ds_read_b128 v[8:11], v64 offset:10240
v_accvgpr_write_b32 a74, v50
v_accvgpr_write_b32 a75, v51
v_mfma_f32_32x32x16_bf16 v[32:47], v[16:19], v[124:127], v[32:47]
s_waitcnt lgkmcnt(2)
ds_read_b128 v[12:15], v64 offset:11264
v_accvgpr_write_b32 a76, v52
v_accvgpr_write_b32 a77, v53
v_mfma_f32_32x32x16_bf16 v[32:47], v[20:23], v[128:131], v[32:47]
s_waitcnt lgkmcnt(2)
ds_read_b128 v[16:19], v64 offset:12288
v_accvgpr_write_b32 a78, v54
v_accvgpr_write_b32 a79, v55
v_mfma_f32_32x32x16_bf16 v[32:47], v[24:27], v[132:135], v[32:47]
s_waitcnt lgkmcnt(2)
ds_read_b128 v[20:23], v64 offset:13312
s_add_u32 m0, s45, 0
s_add_u32 s55, s46, 0
buffer_load_dwordx4 v0, s[4:7], s55 offen offset:0 sc1 lds
buffer_load_dwordx4 v0, s[4:7], s55 offen offset:1024 sc1 lds
v_mfma_f32_32x32x16_bf16 v[32:47], v[8:11], v[136:139], v[32:47]
s_waitcnt lgkmcnt(2)
ds_read_b128 v[24:27], v64 offset:14336
buffer_load_dwordx4 v0, s[4:7], s55 offen offset:2048 sc1 lds
buffer_load_dwordx4 v0, s[4:7], s55 offen offset:3072 sc1 lds
v_mfma_f32_32x32x16_bf16 v[32:47], v[12:15], v[140:143], v[32:47]
s_waitcnt lgkmcnt(2)
ds_read_b128 v[8:11], v64 offset:15360
s_add_u32 m0, s45, 4096
s_add_u32 s55, s46, 4096
buffer_load_dwordx4 v0, s[4:7], s55 offen offset:0 sc1 lds
buffer_load_dwordx4 v0, s[4:7], s55 offen offset:1024 sc1 lds
v_mfma_f32_32x32x16_bf16 v[32:47], v[16:19], v[144:147], v[32:47]
s_waitcnt lgkmcnt(2)
ds_read_b128 v[12:15], v64 offset:16384
buffer_load_dwordx4 v0, s[4:7], s55 offen offset:2048 sc1 lds
buffer_load_dwordx4 v0, s[4:7], s55 offen offset:3072 sc1 lds
v_mfma_f32_32x32x16_bf16 v[32:47], v[20:23], v[148:151], v[32:47]
s_waitcnt lgkmcnt(2)
ds_read_b128 v[16:19], v64 offset:17408
s_add_u32 m0, s45, 8192
s_add_u32 s55, s46, 8192
buffer_load_dwordx4 v0, s[4:7], s55 offen offset:0 sc1 lds
buffer_load_dwordx4 v0, s[4:7], s55 offen offset:1024 sc1 lds
v_mfma_f32_32x32x16_bf16 v[32:47], v[24:27], v[152:155], v[32:47]
s_waitcnt lgkmcnt(2)
ds_read_b128 v[20:23], v64 offset:18432
s_add_u32 s45, s45, 40960
s_cmp_ge_u32 s45, 122880
s_cselect_b32 s55, 122880, 0
s_sub_u32 s45, s45, s55
s_add_u32 s46, s46, 40960
v_mfma_f32_32x32x16_bf16 v[32:47], v[8:11], v[156:159], v[32:47]
s_waitcnt lgkmcnt(2)
ds_read_b128 v[24:27], v64 offset:19456
v_mfma_f32_32x32x16_bf16 v[32:47], v[12:15], v[160:163], v[32:47]
s_waitcnt lgkmcnt(2)
ds_read_b128 v[8:11], v64 offset:20480
v_mfma_f32_32x32x16_bf16 v[32:47], v[16:19], v[164:167], v[32:47]
s_waitcnt lgkmcnt(2)
ds_read_b128 v[12:15], v64 offset:21504
v_mfma_f32_32x32x16_bf16 v[32:47], v[20:23], v[168:171], v[32:47]
s_waitcnt lgkmcnt(2)
ds_read_b128 v[16:19], v64 offset:22528
v_mfma_f32_32x32x16_bf16 v[32:47], v[24:27], v[172:175], v[32:47]
s_waitcnt lgkmcnt(2)
ds_read_b128 v[20:23], v64 offset:23552
v_mfma_f32_32x32x16_bf16 v[32:47], v[8:11], v[176:179], v[32:47]
s_waitcnt lgkmcnt(2)
ds_read_b128 v[24:27], v64 offset:24576
v_mfma_f32_32x32x16_bf16 v[32:47], v[12:15], v[180:183], v[32:47]
s_waitcnt lgkmcnt(2)
ds_read_b128 v[8:11], v64 offset:25600
v_mfma_f32_32x32x16_bf16 v[32:47], v[16:19], v[184:187], v[32:47]
s_waitcnt lgkmcnt(2)
ds_read_b128 v[12:15], v64 offset:26624
v_mfma_f32_32x32x16_bf16 v[32:47], v[20:23], v[188:191], v[32:47]
s_waitcnt lgkmcnt(2)
ds_read_b128 v[16:19], v64 offset:27648
v_mfma_f32_32x32x16_bf16 v[32:47], v[24:27], v[192:195], v[32:47]
s_waitcnt lgkmcnt(2)
ds_read_b128 v[20:23], v64 offset:28672
v_mfma_f32_32x32x16_bf16 v[32:47], v[8:11], v[196:199], v[32:47]
s_waitcnt lgkmcnt(2)
ds_read_b128 v[24:27], v64 offset:29696
v_mfma_f32_32x32x16_bf16 v[32:47], v[12:15], v[200:203], v[32:47]
s_waitcnt lgkmcnt(2)
ds_read_b128 v[8:11], v64 offset:30720
v_mfma_f32_32x32x16_bf16 v[32:47], v[16:19], v[204:207], v[32:47]
s_waitcnt lgkmcnt(2)
ds_read_b128 v[12:15], v64 offset:31744
v_mfma_f32_32x32x16_bf16 v[32:47], v[20:23], v[208:211], v[32:47]
s_waitcnt lgkmcnt(2)
ds_read_b128 v[16:19], v64 offset:32768
v_mfma_f32_32x32x16_bf16 v[32:47], v[24:27], v[212:215], v[32:47]
s_waitcnt lgkmcnt(2)
ds_read_b128 v[20:23], v64 offset:33792
v_mfma_f32_32x32x16_bf16 v[32:47], v[8:11], v[216:219], v[32:47]
s_waitcnt lgkmcnt(2)
ds_read_b128 v[24:27], v64 offset:34816
v_mfma_f32_32x32x16_bf16 v[32:47], v[12:15], v[220:223], v[32:47]
s_waitcnt lgkmcnt(2)
ds_read_b128 v[8:11], v64 offset:35840
v_mfma_f32_32x32x16_bf16 v[32:47], v[16:19], v[224:227], v[32:47]
s_waitcnt lgkmcnt(2)
ds_read_b128 v[12:15], v64 offset:36864
v_mfma_f32_32x32x16_bf16 v[32:47], v[20:23], v[228:231], v[32:47]
s_waitcnt lgkmcnt(2)
ds_read_b128 v[16:19], v64 offset:37888
v_mfma_f32_32x32x16_bf16 v[32:47], v[24:27], v[232:235], v[32:47]
s_waitcnt lgkmcnt(2)
ds_read_b128 v[20:23], v64 offset:38912
v_mfma_f32_32x32x16_bf16 v[32:47], v[8:11], v[236:239], v[32:47]
s_waitcnt lgkmcnt(2)
ds_read_b128 v[24:27], v64 offset:39936
v_mfma_f32_32x32x16_bf16 v[32:47], v[12:15], v[240:243], v[32:47]
s_add_u32 s44, s44, 1
s_cmp_eq_u32 s44, 3
s_mov_b32 s56, 40960
s_cmov_b32 s56, -81920
s_cselect_b32 s44, 0, s44
v_add_u32 v64, s56, v64
s_waitcnt vmcnt(10) lgkmcnt(2)
s_barrier
ds_read_b128 v[8:11], v64 offset:0
v_mfma_f32_32x32x16_bf16 v[32:47], v[16:19], v[244:247], v[32:47]
s_waitcnt lgkmcnt(2)
ds_read_b128 v[12:15], v64 offset:1024
v_mfma_f32_32x32x16_bf16 v[32:47], v[20:23], v[248:251], v[32:47]
s_waitcnt lgkmcnt(2)
ds_read_b128 v[16:19], v64 offset:2048
v_mfma_f32_32x32x16_bf16 v[32:47], v[24:27], v[252:255], v[32:47]
s_waitcnt lgkmcnt(2)
ds_read_b128 v[20:23], v64 offset:3072
v_mfma_f32_32x32x16_bf16 v[48:63], v[8:11], v[96:99], 0
s_waitcnt lgkmcnt(2)
ds_read_b128 v[24:27], v64 offset:4096
v_mfma_f32_32x32x16_bf16 v[48:63], v[12:15], v[100:103], v[48:63]
s_waitcnt lgkmcnt(2)
ds_read_b128 v[8:11], v64 offset:5120
v_cvt_pk_bf16_f32 v32, v32, v33
v_cvt_pk_bf16_f32 v33, v34, v35
v_mfma_f32_32x32x16_bf16 v[48:63], v[16:19], v[104:107], v[48:63]
s_waitcnt lgkmcnt(2)
ds_read_b128 v[12:15], v64 offset:6144
v_cvt_pk_bf16_f32 v34, v36, v37
v_cvt_pk_bf16_f32 v35, v38, v39
v_mfma_f32_32x32x16_bf16 v[48:63], v[20:23], v[108:111], v[48:63]
s_waitcnt lgkmcnt(2)
ds_read_b128 v[16:19], v64 offset:7168
v_cvt_pk_bf16_f32 v36, v40, v41
v_cvt_pk_bf16_f32 v37, v42, v43
v_mfma_f32_32x32x16_bf16 v[48:63], v[24:27], v[112:115], v[48:63]
s_waitcnt lgkmcnt(2)
ds_read_b128 v[20:23], v64 offset:8192
v_cvt_pk_bf16_f32 v38, v44, v45
v_cvt_pk_bf16_f32 v39, v46, v47
v_mfma_f32_32x32x16_bf16 v[48:63], v[8:11], v[116:119], v[48:63]
s_waitcnt lgkmcnt(2)
ds_read_b128 v[24:27], v64 offset:9216
v_accvgpr_write_b32 a80, v32
v_accvgpr_write_b32 a81, v33
v_mfma_f32_32x32x16_bf16 v[48:63], v[12:15], v[120:123], v[48:63]
s_waitcnt lgkmcnt(2)
ds_read_b128 v[8:11], v64 offset:10240
v_accvgpr_write_b32 a82, v34
v_accvgpr_write_b32 a83, v35
v_mfma_f32_32x32x16_bf16 v[48:63], v[16:19], v[124:127], v[48:63]
s_waitcnt lgkmcnt(2)
ds_read_b128 v[12:15], v64 offset:11264
v_accvgpr_write_b32 a84, v36
v_accvgpr_write_b32 a85, v37
v_mfma_f32_32x32x16_bf16 v[48:63], v[20:23], v[128:131], v[48:63]
s_waitcnt lgkmcnt(2)
ds_read_b128 v[16:19], v64 offset:12288
v_accvgpr_write_b32 a86, v38
v_accvgpr_write_b32 a87, v39
v_mfma_f32_32x32x16_bf16 v[48:63], v[24:27], v[132:135], v[48:63]
s_waitcnt lgkmcnt(2)
ds_read_b128 v[20:23], v64 offset:13312
s_add_u32 m0, s45, 0
s_add_u32 s55, s46, 0
buffer_load_dwordx4 v0, s[4:7], s55 offen offset:0 sc1 lds
buffer_load_dwordx4 v0, s[4:7], s55 offen offset:1024 sc1 lds
v_mfma_f32_32x32x16_bf16 v[48:63], v[8:11], v[136:139], v[48:63]
s_waitcnt lgkmcnt(2)
ds_read_b128 v[24:27], v64 offset:14336
buffer_load_dwordx4 v0, s[4:7], s55 offen offset:2048 sc1 lds
buffer_load_dwordx4 v0, s[4:7], s55 offen offset:3072 sc1 lds
v_mfma_f32_32x32x16_bf16 v[48:63], v[12:15], v[140:143], v[48:63]
s_waitcnt lgkmcnt(2)
ds_read_b128 v[8:11], v64 offset:15360
s_add_u32 m0, s45, 4096
s_add_u32 s55, s46, 4096
buffer_load_dwordx4 v0, s[4:7], s55 offen offset:0 sc1 lds
buffer_load_dwordx4 v0, s[4:7], s55 offen offset:1024 sc1 lds
v_mfma_f32_32x32x16_bf16 v[48:63], v[16:19], v[144:147], v[48:63]
s_waitcnt lgkmcnt(2)
ds_read_b128 v[12:15], v64 offset:16384
buffer_load_dwordx4 v0, s[4:7], s55 offen offset:2048 sc1 lds
buffer_load_dwordx4 v0, s[4:7], s55 offen offset:3072 sc1 lds
v_mfma_f32_32x32x16_bf16 v[48:63], v[20:23], v[148:151], v[48:63]
s_waitcnt lgkmcnt(2)
ds_read_b128 v[16:19], v64 offset:17408
s_add_u32 m0, s45, 8192
s_add_u32 s55, s46, 8192
buffer_load_dwordx4 v0, s[4:7], s55 offen offset:0 sc1 lds
buffer_load_dwordx4 v0, s[4:7], s55 offen offset:1024 sc1 lds
v_mfma_f32_32x32x16_bf16 v[48:63], v[24:27], v[152:155], v[48:63]
s_waitcnt lgkmcnt(2)
ds_read_b128 v[20:23], v64 offset:18432
s_add_u32 s45, s45, 40960
s_cmp_ge_u32 s45, 122880
s_cselect_b32 s55, 122880, 0
s_sub_u32 s45, s45, s55
s_add_u32 s46, s46, 40960
v_mfma_f32_32x32x16_bf16 v[48:63], v[8:11], v[156:159], v[48:63]
s_waitcnt lgkmcnt(2)
ds_read_b128 v[24:27], v64 offset:19456
v_mfma_f32_32x32x16_bf16 v[48:63], v[12:15], v[160:163], v[48:63]
s_waitcnt lgkmcnt(2)
ds_read_b128 v[8:11], v64 offset:20480
v_mfma_f32_32x32x16_bf16 v[48:63], v[16:19], v[164:167], v[48:63]
s_waitcnt lgkmcnt(2)
ds_read_b128 v[12:15], v64 offset:21504
v_mfma_f32_32x32x16_bf16 v[48:63], v[20:23], v[168:171], v[48:63]
s_waitcnt lgkmcnt(2)
ds_read_b128 v[16:19], v64 offset:22528
v_mfma_f32_32x32x16_bf16 v[48:63], v[24:27], v[172:175], v[48:63]
s_waitcnt lgkmcnt(2)
ds_read_b128 v[20:23], v64 offset:23552
v_mfma_f32_32x32x16_bf16 v[48:63], v[8:11], v[176:179], v[48:63]
s_waitcnt lgkmcnt(2)
ds_read_b128 v[24:27], v64 offset:24576
v_mfma_f32_32x32x16_bf16 v[48:63], v[12:15], v[180:183], v[48:63]
s_waitcnt lgkmcnt(2)
ds_read_b128 v[8:11], v64 offset:25600
v_mfma_f32_32x32x16_bf16 v[48:63], v[16:19], v[184:187], v[48:63]
s_waitcnt lgkmcnt(2)
ds_read_b128 v[12:15], v64 offset:26624
v_mfma_f32_32x32x16_bf16 v[48:63], v[20:23], v[188:191], v[48:63]
s_waitcnt lgkmcnt(2)
ds_read_b128 v[16:19], v64 offset:27648
v_mfma_f32_32x32x16_bf16 v[48:63], v[24:27], v[192:195], v[48:63]
s_waitcnt lgkmcnt(2)
ds_read_b128 v[20:23], v64 offset:28672
v_mfma_f32_32x32x16_bf16 v[48:63], v[8:11], v[196:199], v[48:63]
s_waitcnt lgkmcnt(2)
ds_read_b128 v[24:27], v64 offset:29696
v_mfma_f32_32x32x16_bf16 v[48:63], v[12:15], v[200:203], v[48:63]
s_waitcnt lgkmcnt(2)
ds_read_b128 v[8:11], v64 offset:30720
v_mfma_f32_32x32x16_bf16 v[48:63], v[16:19], v[204:207], v[48:63]
s_waitcnt lgkmcnt(2)
ds_read_b128 v[12:15], v64 offset:31744
v_mfma_f32_32x32x16_bf16 v[48:63], v[20:23], v[208:211], v[48:63]
s_waitcnt lgkmcnt(2)
ds_read_b128 v[16:19], v64 offset:32768
v_mfma_f32_32x32x16_bf16 v[48:63], v[24:27], v[212:215], v[48:63]
s_waitcnt lgkmcnt(2)
ds_read_b128 v[20:23], v64 offset:33792
v_mfma_f32_32x32x16_bf16 v[48:63], v[8:11], v[216:219], v[48:63]
s_waitcnt lgkmcnt(2)
ds_read_b128 v[24:27], v64 offset:34816
v_mfma_f32_32x32x16_bf16 v[48:63], v[12:15], v[220:223], v[48:63]
s_waitcnt lgkmcnt(2)
ds_read_b128 v[8:11], v64 offset:35840
v_mfma_f32_32x32x16_bf16 v[48:63], v[16:19], v[224:227], v[48:63]
s_waitcnt lgkmcnt(2)
ds_read_b128 v[12:15], v64 offset:36864
v_mfma_f32_32x32x16_bf16 v[48:63], v[20:23], v[228:231], v[48:63]
s_waitcnt lgkmcnt(2)
ds_read_b128 v[16:19], v64 offset:37888
v_mfma_f32_32x32x16_bf16 v[48:63], v[24:27], v[232:235], v[48:63]
s_waitcnt lgkmcnt(2)
ds_read_b128 v[20:23], v64 offset:38912
v_mfma_f32_32x32x16_bf16 v[48:63], v[8:11], v[236:239], v[48:63]
s_waitcnt lgkmcnt(2)
ds_read_b128 v[24:27], v64 offset:39936
v_mfma_f32_32x32x16_bf16 v[48:63], v[12:15], v[240:243], v[48:63]
s_add_u32 s44, s44, 1
s_cmp_eq_u32 s44, 3
s_mov_b32 s56, 40960
s_cmov_b32 s56, -81920
s_cselect_b32 s44, 0, s44
v_add_u32 v64, s56, v64
s_waitcnt vmcnt(10) lgkmcnt(2)
s_barrier
ds_read_b128 v[8:11], v64 offset:0
v_mfma_f32_32x32x16_bf16 v[48:63], v[16:19], v[244:247], v[48:63]
s_waitcnt lgkmcnt(2)
ds_read_b128 v[12:15], v64 offset:1024
v_mfma_f32_32x32x16_bf16 v[48:63], v[20:23], v[248:251], v[48:63]
s_waitcnt lgkmcnt(2)
ds_read_b128 v[16:19], v64 offset:2048
v_mfma_f32_32x32x16_bf16 v[48:63], v[24:27], v[252:255], v[48:63]
s_waitcnt lgkmcnt(2)
ds_read_b128 v[20:23], v64 offset:3072
v_mfma_f32_32x32x16_bf16 v[32:47], v[8:11], v[96:99], 0
s_waitcnt lgkmcnt(2)
ds_read_b128 v[24:27], v64 offset:4096
v_mfma_f32_32x32x16_bf16 v[32:47], v[12:15], v[100:103], v[32:47]
s_waitcnt lgkmcnt(2)
ds_read_b128 v[8:11], v64 offset:5120
v_cvt_pk_bf16_f32 v48, v48, v49
v_cvt_pk_bf16_f32 v49, v50, v51
v_mfma_f32_32x32x16_bf16 v[32:47], v[16:19], v[104:107], v[32:47]
s_waitcnt lgkmcnt(2)
ds_read_b128 v[12:15], v64 offset:6144
v_cvt_pk_bf16_f32 v50, v52, v53
v_cvt_pk_bf16_f32 v51, v54, v55
v_mfma_f32_32x32x16_bf16 v[32:47], v[20:23], v[108:111], v[32:47]
s_waitcnt lgkmcnt(2)
ds_read_b128 v[16:19], v64 offset:7168
v_cvt_pk_bf16_f32 v52, v56, v57
v_cvt_pk_bf16_f32 v53, v58, v59
v_mfma_f32_32x32x16_bf16 v[32:47], v[24:27], v[112:115], v[32:47]
s_waitcnt lgkmcnt(2)
ds_read_b128 v[20:23], v64 offset:8192
v_cvt_pk_bf16_f32 v54, v60, v61
v_cvt_pk_bf16_f32 v55, v62, v63
v_mfma_f32_32x32x16_bf16 v[32:47], v[8:11], v[116:119], v[32:47]
s_waitcnt lgkmcnt(2)
ds_read_b128 v[24:27], v64 offset:9216
v_accvgpr_write_b32 a88, v48
v_accvgpr_write_b32 a89, v49
v_mfma_f32_32x32x16_bf16 v[32:47], v[12:15], v[120:123], v[32:47]
s_waitcnt lgkmcnt(2)
ds_read_b128 v[8:11], v64 offset:10240
v_accvgpr_write_b32 a90, v50
v_accvgpr_write_b32 a91, v51
v_mfma_f32_32x32x16_bf16 v[32:47], v[16:19], v[124:127], v[32:47]
s_waitcnt lgkmcnt(2)
ds_read_b128 v[12:15], v64 offset:11264
v_accvgpr_write_b32 a92, v52
v_accvgpr_write_b32 a93, v53
v_mfma_f32_32x32x16_bf16 v[32:47], v[20:23], v[128:131], v[32:47]
s_waitcnt lgkmcnt(2)
ds_read_b128 v[16:19], v64 offset:12288
v_accvgpr_write_b32 a94, v54
v_accvgpr_write_b32 a95, v55
v_mfma_f32_32x32x16_bf16 v[32:47], v[24:27], v[132:135], v[32:47]
s_waitcnt lgkmcnt(2)
ds_read_b128 v[20:23], v64 offset:13312
s_add_u32 m0, s45, 0
s_add_u32 s55, s46, 0
buffer_load_dwordx4 v0, s[4:7], s55 offen offset:0 sc1 lds
buffer_load_dwordx4 v0, s[4:7], s55 offen offset:1024 sc1 lds
v_mfma_f32_32x32x16_bf16 v[32:47], v[8:11], v[136:139], v[32:47]
s_waitcnt lgkmcnt(2)
ds_read_b128 v[24:27], v64 offset:14336
buffer_load_dwordx4 v0, s[4:7], s55 offen offset:2048 sc1 lds
buffer_load_dwordx4 v0, s[4:7], s55 offen offset:3072 sc1 lds
v_mfma_f32_32x32x16_bf16 v[32:47], v[12:15], v[140:143], v[32:47]
s_waitcnt lgkmcnt(2)
ds_read_b128 v[8:11], v64 offset:15360
s_add_u32 m0, s45, 4096
s_add_u32 s55, s46, 4096
buffer_load_dwordx4 v0, s[4:7], s55 offen offset:0 sc1 lds
buffer_load_dwordx4 v0, s[4:7], s55 offen offset:1024 sc1 lds
v_mfma_f32_32x32x16_bf16 v[32:47], v[16:19], v[144:147], v[32:47]
s_waitcnt lgkmcnt(2)
ds_read_b128 v[12:15], v64 offset:16384
buffer_load_dwordx4 v0, s[4:7], s55 offen offset:2048 sc1 lds
buffer_load_dwordx4 v0, s[4:7], s55 offen offset:3072 sc1 lds
v_mfma_f32_32x32x16_bf16 v[32:47], v[20:23], v[148:151], v[32:47]
s_waitcnt lgkmcnt(2)
ds_read_b128 v[16:19], v64 offset:17408
s_add_u32 m0, s45, 8192
s_add_u32 s55, s46, 8192
buffer_load_dwordx4 v0, s[4:7], s55 offen offset:0 sc1 lds
buffer_load_dwordx4 v0, s[4:7], s55 offen offset:1024 sc1 lds
v_mfma_f32_32x32x16_bf16 v[32:47], v[24:27], v[152:155], v[32:47]
s_waitcnt lgkmcnt(2)
ds_read_b128 v[20:23], v64 offset:18432
s_add_u32 s45, s45, 40960
s_cmp_ge_u32 s45, 122880
s_cselect_b32 s55, 122880, 0
s_sub_u32 s45, s45, s55
s_add_u32 s46, s46, 40960
v_mfma_f32_32x32x16_bf16 v[32:47], v[8:11], v[156:159], v[32:47]
s_waitcnt lgkmcnt(2)
ds_read_b128 v[24:27], v64 offset:19456
v_mfma_f32_32x32x16_bf16 v[32:47], v[12:15], v[160:163], v[32:47]
s_waitcnt lgkmcnt(2)
ds_read_b128 v[8:11], v64 offset:20480
v_mfma_f32_32x32x16_bf16 v[32:47], v[16:19], v[164:167], v[32:47]
s_waitcnt lgkmcnt(2)
ds_read_b128 v[12:15], v64 offset:21504
v_mfma_f32_32x32x16_bf16 v[32:47], v[20:23], v[168:171], v[32:47]
s_waitcnt lgkmcnt(2)
ds_read_b128 v[16:19], v64 offset:22528
v_mfma_f32_32x32x16_bf16 v[32:47], v[24:27], v[172:175], v[32:47]
s_waitcnt lgkmcnt(2)
ds_read_b128 v[20:23], v64 offset:23552
v_mfma_f32_32x32x16_bf16 v[32:47], v[8:11], v[176:179], v[32:47]
s_waitcnt lgkmcnt(2)
ds_read_b128 v[24:27], v64 offset:24576
v_mfma_f32_32x32x16_bf16 v[32:47], v[12:15], v[180:183], v[32:47]
s_waitcnt lgkmcnt(2)
ds_read_b128 v[8:11], v64 offset:25600
v_mfma_f32_32x32x16_bf16 v[32:47], v[16:19], v[184:187], v[32:47]
s_waitcnt lgkmcnt(2)
ds_read_b128 v[12:15], v64 offset:26624
v_mfma_f32_32x32x16_bf16 v[32:47], v[20:23], v[188:191], v[32:47]
s_waitcnt lgkmcnt(2)
ds_read_b128 v[16:19], v64 offset:27648
v_mfma_f32_32x32x16_bf16 v[32:47], v[24:27], v[192:195], v[32:47]
s_waitcnt lgkmcnt(2)
ds_read_b128 v[20:23], v64 offset:28672
v_mfma_f32_32x32x16_bf16 v[32:47], v[8:11], v[196:199], v[32:47]
s_waitcnt lgkmcnt(2)
ds_read_b128 v[24:27], v64 offset:29696
v_mfma_f32_32x32x16_bf16 v[32:47], v[12:15], v[200:203], v[32:47]
s_waitcnt lgkmcnt(2)
ds_read_b128 v[8:11], v64 offset:30720
v_mfma_f32_32x32x16_bf16 v[32:47], v[16:19], v[204:207], v[32:47]
s_waitcnt lgkmcnt(2)
ds_read_b128 v[12:15], v64 offset:31744
v_mfma_f32_32x32x16_bf16 v[32:47], v[20:23], v[208:211], v[32:47]
s_waitcnt lgkmcnt(2)
ds_read_b128 v[16:19], v64 offset:32768
v_mfma_f32_32x32x16_bf16 v[32:47], v[24:27], v[212:215], v[32:47]
s_waitcnt lgkmcnt(2)
ds_read_b128 v[20:23], v64 offset:33792
v_mfma_f32_32x32x16_bf16 v[32:47], v[8:11], v[216:219], v[32:47]
s_waitcnt lgkmcnt(2)
ds_read_b128 v[24:27], v64 offset:34816
v_mfma_f32_32x32x16_bf16 v[32:47], v[12:15], v[220:223], v[32:47]
s_waitcnt lgkmcnt(2)
ds_read_b128 v[8:11], v64 offset:35840
v_mfma_f32_32x32x16_bf16 v[32:47], v[16:19], v[224:227], v[32:47]
s_waitcnt lgkmcnt(2)
ds_read_b128 v[12:15], v64 offset:36864
v_mfma_f32_32x32x16_bf16 v[32:47], v[20:23], v[228:231], v[32:47]
s_waitcnt lgkmcnt(2)
ds_read_b128 v[16:19], v64 offset:37888
v_mfma_f32_32x32x16_bf16 v[32:47], v[24:27], v[232:235], v[32:47]
s_waitcnt lgkmcnt(2)
ds_read_b128 v[20:23], v64 offset:38912
v_mfma_f32_32x32x16_bf16 v[32:47], v[8:11], v[236:239], v[32:47]
s_waitcnt lgkmcnt(2)
ds_read_b128 v[24:27], v64 offset:39936
v_mfma_f32_32x32x16_bf16 v[32:47], v[12:15], v[240:243], v[32:47]
s_add_u32 s44, s44, 1
s_cmp_eq_u32 s44, 3
s_mov_b32 s56, 40960
s_cmov_b32 s56, -81920
s_cselect_b32 s44, 0, s44
v_add_u32 v64, s56, v64
s_waitcnt vmcnt(10) lgkmcnt(2)
s_barrier
ds_read_b128 v[8:11], v64 offset:0
v_mfma_f32_32x32x16_bf16 v[32:47], v[16:19], v[244:247], v[32:47]
s_waitcnt lgkmcnt(2)
ds_read_b128 v[12:15], v64 offset:1024
v_mfma_f32_32x32x16_bf16 v[32:47], v[20:23], v[248:251], v[32:47]
s_waitcnt lgkmcnt(2)
ds_read_b128 v[16:19], v64 offset:2048
v_mfma_f32_32x32x16_bf16 v[32:47], v[24:27], v[252:255], v[32:47]
s_waitcnt lgkmcnt(2)
ds_read_b128 v[20:23], v64 offset:3072
v_mfma_f32_32x32x16_bf16 v[48:63], v[8:11], v[96:99], 0
s_waitcnt lgkmcnt(2)
ds_read_b128 v[24:27], v64 offset:4096
v_mfma_f32_32x32x16_bf16 v[48:63], v[12:15], v[100:103], v[48:63]
s_waitcnt lgkmcnt(2)
ds_read_b128 v[8:11], v64 offset:5120
v_cvt_pk_bf16_f32 v32, v32, v33
v_cvt_pk_bf16_f32 v33, v34, v35
v_mfma_f32_32x32x16_bf16 v[48:63], v[16:19], v[104:107], v[48:63]
s_waitcnt lgkmcnt(2)
ds_read_b128 v[12:15], v64 offset:6144
v_cvt_pk_bf16_f32 v34, v36, v37
v_cvt_pk_bf16_f32 v35, v38, v39
v_mfma_f32_32x32x16_bf16 v[48:63], v[20:23], v[108:111], v[48:63]
s_waitcnt lgkmcnt(2)
ds_read_b128 v[16:19], v64 offset:7168
v_cvt_pk_bf16_f32 v36, v40, v41
v_cvt_pk_bf16_f32 v37, v42, v43
v_mfma_f32_32x32x16_bf16 v[48:63], v[24:27], v[112:115], v[48:63]
s_waitcnt lgkmcnt(2)
ds_read_b128 v[20:23], v64 offset:8192
v_cvt_pk_bf16_f32 v38, v44, v45
v_cvt_pk_bf16_f32 v39, v46, v47
v_mfma_f32_32x32x16_bf16 v[48:63], v[8:11], v[116:119], v[48:63]
s_waitcnt lgkmcnt(2)
ds_read_b128 v[24:27], v64 offset:9216
v_accvgpr_write_b32 a96, v32
v_accvgpr_write_b32 a97, v33
v_mfma_f32_32x32x16_bf16 v[48:63], v[12:15], v[120:123], v[48:63]
s_waitcnt lgkmcnt(2)
ds_read_b128 v[8:11], v64 offset:10240
v_accvgpr_write_b32 a98, v34
v_accvgpr_write_b32 a99, v35
v_mfma_f32_32x32x16_bf16 v[48:63], v[16:19], v[124:127], v[48:63]
s_waitcnt lgkmcnt(2)
ds_read_b128 v[12:15], v64 offset:11264
v_accvgpr_write_b32 a100, v36
v_accvgpr_write_b32 a101, v37
v_mfma_f32_32x32x16_bf16 v[48:63], v[20:23], v[128:131], v[48:63]
s_waitcnt lgkmcnt(2)
ds_read_b128 v[16:19], v64 offset:12288
v_accvgpr_write_b32 a102, v38
v_accvgpr_write_b32 a103, v39
v_mfma_f32_32x32x16_bf16 v[48:63], v[24:27], v[132:135], v[48:63]
s_waitcnt lgkmcnt(2)
ds_read_b128 v[20:23], v64 offset:13312
s_add_u32 m0, s45, 0
s_add_u32 s55, s46, 0
buffer_load_dwordx4 v0, s[4:7], s55 offen offset:0 sc1 lds
buffer_load_dwordx4 v0, s[4:7], s55 offen offset:1024 sc1 lds
v_mfma_f32_32x32x16_bf16 v[48:63], v[8:11], v[136:139], v[48:63]
s_waitcnt lgkmcnt(2)
ds_read_b128 v[24:27], v64 offset:14336
buffer_load_dwordx4 v0, s[4:7], s55 offen offset:2048 sc1 lds
buffer_load_dwordx4 v0, s[4:7], s55 offen offset:3072 sc1 lds
v_mfma_f32_32x32x16_bf16 v[48:63], v[12:15], v[140:143], v[48:63]
s_waitcnt lgkmcnt(2)
ds_read_b128 v[8:11], v64 offset:15360
s_add_u32 m0, s45, 4096
s_add_u32 s55, s46, 4096
buffer_load_dwordx4 v0, s[4:7], s55 offen offset:0 sc1 lds
buffer_load_dwordx4 v0, s[4:7], s55 offen offset:1024 sc1 lds
v_mfma_f32_32x32x16_bf16 v[48:63], v[16:19], v[144:147], v[48:63]
s_waitcnt lgkmcnt(2)
ds_read_b128 v[12:15], v64 offset:16384
buffer_load_dwordx4 v0, s[4:7], s55 offen offset:2048 sc1 lds
buffer_load_dwordx4 v0, s[4:7], s55 offen offset:3072 sc1 lds
v_mfma_f32_32x32x16_bf16 v[48:63], v[20:23], v[148:151], v[48:63]
s_waitcnt lgkmcnt(2)
ds_read_b128 v[16:19], v64 offset:17408
s_add_u32 m0, s45, 8192
s_add_u32 s55, s46, 8192
buffer_load_dwordx4 v0, s[4:7], s55 offen offset:0 sc1 lds
buffer_load_dwordx4 v0, s[4:7], s55 offen offset:1024 sc1 lds
v_mfma_f32_32x32x16_bf16 v[48:63], v[24:27], v[152:155], v[48:63]
s_waitcnt lgkmcnt(2)
ds_read_b128 v[20:23], v64 offset:18432
s_add_u32 s45, s45, 40960
s_cmp_ge_u32 s45, 122880
s_cselect_b32 s55, 122880, 0
s_sub_u32 s45, s45, s55
s_add_u32 s46, s46, 40960
v_mfma_f32_32x32x16_bf16 v[48:63], v[8:11], v[156:159], v[48:63]
s_waitcnt lgkmcnt(2)
ds_read_b128 v[24:27], v64 offset:19456
v_mfma_f32_32x32x16_bf16 v[48:63], v[12:15], v[160:163], v[48:63]
s_waitcnt lgkmcnt(2)
ds_read_b128 v[8:11], v64 offset:20480
v_mfma_f32_32x32x16_bf16 v[48:63], v[16:19], v[164:167], v[48:63]
s_waitcnt lgkmcnt(2)
ds_read_b128 v[12:15], v64 offset:21504
v_mfma_f32_32x32x16_bf16 v[48:63], v[20:23], v[168:171], v[48:63]
s_waitcnt lgkmcnt(2)
ds_read_b128 v[16:19], v64 offset:22528
v_mfma_f32_32x32x16_bf16 v[48:63], v[24:27], v[172:175], v[48:63]
s_waitcnt lgkmcnt(2)
ds_read_b128 v[20:23], v64 offset:23552
v_mfma_f32_32x32x16_bf16 v[48:63], v[8:11], v[176:179], v[48:63]
s_waitcnt lgkmcnt(2)
ds_read_b128 v[24:27], v64 offset:24576
v_mfma_f32_32x32x16_bf16 v[48:63], v[12:15], v[180:183], v[48:63]
s_waitcnt lgkmcnt(2)
ds_read_b128 v[8:11], v64 offset:25600
v_mfma_f32_32x32x16_bf16 v[48:63], v[16:19], v[184:187], v[48:63]
s_waitcnt lgkmcnt(2)
ds_read_b128 v[12:15], v64 offset:26624
v_mfma_f32_32x32x16_bf16 v[48:63], v[20:23], v[188:191], v[48:63]
s_waitcnt lgkmcnt(2)
ds_read_b128 v[16:19], v64 offset:27648
v_mfma_f32_32x32x16_bf16 v[48:63], v[24:27], v[192:195], v[48:63]
s_waitcnt lgkmcnt(2)
ds_read_b128 v[20:23], v64 offset:28672
v_mfma_f32_32x32x16_bf16 v[48:63], v[8:11], v[196:199], v[48:63]
s_waitcnt lgkmcnt(2)
ds_read_b128 v[24:27], v64 offset:29696
v_mfma_f32_32x32x16_bf16 v[48:63], v[12:15], v[200:203], v[48:63]
s_waitcnt lgkmcnt(2)
ds_read_b128 v[8:11], v64 offset:30720
v_mfma_f32_32x32x16_bf16 v[48:63], v[16:19], v[204:207], v[48:63]
s_waitcnt lgkmcnt(2)
ds_read_b128 v[12:15], v64 offset:31744
v_mfma_f32_32x32x16_bf16 v[48:63], v[20:23], v[208:211], v[48:63]
s_waitcnt lgkmcnt(2)
ds_read_b128 v[16:19], v64 offset:32768
v_mfma_f32_32x32x16_bf16 v[48:63], v[24:27], v[212:215], v[48:63]
s_waitcnt lgkmcnt(2)
ds_read_b128 v[20:23], v64 offset:33792
v_mfma_f32_32x32x16_bf16 v[48:63], v[8:11], v[216:219], v[48:63]
s_waitcnt lgkmcnt(2)
ds_read_b128 v[24:27], v64 offset:34816
v_mfma_f32_32x32x16_bf16 v[48:63], v[12:15], v[220:223], v[48:63]
s_waitcnt lgkmcnt(2)
ds_read_b128 v[8:11], v64 offset:35840
v_mfma_f32_32x32x16_bf16 v[48:63], v[16:19], v[224:227], v[48:63]
s_waitcnt lgkmcnt(2)
ds_read_b128 v[12:15], v64 offset:36864
v_mfma_f32_32x32x16_bf16 v[48:63], v[20:23], v[228:231], v[48:63]
s_waitcnt lgkmcnt(2)
ds_read_b128 v[16:19], v64 offset:37888
v_mfma_f32_32x32x16_bf16 v[48:63], v[24:27], v[232:235], v[48:63]
s_waitcnt lgkmcnt(2)
ds_read_b128 v[20:23], v64 offset:38912
v_mfma_f32_32x32x16_bf16 v[48:63], v[8:11], v[236:239], v[48:63]
s_waitcnt lgkmcnt(2)
ds_read_b128 v[24:27], v64 offset:39936
v_mfma_f32_32x32x16_bf16 v[48:63], v[12:15], v[240:243], v[48:63]
s_add_u32 s44, s44, 1
s_cmp_eq_u32 s44, 3
s_mov_b32 s56, 40960
s_cmov_b32 s56, -81920
s_cselect_b32 s44, 0, s44
v_add_u32 v64, s56, v64
s_waitcnt vmcnt(10) lgkmcnt(2)
s_barrier
ds_read_b128 v[8:11], v64 offset:0
v_mfma_f32_32x32x16_bf16 v[48:63], v[16:19], v[244:247], v[48:63]
s_waitcnt lgkmcnt(2)
ds_read_b128 v[12:15], v64 offset:1024
v_mfma_f32_32x32x16_bf16 v[48:63], v[20:23], v[248:251], v[48:63]
s_waitcnt lgkmcnt(2)
ds_read_b128 v[16:19], v64 offset:2048
v_mfma_f32_32x32x16_bf16 v[48:63], v[24:27], v[252:255], v[48:63]
s_waitcnt lgkmcnt(2)
ds_read_b128 v[20:23], v64 offset:3072
v_mfma_f32_32x32x16_bf16 v[32:47], v[8:11], v[96:99], 0
s_waitcnt lgkmcnt(2)
ds_read_b128 v[24:27], v64 offset:4096
v_mfma_f32_32x32x16_bf16 v[32:47], v[12:15], v[100:103], v[32:47]
s_waitcnt lgkmcnt(2)
ds_read_b128 v[8:11], v64 offset:5120
v_cvt_pk_bf16_f32 v48, v48, v49
v_cvt_pk_bf16_f32 v49, v50, v51
v_mfma_f32_32x32x16_bf16 v[32:47], v[16:19], v[104:107], v[32:47]
s_waitcnt lgkmcnt(2)
ds_read_b128 v[12:15], v64 offset:6144
v_cvt_pk_bf16_f32 v50, v52, v53
v_cvt_pk_bf16_f32 v51, v54, v55
v_mfma_f32_32x32x16_bf16 v[32:47], v[20:23], v[108:111], v[32:47]
s_waitcnt lgkmcnt(2)
ds_read_b128 v[16:19], v64 offset:7168
v_cvt_pk_bf16_f32 v52, v56, v57
v_cvt_pk_bf16_f32 v53, v58, v59
v_mfma_f32_32x32x16_bf16 v[32:47], v[24:27], v[112:115], v[32:47]
s_waitcnt lgkmcnt(2)
ds_read_b128 v[20:23], v64 offset:8192
v_cvt_pk_bf16_f32 v54, v60, v61
v_cvt_pk_bf16_f32 v55, v62, v63
v_mfma_f32_32x32x16_bf16 v[32:47], v[8:11], v[116:119], v[32:47]
s_waitcnt lgkmcnt(2)
ds_read_b128 v[24:27], v64 offset:9216
v_accvgpr_write_b32 a104, v48
v_accvgpr_write_b32 a105, v49
v_mfma_f32_32x32x16_bf16 v[32:47], v[12:15], v[120:123], v[32:47]
s_waitcnt lgkmcnt(2)
ds_read_b128 v[8:11], v64 offset:10240
v_accvgpr_write_b32 a106, v50
v_accvgpr_write_b32 a107, v51
v_mfma_f32_32x32x16_bf16 v[32:47], v[16:19], v[124:127], v[32:47]
s_waitcnt lgkmcnt(2)
ds_read_b128 v[12:15], v64 offset:11264
v_accvgpr_write_b32 a108, v52
v_accvgpr_write_b32 a109, v53
v_mfma_f32_32x32x16_bf16 v[32:47], v[20:23], v[128:131], v[32:47]
s_waitcnt lgkmcnt(2)
ds_read_b128 v[16:19], v64 offset:12288
v_accvgpr_write_b32 a110, v54
v_accvgpr_write_b32 a111, v55
v_mfma_f32_32x32x16_bf16 v[32:47], v[24:27], v[132:135], v[32:47]
s_waitcnt lgkmcnt(2)
ds_read_b128 v[20:23], v64 offset:13312
s_add_u32 m0, s45, 0
s_add_u32 s55, s46, 0
buffer_load_dwordx4 v0, s[4:7], s55 offen offset:0 sc1 lds
buffer_load_dwordx4 v0, s[4:7], s55 offen offset:1024 sc1 lds
v_mfma_f32_32x32x16_bf16 v[32:47], v[8:11], v[136:139], v[32:47]
s_waitcnt lgkmcnt(2)
ds_read_b128 v[24:27], v64 offset:14336
buffer_load_dwordx4 v0, s[4:7], s55 offen offset:2048 sc1 lds
buffer_load_dwordx4 v0, s[4:7], s55 offen offset:3072 sc1 lds
v_mfma_f32_32x32x16_bf16 v[32:47], v[12:15], v[140:143], v[32:47]
s_waitcnt lgkmcnt(2)
ds_read_b128 v[8:11], v64 offset:15360
s_add_u32 m0, s45, 4096
s_add_u32 s55, s46, 4096
buffer_load_dwordx4 v0, s[4:7], s55 offen offset:0 sc1 lds
buffer_load_dwordx4 v0, s[4:7], s55 offen offset:1024 sc1 lds
v_mfma_f32_32x32x16_bf16 v[32:47], v[16:19], v[144:147], v[32:47]
s_waitcnt lgkmcnt(2)
ds_read_b128 v[12:15], v64 offset:16384
buffer_load_dwordx4 v0, s[4:7], s55 offen offset:2048 sc1 lds
buffer_load_dwordx4 v0, s[4:7], s55 offen offset:3072 sc1 lds
v_mfma_f32_32x32x16_bf16 v[32:47], v[20:23], v[148:151], v[32:47]
s_waitcnt lgkmcnt(2)
ds_read_b128 v[16:19], v64 offset:17408
s_add_u32 m0, s45, 8192
s_add_u32 s55, s46, 8192
buffer_load_dwordx4 v0, s[4:7], s55 offen offset:0 sc1 lds
buffer_load_dwordx4 v0, s[4:7], s55 offen offset:1024 sc1 lds
v_mfma_f32_32x32x16_bf16 v[32:47], v[24:27], v[152:155], v[32:47]
s_waitcnt lgkmcnt(2)
ds_read_b128 v[20:23], v64 offset:18432
s_add_u32 s45, s45, 40960
s_cmp_ge_u32 s45, 122880
s_cselect_b32 s55, 122880, 0
s_sub_u32 s45, s45, s55
s_add_u32 s46, s46, 40960
v_mfma_f32_32x32x16_bf16 v[32:47], v[8:11], v[156:159], v[32:47]
s_waitcnt lgkmcnt(2)
ds_read_b128 v[24:27], v64 offset:19456
v_mfma_f32_32x32x16_bf16 v[32:47], v[12:15], v[160:163], v[32:47]
s_waitcnt lgkmcnt(2)
ds_read_b128 v[8:11], v64 offset:20480
v_mfma_f32_32x32x16_bf16 v[32:47], v[16:19], v[164:167], v[32:47]
s_waitcnt lgkmcnt(2)
ds_read_b128 v[12:15], v64 offset:21504
v_mfma_f32_32x32x16_bf16 v[32:47], v[20:23], v[168:171], v[32:47]
s_waitcnt lgkmcnt(2)
ds_read_b128 v[16:19], v64 offset:22528
v_mfma_f32_32x32x16_bf16 v[32:47], v[24:27], v[172:175], v[32:47]
s_waitcnt lgkmcnt(2)
ds_read_b128 v[20:23], v64 offset:23552
v_mfma_f32_32x32x16_bf16 v[32:47], v[8:11], v[176:179], v[32:47]
s_waitcnt lgkmcnt(2)
ds_read_b128 v[24:27], v64 offset:24576
v_mfma_f32_32x32x16_bf16 v[32:47], v[12:15], v[180:183], v[32:47]
s_waitcnt lgkmcnt(2)
ds_read_b128 v[8:11], v64 offset:25600
v_mfma_f32_32x32x16_bf16 v[32:47], v[16:19], v[184:187], v[32:47]
s_waitcnt lgkmcnt(2)
ds_read_b128 v[12:15], v64 offset:26624
v_mfma_f32_32x32x16_bf16 v[32:47], v[20:23], v[188:191], v[32:47]
s_waitcnt lgkmcnt(2)
ds_read_b128 v[16:19], v64 offset:27648
v_mfma_f32_32x32x16_bf16 v[32:47], v[24:27], v[192:195], v[32:47]
s_waitcnt lgkmcnt(2)
ds_read_b128 v[20:23], v64 offset:28672
v_mfma_f32_32x32x16_bf16 v[32:47], v[8:11], v[196:199], v[32:47]
s_waitcnt lgkmcnt(2)
ds_read_b128 v[24:27], v64 offset:29696
v_mfma_f32_32x32x16_bf16 v[32:47], v[12:15], v[200:203], v[32:47]
s_waitcnt lgkmcnt(2)
ds_read_b128 v[8:11], v64 offset:30720
v_mfma_f32_32x32x16_bf16 v[32:47], v[16:19], v[204:207], v[32:47]
s_waitcnt lgkmcnt(2)
ds_read_b128 v[12:15], v64 offset:31744
v_mfma_f32_32x32x16_bf16 v[32:47], v[20:23], v[208:211], v[32:47]
s_waitcnt lgkmcnt(2)
ds_read_b128 v[16:19], v64 offset:32768
v_mfma_f32_32x32x16_bf16 v[32:47], v[24:27], v[212:215], v[32:47]
s_waitcnt lgkmcnt(2)
ds_read_b128 v[20:23], v64 offset:33792
v_mfma_f32_32x32x16_bf16 v[32:47], v[8:11], v[216:219], v[32:47]
s_waitcnt lgkmcnt(2)
ds_read_b128 v[24:27], v64 offset:34816
v_mfma_f32_32x32x16_bf16 v[32:47], v[12:15], v[220:223], v[32:47]
s_waitcnt lgkmcnt(2)
ds_read_b128 v[8:11], v64 offset:35840
v_mfma_f32_32x32x16_bf16 v[32:47], v[16:19], v[224:227], v[32:47]
s_waitcnt lgkmcnt(2)
ds_read_b128 v[12:15], v64 offset:36864
v_mfma_f32_32x32x16_bf16 v[32:47], v[20:23], v[228:231], v[32:47]
s_waitcnt lgkmcnt(2)
ds_read_b128 v[16:19], v64 offset:37888
v_mfma_f32_32x32x16_bf16 v[32:47], v[24:27], v[232:235], v[32:47]
s_waitcnt lgkmcnt(2)
ds_read_b128 v[20:23], v64 offset:38912
v_mfma_f32_32x32x16_bf16 v[32:47], v[8:11], v[236:239], v[32:47]
s_waitcnt lgkmcnt(2)
ds_read_b128 v[24:27], v64 offset:39936
v_mfma_f32_32x32x16_bf16 v[32:47], v[12:15], v[240:243], v[32:47]
s_add_u32 s44, s44, 1
s_cmp_eq_u32 s44, 3
s_mov_b32 s56, 40960
s_cmov_b32 s56, -81920
s_cselect_b32 s44, 0, s44
v_add_u32 v64, s56, v64
s_waitcnt vmcnt(10) lgkmcnt(2)
s_barrier
ds_read_b128 v[8:11], v64 offset:0
v_mfma_f32_32x32x16_bf16 v[32:47], v[16:19], v[244:247], v[32:47]
s_waitcnt lgkmcnt(2)
ds_read_b128 v[12:15], v64 offset:1024
v_mfma_f32_32x32x16_bf16 v[32:47], v[20:23], v[248:251], v[32:47]
s_waitcnt lgkmcnt(2)
ds_read_b128 v[16:19], v64 offset:2048
v_mfma_f32_32x32x16_bf16 v[32:47], v[24:27], v[252:255], v[32:47]
s_waitcnt lgkmcnt(2)
ds_read_b128 v[20:23], v64 offset:3072
v_mfma_f32_32x32x16_bf16 v[48:63], v[8:11], v[96:99], 0
s_waitcnt lgkmcnt(2)
ds_read_b128 v[24:27], v64 offset:4096
v_mfma_f32_32x32x16_bf16 v[48:63], v[12:15], v[100:103], v[48:63]
s_waitcnt lgkmcnt(2)
ds_read_b128 v[8:11], v64 offset:5120
v_cvt_pk_bf16_f32 v32, v32, v33
v_cvt_pk_bf16_f32 v33, v34, v35
v_mfma_f32_32x32x16_bf16 v[48:63], v[16:19], v[104:107], v[48:63]
s_waitcnt lgkmcnt(2)
ds_read_b128 v[12:15], v64 offset:6144
v_cvt_pk_bf16_f32 v34, v36, v37
v_cvt_pk_bf16_f32 v35, v38, v39
v_mfma_f32_32x32x16_bf16 v[48:63], v[20:23], v[108:111], v[48:63]
s_waitcnt lgkmcnt(2)
ds_read_b128 v[16:19], v64 offset:7168
v_cvt_pk_bf16_f32 v36, v40, v41
v_cvt_pk_bf16_f32 v37, v42, v43
v_mfma_f32_32x32x16_bf16 v[48:63], v[24:27], v[112:115], v[48:63]
s_waitcnt lgkmcnt(2)
ds_read_b128 v[20:23], v64 offset:8192
v_cvt_pk_bf16_f32 v38, v44, v45
v_cvt_pk_bf16_f32 v39, v46, v47
v_mfma_f32_32x32x16_bf16 v[48:63], v[8:11], v[116:119], v[48:63]
s_waitcnt lgkmcnt(2)
ds_read_b128 v[24:27], v64 offset:9216
v_accvgpr_write_b32 a112, v32
v_accvgpr_write_b32 a113, v33
v_mfma_f32_32x32x16_bf16 v[48:63], v[12:15], v[120:123], v[48:63]
s_waitcnt lgkmcnt(2)
ds_read_b128 v[8:11], v64 offset:10240
v_accvgpr_write_b32 a114, v34
v_accvgpr_write_b32 a115, v35
v_mfma_f32_32x32x16_bf16 v[48:63], v[16:19], v[124:127], v[48:63]
s_waitcnt lgkmcnt(2)
ds_read_b128 v[12:15], v64 offset:11264
v_accvgpr_write_b32 a116, v36
v_accvgpr_write_b32 a117, v37
v_mfma_f32_32x32x16_bf16 v[48:63], v[20:23], v[128:131], v[48:63]
s_waitcnt lgkmcnt(2)
ds_read_b128 v[16:19], v64 offset:12288
v_accvgpr_write_b32 a118, v38
v_accvgpr_write_b32 a119, v39
v_mfma_f32_32x32x16_bf16 v[48:63], v[24:27], v[132:135], v[48:63]
s_waitcnt lgkmcnt(2)
ds_read_b128 v[20:23], v64 offset:13312
s_add_u32 m0, s45, 0
s_add_u32 s55, s46, 0
buffer_load_dwordx4 v0, s[4:7], s55 offen offset:0 sc1 lds
buffer_load_dwordx4 v0, s[4:7], s55 offen offset:1024 sc1 lds
v_mfma_f32_32x32x16_bf16 v[48:63], v[8:11], v[136:139], v[48:63]
s_waitcnt lgkmcnt(2)
ds_read_b128 v[24:27], v64 offset:14336
buffer_load_dwordx4 v0, s[4:7], s55 offen offset:2048 sc1 lds
buffer_load_dwordx4 v0, s[4:7], s55 offen offset:3072 sc1 lds
v_mfma_f32_32x32x16_bf16 v[48:63], v[12:15], v[140:143], v[48:63]
s_waitcnt lgkmcnt(2)
ds_read_b128 v[8:11], v64 offset:15360
s_add_u32 m0, s45, 4096
s_add_u32 s55, s46, 4096
buffer_load_dwordx4 v0, s[4:7], s55 offen offset:0 sc1 lds
buffer_load_dwordx4 v0, s[4:7], s55 offen offset:1024 sc1 lds
v_mfma_f32_32x32x16_bf16 v[48:63], v[16:19], v[144:147], v[48:63]
s_waitcnt lgkmcnt(2)
ds_read_b128 v[12:15], v64 offset:16384
buffer_load_dwordx4 v0, s[4:7], s55 offen offset:2048 sc1 lds
buffer_load_dwordx4 v0, s[4:7], s55 offen offset:3072 sc1 lds
v_mfma_f32_32x32x16_bf16 v[48:63], v[20:23], v[148:151], v[48:63]
s_waitcnt lgkmcnt(2)
ds_read_b128 v[16:19], v64 offset:17408
s_add_u32 m0, s45, 8192
s_add_u32 s55, s46, 8192
buffer_load_dwordx4 v0, s[4:7], s55 offen offset:0 sc1 lds
buffer_load_dwordx4 v0, s[4:7], s55 offen offset:1024 sc1 lds
v_mfma_f32_32x32x16_bf16 v[48:63], v[24:27], v[152:155], v[48:63]
s_waitcnt lgkmcnt(2)
ds_read_b128 v[20:23], v64 offset:18432
s_add_u32 s45, s45, 40960
s_cmp_ge_u32 s45, 122880
s_cselect_b32 s55, 122880, 0
s_sub_u32 s45, s45, s55
s_add_u32 s46, s46, 40960
v_mfma_f32_32x32x16_bf16 v[48:63], v[8:11], v[156:159], v[48:63]
s_waitcnt lgkmcnt(2)
ds_read_b128 v[24:27], v64 offset:19456
v_mfma_f32_32x32x16_bf16 v[48:63], v[12:15], v[160:163], v[48:63]
s_waitcnt lgkmcnt(2)
ds_read_b128 v[8:11], v64 offset:20480
v_mfma_f32_32x32x16_bf16 v[48:63], v[16:19], v[164:167], v[48:63]
s_waitcnt lgkmcnt(2)
ds_read_b128 v[12:15], v64 offset:21504
v_mfma_f32_32x32x16_bf16 v[48:63], v[20:23], v[168:171], v[48:63]
s_waitcnt lgkmcnt(2)
ds_read_b128 v[16:19], v64 offset:22528
v_mfma_f32_32x32x16_bf16 v[48:63], v[24:27], v[172:175], v[48:63]
s_waitcnt lgkmcnt(2)
ds_read_b128 v[20:23], v64 offset:23552
v_mfma_f32_32x32x16_bf16 v[48:63], v[8:11], v[176:179], v[48:63]
s_waitcnt lgkmcnt(2)
ds_read_b128 v[24:27], v64 offset:24576
v_mfma_f32_32x32x16_bf16 v[48:63], v[12:15], v[180:183], v[48:63]
s_waitcnt lgkmcnt(2)
ds_read_b128 v[8:11], v64 offset:25600
v_mfma_f32_32x32x16_bf16 v[48:63], v[16:19], v[184:187], v[48:63]
s_waitcnt lgkmcnt(2)
ds_read_b128 v[12:15], v64 offset:26624
v_mfma_f32_32x32x16_bf16 v[48:63], v[20:23], v[188:191], v[48:63]
s_waitcnt lgkmcnt(2)
ds_read_b128 v[16:19], v64 offset:27648
v_mfma_f32_32x32x16_bf16 v[48:63], v[24:27], v[192:195], v[48:63]
s_waitcnt lgkmcnt(2)
ds_read_b128 v[20:23], v64 offset:28672
v_mfma_f32_32x32x16_bf16 v[48:63], v[8:11], v[196:199], v[48:63]
s_waitcnt lgkmcnt(2)
ds_read_b128 v[24:27], v64 offset:29696
v_mfma_f32_32x32x16_bf16 v[48:63], v[12:15], v[200:203], v[48:63]
s_waitcnt lgkmcnt(2)
ds_read_b128 v[8:11], v64 offset:30720
v_mfma_f32_32x32x16_bf16 v[48:63], v[16:19], v[204:207], v[48:63]
s_waitcnt lgkmcnt(2)
ds_read_b128 v[12:15], v64 offset:31744
v_mfma_f32_32x32x16_bf16 v[48:63], v[20:23], v[208:211], v[48:63]
s_waitcnt lgkmcnt(2)
ds_read_b128 v[16:19], v64 offset:32768
v_mfma_f32_32x32x16_bf16 v[48:63], v[24:27], v[212:215], v[48:63]
s_waitcnt lgkmcnt(2)
ds_read_b128 v[20:23], v64 offset:33792
v_mfma_f32_32x32x16_bf16 v[48:63], v[8:11], v[216:219], v[48:63]
s_waitcnt lgkmcnt(2)
ds_read_b128 v[24:27], v64 offset:34816
v_mfma_f32_32x32x16_bf16 v[48:63], v[12:15], v[220:223], v[48:63]
s_waitcnt lgkmcnt(2)
ds_read_b128 v[8:11], v64 offset:35840
v_mfma_f32_32x32x16_bf16 v[48:63], v[16:19], v[224:227], v[48:63]
s_waitcnt lgkmcnt(2)
ds_read_b128 v[12:15], v64 offset:36864
v_mfma_f32_32x32x16_bf16 v[48:63], v[20:23], v[228:231], v[48:63]
s_waitcnt lgkmcnt(2)
ds_read_b128 v[16:19], v64 offset:37888
v_mfma_f32_32x32x16_bf16 v[48:63], v[24:27], v[232:235], v[48:63]
s_waitcnt lgkmcnt(2)
ds_read_b128 v[20:23], v64 offset:38912
v_mfma_f32_32x32x16_bf16 v[48:63], v[8:11], v[236:239], v[48:63]
s_waitcnt lgkmcnt(2)
ds_read_b128 v[24:27], v64 offset:39936
v_mfma_f32_32x32x16_bf16 v[48:63], v[12:15], v[240:243], v[48:63]
s_add_u32 s44, s44, 1
s_cmp_eq_u32 s44, 3
s_mov_b32 s56, 40960
s_cmov_b32 s56, -81920
s_cselect_b32 s44, 0, s44
v_add_u32 v64, s56, v64
s_waitcnt vmcnt(10) lgkmcnt(2)
s_barrier
ds_read_b128 v[8:11], v64 offset:0
v_mfma_f32_32x32x16_bf16 v[48:63], v[16:19], v[244:247], v[48:63]
s_waitcnt lgkmcnt(2)
ds_read_b128 v[12:15], v64 offset:1024
v_mfma_f32_32x32x16_bf16 v[48:63], v[20:23], v[248:251], v[48:63]
s_waitcnt lgkmcnt(2)
ds_read_b128 v[16:19], v64 offset:2048
v_mfma_f32_32x32x16_bf16 v[48:63], v[24:27], v[252:255], v[48:63]
s_waitcnt lgkmcnt(2)
ds_read_b128 v[20:23], v64 offset:3072
v_mfma_f32_32x32x16_bf16 v[32:47], v[8:11], v[96:99], 0
s_waitcnt lgkmcnt(2)
ds_read_b128 v[24:27], v64 offset:4096
v_mfma_f32_32x32x16_bf16 v[32:47], v[12:15], v[100:103], v[32:47]
s_waitcnt lgkmcnt(2)
ds_read_b128 v[8:11], v64 offset:5120
v_cvt_pk_bf16_f32 v48, v48, v49
v_cvt_pk_bf16_f32 v49, v50, v51
v_mfma_f32_32x32x16_bf16 v[32:47], v[16:19], v[104:107], v[32:47]
s_waitcnt lgkmcnt(2)
ds_read_b128 v[12:15], v64 offset:6144
v_cvt_pk_bf16_f32 v50, v52, v53
v_cvt_pk_bf16_f32 v51, v54, v55
v_mfma_f32_32x32x16_bf16 v[32:47], v[20:23], v[108:111], v[32:47]
s_waitcnt lgkmcnt(2)
ds_read_b128 v[16:19], v64 offset:7168
v_cvt_pk_bf16_f32 v52, v56, v57
v_cvt_pk_bf16_f32 v53, v58, v59
v_mfma_f32_32x32x16_bf16 v[32:47], v[24:27], v[112:115], v[32:47]
s_waitcnt lgkmcnt(2)
ds_read_b128 v[20:23], v64 offset:8192
v_cvt_pk_bf16_f32 v54, v60, v61
v_cvt_pk_bf16_f32 v55, v62, v63
v_mfma_f32_32x32x16_bf16 v[32:47], v[8:11], v[116:119], v[32:47]
s_waitcnt lgkmcnt(2)
ds_read_b128 v[24:27], v64 offset:9216
v_accvgpr_write_b32 a120, v48
v_accvgpr_write_b32 a121, v49
v_mfma_f32_32x32x16_bf16 v[32:47], v[12:15], v[120:123], v[32:47]
s_waitcnt lgkmcnt(2)
ds_read_b128 v[8:11], v64 offset:10240
v_accvgpr_write_b32 a122, v50
v_accvgpr_write_b32 a123, v51
v_mfma_f32_32x32x16_bf16 v[32:47], v[16:19], v[124:127], v[32:47]
s_waitcnt lgkmcnt(2)
ds_read_b128 v[12:15], v64 offset:11264
v_accvgpr_write_b32 a124, v52
v_accvgpr_write_b32 a125, v53
v_mfma_f32_32x32x16_bf16 v[32:47], v[20:23], v[128:131], v[32:47]
s_waitcnt lgkmcnt(2)
ds_read_b128 v[16:19], v64 offset:12288
v_accvgpr_write_b32 a126, v54
v_accvgpr_write_b32 a127, v55
v_mfma_f32_32x32x16_bf16 v[32:47], v[24:27], v[132:135], v[32:47]
s_waitcnt lgkmcnt(2)
ds_read_b128 v[20:23], v64 offset:13312
s_add_u32 m0, s45, 0
s_add_u32 s55, s46, 0
buffer_load_dwordx4 v0, s[4:7], s55 offen offset:0 sc1 lds
buffer_load_dwordx4 v0, s[4:7], s55 offen offset:1024 sc1 lds
v_mfma_f32_32x32x16_bf16 v[32:47], v[8:11], v[136:139], v[32:47]
s_waitcnt lgkmcnt(2)
ds_read_b128 v[24:27], v64 offset:14336
buffer_load_dwordx4 v0, s[4:7], s55 offen offset:2048 sc1 lds
buffer_load_dwordx4 v0, s[4:7], s55 offen offset:3072 sc1 lds
v_mfma_f32_32x32x16_bf16 v[32:47], v[12:15], v[140:143], v[32:47]
s_waitcnt lgkmcnt(2)
ds_read_b128 v[8:11], v64 offset:15360
s_add_u32 m0, s45, 4096
s_add_u32 s55, s46, 4096
buffer_load_dwordx4 v0, s[4:7], s55 offen offset:0 sc1 lds
buffer_load_dwordx4 v0, s[4:7], s55 offen offset:1024 sc1 lds
v_mfma_f32_32x32x16_bf16 v[32:47], v[16:19], v[144:147], v[32:47]
s_waitcnt lgkmcnt(2)
ds_read_b128 v[12:15], v64 offset:16384
buffer_load_dwordx4 v0, s[4:7], s55 offen offset:2048 sc1 lds
buffer_load_dwordx4 v0, s[4:7], s55 offen offset:3072 sc1 lds
v_mfma_f32_32x32x16_bf16 v[32:47], v[20:23], v[148:151], v[32:47]
s_waitcnt lgkmcnt(2)
ds_read_b128 v[16:19], v64 offset:17408
s_add_u32 m0, s45, 8192
s_add_u32 s55, s46, 8192
buffer_load_dwordx4 v0, s[4:7], s55 offen offset:0 sc1 lds
buffer_load_dwordx4 v0, s[4:7], s55 offen offset:1024 sc1 lds
v_mfma_f32_32x32x16_bf16 v[32:47], v[24:27], v[152:155], v[32:47]
s_waitcnt lgkmcnt(2)
ds_read_b128 v[20:23], v64 offset:18432
s_add_u32 s45, s45, 40960
s_cmp_ge_u32 s45, 122880
s_cselect_b32 s55, 122880, 0
s_sub_u32 s45, s45, s55
s_add_u32 s46, s46, 40960
v_mfma_f32_32x32x16_bf16 v[32:47], v[8:11], v[156:159], v[32:47]
s_waitcnt lgkmcnt(2)
ds_read_b128 v[24:27], v64 offset:19456
v_mfma_f32_32x32x16_bf16 v[32:47], v[12:15], v[160:163], v[32:47]
s_waitcnt lgkmcnt(2)
ds_read_b128 v[8:11], v64 offset:20480
v_mfma_f32_32x32x16_bf16 v[32:47], v[16:19], v[164:167], v[32:47]
s_waitcnt lgkmcnt(2)
ds_read_b128 v[12:15], v64 offset:21504
v_mfma_f32_32x32x16_bf16 v[32:47], v[20:23], v[168:171], v[32:47]
s_waitcnt lgkmcnt(2)
ds_read_b128 v[16:19], v64 offset:22528
v_mfma_f32_32x32x16_bf16 v[32:47], v[24:27], v[172:175], v[32:47]
s_waitcnt lgkmcnt(2)
ds_read_b128 v[20:23], v64 offset:23552
v_mfma_f32_32x32x16_bf16 v[32:47], v[8:11], v[176:179], v[32:47]
s_waitcnt lgkmcnt(2)
ds_read_b128 v[24:27], v64 offset:24576
v_mfma_f32_32x32x16_bf16 v[32:47], v[12:15], v[180:183], v[32:47]
s_waitcnt lgkmcnt(2)
ds_read_b128 v[8:11], v64 offset:25600
v_mfma_f32_32x32x16_bf16 v[32:47], v[16:19], v[184:187], v[32:47]
s_waitcnt lgkmcnt(2)
ds_read_b128 v[12:15], v64 offset:26624
v_mfma_f32_32x32x16_bf16 v[32:47], v[20:23], v[188:191], v[32:47]
s_waitcnt lgkmcnt(2)
ds_read_b128 v[16:19], v64 offset:27648
v_mfma_f32_32x32x16_bf16 v[32:47], v[24:27], v[192:195], v[32:47]
s_waitcnt lgkmcnt(2)
ds_read_b128 v[20:23], v64 offset:28672
v_mfma_f32_32x32x16_bf16 v[32:47], v[8:11], v[196:199], v[32:47]
s_waitcnt lgkmcnt(2)
ds_read_b128 v[24:27], v64 offset:29696
v_mfma_f32_32x32x16_bf16 v[32:47], v[12:15], v[200:203], v[32:47]
s_waitcnt lgkmcnt(2)
ds_read_b128 v[8:11], v64 offset:30720
v_mfma_f32_32x32x16_bf16 v[32:47], v[16:19], v[204:207], v[32:47]
s_waitcnt lgkmcnt(2)
ds_read_b128 v[12:15], v64 offset:31744
v_mfma_f32_32x32x16_bf16 v[32:47], v[20:23], v[208:211], v[32:47]
s_waitcnt lgkmcnt(2)
ds_read_b128 v[16:19], v64 offset:32768
v_mfma_f32_32x32x16_bf16 v[32:47], v[24:27], v[212:215], v[32:47]
s_waitcnt lgkmcnt(2)
ds_read_b128 v[20:23], v64 offset:33792
v_mfma_f32_32x32x16_bf16 v[32:47], v[8:11], v[216:219], v[32:47]
s_waitcnt lgkmcnt(2)
ds_read_b128 v[24:27], v64 offset:34816
v_mfma_f32_32x32x16_bf16 v[32:47], v[12:15], v[220:223], v[32:47]
s_waitcnt lgkmcnt(2)
ds_read_b128 v[8:11], v64 offset:35840
v_mfma_f32_32x32x16_bf16 v[32:47], v[16:19], v[224:227], v[32:47]
s_waitcnt lgkmcnt(2)
ds_read_b128 v[12:15], v64 offset:36864
v_mfma_f32_32x32x16_bf16 v[32:47], v[20:23], v[228:231], v[32:47]
s_waitcnt lgkmcnt(2)
ds_read_b128 v[16:19], v64 offset:37888
v_mfma_f32_32x32x16_bf16 v[32:47], v[24:27], v[232:235], v[32:47]
s_waitcnt lgkmcnt(2)
ds_read_b128 v[20:23], v64 offset:38912
v_mfma_f32_32x32x16_bf16 v[32:47], v[8:11], v[236:239], v[32:47]
s_waitcnt lgkmcnt(2)
ds_read_b128 v[24:27], v64 offset:39936
v_mfma_f32_32x32x16_bf16 v[32:47], v[12:15], v[240:243], v[32:47]
s_add_u32 s44, s44, 1
s_cmp_eq_u32 s44, 3
s_mov_b32 s56, 40960
s_cmov_b32 s56, -81920
s_cselect_b32 s44, 0, s44
v_add_u32 v64, s56, v64
s_waitcnt vmcnt(10) lgkmcnt(2)
s_barrier
ds_read_b128 v[8:11], v64 offset:0
v_mfma_f32_32x32x16_bf16 v[32:47], v[16:19], v[244:247], v[32:47]
s_waitcnt lgkmcnt(2)
ds_read_b128 v[12:15], v64 offset:1024
v_mfma_f32_32x32x16_bf16 v[32:47], v[20:23], v[248:251], v[32:47]
s_waitcnt lgkmcnt(2)
ds_read_b128 v[16:19], v64 offset:2048
v_mfma_f32_32x32x16_bf16 v[32:47], v[24:27], v[252:255], v[32:47]
s_waitcnt lgkmcnt(2)
ds_read_b128 v[20:23], v64 offset:3072
v_mfma_f32_32x32x16_bf16 v[48:63], v[8:11], v[96:99], 0
s_waitcnt lgkmcnt(2)
ds_read_b128 v[24:27], v64 offset:4096
v_mfma_f32_32x32x16_bf16 v[48:63], v[12:15], v[100:103], v[48:63]
s_waitcnt lgkmcnt(2)
ds_read_b128 v[8:11], v64 offset:5120
v_cvt_pk_bf16_f32 v32, v32, v33
v_cvt_pk_bf16_f32 v33, v34, v35
v_mfma_f32_32x32x16_bf16 v[48:63], v[16:19], v[104:107], v[48:63]
s_waitcnt lgkmcnt(2)
ds_read_b128 v[12:15], v64 offset:6144
v_cvt_pk_bf16_f32 v34, v36, v37
v_cvt_pk_bf16_f32 v35, v38, v39
v_mfma_f32_32x32x16_bf16 v[48:63], v[20:23], v[108:111], v[48:63]
s_waitcnt lgkmcnt(2)
ds_read_b128 v[16:19], v64 offset:7168
v_cvt_pk_bf16_f32 v36, v40, v41
v_cvt_pk_bf16_f32 v37, v42, v43
v_mfma_f32_32x32x16_bf16 v[48:63], v[24:27], v[112:115], v[48:63]
s_waitcnt lgkmcnt(2)
ds_read_b128 v[20:23], v64 offset:8192
v_cvt_pk_bf16_f32 v38, v44, v45
v_cvt_pk_bf16_f32 v39, v46, v47
v_mfma_f32_32x32x16_bf16 v[48:63], v[8:11], v[116:119], v[48:63]
s_waitcnt lgkmcnt(2)
ds_read_b128 v[24:27], v64 offset:9216
v_accvgpr_write_b32 a128, v32
v_accvgpr_write_b32 a129, v33
v_mfma_f32_32x32x16_bf16 v[48:63], v[12:15], v[120:123], v[48:63]
s_waitcnt lgkmcnt(2)
ds_read_b128 v[8:11], v64 offset:10240
v_accvgpr_write_b32 a130, v34
v_accvgpr_write_b32 a131, v35
v_mfma_f32_32x32x16_bf16 v[48:63], v[16:19], v[124:127], v[48:63]
s_waitcnt lgkmcnt(2)
ds_read_b128 v[12:15], v64 offset:11264
v_accvgpr_write_b32 a132, v36
v_accvgpr_write_b32 a133, v37
v_mfma_f32_32x32x16_bf16 v[48:63], v[20:23], v[128:131], v[48:63]
s_waitcnt lgkmcnt(2)
ds_read_b128 v[16:19], v64 offset:12288
v_accvgpr_write_b32 a134, v38
v_accvgpr_write_b32 a135, v39
v_mfma_f32_32x32x16_bf16 v[48:63], v[24:27], v[132:135], v[48:63]
s_waitcnt lgkmcnt(2)
ds_read_b128 v[20:23], v64 offset:13312
s_add_u32 m0, s45, 0
s_add_u32 s55, s46, 0
buffer_load_dwordx4 v0, s[4:7], s55 offen offset:0 sc1 lds
buffer_load_dwordx4 v0, s[4:7], s55 offen offset:1024 sc1 lds
v_mfma_f32_32x32x16_bf16 v[48:63], v[8:11], v[136:139], v[48:63]
s_waitcnt lgkmcnt(2)
ds_read_b128 v[24:27], v64 offset:14336
buffer_load_dwordx4 v0, s[4:7], s55 offen offset:2048 sc1 lds
buffer_load_dwordx4 v0, s[4:7], s55 offen offset:3072 sc1 lds
v_mfma_f32_32x32x16_bf16 v[48:63], v[12:15], v[140:143], v[48:63]
s_waitcnt lgkmcnt(2)
ds_read_b128 v[8:11], v64 offset:15360
s_add_u32 m0, s45, 4096
s_add_u32 s55, s46, 4096
buffer_load_dwordx4 v0, s[4:7], s55 offen offset:0 sc1 lds
buffer_load_dwordx4 v0, s[4:7], s55 offen offset:1024 sc1 lds
v_mfma_f32_32x32x16_bf16 v[48:63], v[16:19], v[144:147], v[48:63]
s_waitcnt lgkmcnt(2)
ds_read_b128 v[12:15], v64 offset:16384
buffer_load_dwordx4 v0, s[4:7], s55 offen offset:2048 sc1 lds
buffer_load_dwordx4 v0, s[4:7], s55 offen offset:3072 sc1 lds
v_mfma_f32_32x32x16_bf16 v[48:63], v[20:23], v[148:151], v[48:63]
s_waitcnt lgkmcnt(2)
ds_read_b128 v[16:19], v64 offset:17408
s_add_u32 m0, s45, 8192
s_add_u32 s55, s46, 8192
buffer_load_dwordx4 v0, s[4:7], s55 offen offset:0 sc1 lds
buffer_load_dwordx4 v0, s[4:7], s55 offen offset:1024 sc1 lds
v_mfma_f32_32x32x16_bf16 v[48:63], v[24:27], v[152:155], v[48:63]
s_waitcnt lgkmcnt(2)
ds_read_b128 v[20:23], v64 offset:18432
s_add_u32 s45, s45, 40960
s_cmp_ge_u32 s45, 122880
s_cselect_b32 s55, 122880, 0
s_sub_u32 s45, s45, s55
s_add_u32 s46, s46, 40960
v_mfma_f32_32x32x16_bf16 v[48:63], v[8:11], v[156:159], v[48:63]
s_waitcnt lgkmcnt(2)
ds_read_b128 v[24:27], v64 offset:19456
v_mfma_f32_32x32x16_bf16 v[48:63], v[12:15], v[160:163], v[48:63]
s_waitcnt lgkmcnt(2)
ds_read_b128 v[8:11], v64 offset:20480
v_mfma_f32_32x32x16_bf16 v[48:63], v[16:19], v[164:167], v[48:63]
s_waitcnt lgkmcnt(2)
ds_read_b128 v[12:15], v64 offset:21504
v_mfma_f32_32x32x16_bf16 v[48:63], v[20:23], v[168:171], v[48:63]
s_waitcnt lgkmcnt(2)
ds_read_b128 v[16:19], v64 offset:22528
v_mfma_f32_32x32x16_bf16 v[48:63], v[24:27], v[172:175], v[48:63]
s_waitcnt lgkmcnt(2)
ds_read_b128 v[20:23], v64 offset:23552
v_mfma_f32_32x32x16_bf16 v[48:63], v[8:11], v[176:179], v[48:63]
s_waitcnt lgkmcnt(2)
ds_read_b128 v[24:27], v64 offset:24576
v_mfma_f32_32x32x16_bf16 v[48:63], v[12:15], v[180:183], v[48:63]
s_waitcnt lgkmcnt(2)
ds_read_b128 v[8:11], v64 offset:25600
v_mfma_f32_32x32x16_bf16 v[48:63], v[16:19], v[184:187], v[48:63]
s_waitcnt lgkmcnt(2)
ds_read_b128 v[12:15], v64 offset:26624
v_mfma_f32_32x32x16_bf16 v[48:63], v[20:23], v[188:191], v[48:63]
s_waitcnt lgkmcnt(2)
ds_read_b128 v[16:19], v64 offset:27648
v_mfma_f32_32x32x16_bf16 v[48:63], v[24:27], v[192:195], v[48:63]
s_waitcnt lgkmcnt(2)
ds_read_b128 v[20:23], v64 offset:28672
v_mfma_f32_32x32x16_bf16 v[48:63], v[8:11], v[196:199], v[48:63]
s_waitcnt lgkmcnt(2)
ds_read_b128 v[24:27], v64 offset:29696
v_mfma_f32_32x32x16_bf16 v[48:63], v[12:15], v[200:203], v[48:63]
s_waitcnt lgkmcnt(2)
ds_read_b128 v[8:11], v64 offset:30720
v_mfma_f32_32x32x16_bf16 v[48:63], v[16:19], v[204:207], v[48:63]
s_waitcnt lgkmcnt(2)
ds_read_b128 v[12:15], v64 offset:31744
v_mfma_f32_32x32x16_bf16 v[48:63], v[20:23], v[208:211], v[48:63]
s_waitcnt lgkmcnt(2)
ds_read_b128 v[16:19], v64 offset:32768
v_mfma_f32_32x32x16_bf16 v[48:63], v[24:27], v[212:215], v[48:63]
s_waitcnt lgkmcnt(2)
ds_read_b128 v[20:23], v64 offset:33792
v_mfma_f32_32x32x16_bf16 v[48:63], v[8:11], v[216:219], v[48:63]
s_waitcnt lgkmcnt(2)
ds_read_b128 v[24:27], v64 offset:34816
v_mfma_f32_32x32x16_bf16 v[48:63], v[12:15], v[220:223], v[48:63]
s_waitcnt lgkmcnt(2)
ds_read_b128 v[8:11], v64 offset:35840
v_mfma_f32_32x32x16_bf16 v[48:63], v[16:19], v[224:227], v[48:63]
s_waitcnt lgkmcnt(2)
ds_read_b128 v[12:15], v64 offset:36864
v_mfma_f32_32x32x16_bf16 v[48:63], v[20:23], v[228:231], v[48:63]
s_waitcnt lgkmcnt(2)
ds_read_b128 v[16:19], v64 offset:37888
v_mfma_f32_32x32x16_bf16 v[48:63], v[24:27], v[232:235], v[48:63]
s_waitcnt lgkmcnt(2)
ds_read_b128 v[20:23], v64 offset:38912
v_mfma_f32_32x32x16_bf16 v[48:63], v[8:11], v[236:239], v[48:63]
s_waitcnt lgkmcnt(2)
ds_read_b128 v[24:27], v64 offset:39936
v_mfma_f32_32x32x16_bf16 v[48:63], v[12:15], v[240:243], v[48:63]
s_add_u32 s44, s44, 1
s_cmp_eq_u32 s44, 3
s_mov_b32 s56, 40960
s_cmov_b32 s56, -81920
s_cselect_b32 s44, 0, s44
v_add_u32 v64, s56, v64
s_waitcnt vmcnt(10) lgkmcnt(2)
s_barrier
ds_read_b128 v[8:11], v64 offset:0
v_mfma_f32_32x32x16_bf16 v[48:63], v[16:19], v[244:247], v[48:63]
s_waitcnt lgkmcnt(2)
ds_read_b128 v[12:15], v64 offset:1024
v_mfma_f32_32x32x16_bf16 v[48:63], v[20:23], v[248:251], v[48:63]
s_waitcnt lgkmcnt(2)
ds_read_b128 v[16:19], v64 offset:2048
v_mfma_f32_32x32x16_bf16 v[48:63], v[24:27], v[252:255], v[48:63]
s_waitcnt lgkmcnt(2)
ds_read_b128 v[20:23], v64 offset:3072
v_mfma_f32_32x32x16_bf16 v[32:47], v[8:11], v[96:99], 0
s_waitcnt lgkmcnt(2)
ds_read_b128 v[24:27], v64 offset:4096
v_mfma_f32_32x32x16_bf16 v[32:47], v[12:15], v[100:103], v[32:47]
s_waitcnt lgkmcnt(2)
ds_read_b128 v[8:11], v64 offset:5120
v_cvt_pk_bf16_f32 v48, v48, v49
v_cvt_pk_bf16_f32 v49, v50, v51
v_mfma_f32_32x32x16_bf16 v[32:47], v[16:19], v[104:107], v[32:47]
s_waitcnt lgkmcnt(2)
ds_read_b128 v[12:15], v64 offset:6144
v_cvt_pk_bf16_f32 v50, v52, v53
v_cvt_pk_bf16_f32 v51, v54, v55
v_mfma_f32_32x32x16_bf16 v[32:47], v[20:23], v[108:111], v[32:47]
s_waitcnt lgkmcnt(2)
ds_read_b128 v[16:19], v64 offset:7168
v_cvt_pk_bf16_f32 v52, v56, v57
v_cvt_pk_bf16_f32 v53, v58, v59
v_mfma_f32_32x32x16_bf16 v[32:47], v[24:27], v[112:115], v[32:47]
s_waitcnt lgkmcnt(2)
ds_read_b128 v[20:23], v64 offset:8192
v_cvt_pk_bf16_f32 v54, v60, v61
v_cvt_pk_bf16_f32 v55, v62, v63
v_mfma_f32_32x32x16_bf16 v[32:47], v[8:11], v[116:119], v[32:47]
s_waitcnt lgkmcnt(2)
ds_read_b128 v[24:27], v64 offset:9216
v_accvgpr_write_b32 a136, v48
v_accvgpr_write_b32 a137, v49
v_mfma_f32_32x32x16_bf16 v[32:47], v[12:15], v[120:123], v[32:47]
s_waitcnt lgkmcnt(2)
ds_read_b128 v[8:11], v64 offset:10240
v_accvgpr_write_b32 a138, v50
v_accvgpr_write_b32 a139, v51
v_mfma_f32_32x32x16_bf16 v[32:47], v[16:19], v[124:127], v[32:47]
s_waitcnt lgkmcnt(2)
ds_read_b128 v[12:15], v64 offset:11264
v_accvgpr_write_b32 a140, v52
v_accvgpr_write_b32 a141, v53
v_mfma_f32_32x32x16_bf16 v[32:47], v[20:23], v[128:131], v[32:47]
s_waitcnt lgkmcnt(2)
ds_read_b128 v[16:19], v64 offset:12288
v_accvgpr_write_b32 a142, v54
v_accvgpr_write_b32 a143, v55
v_mfma_f32_32x32x16_bf16 v[32:47], v[24:27], v[132:135], v[32:47]
s_waitcnt lgkmcnt(2)
ds_read_b128 v[20:23], v64 offset:13312
s_add_u32 m0, s45, 0
s_add_u32 s55, s46, 0
buffer_load_dwordx4 v0, s[4:7], s55 offen offset:0 sc1 lds
buffer_load_dwordx4 v0, s[4:7], s55 offen offset:1024 sc1 lds
v_mfma_f32_32x32x16_bf16 v[32:47], v[8:11], v[136:139], v[32:47]
s_waitcnt lgkmcnt(2)
ds_read_b128 v[24:27], v64 offset:14336
buffer_load_dwordx4 v0, s[4:7], s55 offen offset:2048 sc1 lds
buffer_load_dwordx4 v0, s[4:7], s55 offen offset:3072 sc1 lds
v_mfma_f32_32x32x16_bf16 v[32:47], v[12:15], v[140:143], v[32:47]
s_waitcnt lgkmcnt(2)
ds_read_b128 v[8:11], v64 offset:15360
s_add_u32 m0, s45, 4096
s_add_u32 s55, s46, 4096
buffer_load_dwordx4 v0, s[4:7], s55 offen offset:0 sc1 lds
buffer_load_dwordx4 v0, s[4:7], s55 offen offset:1024 sc1 lds
v_mfma_f32_32x32x16_bf16 v[32:47], v[16:19], v[144:147], v[32:47]
s_waitcnt lgkmcnt(2)
ds_read_b128 v[12:15], v64 offset:16384
buffer_load_dwordx4 v0, s[4:7], s55 offen offset:2048 sc1 lds
buffer_load_dwordx4 v0, s[4:7], s55 offen offset:3072 sc1 lds
v_mfma_f32_32x32x16_bf16 v[32:47], v[20:23], v[148:151], v[32:47]
s_waitcnt lgkmcnt(2)
ds_read_b128 v[16:19], v64 offset:17408
s_add_u32 m0, s45, 8192
s_add_u32 s55, s46, 8192
buffer_load_dwordx4 v0, s[4:7], s55 offen offset:0 sc1 lds
buffer_load_dwordx4 v0, s[4:7], s55 offen offset:1024 sc1 lds
v_mfma_f32_32x32x16_bf16 v[32:47], v[24:27], v[152:155], v[32:47]
s_waitcnt lgkmcnt(2)
ds_read_b128 v[20:23], v64 offset:18432
s_add_u32 s45, s45, 40960
s_cmp_ge_u32 s45, 122880
s_cselect_b32 s55, 122880, 0
s_sub_u32 s45, s45, s55
s_add_u32 s46, s46, 40960
v_mfma_f32_32x32x16_bf16 v[32:47], v[8:11], v[156:159], v[32:47]
s_waitcnt lgkmcnt(2)
ds_read_b128 v[24:27], v64 offset:19456
v_mfma_f32_32x32x16_bf16 v[32:47], v[12:15], v[160:163], v[32:47]
s_waitcnt lgkmcnt(2)
ds_read_b128 v[8:11], v64 offset:20480
v_mfma_f32_32x32x16_bf16 v[32:47], v[16:19], v[164:167], v[32:47]
s_waitcnt lgkmcnt(2)
ds_read_b128 v[12:15], v64 offset:21504
v_mfma_f32_32x32x16_bf16 v[32:47], v[20:23], v[168:171], v[32:47]
s_waitcnt lgkmcnt(2)
ds_read_b128 v[16:19], v64 offset:22528
v_mfma_f32_32x32x16_bf16 v[32:47], v[24:27], v[172:175], v[32:47]
s_waitcnt lgkmcnt(2)
ds_read_b128 v[20:23], v64 offset:23552
v_mfma_f32_32x32x16_bf16 v[32:47], v[8:11], v[176:179], v[32:47]
s_waitcnt lgkmcnt(2)
ds_read_b128 v[24:27], v64 offset:24576
v_mfma_f32_32x32x16_bf16 v[32:47], v[12:15], v[180:183], v[32:47]
s_waitcnt lgkmcnt(2)
ds_read_b128 v[8:11], v64 offset:25600
v_mfma_f32_32x32x16_bf16 v[32:47], v[16:19], v[184:187], v[32:47]
s_waitcnt lgkmcnt(2)
ds_read_b128 v[12:15], v64 offset:26624
v_mfma_f32_32x32x16_bf16 v[32:47], v[20:23], v[188:191], v[32:47]
s_waitcnt lgkmcnt(2)
ds_read_b128 v[16:19], v64 offset:27648
v_mfma_f32_32x32x16_bf16 v[32:47], v[24:27], v[192:195], v[32:47]
s_waitcnt lgkmcnt(2)
ds_read_b128 v[20:23], v64 offset:28672
v_mfma_f32_32x32x16_bf16 v[32:47], v[8:11], v[196:199], v[32:47]
s_waitcnt lgkmcnt(2)
ds_read_b128 v[24:27], v64 offset:29696
v_mfma_f32_32x32x16_bf16 v[32:47], v[12:15], v[200:203], v[32:47]
s_waitcnt lgkmcnt(2)
ds_read_b128 v[8:11], v64 offset:30720
v_mfma_f32_32x32x16_bf16 v[32:47], v[16:19], v[204:207], v[32:47]
s_waitcnt lgkmcnt(2)
ds_read_b128 v[12:15], v64 offset:31744
v_mfma_f32_32x32x16_bf16 v[32:47], v[20:23], v[208:211], v[32:47]
s_waitcnt lgkmcnt(2)
ds_read_b128 v[16:19], v64 offset:32768
v_mfma_f32_32x32x16_bf16 v[32:47], v[24:27], v[212:215], v[32:47]
s_waitcnt lgkmcnt(2)
ds_read_b128 v[20:23], v64 offset:33792
v_mfma_f32_32x32x16_bf16 v[32:47], v[8:11], v[216:219], v[32:47]
s_waitcnt lgkmcnt(2)
ds_read_b128 v[24:27], v64 offset:34816
v_mfma_f32_32x32x16_bf16 v[32:47], v[12:15], v[220:223], v[32:47]
s_waitcnt lgkmcnt(2)
ds_read_b128 v[8:11], v64 offset:35840
v_mfma_f32_32x32x16_bf16 v[32:47], v[16:19], v[224:227], v[32:47]
s_waitcnt lgkmcnt(2)
ds_read_b128 v[12:15], v64 offset:36864
v_mfma_f32_32x32x16_bf16 v[32:47], v[20:23], v[228:231], v[32:47]
s_waitcnt lgkmcnt(2)
ds_read_b128 v[16:19], v64 offset:37888
v_mfma_f32_32x32x16_bf16 v[32:47], v[24:27], v[232:235], v[32:47]
s_waitcnt lgkmcnt(2)
ds_read_b128 v[20:23], v64 offset:38912
v_mfma_f32_32x32x16_bf16 v[32:47], v[8:11], v[236:239], v[32:47]
s_waitcnt lgkmcnt(2)
ds_read_b128 v[24:27], v64 offset:39936
v_mfma_f32_32x32x16_bf16 v[32:47], v[12:15], v[240:243], v[32:47]
s_add_u32 s44, s44, 1
s_cmp_eq_u32 s44, 3
s_mov_b32 s56, 40960
s_cmov_b32 s56, -81920
s_cselect_b32 s44, 0, s44
v_add_u32 v64, s56, v64
s_waitcnt vmcnt(10) lgkmcnt(2)
s_barrier
ds_read_b128 v[8:11], v64 offset:0
v_mfma_f32_32x32x16_bf16 v[32:47], v[16:19], v[244:247], v[32:47]
s_waitcnt lgkmcnt(2)
ds_read_b128 v[12:15], v64 offset:1024
v_mfma_f32_32x32x16_bf16 v[32:47], v[20:23], v[248:251], v[32:47]
s_waitcnt lgkmcnt(2)
ds_read_b128 v[16:19], v64 offset:2048
v_mfma_f32_32x32x16_bf16 v[32:47], v[24:27], v[252:255], v[32:47]
s_waitcnt lgkmcnt(2)
ds_read_b128 v[20:23], v64 offset:3072
v_mfma_f32_32x32x16_bf16 v[48:63], v[8:11], v[96:99], 0
s_waitcnt lgkmcnt(2)
ds_read_b128 v[24:27], v64 offset:4096
v_mfma_f32_32x32x16_bf16 v[48:63], v[12:15], v[100:103], v[48:63]
s_waitcnt lgkmcnt(2)
ds_read_b128 v[8:11], v64 offset:5120
v_cvt_pk_bf16_f32 v32, v32, v33
v_cvt_pk_bf16_f32 v33, v34, v35
v_mfma_f32_32x32x16_bf16 v[48:63], v[16:19], v[104:107], v[48:63]
s_waitcnt lgkmcnt(2)
ds_read_b128 v[12:15], v64 offset:6144
v_cvt_pk_bf16_f32 v34, v36, v37
v_cvt_pk_bf16_f32 v35, v38, v39
v_mfma_f32_32x32x16_bf16 v[48:63], v[20:23], v[108:111], v[48:63]
s_waitcnt lgkmcnt(2)
ds_read_b128 v[16:19], v64 offset:7168
v_cvt_pk_bf16_f32 v36, v40, v41
v_cvt_pk_bf16_f32 v37, v42, v43
v_mfma_f32_32x32x16_bf16 v[48:63], v[24:27], v[112:115], v[48:63]
s_waitcnt lgkmcnt(2)
ds_read_b128 v[20:23], v64 offset:8192
v_cvt_pk_bf16_f32 v38, v44, v45
v_cvt_pk_bf16_f32 v39, v46, v47
v_mfma_f32_32x32x16_bf16 v[48:63], v[8:11], v[116:119], v[48:63]
s_waitcnt lgkmcnt(2)
ds_read_b128 v[24:27], v64 offset:9216
v_accvgpr_write_b32 a144, v32
v_accvgpr_write_b32 a145, v33
v_mfma_f32_32x32x16_bf16 v[48:63], v[12:15], v[120:123], v[48:63]
s_waitcnt lgkmcnt(2)
ds_read_b128 v[8:11], v64 offset:10240
v_accvgpr_write_b32 a146, v34
v_accvgpr_write_b32 a147, v35
v_mfma_f32_32x32x16_bf16 v[48:63], v[16:19], v[124:127], v[48:63]
s_waitcnt lgkmcnt(2)
ds_read_b128 v[12:15], v64 offset:11264
v_accvgpr_write_b32 a148, v36
v_accvgpr_write_b32 a149, v37
v_mfma_f32_32x32x16_bf16 v[48:63], v[20:23], v[128:131], v[48:63]
s_waitcnt lgkmcnt(2)
ds_read_b128 v[16:19], v64 offset:12288
v_accvgpr_write_b32 a150, v38
v_accvgpr_write_b32 a151, v39
v_mfma_f32_32x32x16_bf16 v[48:63], v[24:27], v[132:135], v[48:63]
s_waitcnt lgkmcnt(2)
ds_read_b128 v[20:23], v64 offset:13312
s_add_u32 m0, s45, 0
s_add_u32 s55, s46, 0
buffer_load_dwordx4 v0, s[4:7], s55 offen offset:0 sc1 lds
buffer_load_dwordx4 v0, s[4:7], s55 offen offset:1024 sc1 lds
v_mfma_f32_32x32x16_bf16 v[48:63], v[8:11], v[136:139], v[48:63]
s_waitcnt lgkmcnt(2)
ds_read_b128 v[24:27], v64 offset:14336
buffer_load_dwordx4 v0, s[4:7], s55 offen offset:2048 sc1 lds
buffer_load_dwordx4 v0, s[4:7], s55 offen offset:3072 sc1 lds
v_mfma_f32_32x32x16_bf16 v[48:63], v[12:15], v[140:143], v[48:63]
s_waitcnt lgkmcnt(2)
ds_read_b128 v[8:11], v64 offset:15360
s_add_u32 m0, s45, 4096
s_add_u32 s55, s46, 4096
buffer_load_dwordx4 v0, s[4:7], s55 offen offset:0 sc1 lds
buffer_load_dwordx4 v0, s[4:7], s55 offen offset:1024 sc1 lds
v_mfma_f32_32x32x16_bf16 v[48:63], v[16:19], v[144:147], v[48:63]
s_waitcnt lgkmcnt(2)
ds_read_b128 v[12:15], v64 offset:16384
buffer_load_dwordx4 v0, s[4:7], s55 offen offset:2048 sc1 lds
buffer_load_dwordx4 v0, s[4:7], s55 offen offset:3072 sc1 lds
v_mfma_f32_32x32x16_bf16 v[48:63], v[20:23], v[148:151], v[48:63]
s_waitcnt lgkmcnt(2)
ds_read_b128 v[16:19], v64 offset:17408
s_add_u32 m0, s45, 8192
s_add_u32 s55, s46, 8192
buffer_load_dwordx4 v0, s[4:7], s55 offen offset:0 sc1 lds
buffer_load_dwordx4 v0, s[4:7], s55 offen offset:1024 sc1 lds
v_mfma_f32_32x32x16_bf16 v[48:63], v[24:27], v[152:155], v[48:63]
s_waitcnt lgkmcnt(2)
ds_read_b128 v[20:23], v64 offset:18432
s_add_u32 s45, s45, 40960
s_cmp_ge_u32 s45, 122880
s_cselect_b32 s55, 122880, 0
s_sub_u32 s45, s45, s55
s_add_u32 s46, s46, 40960
v_mfma_f32_32x32x16_bf16 v[48:63], v[8:11], v[156:159], v[48:63]
s_waitcnt lgkmcnt(2)
ds_read_b128 v[24:27], v64 offset:19456
v_mfma_f32_32x32x16_bf16 v[48:63], v[12:15], v[160:163], v[48:63]
s_waitcnt lgkmcnt(2)
ds_read_b128 v[8:11], v64 offset:20480
v_mfma_f32_32x32x16_bf16 v[48:63], v[16:19], v[164:167], v[48:63]
s_waitcnt lgkmcnt(2)
ds_read_b128 v[12:15], v64 offset:21504
v_mfma_f32_32x32x16_bf16 v[48:63], v[20:23], v[168:171], v[48:63]
s_waitcnt lgkmcnt(2)
ds_read_b128 v[16:19], v64 offset:22528
v_mfma_f32_32x32x16_bf16 v[48:63], v[24:27], v[172:175], v[48:63]
s_waitcnt lgkmcnt(2)
ds_read_b128 v[20:23], v64 offset:23552
v_mfma_f32_32x32x16_bf16 v[48:63], v[8:11], v[176:179], v[48:63]
s_waitcnt lgkmcnt(2)
ds_read_b128 v[24:27], v64 offset:24576
v_mfma_f32_32x32x16_bf16 v[48:63], v[12:15], v[180:183], v[48:63]
s_waitcnt lgkmcnt(2)
ds_read_b128 v[8:11], v64 offset:25600
v_mfma_f32_32x32x16_bf16 v[48:63], v[16:19], v[184:187], v[48:63]
s_waitcnt lgkmcnt(2)
ds_read_b128 v[12:15], v64 offset:26624
v_mfma_f32_32x32x16_bf16 v[48:63], v[20:23], v[188:191], v[48:63]
s_waitcnt lgkmcnt(2)
ds_read_b128 v[16:19], v64 offset:27648
v_mfma_f32_32x32x16_bf16 v[48:63], v[24:27], v[192:195], v[48:63]
s_waitcnt lgkmcnt(2)
ds_read_b128 v[20:23], v64 offset:28672
v_mfma_f32_32x32x16_bf16 v[48:63], v[8:11], v[196:199], v[48:63]
s_waitcnt lgkmcnt(2)
ds_read_b128 v[24:27], v64 offset:29696
v_mfma_f32_32x32x16_bf16 v[48:63], v[12:15], v[200:203], v[48:63]
s_waitcnt lgkmcnt(2)
ds_read_b128 v[8:11], v64 offset:30720
v_mfma_f32_32x32x16_bf16 v[48:63], v[16:19], v[204:207], v[48:63]
s_waitcnt lgkmcnt(2)
ds_read_b128 v[12:15], v64 offset:31744
v_mfma_f32_32x32x16_bf16 v[48:63], v[20:23], v[208:211], v[48:63]
s_waitcnt lgkmcnt(2)
ds_read_b128 v[16:19], v64 offset:32768
v_mfma_f32_32x32x16_bf16 v[48:63], v[24:27], v[212:215], v[48:63]
s_waitcnt lgkmcnt(2)
ds_read_b128 v[20:23], v64 offset:33792
v_mfma_f32_32x32x16_bf16 v[48:63], v[8:11], v[216:219], v[48:63]
s_waitcnt lgkmcnt(2)
ds_read_b128 v[24:27], v64 offset:34816
v_mfma_f32_32x32x16_bf16 v[48:63], v[12:15], v[220:223], v[48:63]
s_waitcnt lgkmcnt(2)
ds_read_b128 v[8:11], v64 offset:35840
v_mfma_f32_32x32x16_bf16 v[48:63], v[16:19], v[224:227], v[48:63]
s_waitcnt lgkmcnt(2)
ds_read_b128 v[12:15], v64 offset:36864
v_mfma_f32_32x32x16_bf16 v[48:63], v[20:23], v[228:231], v[48:63]
s_waitcnt lgkmcnt(2)
ds_read_b128 v[16:19], v64 offset:37888
v_mfma_f32_32x32x16_bf16 v[48:63], v[24:27], v[232:235], v[48:63]
s_waitcnt lgkmcnt(2)
ds_read_b128 v[20:23], v64 offset:38912
v_mfma_f32_32x32x16_bf16 v[48:63], v[8:11], v[236:239], v[48:63]
s_waitcnt lgkmcnt(2)
ds_read_b128 v[24:27], v64 offset:39936
v_mfma_f32_32x32x16_bf16 v[48:63], v[12:15], v[240:243], v[48:63]
s_add_u32 s44, s44, 1
s_cmp_eq_u32 s44, 3
s_mov_b32 s56, 40960
s_cmov_b32 s56, -81920
s_cselect_b32 s44, 0, s44
v_add_u32 v64, s56, v64
s_waitcnt vmcnt(10) lgkmcnt(2)
s_barrier
ds_read_b128 v[8:11], v64 offset:0
v_mfma_f32_32x32x16_bf16 v[48:63], v[16:19], v[244:247], v[48:63]
s_waitcnt lgkmcnt(2)
ds_read_b128 v[12:15], v64 offset:1024
v_mfma_f32_32x32x16_bf16 v[48:63], v[20:23], v[248:251], v[48:63]
s_waitcnt lgkmcnt(2)
ds_read_b128 v[16:19], v64 offset:2048
v_mfma_f32_32x32x16_bf16 v[48:63], v[24:27], v[252:255], v[48:63]
s_waitcnt lgkmcnt(2)
ds_read_b128 v[20:23], v64 offset:3072
s_nop 9
v_cvt_pk_bf16_f32 v48, v48, v49
v_cvt_pk_bf16_f32 v49, v50, v51
v_cvt_pk_bf16_f32 v50, v52, v53
v_cvt_pk_bf16_f32 v51, v54, v55
v_cvt_pk_bf16_f32 v52, v56, v57
v_cvt_pk_bf16_f32 v53, v58, v59
v_cvt_pk_bf16_f32 v54, v60, v61
v_cvt_pk_bf16_f32 v55, v62, v63
v_accvgpr_write_b32 a152, v48
v_accvgpr_write_b32 a153, v49
v_accvgpr_write_b32 a154, v50
v_accvgpr_write_b32 a155, v51
v_accvgpr_write_b32 a156, v52
v_accvgpr_write_b32 a157, v53
v_accvgpr_write_b32 a158, v54
v_accvgpr_write_b32 a159, v55
s_cmp_eq_u32 s3, 0
s_cselect_b32 s52, 0, -1
v_or_b32 v3, s52, v30
s_waitcnt vmcnt(0) lgkmcnt(0)
s_barrier
k_nxt_44:
s_cmp_ge_u32 s30, 80
s_cbranch_scc1 k_fend_45
v_bfe_u32 v8, v0, 4, 5
v_lshrrev_b32 v9, 9, v0
s_lshl_b32 s52, s30, 2
s_add_u32 s52, s52, s3
s_cmp_eq_u32 s52, 0
s_cselect_b32 s47, 0xffff, -1
s_cselect_b32 s53, 0x30000, 0
s_cmov_b32 s52, 320
v_add_u32 v26, s53, v0
s_cmp_lg_u32 s51, 0
s_cbranch_scc1 k_fnog_46
s_load_dwordx2 s[36:37], s[0:1], 64
s_mov_b32 s38, 1314816
s_mov_b32 s39, 0x20000
s_load_dwordx2 s[40:41], s[0:1], 72
s_mov_b32 s42, 1314816
s_mov_b32 s43, 0x20000
v_lshl_add_u32 v20, v9, 8, v8
v_mul_u32_u24 v20, 642, v20
s_lshl_b32 s52, s52, 1
v_add_u32 v22, s52, v20
s_waitcnt lgkmcnt(0)
s_mov_b32 s53, 0
buffer_load_ushort v192, v22, s[36:39], s53 offen
buffer_load_ushort v208, v22, s[40:43], s53 offen
s_mov_b32 s53, 41088
buffer_load_ushort v193, v22, s[36:39], s53 offen
buffer_load_ushort v209, v22, s[40:43], s53 offen
s_mov_b32 s53, 82176
buffer_load_ushort v194, v22, s[36:39], s53 offen
buffer_load_ushort v210, v22, s[40:43], s53 offen
s_mov_b32 s53, 123264
buffer_load_ushort v195, v22, s[36:39], s53 offen
buffer_load_ushort v211, v22, s[40:43], s53 offen
s_mov_b32 s53, 328704
buffer_load_ushort v196, v22, s[36:39], s53 offen
buffer_load_ushort v212, v22, s[40:43], s53 offen
s_mov_b32 s53, 369792
buffer_load_ushort v197, v22, s[36:39], s53 offen
buffer_load_ushort v213, v22, s[40:43], s53 offen
s_mov_b32 s53, 410880
buffer_load_ushort v198, v22, s[36:39], s53 offen
buffer_load_ushort v214, v22, s[40:43], s53 offen
s_mov_b32 s53, 451968
buffer_load_ushort v199, v22, s[36:39], s53 offen
buffer_load_ushort v215, v22, s[40:43], s53 offen
s_mov_b32 s53, 657408
buffer_load_ushort v200, v22, s[36:39], s53 offen
buffer_load_ushort v216, v22, s[40:43], s53 offen
s_mov_b32 s53, 698496
buffer_load_ushort v201, v22, s[36:39], s53 offen
buffer_load_ushort v217, v22, s[40:43], s53 offen
s_mov_b32 s53, 739584
buffer_load_ushort v202, v22, s[36:39], s53 offen
buffer_load_ushort v218, v22, s[40:43], s53 offen
s_mov_b32 s53, 780672
buffer_load_ushort v203, v22, s[36:39], s53 offen
buffer_load_ushort v219, v22, s[40:43], s53 offen
s_mov_b32 s53, 986112
buffer_load_ushort v204, v22, s[36:39], s53 offen
buffer_load_ushort v220, v22, s[40:43], s53 offen
s_mov_b32 s53, 1027200
buffer_load_ushort v205, v22, s[36:39], s53 offen
buffer_load_ushort v221, v22, s[40:43], s53 offen
s_mov_b32 s53, 1068288
buffer_load_ushort v206, v22, s[36:39], s53 offen
buffer_load_ushort v222, v22, s[40:43], s53 offen
s_mov_b32 s53, 1109376
buffer_load_ushort v207, v22, s[36:39], s53 offen
buffer_load_ushort v223, v22, s[40:43], s53 offen
s_mov_b32 s53, 20544
buffer_load_ushort v224, v22, s[36:39], s53 offen
buffer_load_ushort v240, v22, s[40:43], s53 offen
s_mov_b32 s53, 61632
buffer_load_ushort v225, v22, s[36:39], s53 offen
buffer_load_ushort v241, v22, s[40:43], s53 offen
s_mov_b32 s53, 102720
buffer_load_ushort v226, v22, s[36:39], s53 offen
buffer_load_ushort v242, v22, s[40:43], s53 offen
s_mov_b32 s53, 143808
buffer_load_ushort v227, v22, s[36:39], s53 offen
buffer_load_ushort v243, v22, s[40:43], s53 offen
s_mov_b32 s53, 349248
buffer_load_ushort v228, v22, s[36:39], s53 offen
buffer_load_ushort v244, v22, s[40:43], s53 offen
s_mov_b32 s53, 390336
buffer_load_ushort v229, v22, s[36:39], s53 offen
buffer_load_ushort v245, v22, s[40:43], s53 offen
s_mov_b32 s53, 431424
buffer_load_ushort v230, v22, s[36:39], s53 offen
buffer_load_ushort v246, v22, s[40:43], s53 offen
s_mov_b32 s53, 472512
buffer_load_ushort v231, v22, s[36:39], s53 offen
buffer_load_ushort v247, v22, s[40:43], s53 offen
s_mov_b32 s53, 677952
buffer_load_ushort v232, v22, s[36:39], s53 offen
buffer_load_ushort v248, v22, s[40:43], s53 offen
s_mov_b32 s53, 719040
buffer_load_ushort v233, v22, s[36:39], s53 offen
buffer_load_ushort v249, v22, s[40:43], s53 offen
s_mov_b32 s53, 760128
buffer_load_ushort v234, v22, s[36:39], s53 offen
buffer_load_ushort v250, v22, s[40:43], s53 offen
s_mov_b32 s53, 801216
buffer_load_ushort v235, v22, s[36:39], s53 offen
buffer_load_ushort v251, v22, s[40:43], s53 offen
s_mov_b32 s53, 1006656
buffer_load_ushort v236, v22, s[36:39], s53 offen
buffer_load_ushort v252, v22, s[40:43], s53 offen
s_mov_b32 s53, 1047744
buffer_load_ushort v237, v22, s[36:39], s53 offen
buffer_load_ushort v253, v22, s[40:43], s53 offen
s_mov_b32 s53, 1088832
buffer_load_ushort v238, v22, s[36:39], s53 offen
buffer_load_ushort v254, v22, s[40:43], s53 offen
s_mov_b32 s53, 1129920
buffer_load_ushort v239, v22, s[36:39], s53 offen
buffer_load_ushort v255, v22, s[40:43], s53 offen
v_lshl_add_u32 v10, v9, 2, 0
v_mul_u32_u24 v10, v10, v8
v_and_b32 v20, 31, v10
v_cvt_f32_u32 v20, v20
v_mul_f32 v20, 0x3d000000, v20
v_sin_f32 v21, v20
v_cos_f32 v20, v20
v_add_u32 v10, v8, v10
v_cvt_pk_bf16_f32 v32, v20, v21
v_cvt_pk_bf16_f32 v36, -v21, v20
v_and_b32 v20, 31, v10
v_cvt_f32_u32 v20, v20
v_mul_f32 v20, 0x3d000000, v20
v_sin_f32 v21, v20
v_cos_f32 v20, v20
v_add_u32 v10, v8, v10
v_cvt_pk_bf16_f32 v33, v20, v21
v_cvt_pk_bf16_f32 v37, -v21, v20
v_and_b32 v20, 31, v10
v_cvt_f32_u32 v20, v20
v_mul_f32 v20, 0x3d000000, v20
v_sin_f32 v21, v20
v_cos_f32 v20, v20
v_add_u32 v10, v8, v10
v_cvt_pk_bf16_f32 v34, v20, v21
v_cvt_pk_bf16_f32 v38, -v21, v20
v_and_b32 v20, 31, v10
v_cvt_f32_u32 v20, v20
v_mul_f32 v20, 0x3d000000, v20
v_sin_f32 v21, v20
v_cos_f32 v20, v20
v_add_u32 v10, v8, v10
v_cvt_pk_bf16_f32 v35, v20, v21
v_cvt_pk_bf16_f32 v39, -v21, v20
v_accvgpr_write_b32 a160, v32
v_accvgpr_write_b32 a161, v33
v_accvgpr_write_b32 a162, v34
v_accvgpr_write_b32 a163, v35
v_accvgpr_write_b32 a164, v36
v_accvgpr_write_b32 a165, v37
v_accvgpr_write_b32 a166, v38
v_accvgpr_write_b32 a167, v39
v_lshl_add_u32 v10, v9, 2, 8
v_mul_u32_u24 v10, v10, v8
v_and_b32 v20, 31, v10
v_cvt_f32_u32 v20, v20
v_mul_f32 v20, 0x3d000000, v20
v_sin_f32 v21, v20
v_cos_f32 v20, v20
v_add_u32 v10, v8, v10
v_cvt_pk_bf16_f32 v32, v20, v21
v_cvt_pk_bf16_f32 v36, -v21, v20
v_and_b32 v20, 31, v10
v_cvt_f32_u32 v20, v20
v_mul_f32 v20, 0x3d000000, v20
v_sin_f32 v21, v20
v_cos_f32 v20, v20
v_add_u32 v10, v8, v10
v_cvt_pk_bf16_f32 v33, v20, v21
v_cvt_pk_bf16_f32 v37, -v21, v20
v_and_b32 v20, 31, v10
v_cvt_f32_u32 v20, v20
v_mul_f32 v20, 0x3d000000, v20
v_sin_f32 v21, v20
v_cos_f32 v20, v20
v_add_u32 v10, v8, v10
v_cvt_pk_bf16_f32 v34, v20, v21
v_cvt_pk_bf16_f32 v38, -v21, v20
v_and_b32 v20, 31, v10
v_cvt_f32_u32 v20, v20
v_mul_f32 v20, 0x3d000000, v20
v_sin_f32 v21, v20
v_cos_f32 v20, v20
v_add_u32 v10, v8, v10
v_cvt_pk_bf16_f32 v35, v20, v21
v_cvt_pk_bf16_f32 v39, -v21, v20
v_accvgpr_write_b32 a168, v32
v_accvgpr_write_b32 a169, v33
v_accvgpr_write_b32 a170, v34
v_accvgpr_write_b32 a171, v35
v_accvgpr_write_b32 a172, v36
v_accvgpr_write_b32 a173, v37
v_accvgpr_write_b32 a174, v38
v_accvgpr_write_b32 a175, v39
v_lshl_add_u32 v10, v9, 2, 16
v_mul_u32_u24 v10, v10, v8
v_and_b32 v20, 31, v10
v_cvt_f32_u32 v20, v20
v_mul_f32 v20, 0x3d000000, v20
v_sin_f32 v21, v20
v_cos_f32 v20, v20
v_add_u32 v10, v8, v10
v_cvt_pk_bf16_f32 v32, v20, v21
v_cvt_pk_bf16_f32 v36, -v21, v20
v_and_b32 v20, 31, v10
v_cvt_f32_u32 v20, v20
v_mul_f32 v20, 0x3d000000, v20
v_sin_f32 v21, v20
v_cos_f32 v20, v20
v_add_u32 v10, v8, v10
v_cvt_pk_bf16_f32 v33, v20, v21
v_cvt_pk_bf16_f32 v37, -v21, v20
v_and_b32 v20, 31, v10
v_cvt_f32_u32 v20, v20
v_mul_f32 v20, 0x3d000000, v20
v_sin_f32 v21, v20
v_cos_f32 v20, v20
v_add_u32 v10, v8, v10
v_cvt_pk_bf16_f32 v34, v20, v21
v_cvt_pk_bf16_f32 v38, -v21, v20
v_and_b32 v20, 31, v10
v_cvt_f32_u32 v20, v20
v_mul_f32 v20, 0x3d000000, v20
v_sin_f32 v21, v20
v_cos_f32 v20, v20
v_add_u32 v10, v8, v10
v_cvt_pk_bf16_f32 v35, v20, v21
v_cvt_pk_bf16_f32 v39, -v21, v20
v_accvgpr_write_b32 a176, v32
v_accvgpr_write_b32 a177, v33
v_accvgpr_write_b32 a178, v34
v_accvgpr_write_b32 a179, v35
v_accvgpr_write_b32 a180, v36
v_accvgpr_write_b32 a181, v37
v_accvgpr_write_b32 a182, v38
v_accvgpr_write_b32 a183, v39
v_lshl_add_u32 v10, v9, 2, 24
v_mul_u32_u24 v10, v10, v8
v_and_b32 v20, 31, v10
v_cvt_f32_u32 v20, v20
v_mul_f32 v20, 0x3d000000, v20
v_sin_f32 v21, v20
v_cos_f32 v20, v20
v_add_u32 v10, v8, v10
v_cvt_pk_bf16_f32 v32, v20, v21
v_cvt_pk_bf16_f32 v36, -v21, v20
v_and_b32 v20, 31, v10
v_cvt_f32_u32 v20, v20
v_mul_f32 v20, 0x3d000000, v20
v_sin_f32 v21, v20
v_cos_f32 v20, v20
v_add_u32 v10, v8, v10
v_cvt_pk_bf16_f32 v33, v20, v21
v_cvt_pk_bf16_f32 v37, -v21, v20
v_and_b32 v20, 31, v10
v_cvt_f32_u32 v20, v20
v_mul_f32 v20, 0x3d000000, v20
v_sin_f32 v21, v20
v_cos_f32 v20, v20
v_add_u32 v10, v8, v10
v_cvt_pk_bf16_f32 v34, v20, v21
v_cvt_pk_bf16_f32 v38, -v21, v20
v_and_b32 v20, 31, v10
v_cvt_f32_u32 v20, v20
v_mul_f32 v20, 0x3d000000, v20
v_sin_f32 v21, v20
v_cos_f32 v20, v20
v_add_u32 v10, v8, v10
v_cvt_pk_bf16_f32 v35, v20, v21
v_cvt_pk_bf16_f32 v39, -v21, v20
v_accvgpr_write_b32 a184, v32
v_accvgpr_write_b32 a185, v33
v_accvgpr_write_b32 a186, v34
v_accvgpr_write_b32 a187, v35
v_accvgpr_write_b32 a188, v36
v_accvgpr_write_b32 a189, v37
v_accvgpr_write_b32 a190, v38
v_accvgpr_write_b32 a191, v39
s_waitcnt vmcnt(63)
v_lshlrev_b32 v192, 16, v192
v_mul_f32 v192, 0x3a000000, v192
s_waitcnt vmcnt(61)
v_lshlrev_b32 v193, 16, v193
v_mul_f32 v193, 0x3a000000, v193
s_waitcnt vmcnt(59)
v_lshlrev_b32 v194, 16, v194
v_mul_f32 v194, 0x3a000000, v194
s_waitcnt vmcnt(57)
v_lshlrev_b32 v195, 16, v195
v_mul_f32 v195, 0x3a000000, v195
s_waitcnt vmcnt(55)
v_lshlrev_b32 v196, 16, v196
v_mul_f32 v196, 0x3a000000, v196
s_waitcnt vmcnt(53)
v_lshlrev_b32 v197, 16, v197
v_mul_f32 v197, 0x3a000000, v197
s_waitcnt vmcnt(51)
v_lshlrev_b32 v198, 16, v198
v_mul_f32 v198, 0x3a000000, v198
s_waitcnt vmcnt(49)
v_lshlrev_b32 v199, 16, v199
v_mul_f32 v199, 0x3a000000, v199
s_waitcnt vmcnt(47)
v_lshlrev_b32 v200, 16, v200
v_mul_f32 v200, 0x3a000000, v200
s_waitcnt vmcnt(45)
v_lshlrev_b32 v201, 16, v201
v_mul_f32 v201, 0x3a000000, v201
s_waitcnt vmcnt(43)
v_lshlrev_b32 v202, 16, v202
v_mul_f32 v202, 0x3a000000, v202
s_waitcnt vmcnt(41)
v_lshlrev_b32 v203, 16, v203
v_mul_f32 v203, 0x3a000000, v203
s_waitcnt vmcnt(39)
v_lshlrev_b32 v204, 16, v204
v_mul_f32 v204, 0x3a000000, v204
s_waitcnt vmcnt(37)
v_lshlrev_b32 v205, 16, v205
v_mul_f32 v205, 0x3a000000, v205
s_waitcnt vmcnt(35)
v_lshlrev_b32 v206, 16, v206
v_mul_f32 v206, 0x3a000000, v206
s_waitcnt vmcnt(33)
v_lshlrev_b32 v207, 16, v207
v_mul_f32 v207, 0x3a000000, v207
v_lshlrev_b32 v208, 16, v208
v_mul_f32 v208, 0x3a000000, v208
v_lshlrev_b32 v209, 16, v209
v_mul_f32 v209, 0x3a000000, v209
v_lshlrev_b32 v210, 16, v210
v_mul_f32 v210, 0x3a000000, v210
v_lshlrev_b32 v211, 16, v211
v_mul_f32 v211, 0x3a000000, v211
v_lshlrev_b32 v212, 16, v212
v_mul_f32 v212, 0x3a000000, v212
v_lshlrev_b32 v213, 16, v213
v_mul_f32 v213, 0x3a000000, v213
v_lshlrev_b32 v214, 16, v214
v_mul_f32 v214, 0x3a000000, v214
v_lshlrev_b32 v215, 16, v215
v_mul_f32 v215, 0x3a000000, v215
v_lshlrev_b32 v216, 16, v216
v_mul_f32 v216, 0x3a000000, v216
v_lshlrev_b32 v217, 16, v217
v_mul_f32 v217, 0x3a000000, v217
v_lshlrev_b32 v218, 16, v218
v_mul_f32 v218, 0x3a000000, v218
v_lshlrev_b32 v219, 16, v219
v_mul_f32 v219, 0x3a000000, v219
v_lshlrev_b32 v220, 16, v220
v_mul_f32 v220, 0x3a000000, v220
v_lshlrev_b32 v221, 16, v221
v_mul_f32 v221, 0x3a000000, v221
v_lshlrev_b32 v222, 16, v222
v_mul_f32 v222, 0x3a000000, v222
s_waitcnt vmcnt(32)
v_lshlrev_b32 v223, 16, v223
v_mul_f32 v223, 0x3a000000, v223
s_waitcnt vmcnt(31)
v_lshlrev_b32 v224, 16, v224
v_mul_f32 v224, 0x3a000000, v224
s_waitcnt vmcnt(29)
v_lshlrev_b32 v225, 16, v225
v_mul_f32 v225, 0x3a000000, v225
s_waitcnt vmcnt(27)
v_lshlrev_b32 v226, 16, v226
v_mul_f32 v226, 0x3a000000, v226
s_waitcnt vmcnt(25)
v_lshlrev_b32 v227, 16, v227
v_mul_f32 v227, 0x3a000000, v227
s_waitcnt vmcnt(23)
v_lshlrev_b32 v228, 16, v228
v_mul_f32 v228, 0x3a000000, v228
s_waitcnt vmcnt(21)
v_lshlrev_b32 v229, 16, v229
v_mul_f32 v229, 0x3a000000, v229
s_waitcnt vmcnt(19)
v_lshlrev_b32 v230, 16, v230
v_mul_f32 v230, 0x3a000000, v230
s_waitcnt vmcnt(17)
v_lshlrev_b32 v231, 16, v231
v_mul_f32 v231, 0x3a000000, v231
s_waitcnt vmcnt(15)
v_lshlrev_b32 v232, 16, v232
v_mul_f32 v232, 0x3a000000, v232
s_waitcnt vmcnt(13)
v_lshlrev_b32 v233, 16, v233
v_mul_f32 v233, 0x3a000000, v233
s_waitcnt vmcnt(11)
v_lshlrev_b32 v234, 16, v234
v_mul_f32 v234, 0x3a000000, v234
s_waitcnt vmcnt(9)
v_lshlrev_b32 v235, 16, v235
v_mul_f32 v235, 0x3a000000, v235
s_waitcnt vmcnt(7)
v_lshlrev_b32 v236, 16, v236
v_mul_f32 v236, 0x3a000000, v236
s_waitcnt vmcnt(5)
v_lshlrev_b32 v237, 16, v237
v_mul_f32 v237, 0x3a000000, v237
s_waitcnt vmcnt(3)
v_lshlrev_b32 v238, 16, v238
v_mul_f32 v238, 0x3a000000, v238
s_waitcnt vmcnt(1)
v_lshlrev_b32 v239, 16, v239
v_mul_f32 v239, 0x3a000000, v239
v_lshlrev_b32 v240, 16, v240
v_mul_f32 v240, 0x3a000000, v240
v_lshlrev_b32 v241, 16, v241
v_mul_f32 v241, 0x3a000000, v241
v_lshlrev_b32 v242, 16, v242
v_mul_f32 v242, 0x3a000000, v242
v_lshlrev_b32 v243, 16, v243
v_mul_f32 v243, 0x3a000000, v243
v_lshlrev_b32 v244, 16, v244
v_mul_f32 v244, 0x3a000000, v244
v_lshlrev_b32 v245, 16, v245
v_mul_f32 v245, 0x3a000000, v245
v_lshlrev_b32 v246, 16, v246
v_mul_f32 v246, 0x3a000000, v246
v_lshlrev_b32 v247, 16, v247
v_mul_f32 v247, 0x3a000000, v247
v_lshlrev_b32 v248, 16, v248
v_mul_f32 v248, 0x3a000000, v248
v_lshlrev_b32 v249, 16, v249
v_mul_f32 v249, 0x3a000000, v249
v_lshlrev_b32 v250, 16, v250
v_mul_f32 v250, 0x3a000000, v250
v_lshlrev_b32 v251, 16, v251
v_mul_f32 v251, 0x3a000000, v251
v_lshlrev_b32 v252, 16, v252
v_mul_f32 v252, 0x3a000000, v252
v_lshlrev_b32 v253, 16, v253
v_mul_f32 v253, 0x3a000000, v253
v_lshlrev_b32 v254, 16, v254
v_mul_f32 v254, 0x3a000000, v254
s_waitcnt vmcnt(0)
v_lshlrev_b32 v255, 16, v255
v_mul_f32 v255, 0x3a000000, v255
k_fnog_46:
s_lshl_b32 s52, s3, 13
v_add_u32 v12, s52, v0
s_lshl_b32 s52, s3, 4
v_lshl_add_u32 v10, v9, 2, s52
v_add_u32 v10, 0, v10
v_add_u32 v11, 0, v8
v_mul_u32_u24 v10, v10, v11
v_and_b32 v20, 63, v10
v_cvt_f32_u32 v20, v20
v_mul_f32 v20, 0x3c800000, v20
v_sin_f32 v21, v20
v_cos_f32 v20, v20
v_add_u32 v10, v11, v10
v_cvt_pk_bf16_f32 v32, v20, v21
v_cvt_pk_bf16_f32 v36, -v21, v20
v_and_b32 v20, 63, v10
v_cvt_f32_u32 v20, v20
v_mul_f32 v20, 0x3c800000, v20
v_sin_f32 v21, v20
v_cos_f32 v20, v20
v_add_u32 v10, v11, v10
v_cvt_pk_bf16_f32 v33, v20, v21
v_cvt_pk_bf16_f32 v37, -v21, v20
v_and_b32 v20, 63, v10
v_cvt_f32_u32 v20, v20
v_mul_f32 v20, 0x3c800000, v20
v_sin_f32 v21, v20
v_cos_f32 v20, v20
v_add_u32 v10, v11, v10
v_cvt_pk_bf16_f32 v34, v20, v21
v_cvt_pk_bf16_f32 v38, -v21, v20
v_and_b32 v20, 63, v10
v_cvt_f32_u32 v20, v20
v_mul_f32 v20, 0x3c800000, v20
v_sin_f32 v21, v20
v_cos_f32 v20, v20
v_add_u32 v10, v11, v10
v_cvt_pk_bf16_f32 v35, v20, v21
v_cvt_pk_bf16_f32 v39, -v21, v20
ds_write_b128 v12, v[32:35] offset:0
ds_write_b128 v12, v[36:39] offset:1024
v_lshl_add_u32 v10, v9, 2, s52
v_add_u32 v10, 0, v10
v_add_u32 v11, 32, v8
v_mul_u32_u24 v10, v10, v11
v_and_b32 v20, 63, v10
v_cvt_f32_u32 v20, v20
v_mul_f32 v20, 0x3c800000, v20
v_sin_f32 v21, v20
v_cos_f32 v20, v20
v_add_u32 v10, v11, v10
v_cvt_pk_bf16_f32 v40, v20, v21
v_cvt_pk_bf16_f32 v44, -v21, v20
v_and_b32 v20, 63, v10
v_cvt_f32_u32 v20, v20
v_mul_f32 v20, 0x3c800000, v20
v_sin_f32 v21, v20
v_cos_f32 v20, v20
v_add_u32 v10, v11, v10
v_cvt_pk_bf16_f32 v41, v20, v21
v_cvt_pk_bf16_f32 v45, -v21, v20
v_and_b32 v20, 63, v10
v_cvt_f32_u32 v20, v20
v_mul_f32 v20, 0x3c800000, v20
v_sin_f32 v21, v20
v_cos_f32 v20, v20
v_add_u32 v10, v11, v10
v_cvt_pk_bf16_f32 v42, v20, v21
v_cvt_pk_bf16_f32 v46, -v21, v20
v_and_b32 v20, 63, v10
v_cvt_f32_u32 v20, v20
v_mul_f32 v20, 0x3c800000, v20
v_sin_f32 v21, v20
v_cos_f32 v20, v20
v_add_u32 v10, v11, v10
v_cvt_pk_bf16_f32 v43, v20, v21
v_cvt_pk_bf16_f32 v47, -v21, v20
ds_write_b128 v12, v[40:43] offset:2048
ds_write_b128 v12, v[44:47] offset:3072
v_lshl_add_u32 v10, v9, 2, s52
v_add_u32 v10, 8, v10
v_add_u32 v11, 0, v8
v_mul_u32_u24 v10, v10, v11
v_and_b32 v20, 63, v10
v_cvt_f32_u32 v20, v20
v_mul_f32 v20, 0x3c800000, v20
v_sin_f32 v21, v20
v_cos_f32 v20, v20
v_add_u32 v10, v11, v10
v_cvt_pk_bf16_f32 v48, v20, v21
v_cvt_pk_bf16_f32 v52, -v21, v20
v_and_b32 v20, 63, v10
v_cvt_f32_u32 v20, v20
v_mul_f32 v20, 0x3c800000, v20
v_sin_f32 v21, v20
v_cos_f32 v20, v20
v_add_u32 v10, v11, v10
v_cvt_pk_bf16_f32 v49, v20, v21
v_cvt_pk_bf16_f32 v53, -v21, v20
v_and_b32 v20, 63, v10
v_cvt_f32_u32 v20, v20
v_mul_f32 v20, 0x3c800000, v20
v_sin_f32 v21, v20
v_cos_f32 v20, v20
v_add_u32 v10, v11, v10
v_cvt_pk_bf16_f32 v50, v20, v21
v_cvt_pk_bf16_f32 v54, -v21, v20
v_and_b32 v20, 63, v10
v_cvt_f32_u32 v20, v20
v_mul_f32 v20, 0x3c800000, v20
v_sin_f32 v21, v20
v_cos_f32 v20, v20
v_add_u32 v10, v11, v10
v_cvt_pk_bf16_f32 v51, v20, v21
v_cvt_pk_bf16_f32 v55, -v21, v20
ds_write_b128 v12, v[48:51] offset:4096
ds_write_b128 v12, v[52:55] offset:5120
v_lshl_add_u32 v10, v9, 2, s52
v_add_u32 v10, 8, v10
v_add_u32 v11, 32, v8
v_mul_u32_u24 v10, v10, v11
v_and_b32 v20, 63, v10
v_cvt_f32_u32 v20, v20
v_mul_f32 v20, 0x3c800000, v20
v_sin_f32 v21, v20
v_cos_f32 v20, v20
v_add_u32 v10, v11, v10
v_cvt_pk_bf16_f32 v56, v20, v21
v_cvt_pk_bf16_f32 v60, -v21, v20
v_and_b32 v20, 63, v10
v_cvt_f32_u32 v20, v20
v_mul_f32 v20, 0x3c800000, v20
v_sin_f32 v21, v20
v_cos_f32 v20, v20
v_add_u32 v10, v11, v10
v_cvt_pk_bf16_f32 v57, v20, v21
v_cvt_pk_bf16_f32 v61, -v21, v20
v_and_b32 v20, 63, v10
v_cvt_f32_u32 v20, v20
v_mul_f32 v20, 0x3c800000, v20
v_sin_f32 v21, v20
v_cos_f32 v20, v20
v_add_u32 v10, v11, v10
v_cvt_pk_bf16_f32 v58, v20, v21
v_cvt_pk_bf16_f32 v62, -v21, v20
v_and_b32 v20, 63, v10
v_cvt_f32_u32 v20, v20
v_mul_f32 v20, 0x3c800000, v20
v_sin_f32 v21, v20
v_cos_f32 v20, v20
v_add_u32 v10, v11, v10
v_cvt_pk_bf16_f32 v59, v20, v21
v_cvt_pk_bf16_f32 v63, -v21, v20
ds_write_b128 v12, v[56:59] offset:6144
ds_write_b128 v12, v[60:63] offset:7168
s_lshl_b32 s52, s3, 11
v_add_u32 v12, s52, v0
s_lshl_b32 s52, s3, 3
v_lshl_add_u32 v10, v9, 2, s52
v_add_u32 v10, 0, v10
v_add_u32 v11, 0, v8
v_mul_u32_u24 v10, v10, v11
v_cvt_f32_u32 v20, v10
v_mul_f32 v20, 0x3a000000, v20
v_add_u32 v10, v11, v10
v_cos_f32 v64, v20
v_sin_f32 v68, v20
v_cvt_f32_u32 v20, v10
v_mul_f32 v20, 0x3a000000, v20
v_add_u32 v10, v11, v10
v_cos_f32 v65, v20
v_sin_f32 v69, v20
v_cvt_f32_u32 v20, v10
v_mul_f32 v20, 0x3a000000, v20
v_add_u32 v10, v11, v10
v_cos_f32 v66, v20
v_sin_f32 v70, v20
v_cvt_f32_u32 v20, v10
v_mul_f32 v20, 0x3a000000, v20
v_add_u32 v10, v11, v10
v_cos_f32 v67, v20
v_sin_f32 v71, v20
ds_write_b128 v12, v[64:67] offset:32768
ds_write_b128 v12, v[68:71] offset:33792
v_lshl_add_u32 v10, v9, 2, s52
v_add_u32 v10, 0, v10
v_add_u32 v11, 32, v8
v_mul_u32_u24 v10, v10, v11
v_cvt_f32_u32 v20, v10
v_mul_f32 v20, 0x3a000000, v20
v_add_u32 v10, v11, v10
v_cos_f32 v72, v20
v_sin_f32 v76, v20
v_cvt_f32_u32 v20, v10
v_mul_f32 v20, 0x3a000000, v20
v_add_u32 v10, v11, v10
v_cos_f32 v73, v20
v_sin_f32 v77, v20
v_cvt_f32_u32 v20, v10
v_mul_f32 v20, 0x3a000000, v20
v_add_u32 v10, v11, v10
v_cos_f32 v74, v20
v_sin_f32 v78, v20
v_cvt_f32_u32 v20, v10
v_mul_f32 v20, 0x3a000000, v20
v_add_u32 v10, v11, v10
v_cos_f32 v75, v20
v_sin_f32 v79, v20
ds_write_b128 v12, v[72:75] offset:40960
ds_write_b128 v12, v[76:79] offset:41984
v_lshl_add_u32 v10, v9, 2, s52
v_add_u32 v10, 32, v10
v_add_u32 v11, 0, v8
v_mul_u32_u24 v10, v10, v11
v_cvt_f32_u32 v20, v10
v_mul_f32 v20, 0x3a000000, v20
v_add_u32 v10, v11, v10
v_cos_f32 v80, v20
v_sin_f32 v84, v20
v_cvt_f32_u32 v20, v10
v_mul_f32 v20, 0x3a000000, v20
v_add_u32 v10, v11, v10
v_cos_f32 v81, v20
v_sin_f32 v85, v20
v_cvt_f32_u32 v20, v10
v_mul_f32 v20, 0x3a000000, v20
v_add_u32 v10, v11, v10
v_cos_f32 v82, v20
v_sin_f32 v86, v20
v_cvt_f32_u32 v20, v10
v_mul_f32 v20, 0x3a000000, v20
v_add_u32 v10, v11, v10
v_cos_f32 v83, v20
v_sin_f32 v87, v20
ds_write_b128 v12, v[80:83] offset:49152
ds_write_b128 v12, v[84:87] offset:50176
s_lshl_b32 s52, s3, 2
v_lshl_add_u32 v30, v8, 4, s52
v_lshl_add_u32 v30, v9, 11, v30
v_mul_u32_u24 v31, 2560, v9
v_lshl_add_u32 v31, v8, 2, v31
s_lshr_b32 s52, s3, 1
s_lshl_b32 s52, s52, 9
s_and_b32 s53, s3, 1
s_lshl_b32 s53, s53, 3
s_add_u32 s52, s52, s53
v_lshl_add_u32 v24, v8, 4, s52
v_lshl_add_u32 v24, v9, 2, v24
s_mov_b32 s52, 163840
v_mul_lo_u32 v25, v9, s52
v_lshl_add_u32 v25, v8, 4, v25
s_mul_i32 s44, s51, 3145728
s_lshl_b32 s52, s30, 15
s_add_u32 s44, s44, s52
s_add_u32 s44, s44, 205520896
s_mul_i32 s45, s51, 1048576
s_mul_i32 s52, s3, 5120
s_add_u32 s45, s45, s52
s_add_u32 s45, s45, 211812352
s_mul_i32 s48, s51, 3145728
s_lshl_b32 s52, s30, 9
s_add_u32 s48, s48, s52
s_mul_i32 s52, s3, 327680
s_add_u32 s48, s48, s52
s_add_u32 s48, s48, 198180864
s_mov_b32 s49, 0x3acccccd
v_mov_b32 v27, 0x3727c5ac
s_waitcnt vmcnt(0) lgkmcnt(0)
s_barrier
s_mov_b32 s59, 0
ds_read_b128 v[112:115], v0 offset:0
ds_read_b128 v[116:119], v0 offset:1024
ds_read_b128 v[120:123], v0 offset:2048
ds_read_b128 v[124:127], v0 offset:3072
k_pr_49:
buffer_load_dword v18, v30, s[4:7], s44 offen offset:1024 sc1
s_waitcnt vmcnt(0)
v_cmp_eq_u32 vcc, -1, v18
s_cbranch_vccz k_prd_50
s_sleep 8
s_sub_u32 s32, s32, 1
s_cmp_gt_i32 s32, 0
s_cbranch_scc1 k_pr_49
k_prd_50:
k_ps_51:
buffer_load_dword v96, v31, s[4:7], s45 offen offset:0 sc1
buffer_load_dword v97, v31, s[4:7], s45 offen offset:128 sc1
buffer_load_dword v98, v31, s[4:7], s45 offen offset:256 sc1
buffer_load_dword v99, v31, s[4:7], s45 offen offset:384 sc1
buffer_load_dword v100, v31, s[4:7], s45 offen offset:512 sc1
buffer_load_dword v101, v31, s[4:7], s45 offen offset:640 sc1
buffer_load_dword v102, v31, s[4:7], s45 offen offset:768 sc1
buffer_load_dword v103, v31, s[4:7], s45 offen offset:896 sc1
buffer_load_dword v104, v31, s[4:7], s45 offen offset:1024 sc1
buffer_load_dword v105, v31, s[4:7], s45 offen offset:1152 sc1
buffer_load_dword v106, v31, s[4:7], s45 offen offset:1280 sc1
buffer_load_dword v107, v31, s[4:7], s45 offen offset:1408 sc1
buffer_load_dword v108, v31, s[4:7], s45 offen offset:1536 sc1
buffer_load_dword v109, v31, s[4:7], s45 offen offset:1664 sc1
buffer_load_dword v110, v31, s[4:7], s45 offen offset:1792 sc1
buffer_load_dword v111, v31, s[4:7], s45 offen offset:1920 sc1
buffer_load_dword v20, v31, s[4:7], s45 offen offset:2048 sc1
buffer_load_dword v21, v31, s[4:7], s45 offen offset:2176 sc1
buffer_load_dword v22, v31, s[4:7], s45 offen offset:2304 sc1
buffer_load_dword v23, v31, s[4:7], s45 offen offset:2432 sc1
buffer_load_dword v16, v30, s[4:7], s44 offen offset:0 sc1
buffer_load_dword v17, v30, s[4:7], s44 offen offset:512 sc1
buffer_load_dword v19, v30, s[4:7], s44 offen offset:1536 sc1
s_waitcnt vmcnt(21)
v_add_f32 v96, v96, v97
s_waitcnt vmcnt(20)
v_add_f32 v96, v96, v98
s_waitcnt vmcnt(19)
v_add_f32 v96, v96, v99
s_waitcnt vmcnt(18)
v_add_f32 v96, v96, v100
s_waitcnt vmcnt(17)
v_add_f32 v96, v96, v101
s_waitcnt vmcnt(16)
v_add_f32 v96, v96, v102
s_waitcnt vmcnt(15)
v_add_f32 v96, v96, v103
s_waitcnt vmcnt(14)
v_add_f32 v96, v96, v104
s_waitcnt vmcnt(13)
v_add_f32 v96, v96, v105
s_waitcnt vmcnt(12)
v_add_f32 v96, v96, v106
s_waitcnt vmcnt(11)
v_add_f32 v96, v96, v107
s_waitcnt vmcnt(10)
v_add_f32 v96, v96, v108
s_waitcnt vmcnt(9)
v_add_f32 v96, v96, v109
s_waitcnt vmcnt(8)
v_add_f32 v96, v96, v110
s_waitcnt vmcnt(7)
v_add_f32 v96, v96, v111
s_waitcnt vmcnt(6)
v_add_f32 v96, v96, v20
s_waitcnt vmcnt(5)
v_add_f32 v96, v96, v21
s_waitcnt vmcnt(4)
v_add_f32 v96, v96, v22
s_waitcnt vmcnt(3)
v_add_f32 v96, v96, v23
v_cmp_u_f32 vcc, v96, v96
v_fma_f32 v96, v96, s49, v27
s_cbranch_vccz k_psd_52
s_sub_u32 s32, s32, 1
s_cmp_gt_i32 s32, 0
s_cbranch_scc1 k_ps_51
k_psd_52:
v_rsq_f32 v96, v96
s_add_u32 s45, s45, 20480
ds_write_b32 v24, v96 offset:57344
s_branch k_pyd_54
k_py_53:
buffer_load_dword v16, v30, s[4:7], s44 offen offset:0 sc1
buffer_load_dword v17, v30, s[4:7], s44 offen offset:512 sc1
buffer_load_dword v19, v30, s[4:7], s44 offen offset:1536 sc1
s_sub_u32 s32, s32, 1
k_pyd_54:
s_waitcnt vmcnt(0)
v_max3_u32 v20, v16, v17, v19
v_cmp_eq_u32 vcc, -1, v20
s_cmp_gt_i32 s32, 0
s_cselect_b64 vcc, vcc, 0
s_cbranch_vccnz k_py_53
s_add_u32 s44, s44, 4096
s_waitcnt lgkmcnt(0)
s_barrier
ds_read_b128 v[12:15], v0 offset:57344
v_lshlrev_b32 v144, 16, v16
v_and_b32 v128, 0xffff0000, v16
v_lshlrev_b32 v145, 16, v17
v_and_b32 v129, 0xffff0000, v17
v_lshlrev_b32 v146, 16, v18
v_and_b32 v130, 0xffff0000, v18
v_lshlrev_b32 v147, 16, v19
v_and_b32 v131, 0xffff0000, v19
s_waitcnt lgkmcnt(0)
v_mul_f32 v8, v12, v144
v_mul_f32 v12, v12, v128
v_cvt_pk_bf16_f32 v8, v8, v12
v_and_b32 v8, s47, v8
v_mul_f32 v9, v13, v145
v_mul_f32 v13, v13, v129
v_cvt_pk_bf16_f32 v9, v9, v13
v_and_b32 v9, s47, v9
v_mul_f32 v10, v14, v146
v_mul_f32 v14, v14, v130
v_cvt_pk_bf16_f32 v10, v10, v14
v_and_b32 v10, s47, v10
v_mul_f32 v11, v15, v147
v_mul_f32 v15, v15, v131
v_cvt_pk_bf16_f32 v11, v11, v15
v_and_b32 v11, s47, v11
s_nop 1
v_mfma_f32_32x32x16_bf16 v[32:47], v[8:11], v[112:115], 0
v_mfma_f32_32x32x16_bf16 v[48:63], v[8:11], v[116:119], 0
v_mfma_f32_32x32x16_bf16 v[64:79], v[8:11], v[120:123], 0
v_mfma_f32_32x32x16_bf16 v[80:95], v[8:11], v[124:127], 0
ds_read_b128 v[112:115], v0 offset:4096
ds_read_b128 v[116:119], v0 offset:5120
ds_read_b128 v[120:123], v0 offset:6144
ds_read_b128 v[124:127], v0 offset:7168
k_pr_55:
buffer_load_dword v18, v30, s[4:7], s44 offen offset:1024 sc1
s_waitcnt vmcnt(0)
v_cmp_eq_u32 vcc, -1, v18
s_cbranch_vccz k_prd_56
s_sleep 8
s_sub_u32 s32, s32, 1
s_cmp_gt_i32 s32, 0
s_cbranch_scc1 k_pr_55
k_prd_56:
k_ps_57:
buffer_load_dword v96, v31, s[4:7], s45 offen offset:0 sc1
buffer_load_dword v97, v31, s[4:7], s45 offen offset:128 sc1
buffer_load_dword v98, v31, s[4:7], s45 offen offset:256 sc1
buffer_load_dword v99, v31, s[4:7], s45 offen offset:384 sc1
buffer_load_dword v100, v31, s[4:7], s45 offen offset:512 sc1
buffer_load_dword v101, v31, s[4:7], s45 offen offset:640 sc1
buffer_load_dword v102, v31, s[4:7], s45 offen offset:768 sc1
buffer_load_dword v103, v31, s[4:7], s45 offen offset:896 sc1
buffer_load_dword v104, v31, s[4:7], s45 offen offset:1024 sc1
buffer_load_dword v105, v31, s[4:7], s45 offen offset:1152 sc1
buffer_load_dword v106, v31, s[4:7], s45 offen offset:1280 sc1
buffer_load_dword v107, v31, s[4:7], s45 offen offset:1408 sc1
buffer_load_dword v108, v31, s[4:7], s45 offen offset:1536 sc1
buffer_load_dword v109, v31, s[4:7], s45 offen offset:1664 sc1
buffer_load_dword v110, v31, s[4:7], s45 offen offset:1792 sc1
buffer_load_dword v111, v31, s[4:7], s45 offen offset:1920 sc1
buffer_load_dword v20, v31, s[4:7], s45 offen offset:2048 sc1
buffer_load_dword v21, v31, s[4:7], s45 offen offset:2176 sc1
buffer_load_dword v22, v31, s[4:7], s45 offen offset:2304 sc1
buffer_load_dword v23, v31, s[4:7], s45 offen offset:2432 sc1
buffer_load_dword v16, v30, s[4:7], s44 offen offset:0 sc1
buffer_load_dword v17, v30, s[4:7], s44 offen offset:512 sc1
buffer_load_dword v19, v30, s[4:7], s44 offen offset:1536 sc1
s_waitcnt vmcnt(21)
v_add_f32 v96, v96, v97
s_waitcnt vmcnt(20)
v_add_f32 v96, v96, v98
s_waitcnt vmcnt(19)
v_add_f32 v96, v96, v99
s_waitcnt vmcnt(18)
v_add_f32 v96, v96, v100
s_waitcnt vmcnt(17)
v_add_f32 v96, v96, v101
s_waitcnt vmcnt(16)
v_add_f32 v96, v96, v102
s_waitcnt vmcnt(15)
v_add_f32 v96, v96, v103
s_waitcnt vmcnt(14)
v_add_f32 v96, v96, v104
s_waitcnt vmcnt(13)
v_add_f32 v96, v96, v105
s_waitcnt vmcnt(12)
v_add_f32 v96, v96, v106
s_waitcnt vmcnt(11)
v_add_f32 v96, v96, v107
s_waitcnt vmcnt(10)
v_add_f32 v96, v96, v108
s_waitcnt vmcnt(9)
v_add_f32 v96, v96, v109
s_waitcnt vmcnt(8)
v_add_f32 v96, v96, v110
s_waitcnt vmcnt(7)
v_add_f32 v96, v96, v111
s_waitcnt vmcnt(6)
v_add_f32 v96, v96, v20
s_waitcnt vmcnt(5)
v_add_f32 v96, v96, v21
s_waitcnt vmcnt(4)
v_add_f32 v96, v96, v22
s_waitcnt vmcnt(3)
v_add_f32 v96, v96, v23
v_cmp_u_f32 vcc, v96, v96
v_fma_f32 v96, v96, s49, v27
s_cbranch_vccz k_psd_58
s_sub_u32 s32, s32, 1
s_cmp_gt_i32 s32, 0
s_cbranch_scc1 k_ps_57
k_psd_58:
v_rsq_f32 v96, v96
s_add_u32 s45, s45, 20480
ds_write_b32 v24, v96 offset:58368
s_branch k_pyd_60
k_py_59:
buffer_load_dword v16, v30, s[4:7], s44 offen offset:0 sc1
buffer_load_dword v17, v30, s[4:7], s44 offen offset:512 sc1
buffer_load_dword v19, v30, s[4:7], s44 offen offset:1536 sc1
s_sub_u32 s32, s32, 1
k_pyd_60:
s_waitcnt vmcnt(0)
v_max3_u32 v20, v16, v17, v19
v_cmp_eq_u32 vcc, -1, v20
s_cmp_gt_i32 s32, 0
s_cselect_b64 vcc, vcc, 0
s_cbranch_vccnz k_py_59
s_add_u32 s44, s44, 4096
s_waitcnt lgkmcnt(0)
s_barrier
ds_read_b128 v[12:15], v0 offset:58368
v_lshlrev_b32 v148, 16, v16
v_and_b32 v132, 0xffff0000, v16
v_lshlrev_b32 v149, 16, v17
v_and_b32 v133, 0xffff0000, v17
v_lshlrev_b32 v150, 16, v18
v_and_b32 v134, 0xffff0000, v18
v_lshlrev_b32 v151, 16, v19
v_and_b32 v135, 0xffff0000, v19
s_waitcnt lgkmcnt(0)
v_mul_f32 v8, v12, v148
v_mul_f32 v12, v12, v132
v_cvt_pk_bf16_f32 v8, v8, v12
v_and_b32 v8, s47, v8
v_mul_f32 v9, v13, v149
v_mul_f32 v13, v13, v133
v_cvt_pk_bf16_f32 v9, v9, v13
v_and_b32 v9, s47, v9
v_mul_f32 v10, v14, v150
v_mul_f32 v14, v14, v134
v_cvt_pk_bf16_f32 v10, v10, v14
v_and_b32 v10, s47, v10
v_mul_f32 v11, v15, v151
v_mul_f32 v15, v15, v135
v_cvt_pk_bf16_f32 v11, v11, v15
v_and_b32 v11, s47, v11
s_nop 1
v_mfma_f32_32x32x16_bf16 v[32:47], v[8:11], v[112:115], v[32:47]
v_mfma_f32_32x32x16_bf16 v[48:63], v[8:11], v[116:119], v[48:63]
v_mfma_f32_32x32x16_bf16 v[64:79], v[8:11], v[120:123], v[64:79]
v_mfma_f32_32x32x16_bf16 v[80:95], v[8:11], v[124:127], v[80:95]
ds_read_b128 v[112:115], v0 offset:8192
ds_read_b128 v[116:119], v0 offset:9216
ds_read_b128 v[120:123], v0 offset:10240
ds_read_b128 v[124:127], v0 offset:11264
k_pr_61:
buffer_load_dword v18, v30, s[4:7], s44 offen offset:1024 sc1
s_waitcnt vmcnt(0)
v_cmp_eq_u32 vcc, -1, v18
s_cbranch_vccz k_prd_62
s_sleep 8
s_sub_u32 s32, s32, 1
s_cmp_gt_i32 s32, 0
s_cbranch_scc1 k_pr_61
k_prd_62:
k_ps_63:
buffer_load_dword v96, v31, s[4:7], s45 offen offset:0 sc1
buffer_load_dword v97, v31, s[4:7], s45 offen offset:128 sc1
buffer_load_dword v98, v31, s[4:7], s45 offen offset:256 sc1
buffer_load_dword v99, v31, s[4:7], s45 offen offset:384 sc1
buffer_load_dword v100, v31, s[4:7], s45 offen offset:512 sc1
buffer_load_dword v101, v31, s[4:7], s45 offen offset:640 sc1
buffer_load_dword v102, v31, s[4:7], s45 offen offset:768 sc1
buffer_load_dword v103, v31, s[4:7], s45 offen offset:896 sc1
buffer_load_dword v104, v31, s[4:7], s45 offen offset:1024 sc1
buffer_load_dword v105, v31, s[4:7], s45 offen offset:1152 sc1
buffer_load_dword v106, v31, s[4:7], s45 offen offset:1280 sc1
buffer_load_dword v107, v31, s[4:7], s45 offen offset:1408 sc1
buffer_load_dword v108, v31, s[4:7], s45 offen offset:1536 sc1
buffer_load_dword v109, v31, s[4:7], s45 offen offset:1664 sc1
buffer_load_dword v110, v31, s[4:7], s45 offen offset:1792 sc1
buffer_load_dword v111, v31, s[4:7], s45 offen offset:1920 sc1
buffer_load_dword v20, v31, s[4:7], s45 offen offset:2048 sc1
buffer_load_dword v21, v31, s[4:7], s45 offen offset:2176 sc1
buffer_load_dword v22, v31, s[4:7], s45 offen offset:2304 sc1
buffer_load_dword v23, v31, s[4:7], s45 offen offset:2432 sc1
buffer_load_dword v16, v30, s[4:7], s44 offen offset:0 sc1
buffer_load_dword v17, v30, s[4:7], s44 offen offset:512 sc1
buffer_load_dword v19, v30, s[4:7], s44 offen offset:1536 sc1
s_waitcnt vmcnt(21)
v_add_f32 v96, v96, v97
s_waitcnt vmcnt(20)
v_add_f32 v96, v96, v98
s_waitcnt vmcnt(19)
v_add_f32 v96, v96, v99
s_waitcnt vmcnt(18)
v_add_f32 v96, v96, v100
s_waitcnt vmcnt(17)
v_add_f32 v96, v96, v101
s_waitcnt vmcnt(16)
v_add_f32 v96, v96, v102
s_waitcnt vmcnt(15)
v_add_f32 v96, v96, v103
s_waitcnt vmcnt(14)
v_add_f32 v96, v96, v104
s_waitcnt vmcnt(13)
v_add_f32 v96, v96, v105
s_waitcnt vmcnt(12)
v_add_f32 v96, v96, v106
s_waitcnt vmcnt(11)
v_add_f32 v96, v96, v107
s_waitcnt vmcnt(10)
v_add_f32 v96, v96, v108
s_waitcnt vmcnt(9)
v_add_f32 v96, v96, v109
s_waitcnt vmcnt(8)
v_add_f32 v96, v96, v110
s_waitcnt vmcnt(7)
v_add_f32 v96, v96, v111
s_waitcnt vmcnt(6)
v_add_f32 v96, v96, v20
s_waitcnt vmcnt(5)
v_add_f32 v96, v96, v21
s_waitcnt vmcnt(4)
v_add_f32 v96, v96, v22
s_waitcnt vmcnt(3)
v_add_f32 v96, v96, v23
v_cmp_u_f32 vcc, v96, v96
v_fma_f32 v96, v96, s49, v27
s_cbranch_vccz k_psd_64
s_sub_u32 s32, s32, 1
s_cmp_gt_i32 s32, 0
s_cbranch_scc1 k_ps_63
k_psd_64:
v_rsq_f32 v96, v96
s_add_u32 s45, s45, 20480
ds_write_b32 v24, v96 offset:57344
s_branch k_pyd_66
k_py_65:
buffer_load_dword v16, v30, s[4:7], s44 offen offset:0 sc1
buffer_load_dword v17, v30, s[4:7], s44 offen offset:512 sc1
buffer_load_dword v19, v30, s[4:7], s44 offen offset:1536 sc1
s_sub_u32 s32, s32, 1
k_pyd_66:
s_waitcnt vmcnt(0)
v_max3_u32 v20, v16, v17, v19
v_cmp_eq_u32 vcc, -1, v20
s_cmp_gt_i32 s32, 0
s_cselect_b64 vcc, vcc, 0
s_cbranch_vccnz k_py_65
s_add_u32 s44, s44, 4096
s_waitcnt lgkmcnt(0)
s_barrier
ds_read_b128 v[12:15], v0 offset:57344
v_lshlrev_b32 v152, 16, v16
v_and_b32 v136, 0xffff0000, v16
v_lshlrev_b32 v153, 16, v17
v_and_b32 v137, 0xffff0000, v17
v_lshlrev_b32 v154, 16, v18
v_and_b32 v138, 0xffff0000, v18
v_lshlrev_b32 v155, 16, v19
v_and_b32 v139, 0xffff0000, v19
s_waitcnt lgkmcnt(0)
v_mul_f32 v8, v12, v152
v_mul_f32 v12, v12, v136
v_cvt_pk_bf16_f32 v8, v8, v12
v_and_b32 v8, s47, v8
v_mul_f32 v9, v13, v153
v_mul_f32 v13, v13, v137
v_cvt_pk_bf16_f32 v9, v9, v13
v_and_b32 v9, s47, v9
v_mul_f32 v10, v14, v154
v_mul_f32 v14, v14, v138
v_cvt_pk_bf16_f32 v10, v10, v14
v_and_b32 v10, s47, v10
v_mul_f32 v11, v15, v155
v_mul_f32 v15, v15, v139
v_cvt_pk_bf16_f32 v11, v11, v15
v_and_b32 v11, s47, v11
s_nop 1
v_mfma_f32_32x32x16_bf16 v[32:47], v[8:11], v[112:115], v[32:47]
v_mfma_f32_32x32x16_bf16 v[48:63], v[8:11], v[116:119], v[48:63]
v_mfma_f32_32x32x16_bf16 v[64:79], v[8:11], v[120:123], v[64:79]
v_mfma_f32_32x32x16_bf16 v[80:95], v[8:11], v[124:127], v[80:95]
ds_read_b128 v[112:115], v0 offset:12288
ds_read_b128 v[116:119], v0 offset:13312
ds_read_b128 v[120:123], v0 offset:14336
ds_read_b128 v[124:127], v0 offset:15360
k_pr_67:
buffer_load_dword v18, v30, s[4:7], s44 offen offset:1024 sc1
s_waitcnt vmcnt(0)
v_cmp_eq_u32 vcc, -1, v18
s_cbranch_vccz k_prd_68
s_sleep 8
s_sub_u32 s32, s32, 1
s_cmp_gt_i32 s32, 0
s_cbranch_scc1 k_pr_67
k_prd_68:
k_ps_69:
buffer_load_dword v96, v31, s[4:7], s45 offen offset:0 sc1
buffer_load_dword v97, v31, s[4:7], s45 offen offset:128 sc1
buffer_load_dword v98, v31, s[4:7], s45 offen offset:256 sc1
buffer_load_dword v99, v31, s[4:7], s45 offen offset:384 sc1
buffer_load_dword v100, v31, s[4:7], s45 offen offset:512 sc1
buffer_load_dword v101, v31, s[4:7], s45 offen offset:640 sc1
buffer_load_dword v102, v31, s[4:7], s45 offen offset:768 sc1
buffer_load_dword v103, v31, s[4:7], s45 offen offset:896 sc1
buffer_load_dword v104, v31, s[4:7], s45 offen offset:1024 sc1
buffer_load_dword v105, v31, s[4:7], s45 offen offset:1152 sc1
buffer_load_dword v106, v31, s[4:7], s45 offen offset:1280 sc1
buffer_load_dword v107, v31, s[4:7], s45 offen offset:1408 sc1
buffer_load_dword v108, v31, s[4:7], s45 offen offset:1536 sc1
buffer_load_dword v109, v31, s[4:7], s45 offen offset:1664 sc1
buffer_load_dword v110, v31, s[4:7], s45 offen offset:1792 sc1
buffer_load_dword v111, v31, s[4:7], s45 offen offset:1920 sc1
buffer_load_dword v20, v31, s[4:7], s45 offen offset:2048 sc1
buffer_load_dword v21, v31, s[4:7], s45 offen offset:2176 sc1
buffer_load_dword v22, v31, s[4:7], s45 offen offset:2304 sc1
buffer_load_dword v23, v31, s[4:7], s45 offen offset:2432 sc1
buffer_load_dword v16, v30, s[4:7], s44 offen offset:0 sc1
buffer_load_dword v17, v30, s[4:7], s44 offen offset:512 sc1
buffer_load_dword v19, v30, s[4:7], s44 offen offset:1536 sc1
s_waitcnt vmcnt(21)
v_add_f32 v96, v96, v97
s_waitcnt vmcnt(20)
v_add_f32 v96, v96, v98
s_waitcnt vmcnt(19)
v_add_f32 v96, v96, v99
s_waitcnt vmcnt(18)
v_add_f32 v96, v96, v100
s_waitcnt vmcnt(17)
v_add_f32 v96, v96, v101
s_waitcnt vmcnt(16)
v_add_f32 v96, v96, v102
s_waitcnt vmcnt(15)
v_add_f32 v96, v96, v103
s_waitcnt vmcnt(14)
v_add_f32 v96, v96, v104
s_waitcnt vmcnt(13)
v_add_f32 v96, v96, v105
s_waitcnt vmcnt(12)
v_add_f32 v96, v96, v106
s_waitcnt vmcnt(11)
v_add_f32 v96, v96, v107
s_waitcnt vmcnt(10)
v_add_f32 v96, v96, v108
s_waitcnt vmcnt(9)
v_add_f32 v96, v96, v109
s_waitcnt vmcnt(8)
v_add_f32 v96, v96, v110
s_waitcnt vmcnt(7)
v_add_f32 v96, v96, v111
s_waitcnt vmcnt(6)
v_add_f32 v96, v96, v20
s_waitcnt vmcnt(5)
v_add_f32 v96, v96, v21
s_waitcnt vmcnt(4)
v_add_f32 v96, v96, v22
s_waitcnt vmcnt(3)
v_add_f32 v96, v96, v23
v_cmp_u_f32 vcc, v96, v96
v_fma_f32 v96, v96, s49, v27
s_cbranch_vccz k_psd_70
s_sub_u32 s32, s32, 1
s_cmp_gt_i32 s32, 0
s_cbranch_scc1 k_ps_69
k_psd_70:
v_rsq_f32 v96, v96
s_add_u32 s45, s45, 20480
ds_write_b32 v24, v96 offset:58368
s_branch k_pyd_72
k_py_71:
buffer_load_dword v16, v30, s[4:7], s44 offen offset:0 sc1
buffer_load_dword v17, v30, s[4:7], s44 offen offset:512 sc1
buffer_load_dword v19, v30, s[4:7], s44 offen offset:1536 sc1
s_sub_u32 s32, s32, 1
k_pyd_72:
s_waitcnt vmcnt(0)
v_max3_u32 v20, v16, v17, v19
v_cmp_eq_u32 vcc, -1, v20
s_cmp_gt_i32 s32, 0
s_cselect_b64 vcc, vcc, 0
s_cbranch_vccnz k_py_71
s_add_u32 s44, s44, 4096
s_waitcnt lgkmcnt(0)
s_barrier
ds_read_b128 v[12:15], v0 offset:58368
v_lshlrev_b32 v156, 16, v16
v_and_b32 v140, 0xffff0000, v16
v_lshlrev_b32 v157, 16, v17
v_and_b32 v141, 0xffff0000, v17
v_lshlrev_b32 v158, 16, v18
v_and_b32 v142, 0xffff0000, v18
v_lshlrev_b32 v159, 16, v19
v_and_b32 v143, 0xffff0000, v19
s_waitcnt lgkmcnt(0)
v_mul_f32 v8, v12, v156
v_mul_f32 v12, v12, v140
v_cvt_pk_bf16_f32 v8, v8, v12
v_and_b32 v8, s47, v8
v_mul_f32 v9, v13, v157
v_mul_f32 v13, v13, v141
v_cvt_pk_bf16_f32 v9, v9, v13
v_and_b32 v9, s47, v9
v_mul_f32 v10, v14, v158
v_mul_f32 v14, v14, v142
v_cvt_pk_bf16_f32 v10, v10, v14
v_and_b32 v10, s47, v10
v_mul_f32 v11, v15, v159
v_mul_f32 v15, v15, v143
v_cvt_pk_bf16_f32 v11, v11, v15
v_and_b32 v11, s47, v11
s_nop 1
v_mfma_f32_32x32x16_bf16 v[32:47], v[8:11], v[112:115], v[32:47]
v_mfma_f32_32x32x16_bf16 v[48:63], v[8:11], v[116:119], v[48:63]
v_mfma_f32_32x32x16_bf16 v[64:79], v[8:11], v[120:123], v[64:79]
v_mfma_f32_32x32x16_bf16 v[80:95], v[8:11], v[124:127], v[80:95]
ds_read_b128 v[112:115], v0 offset:16384
ds_read_b128 v[116:119], v0 offset:17408
ds_read_b128 v[120:123], v0 offset:18432
ds_read_b128 v[124:127], v0 offset:19456
k_pr_73:
buffer_load_dword v18, v30, s[4:7], s44 offen offset:1024 sc1
s_waitcnt vmcnt(0)
v_cmp_eq_u32 vcc, -1, v18
s_cbranch_vccz k_prd_74
s_sleep 8
s_sub_u32 s32, s32, 1
s_cmp_gt_i32 s32, 0
s_cbranch_scc1 k_pr_73
k_prd_74:
k_ps_75:
buffer_load_dword v96, v31, s[4:7], s45 offen offset:0 sc1
buffer_load_dword v97, v31, s[4:7], s45 offen offset:128 sc1
buffer_load_dword v98, v31, s[4:7], s45 offen offset:256 sc1
buffer_load_dword v99, v31, s[4:7], s45 offen offset:384 sc1
buffer_load_dword v100, v31, s[4:7], s45 offen offset:512 sc1
buffer_load_dword v101, v31, s[4:7], s45 offen offset:640 sc1
buffer_load_dword v102, v31, s[4:7], s45 offen offset:768 sc1
buffer_load_dword v103, v31, s[4:7], s45 offen offset:896 sc1
buffer_load_dword v104, v31, s[4:7], s45 offen offset:1024 sc1
buffer_load_dword v105, v31, s[4:7], s45 offen offset:1152 sc1
buffer_load_dword v106, v31, s[4:7], s45 offen offset:1280 sc1
buffer_load_dword v107, v31, s[4:7], s45 offen offset:1408 sc1
buffer_load_dword v108, v31, s[4:7], s45 offen offset:1536 sc1
buffer_load_dword v109, v31, s[4:7], s45 offen offset:1664 sc1
buffer_load_dword v110, v31, s[4:7], s45 offen offset:1792 sc1
buffer_load_dword v111, v31, s[4:7], s45 offen offset:1920 sc1
buffer_load_dword v20, v31, s[4:7], s45 offen offset:2048 sc1
buffer_load_dword v21, v31, s[4:7], s45 offen offset:2176 sc1
buffer_load_dword v22, v31, s[4:7], s45 offen offset:2304 sc1
buffer_load_dword v23, v31, s[4:7], s45 offen offset:2432 sc1
buffer_load_dword v16, v30, s[4:7], s44 offen offset:0 sc1
buffer_load_dword v17, v30, s[4:7], s44 offen offset:512 sc1
buffer_load_dword v19, v30, s[4:7], s44 offen offset:1536 sc1
s_waitcnt vmcnt(21)
v_add_f32 v96, v96, v97
s_waitcnt vmcnt(20)
v_add_f32 v96, v96, v98
s_waitcnt vmcnt(19)
v_add_f32 v96, v96, v99
s_waitcnt vmcnt(18)
v_add_f32 v96, v96, v100
s_waitcnt vmcnt(17)
v_add_f32 v96, v96, v101
s_waitcnt vmcnt(16)
v_add_f32 v96, v96, v102
s_waitcnt vmcnt(15)
v_add_f32 v96, v96, v103
s_waitcnt vmcnt(14)
v_add_f32 v96, v96, v104
s_waitcnt vmcnt(13)
v_add_f32 v96, v96, v105
s_waitcnt vmcnt(12)
v_add_f32 v96, v96, v106
s_waitcnt vmcnt(11)
v_add_f32 v96, v96, v107
s_waitcnt vmcnt(10)
v_add_f32 v96, v96, v108
s_waitcnt vmcnt(9)
v_add_f32 v96, v96, v109
s_waitcnt vmcnt(8)
v_add_f32 v96, v96, v110
s_waitcnt vmcnt(7)
v_add_f32 v96, v96, v111
s_waitcnt vmcnt(6)
v_add_f32 v96, v96, v20
s_waitcnt vmcnt(5)
v_add_f32 v96, v96, v21
s_waitcnt vmcnt(4)
v_add_f32 v96, v96, v22
s_waitcnt vmcnt(3)
v_add_f32 v96, v96, v23
v_cmp_u_f32 vcc, v96, v96
v_fma_f32 v96, v96, s49, v27
s_cbranch_vccz k_psd_76
s_sub_u32 s32, s32, 1
s_cmp_gt_i32 s32, 0
s_cbranch_scc1 k_ps_75
k_psd_76:
v_rsq_f32 v96, v96
s_add_u32 s45, s45, 20480
ds_write_b32 v24, v96 offset:57344
s_branch k_pyd_78
k_py_77:
buffer_load_dword v16, v30, s[4:7], s44 offen offset:0 sc1
buffer_load_dword v17, v30, s[4:7], s44 offen offset:512 sc1
buffer_load_dword v19, v30, s[4:7], s44 offen offset:1536 sc1
s_sub_u32 s32, s32, 1
k_pyd_78:
s_waitcnt vmcnt(0)
v_max3_u32 v20, v16, v17, v19
v_cmp_eq_u32 vcc, -1, v20
s_cmp_gt_i32 s32, 0
s_cselect_b64 vcc, vcc, 0
s_cbranch_vccnz k_py_77
s_add_u32 s44, s44, 4096
s_waitcnt lgkmcnt(0)
s_barrier
ds_read_b128 v[12:15], v0 offset:57344
v_lshlrev_b32 v176, 16, v16
v_and_b32 v160, 0xffff0000, v16
v_lshlrev_b32 v177, 16, v17
v_and_b32 v161, 0xffff0000, v17
v_lshlrev_b32 v178, 16, v18
v_and_b32 v162, 0xffff0000, v18
v_lshlrev_b32 v179, 16, v19
v_and_b32 v163, 0xffff0000, v19
s_waitcnt lgkmcnt(0)
v_mul_f32 v8, v12, v176
v_mul_f32 v12, v12, v160
v_cvt_pk_bf16_f32 v8, v8, v12
v_and_b32 v8, s47, v8
v_mul_f32 v9, v13, v177
v_mul_f32 v13, v13, v161
v_cvt_pk_bf16_f32 v9, v9, v13
v_and_b32 v9, s47, v9
v_mul_f32 v10, v14, v178
v_mul_f32 v14, v14, v162
v_cvt_pk_bf16_f32 v10, v10, v14
v_and_b32 v10, s47, v10
v_mul_f32 v11, v15, v179
v_mul_f32 v15, v15, v163
v_cvt_pk_bf16_f32 v11, v11, v15
v_and_b32 v11, s47, v11
s_nop 1
v_mfma_f32_32x32x16_bf16 v[32:47], v[8:11], v[112:115], v[32:47]
v_mfma_f32_32x32x16_bf16 v[48:63], v[8:11], v[116:119], v[48:63]
v_mfma_f32_32x32x16_bf16 v[64:79], v[8:11], v[120:123], v[64:79]
v_mfma_f32_32x32x16_bf16 v[80:95], v[8:11], v[124:127], v[80:95]
ds_read_b128 v[112:115], v0 offset:20480
ds_read_b128 v[116:119], v0 offset:21504
ds_read_b128 v[120:123], v0 offset:22528
ds_read_b128 v[124:127], v0 offset:23552
k_pr_79:
buffer_load_dword v18, v30, s[4:7], s44 offen offset:1024 sc1
s_waitcnt vmcnt(0)
v_cmp_eq_u32 vcc, -1, v18
s_cbranch_vccz k_prd_80
s_sleep 8
s_sub_u32 s32, s32, 1
s_cmp_gt_i32 s32, 0
s_cbranch_scc1 k_pr_79
k_prd_80:
k_ps_81:
buffer_load_dword v96, v31, s[4:7], s45 offen offset:0 sc1
buffer_load_dword v97, v31, s[4:7], s45 offen offset:128 sc1
buffer_load_dword v98, v31, s[4:7], s45 offen offset:256 sc1
buffer_load_dword v99, v31, s[4:7], s45 offen offset:384 sc1
buffer_load_dword v100, v31, s[4:7], s45 offen offset:512 sc1
buffer_load_dword v101, v31, s[4:7], s45 offen offset:640 sc1
buffer_load_dword v102, v31, s[4:7], s45 offen offset:768 sc1
buffer_load_dword v103, v31, s[4:7], s45 offen offset:896 sc1
buffer_load_dword v104, v31, s[4:7], s45 offen offset:1024 sc1
buffer_load_dword v105, v31, s[4:7], s45 offen offset:1152 sc1
buffer_load_dword v106, v31, s[4:7], s45 offen offset:1280 sc1
buffer_load_dword v107, v31, s[4:7], s45 offen offset:1408 sc1
buffer_load_dword v108, v31, s[4:7], s45 offen offset:1536 sc1
buffer_load_dword v109, v31, s[4:7], s45 offen offset:1664 sc1
buffer_load_dword v110, v31, s[4:7], s45 offen offset:1792 sc1
buffer_load_dword v111, v31, s[4:7], s45 offen offset:1920 sc1
buffer_load_dword v20, v31, s[4:7], s45 offen offset:2048 sc1
buffer_load_dword v21, v31, s[4:7], s45 offen offset:2176 sc1
buffer_load_dword v22, v31, s[4:7], s45 offen offset:2304 sc1
buffer_load_dword v23, v31, s[4:7], s45 offen offset:2432 sc1
buffer_load_dword v16, v30, s[4:7], s44 offen offset:0 sc1
buffer_load_dword v17, v30, s[4:7], s44 offen offset:512 sc1
buffer_load_dword v19, v30, s[4:7], s44 offen offset:1536 sc1
s_waitcnt vmcnt(21)
v_add_f32 v96, v96, v97
s_waitcnt vmcnt(20)
v_add_f32 v96, v96, v98
s_waitcnt vmcnt(19)
v_add_f32 v96, v96, v99
s_waitcnt vmcnt(18)
v_add_f32 v96, v96, v100
s_waitcnt vmcnt(17)
v_add_f32 v96, v96, v101
s_waitcnt vmcnt(16)
v_add_f32 v96, v96, v102
s_waitcnt vmcnt(15)
v_add_f32 v96, v96, v103
s_waitcnt vmcnt(14)
v_add_f32 v96, v96, v104
s_waitcnt vmcnt(13)
v_add_f32 v96, v96, v105
s_waitcnt vmcnt(12)
v_add_f32 v96, v96, v106
s_waitcnt vmcnt(11)
v_add_f32 v96, v96, v107
s_waitcnt vmcnt(10)
v_add_f32 v96, v96, v108
s_waitcnt vmcnt(9)
v_add_f32 v96, v96, v109
s_waitcnt vmcnt(8)
v_add_f32 v96, v96, v110
s_waitcnt vmcnt(7)
v_add_f32 v96, v96, v111
s_waitcnt vmcnt(6)
v_add_f32 v96, v96, v20
s_waitcnt vmcnt(5)
v_add_f32 v96, v96, v21
s_waitcnt vmcnt(4)
v_add_f32 v96, v96, v22
s_waitcnt vmcnt(3)
v_add_f32 v96, v96, v23
v_cmp_u_f32 vcc, v96, v96
v_fma_f32 v96, v96, s49, v27
s_cbranch_vccz k_psd_82
s_sub_u32 s32, s32, 1
s_cmp_gt_i32 s32, 0
s_cbranch_scc1 k_ps_81
k_psd_82:
v_rsq_f32 v96, v96
s_add_u32 s45, s45, 20480
ds_write_b32 v24, v96 offset:58368
s_branch k_pyd_84
k_py_83:
buffer_load_dword v16, v30, s[4:7], s44 offen offset:0 sc1
buffer_load_dword v17, v30, s[4:7], s44 offen offset:512 sc1
buffer_load_dword v19, v30, s[4:7], s44 offen offset:1536 sc1
s_sub_u32 s32, s32, 1
k_pyd_84:
s_waitcnt vmcnt(0)
v_max3_u32 v20, v16, v17, v19
v_cmp_eq_u32 vcc, -1, v20
s_cmp_gt_i32 s32, 0
s_cselect_b64 vcc, vcc, 0
s_cbranch_vccnz k_py_83
s_add_u32 s44, s44, 4096
s_waitcnt lgkmcnt(0)
s_barrier
ds_read_b128 v[12:15], v0 offset:58368
v_lshlrev_b32 v180, 16, v16
v_and_b32 v164, 0xffff0000, v16
v_lshlrev_b32 v181, 16, v17
v_and_b32 v165, 0xffff0000, v17
v_lshlrev_b32 v182, 16, v18
v_and_b32 v166, 0xffff0000, v18
v_lshlrev_b32 v183, 16, v19
v_and_b32 v167, 0xffff0000, v19
s_waitcnt lgkmcnt(0)
v_mul_f32 v8, v12, v180
v_mul_f32 v12, v12, v164
v_cvt_pk_bf16_f32 v8, v8, v12
v_and_b32 v8, s47, v8
v_mul_f32 v9, v13, v181
v_mul_f32 v13, v13, v165
v_cvt_pk_bf16_f32 v9, v9, v13
v_and_b32 v9, s47, v9
v_mul_f32 v10, v14, v182
v_mul_f32 v14, v14, v166
v_cvt_pk_bf16_f32 v10, v10, v14
v_and_b32 v10, s47, v10
v_mul_f32 v11, v15, v183
v_mul_f32 v15, v15, v167
v_cvt_pk_bf16_f32 v11, v11, v15
v_and_b32 v11, s47, v11
s_nop 1
v_mfma_f32_32x32x16_bf16 v[32:47], v[8:11], v[112:115], v[32:47]
v_mfma_f32_32x32x16_bf16 v[48:63], v[8:11], v[116:119], v[48:63]
v_mfma_f32_32x32x16_bf16 v[64:79], v[8:11], v[120:123], v[64:79]
v_mfma_f32_32x32x16_bf16 v[80:95], v[8:11], v[124:127], v[80:95]
ds_read_b128 v[112:115], v0 offset:24576
ds_read_b128 v[116:119], v0 offset:25600
ds_read_b128 v[120:123], v0 offset:26624
ds_read_b128 v[124:127], v0 offset:27648
k_pr_85:
buffer_load_dword v18, v30, s[4:7], s44 offen offset:1024 sc1
s_waitcnt vmcnt(0)
v_cmp_eq_u32 vcc, -1, v18
s_cbranch_vccz k_prd_86
s_sleep 8
s_sub_u32 s32, s32, 1
s_cmp_gt_i32 s32, 0
s_cbranch_scc1 k_pr_85
k_prd_86:
k_ps_87:
buffer_load_dword v96, v31, s[4:7], s45 offen offset:0 sc1
buffer_load_dword v97, v31, s[4:7], s45 offen offset:128 sc1
buffer_load_dword v98, v31, s[4:7], s45 offen offset:256 sc1
buffer_load_dword v99, v31, s[4:7], s45 offen offset:384 sc1
buffer_load_dword v100, v31, s[4:7], s45 offen offset:512 sc1
buffer_load_dword v101, v31, s[4:7], s45 offen offset:640 sc1
buffer_load_dword v102, v31, s[4:7], s45 offen offset:768 sc1
buffer_load_dword v103, v31, s[4:7], s45 offen offset:896 sc1
buffer_load_dword v104, v31, s[4:7], s45 offen offset:1024 sc1
buffer_load_dword v105, v31, s[4:7], s45 offen offset:1152 sc1
buffer_load_dword v106, v31, s[4:7], s45 offen offset:1280 sc1
buffer_load_dword v107, v31, s[4:7], s45 offen offset:1408 sc1
buffer_load_dword v108, v31, s[4:7], s45 offen offset:1536 sc1
buffer_load_dword v109, v31, s[4:7], s45 offen offset:1664 sc1
buffer_load_dword v110, v31, s[4:7], s45 offen offset:1792 sc1
buffer_load_dword v111, v31, s[4:7], s45 offen offset:1920 sc1
buffer_load_dword v20, v31, s[4:7], s45 offen offset:2048 sc1
buffer_load_dword v21, v31, s[4:7], s45 offen offset:2176 sc1
buffer_load_dword v22, v31, s[4:7], s45 offen offset:2304 sc1
buffer_load_dword v23, v31, s[4:7], s45 offen offset:2432 sc1
buffer_load_dword v16, v30, s[4:7], s44 offen offset:0 sc1
buffer_load_dword v17, v30, s[4:7], s44 offen offset:512 sc1
buffer_load_dword v19, v30, s[4:7], s44 offen offset:1536 sc1
s_waitcnt vmcnt(21)
v_add_f32 v96, v96, v97
s_waitcnt vmcnt(20)
v_add_f32 v96, v96, v98
s_waitcnt vmcnt(19)
v_add_f32 v96, v96, v99
s_waitcnt vmcnt(18)
v_add_f32 v96, v96, v100
s_waitcnt vmcnt(17)
v_add_f32 v96, v96, v101
s_waitcnt vmcnt(16)
v_add_f32 v96, v96, v102
s_waitcnt vmcnt(15)
v_add_f32 v96, v96, v103
s_waitcnt vmcnt(14)
v_add_f32 v96, v96, v104
s_waitcnt vmcnt(13)
v_add_f32 v96, v96, v105
s_waitcnt vmcnt(12)
v_add_f32 v96, v96, v106
s_waitcnt vmcnt(11)
v_add_f32 v96, v96, v107
s_waitcnt vmcnt(10)
v_add_f32 v96, v96, v108
s_waitcnt vmcnt(9)
v_add_f32 v96, v96, v109
s_waitcnt vmcnt(8)
v_add_f32 v96, v96, v110
s_waitcnt vmcnt(7)
v_add_f32 v96, v96, v111
s_waitcnt vmcnt(6)
v_add_f32 v96, v96, v20
s_waitcnt vmcnt(5)
v_add_f32 v96, v96, v21
s_waitcnt vmcnt(4)
v_add_f32 v96, v96, v22
s_waitcnt vmcnt(3)
v_add_f32 v96, v96, v23
v_cmp_u_f32 vcc, v96, v96
v_fma_f32 v96, v96, s49, v27
s_cbranch_vccz k_psd_88
s_sub_u32 s32, s32, 1
s_cmp_gt_i32 s32, 0
s_cbranch_scc1 k_ps_87
k_psd_88:
v_rsq_f32 v96, v96
s_add_u32 s45, s45, 20480
ds_write_b32 v24, v96 offset:57344
s_branch k_pyd_90
k_py_89:
buffer_load_dword v16, v30, s[4:7], s44 offen offset:0 sc1
buffer_load_dword v17, v30, s[4:7], s44 offen offset:512 sc1
buffer_load_dword v19, v30, s[4:7], s44 offen offset:1536 sc1
s_sub_u32 s32, s32, 1
k_pyd_90:
s_waitcnt vmcnt(0)
v_max3_u32 v20, v16, v17, v19
v_cmp_eq_u32 vcc, -1, v20
s_cmp_gt_i32 s32, 0
s_cselect_b64 vcc, vcc, 0
s_cbranch_vccnz k_py_89
s_add_u32 s44, s44, 4096
s_waitcnt lgkmcnt(0)
s_barrier
ds_read_b128 v[12:15], v0 offset:57344
v_lshlrev_b32 v184, 16, v16
v_and_b32 v168, 0xffff0000, v16
v_lshlrev_b32 v185, 16, v17
v_and_b32 v169, 0xffff0000, v17
v_lshlrev_b32 v186, 16, v18
v_and_b32 v170, 0xffff0000, v18
v_lshlrev_b32 v187, 16, v19
v_and_b32 v171, 0xffff0000, v19
s_waitcnt lgkmcnt(0)
v_mul_f32 v8, v12, v184
v_mul_f32 v12, v12, v168
v_cvt_pk_bf16_f32 v8, v8, v12
v_and_b32 v8, s47, v8
v_mul_f32 v9, v13, v185
v_mul_f32 v13, v13, v169
v_cvt_pk_bf16_f32 v9, v9, v13
v_and_b32 v9, s47, v9
v_mul_f32 v10, v14, v186
v_mul_f32 v14, v14, v170
v_cvt_pk_bf16_f32 v10, v10, v14
v_and_b32 v10, s47, v10
v_mul_f32 v11, v15, v187
v_mul_f32 v15, v15, v171
v_cvt_pk_bf16_f32 v11, v11, v15
v_and_b32 v11, s47, v11
s_nop 1
v_mfma_f32_32x32x16_bf16 v[32:47], v[8:11], v[112:115], v[32:47]
v_mfma_f32_32x32x16_bf16 v[48:63], v[8:11], v[116:119], v[48:63]
v_mfma_f32_32x32x16_bf16 v[64:79], v[8:11], v[120:123], v[64:79]
v_mfma_f32_32x32x16_bf16 v[80:95], v[8:11], v[124:127], v[80:95]
ds_read_b128 v[112:115], v0 offset:28672
ds_read_b128 v[116:119], v0 offset:29696
ds_read_b128 v[120:123], v0 offset:30720
ds_read_b128 v[124:127], v0 offset:31744
k_pr_91:
buffer_load_dword v18, v30, s[4:7], s44 offen offset:1024 sc1
s_waitcnt vmcnt(0)
v_cmp_eq_u32 vcc, -1, v18
s_cbranch_vccz k_prd_92
s_sleep 8
s_sub_u32 s32, s32, 1
s_cmp_gt_i32 s32, 0
s_cbranch_scc1 k_pr_91
k_prd_92:
k_ps_93:
buffer_load_dword v96, v31, s[4:7], s45 offen offset:0 sc1
buffer_load_dword v97, v31, s[4:7], s45 offen offset:128 sc1
buffer_load_dword v98, v31, s[4:7], s45 offen offset:256 sc1
buffer_load_dword v99, v31, s[4:7], s45 offen offset:384 sc1
buffer_load_dword v100, v31, s[4:7], s45 offen offset:512 sc1
buffer_load_dword v101, v31, s[4:7], s45 offen offset:640 sc1
buffer_load_dword v102, v31, s[4:7], s45 offen offset:768 sc1
buffer_load_dword v103, v31, s[4:7], s45 offen offset:896 sc1
buffer_load_dword v104, v31, s[4:7], s45 offen offset:1024 sc1
buffer_load_dword v105, v31, s[4:7], s45 offen offset:1152 sc1
buffer_load_dword v106, v31, s[4:7], s45 offen offset:1280 sc1
buffer_load_dword v107, v31, s[4:7], s45 offen offset:1408 sc1
buffer_load_dword v108, v31, s[4:7], s45 offen offset:1536 sc1
buffer_load_dword v109, v31, s[4:7], s45 offen offset:1664 sc1
buffer_load_dword v110, v31, s[4:7], s45 offen offset:1792 sc1
buffer_load_dword v111, v31, s[4:7], s45 offen offset:1920 sc1
buffer_load_dword v20, v31, s[4:7], s45 offen offset:2048 sc1
buffer_load_dword v21, v31, s[4:7], s45 offen offset:2176 sc1
buffer_load_dword v22, v31, s[4:7], s45 offen offset:2304 sc1
buffer_load_dword v23, v31, s[4:7], s45 offen offset:2432 sc1
buffer_load_dword v16, v30, s[4:7], s44 offen offset:0 sc1
buffer_load_dword v17, v30, s[4:7], s44 offen offset:512 sc1
buffer_load_dword v19, v30, s[4:7], s44 offen offset:1536 sc1
s_waitcnt vmcnt(21)
v_add_f32 v96, v96, v97
s_waitcnt vmcnt(20)
v_add_f32 v96, v96, v98
s_waitcnt vmcnt(19)
v_add_f32 v96, v96, v99
s_waitcnt vmcnt(18)
v_add_f32 v96, v96, v100
s_waitcnt vmcnt(17)
v_add_f32 v96, v96, v101
s_waitcnt vmcnt(16)
v_add_f32 v96, v96, v102
s_waitcnt vmcnt(15)
v_add_f32 v96, v96, v103
s_waitcnt vmcnt(14)
v_add_f32 v96, v96, v104
s_waitcnt vmcnt(13)
v_add_f32 v96, v96, v105
s_waitcnt vmcnt(12)
v_add_f32 v96, v96, v106
s_waitcnt vmcnt(11)
v_add_f32 v96, v96, v107
s_waitcnt vmcnt(10)
v_add_f32 v96, v96, v108
s_waitcnt vmcnt(9)
v_add_f32 v96, v96, v109
s_waitcnt vmcnt(8)
v_add_f32 v96, v96, v110
s_waitcnt vmcnt(7)
v_add_f32 v96, v96, v111
s_waitcnt vmcnt(6)
v_add_f32 v96, v96, v20
s_waitcnt vmcnt(5)
v_add_f32 v96, v96, v21
s_waitcnt vmcnt(4)
v_add_f32 v96, v96, v22
s_waitcnt vmcnt(3)
v_add_f32 v96, v96, v23
v_cmp_u_f32 vcc, v96, v96
v_fma_f32 v96, v96, s49, v27
s_cbranch_vccz k_psd_94
s_sub_u32 s32, s32, 1
s_cmp_gt_i32 s32, 0
s_cbranch_scc1 k_ps_93
k_psd_94:
v_rsq_f32 v96, v96
s_add_u32 s45, s45, 20480
ds_write_b32 v24, v96 offset:58368
s_branch k_pyd_96
k_py_95:
buffer_load_dword v16, v30, s[4:7], s44 offen offset:0 sc1
buffer_load_dword v17, v30, s[4:7], s44 offen offset:512 sc1
buffer_load_dword v19, v30, s[4:7], s44 offen offset:1536 sc1
s_sub_u32 s32, s32, 1
k_pyd_96:
s_waitcnt vmcnt(0)
v_max3_u32 v20, v16, v17, v19
v_cmp_eq_u32 vcc, -1, v20
s_cmp_gt_i32 s32, 0
s_cselect_b64 vcc, vcc, 0
s_cbranch_vccnz k_py_95
s_add_u32 s44, s44, 4096
k_k7_48:
s_waitcnt lgkmcnt(0)
s_barrier
ds_read_b128 v[12:15], v0 offset:58368
v_lshlrev_b32 v188, 16, v16
v_and_b32 v172, 0xffff0000, v16
v_lshlrev_b32 v189, 16, v17
v_and_b32 v173, 0xffff0000, v17
v_lshlrev_b32 v190, 16, v18
v_and_b32 v174, 0xffff0000, v18
v_lshlrev_b32 v191, 16, v19
v_and_b32 v175, 0xffff0000, v19
s_waitcnt lgkmcnt(0)
v_mul_f32 v8, v12, v188
v_mul_f32 v12, v12, v172
v_cvt_pk_bf16_f32 v8, v8, v12
v_and_b32 v8, s47, v8
v_mul_f32 v9, v13, v189
v_mul_f32 v13, v13, v173
v_cvt_pk_bf16_f32 v9, v9, v13
v_and_b32 v9, s47, v9
v_mul_f32 v10, v14, v190
v_mul_f32 v14, v14, v174
v_cvt_pk_bf16_f32 v10, v10, v14
v_and_b32 v10, s47, v10
v_mul_f32 v11, v15, v191
v_mul_f32 v15, v15, v175
v_cvt_pk_bf16_f32 v11, v11, v15
v_and_b32 v11, s47, v11
s_nop 1
v_mfma_f32_32x32x16_bf16 v[32:47], v[8:11], v[112:115], v[32:47]
v_mfma_f32_32x32x16_bf16 v[48:63], v[8:11], v[116:119], v[48:63]
v_mfma_f32_32x32x16_bf16 v[64:79], v[8:11], v[120:123], v[64:79]
v_mfma_f32_32x32x16_bf16 v[80:95], v[8:11], v[124:127], v[80:95]
ds_read_b128 v[112:115], v0 offset:32768
ds_read_b128 v[116:119], v0 offset:33792
ds_read_b128 v[120:123], v0 offset:34816
ds_read_b128 v[124:127], v0 offset:35840
s_waitcnt lgkmcnt(3)
v_pk_mul_f32 v[8:9], v[32:33], v[112:113]
v_pk_mul_f32 v[10:11], v[48:49], v[112:113]
s_waitcnt lgkmcnt(2)
v_pk_fma_f32 v[8:9], v[48:49], v[116:117], v[8:9]
v_pk_fma_f32 v[10:11], v[32:33], v[116:117], v[10:11] neg_lo:[1,0,0] neg_hi:[1,0,0]
v_cvt_pk_bf16_f32 v32, v8, v10
v_cvt_pk_bf16_f32 v33, v9, v11
v_pk_mul_f32 v[8:9], v[34:35], v[114:115]
v_pk_mul_f32 v[10:11], v[50:51], v[114:115]
v_pk_fma_f32 v[8:9], v[50:51], v[118:119], v[8:9]
v_pk_fma_f32 v[10:11], v[34:35], v[118:119], v[10:11] neg_lo:[1,0,0] neg_hi:[1,0,0]
v_cvt_pk_bf16_f32 v34, v8, v10
v_cvt_pk_bf16_f32 v35, v9, v11
ds_read_b128 v[112:115], v0 offset:36864
ds_read_b128 v[116:119], v0 offset:37888
s_waitcnt lgkmcnt(3)
v_pk_mul_f32 v[8:9], v[36:37], v[120:121]
v_pk_mul_f32 v[10:11], v[52:53], v[120:121]
s_waitcnt lgkmcnt(2)
v_pk_fma_f32 v[8:9], v[52:53], v[124:125], v[8:9]
v_pk_fma_f32 v[10:11], v[36:37], v[124:125], v[10:11] neg_lo:[1,0,0] neg_hi:[1,0,0]
v_cvt_pk_bf16_f32 v36, v8, v10
v_cvt_pk_bf16_f32 v37, v9, v11
v_pk_mul_f32 v[8:9], v[38:39], v[122:123]
v_pk_mul_f32 v[10:11], v[54:55], v[122:123]
v_pk_fma_f32 v[8:9], v[54:55], v[126:127], v[8:9]
v_pk_fma_f32 v[10:11], v[38:39], v[126:127], v[10:11] neg_lo:[1,0,0] neg_hi:[1,0,0]
v_cvt_pk_bf16_f32 v38, v8, v10
v_cvt_pk_bf16_f32 v39, v9, v11
ds_read_b128 v[120:123], v0 offset:38912
ds_read_b128 v[124:127], v0 offset:39936
s_waitcnt lgkmcnt(3)
v_pk_mul_f32 v[8:9], v[40:41], v[112:113]
v_pk_mul_f32 v[10:11], v[56:57], v[112:113]
s_waitcnt lgkmcnt(2)
v_pk_fma_f32 v[8:9], v[56:57], v[116:117], v[8:9]
v_pk_fma_f32 v[10:11], v[40:41], v[116:117], v[10:11] neg_lo:[1,0,0] neg_hi:[1,0,0]
v_cvt_pk_bf16_f32 v40, v8, v10
v_cvt_pk_bf16_f32 v41, v9, v11
v_pk_mul_f32 v[8:9], v[42:43], v[114:115]
v_pk_mul_f32 v[10:11], v[58:59], v[114:115]
v_pk_fma_f32 v[8:9], v[58:59], v[118:119], v[8:9]
v_pk_fma_f32 v[10:11], v[42:43], v[118:119], v[10:11] neg_lo:[1,0,0] neg_hi:[1,0,0]
v_cvt_pk_bf16_f32 v42, v8, v10
v_cvt_pk_bf16_f32 v43, v9, v11
ds_read_b128 v[112:115], v0 offset:40960
ds_read_b128 v[116:119], v0 offset:41984
s_waitcnt lgkmcnt(3)
v_pk_mul_f32 v[8:9], v[44:45], v[120:121]
v_pk_mul_f32 v[10:11], v[60:61], v[120:121]
s_waitcnt lgkmcnt(2)
v_pk_fma_f32 v[8:9], v[60:61], v[124:125], v[8:9]
v_pk_fma_f32 v[10:11], v[44:45], v[124:125], v[10:11] neg_lo:[1,0,0] neg_hi:[1,0,0]
v_cvt_pk_bf16_f32 v44, v8, v10
v_cvt_pk_bf16_f32 v45, v9, v11
v_pk_mul_f32 v[8:9], v[46:47], v[122:123]
v_pk_mul_f32 v[10:11], v[62:63], v[122:123]
v_pk_fma_f32 v[8:9], v[62:63], v[126:127], v[8:9]
v_pk_fma_f32 v[10:11], v[46:47], v[126:127], v[10:11] neg_lo:[1,0,0] neg_hi:[1,0,0]
v_cvt_pk_bf16_f32 v46, v8, v10
v_cvt_pk_bf16_f32 v47, v9, v11
ds_read_b128 v[120:123], v0 offset:43008
ds_read_b128 v[124:127], v0 offset:44032
v_mfma_f32_32x32x16_bf16 v[48:63], a[160:163], v[32:35], 0
s_waitcnt lgkmcnt(3)
v_pk_mul_f32 v[8:9], v[64:65], v[112:113]
v_pk_mul_f32 v[10:11], v[80:81], v[112:113]
s_waitcnt lgkmcnt(2)
v_pk_fma_f32 v[8:9], v[80:81], v[116:117], v[8:9]
v_pk_fma_f32 v[10:11], v[64:65], v[116:117], v[10:11] neg_lo:[1,0,0] neg_hi:[1,0,0]
v_cvt_pk_bf16_f32 v64, v8, v10
v_cvt_pk_bf16_f32 v65, v9, v11
v_mfma_f32_32x32x16_bf16 v[96:111], a[164:167], v[32:35], 0
v_pk_mul_f32 v[8:9], v[66:67], v[114:115]
v_pk_mul_f32 v[10:11], v[82:83], v[114:115]
v_pk_fma_f32 v[8:9], v[82:83], v[118:119], v[8:9]
v_pk_fma_f32 v[10:11], v[66:67], v[118:119], v[10:11] neg_lo:[1,0,0] neg_hi:[1,0,0]
v_cvt_pk_bf16_f32 v66, v8, v10
v_cvt_pk_bf16_f32 v67, v9, v11
v_mfma_f32_32x32x16_bf16 v[48:63], a[168:171], v[36:39], v[48:63]
ds_read_b128 v[112:115], v0 offset:45056
ds_read_b128 v[116:119], v0 offset:46080
s_waitcnt lgkmcnt(3)
v_pk_mul_f32 v[8:9], v[68:69], v[120:121]
v_pk_mul_f32 v[10:11], v[84:85], v[120:121]
s_waitcnt lgkmcnt(2)
v_pk_fma_f32 v[8:9], v[84:85], v[124:125], v[8:9]
v_pk_fma_f32 v[10:11], v[68:69], v[124:125], v[10:11] neg_lo:[1,0,0] neg_hi:[1,0,0]
v_mfma_f32_32x32x16_bf16 v[96:111], a[172:175], v[36:39], v[96:111]
v_cvt_pk_bf16_f32 v68, v8, v10
v_cvt_pk_bf16_f32 v69, v9, v11
v_pk_mul_f32 v[8:9], v[70:71], v[122:123]
v_pk_mul_f32 v[10:11], v[86:87], v[122:123]
v_pk_fma_f32 v[8:9], v[86:87], v[126:127], v[8:9]
v_pk_fma_f32 v[10:11], v[70:71], v[126:127], v[10:11] neg_lo:[1,0,0] neg_hi:[1,0,0]
v_mfma_f32_32x32x16_bf16 v[48:63], a[176:179], v[40:43], v[48:63]
v_cvt_pk_bf16_f32 v70, v8, v10
v_cvt_pk_bf16_f32 v71, v9, v11
ds_read_b128 v[120:123], v0 offset:47104
ds_read_b128 v[124:127], v0 offset:48128
s_waitcnt lgkmcnt(3)
v_pk_mul_f32 v[8:9], v[72:73], v[112:113]
v_pk_mul_f32 v[10:11], v[88:89], v[112:113]
v_mfma_f32_32x32x16_bf16 v[96:111], a[180:183], v[40:43], v[96:111]
s_waitcnt lgkmcnt(2)
v_pk_fma_f32 v[8:9], v[88:89], v[116:117], v[8:9]
v_pk_fma_f32 v[10:11], v[72:73], v[116:117], v[10:11] neg_lo:[1,0,0] neg_hi:[1,0,0]
v_cvt_pk_bf16_f32 v72, v8, v10
v_cvt_pk_bf16_f32 v73, v9, v11
v_pk_mul_f32 v[8:9], v[74:75], v[114:115]
v_pk_mul_f32 v[10:11], v[90:91], v[114:115]
v_mfma_f32_32x32x16_bf16 v[48:63], a[184:187], v[44:47], v[48:63]
v_pk_fma_f32 v[8:9], v[90:91], v[118:119], v[8:9]
v_pk_fma_f32 v[10:11], v[74:75], v[118:119], v[10:11] neg_lo:[1,0,0] neg_hi:[1,0,0]
v_cvt_pk_bf16_f32 v74, v8, v10
v_cvt_pk_bf16_f32 v75, v9, v11
ds_read_b128 v[112:115], v0 offset:32768
ds_read_b128 v[116:119], v0 offset:33792
v_mfma_f32_32x32x16_bf16 v[96:111], a[188:191], v[44:47], v[96:111]
s_waitcnt lgkmcnt(3)
v_pk_mul_f32 v[8:9], v[76:77], v[120:121]
v_pk_mul_f32 v[10:11], v[92:93], v[120:121]
s_waitcnt lgkmcnt(2)
v_pk_fma_f32 v[8:9], v[92:93], v[124:125], v[8:9]
v_pk_fma_f32 v[10:11], v[76:77], v[124:125], v[10:11] neg_lo:[1,0,0] neg_hi:[1,0,0]
v_cvt_pk_bf16_f32 v76, v8, v10
v_cvt_pk_bf16_f32 v77, v9, v11
v_pk_mul_f32 v[8:9], v[78:79], v[122:123]
v_pk_mul_f32 v[10:11], v[94:95], v[122:123]
v_pk_fma_f32 v[8:9], v[94:95], v[126:127], v[8:9]
v_pk_fma_f32 v[10:11], v[78:79], v[126:127], v[10:11] neg_lo:[1,0,0] neg_hi:[1,0,0]
v_cvt_pk_bf16_f32 v78, v8, v10
v_cvt_pk_bf16_f32 v79, v9, v11
ds_read_b128 v[120:123], v0 offset:34816
ds_read_b128 v[124:127], v0 offset:35840
v_mfma_f32_32x32x16_bf16 v[80:95], a[160:163], v[64:67], 0
v_pk_mul_f32 v[8:9], v[48:49], v[208:209]
v_pk_mul_f32 v[10:11], v[96:97], v[208:209]
v_pk_fma_f32 v[8:9], v[96:97], v[192:193], v[8:9]
v_pk_fma_f32 v[10:11], v[48:49], v[192:193], v[10:11] neg_lo:[0,0,1] neg_hi:[0,0,1]
v_cvt_pk_bf16_f32 v48, v8, v10
v_cvt_pk_bf16_f32 v49, v9, v11
v_mfma_f32_32x32x16_bf16 v[32:47], a[164:167], v[64:67], 0
v_pk_mul_f32 v[8:9], v[50:51], v[210:211]
v_pk_mul_f32 v[10:11], v[98:99], v[210:211]
v_pk_fma_f32 v[8:9], v[98:99], v[194:195], v[8:9]
v_pk_fma_f32 v[10:11], v[50:51], v[194:195], v[10:11] neg_lo:[0,0,1] neg_hi:[0,0,1]
v_cvt_pk_bf16_f32 v50, v8, v10
v_cvt_pk_bf16_f32 v51, v9, v11
v_mfma_f32_32x32x16_bf16 v[80:95], a[168:171], v[68:71], v[80:95]
v_pk_mul_f32 v[8:9], v[52:53], v[212:213]
v_pk_mul_f32 v[10:11], v[100:101], v[212:213]
v_pk_fma_f32 v[8:9], v[100:101], v[196:197], v[8:9]
v_pk_fma_f32 v[10:11], v[52:53], v[196:197], v[10:11] neg_lo:[0,0,1] neg_hi:[0,0,1]
v_cvt_pk_bf16_f32 v52, v8, v10
v_cvt_pk_bf16_f32 v53, v9, v11
v_mfma_f32_32x32x16_bf16 v[32:47], a[172:175], v[68:71], v[32:47]
v_pk_mul_f32 v[8:9], v[54:55], v[214:215]
v_pk_mul_f32 v[10:11], v[102:103], v[214:215]
v_pk_fma_f32 v[8:9], v[102:103], v[198:199], v[8:9]
v_pk_fma_f32 v[10:11], v[54:55], v[198:199], v[10:11] neg_lo:[0,0,1] neg_hi:[0,0,1]
v_cvt_pk_bf16_f32 v54, v8, v10
v_cvt_pk_bf16_f32 v55, v9, v11
v_mfma_f32_32x32x16_bf16 v[80:95], a[176:179], v[72:75], v[80:95]
v_pk_mul_f32 v[8:9], v[56:57], v[216:217]
v_pk_mul_f32 v[10:11], v[104:105], v[216:217]
v_pk_fma_f32 v[8:9], v[104:105], v[200:201], v[8:9]
v_pk_fma_f32 v[10:11], v[56:57], v[200:201], v[10:11] neg_lo:[0,0,1] neg_hi:[0,0,1]
v_cvt_pk_bf16_f32 v56, v8, v10
v_cvt_pk_bf16_f32 v57, v9, v11
v_mfma_f32_32x32x16_bf16 v[32:47], a[180:183], v[72:75], v[32:47]
v_pk_mul_f32 v[8:9], v[58:59], v[218:219]
v_pk_mul_f32 v[10:11], v[106:107], v[218:219]
v_pk_fma_f32 v[8:9], v[106:107], v[202:203], v[8:9]
v_pk_fma_f32 v[10:11], v[58:59], v[202:203], v[10:11] neg_lo:[0,0,1] neg_hi:[0,0,1]
v_cvt_pk_bf16_f32 v58, v8, v10
v_cvt_pk_bf16_f32 v59, v9, v11
v_mfma_f32_32x32x16_bf16 v[80:95], a[184:187], v[76:79], v[80:95]
v_pk_mul_f32 v[8:9], v[60:61], v[220:221]
v_pk_mul_f32 v[10:11], v[108:109], v[220:221]
v_pk_fma_f32 v[8:9], v[108:109], v[204:205], v[8:9]
v_pk_fma_f32 v[10:11], v[60:61], v[204:205], v[10:11] neg_lo:[0,0,1] neg_hi:[0,0,1]
v_cvt_pk_bf16_f32 v60, v8, v10
v_cvt_pk_bf16_f32 v61, v9, v11
v_mfma_f32_32x32x16_bf16 v[32:47], a[188:191], v[76:79], v[32:47]
v_pk_mul_f32 v[8:9], v[62:63], v[222:223]
v_pk_mul_f32 v[10:11], v[110:111], v[222:223]
v_pk_fma_f32 v[8:9], v[110:111], v[206:207], v[8:9]
v_pk_fma_f32 v[10:11], v[62:63], v[206:207], v[10:11] neg_lo:[0,0,1] neg_hi:[0,0,1]
v_cvt_pk_bf16_f32 v62, v8, v10
v_cvt_pk_bf16_f32 v63, v9, v11
v_mfma_f32_32x32x16_bf16 v[96:111], v[48:51], a[160:163], 0
v_pk_mul_f32 v[8:9], v[80:81], v[240:241]
s_nop 2
v_pk_mul_f32 v[10:11], v[32:33], v[240:241]
v_pk_fma_f32 v[8:9], v[32:33], v[224:225], v[8:9]
v_pk_fma_f32 v[10:11], v[80:81], v[224:225], v[10:11] neg_lo:[0,0,1] neg_hi:[0,0,1]
v_cvt_pk_bf16_f32 v80, v8, v10
v_cvt_pk_bf16_f32 v81, v9, v11
v_mfma_f32_32x32x16_bf16 v[64:79], v[48:51], a[164:167], 0
v_pk_mul_f32 v[8:9], v[82:83], v[242:243]
v_pk_mul_f32 v[10:11], v[34:35], v[242:243]
v_pk_fma_f32 v[8:9], v[34:35], v[226:227], v[8:9]
v_pk_fma_f32 v[10:11], v[82:83], v[226:227], v[10:11] neg_lo:[0,0,1] neg_hi:[0,0,1]
v_cvt_pk_bf16_f32 v82, v8, v10
v_cvt_pk_bf16_f32 v83, v9, v11
v_mfma_f32_32x32x16_bf16 v[96:111], v[52:55], a[168:171], v[96:111]
v_pk_mul_f32 v[8:9], v[84:85], v[244:245]
v_pk_mul_f32 v[10:11], v[36:37], v[244:245]
v_pk_fma_f32 v[8:9], v[36:37], v[228:229], v[8:9]
v_pk_fma_f32 v[10:11], v[84:85], v[228:229], v[10:11] neg_lo:[0,0,1] neg_hi:[0,0,1]
v_cvt_pk_bf16_f32 v84, v8, v10
v_cvt_pk_bf16_f32 v85, v9, v11
v_mfma_f32_32x32x16_bf16 v[64:79], v[52:55], a[172:175], v[64:79]
v_pk_mul_f32 v[8:9], v[86:87], v[246:247]
v_pk_mul_f32 v[10:11], v[38:39], v[246:247]
v_pk_fma_f32 v[8:9], v[38:39], v[230:231], v[8:9]
v_pk_fma_f32 v[10:11], v[86:87], v[230:231], v[10:11] neg_lo:[0,0,1] neg_hi:[0,0,1]
v_cvt_pk_bf16_f32 v86, v8, v10
v_cvt_pk_bf16_f32 v87, v9, v11
v_mfma_f32_32x32x16_bf16 v[96:111], v[56:59], a[176:179], v[96:111]
v_pk_mul_f32 v[8:9], v[88:89], v[248:249]
v_pk_mul_f32 v[10:11], v[40:41], v[248:249]
v_pk_fma_f32 v[8:9], v[40:41], v[232:233], v[8:9]
v_pk_fma_f32 v[10:11], v[88:89], v[232:233], v[10:11] neg_lo:[0,0,1] neg_hi:[0,0,1]
v_cvt_pk_bf16_f32 v88, v8, v10
v_cvt_pk_bf16_f32 v89, v9, v11
v_mfma_f32_32x32x16_bf16 v[64:79], v[56:59], a[180:183], v[64:79]
v_pk_mul_f32 v[8:9], v[90:91], v[250:251]
v_pk_mul_f32 v[10:11], v[42:43], v[250:251]
v_pk_fma_f32 v[8:9], v[42:43], v[234:235], v[8:9]
v_pk_fma_f32 v[10:11], v[90:91], v[234:235], v[10:11] neg_lo:[0,0,1] neg_hi:[0,0,1]
v_cvt_pk_bf16_f32 v90, v8, v10
v_cvt_pk_bf16_f32 v91, v9, v11
v_mfma_f32_32x32x16_bf16 v[96:111], v[60:63], a[184:187], v[96:111]
v_pk_mul_f32 v[8:9], v[92:93], v[252:253]
v_pk_mul_f32 v[10:11], v[44:45], v[252:253]
v_pk_fma_f32 v[8:9], v[44:45], v[236:237], v[8:9]
v_pk_fma_f32 v[10:11], v[92:93], v[236:237], v[10:11] neg_lo:[0,0,1] neg_hi:[0,0,1]
v_cvt_pk_bf16_f32 v92, v8, v10
v_cvt_pk_bf16_f32 v93, v9, v11
v_mfma_f32_32x32x16_bf16 v[64:79], v[60:63], a[188:191], v[64:79]
v_pk_mul_f32 v[8:9], v[94:95], v[254:255]
v_pk_mul_f32 v[10:11], v[46:47], v[254:255]
v_pk_fma_f32 v[8:9], v[46:47], v[238:239], v[8:9]
v_pk_fma_f32 v[10:11], v[94:95], v[238:239], v[10:11] neg_lo:[0,0,1] neg_hi:[0,0,1]
v_cvt_pk_bf16_f32 v94, v8, v10
v_cvt_pk_bf16_f32 v95, v9, v11
v_mfma_f32_32x32x16_bf16 v[32:47], v[80:83], a[160:163], 0
s_waitcnt lgkmcnt(3)
v_pk_mul_f32 v[8:9], v[96:97], v[112:113]
s_nop 1
v_pk_mul_f32 v[10:11], v[64:65], v[112:113]
s_waitcnt lgkmcnt(2)
v_pk_fma_f32 v[8:9], v[64:65], v[116:117], v[8:9]
v_pk_fma_f32 v[10:11], v[96:97], v[116:117], v[10:11] neg_lo:[1,0,0] neg_hi:[1,0,0]
v_cvt_pk_bf16_f32 v96, v8, v10
v_cvt_pk_bf16_f32 v97, v9, v11
v_mfma_f32_32x32x16_bf16 v[48:63], v[80:83], a[164:167], 0
v_pk_mul_f32 v[8:9], v[98:99], v[114:115]
v_pk_mul_f32 v[10:11], v[66:67], v[114:115]
v_pk_fma_f32 v[8:9], v[66:67], v[118:119], v[8:9]
v_pk_fma_f32 v[10:11], v[98:99], v[118:119], v[10:11] neg_lo:[1,0,0] neg_hi:[1,0,0]
v_cvt_pk_bf16_f32 v98, v8, v10
v_cvt_pk_bf16_f32 v99, v9, v11
v_mfma_f32_32x32x16_bf16 v[32:47], v[84:87], a[168:171], v[32:47]
ds_read_b128 v[112:115], v0 offset:36864
ds_read_b128 v[116:119], v0 offset:37888
s_waitcnt lgkmcnt(3)
v_pk_mul_f32 v[8:9], v[100:101], v[120:121]
v_pk_mul_f32 v[10:11], v[68:69], v[120:121]
s_waitcnt lgkmcnt(2)
v_pk_fma_f32 v[8:9], v[68:69], v[124:125], v[8:9]
v_pk_fma_f32 v[10:11], v[100:101], v[124:125], v[10:11] neg_lo:[1,0,0] neg_hi:[1,0,0]
v_mfma_f32_32x32x16_bf16 v[48:63], v[84:87], a[172:175], v[48:63]
v_cvt_pk_bf16_f32 v100, v8, v10
v_cvt_pk_bf16_f32 v101, v9, v11
v_pk_mul_f32 v[8:9], v[102:103], v[122:123]
v_pk_mul_f32 v[10:11], v[70:71], v[122:123]
v_pk_fma_f32 v[8:9], v[70:71], v[126:127], v[8:9]
v_pk_fma_f32 v[10:11], v[102:103], v[126:127], v[10:11] neg_lo:[1,0,0] neg_hi:[1,0,0]
v_mfma_f32_32x32x16_bf16 v[32:47], v[88:91], a[176:179], v[32:47]
v_cvt_pk_bf16_f32 v102, v8, v10
v_cvt_pk_bf16_f32 v103, v9, v11
ds_read_b128 v[120:123], v0 offset:38912
ds_read_b128 v[124:127], v0 offset:39936
s_waitcnt lgkmcnt(3)
v_pk_mul_f32 v[8:9], v[104:105], v[112:113]
v_pk_mul_f32 v[10:11], v[72:73], v[112:113]
v_mfma_f32_32x32x16_bf16 v[48:63], v[88:91], a[180:183], v[48:63]
s_waitcnt lgkmcnt(2)
v_pk_fma_f32 v[8:9], v[72:73], v[116:117], v[8:9]
v_pk_fma_f32 v[10:11], v[104:105], v[116:117], v[10:11] neg_lo:[1,0,0] neg_hi:[1,0,0]
v_cvt_pk_bf16_f32 v104, v8, v10
v_cvt_pk_bf16_f32 v105, v9, v11
v_pk_mul_f32 v[8:9], v[106:107], v[114:115]
v_pk_mul_f32 v[10:11], v[74:75], v[114:115]
v_mfma_f32_32x32x16_bf16 v[32:47], v[92:95], a[184:187], v[32:47]
v_pk_fma_f32 v[8:9], v[74:75], v[118:119], v[8:9]
v_pk_fma_f32 v[10:11], v[106:107], v[118:119], v[10:11] neg_lo:[1,0,0] neg_hi:[1,0,0]
v_cvt_pk_bf16_f32 v106, v8, v10
v_cvt_pk_bf16_f32 v107, v9, v11
ds_read_b128 v[112:115], v0 offset:49152
ds_read_b128 v[116:119], v0 offset:50176
v_mfma_f32_32x32x16_bf16 v[48:63], v[92:95], a[188:191], v[48:63]
s_waitcnt lgkmcnt(3)
v_pk_mul_f32 v[8:9], v[108:109], v[120:121]
v_pk_mul_f32 v[10:11], v[76:77], v[120:121]
s_waitcnt lgkmcnt(2)
v_pk_fma_f32 v[8:9], v[76:77], v[124:125], v[8:9]
v_pk_fma_f32 v[10:11], v[108:109], v[124:125], v[10:11] neg_lo:[1,0,0] neg_hi:[1,0,0]
v_cvt_pk_bf16_f32 v108, v8, v10
v_cvt_pk_bf16_f32 v109, v9, v11
v_pk_mul_f32 v[8:9], v[110:111], v[122:123]
v_pk_mul_f32 v[10:11], v[78:79], v[122:123]
v_pk_fma_f32 v[8:9], v[78:79], v[126:127], v[8:9]
v_pk_fma_f32 v[10:11], v[110:111], v[126:127], v[10:11] neg_lo:[1,0,0] neg_hi:[1,0,0]
v_cvt_pk_bf16_f32 v110, v8, v10
v_cvt_pk_bf16_f32 v111, v9, v11
ds_read_b128 v[120:123], v0 offset:51200
ds_read_b128 v[124:127], v0 offset:52224
ds_read_b128 v[80:83], v26 offset:0
ds_read_b128 v[84:87], v0 offset:1024
ds_read_b128 v[88:91], v26 offset:2048
ds_read_b128 v[92:95], v0 offset:3072
ds_read_b128 v[64:67], v26 offset:4096
ds_read_b128 v[68:71], v0 offset:5120
s_lshl_b32 s52, s3, 10
v_add_u32 v20, s52, v0
v_add_u32 v20, 65536, v20
s_waitcnt lgkmcnt(5)
v_mfma_f32_32x32x16_bf16 v[128:143], v[80:83], v[96:99], v[128:143]
ds_read_b128 v[72:75], v26 offset:6144
v_pk_mul_f32 v[8:9], v[32:33], v[112:113]
v_pk_mul_f32 v[10:11], v[48:49], v[112:113]
v_pk_fma_f32 v[8:9], v[48:49], v[116:117], v[8:9]
v_pk_fma_f32 v[10:11], v[32:33], v[116:117], v[10:11] neg_lo:[1,0,0] neg_hi:[1,0,0]
v_cvt_pk_bf16_f32 v32, v8, v10
v_cvt_pk_bf16_f32 v33, v9, v11
s_waitcnt lgkmcnt(5)
v_mfma_f32_32x32x16_bf16 v[144:159], v[84:87], v[96:99], v[144:159]
ds_read_b128 v[76:79], v0 offset:7168
v_pk_mul_f32 v[8:9], v[34:35], v[114:115]
v_pk_mul_f32 v[10:11], v[50:51], v[114:115]
v_pk_fma_f32 v[8:9], v[50:51], v[118:119], v[8:9]
v_pk_fma_f32 v[10:11], v[34:35], v[118:119], v[10:11] neg_lo:[1,0,0] neg_hi:[1,0,0]
v_cvt_pk_bf16_f32 v34, v8, v10
v_cvt_pk_bf16_f32 v35, v9, v11
s_waitcnt lgkmcnt(5)
v_mfma_f32_32x32x16_bf16 v[160:175], v[88:91], v[96:99], v[160:175]
ds_read_b128 v[80:83], v26 offset:8192
ds_read_b128 v[112:115], v0 offset:53248
ds_read_b128 v[116:119], v0 offset:54272
v_pk_mul_f32 v[8:9], v[36:37], v[120:121]
v_pk_mul_f32 v[10:11], v[52:53], v[120:121]
v_pk_fma_f32 v[8:9], v[52:53], v[124:125], v[8:9]
v_pk_fma_f32 v[10:11], v[36:37], v[124:125], v[10:11] neg_lo:[1,0,0] neg_hi:[1,0,0]
s_waitcnt lgkmcnt(7)
v_mfma_f32_32x32x16_bf16 v[176:191], v[92:95], v[96:99], v[176:191]
ds_read_b128 v[84:87], v0 offset:9216
v_cvt_pk_bf16_f32 v36, v8, v10
v_cvt_pk_bf16_f32 v37, v9, v11
v_pk_mul_f32 v[8:9], v[38:39], v[122:123]
v_pk_mul_f32 v[10:11], v[54:55], v[122:123]
v_pk_fma_f32 v[8:9], v[54:55], v[126:127], v[8:9]
v_pk_fma_f32 v[10:11], v[38:39], v[126:127], v[10:11] neg_lo:[1,0,0] neg_hi:[1,0,0]
s_waitcnt lgkmcnt(7)
v_mfma_f32_32x32x16_bf16 v[128:143], v[64:67], v[100:103], v[128:143]
ds_read_b128 v[88:91], v26 offset:10240
v_cvt_pk_bf16_f32 v38, v8, v10
v_cvt_pk_bf16_f32 v39, v9, v11
ds_read_b128 v[120:123], v0 offset:55296
ds_read_b128 v[124:127], v0 offset:56320
s_waitcnt lgkmcnt(5)
v_pk_mul_f32 v[8:9], v[40:41], v[112:113]
v_pk_mul_f32 v[10:11], v[56:57], v[112:113]
v_mfma_f32_32x32x16_bf16 v[144:159], v[68:71], v[100:103], v[144:159]
ds_read_b128 v[92:95], v0 offset:11264
s_waitcnt lgkmcnt(5)
v_pk_fma_f32 v[8:9], v[56:57], v[116:117], v[8:9]
v_pk_fma_f32 v[10:11], v[40:41], v[116:117], v[10:11] neg_lo:[1,0,0] neg_hi:[1,0,0]
v_cvt_pk_bf16_f32 v40, v8, v10
v_cvt_pk_bf16_f32 v41, v9, v11
v_pk_mul_f32 v[8:9], v[42:43], v[114:115]
v_pk_mul_f32 v[10:11], v[58:59], v[114:115]
v_mfma_f32_32x32x16_bf16 v[160:175], v[72:75], v[100:103], v[160:175]
ds_read_b128 v[64:67], v26 offset:12288
v_pk_fma_f32 v[8:9], v[58:59], v[118:119], v[8:9]
v_pk_fma_f32 v[10:11], v[42:43], v[118:119], v[10:11] neg_lo:[1,0,0] neg_hi:[1,0,0]
v_cvt_pk_bf16_f32 v42, v8, v10
v_cvt_pk_bf16_f32 v43, v9, v11
s_waitcnt lgkmcnt(3)
v_pk_mul_f32 v[8:9], v[44:45], v[120:121]
v_pk_mul_f32 v[10:11], v[60:61], v[120:121]
v_mfma_f32_32x32x16_bf16 v[176:191], v[76:79], v[100:103], v[176:191]
ds_read_b128 v[68:71], v0 offset:13312
s_waitcnt lgkmcnt(3)
v_pk_fma_f32 v[8:9], v[60:61], v[124:125], v[8:9]
v_pk_fma_f32 v[10:11], v[44:45], v[124:125], v[10:11] neg_lo:[1,0,0] neg_hi:[1,0,0]
v_cvt_pk_bf16_f32 v44, v8, v10
v_cvt_pk_bf16_f32 v45, v9, v11
v_pk_mul_f32 v[8:9], v[46:47], v[122:123]
v_pk_mul_f32 v[10:11], v[62:63], v[122:123]
v_mfma_f32_32x32x16_bf16 v[128:143], v[80:83], v[104:107], v[128:143]
ds_read_b128 v[72:75], v26 offset:14336
v_pk_fma_f32 v[8:9], v[62:63], v[126:127], v[8:9]
v_pk_fma_f32 v[10:11], v[46:47], v[126:127], v[10:11] neg_lo:[1,0,0] neg_hi:[1,0,0]
v_cvt_pk_bf16_f32 v46, v8, v10
v_cvt_pk_bf16_f32 v47, v9, v11
v_mfma_f32_32x32x16_bf16 v[144:159], v[84:87], v[104:107], v[144:159]
ds_read_b128 v[76:79], v0 offset:15360
v_mfma_f32_32x32x16_bf16 v[160:175], v[88:91], v[104:107], v[160:175]
ds_read_b128 v[80:83], v26 offset:16384
s_waitcnt lgkmcnt(5)
v_mfma_f32_32x32x16_bf16 v[176:191], v[92:95], v[104:107], v[176:191]
ds_read_b128 v[84:87], v0 offset:17408
s_waitcnt lgkmcnt(5)
v_mfma_f32_32x32x16_bf16 v[128:143], v[64:67], v[108:111], v[128:143]
ds_read_b128 v[88:91], v26 offset:20480
s_waitcnt lgkmcnt(5)
v_mfma_f32_32x32x16_bf16 v[144:159], v[68:71], v[108:111], v[144:159]
ds_read_b128 v[92:95], v0 offset:21504
s_waitcnt lgkmcnt(5)
v_mfma_f32_32x32x16_bf16 v[160:175], v[72:75], v[108:111], v[160:175]
ds_read_b128 v[64:67], v26 offset:24576
s_waitcnt lgkmcnt(5)
v_mfma_f32_32x32x16_bf16 v[176:191], v[76:79], v[108:111], v[176:191]
ds_read_b128 v[68:71], v0 offset:25600
s_waitcnt lgkmcnt(5)
v_mfma_f32_32x32x16_bf16 v[128:143], v[80:83], v[32:35], v[128:143]
ds_read_b128 v[72:75], v26 offset:28672
s_waitcnt lgkmcnt(5)
v_mfma_f32_32x32x16_bf16 v[144:159], v[84:87], v[32:35], v[144:159]
ds_read_b128 v[76:79], v0 offset:29696
s_waitcnt lgkmcnt(5)
v_mfma_f32_32x32x16_bf16 v[128:143], v[88:91], v[36:39], v[128:143]
ds_read_b128 v[80:83], v26 offset:18432
s_waitcnt lgkmcnt(5)
v_mfma_f32_32x32x16_bf16 v[144:159], v[92:95], v[36:39], v[144:159]
ds_read_b128 v[84:87], v0 offset:19456
s_waitcnt lgkmcnt(5)
v_mfma_f32_32x32x16_bf16 v[128:143], v[64:67], v[40:43], v[128:143]
ds_read_b128 v[88:91], v26 offset:22528
s_waitcnt lgkmcnt(5)
v_mfma_f32_32x32x16_bf16 v[144:159], v[68:71], v[40:43], v[144:159]
ds_read_b128 v[92:95], v0 offset:23552
s_waitcnt lgkmcnt(5)
v_mfma_f32_32x32x16_bf16 v[128:143], v[72:75], v[44:47], v[128:143]
ds_read_b128 v[64:67], v26 offset:26624
s_waitcnt lgkmcnt(5)
v_mfma_f32_32x32x16_bf16 v[144:159], v[76:79], v[44:47], v[144:159]
ds_read_b128 v[68:71], v0 offset:27648
s_waitcnt lgkmcnt(5)
v_mfma_f32_32x32x16_bf16 v[160:175], v[80:83], v[32:35], v[160:175]
ds_read_b128 v[72:75], v26 offset:30720
s_waitcnt lgkmcnt(5)
v_mfma_f32_32x32x16_bf16 v[176:191], v[84:87], v[32:35], v[176:191]
ds_read_b128 v[76:79], v0 offset:31744
v_cvt_pk_bf16_f32 v128, v144, v128
v_cvt_pk_bf16_f32 v129, v145, v129
v_cvt_pk_bf16_f32 v130, v146, v130
v_cvt_pk_bf16_f32 v131, v147, v131
ds_write_b128 v20, v[128:131] offset:0
v_cvt_pk_bf16_f32 v132, v148, v132
s_waitcnt lgkmcnt(6)
v_mfma_f32_32x32x16_bf16 v[160:175], v[88:91], v[36:39], v[160:175]
v_cvt_pk_bf16_f32 v133, v149, v133
v_cvt_pk_bf16_f32 v134, v150, v134
v_cvt_pk_bf16_f32 v135, v151, v135
ds_write_b128 v20, v[132:135] offset:4096
v_cvt_pk_bf16_f32 v136, v152, v136
v_cvt_pk_bf16_f32 v137, v153, v137
s_waitcnt lgkmcnt(6)
v_mfma_f32_32x32x16_bf16 v[176:191], v[92:95], v[36:39], v[176:191]
v_cvt_pk_bf16_f32 v138, v154, v138
v_cvt_pk_bf16_f32 v139, v155, v139
ds_write_b128 v20, v[136:139] offset:8192
v_cvt_pk_bf16_f32 v140, v156, v140
v_cvt_pk_bf16_f32 v141, v157, v141
v_cvt_pk_bf16_f32 v142, v158, v142
s_waitcnt lgkmcnt(6)
v_mfma_f32_32x32x16_bf16 v[160:175], v[64:67], v[40:43], v[160:175]
v_cvt_pk_bf16_f32 v143, v159, v143
ds_write_b128 v20, v[140:143] offset:12288
s_waitcnt lgkmcnt(6)
v_mfma_f32_32x32x16_bf16 v[176:191], v[68:71], v[40:43], v[176:191]
s_waitcnt lgkmcnt(5)
v_mfma_f32_32x32x16_bf16 v[160:175], v[72:75], v[44:47], v[160:175]
s_waitcnt lgkmcnt(4)
v_mfma_f32_32x32x16_bf16 v[176:191], v[76:79], v[44:47], v[176:191]
s_nop 11
v_cvt_pk_bf16_f32 v160, v176, v160
v_cvt_pk_bf16_f32 v161, v177, v161
v_cvt_pk_bf16_f32 v162, v178, v162
v_cvt_pk_bf16_f32 v163, v179, v163
ds_write_b128 v20, v[160:163] offset:16384
v_cvt_pk_bf16_f32 v164, v180, v164
v_cvt_pk_bf16_f32 v165, v181, v165
v_cvt_pk_bf16_f32 v166, v182, v166
v_cvt_pk_bf16_f32 v167, v183, v167
ds_write_b128 v20, v[164:167] offset:20480
v_cvt_pk_bf16_f32 v168, v184, v168
v_cvt_pk_bf16_f32 v169, v185, v169
v_cvt_pk_bf16_f32 v170, v186, v170
v_cvt_pk_bf16_f32 v171, v187, v171
ds_write_b128 v20, v[168:171] offset:24576
v_cvt_pk_bf16_f32 v172, v188, v172
v_cvt_pk_bf16_f32 v173, v189, v173
v_cvt_pk_bf16_f32 v174, v190, v174
v_cvt_pk_bf16_f32 v175, v191, v175
ds_write_b128 v20, v[172:175] offset:28672
s_lshl_b32 s52, s3, 12
s_add_u32 s52, s52, 65536
v_add_u32 v20, s52, v0
s_waitcnt lgkmcnt(0)
s_barrier
ds_read_b128 v[32:35], v20 offset:0
ds_read_b128 v[36:39], v20 offset:1024
ds_read_b128 v[40:43], v20 offset:2048
ds_read_b128 v[44:47], v20 offset:3072
ds_read_b128 v[48:51], v20 offset:16384
ds_read_b128 v[52:55], v20 offset:17408
ds_read_b128 v[56:59], v20 offset:18432
ds_read_b128 v[60:63], v20 offset:19456
s_waitcnt lgkmcnt(6)
v_swap_b32 v33, v36
s_waitcnt lgkmcnt(5)
v_swap_b32 v34, v40
s_waitcnt lgkmcnt(4)
v_swap_b32 v35, v44
buffer_store_dwordx4 v[32:35], v25, s[4:7], s48 offen sc1
s_add_u32 s48, s48, 40960
v_swap_b32 v38, v41
v_swap_b32 v39, v45
buffer_store_dwordx4 v[36:39], v25, s[4:7], s48 offen sc1
s_add_u32 s48, s48, 40960
v_swap_b32 v43, v46
buffer_store_dwordx4 v[40:43], v25, s[4:7], s48 offen sc1
s_add_u32 s48, s48, 40960
buffer_store_dwordx4 v[44:47], v25, s[4:7], s48 offen sc1
s_add_u32 s48, s48, 1187840
s_waitcnt lgkmcnt(2)
v_swap_b32 v49, v52
s_waitcnt lgkmcnt(1)
v_swap_b32 v50, v56
s_waitcnt lgkmcnt(0)
v_swap_b32 v51, v60
buffer_store_dwordx4 v[48:51], v25, s[4:7], s48 offen sc1
s_add_u32 s48, s48, 40960
v_swap_b32 v54, v57
v_swap_b32 v55, v61
buffer_store_dwordx4 v[52:55], v25, s[4:7], s48 offen sc1
s_add_u32 s48, s48, 40960
v_swap_b32 v59, v62
buffer_store_dwordx4 v[56:59], v25, s[4:7], s48 offen sc1
s_add_u32 s48, s48, 40960
buffer_store_dwordx4 v[60:63], v25, s[4:7], s48 offen sc1
s_add_u32 s48, s48, 1187840
s_lshl_b32 s54, s51, 13
s_lshl_b32 s52, s30, 6
s_add_u32 s54, s54, s52
s_add_u32 s54, s54, 222306304
s_waitcnt vmcnt(0)
s_barrier
s_cmp_lg_u32 s3, 0
s_cbranch_scc1 k_s8_97
s_mov_b64 exec, 1
v_mov_b32 v8, 1
buffer_store_dword v8, off, s[4:7], s54 sc1
s_mov_b64 exec, -1
k_s8_97:
k_fend_45:
s_add_u32 s51, s51, 1
s_cmp_lt_u32 s51, 2
s_cbranch_scc1 k_lay_32
s_add_u32 s30, s30, 64
s_cmp_ge_u32 s30, 144
s_cbranch_scc1 k_fin_7
s_endpgm
k_o_4:
s_load_dwordx2 s[36:37], s[0:1], 0
s_mov_b32 s38, 2621440
s_mov_b32 s39, 0x20000
s_mul_i32 s57, s30, 52429
s_lshr_b32 s57, s57, 18
s_mul_i32 s52, s57, 5
s_sub_u32 s58, s30, s52
s_lshl_b32 s58, s58, 2
s_add_u32 s58, s58, s3
s_mul_i32 s52, s30, 40960
s_mul_i32 s53, s3, 320
s_add_u32 s53, s53, s52
v_bfe_u32 v8, v0, 4, 5
v_mul_u32_u24 v9, 1280, v8
v_lshrrev_b32 v10, 9, v0
v_lshl_add_u32 v9, v10, 4, v9
v_add_u32 v9, s53, v9
s_mul_i32 s56, s3, 10240
s_add_u32 s56, s56, s52
s_add_u32 s56, s56, 83886080
s_waitcnt lgkmcnt(0)
buffer_load_dwordx4 v[100:103], v9, s[36:39], 0 offen offset:0
buffer_load_dwordx4 v[104:107], v9, s[36:39], 0 offen offset:32
buffer_load_dwordx4 v[108:111], v9, s[36:39], 0 offen offset:64
buffer_load_dwordx4 v[112:115], v9, s[36:39], 0 offen offset:96
buffer_load_dwordx4 v[116:119], v9, s[36:39], 0 offen offset:128
buffer_load_dwordx4 v[120:123], v9, s[36:39], 0 offen offset:160
buffer_load_dwordx4 v[124:127], v9, s[36:39], 0 offen offset:192
buffer_load_dwordx4 v[128:131], v9, s[36:39], 0 offen offset:224
buffer_load_dwordx4 v[132:135], v9, s[36:39], 0 offen offset:256
buffer_load_dwordx4 v[136:139], v9, s[36:39], 0 offen offset:288
v_mov_b64 v[4:5], -1
v_mov_b64 v[6:7], -1
s_lshl_b32 s52, s30, 2
s_add_u32 s52, s52, s3
s_lshl_b32 s53, s52, 13
s_lshl_b32 s52, s52, 9
v_lshrrev_b32 v2, 1, v0
s_add_u32 s54, s52, 211812352
buffer_store_dwordx2 v[4:5], v2, s[4:7], s54 offen sc1
s_add_u32 s54, s53, 205520896
buffer_store_dwordx4 v[4:7], v0, s[4:7], s54 offen offset:0 sc1
buffer_store_dwordx4 v[4:7], v0, s[4:7], s54 offen offset:1024 sc1
buffer_store_dwordx4 v[4:7], v0, s[4:7], s54 offen offset:2048 sc1
buffer_store_dwordx4 v[4:7], v0, s[4:7], s54 offen offset:3072 sc1
s_add_u32 s54, s53, 205524992
buffer_store_dwordx4 v[4:7], v0, s[4:7], s54 offen offset:0 sc1
buffer_store_dwordx4 v[4:7], v0, s[4:7], s54 offen offset:1024 sc1
buffer_store_dwordx4 v[4:7], v0, s[4:7], s54 offen offset:2048 sc1
buffer_store_dwordx4 v[4:7], v0, s[4:7], s54 offen offset:3072 sc1
s_add_u32 s54, s52, 212860928
buffer_store_dwordx2 v[4:5], v2, s[4:7], s54 offen sc1
s_add_u32 s54, s53, 208666624
buffer_store_dwordx4 v[4:7], v0, s[4:7], s54 offen offset:0 sc1
buffer_store_dwordx4 v[4:7], v0, s[4:7], s54 offen offset:1024 sc1
buffer_store_dwordx4 v[4:7], v0, s[4:7], s54 offen offset:2048 sc1
buffer_store_dwordx4 v[4:7], v0, s[4:7], s54 offen offset:3072 sc1
s_add_u32 s54, s53, 208670720
buffer_store_dwordx4 v[4:7], v0, s[4:7], s54 offen offset:0 sc1
buffer_store_dwordx4 v[4:7], v0, s[4:7], s54 offen offset:1024 sc1
buffer_store_dwordx4 v[4:7], v0, s[4:7], s54 offen offset:2048 sc1
buffer_store_dwordx4 v[4:7], v0, s[4:7], s54 offen offset:3072 sc1
v_mov_b32 v11, 0x3f803f80
v_mov_b32 v12, 0
v_lshlrev_b32 v8, 5, v8
s_lshl_b32 s52, s3, 3
v_lshl_add_u32 v10, v10, 2, v8
v_add_u32 v10, s52, v10
s_waitcnt vmcnt(27)
v_dot2c_f32_bf16 v12, v100, v11
v_dot2c_f32_bf16 v12, v101, v11
v_dot2c_f32_bf16 v12, v102, v11
v_dot2c_f32_bf16 v12, v103, v11
s_waitcnt vmcnt(26)
v_dot2c_f32_bf16 v12, v104, v11
v_dot2c_f32_bf16 v12, v105, v11
v_dot2c_f32_bf16 v12, v106, v11
v_dot2c_f32_bf16 v12, v107, v11
s_waitcnt vmcnt(25)
v_dot2c_f32_bf16 v12, v108, v11
v_dot2c_f32_bf16 v12, v109, v11
v_dot2c_f32_bf16 v12, v110, v11
v_dot2c_f32_bf16 v12, v111, v11
s_waitcnt vmcnt(24)
v_dot2c_f32_bf16 v12, v112, v11
v_dot2c_f32_bf16 v12, v113, v11
v_dot2c_f32_bf16 v12, v114, v11
v_dot2c_f32_bf16 v12, v115, v11
s_waitcnt vmcnt(23)
v_dot2c_f32_bf16 v12, v116, v11
v_dot2c_f32_bf16 v12, v117, v11
v_dot2c_f32_bf16 v12, v118, v11
v_dot2c_f32_bf16 v12, v119, v11
s_waitcnt vmcnt(22)
v_dot2c_f32_bf16 v12, v120, v11
v_dot2c_f32_bf16 v12, v121, v11
v_dot2c_f32_bf16 v12, v122, v11
v_dot2c_f32_bf16 v12, v123, v11
s_waitcnt vmcnt(21)
v_dot2c_f32_bf16 v12, v124, v11
v_dot2c_f32_bf16 v12, v125, v11
v_dot2c_f32_bf16 v12, v126, v11
v_dot2c_f32_bf16 v12, v127, v11
s_waitcnt vmcnt(20)
v_dot2c_f32_bf16 v12, v128, v11
v_dot2c_f32_bf16 v12, v129, v11
v_dot2c_f32_bf16 v12, v130, v11
v_dot2c_f32_bf16 v12, v131, v11
s_waitcnt vmcnt(19)
v_dot2c_f32_bf16 v12, v132, v11
v_dot2c_f32_bf16 v12, v133, v11
v_dot2c_f32_bf16 v12, v134, v11
v_dot2c_f32_bf16 v12, v135, v11
s_waitcnt vmcnt(18)
v_dot2c_f32_bf16 v12, v136, v11
v_dot2c_f32_bf16 v12, v137, v11
v_dot2c_f32_bf16 v12, v138, v11
v_dot2c_f32_bf16 v12, v139, v11
s_nop 2
ds_write_b32 v10, v12
s_waitcnt lgkmcnt(0)
s_barrier
ds_read_b128 v[12:15], v8
ds_read_b128 v[16:19], v8 offset:16
s_waitcnt lgkmcnt(1)
v_add_f32 v12, v12, v13
v_add_f32 v12, v12, v14
v_add_f32 v12, v12, v15
s_waitcnt lgkmcnt(0)
v_add_f32 v12, v12, v16
v_add_f32 v12, v12, v17
v_add_f32 v12, v12, v18
v_add_f32 v12, v12, v19
v_mul_f32 v12, 0x3acccccd, v12
v_lshlrev_b32 v14, 16, v100
v_and_b32 v15, 0xffff0000, v100
v_sub_f32 v14, v14, v12
v_sub_f32 v15, v15, v12
v_cvt_pk_bf16_f32 v100, v14, v15
v_lshlrev_b32 v14, 16, v101
v_and_b32 v15, 0xffff0000, v101
v_sub_f32 v14, v14, v12
v_sub_f32 v15, v15, v12
v_cvt_pk_bf16_f32 v101, v14, v15
v_lshlrev_b32 v14, 16, v102
v_and_b32 v15, 0xffff0000, v102
v_sub_f32 v14, v14, v12
v_sub_f32 v15, v15, v12
v_cvt_pk_bf16_f32 v102, v14, v15
v_lshlrev_b32 v14, 16, v103
v_and_b32 v15, 0xffff0000, v103
v_sub_f32 v14, v14, v12
v_sub_f32 v15, v15, v12
v_cvt_pk_bf16_f32 v103, v14, v15
buffer_store_dwordx4 v[100:103], v0, s[4:7], s56 offen offset:0 sc1
v_lshlrev_b32 v14, 16, v104
v_and_b32 v15, 0xffff0000, v104
v_sub_f32 v14, v14, v12
v_sub_f32 v15, v15, v12
v_cvt_pk_bf16_f32 v104, v14, v15
v_lshlrev_b32 v14, 16, v105
v_and_b32 v15, 0xffff0000, v105
v_sub_f32 v14, v14, v12
v_sub_f32 v15, v15, v12
v_cvt_pk_bf16_f32 v105, v14, v15
v_lshlrev_b32 v14, 16, v106
v_and_b32 v15, 0xffff0000, v106
v_sub_f32 v14, v14, v12
v_sub_f32 v15, v15, v12
v_cvt_pk_bf16_f32 v106, v14, v15
v_lshlrev_b32 v14, 16, v107
v_and_b32 v15, 0xffff0000, v107
v_sub_f32 v14, v14, v12
v_sub_f32 v15, v15, v12
v_cvt_pk_bf16_f32 v107, v14, v15
buffer_store_dwordx4 v[104:107], v0, s[4:7], s56 offen offset:1024 sc1
v_lshlrev_b32 v14, 16, v108
v_and_b32 v15, 0xffff0000, v108
v_sub_f32 v14, v14, v12
v_sub_f32 v15, v15, v12
v_cvt_pk_bf16_f32 v108, v14, v15
v_lshlrev_b32 v14, 16, v109
v_and_b32 v15, 0xffff0000, v109
v_sub_f32 v14, v14, v12
v_sub_f32 v15, v15, v12
v_cvt_pk_bf16_f32 v109, v14, v15
v_lshlrev_b32 v14, 16, v110
v_and_b32 v15, 0xffff0000, v110
v_sub_f32 v14, v14, v12
v_sub_f32 v15, v15, v12
v_cvt_pk_bf16_f32 v110, v14, v15
v_lshlrev_b32 v14, 16, v111
v_and_b32 v15, 0xffff0000, v111
v_sub_f32 v14, v14, v12
v_sub_f32 v15, v15, v12
v_cvt_pk_bf16_f32 v111, v14, v15
buffer_store_dwordx4 v[108:111], v0, s[4:7], s56 offen offset:2048 sc1
v_lshlrev_b32 v14, 16, v112
v_and_b32 v15, 0xffff0000, v112
v_sub_f32 v14, v14, v12
v_sub_f32 v15, v15, v12
v_cvt_pk_bf16_f32 v112, v14, v15
v_lshlrev_b32 v14, 16, v113
v_and_b32 v15, 0xffff0000, v113
v_sub_f32 v14, v14, v12
v_sub_f32 v15, v15, v12
v_cvt_pk_bf16_f32 v113, v14, v15
v_lshlrev_b32 v14, 16, v114
v_and_b32 v15, 0xffff0000, v114
v_sub_f32 v14, v14, v12
v_sub_f32 v15, v15, v12
v_cvt_pk_bf16_f32 v114, v14, v15
v_lshlrev_b32 v14, 16, v115
v_and_b32 v15, 0xffff0000, v115
v_sub_f32 v14, v14, v12
v_sub_f32 v15, v15, v12
v_cvt_pk_bf16_f32 v115, v14, v15
buffer_store_dwordx4 v[112:115], v0, s[4:7], s56 offen offset:3072 sc1
s_add_u32 s56, s56, 4096
v_lshlrev_b32 v14, 16, v116
v_and_b32 v15, 0xffff0000, v116
v_sub_f32 v14, v14, v12
v_sub_f32 v15, v15, v12
v_cvt_pk_bf16_f32 v116, v14, v15
v_lshlrev_b32 v14, 16, v117
v_and_b32 v15, 0xffff0000, v117
v_sub_f32 v14, v14, v12
v_sub_f32 v15, v15, v12
v_cvt_pk_bf16_f32 v117, v14, v15
v_lshlrev_b32 v14, 16, v118
v_and_b32 v15, 0xffff0000, v118
v_sub_f32 v14, v14, v12
v_sub_f32 v15, v15, v12
v_cvt_pk_bf16_f32 v118, v14, v15
v_lshlrev_b32 v14, 16, v119
v_and_b32 v15, 0xffff0000, v119
v_sub_f32 v14, v14, v12
v_sub_f32 v15, v15, v12
v_cvt_pk_bf16_f32 v119, v14, v15
buffer_store_dwordx4 v[116:119], v0, s[4:7], s56 offen offset:0 sc1
v_lshlrev_b32 v14, 16, v120
v_and_b32 v15, 0xffff0000, v120
v_sub_f32 v14, v14, v12
v_sub_f32 v15, v15, v12
v_cvt_pk_bf16_f32 v120, v14, v15
v_lshlrev_b32 v14, 16, v121
v_and_b32 v15, 0xffff0000, v121
v_sub_f32 v14, v14, v12
v_sub_f32 v15, v15, v12
v_cvt_pk_bf16_f32 v121, v14, v15
v_lshlrev_b32 v14, 16, v122
v_and_b32 v15, 0xffff0000, v122
v_sub_f32 v14, v14, v12
v_sub_f32 v15, v15, v12
v_cvt_pk_bf16_f32 v122, v14, v15
v_lshlrev_b32 v14, 16, v123
v_and_b32 v15, 0xffff0000, v123
v_sub_f32 v14, v14, v12
v_sub_f32 v15, v15, v12
v_cvt_pk_bf16_f32 v123, v14, v15
buffer_store_dwordx4 v[120:123], v0, s[4:7], s56 offen offset:1024 sc1
v_lshlrev_b32 v14, 16, v124
v_and_b32 v15, 0xffff0000, v124
v_sub_f32 v14, v14, v12
v_sub_f32 v15, v15, v12
v_cvt_pk_bf16_f32 v124, v14, v15
v_lshlrev_b32 v14, 16, v125
v_and_b32 v15, 0xffff0000, v125
v_sub_f32 v14, v14, v12
v_sub_f32 v15, v15, v12
v_cvt_pk_bf16_f32 v125, v14, v15
v_lshlrev_b32 v14, 16, v126
v_and_b32 v15, 0xffff0000, v126
v_sub_f32 v14, v14, v12
v_sub_f32 v15, v15, v12
v_cvt_pk_bf16_f32 v126, v14, v15
v_lshlrev_b32 v14, 16, v127
v_and_b32 v15, 0xffff0000, v127
v_sub_f32 v14, v14, v12
v_sub_f32 v15, v15, v12
v_cvt_pk_bf16_f32 v127, v14, v15
buffer_store_dwordx4 v[124:127], v0, s[4:7], s56 offen offset:2048 sc1
v_lshlrev_b32 v14, 16, v128
v_and_b32 v15, 0xffff0000, v128
v_sub_f32 v14, v14, v12
v_sub_f32 v15, v15, v12
v_cvt_pk_bf16_f32 v128, v14, v15
v_lshlrev_b32 v14, 16, v129
v_and_b32 v15, 0xffff0000, v129
v_sub_f32 v14, v14, v12
v_sub_f32 v15, v15, v12
v_cvt_pk_bf16_f32 v129, v14, v15
v_lshlrev_b32 v14, 16, v130
v_and_b32 v15, 0xffff0000, v130
v_sub_f32 v14, v14, v12
v_sub_f32 v15, v15, v12
v_cvt_pk_bf16_f32 v130, v14, v15
v_lshlrev_b32 v14, 16, v131
v_and_b32 v15, 0xffff0000, v131
v_sub_f32 v14, v14, v12
v_sub_f32 v15, v15, v12
v_cvt_pk_bf16_f32 v131, v14, v15
buffer_store_dwordx4 v[128:131], v0, s[4:7], s56 offen offset:3072 sc1
s_add_u32 s56, s56, 4096
v_lshlrev_b32 v14, 16, v132
v_and_b32 v15, 0xffff0000, v132
v_sub_f32 v14, v14, v12
v_sub_f32 v15, v15, v12
v_cvt_pk_bf16_f32 v132, v14, v15
v_lshlrev_b32 v14, 16, v133
v_and_b32 v15, 0xffff0000, v133
v_sub_f32 v14, v14, v12
v_sub_f32 v15, v15, v12
v_cvt_pk_bf16_f32 v133, v14, v15
v_lshlrev_b32 v14, 16, v134
v_and_b32 v15, 0xffff0000, v134
v_sub_f32 v14, v14, v12
v_sub_f32 v15, v15, v12
v_cvt_pk_bf16_f32 v134, v14, v15
v_lshlrev_b32 v14, 16, v135
v_and_b32 v15, 0xffff0000, v135
v_sub_f32 v14, v14, v12
v_sub_f32 v15, v15, v12
v_cvt_pk_bf16_f32 v135, v14, v15
buffer_store_dwordx4 v[132:135], v0, s[4:7], s56 offen offset:0 sc1
v_lshlrev_b32 v14, 16, v136
v_and_b32 v15, 0xffff0000, v136
v_sub_f32 v14, v14, v12
v_sub_f32 v15, v15, v12
v_cvt_pk_bf16_f32 v136, v14, v15
v_lshlrev_b32 v14, 16, v137
v_and_b32 v15, 0xffff0000, v137
v_sub_f32 v14, v14, v12
v_sub_f32 v15, v15, v12
v_cvt_pk_bf16_f32 v137, v14, v15
v_lshlrev_b32 v14, 16, v138
v_and_b32 v15, 0xffff0000, v138
v_sub_f32 v14, v14, v12
v_sub_f32 v15, v15, v12
v_cvt_pk_bf16_f32 v138, v14, v15
v_lshlrev_b32 v14, 16, v139
v_and_b32 v15, 0xffff0000, v139
v_sub_f32 v14, v14, v12
v_sub_f32 v15, v15, v12
v_cvt_pk_bf16_f32 v139, v14, v15
buffer_store_dwordx4 v[136:139], v0, s[4:7], s56 offen offset:1024 sc1
s_waitcnt vmcnt(0)
s_barrier
s_cmp_lg_u32 s3, 0
s_cbranch_scc1 k_sd_98
s_mov_b64 exec, 1
v_mov_b32 v2, 64
v_mov_b32 v3, 1
global_atomic_add v2, v3, s[28:29] sc1
s_mov_b64 exec, -1
k_sd_98:
s_mul_i32 s52, s3, 640
v_lshrrev_b32 v8, 4, v0
v_add_u32 v8, s52, v8
s_mov_b32 s53, 52429
v_add_u32 v9, 0, v8
v_mul_u32_u24 v10, s53, v9
v_lshrrev_b32 v10, 22, v10
v_mul_u32_u24 v11, 80, v10
v_sub_u32 v9, v9, v11
v_and_b32 v11, 15, v10
v_xor_b32 v9, v9, v11
v_mul_u32_u24 v10, 1280, v10
v_lshl_add_u32 v72, v9, 4, v10
v_add_u32 v9, 64, v8
v_mul_u32_u24 v10, s53, v9
v_lshrrev_b32 v10, 22, v10
v_mul_u32_u24 v11, 80, v10
v_sub_u32 v9, v9, v11
v_and_b32 v11, 15, v10
v_xor_b32 v9, v9, v11
v_mul_u32_u24 v10, 1280, v10
v_lshl_add_u32 v73, v9, 4, v10
v_add_u32 v9, 128, v8
v_mul_u32_u24 v10, s53, v9
v_lshrrev_b32 v10, 22, v10
v_mul_u32_u24 v11, 80, v10
v_sub_u32 v9, v9, v11
v_and_b32 v11, 15, v10
v_xor_b32 v9, v9, v11
v_mul_u32_u24 v10, 1280, v10
v_lshl_add_u32 v74, v9, 4, v10
v_add_u32 v9, 192, v8
v_mul_u32_u24 v10, s53, v9
v_lshrrev_b32 v10, 22, v10
v_mul_u32_u24 v11, 80, v10
v_sub_u32 v9, v9, v11
v_and_b32 v11, 15, v10
v_xor_b32 v9, v9, v11
v_mul_u32_u24 v10, 1280, v10
v_lshl_add_u32 v75, v9, 4, v10
v_add_u32 v9, 256, v8
v_mul_u32_u24 v10, s53, v9
v_lshrrev_b32 v10, 22, v10
v_mul_u32_u24 v11, 80, v10
v_sub_u32 v9, v9, v11
v_and_b32 v11, 15, v10
v_xor_b32 v9, v9, v11
v_mul_u32_u24 v10, 1280, v10
v_lshl_add_u32 v76, v9, 4, v10
v_add_u32 v9, 320, v8
v_mul_u32_u24 v10, s53, v9
v_lshrrev_b32 v10, 22, v10
v_mul_u32_u24 v11, 80, v10
v_sub_u32 v9, v9, v11
v_and_b32 v11, 15, v10
v_xor_b32 v9, v9, v11
v_mul_u32_u24 v10, 1280, v10
v_lshl_add_u32 v77, v9, 4, v10
v_add_u32 v9, 384, v8
v_mul_u32_u24 v10, s53, v9
v_lshrrev_b32 v10, 22, v10
v_mul_u32_u24 v11, 80, v10
v_sub_u32 v9, v9, v11
v_and_b32 v11, 15, v10
v_xor_b32 v9, v9, v11
v_mul_u32_u24 v10, 1280, v10
v_lshl_add_u32 v78, v9, 4, v10
v_add_u32 v9, 448, v8
v_mul_u32_u24 v10, s53, v9
v_lshrrev_b32 v10, 22, v10
v_mul_u32_u24 v11, 80, v10
v_sub_u32 v9, v9, v11
v_and_b32 v11, 15, v10
v_xor_b32 v9, v9, v11
v_mul_u32_u24 v10, 1280, v10
v_lshl_add_u32 v79, v9, 4, v10
v_add_u32 v9, 512, v8
v_mul_u32_u24 v10, s53, v9
v_lshrrev_b32 v10, 22, v10
v_mul_u32_u24 v11, 80, v10
v_sub_u32 v9, v9, v11
v_and_b32 v11, 15, v10
v_xor_b32 v9, v9, v11
v_mul_u32_u24 v10, 1280, v10
v_lshl_add_u32 v80, v9, 4, v10
v_add_u32 v9, 576, v8
v_mul_u32_u24 v10, s53, v9
v_lshrrev_b32 v10, 22, v10
v_mul_u32_u24 v11, 80, v10
v_sub_u32 v9, v9, v11
v_and_b32 v11, 15, v10
v_xor_b32 v9, v9, v11
v_mul_u32_u24 v10, 1280, v10
v_lshl_add_u32 v81, v9, 4, v10
s_cmp_lg_u32 s3, 0
s_cbranch_scc1 k_wdd_100
v_mov_b32 v2, 128
k_wd_99:
global_load_dword v3, v2, s[28:29] sc1
s_waitcnt vmcnt(0)
v_readfirstlane_b32 s52, v3
s_cmp_ge_u32 s52, 32
s_cbranch_scc1 k_wdd_100
s_sleep 2
s_sub_u32 s32, s32, 1
s_cmp_gt_i32 s32, 0
s_cbranch_scc1 k_wd_99
k_wdd_100:
s_barrier
s_mul_i32 s53, s58, 40960
s_add_u32 s53, s53, 213909504
buffer_load_dwordx4 v[96:99], v0, s[4:7], s53 offen offset:0 sc1
buffer_load_dwordx4 v[100:103], v0, s[4:7], s53 offen offset:1024 sc1
buffer_load_dwordx4 v[104:107], v0, s[4:7], s53 offen offset:2048 sc1
buffer_load_dwordx4 v[108:111], v0, s[4:7], s53 offen offset:3072 sc1
s_add_u32 s53, s53, 4096
buffer_load_dwordx4 v[112:115], v0, s[4:7], s53 offen offset:0 sc1
buffer_load_dwordx4 v[116:119], v0, s[4:7], s53 offen offset:1024 sc1
buffer_load_dwordx4 v[120:123], v0, s[4:7], s53 offen offset:2048 sc1
buffer_load_dwordx4 v[124:127], v0, s[4:7], s53 offen offset:3072 sc1
s_add_u32 s53, s53, 4096
buffer_load_dwordx4 v[128:131], v0, s[4:7], s53 offen offset:0 sc1
buffer_load_dwordx4 v[132:135], v0, s[4:7], s53 offen offset:1024 sc1
buffer_load_dwordx4 v[136:139], v0, s[4:7], s53 offen offset:2048 sc1
buffer_load_dwordx4 v[140:143], v0, s[4:7], s53 offen offset:3072 sc1
s_add_u32 s53, s53, 4096
buffer_load_dwordx4 v[144:147], v0, s[4:7], s53 offen offset:0 sc1
buffer_load_dwordx4 v[148:151], v0, s[4:7], s53 offen offset:1024 sc1
buffer_load_dwordx4 v[152:155], v0, s[4:7], s53 offen offset:2048 sc1
buffer_load_dwordx4 v[156:159], v0, s[4:7], s53 offen offset:3072 sc1
s_add_u32 s53, s53, 4096
buffer_load_dwordx4 v[160:163], v0, s[4:7], s53 offen offset:0 sc1
buffer_load_dwordx4 v[164:167], v0, s[4:7], s53 offen offset:1024 sc1
buffer_load_dwordx4 v[168:171], v0, s[4:7], s53 offen offset:2048 sc1
buffer_load_dwordx4 v[172:175], v0, s[4:7], s53 offen offset:3072 sc1
s_add_u32 s53, s53, 4096
buffer_load_dwordx4 v[176:179], v0, s[4:7], s53 offen offset:0 sc1
buffer_load_dwordx4 v[180:183], v0, s[4:7], s53 offen offset:1024 sc1
buffer_load_dwordx4 v[184:187], v0, s[4:7], s53 offen offset:2048 sc1
buffer_load_dwordx4 v[188:191], v0, s[4:7], s53 offen offset:3072 sc1
s_add_u32 s53, s53, 4096
buffer_load_dwordx4 v[192:195], v0, s[4:7], s53 offen offset:0 sc1
buffer_load_dwordx4 v[196:199], v0, s[4:7], s53 offen offset:1024 sc1
buffer_load_dwordx4 v[200:203], v0, s[4:7], s53 offen offset:2048 sc1
buffer_load_dwordx4 v[204:207], v0, s[4:7], s53 offen offset:3072 sc1
s_add_u32 s53, s53, 4096
buffer_load_dwordx4 v[208:211], v0, s[4:7], s53 offen offset:0 sc1
buffer_load_dwordx4 v[212:215], v0, s[4:7], s53 offen offset:1024 sc1
buffer_load_dwordx4 v[216:219], v0, s[4:7], s53 offen offset:2048 sc1
buffer_load_dwordx4 v[220:223], v0, s[4:7], s53 offen offset:3072 sc1
s_add_u32 s53, s53, 4096
buffer_load_dwordx4 v[224:227], v0, s[4:7], s53 offen offset:0 sc1
buffer_load_dwordx4 v[228:231], v0, s[4:7], s53 offen offset:1024 sc1
buffer_load_dwordx4 v[232:235], v0, s[4:7], s53 offen offset:2048 sc1
buffer_load_dwordx4 v[236:239], v0, s[4:7], s53 offen offset:3072 sc1
s_add_u32 s53, s53, 4096
buffer_load_dwordx4 v[240:243], v0, s[4:7], s53 offen offset:0 sc1
buffer_load_dwordx4 v[244:247], v0, s[4:7], s53 offen offset:1024 sc1
buffer_load_dwordx4 v[248:251], v0, s[4:7], s53 offen offset:2048 sc1
buffer_load_dwordx4 v[252:255], v0, s[4:7], s53 offen offset:3072 sc1
s_mul_i32 s46, s57, 163840
s_lshl_b32 s48, s58, 11
s_add_u32 s48, s48, s46
s_add_u32 s48, s48, 195035136
s_mov_b32 s47, 0
s_waitcnt lgkmcnt(0)
s_mul_i32 s45, s3, 10240
s_mov_b32 s44, 0
v_bfe_u32 v8, v0, 4, 5
v_mul_u32_u24 v9, 1280, v8
v_and_b32 v8, 15, v8
v_lshrrev_b32 v10, 9, v0
v_xor_b32 v8, v8, v10
v_xor_b32 v10, 0, v8
v_lshl_add_u32 v64, v10, 4, v9
v_xor_b32 v10, 2, v8
v_lshl_add_u32 v65, v10, 4, v9
v_xor_b32 v10, 4, v8
v_lshl_add_u32 v66, v10, 4, v9
v_xor_b32 v10, 6, v8
v_lshl_add_u32 v67, v10, 4, v9
v_xor_b32 v10, 8, v8
v_lshl_add_u32 v68, v10, 4, v9
v_xor_b32 v10, 10, v8
v_lshl_add_u32 v69, v10, 4, v9
v_xor_b32 v10, 12, v8
v_lshl_add_u32 v70, v10, 4, v9
v_xor_b32 v10, 14, v8
v_lshl_add_u32 v71, v10, 4, v9
s_add_u32 m0, s45, 0
s_nop 0
buffer_load_dwordx4 v72, s[36:39], s46 offen lds
s_add_u32 m0, s45, 1024
s_nop 0
buffer_load_dwordx4 v73, s[36:39], s46 offen lds
s_add_u32 m0, s45, 2048
s_nop 0
buffer_load_dwordx4 v74, s[36:39], s46 offen lds
s_add_u32 m0, s45, 3072
s_nop 0
buffer_load_dwordx4 v75, s[36:39], s46 offen lds
s_add_u32 m0, s45, 4096
s_nop 0
buffer_load_dwordx4 v76, s[36:39], s46 offen lds
s_add_u32 m0, s45, 5120
s_nop 0
buffer_load_dwordx4 v77, s[36:39], s46 offen lds
s_add_u32 m0, s45, 6144
s_nop 0
buffer_load_dwordx4 v78, s[36:39], s46 offen lds
s_add_u32 m0, s45, 7168
s_nop 0
buffer_load_dwordx4 v79, s[36:39], s46 offen lds
s_add_u32 m0, s45, 8192
s_nop 0
buffer_load_dwordx4 v80, s[36:39], s46 offen lds
s_add_u32 m0, s45, 9216
s_nop 0
buffer_load_dwordx4 v81, s[36:39], s46 offen lds
s_add_u32 s45, s45, 40960
s_cmp_ge_u32 s45, 122880
s_cselect_b32 s55, 122880, 0
s_sub_u32 s45, s45, s55
s_add_u32 s47, s47, 1
s_cmp_lt_u32 s47, 4
s_cselect_b32 s55, 40960, 0
s_add_u32 s46, s46, s55
s_add_u32 m0, s45, 0
s_nop 0
buffer_load_dwordx4 v72, s[36:39], s46 offen lds
s_add_u32 m0, s45, 1024
s_nop 0
buffer_load_dwordx4 v73, s[36:39], s46 offen lds
s_add_u32 m0, s45, 2048
s_nop 0
buffer_load_dwordx4 v74, s[36:39], s46 offen lds
s_add_u32 m0, s45, 3072
s_nop 0
buffer_load_dwordx4 v75, s[36:39], s46 offen lds
s_add_u32 m0, s45, 4096
s_nop 0
buffer_load_dwordx4 v76, s[36:39], s46 offen lds
s_add_u32 m0, s45, 5120
s_nop 0
buffer_load_dwordx4 v77, s[36:39], s46 offen lds
s_add_u32 m0, s45, 6144
s_nop 0
buffer_load_dwordx4 v78, s[36:39], s46 offen lds
s_add_u32 m0, s45, 7168
s_nop 0
buffer_load_dwordx4 v79, s[36:39], s46 offen lds
s_add_u32 m0, s45, 8192
s_nop 0
buffer_load_dwordx4 v80, s[36:39], s46 offen lds
s_add_u32 m0, s45, 9216
s_nop 0
buffer_load_dwordx4 v81, s[36:39], s46 offen lds
s_add_u32 s45, s45, 40960
s_cmp_ge_u32 s45, 122880
s_cselect_b32 s55, 122880, 0
s_sub_u32 s45, s45, s55
s_add_u32 s47, s47, 1
s_cmp_lt_u32 s47, 4
s_cselect_b32 s55, 40960, 0
s_add_u32 s46, s46, s55
s_waitcnt vmcnt(10)
s_barrier
ds_read_b128 v[8:11], v64 offset:0
ds_read_b128 v[12:15], v65 offset:0
ds_read_b128 v[16:19], v66 offset:0
ds_read_b128 v[20:23], v67 offset:0
s_mov_b32 s59, 2
s_waitcnt lgkmcnt(3)
v_mfma_f32_32x32x16_bf16 v[32:47], v[96:99], v[8:11], 0
s_waitcnt lgkmcnt(2)
ds_read_b128 v[24:27], v68 offset:0
v_mfma_f32_32x32x16_bf16 v[32:47], v[100:103], v[12:15], v[32:47]
s_waitcnt lgkmcnt(2)
ds_read_b128 v[8:11], v69 offset:0
s_add_u32 m0, s45, 0
s_nop 0
buffer_load_dwordx4 v72, s[36:39], s46 offen lds
s_add_u32 m0, s45, 1024
s_nop 0
buffer_load_dwordx4 v73, s[36:39], s46 offen lds
v_mfma_f32_32x32x16_bf16 v[32:47], v[104:107], v[16:19], v[32:47]
s_waitcnt lgkmcnt(2)
ds_read_b128 v[12:15], v70 offset:0
s_add_u32 m0, s45, 2048
s_nop 0
buffer_load_dwordx4 v74, s[36:39], s46 offen lds
s_add_u32 m0, s45, 3072
s_nop 0
buffer_load_dwordx4 v75, s[36:39], s46 offen lds
v_mfma_f32_32x32x16_bf16 v[32:47], v[108:111], v[20:23], v[32:47]
s_waitcnt lgkmcnt(2)
ds_read_b128 v[16:19], v71 offset:0
s_add_u32 m0, s45, 4096
s_nop 0
buffer_load_dwordx4 v76, s[36:39], s46 offen lds
s_add_u32 m0, s45, 5120
s_nop 0
buffer_load_dwordx4 v77, s[36:39], s46 offen lds
v_mfma_f32_32x32x16_bf16 v[32:47], v[112:115], v[24:27], v[32:47]
s_waitcnt lgkmcnt(2)
ds_read_b128 v[20:23], v64 offset:256
s_add_u32 m0, s45, 6144
s_nop 0
buffer_load_dwordx4 v78, s[36:39], s46 offen lds
s_add_u32 m0, s45, 7168
s_nop 0
buffer_load_dwordx4 v79, s[36:39], s46 offen lds
v_mfma_f32_32x32x16_bf16 v[32:47], v[116:119], v[8:11], v[32:47]
s_waitcnt lgkmcnt(2)
ds_read_b128 v[24:27], v65 offset:256
s_add_u32 m0, s45, 8192
s_nop 0
buffer_load_dwordx4 v80, s[36:39], s46 offen lds
s_add_u32 m0, s45, 9216
s_nop 0
buffer_load_dwordx4 v81, s[36:39], s46 offen lds
v_mfma_f32_32x32x16_bf16 v[32:47], v[120:123], v[12:15], v[32:47]
s_waitcnt lgkmcnt(2)
ds_read_b128 v[8:11], v66 offset:256
s_add_u32 s45, s45, 40960
s_cmp_ge_u32 s45, 122880
s_cselect_b32 s55, 122880, 0
s_sub_u32 s45, s45, s55
s_add_u32 s47, s47, 1
s_cmp_lt_u32 s47, 4
s_cselect_b32 s55, 40960, 0
s_add_u32 s46, s46, s55
v_mfma_f32_32x32x16_bf16 v[32:47], v[124:127], v[16:19], v[32:47]
s_waitcnt lgkmcnt(2)
ds_read_b128 v[12:15], v67 offset:256
v_mfma_f32_32x32x16_bf16 v[32:47], v[128:131], v[20:23], v[32:47]
s_waitcnt lgkmcnt(2)
ds_read_b128 v[16:19], v68 offset:256
v_mfma_f32_32x32x16_bf16 v[32:47], v[132:135], v[24:27], v[32:47]
s_waitcnt lgkmcnt(2)
ds_read_b128 v[20:23], v69 offset:256
v_mfma_f32_32x32x16_bf16 v[32:47], v[136:139], v[8:11], v[32:47]
s_waitcnt lgkmcnt(2)
ds_read_b128 v[24:27], v70 offset:256
v_mfma_f32_32x32x16_bf16 v[32:47], v[140:143], v[12:15], v[32:47]
s_waitcnt lgkmcnt(2)
ds_read_b128 v[8:11], v71 offset:256
v_mfma_f32_32x32x16_bf16 v[32:47], v[144:147], v[16:19], v[32:47]
s_waitcnt lgkmcnt(2)
ds_read_b128 v[12:15], v64 offset:512
v_mfma_f32_32x32x16_bf16 v[32:47], v[148:151], v[20:23], v[32:47]
s_waitcnt lgkmcnt(2)
ds_read_b128 v[16:19], v65 offset:512
v_mfma_f32_32x32x16_bf16 v[32:47], v[152:155], v[24:27], v[32:47]
s_waitcnt lgkmcnt(2)
ds_read_b128 v[20:23], v66 offset:512
v_mfma_f32_32x32x16_bf16 v[32:47], v[156:159], v[8:11], v[32:47]
s_waitcnt lgkmcnt(2)
ds_read_b128 v[24:27], v67 offset:512
v_mfma_f32_32x32x16_bf16 v[32:47], v[160:163], v[12:15], v[32:47]
s_waitcnt lgkmcnt(2)
ds_read_b128 v[8:11], v68 offset:512
v_mfma_f32_32x32x16_bf16 v[32:47], v[164:167], v[16:19], v[32:47]
s_waitcnt lgkmcnt(2)
ds_read_b128 v[12:15], v69 offset:512
v_mfma_f32_32x32x16_bf16 v[32:47], v[168:171], v[20:23], v[32:47]
s_waitcnt lgkmcnt(2)
ds_read_b128 v[16:19], v70 offset:512
v_mfma_f32_32x32x16_bf16 v[32:47], v[172:175], v[24:27], v[32:47]
s_waitcnt lgkmcnt(2)
ds_read_b128 v[20:23], v71 offset:512
v_mfma_f32_32x32x16_bf16 v[32:47], v[176:179], v[8:11], v[32:47]
s_waitcnt lgkmcnt(2)
ds_read_b128 v[24:27], v64 offset:768
v_mfma_f32_32x32x16_bf16 v[32:47], v[180:183], v[12:15], v[32:47]
s_waitcnt lgkmcnt(2)
ds_read_b128 v[8:11], v65 offset:768
v_mfma_f32_32x32x16_bf16 v[32:47], v[184:187], v[16:19], v[32:47]
s_waitcnt lgkmcnt(2)
ds_read_b128 v[12:15], v66 offset:768
v_mfma_f32_32x32x16_bf16 v[32:47], v[188:191], v[20:23], v[32:47]
s_waitcnt lgkmcnt(2)
ds_read_b128 v[16:19], v67 offset:768
v_mfma_f32_32x32x16_bf16 v[32:47], v[192:195], v[24:27], v[32:47]
s_waitcnt lgkmcnt(2)
ds_read_b128 v[20:23], v68 offset:768
v_mfma_f32_32x32x16_bf16 v[32:47], v[196:199], v[8:11], v[32:47]
s_waitcnt lgkmcnt(2)
ds_read_b128 v[24:27], v69 offset:768
v_mfma_f32_32x32x16_bf16 v[32:47], v[200:203], v[12:15], v[32:47]
s_waitcnt lgkmcnt(2)
ds_read_b128 v[8:11], v70 offset:768
v_mfma_f32_32x32x16_bf16 v[32:47], v[204:207], v[16:19], v[32:47]
s_waitcnt lgkmcnt(2)
ds_read_b128 v[12:15], v71 offset:768
v_mfma_f32_32x32x16_bf16 v[32:47], v[208:211], v[20:23], v[32:47]
s_waitcnt lgkmcnt(2)
ds_read_b128 v[16:19], v64 offset:1024
v_mfma_f32_32x32x16_bf16 v[32:47], v[212:215], v[24:27], v[32:47]
s_waitcnt lgkmcnt(2)
ds_read_b128 v[20:23], v65 offset:1024
v_mfma_f32_32x32x16_bf16 v[32:47], v[216:219], v[8:11], v[32:47]
s_waitcnt lgkmcnt(2)
ds_read_b128 v[24:27], v66 offset:1024
v_mfma_f32_32x32x16_bf16 v[32:47], v[220:223], v[12:15], v[32:47]
s_waitcnt lgkmcnt(2)
ds_read_b128 v[8:11], v67 offset:1024
v_mfma_f32_32x32x16_bf16 v[32:47], v[224:227], v[16:19], v[32:47]
s_waitcnt lgkmcnt(2)
ds_read_b128 v[12:15], v68 offset:1024
v_mfma_f32_32x32x16_bf16 v[32:47], v[228:231], v[20:23], v[32:47]
s_waitcnt lgkmcnt(2)
ds_read_b128 v[16:19], v69 offset:1024
v_mfma_f32_32x32x16_bf16 v[32:47], v[232:235], v[24:27], v[32:47]
s_waitcnt lgkmcnt(2)
ds_read_b128 v[20:23], v70 offset:1024
v_mfma_f32_32x32x16_bf16 v[32:47], v[236:239], v[8:11], v[32:47]
s_waitcnt lgkmcnt(2)
ds_read_b128 v[24:27], v71 offset:1024
v_mfma_f32_32x32x16_bf16 v[32:47], v[240:243], v[12:15], v[32:47]
s_add_u32 s44, s44, 1
s_cmp_eq_u32 s44, 3
s_mov_b32 s56, 40960
s_cmov_b32 s56, -81920
s_cselect_b32 s44, 0, s44
v_add_u32 v64, s56, v64
v_add_u32 v65, s56, v65
v_add_u32 v66, s56, v66
v_add_u32 v67, s56, v67
v_add_u32 v68, s56, v68
v_add_u32 v69, s56, v69
v_add_u32 v70, s56, v70
v_add_u32 v71, s56, v71
s_waitcnt vmcnt(10) lgkmcnt(2)
s_barrier
ds_read_b128 v[8:11], v64 offset:0
v_mfma_f32_32x32x16_bf16 v[32:47], v[244:247], v[16:19], v[32:47]
s_waitcnt lgkmcnt(2)
ds_read_b128 v[12:15], v65 offset:0
v_mfma_f32_32x32x16_bf16 v[32:47], v[248:251], v[20:23], v[32:47]
s_waitcnt lgkmcnt(2)
ds_read_b128 v[16:19], v66 offset:0
v_mfma_f32_32x32x16_bf16 v[32:47], v[252:255], v[24:27], v[32:47]
s_waitcnt lgkmcnt(2)
ds_read_b128 v[20:23], v67 offset:0
k_st_101:
v_mfma_f32_32x32x16_bf16 v[48:63], v[96:99], v[8:11], 0
s_waitcnt lgkmcnt(2)
ds_read_b128 v[24:27], v68 offset:0
v_mfma_f32_32x32x16_bf16 v[48:63], v[100:103], v[12:15], v[48:63]
s_waitcnt lgkmcnt(2)
ds_read_b128 v[8:11], v69 offset:0
v_cvt_pk_bf16_f32 v32, v32, v33
v_cvt_pk_bf16_f32 v33, v34, v35
v_mfma_f32_32x32x16_bf16 v[48:63], v[104:107], v[16:19], v[48:63]
s_waitcnt lgkmcnt(2)
ds_read_b128 v[12:15], v70 offset:0
v_cvt_pk_bf16_f32 v34, v36, v37
v_cvt_pk_bf16_f32 v35, v38, v39
v_mfma_f32_32x32x16_bf16 v[48:63], v[108:111], v[20:23], v[48:63]
s_waitcnt lgkmcnt(2)
ds_read_b128 v[16:19], v71 offset:0
v_cvt_pk_bf16_f32 v36, v40, v41
v_cvt_pk_bf16_f32 v37, v42, v43
v_mfma_f32_32x32x16_bf16 v[48:63], v[112:115], v[24:27], v[48:63]
s_waitcnt lgkmcnt(2)
ds_read_b128 v[20:23], v64 offset:256
v_cvt_pk_bf16_f32 v38, v44, v45
v_cvt_pk_bf16_f32 v39, v46, v47
v_mfma_f32_32x32x16_bf16 v[48:63], v[116:119], v[8:11], v[48:63]
s_waitcnt lgkmcnt(2)
ds_read_b128 v[24:27], v65 offset:256
buffer_store_dwordx4 v[32:35], v0, s[4:7], s48 offen offset:0 sc1
buffer_store_dwordx4 v[36:39], v0, s[4:7], s48 offen offset:1024 sc1
v_mfma_f32_32x32x16_bf16 v[48:63], v[120:123], v[12:15], v[48:63]
s_waitcnt lgkmcnt(2)
ds_read_b128 v[8:11], v66 offset:256
s_add_u32 s48, s48, 40960
s_add_u32 m0, s45, 0
s_nop 0
buffer_load_dwordx4 v72, s[36:39], s46 offen lds
v_mfma_f32_32x32x16_bf16 v[48:63], v[124:127], v[16:19], v[48:63]
s_waitcnt lgkmcnt(2)
ds_read_b128 v[12:15], v67 offset:256
s_add_u32 m0, s45, 1024
s_nop 0
buffer_load_dwordx4 v73, s[36:39], s46 offen lds
s_add_u32 m0, s45, 2048
s_nop 0
buffer_load_dwordx4 v74, s[36:39], s46 offen lds
v_mfma_f32_32x32x16_bf16 v[48:63], v[128:131], v[20:23], v[48:63]
s_waitcnt lgkmcnt(2)
ds_read_b128 v[16:19], v68 offset:256
s_add_u32 m0, s45, 3072
s_nop 0
buffer_load_dwordx4 v75, s[36:39], s46 offen lds
s_add_u32 m0, s45, 4096
s_nop 0
buffer_load_dwordx4 v76, s[36:39], s46 offen lds
v_mfma_f32_32x32x16_bf16 v[48:63], v[132:135], v[24:27], v[48:63]
s_waitcnt lgkmcnt(2)
ds_read_b128 v[20:23], v69 offset:256
s_add_u32 m0, s45, 5120
s_nop 0
buffer_load_dwordx4 v77, s[36:39], s46 offen lds
s_add_u32 m0, s45, 6144
s_nop 0
buffer_load_dwordx4 v78, s[36:39], s46 offen lds
v_mfma_f32_32x32x16_bf16 v[48:63], v[136:139], v[8:11], v[48:63]
s_waitcnt lgkmcnt(2)
ds_read_b128 v[24:27], v70 offset:256
s_add_u32 m0, s45, 7168
s_nop 0
buffer_load_dwordx4 v79, s[36:39], s46 offen lds
s_add_u32 m0, s45, 8192
s_nop 0
buffer_load_dwordx4 v80, s[36:39], s46 offen lds
v_mfma_f32_32x32x16_bf16 v[48:63], v[140:143], v[12:15], v[48:63]
s_waitcnt lgkmcnt(2)
ds_read_b128 v[8:11], v71 offset:256
s_add_u32 m0, s45, 9216
s_nop 0
buffer_load_dwordx4 v81, s[36:39], s46 offen lds
s_add_u32 s45, s45, 40960
s_cmp_ge_u32 s45, 122880
s_cselect_b32 s55, 122880, 0
s_sub_u32 s45, s45, s55
v_mfma_f32_32x32x16_bf16 v[48:63], v[144:147], v[16:19], v[48:63]
s_waitcnt lgkmcnt(2)
ds_read_b128 v[12:15], v64 offset:512
s_add_u32 s47, s47, 1
s_cmp_lt_u32 s47, 4
s_cselect_b32 s55, 40960, 0
s_add_u32 s46, s46, s55
v_mfma_f32_32x32x16_bf16 v[48:63], v[148:151], v[20:23], v[48:63]
s_waitcnt lgkmcnt(2)
ds_read_b128 v[16:19], v65 offset:512
v_mfma_f32_32x32x16_bf16 v[48:63], v[152:155], v[24:27], v[48:63]
s_waitcnt lgkmcnt(2)
ds_read_b128 v[20:23], v66 offset:512
v_mfma_f32_32x32x16_bf16 v[48:63], v[156:159], v[8:11], v[48:63]
s_waitcnt lgkmcnt(2)
ds_read_b128 v[24:27], v67 offset:512
v_mfma_f32_32x32x16_bf16 v[48:63], v[160:163], v[12:15], v[48:63]
s_waitcnt lgkmcnt(2)
ds_read_b128 v[8:11], v68 offset:512
v_mfma_f32_32x32x16_bf16 v[48:63], v[164:167], v[16:19], v[48:63]
s_waitcnt lgkmcnt(2)
ds_read_b128 v[12:15], v69 offset:512
v_mfma_f32_32x32x16_bf16 v[48:63], v[168:171], v[20:23], v[48:63]
s_waitcnt lgkmcnt(2)
ds_read_b128 v[16:19], v70 offset:512
v_mfma_f32_32x32x16_bf16 v[48:63], v[172:175], v[24:27], v[48:63]
s_waitcnt lgkmcnt(2)
ds_read_b128 v[20:23], v71 offset:512
v_mfma_f32_32x32x16_bf16 v[48:63], v[176:179], v[8:11], v[48:63]
s_waitcnt lgkmcnt(2)
ds_read_b128 v[24:27], v64 offset:768
v_mfma_f32_32x32x16_bf16 v[48:63], v[180:183], v[12:15], v[48:63]
s_waitcnt lgkmcnt(2)
ds_read_b128 v[8:11], v65 offset:768
v_mfma_f32_32x32x16_bf16 v[48:63], v[184:187], v[16:19], v[48:63]
s_waitcnt lgkmcnt(2)
ds_read_b128 v[12:15], v66 offset:768
v_mfma_f32_32x32x16_bf16 v[48:63], v[188:191], v[20:23], v[48:63]
s_waitcnt lgkmcnt(2)
ds_read_b128 v[16:19], v67 offset:768
v_mfma_f32_32x32x16_bf16 v[48:63], v[192:195], v[24:27], v[48:63]
s_waitcnt lgkmcnt(2)
ds_read_b128 v[20:23], v68 offset:768
v_mfma_f32_32x32x16_bf16 v[48:63], v[196:199], v[8:11], v[48:63]
s_waitcnt lgkmcnt(2)
ds_read_b128 v[24:27], v69 offset:768
v_mfma_f32_32x32x16_bf16 v[48:63], v[200:203], v[12:15], v[48:63]
s_waitcnt lgkmcnt(2)
ds_read_b128 v[8:11], v70 offset:768
v_mfma_f32_32x32x16_bf16 v[48:63], v[204:207], v[16:19], v[48:63]
s_waitcnt lgkmcnt(2)
ds_read_b128 v[12:15], v71 offset:768
v_mfma_f32_32x32x16_bf16 v[48:63], v[208:211], v[20:23], v[48:63]
s_waitcnt lgkmcnt(2)
ds_read_b128 v[16:19], v64 offset:1024
v_mfma_f32_32x32x16_bf16 v[48:63], v[212:215], v[24:27], v[48:63]
s_waitcnt lgkmcnt(2)
ds_read_b128 v[20:23], v65 offset:1024
v_mfma_f32_32x32x16_bf16 v[48:63], v[216:219], v[8:11], v[48:63]
s_waitcnt lgkmcnt(2)
ds_read_b128 v[24:27], v66 offset:1024
v_mfma_f32_32x32x16_bf16 v[48:63], v[220:223], v[12:15], v[48:63]
s_waitcnt lgkmcnt(2)
ds_read_b128 v[8:11], v67 offset:1024
v_mfma_f32_32x32x16_bf16 v[48:63], v[224:227], v[16:19], v[48:63]
s_waitcnt lgkmcnt(2)
ds_read_b128 v[12:15], v68 offset:1024
v_mfma_f32_32x32x16_bf16 v[48:63], v[228:231], v[20:23], v[48:63]
s_waitcnt lgkmcnt(2)
ds_read_b128 v[16:19], v69 offset:1024
v_mfma_f32_32x32x16_bf16 v[48:63], v[232:235], v[24:27], v[48:63]
s_waitcnt lgkmcnt(2)
ds_read_b128 v[20:23], v70 offset:1024
v_mfma_f32_32x32x16_bf16 v[48:63], v[236:239], v[8:11], v[48:63]
s_waitcnt lgkmcnt(2)
ds_read_b128 v[24:27], v71 offset:1024
v_mfma_f32_32x32x16_bf16 v[48:63], v[240:243], v[12:15], v[48:63]
s_add_u32 s44, s44, 1
s_cmp_eq_u32 s44, 3
s_mov_b32 s56, 40960
s_cmov_b32 s56, -81920
s_cselect_b32 s44, 0, s44
v_add_u32 v64, s56, v64
v_add_u32 v65, s56, v65
v_add_u32 v66, s56, v66
v_add_u32 v67, s56, v67
v_add_u32 v68, s56, v68
v_add_u32 v69, s56, v69
v_add_u32 v70, s56, v70
v_add_u32 v71, s56, v71
s_waitcnt vmcnt(10) lgkmcnt(2)
s_barrier
ds_read_b128 v[8:11], v64 offset:0
v_mfma_f32_32x32x16_bf16 v[48:63], v[244:247], v[16:19], v[48:63]
s_waitcnt lgkmcnt(2)
ds_read_b128 v[12:15], v65 offset:0
v_mfma_f32_32x32x16_bf16 v[48:63], v[248:251], v[20:23], v[48:63]
s_waitcnt lgkmcnt(2)
ds_read_b128 v[16:19], v66 offset:0
v_mfma_f32_32x32x16_bf16 v[48:63], v[252:255], v[24:27], v[48:63]
s_waitcnt lgkmcnt(2)
ds_read_b128 v[20:23], v67 offset:0
k_sm_103:
s_sub_u32 s59, s59, 1
s_cmp_eq_u32 s59, 0
s_cbranch_scc1 k_so_102
v_mfma_f32_32x32x16_bf16 v[32:47], v[96:99], v[8:11], 0
s_waitcnt lgkmcnt(2)
ds_read_b128 v[24:27], v68 offset:0
v_mfma_f32_32x32x16_bf16 v[32:47], v[100:103], v[12:15], v[32:47]
s_waitcnt lgkmcnt(2)
ds_read_b128 v[8:11], v69 offset:0
v_cvt_pk_bf16_f32 v48, v48, v49
v_cvt_pk_bf16_f32 v49, v50, v51
v_mfma_f32_32x32x16_bf16 v[32:47], v[104:107], v[16:19], v[32:47]
s_waitcnt lgkmcnt(2)
ds_read_b128 v[12:15], v70 offset:0
v_cvt_pk_bf16_f32 v50, v52, v53
v_cvt_pk_bf16_f32 v51, v54, v55
v_mfma_f32_32x32x16_bf16 v[32:47], v[108:111], v[20:23], v[32:47]
s_waitcnt lgkmcnt(2)
ds_read_b128 v[16:19], v71 offset:0
v_cvt_pk_bf16_f32 v52, v56, v57
v_cvt_pk_bf16_f32 v53, v58, v59
v_mfma_f32_32x32x16_bf16 v[32:47], v[112:115], v[24:27], v[32:47]
s_waitcnt lgkmcnt(2)
ds_read_b128 v[20:23], v64 offset:256
v_cvt_pk_bf16_f32 v54, v60, v61
v_cvt_pk_bf16_f32 v55, v62, v63
v_mfma_f32_32x32x16_bf16 v[32:47], v[116:119], v[8:11], v[32:47]
s_waitcnt lgkmcnt(2)
ds_read_b128 v[24:27], v65 offset:256
buffer_store_dwordx4 v[48:51], v0, s[4:7], s48 offen offset:0 sc1
buffer_store_dwordx4 v[52:55], v0, s[4:7], s48 offen offset:1024 sc1
v_mfma_f32_32x32x16_bf16 v[32:47], v[120:123], v[12:15], v[32:47]
s_waitcnt lgkmcnt(2)
ds_read_b128 v[8:11], v66 offset:256
s_add_u32 s48, s48, 40960
s_add_u32 m0, s45, 0
s_nop 0
buffer_load_dwordx4 v72, s[36:39], s46 offen lds
v_mfma_f32_32x32x16_bf16 v[32:47], v[124:127], v[16:19], v[32:47]
s_waitcnt lgkmcnt(2)
ds_read_b128 v[12:15], v67 offset:256
s_add_u32 m0, s45, 1024
s_nop 0
buffer_load_dwordx4 v73, s[36:39], s46 offen lds
s_add_u32 m0, s45, 2048
s_nop 0
buffer_load_dwordx4 v74, s[36:39], s46 offen lds
v_mfma_f32_32x32x16_bf16 v[32:47], v[128:131], v[20:23], v[32:47]
s_waitcnt lgkmcnt(2)
ds_read_b128 v[16:19], v68 offset:256
s_add_u32 m0, s45, 3072
s_nop 0
buffer_load_dwordx4 v75, s[36:39], s46 offen lds
s_add_u32 m0, s45, 4096
s_nop 0
buffer_load_dwordx4 v76, s[36:39], s46 offen lds
v_mfma_f32_32x32x16_bf16 v[32:47], v[132:135], v[24:27], v[32:47]
s_waitcnt lgkmcnt(2)
ds_read_b128 v[20:23], v69 offset:256
s_add_u32 m0, s45, 5120
s_nop 0
buffer_load_dwordx4 v77, s[36:39], s46 offen lds
s_add_u32 m0, s45, 6144
s_nop 0
buffer_load_dwordx4 v78, s[36:39], s46 offen lds
v_mfma_f32_32x32x16_bf16 v[32:47], v[136:139], v[8:11], v[32:47]
s_waitcnt lgkmcnt(2)
ds_read_b128 v[24:27], v70 offset:256
s_add_u32 m0, s45, 7168
s_nop 0
buffer_load_dwordx4 v79, s[36:39], s46 offen lds
s_add_u32 m0, s45, 8192
s_nop 0
buffer_load_dwordx4 v80, s[36:39], s46 offen lds
v_mfma_f32_32x32x16_bf16 v[32:47], v[140:143], v[12:15], v[32:47]
s_waitcnt lgkmcnt(2)
ds_read_b128 v[8:11], v71 offset:256
s_add_u32 m0, s45, 9216
s_nop 0
buffer_load_dwordx4 v81, s[36:39], s46 offen lds
s_add_u32 s45, s45, 40960
s_cmp_ge_u32 s45, 122880
s_cselect_b32 s55, 122880, 0
s_sub_u32 s45, s45, s55
v_mfma_f32_32x32x16_bf16 v[32:47], v[144:147], v[16:19], v[32:47]
s_waitcnt lgkmcnt(2)
ds_read_b128 v[12:15], v64 offset:512
s_add_u32 s47, s47, 1
s_cmp_lt_u32 s47, 4
s_cselect_b32 s55, 40960, 0
s_add_u32 s46, s46, s55
v_mfma_f32_32x32x16_bf16 v[32:47], v[148:151], v[20:23], v[32:47]
s_waitcnt lgkmcnt(2)
ds_read_b128 v[16:19], v65 offset:512
v_mfma_f32_32x32x16_bf16 v[32:47], v[152:155], v[24:27], v[32:47]
s_waitcnt lgkmcnt(2)
ds_read_b128 v[20:23], v66 offset:512
v_mfma_f32_32x32x16_bf16 v[32:47], v[156:159], v[8:11], v[32:47]
s_waitcnt lgkmcnt(2)
ds_read_b128 v[24:27], v67 offset:512
v_mfma_f32_32x32x16_bf16 v[32:47], v[160:163], v[12:15], v[32:47]
s_waitcnt lgkmcnt(2)
ds_read_b128 v[8:11], v68 offset:512
v_mfma_f32_32x32x16_bf16 v[32:47], v[164:167], v[16:19], v[32:47]
s_waitcnt lgkmcnt(2)
ds_read_b128 v[12:15], v69 offset:512
v_mfma_f32_32x32x16_bf16 v[32:47], v[168:171], v[20:23], v[32:47]
s_waitcnt lgkmcnt(2)
ds_read_b128 v[16:19], v70 offset:512
v_mfma_f32_32x32x16_bf16 v[32:47], v[172:175], v[24:27], v[32:47]
s_waitcnt lgkmcnt(2)
ds_read_b128 v[20:23], v71 offset:512
v_mfma_f32_32x32x16_bf16 v[32:47], v[176:179], v[8:11], v[32:47]
s_waitcnt lgkmcnt(2)
ds_read_b128 v[24:27], v64 offset:768
v_mfma_f32_32x32x16_bf16 v[32:47], v[180:183], v[12:15], v[32:47]
s_waitcnt lgkmcnt(2)
ds_read_b128 v[8:11], v65 offset:768
v_mfma_f32_32x32x16_bf16 v[32:47], v[184:187], v[16:19], v[32:47]
s_waitcnt lgkmcnt(2)
ds_read_b128 v[12:15], v66 offset:768
v_mfma_f32_32x32x16_bf16 v[32:47], v[188:191], v[20:23], v[32:47]
s_waitcnt lgkmcnt(2)
ds_read_b128 v[16:19], v67 offset:768
v_mfma_f32_32x32x16_bf16 v[32:47], v[192:195], v[24:27], v[32:47]
s_waitcnt lgkmcnt(2)
ds_read_b128 v[20:23], v68 offset:768
v_mfma_f32_32x32x16_bf16 v[32:47], v[196:199], v[8:11], v[32:47]
s_waitcnt lgkmcnt(2)
ds_read_b128 v[24:27], v69 offset:768
v_mfma_f32_32x32x16_bf16 v[32:47], v[200:203], v[12:15], v[32:47]
s_waitcnt lgkmcnt(2)
ds_read_b128 v[8:11], v70 offset:768
v_mfma_f32_32x32x16_bf16 v[32:47], v[204:207], v[16:19], v[32:47]
s_waitcnt lgkmcnt(2)
ds_read_b128 v[12:15], v71 offset:768
v_mfma_f32_32x32x16_bf16 v[32:47], v[208:211], v[20:23], v[32:47]
s_waitcnt lgkmcnt(2)
ds_read_b128 v[16:19], v64 offset:1024
v_mfma_f32_32x32x16_bf16 v[32:47], v[212:215], v[24:27], v[32:47]
s_waitcnt lgkmcnt(2)
ds_read_b128 v[20:23], v65 offset:1024
v_mfma_f32_32x32x16_bf16 v[32:47], v[216:219], v[8:11], v[32:47]
s_waitcnt lgkmcnt(2)
ds_read_b128 v[24:27], v66 offset:1024
v_mfma_f32_32x32x16_bf16 v[32:47], v[220:223], v[12:15], v[32:47]
s_waitcnt lgkmcnt(2)
ds_read_b128 v[8:11], v67 offset:1024
v_mfma_f32_32x32x16_bf16 v[32:47], v[224:227], v[16:19], v[32:47]
s_waitcnt lgkmcnt(2)
ds_read_b128 v[12:15], v68 offset:1024
v_mfma_f32_32x32x16_bf16 v[32:47], v[228:231], v[20:23], v[32:47]
s_waitcnt lgkmcnt(2)
ds_read_b128 v[16:19], v69 offset:1024
v_mfma_f32_32x32x16_bf16 v[32:47], v[232:235], v[24:27], v[32:47]
s_waitcnt lgkmcnt(2)
ds_read_b128 v[20:23], v70 offset:1024
v_mfma_f32_32x32x16_bf16 v[32:47], v[236:239], v[8:11], v[32:47]
s_waitcnt lgkmcnt(2)
ds_read_b128 v[24:27], v71 offset:1024
v_mfma_f32_32x32x16_bf16 v[32:47], v[240:243], v[12:15], v[32:47]
s_add_u32 s44, s44, 1
s_cmp_eq_u32 s44, 3
s_mov_b32 s56, 40960
s_cmov_b32 s56, -81920
s_cselect_b32 s44, 0, s44
v_add_u32 v64, s56, v64
v_add_u32 v65, s56, v65
v_add_u32 v66, s56, v66
v_add_u32 v67, s56, v67
v_add_u32 v68, s56, v68
v_add_u32 v69, s56, v69
v_add_u32 v70, s56, v70
v_add_u32 v71, s56, v71
s_waitcnt vmcnt(10) lgkmcnt(2)
s_barrier
ds_read_b128 v[8:11], v64 offset:0
v_mfma_f32_32x32x16_bf16 v[32:47], v[244:247], v[16:19], v[32:47]
s_waitcnt lgkmcnt(2)
ds_read_b128 v[12:15], v65 offset:0
v_mfma_f32_32x32x16_bf16 v[32:47], v[248:251], v[20:23], v[32:47]
s_waitcnt lgkmcnt(2)
ds_read_b128 v[16:19], v66 offset:0
v_mfma_f32_32x32x16_bf16 v[32:47], v[252:255], v[24:27], v[32:47]
s_waitcnt lgkmcnt(2)
ds_read_b128 v[20:23], v67 offset:0
s_branch k_st_101
k_so_102:
s_nop 6
v_cvt_pk_bf16_f32 v48, v48, v49
v_cvt_pk_bf16_f32 v49, v50, v51
v_cvt_pk_bf16_f32 v50, v52, v53
v_cvt_pk_bf16_f32 v51, v54, v55
v_cvt_pk_bf16_f32 v52, v56, v57
v_cvt_pk_bf16_f32 v53, v58, v59
v_cvt_pk_bf16_f32 v54, v60, v61
v_cvt_pk_bf16_f32 v55, v62, v63
buffer_store_dwordx4 v[48:51], v0, s[4:7], s48 offen offset:0 sc1
buffer_store_dwordx4 v[52:55], v0, s[4:7], s48 offen offset:1024 sc1
s_add_u32 s48, s48, 40960
s_lshl_b32 s54, s30, 6
s_add_u32 s54, s54, 222298112
s_waitcnt lgkmcnt(0)
s_waitcnt vmcnt(0)
s_barrier
s_cmp_lg_u32 s3, 0
s_cbranch_scc1 k_s8_104
s_mov_b64 exec, 1
v_mov_b32 v2, 1
buffer_store_dword v2, off, s[4:7], s54 sc1
s_mov_b64 exec, -1
k_s8_104:
s_mul_i32 s52, s3, 640
v_lshrrev_b32 v8, 4, v0
v_add_u32 v8, s52, v8
s_mov_b32 s53, 52429
v_add_u32 v9, 0, v8
v_mul_u32_u24 v10, s53, v9
v_lshrrev_b32 v10, 22, v10
v_mul_u32_u24 v11, 80, v10
v_sub_u32 v9, v9, v11
v_and_b32 v11, 15, v10
v_xor_b32 v9, v9, v11
v_and_b32 v11, 1, v10
v_bfe_u32 v12, v10, 1, 1
v_lshl_add_u32 v11, v12, 4, v11
v_bfe_u32 v12, v10, 2, 1
v_lshl_add_u32 v11, v12, 6, v11
v_bfe_u32 v12, v10, 3, 1
v_lshl_add_u32 v11, v12, 1, v11
v_bfe_u32 v12, v10, 4, 1
v_lshl_add_u32 v10, v12, 3, v11
v_mul_u32_u24 v10, 1280, v10
v_lshl_add_u32 v72, v9, 4, v10
v_add_u32 v9, 64, v8
v_mul_u32_u24 v10, s53, v9
v_lshrrev_b32 v10, 22, v10
v_mul_u32_u24 v11, 80, v10
v_sub_u32 v9, v9, v11
v_and_b32 v11, 15, v10
v_xor_b32 v9, v9, v11
v_and_b32 v11, 1, v10
v_bfe_u32 v12, v10, 1, 1
v_lshl_add_u32 v11, v12, 4, v11
v_bfe_u32 v12, v10, 2, 1
v_lshl_add_u32 v11, v12, 6, v11
v_bfe_u32 v12, v10, 3, 1
v_lshl_add_u32 v11, v12, 1, v11
v_bfe_u32 v12, v10, 4, 1
v_lshl_add_u32 v10, v12, 3, v11
v_mul_u32_u24 v10, 1280, v10
v_lshl_add_u32 v73, v9, 4, v10
v_add_u32 v9, 128, v8
v_mul_u32_u24 v10, s53, v9
v_lshrrev_b32 v10, 22, v10
v_mul_u32_u24 v11, 80, v10
v_sub_u32 v9, v9, v11
v_and_b32 v11, 15, v10
v_xor_b32 v9, v9, v11
v_and_b32 v11, 1, v10
v_bfe_u32 v12, v10, 1, 1
v_lshl_add_u32 v11, v12, 4, v11
v_bfe_u32 v12, v10, 2, 1
v_lshl_add_u32 v11, v12, 6, v11
v_bfe_u32 v12, v10, 3, 1
v_lshl_add_u32 v11, v12, 1, v11
v_bfe_u32 v12, v10, 4, 1
v_lshl_add_u32 v10, v12, 3, v11
v_mul_u32_u24 v10, 1280, v10
v_lshl_add_u32 v74, v9, 4, v10
v_add_u32 v9, 192, v8
v_mul_u32_u24 v10, s53, v9
v_lshrrev_b32 v10, 22, v10
v_mul_u32_u24 v11, 80, v10
v_sub_u32 v9, v9, v11
v_and_b32 v11, 15, v10
v_xor_b32 v9, v9, v11
v_and_b32 v11, 1, v10
v_bfe_u32 v12, v10, 1, 1
v_lshl_add_u32 v11, v12, 4, v11
v_bfe_u32 v12, v10, 2, 1
v_lshl_add_u32 v11, v12, 6, v11
v_bfe_u32 v12, v10, 3, 1
v_lshl_add_u32 v11, v12, 1, v11
v_bfe_u32 v12, v10, 4, 1
v_lshl_add_u32 v10, v12, 3, v11
v_mul_u32_u24 v10, 1280, v10
v_lshl_add_u32 v75, v9, 4, v10
v_add_u32 v9, 256, v8
v_mul_u32_u24 v10, s53, v9
v_lshrrev_b32 v10, 22, v10
v_mul_u32_u24 v11, 80, v10
v_sub_u32 v9, v9, v11
v_and_b32 v11, 15, v10
v_xor_b32 v9, v9, v11
v_and_b32 v11, 1, v10
v_bfe_u32 v12, v10, 1, 1
v_lshl_add_u32 v11, v12, 4, v11
v_bfe_u32 v12, v10, 2, 1
v_lshl_add_u32 v11, v12, 6, v11
v_bfe_u32 v12, v10, 3, 1
v_lshl_add_u32 v11, v12, 1, v11
v_bfe_u32 v12, v10, 4, 1
v_lshl_add_u32 v10, v12, 3, v11
v_mul_u32_u24 v10, 1280, v10
v_lshl_add_u32 v76, v9, 4, v10
v_add_u32 v9, 320, v8
v_mul_u32_u24 v10, s53, v9
v_lshrrev_b32 v10, 22, v10
v_mul_u32_u24 v11, 80, v10
v_sub_u32 v9, v9, v11
v_and_b32 v11, 15, v10
v_xor_b32 v9, v9, v11
v_and_b32 v11, 1, v10
v_bfe_u32 v12, v10, 1, 1
v_lshl_add_u32 v11, v12, 4, v11
v_bfe_u32 v12, v10, 2, 1
v_lshl_add_u32 v11, v12, 6, v11
v_bfe_u32 v12, v10, 3, 1
v_lshl_add_u32 v11, v12, 1, v11
v_bfe_u32 v12, v10, 4, 1
v_lshl_add_u32 v10, v12, 3, v11
v_mul_u32_u24 v10, 1280, v10
v_lshl_add_u32 v77, v9, 4, v10
v_add_u32 v9, 384, v8
v_mul_u32_u24 v10, s53, v9
v_lshrrev_b32 v10, 22, v10
v_mul_u32_u24 v11, 80, v10
v_sub_u32 v9, v9, v11
v_and_b32 v11, 15, v10
v_xor_b32 v9, v9, v11
v_and_b32 v11, 1, v10
v_bfe_u32 v12, v10, 1, 1
v_lshl_add_u32 v11, v12, 4, v11
v_bfe_u32 v12, v10, 2, 1
v_lshl_add_u32 v11, v12, 6, v11
v_bfe_u32 v12, v10, 3, 1
v_lshl_add_u32 v11, v12, 1, v11
v_bfe_u32 v12, v10, 4, 1
v_lshl_add_u32 v10, v12, 3, v11
v_mul_u32_u24 v10, 1280, v10
v_lshl_add_u32 v78, v9, 4, v10
v_add_u32 v9, 448, v8
v_mul_u32_u24 v10, s53, v9
v_lshrrev_b32 v10, 22, v10
v_mul_u32_u24 v11, 80, v10
v_sub_u32 v9, v9, v11
v_and_b32 v11, 15, v10
v_xor_b32 v9, v9, v11
v_and_b32 v11, 1, v10
v_bfe_u32 v12, v10, 1, 1
v_lshl_add_u32 v11, v12, 4, v11
v_bfe_u32 v12, v10, 2, 1
v_lshl_add_u32 v11, v12, 6, v11
v_bfe_u32 v12, v10, 3, 1
v_lshl_add_u32 v11, v12, 1, v11
v_bfe_u32 v12, v10, 4, 1
v_lshl_add_u32 v10, v12, 3, v11
v_mul_u32_u24 v10, 1280, v10
v_lshl_add_u32 v79, v9, 4, v10
v_add_u32 v9, 512, v8
v_mul_u32_u24 v10, s53, v9
v_lshrrev_b32 v10, 22, v10
v_mul_u32_u24 v11, 80, v10
v_sub_u32 v9, v9, v11
v_and_b32 v11, 15, v10
v_xor_b32 v9, v9, v11
v_and_b32 v11, 1, v10
v_bfe_u32 v12, v10, 1, 1
v_lshl_add_u32 v11, v12, 4, v11
v_bfe_u32 v12, v10, 2, 1
v_lshl_add_u32 v11, v12, 6, v11
v_bfe_u32 v12, v10, 3, 1
v_lshl_add_u32 v11, v12, 1, v11
v_bfe_u32 v12, v10, 4, 1
v_lshl_add_u32 v10, v12, 3, v11
v_mul_u32_u24 v10, 1280, v10
v_lshl_add_u32 v80, v9, 4, v10
v_add_u32 v9, 576, v8
v_mul_u32_u24 v10, s53, v9
v_lshrrev_b32 v10, 22, v10
v_mul_u32_u24 v11, 80, v10
v_sub_u32 v9, v9, v11
v_and_b32 v11, 15, v10
v_xor_b32 v9, v9, v11
v_and_b32 v11, 1, v10
v_bfe_u32 v12, v10, 1, 1
v_lshl_add_u32 v11, v12, 4, v11
v_bfe_u32 v12, v10, 2, 1
v_lshl_add_u32 v11, v12, 6, v11
v_bfe_u32 v12, v10, 3, 1
v_lshl_add_u32 v11, v12, 1, v11
v_bfe_u32 v12, v10, 4, 1
v_lshl_add_u32 v10, v12, 3, v11
v_mul_u32_u24 v10, 1280, v10
v_lshl_add_u32 v81, v9, 4, v10
s_mul_i32 s49, s57, 327680
s_mov_b32 s46, s49
s_mov_b32 s47, 0
s_lshl_b32 s48, s58, 18
s_lshl_b32 s52, s57, 14
s_add_u32 s48, s48, s52
s_add_u32 s48, s48, 216006656
s_mov_b32 s50, 512
v_bfe_u32 v2, v0, 6, 1
v_bfe_u32 v3, v0, 7, 1
v_and_b32 v1, 0x30, v0
v_lshl_add_u32 v1, v2, 7, v1
v_lshl_add_u32 v1, v3, 6, v1
v_bfe_u32 v2, v0, 8, 1
v_lshl_add_u32 v1, v2, 11, v1
v_bfe_u32 v2, v0, 9, 1
v_lshl_add_u32 v1, v2, 8, v1
s_mul_i32 s45, s3, 10240
s_mov_b32 s44, 0
v_bfe_u32 v8, v0, 4, 5
v_mul_u32_u24 v9, 1280, v8
v_and_b32 v8, 15, v8
v_lshrrev_b32 v10, 9, v0
v_xor_b32 v8, v8, v10
v_xor_b32 v10, 0, v8
v_lshl_add_u32 v64, v10, 4, v9
v_xor_b32 v10, 2, v8
v_lshl_add_u32 v65, v10, 4, v9
v_xor_b32 v10, 4, v8
v_lshl_add_u32 v66, v10, 4, v9
v_xor_b32 v10, 6, v8
v_lshl_add_u32 v67, v10, 4, v9
v_xor_b32 v10, 8, v8
v_lshl_add_u32 v68, v10, 4, v9
v_xor_b32 v10, 10, v8
v_lshl_add_u32 v69, v10, 4, v9
v_xor_b32 v10, 12, v8
v_lshl_add_u32 v70, v10, 4, v9
v_xor_b32 v10, 14, v8
v_lshl_add_u32 v71, v10, 4, v9
s_add_u32 m0, s45, 0
s_nop 0
buffer_load_dwordx4 v72, s[20:23], s46 offen lds
s_add_u32 m0, s45, 1024
s_nop 0
buffer_load_dwordx4 v73, s[20:23], s46 offen lds
s_add_u32 m0, s45, 2048
s_nop 0
buffer_load_dwordx4 v74, s[20:23], s46 offen lds
s_add_u32 m0, s45, 3072
s_nop 0
buffer_load_dwordx4 v75, s[20:23], s46 offen lds
s_add_u32 m0, s45, 4096
s_nop 0
buffer_load_dwordx4 v76, s[20:23], s46 offen lds
s_add_u32 m0, s45, 5120
s_nop 0
buffer_load_dwordx4 v77, s[20:23], s46 offen lds
s_add_u32 m0, s45, 6144
s_nop 0
buffer_load_dwordx4 v78, s[20:23], s46 offen lds
s_add_u32 m0, s45, 7168
s_nop 0
buffer_load_dwordx4 v79, s[20:23], s46 offen lds
s_add_u32 m0, s45, 8192
s_nop 0
buffer_load_dwordx4 v80, s[20:23], s46 offen lds
s_add_u32 m0, s45, 9216
s_nop 0
buffer_load_dwordx4 v81, s[20:23], s46 offen lds
s_add_u32 s45, s45, 40960
s_cmp_ge_u32 s45, 122880
s_cselect_b32 s55, 122880, 0
s_sub_u32 s45, s45, s55
s_add_u32 s47, s47, 1
s_and_b32 s55, s47, 1
s_mul_i32 s46, s55, 5120
s_and_b32 s55, s47, 2
s_mul_i32 s55, s55, 20480
s_add_u32 s46, s46, s55
s_and_b32 s55, s47, 4
s_mul_i32 s55, s55, 40960
s_add_u32 s46, s46, s55
s_add_u32 s46, s46, s49
s_add_u32 m0, s45, 0
s_nop 0
buffer_load_dwordx4 v72, s[20:23], s46 offen lds
s_add_u32 m0, s45, 1024
s_nop 0
buffer_load_dwordx4 v73, s[20:23], s46 offen lds
s_add_u32 m0, s45, 2048
s_nop 0
buffer_load_dwordx4 v74, s[20:23], s46 offen lds
s_add_u32 m0, s45, 3072
s_nop 0
buffer_load_dwordx4 v75, s[20:23], s46 offen lds
s_add_u32 m0, s45, 4096
s_nop 0
buffer_load_dwordx4 v76, s[20:23], s46 offen lds
s_add_u32 m0, s45, 5120
s_nop 0
buffer_load_dwordx4 v77, s[20:23], s46 offen lds
s_add_u32 m0, s45, 6144
s_nop 0
buffer_load_dwordx4 v78, s[20:23], s46 offen lds
s_add_u32 m0, s45, 7168
s_nop 0
buffer_load_dwordx4 v79, s[20:23], s46 offen lds
s_add_u32 m0, s45, 8192
s_nop 0
buffer_load_dwordx4 v80, s[20:23], s46 offen lds
s_add_u32 m0, s45, 9216
s_nop 0
buffer_load_dwordx4 v81, s[20:23], s46 offen lds
s_add_u32 s45, s45, 40960
s_cmp_ge_u32 s45, 122880
s_cselect_b32 s55, 122880, 0
s_sub_u32 s45, s45, s55
s_add_u32 s47, s47, 1
s_and_b32 s55, s47, 1
s_mul_i32 s46, s55, 5120
s_and_b32 s55, s47, 2
s_mul_i32 s55, s55, 20480
s_add_u32 s46, s46, s55
s_and_b32 s55, s47, 4
s_mul_i32 s55, s55, 40960
s_add_u32 s46, s46, s55
s_add_u32 s46, s46, s49
s_waitcnt vmcnt(10)
s_barrier
ds_read_b128 v[8:11], v64 offset:0
ds_read_b128 v[12:15], v65 offset:0
ds_read_b128 v[16:19], v66 offset:0
ds_read_b128 v[20:23], v67 offset:0
s_mov_b32 s59, 4
s_waitcnt lgkmcnt(3)
v_mfma_f32_32x32x16_bf16 v[32:47], v[8:11], v[96:99], 0
s_waitcnt lgkmcnt(2)
ds_read_b128 v[24:27], v68 offset:0
v_mfma_f32_32x32x16_bf16 v[32:47], v[12:15], v[100:103], v[32:47]
s_waitcnt lgkmcnt(2)
ds_read_b128 v[8:11], v69 offset:0
s_add_u32 m0, s45, 0
s_nop 0
buffer_load_dwordx4 v72, s[20:23], s46 offen lds
s_add_u32 m0, s45, 1024
s_nop 0
buffer_load_dwordx4 v73, s[20:23], s46 offen lds
v_mfma_f32_32x32x16_bf16 v[32:47], v[16:19], v[104:107], v[32:47]
s_waitcnt lgkmcnt(2)
ds_read_b128 v[12:15], v70 offset:0
s_add_u32 m0, s45, 2048
s_nop 0
buffer_load_dwordx4 v74, s[20:23], s46 offen lds
s_add_u32 m0, s45, 3072
s_nop 0
buffer_load_dwordx4 v75, s[20:23], s46 offen lds
v_mfma_f32_32x32x16_bf16 v[32:47], v[20:23], v[108:111], v[32:47]
s_waitcnt lgkmcnt(2)
ds_read_b128 v[16:19], v71 offset:0
s_add_u32 m0, s45, 4096
s_nop 0
buffer_load_dwordx4 v76, s[20:23], s46 offen lds
s_add_u32 m0, s45, 5120
s_nop 0
buffer_load_dwordx4 v77, s[20:23], s46 offen lds
v_mfma_f32_32x32x16_bf16 v[32:47], v[24:27], v[112:115], v[32:47]
s_waitcnt lgkmcnt(2)
ds_read_b128 v[20:23], v64 offset:256
s_add_u32 m0, s45, 6144
s_nop 0
buffer_load_dwordx4 v78, s[20:23], s46 offen lds
s_add_u32 m0, s45, 7168
s_nop 0
buffer_load_dwordx4 v79, s[20:23], s46 offen lds
v_mfma_f32_32x32x16_bf16 v[32:47], v[8:11], v[116:119], v[32:47]
s_waitcnt lgkmcnt(2)
ds_read_b128 v[24:27], v65 offset:256
s_add_u32 m0, s45, 8192
s_nop 0
buffer_load_dwordx4 v80, s[20:23], s46 offen lds
s_add_u32 m0, s45, 9216
s_nop 0
buffer_load_dwordx4 v81, s[20:23], s46 offen lds
v_mfma_f32_32x32x16_bf16 v[32:47], v[12:15], v[120:123], v[32:47]
s_waitcnt lgkmcnt(2)
ds_read_b128 v[8:11], v66 offset:256
s_add_u32 s45, s45, 40960
s_cmp_ge_u32 s45, 122880
s_cselect_b32 s55, 122880, 0
s_sub_u32 s45, s45, s55
s_add_u32 s47, s47, 1
s_and_b32 s55, s47, 1
s_mul_i32 s46, s55, 5120
s_and_b32 s55, s47, 2
s_mul_i32 s55, s55, 20480
s_add_u32 s46, s46, s55
s_and_b32 s55, s47, 4
s_mul_i32 s55, s55, 40960
s_add_u32 s46, s46, s55
s_add_u32 s46, s46, s49
v_mfma_f32_32x32x16_bf16 v[32:47], v[16:19], v[124:127], v[32:47]
s_waitcnt lgkmcnt(2)
ds_read_b128 v[12:15], v67 offset:256
v_mfma_f32_32x32x16_bf16 v[32:47], v[20:23], v[128:131], v[32:47]
s_waitcnt lgkmcnt(2)
ds_read_b128 v[16:19], v68 offset:256
v_mfma_f32_32x32x16_bf16 v[32:47], v[24:27], v[132:135], v[32:47]
s_waitcnt lgkmcnt(2)
ds_read_b128 v[20:23], v69 offset:256
v_mfma_f32_32x32x16_bf16 v[32:47], v[8:11], v[136:139], v[32:47]
s_waitcnt lgkmcnt(2)
ds_read_b128 v[24:27], v70 offset:256
v_mfma_f32_32x32x16_bf16 v[32:47], v[12:15], v[140:143], v[32:47]
s_waitcnt lgkmcnt(2)
ds_read_b128 v[8:11], v71 offset:256
v_mfma_f32_32x32x16_bf16 v[32:47], v[16:19], v[144:147], v[32:47]
s_waitcnt lgkmcnt(2)
ds_read_b128 v[12:15], v64 offset:512
v_mfma_f32_32x32x16_bf16 v[32:47], v[20:23], v[148:151], v[32:47]
s_waitcnt lgkmcnt(2)
ds_read_b128 v[16:19], v65 offset:512
v_mfma_f32_32x32x16_bf16 v[32:47], v[24:27], v[152:155], v[32:47]
s_waitcnt lgkmcnt(2)
ds_read_b128 v[20:23], v66 offset:512
v_mfma_f32_32x32x16_bf16 v[32:47], v[8:11], v[156:159], v[32:47]
s_waitcnt lgkmcnt(2)
ds_read_b128 v[24:27], v67 offset:512
v_mfma_f32_32x32x16_bf16 v[32:47], v[12:15], v[160:163], v[32:47]
s_waitcnt lgkmcnt(2)
ds_read_b128 v[8:11], v68 offset:512
v_mfma_f32_32x32x16_bf16 v[32:47], v[16:19], v[164:167], v[32:47]
s_waitcnt lgkmcnt(2)
ds_read_b128 v[12:15], v69 offset:512
v_mfma_f32_32x32x16_bf16 v[32:47], v[20:23], v[168:171], v[32:47]
s_waitcnt lgkmcnt(2)
ds_read_b128 v[16:19], v70 offset:512
v_mfma_f32_32x32x16_bf16 v[32:47], v[24:27], v[172:175], v[32:47]
s_waitcnt lgkmcnt(2)
ds_read_b128 v[20:23], v71 offset:512
v_mfma_f32_32x32x16_bf16 v[32:47], v[8:11], v[176:179], v[32:47]
s_waitcnt lgkmcnt(2)
ds_read_b128 v[24:27], v64 offset:768
v_mfma_f32_32x32x16_bf16 v[32:47], v[12:15], v[180:183], v[32:47]
s_waitcnt lgkmcnt(2)
ds_read_b128 v[8:11], v65 offset:768
v_mfma_f32_32x32x16_bf16 v[32:47], v[16:19], v[184:187], v[32:47]
s_waitcnt lgkmcnt(2)
ds_read_b128 v[12:15], v66 offset:768
v_mfma_f32_32x32x16_bf16 v[32:47], v[20:23], v[188:191], v[32:47]
s_waitcnt lgkmcnt(2)
ds_read_b128 v[16:19], v67 offset:768
v_mfma_f32_32x32x16_bf16 v[32:47], v[24:27], v[192:195], v[32:47]
s_waitcnt lgkmcnt(2)
ds_read_b128 v[20:23], v68 offset:768
v_mfma_f32_32x32x16_bf16 v[32:47], v[8:11], v[196:199], v[32:47]
s_waitcnt lgkmcnt(2)
ds_read_b128 v[24:27], v69 offset:768
v_mfma_f32_32x32x16_bf16 v[32:47], v[12:15], v[200:203], v[32:47]
s_waitcnt lgkmcnt(2)
ds_read_b128 v[8:11], v70 offset:768
v_mfma_f32_32x32x16_bf16 v[32:47], v[16:19], v[204:207], v[32:47]
s_waitcnt lgkmcnt(2)
ds_read_b128 v[12:15], v71 offset:768
v_mfma_f32_32x32x16_bf16 v[32:47], v[20:23], v[208:211], v[32:47]
s_waitcnt lgkmcnt(2)
ds_read_b128 v[16:19], v64 offset:1024
v_mfma_f32_32x32x16_bf16 v[32:47], v[24:27], v[212:215], v[32:47]
s_waitcnt lgkmcnt(2)
ds_read_b128 v[20:23], v65 offset:1024
v_mfma_f32_32x32x16_bf16 v[32:47], v[8:11], v[216:219], v[32:47]
s_waitcnt lgkmcnt(2)
ds_read_b128 v[24:27], v66 offset:1024
v_mfma_f32_32x32x16_bf16 v[32:47], v[12:15], v[220:223], v[32:47]
s_waitcnt lgkmcnt(2)
ds_read_b128 v[8:11], v67 offset:1024
v_mfma_f32_32x32x16_bf16 v[32:47], v[16:19], v[224:227], v[32:47]
s_waitcnt lgkmcnt(2)
ds_read_b128 v[12:15], v68 offset:1024
v_mfma_f32_32x32x16_bf16 v[32:47], v[20:23], v[228:231], v[32:47]
s_waitcnt lgkmcnt(2)
ds_read_b128 v[16:19], v69 offset:1024
v_mfma_f32_32x32x16_bf16 v[32:47], v[24:27], v[232:235], v[32:47]
s_waitcnt lgkmcnt(2)
ds_read_b128 v[20:23], v70 offset:1024
v_mfma_f32_32x32x16_bf16 v[32:47], v[8:11], v[236:239], v[32:47]
s_waitcnt lgkmcnt(2)
ds_read_b128 v[24:27], v71 offset:1024
v_mfma_f32_32x32x16_bf16 v[32:47], v[12:15], v[240:243], v[32:47]
s_add_u32 s44, s44, 1
s_cmp_eq_u32 s44, 3
s_mov_b32 s56, 40960
s_cmov_b32 s56, -81920
s_cselect_b32 s44, 0, s44
v_add_u32 v64, s56, v64
v_add_u32 v65, s56, v65
v_add_u32 v66, s56, v66
v_add_u32 v67, s56, v67
v_add_u32 v68, s56, v68
v_add_u32 v69, s56, v69
v_add_u32 v70, s56, v70
v_add_u32 v71, s56, v71
s_waitcnt vmcnt(10) lgkmcnt(2)
s_barrier
ds_read_b128 v[8:11], v64 offset:0
v_mfma_f32_32x32x16_bf16 v[32:47], v[16:19], v[244:247], v[32:47]
s_waitcnt lgkmcnt(2)
ds_read_b128 v[12:15], v65 offset:0
v_mfma_f32_32x32x16_bf16 v[32:47], v[20:23], v[248:251], v[32:47]
s_waitcnt lgkmcnt(2)
ds_read_b128 v[16:19], v66 offset:0
v_mfma_f32_32x32x16_bf16 v[32:47], v[24:27], v[252:255], v[32:47]
s_waitcnt lgkmcnt(2)
ds_read_b128 v[20:23], v67 offset:0
k_st_105:
v_mfma_f32_32x32x16_bf16 v[48:63], v[8:11], v[96:99], 0
s_waitcnt lgkmcnt(2)
ds_read_b128 v[24:27], v68 offset:0
v_mfma_f32_32x32x16_bf16 v[48:63], v[12:15], v[100:103], v[48:63]
s_waitcnt lgkmcnt(2)
ds_read_b128 v[8:11], v69 offset:0
v_cvt_pk_bf16_f32 v32, v32, v33
v_cvt_pk_bf16_f32 v33, v34, v35
v_mfma_f32_32x32x16_bf16 v[48:63], v[16:19], v[104:107], v[48:63]
s_waitcnt lgkmcnt(2)
ds_read_b128 v[12:15], v70 offset:0
v_cvt_pk_bf16_f32 v34, v36, v37
v_cvt_pk_bf16_f32 v35, v38, v39
v_mfma_f32_32x32x16_bf16 v[48:63], v[20:23], v[108:111], v[48:63]
s_waitcnt lgkmcnt(2)
ds_read_b128 v[16:19], v71 offset:0
v_cvt_pk_bf16_f32 v36, v40, v41
v_cvt_pk_bf16_f32 v37, v42, v43
v_mfma_f32_32x32x16_bf16 v[48:63], v[24:27], v[112:115], v[48:63]
s_waitcnt lgkmcnt(2)
ds_read_b128 v[20:23], v64 offset:256
v_cvt_pk_bf16_f32 v38, v44, v45
v_cvt_pk_bf16_f32 v39, v46, v47
v_mfma_f32_32x32x16_bf16 v[48:63], v[8:11], v[116:119], v[48:63]
s_waitcnt lgkmcnt(2)
ds_read_b128 v[24:27], v65 offset:256
buffer_store_dwordx4 v[32:35], v1, s[4:7], s48 offen offset:0 sc1
buffer_store_dwordx4 v[36:39], v1, s[4:7], s48 offen offset:1024 sc1
v_mfma_f32_32x32x16_bf16 v[48:63], v[12:15], v[120:123], v[48:63]
s_waitcnt lgkmcnt(2)
ds_read_b128 v[8:11], v66 offset:256
s_add_u32 s48, s48, s50
s_sub_u32 s50, 4096, s50
s_add_u32 m0, s45, 0
s_nop 0
buffer_load_dwordx4 v72, s[20:23], s46 offen lds
v_mfma_f32_32x32x16_bf16 v[48:63], v[16:19], v[124:127], v[48:63]
s_waitcnt lgkmcnt(2)
ds_read_b128 v[12:15], v67 offset:256
s_add_u32 m0, s45, 1024
s_nop 0
buffer_load_dwordx4 v73, s[20:23], s46 offen lds
s_add_u32 m0, s45, 2048
s_nop 0
buffer_load_dwordx4 v74, s[20:23], s46 offen lds
v_mfma_f32_32x32x16_bf16 v[48:63], v[20:23], v[128:131], v[48:63]
s_waitcnt lgkmcnt(2)
ds_read_b128 v[16:19], v68 offset:256
s_add_u32 m0, s45, 3072
s_nop 0
buffer_load_dwordx4 v75, s[20:23], s46 offen lds
s_add_u32 m0, s45, 4096
s_nop 0
buffer_load_dwordx4 v76, s[20:23], s46 offen lds
v_mfma_f32_32x32x16_bf16 v[48:63], v[24:27], v[132:135], v[48:63]
s_waitcnt lgkmcnt(2)
ds_read_b128 v[20:23], v69 offset:256
s_add_u32 m0, s45, 5120
s_nop 0
buffer_load_dwordx4 v77, s[20:23], s46 offen lds
s_add_u32 m0, s45, 6144
s_nop 0
buffer_load_dwordx4 v78, s[20:23], s46 offen lds
v_mfma_f32_32x32x16_bf16 v[48:63], v[8:11], v[136:139], v[48:63]
s_waitcnt lgkmcnt(2)
ds_read_b128 v[24:27], v70 offset:256
s_add_u32 m0, s45, 7168
s_nop 0
buffer_load_dwordx4 v79, s[20:23], s46 offen lds
s_add_u32 m0, s45, 8192
s_nop 0
buffer_load_dwordx4 v80, s[20:23], s46 offen lds
v_mfma_f32_32x32x16_bf16 v[48:63], v[12:15], v[140:143], v[48:63]
s_waitcnt lgkmcnt(2)
ds_read_b128 v[8:11], v71 offset:256
s_add_u32 m0, s45, 9216
s_nop 0
buffer_load_dwordx4 v81, s[20:23], s46 offen lds
s_add_u32 s45, s45, 40960
s_cmp_ge_u32 s45, 122880
s_cselect_b32 s55, 122880, 0
s_sub_u32 s45, s45, s55
v_mfma_f32_32x32x16_bf16 v[48:63], v[16:19], v[144:147], v[48:63]
s_waitcnt lgkmcnt(2)
ds_read_b128 v[12:15], v64 offset:512
s_add_u32 s47, s47, 1
s_and_b32 s55, s47, 1
s_mul_i32 s46, s55, 5120
s_and_b32 s55, s47, 2
s_mul_i32 s55, s55, 20480
s_add_u32 s46, s46, s55
s_and_b32 s55, s47, 4
s_mul_i32 s55, s55, 40960
s_add_u32 s46, s46, s55
s_add_u32 s46, s46, s49
v_mfma_f32_32x32x16_bf16 v[48:63], v[20:23], v[148:151], v[48:63]
s_waitcnt lgkmcnt(2)
ds_read_b128 v[16:19], v65 offset:512
v_mfma_f32_32x32x16_bf16 v[48:63], v[24:27], v[152:155], v[48:63]
s_waitcnt lgkmcnt(2)
ds_read_b128 v[20:23], v66 offset:512
v_mfma_f32_32x32x16_bf16 v[48:63], v[8:11], v[156:159], v[48:63]
s_waitcnt lgkmcnt(2)
ds_read_b128 v[24:27], v67 offset:512
v_mfma_f32_32x32x16_bf16 v[48:63], v[12:15], v[160:163], v[48:63]
s_waitcnt lgkmcnt(2)
ds_read_b128 v[8:11], v68 offset:512
v_mfma_f32_32x32x16_bf16 v[48:63], v[16:19], v[164:167], v[48:63]
s_waitcnt lgkmcnt(2)
ds_read_b128 v[12:15], v69 offset:512
v_mfma_f32_32x32x16_bf16 v[48:63], v[20:23], v[168:171], v[48:63]
s_waitcnt lgkmcnt(2)
ds_read_b128 v[16:19], v70 offset:512
v_mfma_f32_32x32x16_bf16 v[48:63], v[24:27], v[172:175], v[48:63]
s_waitcnt lgkmcnt(2)
ds_read_b128 v[20:23], v71 offset:512
v_mfma_f32_32x32x16_bf16 v[48:63], v[8:11], v[176:179], v[48:63]
s_waitcnt lgkmcnt(2)
ds_read_b128 v[24:27], v64 offset:768
v_mfma_f32_32x32x16_bf16 v[48:63], v[12:15], v[180:183], v[48:63]
s_waitcnt lgkmcnt(2)
ds_read_b128 v[8:11], v65 offset:768
v_mfma_f32_32x32x16_bf16 v[48:63], v[16:19], v[184:187], v[48:63]
s_waitcnt lgkmcnt(2)
ds_read_b128 v[12:15], v66 offset:768
v_mfma_f32_32x32x16_bf16 v[48:63], v[20:23], v[188:191], v[48:63]
s_waitcnt lgkmcnt(2)
ds_read_b128 v[16:19], v67 offset:768
v_mfma_f32_32x32x16_bf16 v[48:63], v[24:27], v[192:195], v[48:63]
s_waitcnt lgkmcnt(2)
ds_read_b128 v[20:23], v68 offset:768
v_mfma_f32_32x32x16_bf16 v[48:63], v[8:11], v[196:199], v[48:63]
s_waitcnt lgkmcnt(2)
ds_read_b128 v[24:27], v69 offset:768
v_mfma_f32_32x32x16_bf16 v[48:63], v[12:15], v[200:203], v[48:63]
s_waitcnt lgkmcnt(2)
ds_read_b128 v[8:11], v70 offset:768
v_mfma_f32_32x32x16_bf16 v[48:63], v[16:19], v[204:207], v[48:63]
s_waitcnt lgkmcnt(2)
ds_read_b128 v[12:15], v71 offset:768
v_mfma_f32_32x32x16_bf16 v[48:63], v[20:23], v[208:211], v[48:63]
s_waitcnt lgkmcnt(2)
ds_read_b128 v[16:19], v64 offset:1024
v_mfma_f32_32x32x16_bf16 v[48:63], v[24:27], v[212:215], v[48:63]
s_waitcnt lgkmcnt(2)
ds_read_b128 v[20:23], v65 offset:1024
v_mfma_f32_32x32x16_bf16 v[48:63], v[8:11], v[216:219], v[48:63]
s_waitcnt lgkmcnt(2)
ds_read_b128 v[24:27], v66 offset:1024
v_mfma_f32_32x32x16_bf16 v[48:63], v[12:15], v[220:223], v[48:63]
s_waitcnt lgkmcnt(2)
ds_read_b128 v[8:11], v67 offset:1024
v_mfma_f32_32x32x16_bf16 v[48:63], v[16:19], v[224:227], v[48:63]
s_waitcnt lgkmcnt(2)
ds_read_b128 v[12:15], v68 offset:1024
v_mfma_f32_32x32x16_bf16 v[48:63], v[20:23], v[228:231], v[48:63]
s_waitcnt lgkmcnt(2)
ds_read_b128 v[16:19], v69 offset:1024
v_mfma_f32_32x32x16_bf16 v[48:63], v[24:27], v[232:235], v[48:63]
s_waitcnt lgkmcnt(2)
ds_read_b128 v[20:23], v70 offset:1024
v_mfma_f32_32x32x16_bf16 v[48:63], v[8:11], v[236:239], v[48:63]
s_waitcnt lgkmcnt(2)
ds_read_b128 v[24:27], v71 offset:1024
v_mfma_f32_32x32x16_bf16 v[48:63], v[12:15], v[240:243], v[48:63]
s_add_u32 s44, s44, 1
s_cmp_eq_u32 s44, 3
s_mov_b32 s56, 40960
s_cmov_b32 s56, -81920
s_cselect_b32 s44, 0, s44
v_add_u32 v64, s56, v64
v_add_u32 v65, s56, v65
v_add_u32 v66, s56, v66
v_add_u32 v67, s56, v67
v_add_u32 v68, s56, v68
v_add_u32 v69, s56, v69
v_add_u32 v70, s56, v70
v_add_u32 v71, s56, v71
s_waitcnt vmcnt(10) lgkmcnt(2)
s_barrier
ds_read_b128 v[8:11], v64 offset:0
v_mfma_f32_32x32x16_bf16 v[48:63], v[16:19], v[244:247], v[48:63]
s_waitcnt lgkmcnt(2)
ds_read_b128 v[12:15], v65 offset:0
v_mfma_f32_32x32x16_bf16 v[48:63], v[20:23], v[248:251], v[48:63]
s_waitcnt lgkmcnt(2)
ds_read_b128 v[16:19], v66 offset:0
v_mfma_f32_32x32x16_bf16 v[48:63], v[24:27], v[252:255], v[48:63]
s_waitcnt lgkmcnt(2)
ds_read_b128 v[20:23], v67 offset:0
k_sm_107:
s_sub_u32 s59, s59, 1
s_cmp_eq_u32 s59, 0
s_cbranch_scc1 k_so_106
v_mfma_f32_32x32x16_bf16 v[32:47], v[8:11], v[96:99], 0
s_waitcnt lgkmcnt(2)
ds_read_b128 v[24:27], v68 offset:0
v_mfma_f32_32x32x16_bf16 v[32:47], v[12:15], v[100:103], v[32:47]
s_waitcnt lgkmcnt(2)
ds_read_b128 v[8:11], v69 offset:0
v_cvt_pk_bf16_f32 v48, v48, v49
v_cvt_pk_bf16_f32 v49, v50, v51
v_mfma_f32_32x32x16_bf16 v[32:47], v[16:19], v[104:107], v[32:47]
s_waitcnt lgkmcnt(2)
ds_read_b128 v[12:15], v70 offset:0
v_cvt_pk_bf16_f32 v50, v52, v53
v_cvt_pk_bf16_f32 v51, v54, v55
v_mfma_f32_32x32x16_bf16 v[32:47], v[20:23], v[108:111], v[32:47]
s_waitcnt lgkmcnt(2)
ds_read_b128 v[16:19], v71 offset:0
v_cvt_pk_bf16_f32 v52, v56, v57
v_cvt_pk_bf16_f32 v53, v58, v59
v_mfma_f32_32x32x16_bf16 v[32:47], v[24:27], v[112:115], v[32:47]
s_waitcnt lgkmcnt(2)
ds_read_b128 v[20:23], v64 offset:256
v_cvt_pk_bf16_f32 v54, v60, v61
v_cvt_pk_bf16_f32 v55, v62, v63
v_mfma_f32_32x32x16_bf16 v[32:47], v[8:11], v[116:119], v[32:47]
s_waitcnt lgkmcnt(2)
ds_read_b128 v[24:27], v65 offset:256
buffer_store_dwordx4 v[48:51], v1, s[4:7], s48 offen offset:0 sc1
buffer_store_dwordx4 v[52:55], v1, s[4:7], s48 offen offset:1024 sc1
v_mfma_f32_32x32x16_bf16 v[32:47], v[12:15], v[120:123], v[32:47]
s_waitcnt lgkmcnt(2)
ds_read_b128 v[8:11], v66 offset:256
s_add_u32 s48, s48, s50
s_sub_u32 s50, 4096, s50
s_add_u32 m0, s45, 0
s_nop 0
buffer_load_dwordx4 v72, s[20:23], s46 offen lds
v_mfma_f32_32x32x16_bf16 v[32:47], v[16:19], v[124:127], v[32:47]
s_waitcnt lgkmcnt(2)
ds_read_b128 v[12:15], v67 offset:256
s_add_u32 m0, s45, 1024
s_nop 0
buffer_load_dwordx4 v73, s[20:23], s46 offen lds
s_add_u32 m0, s45, 2048
s_nop 0
buffer_load_dwordx4 v74, s[20:23], s46 offen lds
v_mfma_f32_32x32x16_bf16 v[32:47], v[20:23], v[128:131], v[32:47]
s_waitcnt lgkmcnt(2)
ds_read_b128 v[16:19], v68 offset:256
s_add_u32 m0, s45, 3072
s_nop 0
buffer_load_dwordx4 v75, s[20:23], s46 offen lds
s_add_u32 m0, s45, 4096
s_nop 0
buffer_load_dwordx4 v76, s[20:23], s46 offen lds
v_mfma_f32_32x32x16_bf16 v[32:47], v[24:27], v[132:135], v[32:47]
s_waitcnt lgkmcnt(2)
ds_read_b128 v[20:23], v69 offset:256
s_add_u32 m0, s45, 5120
s_nop 0
buffer_load_dwordx4 v77, s[20:23], s46 offen lds
s_add_u32 m0, s45, 6144
s_nop 0
buffer_load_dwordx4 v78, s[20:23], s46 offen lds
v_mfma_f32_32x32x16_bf16 v[32:47], v[8:11], v[136:139], v[32:47]
s_waitcnt lgkmcnt(2)
ds_read_b128 v[24:27], v70 offset:256
s_add_u32 m0, s45, 7168
s_nop 0
buffer_load_dwordx4 v79, s[20:23], s46 offen lds
s_add_u32 m0, s45, 8192
s_nop 0
buffer_load_dwordx4 v80, s[20:23], s46 offen lds
v_mfma_f32_32x32x16_bf16 v[32:47], v[12:15], v[140:143], v[32:47]
s_waitcnt lgkmcnt(2)
ds_read_b128 v[8:11], v71 offset:256
s_add_u32 m0, s45, 9216
s_nop 0
buffer_load_dwordx4 v81, s[20:23], s46 offen lds
s_add_u32 s45, s45, 40960
s_cmp_ge_u32 s45, 122880
s_cselect_b32 s55, 122880, 0
s_sub_u32 s45, s45, s55
v_mfma_f32_32x32x16_bf16 v[32:47], v[16:19], v[144:147], v[32:47]
s_waitcnt lgkmcnt(2)
ds_read_b128 v[12:15], v64 offset:512
s_add_u32 s47, s47, 1
s_and_b32 s55, s47, 1
s_mul_i32 s46, s55, 5120
s_and_b32 s55, s47, 2
s_mul_i32 s55, s55, 20480
s_add_u32 s46, s46, s55
s_and_b32 s55, s47, 4
s_mul_i32 s55, s55, 40960
s_add_u32 s46, s46, s55
s_add_u32 s46, s46, s49
v_mfma_f32_32x32x16_bf16 v[32:47], v[20:23], v[148:151], v[32:47]
s_waitcnt lgkmcnt(2)
ds_read_b128 v[16:19], v65 offset:512
v_mfma_f32_32x32x16_bf16 v[32:47], v[24:27], v[152:155], v[32:47]
s_waitcnt lgkmcnt(2)
ds_read_b128 v[20:23], v66 offset:512
v_mfma_f32_32x32x16_bf16 v[32:47], v[8:11], v[156:159], v[32:47]
s_waitcnt lgkmcnt(2)
ds_read_b128 v[24:27], v67 offset:512
v_mfma_f32_32x32x16_bf16 v[32:47], v[12:15], v[160:163], v[32:47]
s_waitcnt lgkmcnt(2)
ds_read_b128 v[8:11], v68 offset:512
v_mfma_f32_32x32x16_bf16 v[32:47], v[16:19], v[164:167], v[32:47]
s_waitcnt lgkmcnt(2)
ds_read_b128 v[12:15], v69 offset:512
v_mfma_f32_32x32x16_bf16 v[32:47], v[20:23], v[168:171], v[32:47]
s_waitcnt lgkmcnt(2)
ds_read_b128 v[16:19], v70 offset:512
v_mfma_f32_32x32x16_bf16 v[32:47], v[24:27], v[172:175], v[32:47]
s_waitcnt lgkmcnt(2)
ds_read_b128 v[20:23], v71 offset:512
v_mfma_f32_32x32x16_bf16 v[32:47], v[8:11], v[176:179], v[32:47]
s_waitcnt lgkmcnt(2)
ds_read_b128 v[24:27], v64 offset:768
v_mfma_f32_32x32x16_bf16 v[32:47], v[12:15], v[180:183], v[32:47]
s_waitcnt lgkmcnt(2)
ds_read_b128 v[8:11], v65 offset:768
v_mfma_f32_32x32x16_bf16 v[32:47], v[16:19], v[184:187], v[32:47]
s_waitcnt lgkmcnt(2)
ds_read_b128 v[12:15], v66 offset:768
v_mfma_f32_32x32x16_bf16 v[32:47], v[20:23], v[188:191], v[32:47]
s_waitcnt lgkmcnt(2)
ds_read_b128 v[16:19], v67 offset:768
v_mfma_f32_32x32x16_bf16 v[32:47], v[24:27], v[192:195], v[32:47]
s_waitcnt lgkmcnt(2)
ds_read_b128 v[20:23], v68 offset:768
v_mfma_f32_32x32x16_bf16 v[32:47], v[8:11], v[196:199], v[32:47]
s_waitcnt lgkmcnt(2)
ds_read_b128 v[24:27], v69 offset:768
v_mfma_f32_32x32x16_bf16 v[32:47], v[12:15], v[200:203], v[32:47]
s_waitcnt lgkmcnt(2)
ds_read_b128 v[8:11], v70 offset:768
v_mfma_f32_32x32x16_bf16 v[32:47], v[16:19], v[204:207], v[32:47]
s_waitcnt lgkmcnt(2)
ds_read_b128 v[12:15], v71 offset:768
v_mfma_f32_32x32x16_bf16 v[32:47], v[20:23], v[208:211], v[32:47]
s_waitcnt lgkmcnt(2)
ds_read_b128 v[16:19], v64 offset:1024
v_mfma_f32_32x32x16_bf16 v[32:47], v[24:27], v[212:215], v[32:47]
s_waitcnt lgkmcnt(2)
ds_read_b128 v[20:23], v65 offset:1024
v_mfma_f32_32x32x16_bf16 v[32:47], v[8:11], v[216:219], v[32:47]
s_waitcnt lgkmcnt(2)
ds_read_b128 v[24:27], v66 offset:1024
v_mfma_f32_32x32x16_bf16 v[32:47], v[12:15], v[220:223], v[32:47]
s_waitcnt lgkmcnt(2)
ds_read_b128 v[8:11], v67 offset:1024
v_mfma_f32_32x32x16_bf16 v[32:47], v[16:19], v[224:227], v[32:47]
s_waitcnt lgkmcnt(2)
ds_read_b128 v[12:15], v68 offset:1024
v_mfma_f32_32x32x16_bf16 v[32:47], v[20:23], v[228:231], v[32:47]
s_waitcnt lgkmcnt(2)
ds_read_b128 v[16:19], v69 offset:1024
v_mfma_f32_32x32x16_bf16 v[32:47], v[24:27], v[232:235], v[32:47]
s_waitcnt lgkmcnt(2)
ds_read_b128 v[20:23], v70 offset:1024
v_mfma_f32_32x32x16_bf16 v[32:47], v[8:11], v[236:239], v[32:47]
s_waitcnt lgkmcnt(2)
ds_read_b128 v[24:27], v71 offset:1024
v_mfma_f32_32x32x16_bf16 v[32:47], v[12:15], v[240:243], v[32:47]
s_add_u32 s44, s44, 1
s_cmp_eq_u32 s44, 3
s_mov_b32 s56, 40960
s_cmov_b32 s56, -81920
s_cselect_b32 s44, 0, s44
v_add_u32 v64, s56, v64
v_add_u32 v65, s56, v65
v_add_u32 v66, s56, v66
v_add_u32 v67, s56, v67
v_add_u32 v68, s56, v68
v_add_u32 v69, s56, v69
v_add_u32 v70, s56, v70
v_add_u32 v71, s56, v71
s_waitcnt vmcnt(10) lgkmcnt(2)
s_barrier
ds_read_b128 v[8:11], v64 offset:0
v_mfma_f32_32x32x16_bf16 v[32:47], v[16:19], v[244:247], v[32:47]
s_waitcnt lgkmcnt(2)
ds_read_b128 v[12:15], v65 offset:0
v_mfma_f32_32x32x16_bf16 v[32:47], v[20:23], v[248:251], v[32:47]
s_waitcnt lgkmcnt(2)
ds_read_b128 v[16:19], v66 offset:0
v_mfma_f32_32x32x16_bf16 v[32:47], v[24:27], v[252:255], v[32:47]
s_waitcnt lgkmcnt(2)
ds_read_b128 v[20:23], v67 offset:0
s_branch k_st_105
k_so_106:
s_nop 6
v_cvt_pk_bf16_f32 v48, v48, v49
v_cvt_pk_bf16_f32 v49, v50, v51
v_cvt_pk_bf16_f32 v50, v52, v53
v_cvt_pk_bf16_f32 v51, v54, v55
v_cvt_pk_bf16_f32 v52, v56, v57
v_cvt_pk_bf16_f32 v53, v58, v59
v_cvt_pk_bf16_f32 v54, v60, v61
v_cvt_pk_bf16_f32 v55, v62, v63
buffer_store_dwordx4 v[48:51], v1, s[4:7], s48 offen offset:0 sc1
buffer_store_dwordx4 v[52:55], v1, s[4:7], s48 offen offset:1024 sc1
s_add_u32 s48, s48, s50
s_sub_u32 s50, 4096, s50
s_lshl_b32 s54, s30, 6
s_add_u32 s54, s54, 222322688
s_waitcnt lgkmcnt(0)
s_waitcnt vmcnt(0)
s_barrier
s_cmp_lg_u32 s3, 0
s_cbranch_scc1 k_s8_108
s_mov_b64 exec, 1
v_mov_b32 v2, 1
buffer_store_dword v2, off, s[4:7], s54 sc1
s_mov_b64 exec, -1
k_s8_108:
s_mul_i32 s57, s30, 3277
s_lshr_b32 s57, s57, 16
s_mul_i32 s52, s57, 20
s_sub_u32 s58, s30, s52
s_mov_b32 s54, 222322688
v_add_u32 v10, 4096, v0
v_add_u32 v11, 8192, v0
v_add_u32 v12, 12288, v0
s_cmp_lg_u32 s3, 0
s_cbranch_scc1 k_w8d_110
v_lshlrev_b32 v96, 2, v0
k_w8_109:
buffer_load_dword v97, v96, s[4:7], s54 offen sc1
buffer_load_dword v98, v96, s[4:7], s54 offen offset:1024 sc1
s_waitcnt vmcnt(0)
v_and_b32 v97, v97, v98
v_cmp_eq_u32 vcc, 0, v97
s_cbranch_vccz k_w8d_110
s_sleep 1
s_sub_u32 s32, s32, 1
s_cmp_gt_i32 s32, 0
s_cbranch_scc1 k_w8_109
k_w8d_110:
s_barrier
s_lshl_b32 s52, s58, 2
s_add_u32 s52, s52, s3
s_lshl_b32 s52, s52, 16
s_add_u32 s52, s52, 216006656
buffer_load_dwordx4 a[0:3], v0, s[4:7], s52 offen offset:0 sc1
buffer_load_dwordx4 a[4:7], v0, s[4:7], s52 offen offset:1024 sc1
buffer_load_dwordx4 a[8:11], v0, s[4:7], s52 offen offset:2048 sc1
buffer_load_dwordx4 a[12:15], v0, s[4:7], s52 offen offset:3072 sc1
buffer_load_dwordx4 a[16:19], v10, s[4:7], s52 offen offset:0 sc1
buffer_load_dwordx4 a[20:23], v10, s[4:7], s52 offen offset:1024 sc1
buffer_load_dwordx4 a[24:27], v10, s[4:7], s52 offen offset:2048 sc1
buffer_load_dwordx4 a[28:31], v10, s[4:7], s52 offen offset:3072 sc1
buffer_load_dwordx4 a[32:35], v11, s[4:7], s52 offen offset:0 sc1
buffer_load_dwordx4 a[36:39], v11, s[4:7], s52 offen offset:1024 sc1
buffer_load_dwordx4 a[40:43], v11, s[4:7], s52 offen offset:2048 sc1
buffer_load_dwordx4 a[44:47], v11, s[4:7], s52 offen offset:3072 sc1
buffer_load_dwordx4 a[48:51], v12, s[4:7], s52 offen offset:0 sc1
buffer_load_dwordx4 a[52:55], v12, s[4:7], s52 offen offset:1024 sc1
buffer_load_dwordx4 a[56:59], v12, s[4:7], s52 offen offset:2048 sc1
buffer_load_dwordx4 a[60:63], v12, s[4:7], s52 offen offset:3072 sc1
s_add_u32 s52, s52, 16384
buffer_load_dwordx4 a[64:67], v0, s[4:7], s52 offen offset:0 sc1
buffer_load_dwordx4 a[68:71], v0, s[4:7], s52 offen offset:1024 sc1
buffer_load_dwordx4 a[72:75], v0, s[4:7], s52 offen offset:2048 sc1
buffer_load_dwordx4 a[76:79], v0, s[4:7], s52 offen offset:3072 sc1
buffer_load_dwordx4 a[80:83], v10, s[4:7], s52 offen offset:0 sc1
buffer_load_dwordx4 a[84:87], v10, s[4:7], s52 offen offset:1024 sc1
buffer_load_dwordx4 a[88:91], v10, s[4:7], s52 offen offset:2048 sc1
buffer_load_dwordx4 a[92:95], v10, s[4:7], s52 offen offset:3072 sc1
buffer_load_dwordx4 a[96:99], v11, s[4:7], s52 offen offset:0 sc1
buffer_load_dwordx4 a[100:103], v11, s[4:7], s52 offen offset:1024 sc1
buffer_load_dwordx4 a[104:107], v11, s[4:7], s52 offen offset:2048 sc1
buffer_load_dwordx4 a[108:111], v11, s[4:7], s52 offen offset:3072 sc1
buffer_load_dwordx4 a[112:115], v12, s[4:7], s52 offen offset:0 sc1
buffer_load_dwordx4 a[116:119], v12, s[4:7], s52 offen offset:1024 sc1
buffer_load_dwordx4 a[120:123], v12, s[4:7], s52 offen offset:2048 sc1
buffer_load_dwordx4 a[124:127], v12, s[4:7], s52 offen offset:3072 sc1
s_waitcnt vmcnt(0)
s_add_u32 s52, s52, 16384
buffer_load_dwordx4 a[128:131], v0, s[4:7], s52 offen offset:0 sc1
buffer_load_dwordx4 a[132:135], v0, s[4:7], s52 offen offset:1024 sc1
buffer_load_dwordx4 a[136:139], v0, s[4:7], s52 offen offset:2048 sc1
buffer_load_dwordx4 a[140:143], v0, s[4:7], s52 offen offset:3072 sc1
buffer_load_dwordx4 a[144:147], v10, s[4:7], s52 offen offset:0 sc1
buffer_load_dwordx4 a[148:151], v10, s[4:7], s52 offen offset:1024 sc1
buffer_load_dwordx4 a[152:155], v10, s[4:7], s52 offen offset:2048 sc1
buffer_load_dwordx4 a[156:159], v10, s[4:7], s52 offen offset:3072 sc1
buffer_load_dwordx4 a[160:163], v11, s[4:7], s52 offen offset:0 sc1
buffer_load_dwordx4 a[164:167], v11, s[4:7], s52 offen offset:1024 sc1
buffer_load_dwordx4 a[168:171], v11, s[4:7], s52 offen offset:2048 sc1
buffer_load_dwordx4 a[172:175], v11, s[4:7], s52 offen offset:3072 sc1
buffer_load_dwordx4 a[176:179], v12, s[4:7], s52 offen offset:0 sc1
buffer_load_dwordx4 a[180:183], v12, s[4:7], s52 offen offset:1024 sc1
buffer_load_dwordx4 a[184:187], v12, s[4:7], s52 offen offset:2048 sc1
buffer_load_dwordx4 a[188:191], v12, s[4:7], s52 offen offset:3072 sc1
s_add_u32 s52, s52, 16384
buffer_load_dwordx4 a[192:195], v0, s[4:7], s52 offen offset:0 sc1
buffer_load_dwordx4 a[196:199], v0, s[4:7], s52 offen offset:1024 sc1
buffer_load_dwordx4 a[200:203], v0, s[4:7], s52 offen offset:2048 sc1
buffer_load_dwordx4 a[204:207], v0, s[4:7], s52 offen offset:3072 sc1
buffer_load_dwordx4 a[208:211], v10, s[4:7], s52 offen offset:0 sc1
buffer_load_dwordx4 a[212:215], v10, s[4:7], s52 offen offset:1024 sc1
buffer_load_dwordx4 a[216:219], v10, s[4:7], s52 offen offset:2048 sc1
buffer_load_dwordx4 a[220:223], v10, s[4:7], s52 offen offset:3072 sc1
buffer_load_dwordx4 a[224:227], v11, s[4:7], s52 offen offset:0 sc1
buffer_load_dwordx4 a[228:231], v11, s[4:7], s52 offen offset:1024 sc1
buffer_load_dwordx4 a[232:235], v11, s[4:7], s52 offen offset:2048 sc1
buffer_load_dwordx4 a[236:239], v11, s[4:7], s52 offen offset:3072 sc1
buffer_load_dwordx4 a[240:243], v12, s[4:7], s52 offen offset:0 sc1
buffer_load_dwordx4 a[244:247], v12, s[4:7], s52 offen offset:1024 sc1
buffer_load_dwordx4 a[248:251], v12, s[4:7], s52 offen offset:2048 sc1
buffer_load_dwordx4 a[252:255], v12, s[4:7], s52 offen offset:3072 sc1
s_waitcnt vmcnt(0)
s_lshl_b32 s46, s57, 16
s_lshl_b32 s52, s3, 14
s_add_u32 s46, s46, s52
s_add_u32 s46, s46, 159383552
s_lshl_b32 s53, s57, 7
s_lshl_b32 s44, s58, 11
s_add_u32 s44, s44, s53
s_add_u32 s44, s44, 195035136
s_lshl_b32 s45, s58, 17
s_add_u32 s45, s45, s53
s_add_u32 s45, s45, 205520896
s_lshl_b32 s48, s58, 7
s_lshl_b32 s53, s57, 5
s_add_u32 s48, s48, s53
s_add_u32 s48, s48, 211812352
s_lshr_b32 s49, s57, 1
s_lshl_b32 s49, s49, 8
s_lshl_b32 s53, s3, 5
s_add_u32 s49, s49, s53
s_add_u32 s49, s49, 222339072
s_mov_b32 s50, 1
v_lshrrev_b32 v96, 4, v0
v_and_b32 v97, 8, v96
v_cmp_ne_u32 vcc, 0, v97
v_mov_b32 v1, 0x4444
v_mov_b32 v97, 0xeeee
v_cndmask_b32 v1, v1, v97, vcc
v_and_b32 v97, 7, v96
v_lshrrev_b32 v98, 3, v96
v_lshlrev_b32 v2, 2, v97
v_mul_u32_u24 v4, 144, v98
v_lshl_add_u32 v4, v97, 4, v4
v_and_b32 v99, 1, v96
v_lshlrev_b32 v99, 3, v99
v_lshl_add_u32 v99, v98, 4, v99
v_bfe_u32 v100, v96, 1, 2
v_lshl_add_u32 v5, v100, 9, v99
v_lshl_add_u32 v6, v100, 15, v99
v_lshlrev_b32 v7, 2, v98
v_mov_b32 v99, 2146435072
v_cmp_eq_u32 vcc, 0, v97
s_nop 1
v_cndmask_b32 v7, v99, v7, vcc
v_add_u32 v97, s58, v97
v_cmp_eq_u32 vcc, 0, v97
s_nop 1
v_cndmask_b32 v9, 1.0, 0, vcc
v_and_b32 v3, 15, v96
v_bfe_u32 v97, v96, 4, 1
v_mul_u32_u24 v97, 144, v97
v_add_u32 v3, v3, v97
v_lshrrev_b32 v97, 5, v96
v_lshl_add_u32 v3, v97, 4, v3
v_lshlrev_b32 v3, 2, v3
s_mul_i32 s52, s3, 1152
v_add_u32 v3, s52, v3
s_mov_b32 s56, 8192
k_poll_112:
buffer_load_dword v8, v2, s[4:7], s49 offen sc1
s_waitcnt vmcnt(0)
v_cmp_gt_u32 vcc, s50, v8
s_cbranch_vccz k_pd_113
s_sleep 1
s_sub_u32 s32, s32, 1
s_cmp_gt_i32 s32, 0
s_cbranch_scc1 k_poll_112
k_pd_113:
buffer_load_dwordx2 v[14:15], v5, s[4:7], s44 offen sc1
buffer_load_dwordx4 v[32:35], v0, s[4:7], s46 offen offset:0 sc1
buffer_load_dwordx4 v[36:39], v0, s[4:7], s46 offen offset:1024 sc1
buffer_load_dwordx4 v[40:43], v0, s[4:7], s46 offen offset:2048 sc1
buffer_load_dwordx4 v[44:47], v0, s[4:7], s46 offen offset:3072 sc1
buffer_load_dwordx4 v[48:51], v10, s[4:7], s46 offen offset:0 sc1
buffer_load_dwordx4 v[52:55], v10, s[4:7], s46 offen offset:1024 sc1
buffer_load_dwordx4 v[56:59], v10, s[4:7], s46 offen offset:2048 sc1
buffer_load_dwordx4 v[60:63], v10, s[4:7], s46 offen offset:3072 sc1
buffer_load_dwordx4 v[64:67], v11, s[4:7], s46 offen offset:0 sc1
buffer_load_dwordx4 v[68:71], v11, s[4:7], s46 offen offset:1024 sc1
buffer_load_dwordx4 v[72:75], v11, s[4:7], s46 offen offset:2048 sc1
buffer_load_dwordx4 v[76:79], v11, s[4:7], s46 offen offset:3072 sc1
buffer_load_dwordx4 v[80:83], v12, s[4:7], s46 offen offset:0 sc1
buffer_load_dwordx4 v[84:87], v12, s[4:7], s46 offen offset:1024 sc1
buffer_load_dwordx4 v[88:91], v12, s[4:7], s46 offen offset:2048 sc1
buffer_load_dwordx4 v[92:95], v12, s[4:7], s46 offen offset:3072 sc1
s_xor_b32 s49, s49, 512
buffer_load_dword v8, v2, s[4:7], s49 offen sc1
k_top_111:
v_mov_b64 v[24:25], 0
v_mov_b64 v[26:27], 0
v_mov_b64 v[28:29], 0
v_mov_b64 v[30:31], 0
s_add_u32 s50, s50, 1
s_add_u32 s46, s46, 262144
s_add_u32 s44, s44, 40960
s_cmp_eq_u32 s50, 65
s_cselect_b32 s52, 1048576, 0
s_cselect_b32 s53, 524288, 0
s_add_u32 s46, s46, s52
s_add_u32 s44, s44, s53
s_waitcnt vmcnt(17)
v_lshlrev_b32 v16, 16, v14
v_and_b32 v17, 0xffff0000, v14
v_lshlrev_b32 v18, 16, v15
v_and_b32 v19, 0xffff0000, v15
s_waitcnt vmcnt(16)
v_smfmac_f32_16x16x64_bf16 v[24:27], v[32:35], a[0:7], v1
v_smfmac_f32_16x16x64_bf16 v[28:31], v[32:35], a[8:15], v1
s_waitcnt vmcnt(15)
v_smfmac_f32_16x16x64_bf16 v[24:27], v[36:39], a[16:23], v1
v_smfmac_f32_16x16x64_bf16 v[28:31], v[36:39], a[24:31], v1
s_waitcnt vmcnt(14)
v_smfmac_f32_16x16x64_bf16 v[24:27], v[40:43], a[32:39], v1
v_smfmac_f32_16x16x64_bf16 v[28:31], v[40:43], a[40:47], v1
s_waitcnt vmcnt(13)
v_smfmac_f32_16x16x64_bf16 v[24:27], v[44:47], a[48:55], v1
v_smfmac_f32_16x16x64_bf16 v[28:31], v[44:47], a[56:63], v1
s_waitcnt vmcnt(12)
v_smfmac_f32_16x16x64_bf16 v[24:27], v[48:51], a[64:71], v1
v_smfmac_f32_16x16x64_bf16 v[28:31], v[48:51], a[72:79], v1
s_waitcnt vmcnt(11)
v_smfmac_f32_16x16x64_bf16 v[24:27], v[52:55], a[80:87], v1
v_smfmac_f32_16x16x64_bf16 v[28:31], v[52:55], a[88:95], v1
s_waitcnt vmcnt(10)
v_smfmac_f32_16x16x64_bf16 v[24:27], v[56:59], a[96:103], v1
v_smfmac_f32_16x16x64_bf16 v[28:31], v[56:59], a[104:111], v1
s_waitcnt vmcnt(9)
v_smfmac_f32_16x16x64_bf16 v[24:27], v[60:63], a[112:119], v1
v_smfmac_f32_16x16x64_bf16 v[28:31], v[60:63], a[120:127], v1
s_waitcnt vmcnt(8)
v_smfmac_f32_16x16x64_bf16 v[24:27], v[64:67], a[128:135], v1
v_smfmac_f32_16x16x64_bf16 v[28:31], v[64:67], a[136:143], v1
s_waitcnt vmcnt(7)
v_smfmac_f32_16x16x64_bf16 v[24:27], v[68:71], a[144:151], v1
v_smfmac_f32_16x16x64_bf16 v[28:31], v[68:71], a[152:159], v1
s_waitcnt vmcnt(6)
v_smfmac_f32_16x16x64_bf16 v[24:27], v[72:75], a[160:167], v1
v_smfmac_f32_16x16x64_bf16 v[28:31], v[72:75], a[168:175], v1
s_waitcnt vmcnt(5)
v_smfmac_f32_16x16x64_bf16 v[24:27], v[76:79], a[176:183], v1
v_smfmac_f32_16x16x64_bf16 v[28:31], v[76:79], a[184:191], v1
s_waitcnt vmcnt(4)
v_smfmac_f32_16x16x64_bf16 v[24:27], v[80:83], a[192:199], v1
v_smfmac_f32_16x16x64_bf16 v[28:31], v[80:83], a[200:207], v1
s_waitcnt vmcnt(3)
v_smfmac_f32_16x16x64_bf16 v[24:27], v[84:87], a[208:215], v1
v_smfmac_f32_16x16x64_bf16 v[28:31], v[84:87], a[216:223], v1
s_waitcnt vmcnt(2)
v_smfmac_f32_16x16x64_bf16 v[24:27], v[88:91], a[224:231], v1
v_smfmac_f32_16x16x64_bf16 v[28:31], v[88:91], a[232:239], v1
s_waitcnt vmcnt(1)
v_smfmac_f32_16x16x64_bf16 v[24:27], v[92:95], a[240:247], v1
v_smfmac_f32_16x16x64_bf16 v[28:31], v[92:95], a[248:255], v1
s_waitcnt vmcnt(0)
v_cmp_gt_u32 vcc, s50, v8
s_mov_b32 s47, 0
s_cbranch_vccnz k_nr_114
s_mov_b32 s47, 1
buffer_load_dwordx2 v[14:15], v5, s[4:7], s44 offen sc1
buffer_load_dwordx4 v[32:35], v0, s[4:7], s46 offen offset:0 sc1
buffer_load_dwordx4 v[36:39], v0, s[4:7], s46 offen offset:1024 sc1
buffer_load_dwordx4 v[40:43], v0, s[4:7], s46 offen offset:2048 sc1
buffer_load_dwordx4 v[44:47], v0, s[4:7], s46 offen offset:3072 sc1
buffer_load_dwordx4 v[48:51], v10, s[4:7], s46 offen offset:0 sc1
buffer_load_dwordx4 v[52:55], v10, s[4:7], s46 offen offset:1024 sc1
buffer_load_dwordx4 v[56:59], v10, s[4:7], s46 offen offset:2048 sc1
buffer_load_dwordx4 v[60:63], v10, s[4:7], s46 offen offset:3072 sc1
buffer_load_dwordx4 v[64:67], v11, s[4:7], s46 offen offset:0 sc1
buffer_load_dwordx4 v[68:71], v11, s[4:7], s46 offen offset:1024 sc1
buffer_load_dwordx4 v[72:75], v11, s[4:7], s46 offen offset:2048 sc1
buffer_load_dwordx4 v[76:79], v11, s[4:7], s46 offen offset:3072 sc1
buffer_load_dwordx4 v[80:83], v12, s[4:7], s46 offen offset:0 sc1
buffer_load_dwordx4 v[84:87], v12, s[4:7], s46 offen offset:1024 sc1
buffer_load_dwordx4 v[88:91], v12, s[4:7], s46 offen offset:2048 sc1
buffer_load_dwordx4 v[92:95], v12, s[4:7], s46 offen offset:3072 sc1
s_xor_b32 s49, s49, 512
buffer_load_dword v8, v2, s[4:7], s49 offen sc1
k_nr_114:
s_nop 2
v_permlane32_swap_b32 v24, v28
v_permlane32_swap_b32 v25, v29
v_permlane32_swap_b32 v26, v30
v_permlane32_swap_b32 v27, v31
v_add_f32 v24, v24, v28
ds_write_b32 v3, v24 offset:0
v_add_f32 v25, v25, v29
ds_write_b32 v3, v25 offset:144
v_add_f32 v26, v26, v30
ds_write_b32 v3, v26 offset:288
v_add_f32 v27, v27, v31
ds_write_b32 v3, v27 offset:432
v_add_u32 v3, s56, v3
s_waitcnt lgkmcnt(0)
s_barrier
s_cmp_lg_u32 s3, 0
s_cbranch_scc1 k_ne_115
ds_read_b128 v[96:99], v4 offset:0
ds_read_b128 v[100:103], v4 offset:1152
ds_read_b128 v[104:107], v4 offset:2304
ds_read_b128 v[108:111], v4 offset:3456
v_add_u32 v4, s56, v4
s_waitcnt lgkmcnt(3)
v_add_f32 v16, v16, v96
v_add_f32 v17, v17, v97
v_add_f32 v18, v18, v98
v_add_f32 v19, v19, v99
s_waitcnt lgkmcnt(2)
v_add_f32 v16, v16, v100
v_add_f32 v17, v17, v101
v_add_f32 v18, v18, v102
v_add_f32 v19, v19, v103
s_waitcnt lgkmcnt(1)
v_add_f32 v16, v16, v104
v_add_f32 v17, v17, v105
v_add_f32 v18, v18, v106
v_add_f32 v19, v19, v107
s_waitcnt lgkmcnt(0)
v_add_f32 v16, v16, v108
v_add_f32 v17, v17, v109
v_add_f32 v18, v18, v110
v_add_f32 v19, v19, v111
v_cvt_pk_bf16_f32 v96, v16, v17
v_cvt_pk_bf16_f32 v97, v18, v19
buffer_store_dwordx2 v[96:97], v6, s[4:7], s45 offen sc1
v_mul_f32 v17, v9, v17
v_mul_f32 v16, v16, v16
v_fmac_f32 v16, v17, v17
v_fmac_f32 v16, v18, v18
v_fmac_f32 v16, v19, v19
s_nop 1
v_add_f32_dpp v16, v16, v16 quad_perm:[1,0,3,2] row_mask:0xf bank_mask:0xf
s_nop 1
v_add_f32_dpp v16, v16, v16 quad_perm:[2,3,0,1] row_mask:0xf bank_mask:0xf
s_nop 1
v_add_f32_dpp v16, v16, v16 row_half_mirror row_mask:0xf bank_mask:0xf
buffer_store_dword v16, v7, s[4:7], s48 offen sc1
s_add_u32 s45, s45, 512
s_add_u32 s48, s48, 2560
s_cmp_eq_u32 s50, 65
s_cbranch_scc0 k_ne_115
s_add_u32 s45, s45, 3112960
s_add_u32 s48, s48, 884736
k_ne_115:
s_sub_u32 s56, 0, s56
s_cmp_eq_u32 s47, 1
s_cbranch_scc1 k_top_111
s_cmp_le_u32 s50, 128
s_cbranch_scc1 k_poll_112
s_waitcnt vmcnt(0) lgkmcnt(0)
s_barrier
k_fin_7:
s_mul_i32 s57, s30, 52429
s_lshr_b32 s57, s57, 18
s_mul_i32 s52, s57, 5
s_sub_u32 s58, s30, s52
s_lshl_b32 s58, s58, 2
s_add_u32 s58, s58, s3
s_mul_i32 s53, s58, 40960
s_add_u32 s53, s53, 214958080
s_load_dwordx2 s[36:37], s[0:1], 80
s_mov_b32 s38, 2621440
s_mov_b32 s39, 0x20000
buffer_load_dwordx4 v[96:99], v0, s[4:7], s53 offen offset:0 sc1
buffer_load_dwordx4 v[100:103], v0, s[4:7], s53 offen offset:1024 sc1
buffer_load_dwordx4 v[104:107], v0, s[4:7], s53 offen offset:2048 sc1
buffer_load_dwordx4 v[108:111], v0, s[4:7], s53 offen offset:3072 sc1
s_add_u32 s53, s53, 4096
buffer_load_dwordx4 v[112:115], v0, s[4:7], s53 offen offset:0 sc1
buffer_load_dwordx4 v[116:119], v0, s[4:7], s53 offen offset:1024 sc1
buffer_load_dwordx4 v[120:123], v0, s[4:7], s53 offen offset:2048 sc1
buffer_load_dwordx4 v[124:127], v0, s[4:7], s53 offen offset:3072 sc1
s_add_u32 s53, s53, 4096
buffer_load_dwordx4 v[128:131], v0, s[4:7], s53 offen offset:0 sc1
buffer_load_dwordx4 v[132:135], v0, s[4:7], s53 offen offset:1024 sc1
buffer_load_dwordx4 v[136:139], v0, s[4:7], s53 offen offset:2048 sc1
buffer_load_dwordx4 v[140:143], v0, s[4:7], s53 offen offset:3072 sc1
s_add_u32 s53, s53, 4096
buffer_load_dwordx4 v[144:147], v0, s[4:7], s53 offen offset:0 sc1
buffer_load_dwordx4 v[148:151], v0, s[4:7], s53 offen offset:1024 sc1
buffer_load_dwordx4 v[152:155], v0, s[4:7], s53 offen offset:2048 sc1
buffer_load_dwordx4 v[156:159], v0, s[4:7], s53 offen offset:3072 sc1
s_add_u32 s53, s53, 4096
buffer_load_dwordx4 v[160:163], v0, s[4:7], s53 offen offset:0 sc1
buffer_load_dwordx4 v[164:167], v0, s[4:7], s53 offen offset:1024 sc1
buffer_load_dwordx4 v[168:171], v0, s[4:7], s53 offen offset:2048 sc1
buffer_load_dwordx4 v[172:175], v0, s[4:7], s53 offen offset:3072 sc1
s_add_u32 s53, s53, 4096
buffer_load_dwordx4 v[176:179], v0, s[4:7], s53 offen offset:0 sc1
buffer_load_dwordx4 v[180:183], v0, s[4:7], s53 offen offset:1024 sc1
buffer_load_dwordx4 v[184:187], v0, s[4:7], s53 offen offset:2048 sc1
buffer_load_dwordx4 v[188:191], v0, s[4:7], s53 offen offset:3072 sc1
s_add_u32 s53, s53, 4096
buffer_load_dwordx4 v[192:195], v0, s[4:7], s53 offen offset:0 sc1
buffer_load_dwordx4 v[196:199], v0, s[4:7], s53 offen offset:1024 sc1
buffer_load_dwordx4 v[200:203], v0, s[4:7], s53 offen offset:2048 sc1
buffer_load_dwordx4 v[204:207], v0, s[4:7], s53 offen offset:3072 sc1
s_add_u32 s53, s53, 4096
buffer_load_dwordx4 v[208:211], v0, s[4:7], s53 offen offset:0 sc1
buffer_load_dwordx4 v[212:215], v0, s[4:7], s53 offen offset:1024 sc1
buffer_load_dwordx4 v[216:219], v0, s[4:7], s53 offen offset:2048 sc1
buffer_load_dwordx4 v[220:223], v0, s[4:7], s53 offen offset:3072 sc1
s_add_u32 s53, s53, 4096
buffer_load_dwordx4 v[224:227], v0, s[4:7], s53 offen offset:0 sc1
buffer_load_dwordx4 v[228:231], v0, s[4:7], s53 offen offset:1024 sc1
buffer_load_dwordx4 v[232:235], v0, s[4:7], s53 offen offset:2048 sc1
buffer_load_dwordx4 v[236:239], v0, s[4:7], s53 offen offset:3072 sc1
s_add_u32 s53, s53, 4096
buffer_load_dwordx4 v[240:243], v0, s[4:7], s53 offen offset:0 sc1
buffer_load_dwordx4 v[244:247], v0, s[4:7], s53 offen offset:1024 sc1
buffer_load_dwordx4 v[248:251], v0, s[4:7], s53 offen offset:2048 sc1
buffer_load_dwordx4 v[252:255], v0, s[4:7], s53 offen offset:3072 sc1
s_lshl_b32 s58, s58, 6
s_mov_b32 s38, 2621440
s_mov_b32 s47, 201326592
k_ft_118:
s_mul_i32 s48, s57, 40960
s_mul_i32 s52, s3, 10240
s_add_u32 s46, s48, s52
s_add_u32 s46, s46, s47
s_add_u32 s48, s48, s58
v_bfe_u32 v1, v0, 4, 5
v_mul_u32_u24 v1, 1280, v1
v_lshrrev_b32 v2, 9, v0
v_lshl_add_u32 v1, v2, 5, v1
s_mov_b32 s49, 1310720
s_mov_b32 s54, 222314496
s_cmp_eq_u32 s38, 0
s_cbranch_scc1 k_fg_119
s_waitcnt vmcnt(0) lgkmcnt(0)
s_cmp_lg_u32 s3, 0
s_cbranch_scc1 k_w8d_121
v_lshlrev_b32 v2, 2, v0
k_w8_120:
buffer_load_dword v3, v2, s[4:7], s54 offen sc1
buffer_load_dword v4, v2, s[4:7], s54 offen offset:1024 sc1
s_waitcnt vmcnt(0)
v_and_b32 v3, v3, v4
v_cmp_eq_u32 vcc, 0, v3
s_cbranch_vccz k_w8d_121
s_sleep 1
s_sub_u32 s32, s32, 1
s_cmp_gt_i32 s32, 0
s_cbranch_scc1 k_w8_120
k_w8d_121:
s_barrier
k_fg_119:
s_mul_i32 s45, s3, 10240
s_mov_b32 s44, 0
v_mov_b32 v64, v0
s_add_u32 m0, s45, 0
s_add_u32 s55, s46, 0
buffer_load_dwordx4 v0, s[4:7], s55 offen offset:0 sc1 lds
buffer_load_dwordx4 v0, s[4:7], s55 offen offset:1024 sc1 lds
buffer_load_dwordx4 v0, s[4:7], s55 offen offset:2048 sc1 lds
buffer_load_dwordx4 v0, s[4:7], s55 offen offset:3072 sc1 lds
s_add_u32 m0, s45, 4096
s_add_u32 s55, s46, 4096
buffer_load_dwordx4 v0, s[4:7], s55 offen offset:0 sc1 lds
buffer_load_dwordx4 v0, s[4:7], s55 offen offset:1024 sc1 lds
buffer_load_dwordx4 v0, s[4:7], s55 offen offset:2048 sc1 lds
buffer_load_dwordx4 v0, s[4:7], s55 offen offset:3072 sc1 lds
s_add_u32 m0, s45, 8192
s_add_u32 s55, s46, 8192
buffer_load_dwordx4 v0, s[4:7], s55 offen offset:0 sc1 lds
buffer_load_dwordx4 v0, s[4:7], s55 offen offset:1024 sc1 lds
s_add_u32 s45, s45, 40960
s_cmp_ge_u32 s45, 122880
s_cselect_b32 s55, 122880, 0
s_sub_u32 s45, s45, s55
s_add_u32 s46, s46, s49
s_mov_b32 s49, 0
s_add_u32 m0, s45, 0
s_add_u32 s55, s46, 0
buffer_load_dwordx4 v0, s[4:7], s55 offen offset:0 sc1 lds
buffer_load_dwordx4 v0, s[4:7], s55 offen offset:1024 sc1 lds
buffer_load_dwordx4 v0, s[4:7], s55 offen offset:2048 sc1 lds
buffer_load_dwordx4 v0, s[4:7], s55 offen offset:3072 sc1 lds
s_add_u32 m0, s45, 4096
s_add_u32 s55, s46, 4096
buffer_load_dwordx4 v0, s[4:7], s55 offen offset:0 sc1 lds
buffer_load_dwordx4 v0, s[4:7], s55 offen offset:1024 sc1 lds
buffer_load_dwordx4 v0, s[4:7], s55 offen offset:2048 sc1 lds
buffer_load_dwordx4 v0, s[4:7], s55 offen offset:3072 sc1 lds
s_add_u32 m0, s45, 8192
s_add_u32 s55, s46, 8192
buffer_load_dwordx4 v0, s[4:7], s55 offen offset:0 sc1 lds
buffer_load_dwordx4 v0, s[4:7], s55 offen offset:1024 sc1 lds
s_add_u32 s45, s45, 40960
s_cmp_ge_u32 s45, 122880
s_cselect_b32 s55, 122880, 0
s_sub_u32 s45, s45, s55
s_add_u32 s46, s46, s49
s_mov_b32 s49, 0
s_waitcnt vmcnt(10)
s_barrier
ds_read_b128 v[8:11], v64 offset:0
ds_read_b128 v[12:15], v64 offset:1024
ds_read_b128 v[16:19], v64 offset:2048
ds_read_b128 v[20:23], v64 offset:3072
s_mov_b32 s59, 1
s_waitcnt lgkmcnt(0)
v_mfma_f32_32x32x16_bf16 v[32:47], v[96:99], v[8:11], 0
ds_read_b128 v[24:27], v64 offset:4096
v_mfma_f32_32x32x16_bf16 v[32:47], v[100:103], v[12:15], v[32:47]
ds_read_b128 v[8:11], v64 offset:5120
v_mfma_f32_32x32x16_bf16 v[32:47], v[104:107], v[16:19], v[32:47]
ds_read_b128 v[12:15], v64 offset:6144
v_mfma_f32_32x32x16_bf16 v[32:47], v[108:111], v[20:23], v[32:47]
s_waitcnt lgkmcnt(2)
ds_read_b128 v[16:19], v64 offset:7168
v_mfma_f32_32x32x16_bf16 v[32:47], v[112:115], v[24:27], v[32:47]
s_waitcnt lgkmcnt(2)
ds_read_b128 v[20:23], v64 offset:8192
v_mfma_f32_32x32x16_bf16 v[32:47], v[116:119], v[8:11], v[32:47]
s_waitcnt lgkmcnt(2)
ds_read_b128 v[24:27], v64 offset:9216
v_mfma_f32_32x32x16_bf16 v[32:47], v[120:123], v[12:15], v[32:47]
s_waitcnt lgkmcnt(2)
ds_read_b128 v[8:11], v64 offset:10240
v_mfma_f32_32x32x16_bf16 v[32:47], v[124:127], v[16:19], v[32:47]
s_waitcnt lgkmcnt(2)
ds_read_b128 v[12:15], v64 offset:11264
v_mfma_f32_32x32x16_bf16 v[32:47], v[128:131], v[20:23], v[32:47]
s_waitcnt lgkmcnt(2)
ds_read_b128 v[16:19], v64 offset:12288
v_mfma_f32_32x32x16_bf16 v[32:47], v[132:135], v[24:27], v[32:47]
s_waitcnt lgkmcnt(2)
ds_read_b128 v[20:23], v64 offset:13312
v_mfma_f32_32x32x16_bf16 v[32:47], v[136:139], v[8:11], v[32:47]
s_waitcnt lgkmcnt(2)
ds_read_b128 v[24:27], v64 offset:14336
v_mfma_f32_32x32x16_bf16 v[32:47], v[140:143], v[12:15], v[32:47]
s_waitcnt lgkmcnt(2)
ds_read_b128 v[8:11], v64 offset:15360
v_mfma_f32_32x32x16_bf16 v[32:47], v[144:147], v[16:19], v[32:47]
s_waitcnt lgkmcnt(2)
ds_read_b128 v[12:15], v64 offset:16384
v_mfma_f32_32x32x16_bf16 v[32:47], v[148:151], v[20:23], v[32:47]
s_waitcnt lgkmcnt(2)
ds_read_b128 v[16:19], v64 offset:17408
v_mfma_f32_32x32x16_bf16 v[32:47], v[152:155], v[24:27], v[32:47]
s_waitcnt lgkmcnt(2)
ds_read_b128 v[20:23], v64 offset:18432
v_mfma_f32_32x32x16_bf16 v[32:47], v[156:159], v[8:11], v[32:47]
s_waitcnt lgkmcnt(2)
ds_read_b128 v[24:27], v64 offset:19456
v_mfma_f32_32x32x16_bf16 v[32:47], v[160:163], v[12:15], v[32:47]
s_waitcnt lgkmcnt(2)
ds_read_b128 v[8:11], v64 offset:20480
v_mfma_f32_32x32x16_bf16 v[32:47], v[164:167], v[16:19], v[32:47]
s_waitcnt lgkmcnt(2)
ds_read_b128 v[12:15], v64 offset:21504
v_mfma_f32_32x32x16_bf16 v[32:47], v[168:171], v[20:23], v[32:47]
s_waitcnt lgkmcnt(2)
ds_read_b128 v[16:19], v64 offset:22528
v_mfma_f32_32x32x16_bf16 v[32:47], v[172:175], v[24:27], v[32:47]
s_waitcnt lgkmcnt(2)
ds_read_b128 v[20:23], v64 offset:23552
v_mfma_f32_32x32x16_bf16 v[32:47], v[176:179], v[8:11], v[32:47]
s_waitcnt lgkmcnt(2)
ds_read_b128 v[24:27], v64 offset:24576
v_mfma_f32_32x32x16_bf16 v[32:47], v[180:183], v[12:15], v[32:47]
s_waitcnt lgkmcnt(2)
ds_read_b128 v[8:11], v64 offset:25600
v_mfma_f32_32x32x16_bf16 v[32:47], v[184:187], v[16:19], v[32:47]
s_waitcnt lgkmcnt(2)
ds_read_b128 v[12:15], v64 offset:26624
v_mfma_f32_32x32x16_bf16 v[32:47], v[188:191], v[20:23], v[32:47]
s_waitcnt lgkmcnt(2)
ds_read_b128 v[16:19], v64 offset:27648
v_mfma_f32_32x32x16_bf16 v[32:47], v[192:195], v[24:27], v[32:47]
s_waitcnt lgkmcnt(2)
ds_read_b128 v[20:23], v64 offset:28672
v_mfma_f32_32x32x16_bf16 v[32:47], v[196:199], v[8:11], v[32:47]
s_waitcnt lgkmcnt(2)
ds_read_b128 v[24:27], v64 offset:29696
v_mfma_f32_32x32x16_bf16 v[32:47], v[200:203], v[12:15], v[32:47]
s_waitcnt lgkmcnt(2)
ds_read_b128 v[8:11], v64 offset:30720
v_mfma_f32_32x32x16_bf16 v[32:47], v[204:207], v[16:19], v[32:47]
s_waitcnt lgkmcnt(2)
ds_read_b128 v[12:15], v64 offset:31744
v_mfma_f32_32x32x16_bf16 v[32:47], v[208:211], v[20:23], v[32:47]
s_waitcnt lgkmcnt(2)
ds_read_b128 v[16:19], v64 offset:32768
v_mfma_f32_32x32x16_bf16 v[32:47], v[212:215], v[24:27], v[32:47]
s_waitcnt lgkmcnt(2)
ds_read_b128 v[20:23], v64 offset:33792
v_mfma_f32_32x32x16_bf16 v[32:47], v[216:219], v[8:11], v[32:47]
s_waitcnt lgkmcnt(2)
ds_read_b128 v[24:27], v64 offset:34816
v_mfma_f32_32x32x16_bf16 v[32:47], v[220:223], v[12:15], v[32:47]
s_waitcnt lgkmcnt(2)
ds_read_b128 v[8:11], v64 offset:35840
v_mfma_f32_32x32x16_bf16 v[32:47], v[224:227], v[16:19], v[32:47]
s_waitcnt lgkmcnt(2)
ds_read_b128 v[12:15], v64 offset:36864
v_mfma_f32_32x32x16_bf16 v[32:47], v[228:231], v[20:23], v[32:47]
s_waitcnt lgkmcnt(2)
ds_read_b128 v[16:19], v64 offset:37888
v_mfma_f32_32x32x16_bf16 v[32:47], v[232:235], v[24:27], v[32:47]
s_waitcnt lgkmcnt(2)
ds_read_b128 v[20:23], v64 offset:38912
v_mfma_f32_32x32x16_bf16 v[32:47], v[236:239], v[8:11], v[32:47]
s_waitcnt lgkmcnt(2)
ds_read_b128 v[24:27], v64 offset:39936
v_mfma_f32_32x32x16_bf16 v[32:47], v[240:243], v[12:15], v[32:47]
s_add_u32 s44, s44, 1
s_cmp_eq_u32 s44, 3
s_mov_b32 s56, 40960
s_cmov_b32 s56, -81920
s_cselect_b32 s44, 0, s44
v_add_u32 v64, s56, v64
s_waitcnt vmcnt(0) lgkmcnt(2)
s_barrier
ds_read_b128 v[8:11], v64 offset:0
v_mfma_f32_32x32x16_bf16 v[32:47], v[244:247], v[16:19], v[32:47]
s_waitcnt lgkmcnt(2)
ds_read_b128 v[12:15], v64 offset:1024
v_mfma_f32_32x32x16_bf16 v[32:47], v[248:251], v[20:23], v[32:47]
s_waitcnt lgkmcnt(2)
ds_read_b128 v[16:19], v64 offset:2048
v_mfma_f32_32x32x16_bf16 v[32:47], v[252:255], v[24:27], v[32:47]
s_waitcnt lgkmcnt(2)
ds_read_b128 v[20:23], v64 offset:3072
k_st_122:
v_mfma_f32_32x32x16_bf16 v[48:63], v[96:99], v[8:11], 0
s_waitcnt lgkmcnt(2)
ds_read_b128 v[24:27], v64 offset:4096
v_mfma_f32_32x32x16_bf16 v[48:63], v[100:103], v[12:15], v[48:63]
s_waitcnt lgkmcnt(2)
ds_read_b128 v[8:11], v64 offset:5120
v_cvt_pk_bf16_f32 v32, v32, v33
v_cvt_pk_bf16_f32 v33, v34, v35
v_mfma_f32_32x32x16_bf16 v[48:63], v[104:107], v[16:19], v[48:63]
s_waitcnt lgkmcnt(2)
ds_read_b128 v[12:15], v64 offset:6144
v_cvt_pk_bf16_f32 v34, v36, v37
v_cvt_pk_bf16_f32 v35, v38, v39
v_mfma_f32_32x32x16_bf16 v[48:63], v[108:111], v[20:23], v[48:63]
s_waitcnt lgkmcnt(2)
ds_read_b128 v[16:19], v64 offset:7168
v_cvt_pk_bf16_f32 v36, v40, v41
v_cvt_pk_bf16_f32 v37, v42, v43
v_mfma_f32_32x32x16_bf16 v[48:63], v[112:115], v[24:27], v[48:63]
s_waitcnt lgkmcnt(2)
ds_read_b128 v[20:23], v64 offset:8192
v_cvt_pk_bf16_f32 v38, v44, v45
v_cvt_pk_bf16_f32 v39, v46, v47
v_mfma_f32_32x32x16_bf16 v[48:63], v[116:119], v[8:11], v[48:63]
s_waitcnt lgkmcnt(2)
ds_read_b128 v[24:27], v64 offset:9216
buffer_store_dwordx4 v[32:35], v1, s[36:39], s48 offen offset:0
buffer_store_dwordx4 v[36:39], v1, s[36:39], s48 offen offset:16
v_mfma_f32_32x32x16_bf16 v[48:63], v[120:123], v[12:15], v[48:63]
s_waitcnt lgkmcnt(2)
ds_read_b128 v[8:11], v64 offset:10240
s_add_u32 s48, s48, 1310720
v_mfma_f32_32x32x16_bf16 v[48:63], v[124:127], v[16:19], v[48:63]
s_waitcnt lgkmcnt(2)
ds_read_b128 v[12:15], v64 offset:11264
v_mfma_f32_32x32x16_bf16 v[48:63], v[128:131], v[20:23], v[48:63]
s_waitcnt lgkmcnt(2)
ds_read_b128 v[16:19], v64 offset:12288
v_mfma_f32_32x32x16_bf16 v[48:63], v[132:135], v[24:27], v[48:63]
s_waitcnt lgkmcnt(2)
ds_read_b128 v[20:23], v64 offset:13312
v_mfma_f32_32x32x16_bf16 v[48:63], v[136:139], v[8:11], v[48:63]
s_waitcnt lgkmcnt(2)
ds_read_b128 v[24:27], v64 offset:14336
v_mfma_f32_32x32x16_bf16 v[48:63], v[140:143], v[12:15], v[48:63]
s_waitcnt lgkmcnt(2)
ds_read_b128 v[8:11], v64 offset:15360
v_mfma_f32_32x32x16_bf16 v[48:63], v[144:147], v[16:19], v[48:63]
s_waitcnt lgkmcnt(2)
ds_read_b128 v[12:15], v64 offset:16384
v_mfma_f32_32x32x16_bf16 v[48:63], v[148:151], v[20:23], v[48:63]
s_waitcnt lgkmcnt(2)
ds_read_b128 v[16:19], v64 offset:17408
v_mfma_f32_32x32x16_bf16 v[48:63], v[152:155], v[24:27], v[48:63]
s_waitcnt lgkmcnt(2)
ds_read_b128 v[20:23], v64 offset:18432
v_mfma_f32_32x32x16_bf16 v[48:63], v[156:159], v[8:11], v[48:63]
s_waitcnt lgkmcnt(2)
ds_read_b128 v[24:27], v64 offset:19456
v_mfma_f32_32x32x16_bf16 v[48:63], v[160:163], v[12:15], v[48:63]
s_waitcnt lgkmcnt(2)
ds_read_b128 v[8:11], v64 offset:20480
v_mfma_f32_32x32x16_bf16 v[48:63], v[164:167], v[16:19], v[48:63]
s_waitcnt lgkmcnt(2)
ds_read_b128 v[12:15], v64 offset:21504
v_mfma_f32_32x32x16_bf16 v[48:63], v[168:171], v[20:23], v[48:63]
s_waitcnt lgkmcnt(2)
ds_read_b128 v[16:19], v64 offset:22528
v_mfma_f32_32x32x16_bf16 v[48:63], v[172:175], v[24:27], v[48:63]
s_waitcnt lgkmcnt(2)
ds_read_b128 v[20:23], v64 offset:23552
v_mfma_f32_32x32x16_bf16 v[48:63], v[176:179], v[8:11], v[48:63]
s_waitcnt lgkmcnt(2)
ds_read_b128 v[24:27], v64 offset:24576
v_mfma_f32_32x32x16_bf16 v[48:63], v[180:183], v[12:15], v[48:63]
s_waitcnt lgkmcnt(2)
ds_read_b128 v[8:11], v64 offset:25600
v_mfma_f32_32x32x16_bf16 v[48:63], v[184:187], v[16:19], v[48:63]
s_waitcnt lgkmcnt(2)
ds_read_b128 v[12:15], v64 offset:26624
v_mfma_f32_32x32x16_bf16 v[48:63], v[188:191], v[20:23], v[48:63]
s_waitcnt lgkmcnt(2)
ds_read_b128 v[16:19], v64 offset:27648
v_mfma_f32_32x32x16_bf16 v[48:63], v[192:195], v[24:27], v[48:63]
s_waitcnt lgkmcnt(2)
ds_read_b128 v[20:23], v64 offset:28672
v_mfma_f32_32x32x16_bf16 v[48:63], v[196:199], v[8:11], v[48:63]
s_waitcnt lgkmcnt(2)
ds_read_b128 v[24:27], v64 offset:29696
v_mfma_f32_32x32x16_bf16 v[48:63], v[200:203], v[12:15], v[48:63]
s_waitcnt lgkmcnt(2)
ds_read_b128 v[8:11], v64 offset:30720
v_mfma_f32_32x32x16_bf16 v[48:63], v[204:207], v[16:19], v[48:63]
s_waitcnt lgkmcnt(2)
ds_read_b128 v[12:15], v64 offset:31744
v_mfma_f32_32x32x16_bf16 v[48:63], v[208:211], v[20:23], v[48:63]
s_waitcnt lgkmcnt(2)
ds_read_b128 v[16:19], v64 offset:32768
v_mfma_f32_32x32x16_bf16 v[48:63], v[212:215], v[24:27], v[48:63]
s_waitcnt lgkmcnt(2)
ds_read_b128 v[20:23], v64 offset:33792
v_mfma_f32_32x32x16_bf16 v[48:63], v[216:219], v[8:11], v[48:63]
s_waitcnt lgkmcnt(2)
ds_read_b128 v[24:27], v64 offset:34816
v_mfma_f32_32x32x16_bf16 v[48:63], v[220:223], v[12:15], v[48:63]
s_waitcnt lgkmcnt(2)
ds_read_b128 v[8:11], v64 offset:35840
v_mfma_f32_32x32x16_bf16 v[48:63], v[224:227], v[16:19], v[48:63]
s_waitcnt lgkmcnt(2)
ds_read_b128 v[12:15], v64 offset:36864
v_mfma_f32_32x32x16_bf16 v[48:63], v[228:231], v[20:23], v[48:63]
s_waitcnt lgkmcnt(2)
ds_read_b128 v[16:19], v64 offset:37888
v_mfma_f32_32x32x16_bf16 v[48:63], v[232:235], v[24:27], v[48:63]
s_waitcnt lgkmcnt(2)
ds_read_b128 v[20:23], v64 offset:38912
v_mfma_f32_32x32x16_bf16 v[48:63], v[236:239], v[8:11], v[48:63]
s_waitcnt lgkmcnt(2)
ds_read_b128 v[24:27], v64 offset:39936
v_mfma_f32_32x32x16_bf16 v[48:63], v[240:243], v[12:15], v[48:63]
s_add_u32 s44, s44, 1
s_cmp_eq_u32 s44, 3
s_mov_b32 s56, 40960
s_cmov_b32 s56, -81920
s_cselect_b32 s44, 0, s44
v_add_u32 v64, s56, v64
s_waitcnt vmcnt(10) lgkmcnt(2)
s_barrier
ds_read_b128 v[8:11], v64 offset:0
v_mfma_f32_32x32x16_bf16 v[48:63], v[244:247], v[16:19], v[48:63]
s_waitcnt lgkmcnt(2)
ds_read_b128 v[12:15], v64 offset:1024
v_mfma_f32_32x32x16_bf16 v[48:63], v[248:251], v[20:23], v[48:63]
s_waitcnt lgkmcnt(2)
ds_read_b128 v[16:19], v64 offset:2048
v_mfma_f32_32x32x16_bf16 v[48:63], v[252:255], v[24:27], v[48:63]
s_waitcnt lgkmcnt(2)
ds_read_b128 v[20:23], v64 offset:3072
k_sm_124:
s_nop 9
v_cvt_pk_bf16_f32 v48, v48, v49
v_cvt_pk_bf16_f32 v49, v50, v51
v_cvt_pk_bf16_f32 v50, v52, v53
v_cvt_pk_bf16_f32 v51, v54, v55
v_cvt_pk_bf16_f32 v52, v56, v57
v_cvt_pk_bf16_f32 v53, v58, v59
v_cvt_pk_bf16_f32 v54, v60, v61
v_cvt_pk_bf16_f32 v55, v62, v63
buffer_store_dwordx4 v[48:51], v1, s[36:39], s48 offen offset:0
buffer_store_dwordx4 v[52:55], v1, s[36:39], s48 offen offset:16
s_add_u32 s48, s48, 1310720
s_cmp_eq_u32 s38, 0
s_mov_b32 s38, 2621440
s_mov_b32 s47, 201326592
s_cbranch_scc1 k_ft_118
s_waitcnt vmcnt(0)
s_endpgm
k_team_3:
s_cmp_eq_u32 s3, 1
s_cbranch_scc1 k_w1_126
s_cmp_eq_u32 s3, 2
s_cbranch_scc1 k_w2_127
s_cmp_eq_u32 s3, 3
s_cbranch_scc1 k_w3_128
k_w0_125:
v_lshrrev_b32 v12, 3, v0
v_lshlrev_b32 v10, 13, v12
v_bfe_u32 v12, v0, 1, 2
v_lshrrev_b32 v13, 4, v0
v_xor_b32 v12, v12, v13
v_lshl_add_u32 v10, v12, 5, v10
v_and_b32 v14, 1, v0
v_lshl_add_u32 v10, v14, 4, v10
v_mul_u32_u24 v11, 1280, v13
v_bfe_u32 v12, v0, 1, 3
v_and_b32 v13, 1, v13
v_lshlrev_b32 v13, 1, v13
v_xor_b32 v12, v12, v13
v_xor_b32 v12, 0, v12
v_lshl_add_u32 v11, v12, 5, v11
v_lshl_add_u32 v11, v14, 4, v11
v_bfe_u32 v12, v0, 5, 1
v_lshlrev_b32 v12, 4, v12
v_bfe_u32 v13, v0, 4, 1
v_lshl_add_u32 v12, v13, 1, v12
v_bfe_u32 v13, v0, 2, 1
v_lshl_add_u32 v12, v13, 2, v12
v_bfe_u32 v13, v0, 3, 1
v_mul_u32_u24 v15, 4224, v13
v_add_u32 v12, v13, v12
v_bfe_u32 v13, v12, 1, 2
v_xor_b32 v13, 0, v13
v_lshlrev_b32 v13, 5, v13
v_lshl_add_u32 v4, v12, 7, v13
v_and_b32 v14, 3, v0
v_lshl_add_u32 v4, v14, 3, v4
v_add_u32 v5, 0x10000, v4
v_add_u32 v6, 0x20000, v4
v_bfe_u32 v12, v0, 4, 1
v_lshlrev_b32 v13, 4, v12
v_lshlrev_b32 v12, 2, v12
v_bfe_u32 v8, v0, 5, 1
v_lshl_add_u32 v13, v8, 2, v13
v_bfe_u32 v8, v0, 2, 1
v_add_u32 v13, v8, v13
v_lshl_add_u32 v12, v8, 1, v12
v_bfe_u32 v8, v0, 3, 1
v_add_u32 v8, 0, v8
v_xor_b32 v12, v12, v8
v_lshlrev_b32 v12, 5, v12
v_lshl_add_u32 v7, v13, 8, v12
v_lshl_add_u32 v7, v14, 3, v7
v_add_u32 v8, 0x10000, v7
v_add_u32 v9, 0x20000, v7
v_lshlrev_b32 v0, 4, v0
v_add_u32 v2, 98304, v0
s_lshl_b32 s49, s30, 8
s_mul_i32 s50, s30, 163840
s_mul_i32 s60, s30, 131072
s_add_u32 s60, s60, 120586240
s_add_u32 s61, s60, 4096
s_add_u32 s62, s60, 8192
s_mov_b32 m0, 0
s_add_u32 s48, s49, 0
buffer_load_dwordx4 v10, s[8:11], s48 offen lds
s_mov_b32 m0, 1024
s_add_u32 s48, s49, 65536
buffer_load_dwordx4 v10, s[8:11], s48 offen lds
s_mov_b32 m0, 8192
s_add_u32 s48, s49, 128
buffer_load_dwordx4 v10, s[8:11], s48 offen lds
s_mov_b32 m0, 9216
s_add_u32 s48, s49, 65664
buffer_load_dwordx4 v10, s[8:11], s48 offen lds
s_mov_b32 m0, 16384
s_add_u32 s48, s49, 128
buffer_load_dwordx4 v10, s[12:15], s48 offen lds
s_mov_b32 m0, 17408
s_add_u32 s48, s49, 65664
buffer_load_dwordx4 v10, s[12:15], s48 offen lds
s_mov_b32 m0, 24576
s_add_u32 s48, s49, 0
buffer_load_dwordx4 v10, s[16:19], s48 offen lds
s_mov_b32 m0, 25600
s_add_u32 s48, s49, 65536
buffer_load_dwordx4 v10, s[16:19], s48 offen lds
s_mov_b32 m0, 32768
s_add_u32 s48, s49, 128
buffer_load_dwordx4 v10, s[16:19], s48 offen lds
s_mov_b32 m0, 33792
s_add_u32 s48, s49, 65664
buffer_load_dwordx4 v10, s[16:19], s48 offen lds
s_mov_b32 m0, 40960
s_add_u32 s48, s49, 524288
buffer_load_dwordx4 v10, s[8:11], s48 offen lds
s_mov_b32 m0, 41984
s_add_u32 s48, s49, 589824
buffer_load_dwordx4 v10, s[8:11], s48 offen lds
s_mov_b32 m0, 49152
s_add_u32 s48, s49, 524416
buffer_load_dwordx4 v10, s[8:11], s48 offen lds
s_mov_b32 m0, 50176
s_add_u32 s48, s49, 589952
buffer_load_dwordx4 v10, s[8:11], s48 offen lds
s_mov_b32 m0, 57344
s_add_u32 s48, s49, 524416
buffer_load_dwordx4 v10, s[12:15], s48 offen lds
s_mov_b32 m0, 58368
s_add_u32 s48, s49, 589952
buffer_load_dwordx4 v10, s[12:15], s48 offen lds
s_mov_b32 m0, 65536
s_add_u32 s48, s49, 524288
buffer_load_dwordx4 v10, s[16:19], s48 offen lds
s_mov_b32 m0, 66560
s_add_u32 s48, s49, 589824
buffer_load_dwordx4 v10, s[16:19], s48 offen lds
s_mov_b32 m0, 73728
s_add_u32 s48, s49, 524416
buffer_load_dwordx4 v10, s[16:19], s48 offen lds
s_mov_b32 m0, 74752
s_add_u32 s48, s49, 589952
buffer_load_dwordx4 v10, s[16:19], s48 offen lds
s_mov_b32 m0, 81920
s_add_u32 s48, s49, 1048576
buffer_load_dwordx4 v10, s[8:11], s48 offen lds
s_mov_b32 m0, 82944
s_add_u32 s48, s49, 1114112
buffer_load_dwordx4 v10, s[8:11], s48 offen lds
s_mov_b32 m0, 90112
s_add_u32 s48, s49, 1048704
buffer_load_dwordx4 v10, s[8:11], s48 offen lds
s_mov_b32 m0, 91136
s_add_u32 s48, s49, 1114240
buffer_load_dwordx4 v10, s[8:11], s48 offen lds
s_mov_b32 m0, 98304
s_add_u32 s48, s49, 1048704
buffer_load_dwordx4 v10, s[12:15], s48 offen lds
s_mov_b32 m0, 99328
s_add_u32 s48, s49, 1114240
buffer_load_dwordx4 v10, s[12:15], s48 offen lds
s_mov_b32 m0, 106496
s_add_u32 s48, s49, 1048576
buffer_load_dwordx4 v10, s[16:19], s48 offen lds
s_mov_b32 m0, 107520
s_add_u32 s48, s49, 1114112
buffer_load_dwordx4 v10, s[16:19], s48 offen lds
s_mov_b32 m0, 114688
s_add_u32 s48, s49, 1572864
buffer_load_dwordx4 v10, s[8:11], s48 offen lds
s_mov_b32 m0, 115712
s_add_u32 s48, s49, 1638400
buffer_load_dwordx4 v10, s[8:11], s48 offen lds
s_mov_b32 m0, 122880
s_add_u32 s48, s49, 1572992
buffer_load_dwordx4 v10, s[8:11], s48 offen lds
s_mov_b32 m0, 123904
s_add_u32 s48, s49, 1638528
buffer_load_dwordx4 v10, s[8:11], s48 offen lds
s_waitcnt vmcnt(24)
s_barrier
s_mov_b32 m0, 131072
s_add_u32 s48, s49, 1572992
buffer_load_dwordx4 v10, s[12:15], s48 offen lds
s_mov_b32 m0, 132096
s_add_u32 s48, s49, 1638528
buffer_load_dwordx4 v10, s[12:15], s48 offen lds
s_mov_b32 m0, 139264
s_add_u32 s48, s49, 1572864
buffer_load_dwordx4 v10, s[16:19], s48 offen lds
s_mov_b32 m0, 140288
s_add_u32 s48, s49, 1638400
buffer_load_dwordx4 v10, s[16:19], s48 offen lds
s_mov_b32 m0, 147456
s_add_u32 s48, s49, 2097152
buffer_load_dwordx4 v10, s[8:11], s48 offen lds
s_mov_b32 m0, 148480
s_add_u32 s48, s49, 2162688
buffer_load_dwordx4 v10, s[8:11], s48 offen lds
s_mov_b32 m0, 155648
s_add_u32 s48, s49, 2097280
buffer_load_dwordx4 v10, s[8:11], s48 offen lds
s_mov_b32 m0, 156672
s_add_u32 s48, s49, 2162816
buffer_load_dwordx4 v10, s[8:11], s48 offen lds
ds_read_b64_tr_b16 a[0:1], v4 offset:0
ds_read_b64_tr_b16 a[2:3], v4 offset:1024
ds_read_b64_tr_b16 a[4:5], v4 offset:4096
ds_read_b64_tr_b16 a[6:7], v4 offset:5120
ds_read_b64_tr_b16 a[8:9], v4 offset:8192
ds_read_b64_tr_b16 a[10:11], v4 offset:9216
ds_read_b64_tr_b16 a[12:13], v4 offset:12288
ds_read_b64_tr_b16 a[14:15], v4 offset:13312
ds_read_b64_tr_b16 a[16:17], v4 offset:16384
ds_read_b64_tr_b16 a[18:19], v4 offset:17408
ds_read_b64_tr_b16 a[20:21], v4 offset:20480
ds_read_b64_tr_b16 a[22:23], v4 offset:21504
ds_read_b64_tr_b16 v[40:41], v4 offset:24576
ds_read_b64_tr_b16 v[42:43], v4 offset:25600
ds_read_b64_tr_b16 v[44:45], v4 offset:28672
ds_read_b64_tr_b16 v[46:47], v4 offset:29696
s_waitcnt lgkmcnt(0)
buffer_store_dwordx4 v[40:43], v0, s[4:7], s60 offen offset:0
buffer_store_dwordx4 v[44:47], v0, s[4:7], s60 offen offset:1024
s_waitcnt vmcnt(26)
s_barrier
s_mov_b32 m0, 0
s_add_u32 s48, s49, 2097280
buffer_load_dwordx4 v10, s[12:15], s48 offen lds
s_mov_b32 m0, 1024
s_add_u32 s48, s49, 2162816
buffer_load_dwordx4 v10, s[12:15], s48 offen lds
s_mov_b32 m0, 8192
s_add_u32 s48, s49, 2097152
buffer_load_dwordx4 v10, s[16:19], s48 offen lds
s_mov_b32 m0, 9216
s_add_u32 s48, s49, 2162688
buffer_load_dwordx4 v10, s[16:19], s48 offen lds
s_mov_b32 m0, 16384
s_add_u32 s48, s49, 2621440
buffer_load_dwordx4 v10, s[8:11], s48 offen lds
s_mov_b32 m0, 17408
s_add_u32 s48, s49, 2686976
buffer_load_dwordx4 v10, s[8:11], s48 offen lds
s_mov_b32 m0, 24576
s_add_u32 s48, s49, 2621568
buffer_load_dwordx4 v10, s[8:11], s48 offen lds
s_mov_b32 m0, 25600
s_add_u32 s48, s49, 2687104
buffer_load_dwordx4 v10, s[8:11], s48 offen lds
ds_read_b64_tr_b16 v[16:17], v4 offset:32768
ds_read_b64_tr_b16 v[18:19], v4 offset:33792
ds_read_b64_tr_b16 v[20:21], v4 offset:36864
ds_read_b64_tr_b16 v[22:23], v4 offset:37888
ds_read_b64_tr_b16 a[24:25], v4 offset:40960
ds_read_b64_tr_b16 a[26:27], v4 offset:41984
ds_read_b64_tr_b16 a[28:29], v4 offset:45056
ds_read_b64_tr_b16 a[30:31], v4 offset:46080
ds_read_b64_tr_b16 a[32:33], v4 offset:49152
ds_read_b64_tr_b16 a[34:35], v4 offset:50176
ds_read_b64_tr_b16 a[36:37], v4 offset:53248
ds_read_b64_tr_b16 a[38:39], v4 offset:54272
ds_read_b64_tr_b16 a[40:41], v4 offset:57344
ds_read_b64_tr_b16 a[42:43], v4 offset:58368
ds_read_b64_tr_b16 a[44:45], v4 offset:61440
ds_read_b64_tr_b16 a[46:47], v4 offset:62464
s_waitcnt lgkmcnt(0)
buffer_store_dwordx4 v[16:19], v0, s[4:7], s60 offen offset:2048
buffer_store_dwordx4 v[20:23], v0, s[4:7], s60 offen offset:3072
s_waitcnt vmcnt(28)
s_barrier
s_mov_b32 m0, 32768
s_add_u32 s48, s49, 2621568
buffer_load_dwordx4 v10, s[12:15], s48 offen lds
s_mov_b32 m0, 33792
s_add_u32 s48, s49, 2687104
buffer_load_dwordx4 v10, s[12:15], s48 offen lds
s_mov_b32 m0, 40960
s_add_u32 s48, s49, 2621440
buffer_load_dwordx4 v10, s[16:19], s48 offen lds
s_mov_b32 m0, 41984
s_add_u32 s48, s49, 2686976
buffer_load_dwordx4 v10, s[16:19], s48 offen lds
s_mov_b32 m0, 49152
s_add_u32 s48, s49, 3145856
buffer_load_dwordx4 v10, s[8:11], s48 offen lds
s_mov_b32 m0, 50176
s_add_u32 s48, s49, 3211392
buffer_load_dwordx4 v10, s[8:11], s48 offen lds
s_mov_b32 m0, 57344
s_add_u32 s48, s49, 3670016
buffer_load_dwordx4 v10, s[8:11], s48 offen lds
s_mov_b32 m0, 58368
s_add_u32 s48, s49, 3735552
buffer_load_dwordx4 v10, s[8:11], s48 offen lds
ds_read_b64_tr_b16 a[176:177], v5 offset:0
ds_read_b64_tr_b16 a[178:179], v5 offset:1024
ds_read_b64_tr_b16 a[180:181], v5 offset:4096
ds_read_b64_tr_b16 a[182:183], v5 offset:5120
ds_read_b64_tr_b16 v[232:233], v5 offset:8192
ds_read_b64_tr_b16 v[234:235], v5 offset:9216
ds_read_b64_tr_b16 v[236:237], v5 offset:12288
ds_read_b64_tr_b16 v[238:239], v5 offset:13312
ds_read_b64_tr_b16 a[48:49], v5 offset:16384
ds_read_b64_tr_b16 a[50:51], v5 offset:17408
ds_read_b64_tr_b16 a[52:53], v5 offset:20480
ds_read_b64_tr_b16 a[54:55], v5 offset:21504
ds_read_b64_tr_b16 a[56:57], v5 offset:24576
ds_read_b64_tr_b16 a[58:59], v5 offset:25600
ds_read_b64_tr_b16 a[60:61], v5 offset:28672
ds_read_b64_tr_b16 a[62:63], v5 offset:29696
s_waitcnt lgkmcnt(0)
s_waitcnt vmcnt(28)
s_barrier
s_mov_b32 m0, 65536
s_add_u32 s48, s49, 3670144
buffer_load_dwordx4 v10, s[8:11], s48 offen lds
s_mov_b32 m0, 66560
s_add_u32 s48, s49, 3735680
buffer_load_dwordx4 v10, s[8:11], s48 offen lds
s_mov_b32 m0, 73728
s_add_u32 s48, s49, 4194304
buffer_load_dwordx4 v10, s[8:11], s48 offen lds
s_mov_b32 m0, 74752
s_add_u32 s48, s49, 4259840
buffer_load_dwordx4 v10, s[8:11], s48 offen lds
s_mov_b32 m0, 81920
s_add_u32 s48, s49, 4194432
buffer_load_dwordx4 v10, s[8:11], s48 offen lds
s_mov_b32 m0, 82944
s_add_u32 s48, s49, 4259968
buffer_load_dwordx4 v10, s[8:11], s48 offen lds
s_mov_b32 m0, 90112
s_add_u32 s48, s49, 4718592
buffer_load_dwordx4 v10, s[8:11], s48 offen lds
s_mov_b32 m0, 91136
s_add_u32 s48, s49, 4784128
buffer_load_dwordx4 v10, s[8:11], s48 offen lds
ds_read_b64_tr_b16 a[64:65], v5 offset:32768
ds_read_b64_tr_b16 a[66:67], v5 offset:33792
ds_read_b64_tr_b16 a[68:69], v5 offset:36864
ds_read_b64_tr_b16 a[70:71], v5 offset:37888
ds_read_b64_tr_b16 a[72:73], v5 offset:40960
ds_read_b64_tr_b16 a[74:75], v5 offset:41984
ds_read_b64_tr_b16 a[76:77], v5 offset:45056
ds_read_b64_tr_b16 a[78:79], v5 offset:46080
ds_read_b64_tr_b16 a[80:81], v5 offset:49152
ds_read_b64_tr_b16 a[82:83], v5 offset:50176
ds_read_b64_tr_b16 a[84:85], v5 offset:53248
ds_read_b64_tr_b16 a[86:87], v5 offset:54272
ds_read_b64_tr_b16 a[88:89], v5 offset:57344
ds_read_b64_tr_b16 a[90:91], v5 offset:58368
ds_read_b64_tr_b16 a[92:93], v5 offset:61440
ds_read_b64_tr_b16 a[94:95], v5 offset:62464
s_waitcnt lgkmcnt(0)
s_waitcnt vmcnt(28)
s_barrier
s_mov_b32 m0, 98304
s_add_u32 s48, s49, 4718720
buffer_load_dwordx4 v10, s[8:11], s48 offen lds
s_mov_b32 m0, 99328
s_add_u32 s48, s49, 4784256
buffer_load_dwordx4 v10, s[8:11], s48 offen lds
s_mov_b32 m0, 106496
s_add_u32 s48, s49, 3145728
buffer_load_dwordx4 v10, s[12:15], s48 offen lds
s_mov_b32 m0, 107520
s_add_u32 s48, s49, 3211264
buffer_load_dwordx4 v10, s[12:15], s48 offen lds
s_mov_b32 m0, 114688
s_add_u32 s48, s49, 3145856
buffer_load_dwordx4 v10, s[12:15], s48 offen lds
s_mov_b32 m0, 115712
s_add_u32 s48, s49, 3211392
buffer_load_dwordx4 v10, s[12:15], s48 offen lds
s_mov_b32 m0, 122880
s_add_u32 s48, s49, 3670016
buffer_load_dwordx4 v10, s[12:15], s48 offen lds
s_mov_b32 m0, 123904
s_add_u32 s48, s49, 3735552
buffer_load_dwordx4 v10, s[12:15], s48 offen lds
ds_read_b64_tr_b16 a[96:97], v6 offset:0
ds_read_b64_tr_b16 a[98:99], v6 offset:1024
ds_read_b64_tr_b16 a[100:101], v6 offset:4096
ds_read_b64_tr_b16 a[102:103], v6 offset:5120
ds_read_b64_tr_b16 a[104:105], v6 offset:8192
ds_read_b64_tr_b16 a[106:107], v6 offset:9216
ds_read_b64_tr_b16 a[108:109], v6 offset:12288
ds_read_b64_tr_b16 a[110:111], v6 offset:13312
ds_read_b64_tr_b16 a[112:113], v6 offset:16384
ds_read_b64_tr_b16 a[114:115], v6 offset:17408
ds_read_b64_tr_b16 a[116:117], v6 offset:20480
ds_read_b64_tr_b16 a[118:119], v6 offset:21504
ds_read_b64_tr_b16 a[120:121], v6 offset:24576
ds_read_b64_tr_b16 a[122:123], v6 offset:25600
ds_read_b64_tr_b16 a[124:125], v6 offset:28672
ds_read_b64_tr_b16 a[126:127], v6 offset:29696
s_waitcnt lgkmcnt(0)
s_waitcnt vmcnt(26)
s_barrier
s_mov_b32 m0, 131072
s_add_u32 s48, s49, 3670144
buffer_load_dwordx4 v10, s[12:15], s48 offen lds
s_mov_b32 m0, 132096
s_add_u32 s48, s49, 3735680
buffer_load_dwordx4 v10, s[12:15], s48 offen lds
s_mov_b32 m0, 139264
s_add_u32 s48, s49, 4194304
buffer_load_dwordx4 v10, s[12:15], s48 offen lds
s_mov_b32 m0, 140288
s_add_u32 s48, s49, 4259840
buffer_load_dwordx4 v10, s[12:15], s48 offen lds
s_mov_b32 m0, 147456
s_add_u32 s48, s49, 4194432
buffer_load_dwordx4 v10, s[12:15], s48 offen lds
s_mov_b32 m0, 148480
s_add_u32 s48, s49, 4259968
buffer_load_dwordx4 v10, s[12:15], s48 offen lds
s_mov_b32 m0, 155648
s_add_u32 s48, s49, 4718592
buffer_load_dwordx4 v10, s[12:15], s48 offen lds
s_mov_b32 m0, 156672
s_add_u32 s48, s49, 4784128
buffer_load_dwordx4 v10, s[12:15], s48 offen lds
ds_read_b64_tr_b16 a[128:129], v4 offset:0
ds_read_b64_tr_b16 a[130:131], v4 offset:1024
ds_read_b64_tr_b16 a[132:133], v4 offset:4096
ds_read_b64_tr_b16 a[134:135], v4 offset:5120
ds_read_b64_tr_b16 a[136:137], v4 offset:8192
ds_read_b64_tr_b16 a[138:139], v4 offset:9216
ds_read_b64_tr_b16 a[140:141], v4 offset:12288
ds_read_b64_tr_b16 a[142:143], v4 offset:13312
ds_read_b64_tr_b16 a[144:145], v4 offset:16384
ds_read_b64_tr_b16 a[146:147], v4 offset:17408
ds_read_b64_tr_b16 a[148:149], v4 offset:20480
ds_read_b64_tr_b16 a[150:151], v4 offset:21504
ds_read_b64_tr_b16 a[152:153], v4 offset:24576
ds_read_b64_tr_b16 a[154:155], v4 offset:25600
ds_read_b64_tr_b16 a[156:157], v4 offset:28672
ds_read_b64_tr_b16 a[158:159], v4 offset:29696
s_waitcnt lgkmcnt(0)
s_waitcnt vmcnt(24)
s_barrier
s_mov_b32 m0, 0
s_add_u32 s48, s49, 4718720
buffer_load_dwordx4 v10, s[12:15], s48 offen lds
s_mov_b32 m0, 1024
s_add_u32 s48, s49, 4784256
buffer_load_dwordx4 v10, s[12:15], s48 offen lds
s_mov_b32 m0, 8192
s_add_u32 s48, s49, 3145728
buffer_load_dwordx4 v10, s[16:19], s48 offen lds
s_mov_b32 m0, 9216
s_add_u32 s48, s49, 3211264
buffer_load_dwordx4 v10, s[16:19], s48 offen lds
s_mov_b32 m0, 16384
s_add_u32 s48, s49, 3145856
buffer_load_dwordx4 v10, s[16:19], s48 offen lds
s_mov_b32 m0, 17408
s_add_u32 s48, s49, 3211392
buffer_load_dwordx4 v10, s[16:19], s48 offen lds
s_mov_b32 m0, 24576
s_add_u32 s48, s49, 3670016
buffer_load_dwordx4 v10, s[16:19], s48 offen lds
s_mov_b32 m0, 25600
s_add_u32 s48, s49, 3735552
buffer_load_dwordx4 v10, s[16:19], s48 offen lds
ds_read_b64_tr_b16 a[160:161], v4 offset:32768
ds_read_b64_tr_b16 a[162:163], v4 offset:33792
ds_read_b64_tr_b16 a[164:165], v4 offset:36864
ds_read_b64_tr_b16 a[166:167], v4 offset:37888
ds_read_b64_tr_b16 a[168:169], v4 offset:40960
ds_read_b64_tr_b16 a[170:171], v4 offset:41984
ds_read_b64_tr_b16 a[172:173], v4 offset:45056
ds_read_b64_tr_b16 a[174:175], v4 offset:46080
ds_read_b64_tr_b16 a[192:193], v4 offset:49152
ds_read_b64_tr_b16 a[194:195], v4 offset:50176
ds_read_b64_tr_b16 a[196:197], v4 offset:53248
ds_read_b64_tr_b16 a[198:199], v4 offset:54272
ds_read_b64_tr_b16 v[240:241], v4 offset:57344
ds_read_b64_tr_b16 v[242:243], v4 offset:58368
ds_read_b64_tr_b16 v[244:245], v4 offset:61440
ds_read_b64_tr_b16 v[246:247], v4 offset:62464
s_waitcnt lgkmcnt(0)
s_waitcnt vmcnt(24)
s_barrier
s_mov_b32 m0, 32768
s_add_u32 s48, s49, 3670144
buffer_load_dwordx4 v10, s[16:19], s48 offen lds
s_mov_b32 m0, 33792
s_add_u32 s48, s49, 3735680
buffer_load_dwordx4 v10, s[16:19], s48 offen lds
s_mov_b32 m0, 40960
s_add_u32 s48, s49, 4194304
buffer_load_dwordx4 v10, s[16:19], s48 offen lds
s_mov_b32 m0, 41984
s_add_u32 s48, s49, 4259840
buffer_load_dwordx4 v10, s[16:19], s48 offen lds
s_mov_b32 m0, 49152
s_add_u32 s48, s49, 4194432
buffer_load_dwordx4 v10, s[16:19], s48 offen lds
s_mov_b32 m0, 50176
s_add_u32 s48, s49, 4259968
buffer_load_dwordx4 v10, s[16:19], s48 offen lds
s_mov_b32 m0, 57344
s_add_u32 s48, s49, 4718592
buffer_load_dwordx4 v10, s[16:19], s48 offen lds
s_mov_b32 m0, 58368
s_add_u32 s48, s49, 4784128
buffer_load_dwordx4 v10, s[16:19], s48 offen lds
ds_read_b64_tr_b16 a[200:201], v5 offset:0
ds_read_b64_tr_b16 a[202:203], v5 offset:1024
ds_read_b64_tr_b16 a[204:205], v5 offset:4096
ds_read_b64_tr_b16 a[206:207], v5 offset:5120
ds_read_b64_tr_b16 a[208:209], v5 offset:8192
ds_read_b64_tr_b16 a[210:211], v5 offset:9216
ds_read_b64_tr_b16 a[212:213], v5 offset:12288
ds_read_b64_tr_b16 a[214:215], v5 offset:13312
ds_read_b64_tr_b16 a[216:217], v5 offset:16384
ds_read_b64_tr_b16 a[218:219], v5 offset:17408
ds_read_b64_tr_b16 a[220:221], v5 offset:20480
ds_read_b64_tr_b16 a[222:223], v5 offset:21504
ds_read_b64_tr_b16 a[224:225], v5 offset:24576
ds_read_b64_tr_b16 a[226:227], v5 offset:25600
ds_read_b64_tr_b16 a[228:229], v5 offset:28672
ds_read_b64_tr_b16 a[230:231], v5 offset:29696
s_waitcnt lgkmcnt(0)
s_waitcnt vmcnt(24)
s_barrier
s_mov_b32 m0, 65536
s_add_u32 s48, s49, 4718720
buffer_load_dwordx4 v10, s[16:19], s48 offen lds
s_mov_b32 m0, 66560
s_add_u32 s48, s49, 4784256
buffer_load_dwordx4 v10, s[16:19], s48 offen lds
s_mov_b32 m0, 73728
s_add_u32 s48, s50, 0
buffer_load_dwordx4 v11, s[20:23], s48 offen lds
s_mov_b32 m0, 74752
s_add_u32 s48, s50, 5120
buffer_load_dwordx4 v11, s[20:23], s48 offen lds
s_mov_b32 m0, 81920
s_add_u32 s48, s50, 20480
buffer_load_dwordx4 v11, s[20:23], s48 offen lds
s_mov_b32 m0, 82944
s_add_u32 s48, s50, 25600
buffer_load_dwordx4 v11, s[20:23], s48 offen lds
s_mov_b32 m0, 90112
s_add_u32 s48, s50, 40960
buffer_load_dwordx4 v11, s[20:23], s48 offen lds
s_mov_b32 m0, 91136
s_add_u32 s48, s50, 46080
buffer_load_dwordx4 v11, s[20:23], s48 offen lds
ds_read_b64_tr_b16 a[232:233], v5 offset:32768
ds_read_b64_tr_b16 a[234:235], v5 offset:33792
ds_read_b64_tr_b16 a[236:237], v5 offset:36864
ds_read_b64_tr_b16 a[238:239], v5 offset:37888
ds_read_b64_tr_b16 v[248:249], v5 offset:40960
ds_read_b64_tr_b16 v[250:251], v5 offset:41984
ds_read_b64_tr_b16 v[252:253], v5 offset:45056
ds_read_b64_tr_b16 v[254:255], v5 offset:46080
ds_read_b64_tr_b16 a[240:241], v5 offset:49152
ds_read_b64_tr_b16 a[242:243], v5 offset:50176
ds_read_b64_tr_b16 a[244:245], v5 offset:53248
ds_read_b64_tr_b16 a[246:247], v5 offset:54272
ds_read_b64_tr_b16 a[248:249], v5 offset:57344
ds_read_b64_tr_b16 a[250:251], v5 offset:58368
ds_read_b64_tr_b16 a[252:253], v5 offset:61440
ds_read_b64_tr_b16 a[254:255], v5 offset:62464
s_waitcnt lgkmcnt(0)
s_waitcnt vmcnt(24)
s_barrier
s_mov_b32 m0, 98304
s_add_u32 s48, s50, 61440
buffer_load_dwordx4 v11, s[20:23], s48 offen lds
s_mov_b32 m0, 99328
s_add_u32 s48, s50, 66560
buffer_load_dwordx4 v11, s[20:23], s48 offen lds
s_mov_b32 m0, 106496
s_add_u32 s48, s50, 256
buffer_load_dwordx4 v11, s[20:23], s48 offen lds
s_mov_b32 m0, 107520
s_add_u32 s48, s50, 5376
buffer_load_dwordx4 v11, s[20:23], s48 offen lds
s_mov_b32 m0, 114688
s_add_u32 s48, s50, 20736
buffer_load_dwordx4 v11, s[20:23], s48 offen lds
s_mov_b32 m0, 115712
s_add_u32 s48, s50, 25856
buffer_load_dwordx4 v11, s[20:23], s48 offen lds
s_mov_b32 m0, 122880
s_add_u32 s48, s50, 41216
buffer_load_dwordx4 v11, s[20:23], s48 offen lds
s_mov_b32 m0, 123904
s_add_u32 s48, s50, 46336
buffer_load_dwordx4 v11, s[20:23], s48 offen lds
ds_read_b64_tr_b16 v[72:73], v6 offset:0
ds_read_b64_tr_b16 v[74:75], v6 offset:1024
ds_read_b64_tr_b16 v[76:77], v6 offset:4096
ds_read_b64_tr_b16 v[78:79], v6 offset:5120
ds_read_b64_tr_b16 v[80:81], v6 offset:8192
ds_read_b64_tr_b16 v[82:83], v6 offset:9216
ds_read_b64_tr_b16 v[84:85], v6 offset:12288
ds_read_b64_tr_b16 v[86:87], v6 offset:13312
ds_read_b64_tr_b16 v[88:89], v6 offset:16384
ds_read_b64_tr_b16 v[90:91], v6 offset:17408
ds_read_b64_tr_b16 v[92:93], v6 offset:20480
ds_read_b64_tr_b16 v[94:95], v6 offset:21504
ds_read_b64_tr_b16 v[96:97], v6 offset:24576
ds_read_b64_tr_b16 v[98:99], v6 offset:25600
ds_read_b64_tr_b16 v[100:101], v6 offset:28672
ds_read_b64_tr_b16 v[102:103], v6 offset:29696
s_waitcnt lgkmcnt(0)
s_waitcnt vmcnt(24)
s_barrier
s_mov_b32 m0, 131072
s_add_u32 s48, s50, 61696
buffer_load_dwordx4 v11, s[20:23], s48 offen lds
s_mov_b32 m0, 132096
s_add_u32 s48, s50, 66816
buffer_load_dwordx4 v11, s[20:23], s48 offen lds
s_mov_b32 m0, 139264
s_add_u32 s48, s50, 512
buffer_load_dwordx4 v11, s[20:23], s48 offen lds
s_mov_b32 m0, 140288
s_add_u32 s48, s50, 5632
buffer_load_dwordx4 v11, s[20:23], s48 offen lds
s_mov_b32 m0, 147456
s_add_u32 s48, s50, 20992
buffer_load_dwordx4 v11, s[20:23], s48 offen lds
s_mov_b32 m0, 148480
s_add_u32 s48, s50, 26112
buffer_load_dwordx4 v11, s[20:23], s48 offen lds
s_mov_b32 m0, 155648
s_add_u32 s48, s50, 41472
buffer_load_dwordx4 v11, s[20:23], s48 offen lds
s_mov_b32 m0, 156672
s_add_u32 s48, s50, 46592
buffer_load_dwordx4 v11, s[20:23], s48 offen lds
ds_read_b64_tr_b16 v[104:105], v4 offset:0
ds_read_b64_tr_b16 v[106:107], v4 offset:1024
ds_read_b64_tr_b16 v[108:109], v4 offset:4096
ds_read_b64_tr_b16 v[110:111], v4 offset:5120
ds_read_b64_tr_b16 v[112:113], v4 offset:8192
ds_read_b64_tr_b16 v[114:115], v4 offset:9216
ds_read_b64_tr_b16 v[116:117], v4 offset:12288
ds_read_b64_tr_b16 v[118:119], v4 offset:13312
ds_read_b64_tr_b16 v[120:121], v4 offset:16384
ds_read_b64_tr_b16 v[122:123], v4 offset:17408
ds_read_b64_tr_b16 v[124:125], v4 offset:20480
ds_read_b64_tr_b16 v[126:127], v4 offset:21504
ds_read_b64_tr_b16 v[128:129], v4 offset:24576
ds_read_b64_tr_b16 v[130:131], v4 offset:25600
ds_read_b64_tr_b16 v[132:133], v4 offset:28672
ds_read_b64_tr_b16 v[134:135], v4 offset:29696
s_waitcnt lgkmcnt(0)
s_waitcnt vmcnt(24)
s_barrier
s_mov_b32 m0, 0
s_add_u32 s48, s50, 61952
buffer_load_dwordx4 v11, s[20:23], s48 offen lds
s_mov_b32 m0, 1024
s_add_u32 s48, s50, 67072
buffer_load_dwordx4 v11, s[20:23], s48 offen lds
s_mov_b32 m0, 8192
s_add_u32 s48, s49, 0
buffer_load_dwordx4 v10, s[12:15], s48 offen lds
s_mov_b32 m0, 9216
s_add_u32 s48, s49, 65536
buffer_load_dwordx4 v10, s[12:15], s48 offen lds
s_mov_b32 m0, 16384
s_add_u32 s48, s49, 524288
buffer_load_dwordx4 v10, s[12:15], s48 offen lds
s_mov_b32 m0, 17408
s_add_u32 s48, s49, 589824
buffer_load_dwordx4 v10, s[12:15], s48 offen lds
s_mov_b32 m0, 24576
s_add_u32 s48, s49, 1048576
buffer_load_dwordx4 v10, s[12:15], s48 offen lds
s_mov_b32 m0, 25600
s_add_u32 s48, s49, 1114112
buffer_load_dwordx4 v10, s[12:15], s48 offen lds
ds_read_b64_tr_b16 v[136:137], v4 offset:32768
ds_read_b64_tr_b16 v[138:139], v4 offset:33792
ds_read_b64_tr_b16 v[140:141], v4 offset:36864
ds_read_b64_tr_b16 v[142:143], v4 offset:37888
ds_read_b64_tr_b16 v[144:145], v4 offset:40960
ds_read_b64_tr_b16 v[146:147], v4 offset:41984
ds_read_b64_tr_b16 v[148:149], v4 offset:45056
ds_read_b64_tr_b16 v[150:151], v4 offset:46080
ds_read_b64_tr_b16 v[152:153], v4 offset:49152
ds_read_b64_tr_b16 v[154:155], v4 offset:50176
ds_read_b64_tr_b16 v[156:157], v4 offset:53248
ds_read_b64_tr_b16 v[158:159], v4 offset:54272
ds_read_b64_tr_b16 v[160:161], v4 offset:57344
ds_read_b64_tr_b16 v[162:163], v4 offset:58368
ds_read_b64_tr_b16 v[164:165], v4 offset:61440
ds_read_b64_tr_b16 v[166:167], v4 offset:62464
s_waitcnt lgkmcnt(0)
s_waitcnt vmcnt(24)
s_barrier
s_mov_b32 m0, 32768
s_add_u32 s48, s49, 1572864
buffer_load_dwordx4 v10, s[12:15], s48 offen lds
s_mov_b32 m0, 33792
s_add_u32 s48, s49, 1638400
buffer_load_dwordx4 v10, s[12:15], s48 offen lds
s_mov_b32 m0, 40960
s_add_u32 s48, s49, 2097152
buffer_load_dwordx4 v10, s[12:15], s48 offen lds
s_mov_b32 m0, 41984
s_add_u32 s48, s49, 2162688
buffer_load_dwordx4 v10, s[12:15], s48 offen lds
s_mov_b32 m0, 49152
s_add_u32 s48, s49, 2621440
buffer_load_dwordx4 v10, s[12:15], s48 offen lds
s_mov_b32 m0, 50176
s_add_u32 s48, s49, 2686976
buffer_load_dwordx4 v10, s[12:15], s48 offen lds
s_mov_b32 m0, 57344
s_add_u32 s48, s49, 1048704
buffer_load_dwordx4 v10, s[16:19], s48 offen lds
s_mov_b32 m0, 58368
s_add_u32 s48, s49, 1114240
buffer_load_dwordx4 v10, s[16:19], s48 offen lds
ds_read_b64_tr_b16 v[168:169], v5 offset:0
ds_read_b64_tr_b16 v[170:171], v5 offset:1024
ds_read_b64_tr_b16 v[172:173], v5 offset:4096
ds_read_b64_tr_b16 v[174:175], v5 offset:5120
v_xor_b32 v12, v15, v8
ds_read_b64_tr_b16 v[24:25], v12 offset:8192
ds_read_b64_tr_b16 v[26:27], v12 offset:8704
ds_read_b64_tr_b16 v[28:29], v12 offset:10240
ds_read_b64_tr_b16 v[30:31], v12 offset:10752
ds_read_b64_tr_b16 v[176:177], v8 offset:16384
ds_read_b64_tr_b16 v[178:179], v8 offset:16896
ds_read_b64_tr_b16 v[180:181], v8 offset:18432
ds_read_b64_tr_b16 v[182:183], v8 offset:18944
ds_read_b64_tr_b16 v[184:185], v8 offset:24576
ds_read_b64_tr_b16 v[186:187], v8 offset:25088
ds_read_b64_tr_b16 v[188:189], v8 offset:26624
ds_read_b64_tr_b16 v[190:191], v8 offset:27136
s_waitcnt lgkmcnt(0)
buffer_store_dwordx4 v[24:27], v0, s[4:7], s61 offen offset:0
buffer_store_dwordx4 v[28:31], v0, s[4:7], s61 offen offset:1024
s_waitcnt vmcnt(26)
s_barrier
s_mov_b32 m0, 65536
s_add_u32 s48, s49, 1572992
buffer_load_dwordx4 v10, s[16:19], s48 offen lds
s_mov_b32 m0, 66560
s_add_u32 s48, s49, 1638528
buffer_load_dwordx4 v10, s[16:19], s48 offen lds
s_mov_b32 m0, 73728
s_add_u32 s48, s49, 2097280
buffer_load_dwordx4 v10, s[16:19], s48 offen lds
s_mov_b32 m0, 74752
s_add_u32 s48, s49, 2162816
buffer_load_dwordx4 v10, s[16:19], s48 offen lds
s_mov_b32 m0, 81920
s_add_u32 s48, s49, 2621568
buffer_load_dwordx4 v10, s[16:19], s48 offen lds
s_mov_b32 m0, 82944
s_add_u32 s48, s49, 2687104
buffer_load_dwordx4 v10, s[16:19], s48 offen lds
s_mov_b32 m0, 90112
s_add_u32 s48, s50, 768
buffer_load_dwordx4 v11, s[20:23], s48 offen lds
s_mov_b32 m0, 91136
s_add_u32 s48, s50, 5888
buffer_load_dwordx4 v11, s[20:23], s48 offen lds
ds_read_b64_tr_b16 v[192:193], v8 offset:32768
ds_read_b64_tr_b16 v[194:195], v8 offset:33280
ds_read_b64_tr_b16 v[196:197], v8 offset:34816
ds_read_b64_tr_b16 v[198:199], v8 offset:35328
v_xor_b32 v12, v15, v8
ds_read_b64_tr_b16 v[24:25], v12 offset:40960
ds_read_b64_tr_b16 v[26:27], v12 offset:41472
ds_read_b64_tr_b16 v[28:29], v12 offset:43008
ds_read_b64_tr_b16 v[30:31], v12 offset:43520
ds_read_b64_tr_b16 a[184:185], v8 offset:49152
ds_read_b64_tr_b16 a[186:187], v8 offset:49664
ds_read_b64_tr_b16 a[188:189], v8 offset:51200
ds_read_b64_tr_b16 a[190:191], v8 offset:51712
ds_read_b64_tr_b16 v[224:225], v8 offset:57344
ds_read_b64_tr_b16 v[226:227], v8 offset:57856
ds_read_b64_tr_b16 v[228:229], v8 offset:59392
ds_read_b64_tr_b16 v[230:231], v8 offset:59904
s_waitcnt lgkmcnt(0)
buffer_store_dwordx4 v[24:27], v0, s[4:7], s61 offen offset:2048
buffer_store_dwordx4 v[28:31], v0, s[4:7], s61 offen offset:3072
s_waitcnt vmcnt(28)
s_barrier
s_mov_b32 m0, 98304
s_add_u32 s48, s50, 21248
buffer_load_dwordx4 v11, s[20:23], s48 offen lds
s_mov_b32 m0, 99328
s_add_u32 s48, s50, 26368
buffer_load_dwordx4 v11, s[20:23], s48 offen lds
s_mov_b32 m0, 106496
s_add_u32 s48, s50, 41728
buffer_load_dwordx4 v11, s[20:23], s48 offen lds
s_mov_b32 m0, 107520
s_add_u32 s48, s50, 46848
buffer_load_dwordx4 v11, s[20:23], s48 offen lds
s_mov_b32 m0, 114688
s_add_u32 s48, s50, 62208
buffer_load_dwordx4 v11, s[20:23], s48 offen lds
s_mov_b32 m0, 115712
s_add_u32 s48, s50, 67328
buffer_load_dwordx4 v11, s[20:23], s48 offen lds
s_mov_b32 m0, 122880
s_add_u32 s48, s50, 1024
buffer_load_dwordx4 v11, s[20:23], s48 offen lds
s_mov_b32 m0, 123904
s_add_u32 s48, s50, 6144
buffer_load_dwordx4 v11, s[20:23], s48 offen lds
ds_read_b64_tr_b16 v[16:17], v9 offset:0
ds_read_b64_tr_b16 v[18:19], v9 offset:512
ds_read_b64_tr_b16 v[20:21], v9 offset:2048
ds_read_b64_tr_b16 v[22:23], v9 offset:2560
v_xor_b32 v12, v15, v9
ds_read_b64_tr_b16 v[200:201], v12 offset:8192
ds_read_b64_tr_b16 v[202:203], v12 offset:8704
ds_read_b64_tr_b16 v[204:205], v12 offset:10240
ds_read_b64_tr_b16 v[206:207], v12 offset:10752
ds_read_b64_tr_b16 v[32:33], v9 offset:16384
ds_read_b64_tr_b16 v[34:35], v9 offset:16896
ds_read_b64_tr_b16 v[36:37], v9 offset:18432
ds_read_b64_tr_b16 v[38:39], v9 offset:18944
ds_read_b64_tr_b16 v[208:209], v9 offset:24576
ds_read_b64_tr_b16 v[210:211], v9 offset:25088
ds_read_b64_tr_b16 v[212:213], v9 offset:26624
ds_read_b64_tr_b16 v[214:215], v9 offset:27136
s_waitcnt lgkmcnt(0)
buffer_store_dwordx4 v[16:19], v0, s[4:7], s62 offen offset:0
buffer_store_dwordx4 v[20:23], v0, s[4:7], s62 offen offset:1024
buffer_store_dwordx4 v[32:35], v0, s[4:7], s62 offen offset:2048
buffer_store_dwordx4 v[36:39], v0, s[4:7], s62 offen offset:3072
s_waitcnt vmcnt(38)
s_barrier
s_mov_b32 m0, 131072
s_add_u32 s48, s50, 21504
buffer_load_dwordx4 v11, s[20:23], s48 offen lds
s_mov_b32 m0, 132096
s_add_u32 s48, s50, 26624
buffer_load_dwordx4 v11, s[20:23], s48 offen lds
s_mov_b32 m0, 139264
s_add_u32 s48, s50, 41984
buffer_load_dwordx4 v11, s[20:23], s48 offen lds
s_mov_b32 m0, 140288
s_add_u32 s48, s50, 47104
buffer_load_dwordx4 v11, s[20:23], s48 offen lds
s_mov_b32 m0, 147456
s_add_u32 s48, s50, 62464
buffer_load_dwordx4 v11, s[20:23], s48 offen lds
s_mov_b32 m0, 148480
s_add_u32 s48, s50, 67584
buffer_load_dwordx4 v11, s[20:23], s48 offen lds
s_mov_b32 m0, 155648
s_add_u32 s48, s49, 3145728
buffer_load_dwordx4 v10, s[8:11], s48 offen lds
s_mov_b32 m0, 156672
s_add_u32 s48, s49, 3211264
buffer_load_dwordx4 v10, s[8:11], s48 offen lds
ds_read_b64_tr_b16 v[216:217], v7 offset:0
ds_read_b64_tr_b16 v[218:219], v7 offset:512
ds_read_b64_tr_b16 v[220:221], v7 offset:2048
ds_read_b64_tr_b16 v[222:223], v7 offset:2560
s_waitcnt lgkmcnt(0)
s_waitcnt vmcnt(32)
s_barrier
ds_read_b64_tr_b16 v[16:17], v4 offset:8192
ds_read_b64_tr_b16 v[18:19], v4 offset:9216
ds_read_b64_tr_b16 v[20:21], v4 offset:12288
ds_read_b64_tr_b16 v[22:23], v4 offset:13312
ds_read_b64_tr_b16 v[24:25], v4 offset:16384
ds_read_b64_tr_b16 v[26:27], v4 offset:17408
ds_read_b64_tr_b16 v[28:29], v4 offset:20480
ds_read_b64_tr_b16 v[30:31], v4 offset:21504
ds_read_b64_tr_b16 v[32:33], v4 offset:24576
ds_read_b64_tr_b16 v[34:35], v4 offset:25600
ds_read_b64_tr_b16 v[36:37], v4 offset:28672
ds_read_b64_tr_b16 v[38:39], v4 offset:29696
ds_read_b64_tr_b16 v[40:41], v4 offset:32768
ds_read_b64_tr_b16 v[42:43], v4 offset:33792
ds_read_b64_tr_b16 v[44:45], v4 offset:36864
ds_read_b64_tr_b16 v[46:47], v4 offset:37888
ds_read_b64_tr_b16 v[48:49], v4 offset:40960
ds_read_b64_tr_b16 v[50:51], v4 offset:41984
ds_read_b64_tr_b16 v[52:53], v4 offset:45056
ds_read_b64_tr_b16 v[54:55], v4 offset:46080
ds_read_b64_tr_b16 v[56:57], v4 offset:49152
ds_read_b64_tr_b16 v[58:59], v4 offset:50176
ds_read_b64_tr_b16 v[60:61], v4 offset:53248
ds_read_b64_tr_b16 v[62:63], v4 offset:54272
ds_read_b64_tr_b16 v[64:65], v4 offset:57344
ds_read_b64_tr_b16 v[66:67], v4 offset:58368
ds_read_b64_tr_b16 v[68:69], v4 offset:61440
ds_read_b64_tr_b16 v[70:71], v4 offset:62464
s_waitcnt lgkmcnt(0)
s_barrier
ds_write_b128 v0, v[16:19] offset:8192
ds_write_b128 v0, v[20:23] offset:9216
ds_write_b128 v0, v[24:27] offset:10240
ds_write_b128 v0, v[28:31] offset:11264
ds_write_b128 v0, v[32:35] offset:12288
ds_write_b128 v0, v[36:39] offset:13312
ds_write_b128 v0, v[40:43] offset:14336
ds_write_b128 v0, v[44:47] offset:15360
ds_write_b128 v0, v[48:51] offset:16384
ds_write_b128 v0, v[52:55] offset:17408
ds_write_b128 v0, v[56:59] offset:18432
ds_write_b128 v0, v[60:63] offset:19456
ds_write_b128 v0, v[64:67] offset:20480
ds_write_b128 v0, v[68:71] offset:21504
s_waitcnt lgkmcnt(0)
s_waitcnt vmcnt(6)
s_barrier
v_xor_b32 v12, v15, v8
ds_read_b64_tr_b16 v[16:17], v12 offset:24576
ds_read_b64_tr_b16 v[18:19], v12 offset:25088
ds_read_b64_tr_b16 v[20:21], v12 offset:26624
ds_read_b64_tr_b16 v[22:23], v12 offset:27136
ds_read_b64_tr_b16 v[24:25], v8 offset:32768
ds_read_b64_tr_b16 v[26:27], v8 offset:33280
ds_read_b64_tr_b16 v[28:29], v8 offset:34816
ds_read_b64_tr_b16 v[30:31], v8 offset:35328
ds_read_b64_tr_b16 v[32:33], v8 offset:40960
ds_read_b64_tr_b16 v[34:35], v8 offset:41472
ds_read_b64_tr_b16 v[36:37], v8 offset:43008
ds_read_b64_tr_b16 v[38:39], v8 offset:43520
ds_read_b64_tr_b16 v[40:41], v8 offset:49152
ds_read_b64_tr_b16 v[42:43], v8 offset:49664
ds_read_b64_tr_b16 v[44:45], v8 offset:51200
ds_read_b64_tr_b16 v[46:47], v8 offset:51712
v_xor_b32 v12, v15, v8
ds_read_b64_tr_b16 v[48:49], v12 offset:57344
ds_read_b64_tr_b16 v[50:51], v12 offset:57856
ds_read_b64_tr_b16 v[52:53], v12 offset:59392
ds_read_b64_tr_b16 v[54:55], v12 offset:59904
ds_read_b64_tr_b16 v[56:57], v9 offset:0
ds_read_b64_tr_b16 v[58:59], v9 offset:512
ds_read_b64_tr_b16 v[60:61], v9 offset:2048
ds_read_b64_tr_b16 v[62:63], v9 offset:2560
s_waitcnt lgkmcnt(0)
s_barrier
ds_write_b128 v2, v[224:227] offset:16384
ds_write_b128 v2, v[228:231] offset:17408
ds_write_b128 v2, v[24:27] offset:18432
ds_write_b128 v2, v[28:31] offset:19456
ds_write_b128 v2, v[32:35] offset:20480
ds_write_b128 v2, v[36:39] offset:21504
ds_write_b128 v2, v[232:235] offset:22528
ds_write_b128 v2, v[236:239] offset:23552
ds_write_b128 v2, v[240:243] offset:24576
ds_write_b128 v2, v[244:247] offset:25600
ds_write_b128 v2, v[56:59] offset:26624
ds_write_b128 v2, v[60:63] offset:27648
s_waitcnt lgkmcnt(0)
v_mov_b32 v224, v16
v_mov_b32 v225, v17
v_mov_b32 v226, v18
v_mov_b32 v227, v19
v_mov_b32 v228, v20
v_mov_b32 v229, v21
v_mov_b32 v230, v22
v_mov_b32 v231, v23
v_mov_b32 v232, v40
v_mov_b32 v233, v41
v_mov_b32 v234, v42
v_mov_b32 v235, v43
v_mov_b32 v236, v44
v_mov_b32 v237, v45
v_mov_b32 v238, v46
v_mov_b32 v239, v47
v_mov_b32 v240, v48
v_mov_b32 v241, v49
v_mov_b32 v242, v50
v_mov_b32 v243, v51
v_mov_b32 v244, v52
v_mov_b32 v245, v53
v_mov_b32 v246, v54
v_mov_b32 v247, v55
s_waitcnt vmcnt(0)
s_barrier
ds_read_b64_tr_b16 v[16:17], v5 offset:0
ds_read_b64_tr_b16 v[18:19], v5 offset:1024
ds_read_b64_tr_b16 v[20:21], v5 offset:4096
ds_read_b64_tr_b16 v[22:23], v5 offset:5120
ds_read_b64_tr_b16 v[24:25], v5 offset:8192
ds_read_b64_tr_b16 v[26:27], v5 offset:9216
ds_read_b64_tr_b16 v[28:29], v5 offset:12288
ds_read_b64_tr_b16 v[30:31], v5 offset:13312
ds_read_b64_tr_b16 v[32:33], v5 offset:16384
ds_read_b64_tr_b16 v[34:35], v5 offset:17408
ds_read_b64_tr_b16 v[36:37], v5 offset:20480
ds_read_b64_tr_b16 v[38:39], v5 offset:21504
ds_read_b64_tr_b16 v[40:41], v9 offset:8192
ds_read_b64_tr_b16 v[42:43], v9 offset:8704
ds_read_b64_tr_b16 v[44:45], v9 offset:10240
ds_read_b64_tr_b16 v[46:47], v9 offset:10752
ds_read_b64_tr_b16 v[48:49], v9 offset:16384
ds_read_b64_tr_b16 v[50:51], v9 offset:16896
ds_read_b64_tr_b16 v[52:53], v9 offset:18432
ds_read_b64_tr_b16 v[54:55], v9 offset:18944
ds_read_b64_tr_b16 v[56:57], v6 offset:24576
ds_read_b64_tr_b16 v[58:59], v6 offset:25600
ds_read_b64_tr_b16 v[60:61], v6 offset:28672
ds_read_b64_tr_b16 v[62:63], v6 offset:29696
s_waitcnt lgkmcnt(0)
s_barrier
ds_write_b128 v2, v[16:19] offset:40960
ds_write_b128 v2, v[20:23] offset:41984
ds_write_b128 v2, v[24:27] offset:43008
ds_write_b128 v2, v[28:31] offset:44032
ds_write_b128 v2, a[176:179] offset:45056
ds_write_b128 v2, a[180:183] offset:46080
ds_write_b128 v2, v[40:43] offset:47104
ds_write_b128 v2, v[44:47] offset:48128
ds_write_b128 v2, v[248:251] offset:49152
ds_write_b128 v2, v[252:255] offset:50176
ds_write_b128 v2, a[184:187] offset:51200
ds_write_b128 v2, a[188:191] offset:52224
s_waitcnt lgkmcnt(0)
v_accvgpr_write_b32 a176, v32
v_accvgpr_write_b32 a177, v33
v_accvgpr_write_b32 a178, v34
v_accvgpr_write_b32 a179, v35
v_accvgpr_write_b32 a180, v36
v_accvgpr_write_b32 a181, v37
v_accvgpr_write_b32 a182, v38
v_accvgpr_write_b32 a183, v39
v_mov_b32 v248, v48
v_mov_b32 v249, v49
v_mov_b32 v250, v50
v_mov_b32 v251, v51
v_mov_b32 v252, v52
v_mov_b32 v253, v53
v_mov_b32 v254, v54
v_mov_b32 v255, v55
v_accvgpr_write_b32 a184, v56
v_accvgpr_write_b32 a185, v57
v_accvgpr_write_b32 a186, v58
v_accvgpr_write_b32 a187, v59
v_accvgpr_write_b32 a188, v60
v_accvgpr_write_b32 a189, v61
v_accvgpr_write_b32 a190, v62
v_accvgpr_write_b32 a191, v63
s_mov_b32 s90, 0x300003
s_mov_b32 s91, 0x300003
s_mov_b32 s12, 0x3030303
s_mov_b32 s13, 0x3030303
s_mov_b32 s92, 0xc0000c
s_mov_b32 s93, 0xc0000c
s_mov_b32 s14, 0xc0c0c0c
s_mov_b32 s15, 0xc0c0c0c
s_mov_b32 s94, 0x30000300
s_mov_b32 s95, 0x30000300
s_mov_b32 s16, 0x30303030
s_mov_b32 s17, 0x30303030
s_mov_b32 s96, 0xc0000c00
s_mov_b32 s97, 0xc0000c00
s_mov_b32 s18, 0xc0c0c0c0
s_mov_b32 s19, 0xc0c0c0c0
s_mov_b32 s98, 0xff00ff00
s_mov_b32 s99, 0xff00ff00
v_mov_b32 v1, 0x4444
v_mov_b32 v4, 0xeeee
v_cndmask_b32 v1, v1, v4, s[98:99]
v_lshrrev_b32 v4, 8, v0
v_lshl_or_b32 v1, v4, 28, v1
v_bfe_u32 v4, v0, 4, 4
v_lshl_or_b32 v1, v4, 19, v1
s_mov_b32 s51, 0x3e0293ee
s_mov_b32 s52, 0x3f803f80
s_mov_b32 s53, 0x3f803f80
s_mov_b32 s54, 0x3f003f00
s_mov_b32 s55, 0x3f003f00
s_mov_b32 s56, 0xff800000
s_mov_b32 s57, 0xff800000
s_mov_b32 s58, 0x3f80
s_mov_b32 s8, s4
s_mov_b32 s9, s5
s_cmp_eq_u32 s30, 28
s_cselect_b32 s10, s6, 0
s_mov_b32 s31, 0
s_mov_b32 s45, -2
s_lshl_b32 s46, s30, 6
s_add_u32 s46, s46, 222330880
s_lshl_b32 s48, s30, 7
s_and_b32 s49, s30, 15
s_lshl_b32 s49, s49, 12
s_add_u32 s43, s49, 119537664
v_mov_b64 v[12:13], -1
s_add_u32 s38, s48, 119537664
s_add_u32 s39, s48, 119603200
s_add_u32 s40, s48, 119668736
s_add_u32 s41, s48, 119734272
s_add_u32 s42, s48, 119799808
v_lshrrev_b32 v4, 16, v1
buffer_store_dwordx2 v[12:13], v4, s[4:7], s38 offen sc1
buffer_store_dwordx2 v[12:13], v4, s[4:7], s39 offen sc1
buffer_store_dwordx2 v[12:13], v4, s[4:7], s40 offen sc1
buffer_store_dwordx2 v[12:13], v4, s[4:7], s41 offen sc1
buffer_store_dwordx2 v[12:13], v4, s[4:7], s42 offen sc1
k_lay_129:
s_add_u32 s47, s31, 63
s_mov_b32 s33, 120324096
s_mov_b32 s34, 120326144
s_mov_b32 s35, 120330240
s_mul_i32 s48, s31, 655360
s_lshl_b32 s36, s30, 14
s_add_u32 s36, s36, s48
s_add_u32 s36, s36, 0
v_mov_b32 v12, -1
s_and_b32 s48, s30, 15
s_add_u32 s48, s48, 0
s_lshr_b32 s49, s48, 1
s_and_b32 s48, s48, 1
s_lshl_b32 s44, s49, 8
s_lshl_b32 s50, s48, 6
s_add_u32 s44, s44, s50
s_add_u32 s44, s44, s33
s_mul_i32 s48, s48, 5120
s_lshl_b32 s49, s49, 5
s_add_u32 s48, s48, s49
v_lshrrev_b32 v8, 4, v0
v_and_b32 v9, 3, v8
v_mul_u32_u24 v9, 1280, v9
v_bfe_u32 v10, v8, 2, 1
v_lshl_add_u32 v9, v10, 1, v9
v_bfe_u32 v10, v8, 4, 1
v_lshl_add_u32 v9, v10, 4, v9
v_bfe_u32 v10, v8, 5, 1
v_lshl_add_u32 v9, v10, 2, v9
buffer_load_ushort v10, v9, s[24:27], s48 offen
buffer_load_ushort v11, v9, s[24:27], s48 offen offset:8
v_and_b32 v45, 0x30, v0
v_lshrrev_b32 v46, 8, v0
v_lshl_or_b32 v45, v46, 2, v45
v_bfe_u32 v46, v0, 6, 1
v_lshl_or_b32 v45, v46, 7, v45
v_cndmask_b32 v45, v45, 2.0, s[98:99]
s_waitcnt vmcnt(0)
v_lshl_or_b32 v10, v11, 16, v10
s_lshl_b32 s63, s30, 10
s_add_u32 s63, s63, 120356864
s_lshl_b32 s37, s31, 14
s_add_u32 s37, s37, 117440512
s_add_u32 s59, s37, 4096
s_cmp_eq_u32 s31, 0
s_cbranch_scc1 k_l0_130
s_waitcnt vmcnt(0)
s_barrier
v_mov_b32 v8, 160
s_mov_b64 exec, 1
v_or_b32 v9, s64, 1
global_atomic_add v8, v9, s[28:29] sc1
s_add_u32 s49, s31, 0
k_tb_131:
global_load_dword v9, v8, s[28:29] sc1
global_load_dword v11, v8, s[28:29] offset:32 sc1
s_waitcnt vmcnt(1)
v_readfirstlane_b32 s48, v9
s_waitcnt vmcnt(0)
v_readfirstlane_b32 s50, v11
s_cmp_gt_u32 s48, 0xffff
s_cmov_b32 s64, 0x10000
s_cmp_ge_u32 s50, 32
s_cselect_b32 s50, 0xffff, 0
s_and_b32 s48, s48, s50
s_cmp_ge_u32 s48, s49
s_cbranch_scc1 k_tbd_132
s_sub_u32 s32, s32, 1
s_cmp_gt_i32 s32, 0
s_cbranch_scc1 k_tb_131
k_tbd_132:
v_mov_b32 v9, s64
ds_write_b32 v8, v9
s_mov_b64 exec, -1
s_waitcnt lgkmcnt(0)
s_barrier
ds_read_b32 v9, v8
s_waitcnt lgkmcnt(0)
v_readfirstlane_b32 s64, v9
k_l0_130:
buffer_store_dword v10, v45, s[4:7], s44 offen sc1
s_add_u32 s44, s44, 16384
buffer_store_dword v12, v45, s[4:7], s44 offen sc1
s_waitcnt vmcnt(0)
s_barrier
v_mov_b32 v8, 160
s_mov_b64 exec, 1
v_or_b32 v9, s64, 1
global_atomic_add v8, v9, s[28:29] sc1
s_add_u32 s49, s31, 32
k_tb_133:
global_load_dword v9, v8, s[28:29] sc1
global_load_dword v11, v8, s[28:29] offset:32 sc1
s_waitcnt vmcnt(1)
v_readfirstlane_b32 s48, v9
s_waitcnt vmcnt(0)
v_readfirstlane_b32 s50, v11
s_cmp_gt_u32 s48, 0xffff
s_cmov_b32 s64, 0x10000
s_cmp_ge_u32 s50, 32
s_cselect_b32 s50, 0xffff, 0
s_and_b32 s48, s48, s50
s_cmp_ge_u32 s48, s49
s_cbranch_scc1 k_tbd_134
s_sub_u32 s32, s32, 1
s_cmp_gt_i32 s32, 0
s_cbranch_scc1 k_tb_133
k_tbd_134:
v_mov_b32 v9, s64
ds_write_b32 v8, v9
s_mov_b64 exec, -1
s_waitcnt lgkmcnt(0)
s_barrier
ds_read_b32 v9, v8
s_waitcnt lgkmcnt(0)
v_readfirstlane_b32 s64, v9
v_lshlrev_b32 v23, v0, s58
v_cndmask_b32 v20, 0, v23, s[90:91]
v_cndmask_b32 v21, 0, v23, s[92:93]
v_cndmask_b32 v22, 0, v23, s[94:95]
v_cndmask_b32 v23, 0, v23, s[96:97]
s_cmp_lg_u32 s64, 0
s_cbranch_scc1 k_far_135
s_branch k_cold2_139
k_T0_137:
s_waitcnt vmcnt(2)
v_smfmac_f32_16x16x64_bf16 v[40:43], v[4:7], v[48:55], v1
s_waitcnt vmcnt(1)
v_cmp_u_f32 vcc, v4, v8
v_smfmac_f32_16x16x64_bf16 v[24:27], v[8:11], a[24:31], v1
v_smfmac_f32_16x16x64_bf16 v[28:31], v[8:11], a[32:39], v1
s_cbranch_vccnz k_cold_138
k_okC_140:
s_waitcnt vmcnt(1)
v_smfmac_f32_16x16x64_bf16 v[36:39], v[8:11], a[40:47], v1
s_waitcnt lgkmcnt(0)
ds_read_b128 v[48:51], v2 offset:45056
v_smfmac_f32_16x16x64_bf16 v[32:35], v[4:7], v[64:71], v1
ds_read_b128 v[52:55], v2 offset:46080
ds_read_b128 v[64:67], v0 offset:10240
v_smfmac_f32_16x16x64_bf16 v[44:47], v[4:7], v[56:63], v1
ds_read_b128 v[68:71], v0 offset:11264
v_smfmac_f32_16x16x64_bf16 v[28:31], v[4:7], a[8:15], v1
v_smfmac_f32_16x16x64_bf16 v[24:27], v[4:7], a[0:7], v1
ds_read_b128 v[56:59], v2 offset:22528
v_smfmac_f32_16x16x64_bf16 v[36:39], v[4:7], a[16:23], v1
ds_read_b128 v[60:63], v2 offset:23552
s_waitcnt lgkmcnt(4)
v_smfmac_f32_16x16x64_bf16 v[40:43], v[8:11], v[48:55], v1
s_waitcnt vmcnt(0)
ds_write_b128 v0, v[12:15] offset:0
s_waitcnt lgkmcnt(3)
v_smfmac_f32_16x16x64_bf16 v[32:35], v[8:11], v[64:71], v1
buffer_load_dwordx4 v[16:19], v0, s[4:7], s35 offen offset:0 sc1
v_cmp_u_f32 vcc, v12, v12
s_waitcnt lgkmcnt(1)
v_smfmac_f32_16x16x64_bf16 v[44:47], v[8:11], v[56:63], v1
ds_read_b128 v[56:59], v0 offset:20480
ds_read_b128 v[60:63], v0 offset:21504
ds_read_b128 v[64:67], v0 offset:12288
s_cbranch_vccnz k_coldA_141
k_okA_142:
v_smfmac_f32_16x16x64_bf16 v[36:39], v[12:15], a[64:71], v1
ds_read_b128 v[68:71], v0 offset:13312
s_waitcnt lgkmcnt(4)
v_smfmac_f32_16x16x64_bf16 v[40:43], v[12:15], a[72:79], v1
s_barrier
v_smfmac_f32_16x16x64_bf16 v[28:31], v[12:15], a[56:63], v1
ds_read_b128 v[8:11], v0 offset:1024
buffer_load_dwordx4 v[48:51], v0, s[4:7], s36 offen offset:0 sc1
s_waitcnt lgkmcnt(3)
v_smfmac_f32_16x16x64_bf16 v[44:47], v[12:15], v[56:63], v1
ds_read_b128 v[56:59], v2 offset:40960
v_smfmac_f32_16x16x64_bf16 v[24:27], v[12:15], a[48:55], v1
ds_read_b128 v[60:63], v2 offset:41984
s_waitcnt lgkmcnt(3)
v_smfmac_f32_16x16x64_bf16 v[32:35], v[12:15], v[64:71], v1
buffer_load_dwordx4 v[52:55], v0, s[4:7], s36 offen offset:1024 sc1
s_waitcnt lgkmcnt(2)
v_smfmac_f32_16x16x64_bf16 v[24:27], v[8:11], a[80:87], v1
ds_read_b128 v[64:67], v0 offset:14336
ds_read_b128 v[68:71], v0 offset:15360
v_smfmac_f32_16x16x64_bf16 v[36:39], v[8:11], a[96:103], v1
buffer_store_dwordx4 v[4:7], v0, s[8:11], s37 offen offset:0 sc1
s_waitcnt lgkmcnt(2)
s_nop 0
ds_read_b128 v[4:7], v0 offset:2048
v_smfmac_f32_16x16x64_bf16 v[44:47], v[8:11], v[56:63], v1
ds_read_b128 v[56:59], v2 offset:43008
ds_read_b128 v[60:63], v2 offset:44032
v_smfmac_f32_16x16x64_bf16 v[28:31], v[8:11], a[88:95], v1
buffer_store_dwordx4 v[12:15], v0, s[8:11], s37 offen offset:2048 sc1
v_smfmac_f32_16x16x64_bf16 v[40:43], v[8:11], a[104:111], v1
s_waitcnt lgkmcnt(3)
s_waitcnt lgkmcnt(2)
v_smfmac_f32_16x16x64_bf16 v[32:35], v[8:11], v[64:71], v1
ds_read_b128 v[64:67], v0 offset:16384
ds_read_b128 v[12:15], v0 offset:3072
v_smfmac_f32_16x16x64_bf16 v[36:39], v[4:7], a[128:135], v1
s_waitcnt lgkmcnt(2)
v_smfmac_f32_16x16x64_bf16 v[44:47], v[4:7], v[56:63], v1
ds_read_b128 v[68:71], v0 offset:17408
buffer_load_dwordx4 v[56:59], v0, s[4:7], s36 offen offset:2048 sc1
v_smfmac_f32_16x16x64_bf16 v[28:31], v[4:7], a[120:127], v1
v_smfmac_f32_16x16x64_bf16 v[24:27], v[4:7], a[112:119], v1
s_waitcnt vmcnt(5)
ds_write_b128 v0, v[16:19] offset:4096
v_smfmac_f32_16x16x64_bf16 v[40:43], v[4:7], a[136:143], v1
s_waitcnt lgkmcnt(1)
buffer_load_dwordx4 v[60:63], v0, s[4:7], s36 offen offset:3072 sc1
v_cmp_u_f32 vcc, v16, v16
v_smfmac_f32_16x16x64_bf16 v[32:35], v[4:7], v[64:71], v1
ds_read_b128 v[64:67], v0 offset:18432
ds_read_b128 v[68:71], v0 offset:19456
v_smfmac_f32_16x16x64_bf16 v[28:31], v[12:15], a[152:159], v1
v_smfmac_f32_16x16x64_bf16 v[24:27], v[12:15], a[144:151], v1
s_cbranch_vccnz k_coldB_143
k_okB_144:
v_smfmac_f32_16x16x64_bf16 v[36:39], v[12:15], a[160:167], v1
s_waitcnt lgkmcnt(2)
buffer_store_dwordx4 v[16:19], v0, s[8:11], s59 offen offset:2048 sc1
s_barrier
ds_read_b128 v[4:7], v0 offset:6144
v_smfmac_f32_16x16x64_bf16 v[44:47], v[12:15], a[176:183], v1
ds_read_b128 v[8:11], v0 offset:5120
s_waitcnt lgkmcnt(2)
v_smfmac_f32_16x16x64_bf16 v[32:35], v[12:15], v[64:71], v1
ds_read_b128 v[64:67], v2 offset:24576
ds_read_b128 v[68:71], v2 offset:25600
v_smfmac_f32_16x16x64_bf16 v[24:27], v[16:19], a[184:191], v1
v_smfmac_f32_16x16x64_bf16 v[40:43], v[12:15], a[168:175], v1
s_waitcnt lgkmcnt(3)
ds_read_b128 v[12:15], v0 offset:7168
v_smfmac_f32_16x16x64_bf16 v[24:27], v[4:7], a[208:215], v1
s_waitcnt lgkmcnt(3)
v_smfmac_f32_16x16x64_bf16 v[28:31], v[4:7], a[216:223], v1
v_smfmac_f32_16x16x64_bf16 v[28:31], v[8:11], a[200:207], v1
s_waitcnt lgkmcnt(1)
v_smfmac_f32_16x16x64_bf16 v[24:27], v[8:11], v[64:71], v1
ds_read_b128 v[64:67], v2 offset:49152
s_waitcnt lgkmcnt(1)
v_smfmac_f32_16x16x64_bf16 v[24:27], v[12:15], a[224:231], v1
ds_read_b128 v[68:71], v2 offset:50176
v_smfmac_f32_16x16x64_bf16 v[28:31], v[12:15], a[232:239], v1
v_smfmac_f32_16x16x64_bf16 v[28:31], v[16:19], a[192:199], v1
v_cvt_pk_bf16_f32 v24, v24, v25
v_cvt_pk_bf16_f32 v25, v26, v27
v_smfmac_f32_16x16x64_bf16 v[32:35], v[4:7], v[80:87], v1
v_cvt_pk_bf16_f32 v26, v28, v29
v_cvt_pk_bf16_f32 v27, v30, v31
v_smfmac_f32_16x16x64_bf16 v[32:35], v[8:11], a[248:255], v1
s_waitcnt lgkmcnt(0)
v_mfma_f32_16x16x32_bf16 v[28:31], v[24:27], v[20:23], 0
v_and_b32 v26, 0xffffff7f, v0
v_smfmac_f32_16x16x64_bf16 v[32:35], v[16:19], v[64:71], v1
v_and_or_b32 v26, v1, 8, v26
v_mul_f32 v28, s51, v28
v_mul_f32 v29, s51, v29
v_mul_f32 v31, s51, v31
v_cvt_pk_bf16_f32 v24, v28, v29
v_mul_f32 v30, s51, v30
v_cvt_pk_bf16_f32 v25, v30, v31
v_smfmac_f32_16x16x64_bf16 v[32:35], v[12:15], v[96:103], v1
ds_write_b64 v26, v[24:25] offset:0
v_smfmac_f32_16x16x64_bf16 v[36:39], v[8:11], v[72:79], v1
v_cvt_pk_bf16_f32 v32, v32, v33
v_smfmac_f32_16x16x64_bf16 v[36:39], v[16:19], a[240:247], v1
buffer_load_dwordx4 v[64:67], v0, s[4:7], s61 offen offset:0
v_cvt_pk_bf16_f32 v33, v34, v35
v_smfmac_f32_16x16x64_bf16 v[36:39], v[12:15], v[104:111], v1
s_waitcnt lgkmcnt(0)
v_smfmac_f32_16x16x64_bf16 v[36:39], v[4:7], v[88:95], v1
s_barrier
ds_read_b128 v[24:27], v0 offset:0
v_smfmac_f32_16x16x64_bf16 v[40:43], v[4:7], v[144:151], v1
ds_read_b128 v[28:31], v0 offset:1024
s_nop 0
v_cvt_pk_bf16_f32 v34, v36, v37
v_cvt_pk_bf16_f32 v35, v38, v39
s_nop 1
v_mfma_f32_16x16x32_bf16 v[36:39], v[32:35], v[20:23], 0
s_waitcnt vmcnt(6)
buffer_load_dwordx4 v[68:71], v0, s[4:7], s61 offen offset:1024
v_and_b32 v34, 0xffffff7f, v0
v_and_or_b32 v34, v1, 8, v34
s_waitcnt lgkmcnt(1)
v_mfma_f32_16x16x32_bf16 v[48:51], v[48:51], v[24:27], 0
v_cvt_pk_bf16_f32 v32, v36, v37
s_waitcnt lgkmcnt(0)
v_mfma_f32_16x16x32_bf16 v[48:51], v[52:55], v[28:31], v[48:51]
v_mov_b64 v[52:53], s[56:57]
v_cvt_pk_bf16_f32 v33, v38, v39
v_smfmac_f32_16x16x64_bf16 v[44:47], v[4:7], v[152:159], v1
ds_write_b64 v34, v[32:33] offset:2048
v_permlane32_swap_b32 v48, v50
v_permlane32_swap_b32 v49, v51
v_add_f32_dpp v52, v50, v48 row_ror:8 row_mask:0xf bank_mask:0x3
v_exp_f32 v52, v52
v_add_f32_dpp v53, v51, v49 row_ror:8 row_mask:0xf bank_mask:0x3
v_exp_f32 v53, v53
s_nop 0
v_cvt_pk_bf16_f32 v48, v52, v53
v_smfmac_f32_16x16x64_bf16 v[44:47], v[16:19], v[120:127], v1
ds_write_b32 v0, v48 offset:4096
v_smfmac_f32_16x16x64_bf16 v[44:47], v[12:15], v[168:175], v1
buffer_load_dwordx4 v[48:51], v0, s[4:7], s61 offen offset:2048
v_smfmac_f32_16x16x64_bf16 v[40:43], v[12:15], v[160:167], v1
s_waitcnt lgkmcnt(1)
v_xor_b32 v12, 0x80, v0
v_smfmac_f32_16x16x64_bf16 v[40:43], v[8:11], v[128:135], v1
s_waitcnt lgkmcnt(0)
s_barrier
ds_read_b128 v[32:35], v0 offset:2048
v_mov_b64 v[22:23], s[52:53]
v_smfmac_f32_16x16x64_bf16 v[40:43], v[16:19], v[112:119], v1
ds_read_b128 v[36:39], v0 offset:3072
ds_read_b128 v[16:19], v0 offset:4096
buffer_load_dwordx4 v[52:55], v0, s[4:7], s61 offen offset:3072
v_smfmac_f32_16x16x64_bf16 v[44:47], v[8:11], v[136:143], v1
ds_read_b128 v[12:15], v12 offset:4096
v_cvt_pk_bf16_f32 v40, v40, v41
v_mov_b64 v[20:21], s[52:53]
s_waitcnt lgkmcnt(3)
v_mfma_f32_16x16x32_bf16 v[24:27], v[32:35], v[24:27], 0
v_cvt_pk_bf16_f32 v41, v42, v43
s_waitcnt lgkmcnt(2)
v_mfma_f32_16x16x32_bf16 v[24:27], v[36:39], v[28:31], v[24:27]
s_waitcnt vmcnt(5)
s_waitcnt lgkmcnt(1)
v_mfma_f32_16x16x32_bf16 v[8:11], v[56:59], v[16:19], 0
buffer_load_dwordx4 v[56:59], v0, s[4:7], s62 offen offset:0
v_mov_b64 v[28:29], s[56:57]
v_cvt_pk_bf16_f32 v43, v46, v47
v_cvt_pk_bf16_f32 v42, v44, v45
v_permlane32_swap_b32 v25, v27
v_permlane32_swap_b32 v24, v26
v_mfma_f32_16x16x32_bf16 v[4:7], v[20:23], v[16:19], 0
s_waitcnt lgkmcnt(0)
v_add_f32_dpp v28, v26, v24 row_ror:8 row_mask:0xf bank_mask:0x3
v_add_f32_dpp v29, v27, v25 row_ror:8 row_mask:0xf bank_mask:0x3
v_exp_f32 v28, v28
v_mfma_f32_16x16x32_bf16 v[8:11], v[60:63], v[12:15], v[8:11]
buffer_load_dwordx4 v[60:63], v0, s[4:7], s62 offen offset:1024
v_exp_f32 v29, v29
v_permlane32_swap_b32 v42, v43
v_cvt_pk_bf16_f32 v24, v28, v29
v_mov_b64 v[44:45], s[54:55]
v_cvt_pk_bf16_f32 v25, v28, v29
v_mov_b32_dpp v26, v24 row_ror:8 row_mask:0xf bank_mask:0xf
v_mov_b32_dpp v27, v24 row_ror:8 row_mask:0xf bank_mask:0xf
v_mfma_f32_16x16x16_bf16 v[4:7], v[44:45], v[24:25], v[4:7]
v_permlane32_swap_b32 v40, v41
v_mov_b64 v[36:37], 0
v_mov_b64 v[38:39], 0
v_mov_b64 v[30:31], 0
v_mfma_f32_16x16x32_bf16 v[8:11], v[40:43], v[24:27], v[8:11]
buffer_load_dwordx4 v[16:19], v0, s[4:7], s62 offen offset:2048
v_rcp_f32 v6, v4
v_and_b32 v12, 0xffffff7f, v0
v_and_or_b32 v13, v1, 8, v12
v_rcp_f32_dpp v6, v4 row_ror:8 row_mask:0xf bank_mask:0xc
v_mov_b64 v[26:27], 0
v_pk_mul_f32 v[8:9], v[8:9], v[6:7] op_sel_hi:[1,0]
v_cvt_pk_bf16_f32 v44, v8, v9
v_pk_mul_f32 v[10:11], v[10:11], v[6:7] op_sel_hi:[1,0]
v_cvt_pk_bf16_f32 v45, v10, v11
s_waitcnt vmcnt(5)
ds_write_b64 v13, v[44:45] offset:6144
buffer_load_dwordx4 v[20:23], v0, s[4:7], s62 offen offset:3072
v_add_u32 v6, 0xd4800000, v6
v_cmp_lt_u32 vcc, 0x28000000, v6
v_mov_b64 v[34:35], 0
v_mov_b32_dpp v46, v44 row_ror:8 row_mask:0xf bank_mask:0xf
v_mov_b32_dpp v47, v45 row_ror:8 row_mask:0xf bank_mask:0xf
v_mov_b64 v[28:29], 0
v_mov_b64 v[32:33], 0
s_cbranch_vccnz k_slow_145
k_okS_146:
v_smfmac_f32_16x16x64_bf16 v[36:39], v[44:47], v[224:231], v1
s_waitcnt lgkmcnt(0)
s_barrier
ds_read_b128 v[8:11], v12 offset:7168
v_smfmac_f32_16x16x64_bf16 v[32:35], v[44:47], v[200:207], v1
s_waitcnt vmcnt(4)
ds_read_b128 v[4:7], v12 offset:6272
v_mov_b64 v[24:25], 0
v_smfmac_f32_16x16x64_bf16 v[28:31], v[44:47], v[48:55], v1
ds_read_b128 v[12:15], v12 offset:7296
ds_read_b128 v[48:51], v2 offset:16384
v_smfmac_f32_16x16x64_bf16 v[24:27], v[44:47], v[64:71], v1
ds_read_b128 v[52:55], v2 offset:17408
v_mov_b64 v[42:43], 0
s_waitcnt lgkmcnt(4)
v_smfmac_f32_16x16x64_bf16 v[24:27], v[8:11], v[184:191], v1
s_waitcnt lgkmcnt(3)
v_mov_b64 v[40:41], 0
v_smfmac_f32_16x16x64_bf16 v[24:27], v[4:7], v[176:183], v1
s_waitcnt lgkmcnt(2)
ds_read_b128 v[64:67], v2 offset:51200
v_smfmac_f32_16x16x64_bf16 v[24:27], v[12:15], v[192:199], v1
ds_read_b128 v[68:71], v2 offset:52224
v_smfmac_f32_16x16x64_bf16 v[40:43], v[44:47], v[240:247], v1
s_waitcnt vmcnt(2)
s_waitcnt lgkmcnt(2)
v_lshrrev_b32 v44, 16, v1
v_cvt_pk_bf16_f32 v24, v24, v25
v_bfi_b32 v24, 1, s45, v24
v_cvt_pk_bf16_f32 v25, v26, v27
v_smfmac_f32_16x16x64_bf16 v[28:31], v[8:11], v[48:55], v1
buffer_store_dwordx2 v[24:25], v44, s[4:7], s38 offen
ds_read_b128 v[48:51], v2 offset:20480
ds_read_b128 v[52:55], v2 offset:21504
v_smfmac_f32_16x16x64_bf16 v[28:31], v[12:15], v[56:63], v1
s_waitcnt lgkmcnt(2)
ds_read_b128 v[56:59], v2 offset:26624
v_smfmac_f32_16x16x64_bf16 v[28:31], v[4:7], v[64:71], v1
ds_read_b128 v[60:63], v2 offset:27648
v_smfmac_f32_16x16x64_bf16 v[32:35], v[8:11], v[208:215], v1
ds_read_b128 v[64:67], v2 offset:18432
s_nop 0
v_cvt_pk_bf16_f32 v28, v28, v29
v_bfi_b32 v28, 1, s45, v28
v_cvt_pk_bf16_f32 v29, v30, v31
v_smfmac_f32_16x16x64_bf16 v[32:35], v[12:15], v[216:223], v1
buffer_store_dwordx2 v[28:29], v44, s[4:7], s39 offen
v_smfmac_f32_16x16x64_bf16 v[40:43], v[12:15], v[248:255], v1
ds_read_b128 v[68:71], v2 offset:19456
s_waitcnt vmcnt(2)
v_smfmac_f32_16x16x64_bf16 v[32:35], v[4:7], v[16:23], v1
s_waitcnt lgkmcnt(2)
v_smfmac_f32_16x16x64_bf16 v[36:39], v[12:15], v[232:239], v1
ds_read_b128 v[16:19], v2 offset:47104
ds_read_b128 v[20:23], v2 offset:48128
v_cvt_pk_bf16_f32 v32, v32, v33
v_bfi_b32 v32, 1, s45, v32
v_cvt_pk_bf16_f32 v33, v34, v35
v_smfmac_f32_16x16x64_bf16 v[36:39], v[8:11], v[48:55], v1
buffer_store_dwordx2 v[32:33], v44, s[4:7], s40 offen
s_waitcnt lgkmcnt(2)
v_smfmac_f32_16x16x64_bf16 v[36:39], v[4:7], v[64:71], v1
s_nop 6
v_cvt_pk_bf16_f32 v36, v36, v37
v_cvt_pk_bf16_f32 v37, v38, v39
s_waitcnt lgkmcnt(0)
v_bfi_b32 v36, 1, s45, v36
v_smfmac_f32_16x16x64_bf16 v[40:43], v[8:11], v[16:23], v1
buffer_store_dwordx2 v[36:37], v44, s[4:7], s41 offen
v_smfmac_f32_16x16x64_bf16 v[40:43], v[4:7], v[56:63], v1
s_nop 6
v_cvt_pk_bf16_f32 v40, v40, v41
v_bfi_b32 v40, 1, s45, v40
v_cvt_pk_bf16_f32 v41, v42, v43
buffer_store_dwordx2 v[40:41], v44, s[4:7], s42 offen
s_barrier
buffer_load_dwordx4 v[24:27], v0, s[4:7], s43 offen offset:0 sc1
buffer_load_dwordx4 v[28:31], v0, s[4:7], s43 offen offset:1024 sc1
buffer_load_dwordx4 v[32:35], v0, s[4:7], s43 offen offset:2048 sc1
buffer_load_dwordx4 v[36:39], v0, s[4:7], s43 offen offset:3072 sc1
v_lshlrev_b32 v23, v0, s58
v_cndmask_b32 v16, 0, v23, s[12:13]
v_cndmask_b32 v17, 0, v23, s[14:15]
v_cndmask_b32 v18, 0, v23, s[16:17]
v_cndmask_b32 v19, 0, v23, s[18:19]
v_and_b32 v45, 0x30, v0
v_lshrrev_b32 v46, 8, v0
v_lshl_or_b32 v45, v46, 2, v45
v_bfe_u32 v46, v0, 6, 1
v_lshl_or_b32 v45, v46, 7, v45
v_cndmask_b32 v45, v45, 2.0, s[98:99]
v_cndmask_b32 v20, 0, v23, s[90:91]
v_cndmask_b32 v21, 0, v23, s[92:93]
v_cndmask_b32 v22, 0, v23, s[94:95]
v_cndmask_b32 v23, 0, v23, s[96:97]
s_add_u32 s33, s33, 16384
s_bitset0_b32 s33, 16
s_waitcnt vmcnt(3)
v_mfma_f32_16x16x32_bf16 v[40:43], v[24:27], v[16:19], 0
s_waitcnt vmcnt(2)
v_mfma_f32_16x16x32_bf16 v[40:43], v[28:31], v[16:19], v[40:43]
v_bitop3_b32 v46, v24, v28, s45 bitop3:0x7e
s_waitcnt vmcnt(1)
v_mfma_f32_16x16x32_bf16 v[40:43], v[32:35], v[16:19], v[40:43]
s_waitcnt vmcnt(0)
v_mfma_f32_16x16x32_bf16 v[40:43], v[36:39], v[16:19], v[40:43]
v_bitop3_b32 v47, v32, v36, s45 bitop3:0x7e
v_bitop3_b32 v46, v46, v47, 1 bitop3:0xa8
v_cmp_ne_u32 vcc, 0, v46
v_mov_b64 v[24:25], 0
v_mov_b64 v[26:27], 0
v_mov_b64 v[28:29], 0
v_mov_b64 v[30:31], 0
v_permlane32_swap_b32 v40, v41
v_permlane32_swap_b32 v42, v43
v_add_f32 v40, v40, v41
v_add_f32 v41, v42, v43
v_cvt_pk_bf16_f32 v42, v40, v41
s_cbranch_vccnz k_r1_148
k_ok1_149:
buffer_store_dword v42, v45, s[4:7], s44 offen
buffer_load_dwordx4 v[48:51], v0, s[4:7], s60 offen offset:0
buffer_load_dwordx4 v[52:55], v0, s[4:7], s60 offen offset:1024
buffer_load_dwordx4 v[56:59], v0, s[4:7], s60 offen offset:2048
buffer_load_dwordx4 v[60:63], v0, s[4:7], s60 offen offset:3072
s_barrier
buffer_load_dwordx4 v[4:7], v0, s[4:7], s33 offen offset:0 sc1
buffer_load_dwordx4 v[8:11], v0, s[4:7], s33 offen offset:1024 sc1
s_add_u32 s34, s33, 2048
s_add_u32 s35, s33, 6144
s_add_u32 s36, s36, 524288
s_add_u32 s37, s37, 10240
s_add_u32 s59, s59, 10240
v_mov_b64 v[32:33], 0
v_mov_b64 v[34:35], 0
v_mov_b64 v[36:37], 0
v_mov_b64 v[38:39], 0
v_mov_b64 v[40:41], 0
v_mov_b64 v[42:43], 0
v_mov_b64 v[44:45], 0
v_mov_b64 v[46:47], 0
s_add_u32 s44, s44, 16384
s_bitset0_b32 s44, 16
s_sub_u32 s45, s45, 1
s_add_u32 s31, s31, 1
ds_read_b128 v[64:67], v0 offset:8192
ds_read_b128 v[68:71], v0 offset:9216
buffer_load_dwordx4 v[12:15], v0, s[4:7], s34 offen offset:0 sc1
s_cmp_lg_u32 s31, s47
s_cbranch_scc1 k_T0_137
s_branch k_done_147
k_cold2_139:
s_barrier
buffer_load_dwordx4 v[48:51], v0, s[4:7], s60 offen offset:0
buffer_load_dwordx4 v[52:55], v0, s[4:7], s60 offen offset:1024
buffer_load_dwordx4 v[56:59], v0, s[4:7], s60 offen offset:2048
buffer_load_dwordx4 v[60:63], v0, s[4:7], s60 offen offset:3072
ds_read_b128 v[64:67], v0 offset:8192
ds_read_b128 v[68:71], v0 offset:9216
k_cold_138:
buffer_load_dwordx4 v[4:7], v0, s[4:7], s33 offen offset:0 sc1
buffer_load_dwordx4 v[8:11], v0, s[4:7], s33 offen offset:1024 sc1
buffer_load_dwordx4 v[12:15], v0, s[4:7], s34 offen offset:0 sc1
s_sub_u32 s32, s32, 1
s_cmp_gt_i32 s32, 0
s_cbranch_scc0 k_okC_140
v_mov_b64 v[24:25], 0
v_mov_b64 v[26:27], 0
v_mov_b64 v[28:29], 0
v_mov_b64 v[30:31], 0
v_mov_b64 v[32:33], 0
v_mov_b64 v[34:35], 0
v_mov_b64 v[36:37], 0
v_mov_b64 v[38:39], 0
v_mov_b64 v[40:41], 0
v_mov_b64 v[42:43], 0
v_mov_b64 v[44:45], 0
v_mov_b64 v[46:47], 0
s_branch k_T0_137
k_coldA_141:
buffer_load_dwordx4 v[12:15], v0, s[4:7], s34 offen offset:0 sc1
s_sub_u32 s32, s32, 1
s_cmp_gt_i32 s32, 0
s_waitcnt vmcnt(0)
v_cmp_u_f32 vcc, v12, v12
ds_write_b128 v0, v[12:15] offset:0
s_waitcnt lgkmcnt(0)
s_cbranch_vccz k_okA_142
s_cbranch_scc1 k_coldA_141
s_branch k_okA_142
k_coldB_143:
buffer_load_dwordx4 v[16:19], v0, s[4:7], s35 offen offset:0 sc1
s_sub_u32 s32, s32, 1
s_cmp_gt_i32 s32, 0
s_waitcnt vmcnt(0)
v_cmp_u_f32 vcc, v16, v16
ds_write_b128 v0, v[16:19] offset:4096
s_waitcnt lgkmcnt(0)
s_cbranch_vccz k_okB_144
s_cbranch_scc1 k_coldB_143
s_branch k_okB_144
k_r1_148:
buffer_load_dwordx4 v[24:27], v0, s[4:7], s43 offen offset:0 sc1
buffer_load_dwordx4 v[28:31], v0, s[4:7], s43 offen offset:1024 sc1
buffer_load_dwordx4 v[32:35], v0, s[4:7], s43 offen offset:2048 sc1
buffer_load_dwordx4 v[36:39], v0, s[4:7], s43 offen offset:3072 sc1
s_sub_u32 s32, s32, 1
s_cmp_gt_i32 s32, 0
s_waitcnt vmcnt(3)
v_mfma_f32_16x16x32_bf16 v[40:43], v[24:27], v[16:19], 0
s_waitcnt vmcnt(2)
v_mfma_f32_16x16x32_bf16 v[40:43], v[28:31], v[16:19], v[40:43]
v_bitop3_b32 v46, v24, v28, s45 bitop3:0x7e
s_waitcnt vmcnt(1)
v_mfma_f32_16x16x32_bf16 v[40:43], v[32:35], v[16:19], v[40:43]
s_waitcnt vmcnt(0)
v_mfma_f32_16x16x32_bf16 v[40:43], v[36:39], v[16:19], v[40:43]
v_bitop3_b32 v47, v32, v36, s45 bitop3:0x7e
v_bitop3_b32 v46, v46, v47, 1 bitop3:0xa8
v_cmp_ne_u32 vcc, 0, v46
v_mov_b64 v[24:25], 0
v_mov_b64 v[26:27], 0
v_mov_b64 v[28:29], 0
v_mov_b64 v[30:31], 0
v_permlane32_swap_b32 v40, v41
v_permlane32_swap_b32 v42, v43
v_add_f32 v40, v40, v41
v_add_f32 v41, v42, v43
v_cvt_pk_bf16_f32 v42, v40, v41
s_cbranch_vccz k_ok1_149
s_cbranch_scc1 k_r1_148
s_branch k_ok1_149
k_slow_145:
ds_read_b128 v[24:27], v0 offset:0
ds_read_b128 v[28:31], v0 offset:1024
v_mov_b32 v46, 0xff7fffff
s_add_u32 s48, s36, 0x0
buffer_load_dwordx4 v[32:35], v0, s[4:7], s48 offen offset:0 sc1
buffer_load_dwordx4 v[36:39], v0, s[4:7], s48 offen offset:1024 sc1
s_waitcnt vmcnt(1) lgkmcnt(1)
v_mfma_f32_16x16x32_bf16 v[4:7], v[32:35], v[24:27], 0
s_waitcnt vmcnt(0) lgkmcnt(0)
v_mfma_f32_16x16x32_bf16 v[4:7], v[36:39], v[28:31], v[4:7]
v_mov_b64 v[8:9], s[56:57]
s_nop 5
v_permlane32_swap_b32 v4, v6
v_permlane32_swap_b32 v5, v7
v_add_f32_dpp v8, v6, v4 row_ror:8 row_mask:0xf bank_mask:0x3
s_nop 0
v_add_f32_dpp v9, v7, v5 row_ror:8 row_mask:0xf bank_mask:0x3
v_max3_f32 v46, v46, v8, v9
s_add_u32 s48, s36, 0x1000
buffer_load_dwordx4 v[32:35], v0, s[4:7], s48 offen offset:0 sc1
buffer_load_dwordx4 v[36:39], v0, s[4:7], s48 offen offset:1024 sc1
s_waitcnt vmcnt(1)
v_mfma_f32_16x16x32_bf16 v[4:7], v[32:35], v[24:27], 0
s_waitcnt vmcnt(0)
v_mfma_f32_16x16x32_bf16 v[4:7], v[36:39], v[28:31], v[4:7]
v_mov_b64 v[10:11], s[56:57]
s_nop 5
v_permlane32_swap_b32 v4, v6
v_permlane32_swap_b32 v5, v7
v_add_f32_dpp v10, v6, v4 row_ror:8 row_mask:0xf bank_mask:0x3
s_nop 0
v_add_f32_dpp v11, v7, v5 row_ror:8 row_mask:0xf bank_mask:0x3
v_max3_f32 v46, v46, v10, v11
s_add_u32 s48, s36, 0x2000
buffer_load_dwordx4 v[32:35], v0, s[4:7], s48 offen offset:0 sc1
buffer_load_dwordx4 v[36:39], v0, s[4:7], s48 offen offset:1024 sc1
s_waitcnt vmcnt(1)
v_mfma_f32_16x16x32_bf16 v[4:7], v[32:35], v[24:27], 0
s_waitcnt vmcnt(0)
v_mfma_f32_16x16x32_bf16 v[4:7], v[36:39], v[28:31], v[4:7]
v_mov_b64 v[12:13], s[56:57]
s_nop 5
v_permlane32_swap_b32 v4, v6
v_permlane32_swap_b32 v5, v7
v_add_f32_dpp v12, v6, v4 row_ror:8 row_mask:0xf bank_mask:0x3
s_nop 0
v_add_f32_dpp v13, v7, v5 row_ror:8 row_mask:0xf bank_mask:0x3
v_max3_f32 v46, v46, v12, v13
s_add_u32 s48, s36, 0x3000
buffer_load_dwordx4 v[32:35], v0, s[4:7], s48 offen offset:0 sc1
buffer_load_dwordx4 v[36:39], v0, s[4:7], s48 offen offset:1024 sc1
s_waitcnt vmcnt(1)
v_mfma_f32_16x16x32_bf16 v[4:7], v[32:35], v[24:27], 0
s_waitcnt vmcnt(0)
v_mfma_f32_16x16x32_bf16 v[4:7], v[36:39], v[28:31], v[4:7]
v_mov_b64 v[14:15], s[56:57]
s_nop 5
v_permlane32_swap_b32 v4, v6
v_permlane32_swap_b32 v5, v7
v_add_f32_dpp v14, v6, v4 row_ror:8 row_mask:0xf bank_mask:0x3
s_nop 0
v_add_f32_dpp v15, v7, v5 row_ror:8 row_mask:0xf bank_mask:0x3
v_max3_f32 v46, v46, v14, v15
ds_read_b128 v[32:35], v0 offset:2048
ds_read_b128 v[36:39], v0 offset:3072
s_waitcnt lgkmcnt(1)
v_mfma_f32_16x16x32_bf16 v[4:7], v[32:35], v[24:27], 0
s_waitcnt lgkmcnt(0)
v_mfma_f32_16x16x32_bf16 v[4:7], v[36:39], v[28:31], v[4:7]
v_mov_b64 v[44:45], s[56:57]
s_nop 5
v_permlane32_swap_b32 v4, v6
v_permlane32_swap_b32 v5, v7
v_add_f32_dpp v44, v6, v4 row_ror:8 row_mask:0xf bank_mask:0x3
s_nop 0
v_add_f32_dpp v45, v7, v5 row_ror:8 row_mask:0xf bank_mask:0x3
v_max3_f32 v46, v46, v44, v45
buffer_load_dwordx4 v[32:35], v0, s[4:7], s36 offen offset:2048 sc1
buffer_load_dwordx4 v[36:39], v0, s[4:7], s36 offen offset:3072 sc1
v_mov_b32 v47, v46
s_nop 1
v_permlane32_swap_b32 v46, v47
v_max_f32 v46, v46, v47
v_mov_b32 v47, v46
s_nop 1
v_permlane16_swap_b32 v46, v47
v_max_f32 v46, v46, v47
v_sub_f32 v8, v8, v46
v_exp_f32 v8, v8
v_sub_f32 v9, v9, v46
v_exp_f32 v9, v9
v_sub_f32 v10, v10, v46
v_exp_f32 v10, v10
v_sub_f32 v11, v11, v46
v_exp_f32 v11, v11
v_sub_f32 v12, v12, v46
v_exp_f32 v12, v12
v_sub_f32 v13, v13, v46
v_exp_f32 v13, v13
v_sub_f32 v14, v14, v46
v_exp_f32 v14, v14
v_sub_f32 v15, v15, v46
v_exp_f32 v15, v15
v_sub_f32 v44, v44, v46
v_exp_f32 v44, v44
v_sub_f32 v45, v45, v46
v_exp_f32 v45, v45
v_cvt_pk_bf16_f32 v4, v8, v9
v_cvt_pk_bf16_f32 v5, v10, v11
v_cvt_pk_bf16_f32 v6, v12, v13
v_cvt_pk_bf16_f32 v7, v14, v15
v_mov_b32_dpp v8, v4 row_ror:8 row_mask:0xf bank_mask:0xf
v_mov_b32_dpp v9, v5 row_ror:8 row_mask:0xf bank_mask:0xf
v_mov_b32_dpp v10, v6 row_ror:8 row_mask:0xf bank_mask:0xf
v_mov_b32_dpp v11, v7 row_ror:8 row_mask:0xf bank_mask:0xf
v_cvt_pk_bf16_f32 v24, v44, v45
v_cvt_pk_bf16_f32 v25, v44, v45
s_nop 0
v_mov_b32_dpp v26, v24 row_ror:8 row_mask:0xf bank_mask:0xf
v_mov_b32_dpp v27, v24 row_ror:8 row_mask:0xf bank_mask:0xf
v_mov_b64 v[28:29], s[52:53]
v_mov_b64 v[30:31], s[52:53]
s_nop 1
v_mfma_f32_16x16x32_bf16 v[44:47], v[28:31], v[4:7], 0
s_waitcnt vmcnt(1)
v_mfma_f32_16x16x32_bf16 v[12:15], v[32:35], v[4:7], 0
s_waitcnt vmcnt(0)
v_mfma_f32_16x16x32_bf16 v[12:15], v[36:39], v[8:11], v[12:15]
v_mfma_f32_16x16x32_bf16 v[12:15], v[40:43], v[24:27], v[12:15]
v_mov_b64 v[28:29], s[54:55]
s_nop 1
v_mfma_f32_16x16x16_bf16 v[44:47], v[28:29], v[24:25], v[44:47]
s_nop 6
v_rcp_f32 v4, v44
s_nop 1
v_rcp_f32_dpp v4, v44 row_ror:8 row_mask:0xf bank_mask:0xc
s_nop 0
v_mul_f32 v12, v4, v12
v_mul_f32 v13, v4, v13
v_mul_f32 v14, v4, v14
v_mul_f32 v15, v4, v15
v_cvt_pk_bf16_f32 v44, v12, v13
v_cvt_pk_bf16_f32 v45, v14, v15
v_and_b32 v12, 0xffffff7f, v0
v_and_or_b32 v8, v1, 8, v12
ds_write_b64 v8, v[44:45] offset:6144
v_mov_b32_dpp v46, v44 row_ror:8 row_mask:0xf bank_mask:0xf
v_mov_b32_dpp v47, v45 row_ror:8 row_mask:0xf bank_mask:0xf
v_mov_b64 v[24:25], 0
v_mov_b64 v[26:27], 0
v_mov_b64 v[28:29], 0
v_mov_b64 v[30:31], 0
v_mov_b64 v[32:33], 0
v_mov_b64 v[34:35], 0
v_mov_b64 v[36:37], 0
v_mov_b64 v[38:39], 0
s_waitcnt lgkmcnt(0)
s_branch k_okS_146
k_done_147:
buffer_load_dwordx4 v[16:19], v0, s[4:7], s35 offen offset:0 sc1
k_xs_153:
s_waitcnt vmcnt(1)
v_cmp_u_f32 vcc, v4, v12
s_waitcnt vmcnt(0)
v_cmp_u_f32 s[66:67], v16, v16
s_or_b64 vcc, vcc, s[66:67]
s_cbranch_vccz k_xd_154
buffer_load_dwordx4 v[4:7], v0, s[4:7], s33 offen offset:0 sc1
buffer_load_dwordx4 v[8:11], v0, s[4:7], s33 offen offset:1024 sc1
buffer_load_dwordx4 v[12:15], v0, s[4:7], s34 offen offset:0 sc1
buffer_load_dwordx4 v[16:19], v0, s[4:7], s35 offen offset:0 sc1
s_sub_u32 s32, s32, 1
s_cmp_gt_i32 s32, 0
s_cbranch_scc1 k_xs_153
k_xd_154:
s_waitcnt vmcnt(3)
buffer_store_dwordx4 v[4:7], v0, s[8:11], s37 offen offset:0 sc1
s_waitcnt vmcnt(2)
buffer_store_dwordx4 v[12:15], v0, s[8:11], s37 offen offset:2048 sc1
s_waitcnt vmcnt(2)
buffer_store_dwordx4 v[16:19], v0, s[8:11], s59 offen offset:2048 sc1
s_add_u32 s31, s31, 1
s_branch k_jn_136
k_far_135:
s_branch k_cold2_157
k_T0_155:
s_waitcnt vmcnt(2)
v_smfmac_f32_16x16x64_bf16 v[40:43], v[4:7], v[48:55], v1
s_waitcnt vmcnt(1)
v_cmp_u_f32 vcc, v4, v8
v_smfmac_f32_16x16x64_bf16 v[24:27], v[8:11], a[24:31], v1
v_smfmac_f32_16x16x64_bf16 v[28:31], v[8:11], a[32:39], v1
s_cbranch_vccnz k_cold_156
k_okC_158:
s_waitcnt vmcnt(1)
v_smfmac_f32_16x16x64_bf16 v[36:39], v[8:11], a[40:47], v1
s_waitcnt lgkmcnt(0)
ds_read_b128 v[48:51], v2 offset:45056
v_smfmac_f32_16x16x64_bf16 v[32:35], v[4:7], v[64:71], v1
ds_read_b128 v[52:55], v2 offset:46080
ds_read_b128 v[64:67], v0 offset:10240
v_smfmac_f32_16x16x64_bf16 v[44:47], v[4:7], v[56:63], v1
ds_read_b128 v[68:71], v0 offset:11264
v_smfmac_f32_16x16x64_bf16 v[28:31], v[4:7], a[8:15], v1
v_smfmac_f32_16x16x64_bf16 v[24:27], v[4:7], a[0:7], v1
ds_read_b128 v[56:59], v2 offset:22528
v_smfmac_f32_16x16x64_bf16 v[36:39], v[4:7], a[16:23], v1
ds_read_b128 v[60:63], v2 offset:23552
s_waitcnt lgkmcnt(4)
v_smfmac_f32_16x16x64_bf16 v[40:43], v[8:11], v[48:55], v1
s_waitcnt vmcnt(0)
ds_write_b128 v0, v[12:15] offset:0
s_waitcnt lgkmcnt(3)
v_smfmac_f32_16x16x64_bf16 v[32:35], v[8:11], v[64:71], v1
buffer_load_dwordx4 v[16:19], v0, s[4:7], s35 offen offset:0 sc1
v_cmp_u_f32 vcc, v12, v12
s_waitcnt lgkmcnt(1)
v_smfmac_f32_16x16x64_bf16 v[44:47], v[8:11], v[56:63], v1
ds_read_b128 v[56:59], v0 offset:20480
ds_read_b128 v[60:63], v0 offset:21504
ds_read_b128 v[64:67], v0 offset:12288
s_cbranch_vccnz k_coldA_159
k_okA_160:
v_smfmac_f32_16x16x64_bf16 v[36:39], v[12:15], a[64:71], v1
ds_read_b128 v[68:71], v0 offset:13312
s_waitcnt lgkmcnt(4)
v_smfmac_f32_16x16x64_bf16 v[40:43], v[12:15], a[72:79], v1
s_barrier
v_smfmac_f32_16x16x64_bf16 v[28:31], v[12:15], a[56:63], v1
ds_read_b128 v[8:11], v0 offset:1024
buffer_load_dwordx4 v[48:51], v0, s[4:7], s36 offen offset:0 sc1
s_waitcnt lgkmcnt(3)
v_smfmac_f32_16x16x64_bf16 v[44:47], v[12:15], v[56:63], v1
ds_read_b128 v[56:59], v2 offset:40960
v_smfmac_f32_16x16x64_bf16 v[24:27], v[12:15], a[48:55], v1
ds_read_b128 v[60:63], v2 offset:41984
s_waitcnt lgkmcnt(3)
v_smfmac_f32_16x16x64_bf16 v[32:35], v[12:15], v[64:71], v1
buffer_load_dwordx4 v[52:55], v0, s[4:7], s36 offen offset:1024 sc1
s_waitcnt lgkmcnt(2)
v_smfmac_f32_16x16x64_bf16 v[24:27], v[8:11], a[80:87], v1
ds_read_b128 v[64:67], v0 offset:14336
ds_read_b128 v[68:71], v0 offset:15360
v_smfmac_f32_16x16x64_bf16 v[36:39], v[8:11], a[96:103], v1
buffer_store_dwordx4 v[4:7], v0, s[8:11], s37 offen offset:0 sc1
s_waitcnt lgkmcnt(2)
s_nop 0
ds_read_b128 v[4:7], v0 offset:2048
v_smfmac_f32_16x16x64_bf16 v[44:47], v[8:11], v[56:63], v1
ds_read_b128 v[56:59], v2 offset:43008
ds_read_b128 v[60:63], v2 offset:44032
v_smfmac_f32_16x16x64_bf16 v[28:31], v[8:11], a[88:95], v1
buffer_store_dwordx4 v[12:15], v0, s[8:11], s37 offen offset:2048 sc1
v_smfmac_f32_16x16x64_bf16 v[40:43], v[8:11], a[104:111], v1
s_waitcnt lgkmcnt(3)
s_waitcnt lgkmcnt(2)
v_smfmac_f32_16x16x64_bf16 v[32:35], v[8:11], v[64:71], v1
ds_read_b128 v[64:67], v0 offset:16384
ds_read_b128 v[12:15], v0 offset:3072
v_smfmac_f32_16x16x64_bf16 v[36:39], v[4:7], a[128:135], v1
s_waitcnt lgkmcnt(2)
v_smfmac_f32_16x16x64_bf16 v[44:47], v[4:7], v[56:63], v1
ds_read_b128 v[68:71], v0 offset:17408
buffer_load_dwordx4 v[56:59], v0, s[4:7], s36 offen offset:2048 sc1
v_smfmac_f32_16x16x64_bf16 v[28:31], v[4:7], a[120:127], v1
v_smfmac_f32_16x16x64_bf16 v[24:27], v[4:7], a[112:119], v1
s_waitcnt vmcnt(5)
ds_write_b128 v0, v[16:19] offset:4096
v_smfmac_f32_16x16x64_bf16 v[40:43], v[4:7], a[136:143], v1
s_waitcnt lgkmcnt(1)
buffer_load_dwordx4 v[60:63], v0, s[4:7], s36 offen offset:3072 sc1
v_cmp_u_f32 vcc, v16, v16
v_smfmac_f32_16x16x64_bf16 v[32:35], v[4:7], v[64:71], v1
ds_read_b128 v[64:67], v0 offset:18432
ds_read_b128 v[68:71], v0 offset:19456
v_smfmac_f32_16x16x64_bf16 v[28:31], v[12:15], a[152:159], v1
v_smfmac_f32_16x16x64_bf16 v[24:27], v[12:15], a[144:151], v1
s_cbranch_vccnz k_coldB_161
k_okB_162:
v_smfmac_f32_16x16x64_bf16 v[36:39], v[12:15], a[160:167], v1
s_waitcnt lgkmcnt(2)
buffer_store_dwordx4 v[16:19], v0, s[8:11], s59 offen offset:2048 sc1
s_barrier
ds_read_b128 v[4:7], v0 offset:6144
v_smfmac_f32_16x16x64_bf16 v[44:47], v[12:15], a[176:183], v1
ds_read_b128 v[8:11], v0 offset:5120
s_waitcnt lgkmcnt(2)
v_smfmac_f32_16x16x64_bf16 v[32:35], v[12:15], v[64:71], v1
ds_read_b128 v[64:67], v2 offset:24576
ds_read_b128 v[68:71], v2 offset:25600
v_smfmac_f32_16x16x64_bf16 v[24:27], v[16:19], a[184:191], v1
v_smfmac_f32_16x16x64_bf16 v[40:43], v[12:15], a[168:175], v1
s_waitcnt lgkmcnt(3)
ds_read_b128 v[12:15], v0 offset:7168
v_smfmac_f32_16x16x64_bf16 v[24:27], v[4:7], a[208:215], v1
s_waitcnt lgkmcnt(3)
v_smfmac_f32_16x16x64_bf16 v[28:31], v[4:7], a[216:223], v1
v_smfmac_f32_16x16x64_bf16 v[28:31], v[8:11], a[200:207], v1
s_waitcnt lgkmcnt(1)
v_smfmac_f32_16x16x64_bf16 v[24:27], v[8:11], v[64:71], v1
ds_read_b128 v[64:67], v2 offset:49152
s_waitcnt lgkmcnt(1)
v_smfmac_f32_16x16x64_bf16 v[24:27], v[12:15], a[224:231], v1
ds_read_b128 v[68:71], v2 offset:50176
v_smfmac_f32_16x16x64_bf16 v[28:31], v[12:15], a[232:239], v1
v_smfmac_f32_16x16x64_bf16 v[28:31], v[16:19], a[192:199], v1
v_cvt_pk_bf16_f32 v24, v24, v25
v_cvt_pk_bf16_f32 v25, v26, v27
v_smfmac_f32_16x16x64_bf16 v[32:35], v[4:7], v[80:87], v1
v_cvt_pk_bf16_f32 v26, v28, v29
v_cvt_pk_bf16_f32 v27, v30, v31
v_smfmac_f32_16x16x64_bf16 v[32:35], v[8:11], a[248:255], v1
s_waitcnt lgkmcnt(0)
v_mfma_f32_16x16x32_bf16 v[28:31], v[24:27], v[20:23], 0
v_and_b32 v26, 0xffffff7f, v0
v_smfmac_f32_16x16x64_bf16 v[32:35], v[16:19], v[64:71], v1
v_and_or_b32 v26, v1, 8, v26
v_mul_f32 v28, s51, v28
v_mul_f32 v29, s51, v29
v_mul_f32 v31, s51, v31
v_cvt_pk_bf16_f32 v24, v28, v29
v_mul_f32 v30, s51, v30
v_cvt_pk_bf16_f32 v25, v30, v31
v_smfmac_f32_16x16x64_bf16 v[32:35], v[12:15], v[96:103], v1
ds_write_b64 v26, v[24:25] offset:0
v_smfmac_f32_16x16x64_bf16 v[36:39], v[8:11], v[72:79], v1
v_cvt_pk_bf16_f32 v32, v32, v33
v_smfmac_f32_16x16x64_bf16 v[36:39], v[16:19], a[240:247], v1
buffer_load_dwordx4 v[64:67], v0, s[4:7], s61 offen offset:0
v_cvt_pk_bf16_f32 v33, v34, v35
v_smfmac_f32_16x16x64_bf16 v[36:39], v[12:15], v[104:111], v1
s_waitcnt lgkmcnt(0)
v_smfmac_f32_16x16x64_bf16 v[36:39], v[4:7], v[88:95], v1
s_barrier
ds_read_b128 v[24:27], v0 offset:0
v_smfmac_f32_16x16x64_bf16 v[40:43], v[4:7], v[144:151], v1
ds_read_b128 v[28:31], v0 offset:1024
s_nop 0
v_cvt_pk_bf16_f32 v34, v36, v37
v_cvt_pk_bf16_f32 v35, v38, v39
s_nop 1
v_mfma_f32_16x16x32_bf16 v[36:39], v[32:35], v[20:23], 0
s_waitcnt vmcnt(6)
buffer_load_dwordx4 v[68:71], v0, s[4:7], s61 offen offset:1024
v_and_b32 v34, 0xffffff7f, v0
v_and_or_b32 v34, v1, 8, v34
s_waitcnt lgkmcnt(1)
v_mfma_f32_16x16x32_bf16 v[48:51], v[48:51], v[24:27], 0
v_cvt_pk_bf16_f32 v32, v36, v37
s_waitcnt lgkmcnt(0)
v_mfma_f32_16x16x32_bf16 v[48:51], v[52:55], v[28:31], v[48:51]
v_mov_b64 v[52:53], s[56:57]
v_cvt_pk_bf16_f32 v33, v38, v39
v_smfmac_f32_16x16x64_bf16 v[44:47], v[4:7], v[152:159], v1
ds_write_b64 v34, v[32:33] offset:2048
v_permlane32_swap_b32 v48, v50
v_permlane32_swap_b32 v49, v51
v_add_f32_dpp v52, v50, v48 row_ror:8 row_mask:0xf bank_mask:0x3
v_exp_f32 v52, v52
v_add_f32_dpp v53, v51, v49 row_ror:8 row_mask:0xf bank_mask:0x3
v_exp_f32 v53, v53
s_nop 0
v_cvt_pk_bf16_f32 v48, v52, v53
v_smfmac_f32_16x16x64_bf16 v[44:47], v[16:19], v[120:127], v1
ds_write_b32 v0, v48 offset:4096
v_smfmac_f32_16x16x64_bf16 v[44:47], v[12:15], v[168:175], v1
buffer_load_dwordx4 v[48:51], v0, s[4:7], s61 offen offset:2048
v_smfmac_f32_16x16x64_bf16 v[40:43], v[12:15], v[160:167], v1
s_waitcnt lgkmcnt(1)
v_xor_b32 v12, 0x80, v0
v_smfmac_f32_16x16x64_bf16 v[40:43], v[8:11], v[128:135], v1
s_waitcnt lgkmcnt(0)
s_barrier
ds_read_b128 v[32:35], v0 offset:2048
v_mov_b64 v[22:23], s[52:53]
v_smfmac_f32_16x16x64_bf16 v[40:43], v[16:19], v[112:119], v1
ds_read_b128 v[36:39], v0 offset:3072
ds_read_b128 v[16:19], v0 offset:4096
buffer_load_dwordx4 v[52:55], v0, s[4:7], s61 offen offset:3072
v_smfmac_f32_16x16x64_bf16 v[44:47], v[8:11], v[136:143], v1
ds_read_b128 v[12:15], v12 offset:4096
v_cvt_pk_bf16_f32 v40, v40, v41
v_mov_b64 v[20:21], s[52:53]
s_waitcnt lgkmcnt(3)
v_mfma_f32_16x16x32_bf16 v[24:27], v[32:35], v[24:27], 0
v_cvt_pk_bf16_f32 v41, v42, v43
s_waitcnt lgkmcnt(2)
v_mfma_f32_16x16x32_bf16 v[24:27], v[36:39], v[28:31], v[24:27]
s_waitcnt vmcnt(5)
s_waitcnt lgkmcnt(1)
v_mfma_f32_16x16x32_bf16 v[8:11], v[56:59], v[16:19], 0
buffer_load_dwordx4 v[56:59], v0, s[4:7], s62 offen offset:0
v_mov_b64 v[28:29], s[56:57]
v_cvt_pk_bf16_f32 v43, v46, v47
v_cvt_pk_bf16_f32 v42, v44, v45
v_permlane32_swap_b32 v25, v27
v_permlane32_swap_b32 v24, v26
v_mfma_f32_16x16x32_bf16 v[4:7], v[20:23], v[16:19], 0
s_waitcnt lgkmcnt(0)
v_add_f32_dpp v28, v26, v24 row_ror:8 row_mask:0xf bank_mask:0x3
v_add_f32_dpp v29, v27, v25 row_ror:8 row_mask:0xf bank_mask:0x3
v_exp_f32 v28, v28
v_mfma_f32_16x16x32_bf16 v[8:11], v[60:63], v[12:15], v[8:11]
buffer_load_dwordx4 v[60:63], v0, s[4:7], s62 offen offset:1024
v_exp_f32 v29, v29
v_permlane32_swap_b32 v42, v43
v_cvt_pk_bf16_f32 v24, v28, v29
v_mov_b64 v[44:45], s[54:55]
v_cvt_pk_bf16_f32 v25, v28, v29
v_mov_b32_dpp v26, v24 row_ror:8 row_mask:0xf bank_mask:0xf
v_mov_b32_dpp v27, v24 row_ror:8 row_mask:0xf bank_mask:0xf
v_mfma_f32_16x16x16_bf16 v[4:7], v[44:45], v[24:25], v[4:7]
v_permlane32_swap_b32 v40, v41
v_mov_b64 v[36:37], 0
v_mov_b64 v[38:39], 0
v_mov_b64 v[30:31], 0
v_mfma_f32_16x16x32_bf16 v[8:11], v[40:43], v[24:27], v[8:11]
buffer_load_dwordx4 v[16:19], v0, s[4:7], s62 offen offset:2048
v_rcp_f32 v6, v4
v_and_b32 v12, 0xffffff7f, v0
v_and_or_b32 v13, v1, 8, v12
v_rcp_f32_dpp v6, v4 row_ror:8 row_mask:0xf bank_mask:0xc
v_mov_b64 v[26:27], 0
v_pk_mul_f32 v[8:9], v[8:9], v[6:7] op_sel_hi:[1,0]
v_cvt_pk_bf16_f32 v44, v8, v9
v_pk_mul_f32 v[10:11], v[10:11], v[6:7] op_sel_hi:[1,0]
v_cvt_pk_bf16_f32 v45, v10, v11
s_waitcnt vmcnt(5)
ds_write_b64 v13, v[44:45] offset:6144
buffer_load_dwordx4 v[20:23], v0, s[4:7], s62 offen offset:3072
v_add_u32 v6, 0xd4800000, v6
v_cmp_lt_u32 vcc, 0x28000000, v6
v_mov_b64 v[34:35], 0
v_mov_b32_dpp v46, v44 row_ror:8 row_mask:0xf bank_mask:0xf
v_mov_b32_dpp v47, v45 row_ror:8 row_mask:0xf bank_mask:0xf
v_mov_b64 v[28:29], 0
v_mov_b64 v[32:33], 0
s_cbranch_vccnz k_slow_163
k_okS_164:
v_smfmac_f32_16x16x64_bf16 v[36:39], v[44:47], v[224:231], v1
s_waitcnt lgkmcnt(0)
s_barrier
ds_read_b128 v[8:11], v12 offset:7168
v_smfmac_f32_16x16x64_bf16 v[32:35], v[44:47], v[200:207], v1
s_waitcnt vmcnt(4)
ds_read_b128 v[4:7], v12 offset:6272
v_mov_b64 v[24:25], 0
v_smfmac_f32_16x16x64_bf16 v[28:31], v[44:47], v[48:55], v1
ds_read_b128 v[12:15], v12 offset:7296
ds_read_b128 v[48:51], v2 offset:16384
v_smfmac_f32_16x16x64_bf16 v[24:27], v[44:47], v[64:71], v1
ds_read_b128 v[52:55], v2 offset:17408
v_mov_b64 v[42:43], 0
s_waitcnt lgkmcnt(4)
v_smfmac_f32_16x16x64_bf16 v[24:27], v[8:11], v[184:191], v1
s_waitcnt lgkmcnt(3)
v_mov_b64 v[40:41], 0
v_smfmac_f32_16x16x64_bf16 v[24:27], v[4:7], v[176:183], v1
s_waitcnt lgkmcnt(2)
ds_read_b128 v[64:67], v2 offset:51200
v_smfmac_f32_16x16x64_bf16 v[24:27], v[12:15], v[192:199], v1
ds_read_b128 v[68:71], v2 offset:52224
v_smfmac_f32_16x16x64_bf16 v[40:43], v[44:47], v[240:247], v1
s_waitcnt vmcnt(2)
s_waitcnt lgkmcnt(2)
v_lshrrev_b32 v44, 16, v1
v_cvt_pk_bf16_f32 v24, v24, v25
v_bfi_b32 v24, 1, s45, v24
v_cvt_pk_bf16_f32 v25, v26, v27
v_smfmac_f32_16x16x64_bf16 v[28:31], v[8:11], v[48:55], v1
buffer_store_dwordx2 v[24:25], v44, s[4:7], s38 offen sc1
ds_read_b128 v[48:51], v2 offset:20480
ds_read_b128 v[52:55], v2 offset:21504
v_smfmac_f32_16x16x64_bf16 v[28:31], v[12:15], v[56:63], v1
s_waitcnt lgkmcnt(2)
ds_read_b128 v[56:59], v2 offset:26624
v_smfmac_f32_16x16x64_bf16 v[28:31], v[4:7], v[64:71], v1
ds_read_b128 v[60:63], v2 offset:27648
v_smfmac_f32_16x16x64_bf16 v[32:35], v[8:11], v[208:215], v1
ds_read_b128 v[64:67], v2 offset:18432
s_nop 0
v_cvt_pk_bf16_f32 v28, v28, v29
v_bfi_b32 v28, 1, s45, v28
v_cvt_pk_bf16_f32 v29, v30, v31
v_smfmac_f32_16x16x64_bf16 v[32:35], v[12:15], v[216:223], v1
buffer_store_dwordx2 v[28:29], v44, s[4:7], s39 offen sc1
v_smfmac_f32_16x16x64_bf16 v[40:43], v[12:15], v[248:255], v1
ds_read_b128 v[68:71], v2 offset:19456
s_waitcnt vmcnt(2)
v_smfmac_f32_16x16x64_bf16 v[32:35], v[4:7], v[16:23], v1
s_waitcnt lgkmcnt(2)
v_smfmac_f32_16x16x64_bf16 v[36:39], v[12:15], v[232:239], v1
ds_read_b128 v[16:19], v2 offset:47104
ds_read_b128 v[20:23], v2 offset:48128
v_cvt_pk_bf16_f32 v32, v32, v33
v_bfi_b32 v32, 1, s45, v32
v_cvt_pk_bf16_f32 v33, v34, v35
v_smfmac_f32_16x16x64_bf16 v[36:39], v[8:11], v[48:55], v1
buffer_store_dwordx2 v[32:33], v44, s[4:7], s40 offen sc1
s_waitcnt lgkmcnt(2)
v_smfmac_f32_16x16x64_bf16 v[36:39], v[4:7], v[64:71], v1
s_nop 6
v_cvt_pk_bf16_f32 v36, v36, v37
v_cvt_pk_bf16_f32 v37, v38, v39
s_waitcnt lgkmcnt(0)
v_bfi_b32 v36, 1, s45, v36
v_smfmac_f32_16x16x64_bf16 v[40:43], v[8:11], v[16:23], v1
buffer_store_dwordx2 v[36:37], v44, s[4:7], s41 offen sc1
v_smfmac_f32_16x16x64_bf16 v[40:43], v[4:7], v[56:63], v1
s_nop 6
v_cvt_pk_bf16_f32 v40, v40, v41
v_bfi_b32 v40, 1, s45, v40
v_cvt_pk_bf16_f32 v41, v42, v43
buffer_store_dwordx2 v[40:41], v44, s[4:7], s42 offen sc1
s_barrier
buffer_load_dwordx4 v[24:27], v0, s[4:7], s43 offen offset:0 sc1
buffer_load_dwordx4 v[28:31], v0, s[4:7], s43 offen offset:1024 sc1
buffer_load_dwordx4 v[32:35], v0, s[4:7], s43 offen offset:2048 sc1
buffer_load_dwordx4 v[36:39], v0, s[4:7], s43 offen offset:3072 sc1
v_lshlrev_b32 v23, v0, s58
v_cndmask_b32 v16, 0, v23, s[12:13]
v_cndmask_b32 v17, 0, v23, s[14:15]
v_cndmask_b32 v18, 0, v23, s[16:17]
v_cndmask_b32 v19, 0, v23, s[18:19]
v_and_b32 v45, 0x30, v0
v_lshrrev_b32 v46, 8, v0
v_lshl_or_b32 v45, v46, 2, v45
v_bfe_u32 v46, v0, 6, 1
v_lshl_or_b32 v45, v46, 7, v45
v_cndmask_b32 v45, v45, 2.0, s[98:99]
v_cndmask_b32 v20, 0, v23, s[90:91]
v_cndmask_b32 v21, 0, v23, s[92:93]
v_cndmask_b32 v22, 0, v23, s[94:95]
v_cndmask_b32 v23, 0, v23, s[96:97]
s_add_u32 s33, s33, 16384
s_bitset0_b32 s33, 16
s_waitcnt vmcnt(3)
v_mfma_f32_16x16x32_bf16 v[40:43], v[24:27], v[16:19], 0
s_waitcnt vmcnt(2)
v_mfma_f32_16x16x32_bf16 v[40:43], v[28:31], v[16:19], v[40:43]
v_bitop3_b32 v46, v24, v28, s45 bitop3:0x7e
s_waitcnt vmcnt(1)
v_mfma_f32_16x16x32_bf16 v[40:43], v[32:35], v[16:19], v[40:43]
s_waitcnt vmcnt(0)
v_mfma_f32_16x16x32_bf16 v[40:43], v[36:39], v[16:19], v[40:43]
v_bitop3_b32 v47, v32, v36, s45 bitop3:0x7e
v_bitop3_b32 v46, v46, v47, 1 bitop3:0xa8
v_cmp_ne_u32 vcc, 0, v46
v_mov_b64 v[24:25], 0
v_mov_b64 v[26:27], 0
v_mov_b64 v[28:29], 0
v_mov_b64 v[30:31], 0
v_permlane32_swap_b32 v40, v41
v_permlane32_swap_b32 v42, v43
v_add_f32 v40, v40, v41
v_add_f32 v41, v42, v43
v_cvt_pk_bf16_f32 v42, v40, v41
s_cbranch_vccnz k_r1_166
k_ok1_167:
buffer_store_dword v42, v45, s[4:7], s44 offen sc1
buffer_load_dwordx4 v[48:51], v0, s[4:7], s60 offen offset:0
buffer_load_dwordx4 v[52:55], v0, s[4:7], s60 offen offset:1024
buffer_load_dwordx4 v[56:59], v0, s[4:7], s60 offen offset:2048
buffer_load_dwordx4 v[60:63], v0, s[4:7], s60 offen offset:3072
s_barrier
buffer_load_dwordx4 v[4:7], v0, s[4:7], s33 offen offset:0 sc1
buffer_load_dwordx4 v[8:11], v0, s[4:7], s33 offen offset:1024 sc1
s_add_u32 s34, s33, 2048
s_add_u32 s35, s33, 6144
s_add_u32 s36, s36, 524288
s_add_u32 s37, s37, 10240
s_add_u32 s59, s59, 10240
v_mov_b64 v[32:33], 0
v_mov_b64 v[34:35], 0
v_mov_b64 v[36:37], 0
v_mov_b64 v[38:39], 0
v_mov_b64 v[40:41], 0
v_mov_b64 v[42:43], 0
v_mov_b64 v[44:45], 0
v_mov_b64 v[46:47], 0
s_add_u32 s44, s44, 16384
s_bitset0_b32 s44, 16
s_sub_u32 s45, s45, 1
s_add_u32 s31, s31, 1
ds_read_b128 v[64:67], v0 offset:8192
ds_read_b128 v[68:71], v0 offset:9216
buffer_load_dwordx4 v[12:15], v0, s[4:7], s34 offen offset:0 sc1
s_cmp_lg_u32 s31, s47
s_cbranch_scc1 k_T0_155
s_branch k_done_165
k_cold2_157:
s_barrier
buffer_load_dwordx4 v[48:51], v0, s[4:7], s60 offen offset:0
buffer_load_dwordx4 v[52:55], v0, s[4:7], s60 offen offset:1024
buffer_load_dwordx4 v[56:59], v0, s[4:7], s60 offen offset:2048
buffer_load_dwordx4 v[60:63], v0, s[4:7], s60 offen offset:3072
ds_read_b128 v[64:67], v0 offset:8192
ds_read_b128 v[68:71], v0 offset:9216
k_cold_156:
buffer_load_dwordx4 v[4:7], v0, s[4:7], s33 offen offset:0 sc1
buffer_load_dwordx4 v[8:11], v0, s[4:7], s33 offen offset:1024 sc1
buffer_load_dwordx4 v[12:15], v0, s[4:7], s34 offen offset:0 sc1
s_sub_u32 s32, s32, 1
s_cmp_gt_i32 s32, 0
s_cbranch_scc0 k_okC_158
v_mov_b64 v[24:25], 0
v_mov_b64 v[26:27], 0
v_mov_b64 v[28:29], 0
v_mov_b64 v[30:31], 0
v_mov_b64 v[32:33], 0
v_mov_b64 v[34:35], 0
v_mov_b64 v[36:37], 0
v_mov_b64 v[38:39], 0
v_mov_b64 v[40:41], 0
v_mov_b64 v[42:43], 0
v_mov_b64 v[44:45], 0
v_mov_b64 v[46:47], 0
s_branch k_T0_155
k_coldA_159:
buffer_load_dwordx4 v[12:15], v0, s[4:7], s34 offen offset:0 sc1
s_sub_u32 s32, s32, 1
s_cmp_gt_i32 s32, 0
s_waitcnt vmcnt(0)
v_cmp_u_f32 vcc, v12, v12
ds_write_b128 v0, v[12:15] offset:0
s_waitcnt lgkmcnt(0)
s_cbranch_vccz k_okA_160
s_cbranch_scc1 k_coldA_159
s_branch k_okA_160
k_coldB_161:
buffer_load_dwordx4 v[16:19], v0, s[4:7], s35 offen offset:0 sc1
s_sub_u32 s32, s32, 1
s_cmp_gt_i32 s32, 0
s_waitcnt vmcnt(0)
v_cmp_u_f32 vcc, v16, v16
ds_write_b128 v0, v[16:19] offset:4096
s_waitcnt lgkmcnt(0)
s_cbranch_vccz k_okB_162
s_cbranch_scc1 k_coldB_161
s_branch k_okB_162
k_r1_166:
buffer_load_dwordx4 v[24:27], v0, s[4:7], s43 offen offset:0 sc1
buffer_load_dwordx4 v[28:31], v0, s[4:7], s43 offen offset:1024 sc1
buffer_load_dwordx4 v[32:35], v0, s[4:7], s43 offen offset:2048 sc1
buffer_load_dwordx4 v[36:39], v0, s[4:7], s43 offen offset:3072 sc1
s_sub_u32 s32, s32, 1
s_cmp_gt_i32 s32, 0
s_waitcnt vmcnt(3)
v_mfma_f32_16x16x32_bf16 v[40:43], v[24:27], v[16:19], 0
s_waitcnt vmcnt(2)
v_mfma_f32_16x16x32_bf16 v[40:43], v[28:31], v[16:19], v[40:43]
v_bitop3_b32 v46, v24, v28, s45 bitop3:0x7e
s_waitcnt vmcnt(1)
v_mfma_f32_16x16x32_bf16 v[40:43], v[32:35], v[16:19], v[40:43]
s_waitcnt vmcnt(0)
v_mfma_f32_16x16x32_bf16 v[40:43], v[36:39], v[16:19], v[40:43]
v_bitop3_b32 v47, v32, v36, s45 bitop3:0x7e
v_bitop3_b32 v46, v46, v47, 1 bitop3:0xa8
v_cmp_ne_u32 vcc, 0, v46
v_mov_b64 v[24:25], 0
v_mov_b64 v[26:27], 0
v_mov_b64 v[28:29], 0
v_mov_b64 v[30:31], 0
v_permlane32_swap_b32 v40, v41
v_permlane32_swap_b32 v42, v43
v_add_f32 v40, v40, v41
v_add_f32 v41, v42, v43
v_cvt_pk_bf16_f32 v42, v40, v41
s_cbranch_vccz k_ok1_167
s_cbranch_scc1 k_r1_166
s_branch k_ok1_167
k_slow_163:
ds_read_b128 v[24:27], v0 offset:0
ds_read_b128 v[28:31], v0 offset:1024
v_mov_b32 v46, 0xff7fffff
s_add_u32 s48, s36, 0x0
buffer_load_dwordx4 v[32:35], v0, s[4:7], s48 offen offset:0 sc1
buffer_load_dwordx4 v[36:39], v0, s[4:7], s48 offen offset:1024 sc1
s_waitcnt vmcnt(1) lgkmcnt(1)
v_mfma_f32_16x16x32_bf16 v[4:7], v[32:35], v[24:27], 0
s_waitcnt vmcnt(0) lgkmcnt(0)
v_mfma_f32_16x16x32_bf16 v[4:7], v[36:39], v[28:31], v[4:7]
v_mov_b64 v[8:9], s[56:57]
s_nop 5
v_permlane32_swap_b32 v4, v6
v_permlane32_swap_b32 v5, v7
v_add_f32_dpp v8, v6, v4 row_ror:8 row_mask:0xf bank_mask:0x3
s_nop 0
v_add_f32_dpp v9, v7, v5 row_ror:8 row_mask:0xf bank_mask:0x3
v_max3_f32 v46, v46, v8, v9
s_add_u32 s48, s36, 0x1000
buffer_load_dwordx4 v[32:35], v0, s[4:7], s48 offen offset:0 sc1
buffer_load_dwordx4 v[36:39], v0, s[4:7], s48 offen offset:1024 sc1
s_waitcnt vmcnt(1)
v_mfma_f32_16x16x32_bf16 v[4:7], v[32:35], v[24:27], 0
s_waitcnt vmcnt(0)
v_mfma_f32_16x16x32_bf16 v[4:7], v[36:39], v[28:31], v[4:7]
v_mov_b64 v[10:11], s[56:57]
s_nop 5
v_permlane32_swap_b32 v4, v6
v_permlane32_swap_b32 v5, v7
v_add_f32_dpp v10, v6, v4 row_ror:8 row_mask:0xf bank_mask:0x3
s_nop 0
v_add_f32_dpp v11, v7, v5 row_ror:8 row_mask:0xf bank_mask:0x3
v_max3_f32 v46, v46, v10, v11
s_add_u32 s48, s36, 0x2000
buffer_load_dwordx4 v[32:35], v0, s[4:7], s48 offen offset:0 sc1
buffer_load_dwordx4 v[36:39], v0, s[4:7], s48 offen offset:1024 sc1
s_waitcnt vmcnt(1)
v_mfma_f32_16x16x32_bf16 v[4:7], v[32:35], v[24:27], 0
s_waitcnt vmcnt(0)
v_mfma_f32_16x16x32_bf16 v[4:7], v[36:39], v[28:31], v[4:7]
v_mov_b64 v[12:13], s[56:57]
s_nop 5
v_permlane32_swap_b32 v4, v6
v_permlane32_swap_b32 v5, v7
v_add_f32_dpp v12, v6, v4 row_ror:8 row_mask:0xf bank_mask:0x3
s_nop 0
v_add_f32_dpp v13, v7, v5 row_ror:8 row_mask:0xf bank_mask:0x3
v_max3_f32 v46, v46, v12, v13
s_add_u32 s48, s36, 0x3000
buffer_load_dwordx4 v[32:35], v0, s[4:7], s48 offen offset:0 sc1
buffer_load_dwordx4 v[36:39], v0, s[4:7], s48 offen offset:1024 sc1
s_waitcnt vmcnt(1)
v_mfma_f32_16x16x32_bf16 v[4:7], v[32:35], v[24:27], 0
s_waitcnt vmcnt(0)
v_mfma_f32_16x16x32_bf16 v[4:7], v[36:39], v[28:31], v[4:7]
v_mov_b64 v[14:15], s[56:57]
s_nop 5
v_permlane32_swap_b32 v4, v6
v_permlane32_swap_b32 v5, v7
v_add_f32_dpp v14, v6, v4 row_ror:8 row_mask:0xf bank_mask:0x3
s_nop 0
v_add_f32_dpp v15, v7, v5 row_ror:8 row_mask:0xf bank_mask:0x3
v_max3_f32 v46, v46, v14, v15
ds_read_b128 v[32:35], v0 offset:2048
ds_read_b128 v[36:39], v0 offset:3072
s_waitcnt lgkmcnt(1)
v_mfma_f32_16x16x32_bf16 v[4:7], v[32:35], v[24:27], 0
s_waitcnt lgkmcnt(0)
v_mfma_f32_16x16x32_bf16 v[4:7], v[36:39], v[28:31], v[4:7]
v_mov_b64 v[44:45], s[56:57]
s_nop 5
v_permlane32_swap_b32 v4, v6
v_permlane32_swap_b32 v5, v7
v_add_f32_dpp v44, v6, v4 row_ror:8 row_mask:0xf bank_mask:0x3
s_nop 0
v_add_f32_dpp v45, v7, v5 row_ror:8 row_mask:0xf bank_mask:0x3
v_max3_f32 v46, v46, v44, v45
buffer_load_dwordx4 v[32:35], v0, s[4:7], s36 offen offset:2048 sc1
buffer_load_dwordx4 v[36:39], v0, s[4:7], s36 offen offset:3072 sc1
v_mov_b32 v47, v46
s_nop 1
v_permlane32_swap_b32 v46, v47
v_max_f32 v46, v46, v47
v_mov_b32 v47, v46
s_nop 1
v_permlane16_swap_b32 v46, v47
v_max_f32 v46, v46, v47
v_sub_f32 v8, v8, v46
v_exp_f32 v8, v8
v_sub_f32 v9, v9, v46
v_exp_f32 v9, v9
v_sub_f32 v10, v10, v46
v_exp_f32 v10, v10
v_sub_f32 v11, v11, v46
v_exp_f32 v11, v11
v_sub_f32 v12, v12, v46
v_exp_f32 v12, v12
v_sub_f32 v13, v13, v46
v_exp_f32 v13, v13
v_sub_f32 v14, v14, v46
v_exp_f32 v14, v14
v_sub_f32 v15, v15, v46
v_exp_f32 v15, v15
v_sub_f32 v44, v44, v46
v_exp_f32 v44, v44
v_sub_f32 v45, v45, v46
v_exp_f32 v45, v45
v_cvt_pk_bf16_f32 v4, v8, v9
v_cvt_pk_bf16_f32 v5, v10, v11
v_cvt_pk_bf16_f32 v6, v12, v13
v_cvt_pk_bf16_f32 v7, v14, v15
v_mov_b32_dpp v8, v4 row_ror:8 row_mask:0xf bank_mask:0xf
v_mov_b32_dpp v9, v5 row_ror:8 row_mask:0xf bank_mask:0xf
v_mov_b32_dpp v10, v6 row_ror:8 row_mask:0xf bank_mask:0xf
v_mov_b32_dpp v11, v7 row_ror:8 row_mask:0xf bank_mask:0xf
v_cvt_pk_bf16_f32 v24, v44, v45
v_cvt_pk_bf16_f32 v25, v44, v45
s_nop 0
v_mov_b32_dpp v26, v24 row_ror:8 row_mask:0xf bank_mask:0xf
v_mov_b32_dpp v27, v24 row_ror:8 row_mask:0xf bank_mask:0xf
v_mov_b64 v[28:29], s[52:53]
v_mov_b64 v[30:31], s[52:53]
s_nop 1
v_mfma_f32_16x16x32_bf16 v[44:47], v[28:31], v[4:7], 0
s_waitcnt vmcnt(1)
v_mfma_f32_16x16x32_bf16 v[12:15], v[32:35], v[4:7], 0
s_waitcnt vmcnt(0)
v_mfma_f32_16x16x32_bf16 v[12:15], v[36:39], v[8:11], v[12:15]
v_mfma_f32_16x16x32_bf16 v[12:15], v[40:43], v[24:27], v[12:15]
v_mov_b64 v[28:29], s[54:55]
s_nop 1
v_mfma_f32_16x16x16_bf16 v[44:47], v[28:29], v[24:25], v[44:47]
s_nop 6
v_rcp_f32 v4, v44
s_nop 1
v_rcp_f32_dpp v4, v44 row_ror:8 row_mask:0xf bank_mask:0xc
s_nop 0
v_mul_f32 v12, v4, v12
v_mul_f32 v13, v4, v13
v_mul_f32 v14, v4, v14
v_mul_f32 v15, v4, v15
v_cvt_pk_bf16_f32 v44, v12, v13
v_cvt_pk_bf16_f32 v45, v14, v15
v_and_b32 v12, 0xffffff7f, v0
v_and_or_b32 v8, v1, 8, v12
ds_write_b64 v8, v[44:45] offset:6144
v_mov_b32_dpp v46, v44 row_ror:8 row_mask:0xf bank_mask:0xf
v_mov_b32_dpp v47, v45 row_ror:8 row_mask:0xf bank_mask:0xf
v_mov_b64 v[24:25], 0
v_mov_b64 v[26:27], 0
v_mov_b64 v[28:29], 0
v_mov_b64 v[30:31], 0
v_mov_b64 v[32:33], 0
v_mov_b64 v[34:35], 0
v_mov_b64 v[36:37], 0
v_mov_b64 v[38:39], 0
s_waitcnt lgkmcnt(0)
s_branch k_okS_164
k_done_165:
buffer_load_dwordx4 v[16:19], v0, s[4:7], s35 offen offset:0 sc1
k_xs_171:
s_waitcnt vmcnt(1)
v_cmp_u_f32 vcc, v4, v12
s_waitcnt vmcnt(0)
v_cmp_u_f32 s[66:67], v16, v16
s_or_b64 vcc, vcc, s[66:67]
s_cbranch_vccz k_xd_172
buffer_load_dwordx4 v[4:7], v0, s[4:7], s33 offen offset:0 sc1
buffer_load_dwordx4 v[8:11], v0, s[4:7], s33 offen offset:1024 sc1
buffer_load_dwordx4 v[12:15], v0, s[4:7], s34 offen offset:0 sc1
buffer_load_dwordx4 v[16:19], v0, s[4:7], s35 offen offset:0 sc1
s_sub_u32 s32, s32, 1
s_cmp_gt_i32 s32, 0
s_cbranch_scc1 k_xs_171
k_xd_172:
s_waitcnt vmcnt(3)
buffer_store_dwordx4 v[4:7], v0, s[8:11], s37 offen offset:0 sc1
s_waitcnt vmcnt(2)
buffer_store_dwordx4 v[12:15], v0, s[8:11], s37 offen offset:2048 sc1
s_waitcnt vmcnt(2)
buffer_store_dwordx4 v[16:19], v0, s[8:11], s59 offen offset:2048 sc1
s_add_u32 s31, s31, 1
k_jn_136:
s_cmp_lt_u32 s31, 128
s_cbranch_scc1 k_lay_129
s_add_u32 s30, s30, 112
s_waitcnt vmcnt(0) lgkmcnt(0)
s_barrier
s_branch k_fin_7
k_w1_126:
v_lshrrev_b32 v12, 3, v0
v_lshlrev_b32 v10, 13, v12
v_bfe_u32 v12, v0, 1, 2
v_lshrrev_b32 v13, 4, v0
v_xor_b32 v12, v12, v13
v_lshl_add_u32 v10, v12, 5, v10
v_and_b32 v14, 1, v0
v_lshl_add_u32 v10, v14, 4, v10
v_mul_u32_u24 v11, 1280, v13
v_bfe_u32 v12, v0, 1, 3
v_and_b32 v13, 1, v13
v_lshlrev_b32 v13, 1, v13
v_xor_b32 v12, v12, v13
v_xor_b32 v12, 0, v12
v_lshl_add_u32 v11, v12, 5, v11
v_lshl_add_u32 v11, v14, 4, v11
v_bfe_u32 v12, v0, 5, 1
v_lshlrev_b32 v12, 4, v12
v_bfe_u32 v13, v0, 4, 1
v_lshl_add_u32 v12, v13, 1, v12
v_bfe_u32 v13, v0, 2, 1
v_lshl_add_u32 v12, v13, 2, v12
v_bfe_u32 v13, v0, 3, 1
v_mul_u32_u24 v15, 4224, v13
v_add_u32 v12, v13, v12
v_bfe_u32 v13, v12, 1, 2
v_xor_b32 v13, 1, v13
v_lshlrev_b32 v13, 5, v13
v_lshl_add_u32 v4, v12, 7, v13
v_and_b32 v14, 3, v0
v_lshl_add_u32 v4, v14, 3, v4
v_add_u32 v5, 0x10000, v4
v_add_u32 v6, 0x20000, v4
v_bfe_u32 v12, v0, 4, 1
v_lshlrev_b32 v13, 4, v12
v_lshlrev_b32 v12, 2, v12
v_bfe_u32 v8, v0, 5, 1
v_lshl_add_u32 v13, v8, 2, v13
v_bfe_u32 v8, v0, 2, 1
v_add_u32 v13, v8, v13
v_lshl_add_u32 v12, v8, 1, v12
v_bfe_u32 v8, v0, 3, 1
v_add_u32 v8, 2, v8
v_xor_b32 v12, v12, v8
v_lshlrev_b32 v12, 5, v12
v_lshl_add_u32 v7, v13, 8, v12
v_lshl_add_u32 v7, v14, 3, v7
v_add_u32 v8, 0x10000, v7
v_add_u32 v9, 0x20000, v7
v_lshlrev_b32 v0, 4, v0
v_add_u32 v2, 98304, v0
s_lshl_b32 s49, s30, 8
s_mul_i32 s50, s30, 163840
s_mul_i32 s60, s30, 131072
s_add_u32 s60, s60, 120619008
s_add_u32 s61, s60, 4096
s_add_u32 s62, s60, 8192
s_mov_b32 m0, 2048
s_add_u32 s48, s49, 131072
buffer_load_dwordx4 v10, s[8:11], s48 offen lds
s_mov_b32 m0, 3072
s_add_u32 s48, s49, 196608
buffer_load_dwordx4 v10, s[8:11], s48 offen lds
s_mov_b32 m0, 10240
s_add_u32 s48, s49, 131200
buffer_load_dwordx4 v10, s[8:11], s48 offen lds
s_mov_b32 m0, 11264
s_add_u32 s48, s49, 196736
buffer_load_dwordx4 v10, s[8:11], s48 offen lds
s_mov_b32 m0, 18432
s_add_u32 s48, s49, 131200
buffer_load_dwordx4 v10, s[12:15], s48 offen lds
s_mov_b32 m0, 19456
s_add_u32 s48, s49, 196736
buffer_load_dwordx4 v10, s[12:15], s48 offen lds
s_mov_b32 m0, 26624
s_add_u32 s48, s49, 131072
buffer_load_dwordx4 v10, s[16:19], s48 offen lds
s_mov_b32 m0, 27648
s_add_u32 s48, s49, 196608
buffer_load_dwordx4 v10, s[16:19], s48 offen lds
s_mov_b32 m0, 34816
s_add_u32 s48, s49, 131200
buffer_load_dwordx4 v10, s[16:19], s48 offen lds
s_mov_b32 m0, 35840
s_add_u32 s48, s49, 196736
buffer_load_dwordx4 v10, s[16:19], s48 offen lds
s_mov_b32 m0, 43008
s_add_u32 s48, s49, 655360
buffer_load_dwordx4 v10, s[8:11], s48 offen lds
s_mov_b32 m0, 44032
s_add_u32 s48, s49, 720896
buffer_load_dwordx4 v10, s[8:11], s48 offen lds
s_mov_b32 m0, 51200
s_add_u32 s48, s49, 655488
buffer_load_dwordx4 v10, s[8:11], s48 offen lds
s_mov_b32 m0, 52224
s_add_u32 s48, s49, 721024
buffer_load_dwordx4 v10, s[8:11], s48 offen lds
s_mov_b32 m0, 59392
s_add_u32 s48, s49, 655488
buffer_load_dwordx4 v10, s[12:15], s48 offen lds
s_mov_b32 m0, 60416
s_add_u32 s48, s49, 721024
buffer_load_dwordx4 v10, s[12:15], s48 offen lds
s_mov_b32 m0, 67584
s_add_u32 s48, s49, 655360
buffer_load_dwordx4 v10, s[16:19], s48 offen lds
s_mov_b32 m0, 68608
s_add_u32 s48, s49, 720896
buffer_load_dwordx4 v10, s[16:19], s48 offen lds
s_mov_b32 m0, 75776
s_add_u32 s48, s49, 655488
buffer_load_dwordx4 v10, s[16:19], s48 offen lds
s_mov_b32 m0, 76800
s_add_u32 s48, s49, 721024
buffer_load_dwordx4 v10, s[16:19], s48 offen lds
s_mov_b32 m0, 83968
s_add_u32 s48, s49, 1179648
buffer_load_dwordx4 v10, s[8:11], s48 offen lds
s_mov_b32 m0, 84992
s_add_u32 s48, s49, 1245184
buffer_load_dwordx4 v10, s[8:11], s48 offen lds
s_mov_b32 m0, 92160
s_add_u32 s48, s49, 1179776
buffer_load_dwordx4 v10, s[8:11], s48 offen lds
s_mov_b32 m0, 93184
s_add_u32 s48, s49, 1245312
buffer_load_dwordx4 v10, s[8:11], s48 offen lds
s_mov_b32 m0, 100352
s_add_u32 s48, s49, 1179776
buffer_load_dwordx4 v10, s[12:15], s48 offen lds
s_mov_b32 m0, 101376
s_add_u32 s48, s49, 1245312
buffer_load_dwordx4 v10, s[12:15], s48 offen lds
s_mov_b32 m0, 108544
s_add_u32 s48, s49, 1179648
buffer_load_dwordx4 v10, s[16:19], s48 offen lds
s_mov_b32 m0, 109568
s_add_u32 s48, s49, 1245184
buffer_load_dwordx4 v10, s[16:19], s48 offen lds
s_mov_b32 m0, 116736
s_add_u32 s48, s49, 1703936
buffer_load_dwordx4 v10, s[8:11], s48 offen lds
s_mov_b32 m0, 117760
s_add_u32 s48, s49, 1769472
buffer_load_dwordx4 v10, s[8:11], s48 offen lds
s_mov_b32 m0, 124928
s_add_u32 s48, s49, 1704064
buffer_load_dwordx4 v10, s[8:11], s48 offen lds
s_mov_b32 m0, 125952
s_add_u32 s48, s49, 1769600
buffer_load_dwordx4 v10, s[8:11], s48 offen lds
s_waitcnt vmcnt(24)
s_barrier
s_mov_b32 m0, 133120
s_add_u32 s48, s49, 1704064
buffer_load_dwordx4 v10, s[12:15], s48 offen lds
s_mov_b32 m0, 134144
s_add_u32 s48, s49, 1769600
buffer_load_dwordx4 v10, s[12:15], s48 offen lds
s_mov_b32 m0, 141312
s_add_u32 s48, s49, 1703936
buffer_load_dwordx4 v10, s[16:19], s48 offen lds
s_mov_b32 m0, 142336
s_add_u32 s48, s49, 1769472
buffer_load_dwordx4 v10, s[16:19], s48 offen lds
s_mov_b32 m0, 149504
s_add_u32 s48, s49, 2228224
buffer_load_dwordx4 v10, s[8:11], s48 offen lds
s_mov_b32 m0, 150528
s_add_u32 s48, s49, 2293760
buffer_load_dwordx4 v10, s[8:11], s48 offen lds
s_mov_b32 m0, 157696
s_add_u32 s48, s49, 2228352
buffer_load_dwordx4 v10, s[8:11], s48 offen lds
s_mov_b32 m0, 158720
s_add_u32 s48, s49, 2293888
buffer_load_dwordx4 v10, s[8:11], s48 offen lds
ds_read_b64_tr_b16 a[24:25], v4 offset:0
ds_read_b64_tr_b16 a[26:27], v4 offset:1024
ds_read_b64_tr_b16 a[28:29], v4 offset:4096
ds_read_b64_tr_b16 a[30:31], v4 offset:5120
ds_read_b64_tr_b16 a[32:33], v4 offset:8192
ds_read_b64_tr_b16 a[34:35], v4 offset:9216
ds_read_b64_tr_b16 a[36:37], v4 offset:12288
ds_read_b64_tr_b16 a[38:39], v4 offset:13312
ds_read_b64_tr_b16 a[40:41], v4 offset:16384
ds_read_b64_tr_b16 a[42:43], v4 offset:17408
ds_read_b64_tr_b16 a[44:45], v4 offset:20480
ds_read_b64_tr_b16 a[46:47], v4 offset:21504
ds_read_b64_tr_b16 a[176:177], v4 offset:24576
ds_read_b64_tr_b16 a[178:179], v4 offset:25600
ds_read_b64_tr_b16 a[180:181], v4 offset:28672
ds_read_b64_tr_b16 a[182:183], v4 offset:29696
s_waitcnt lgkmcnt(0)
s_waitcnt vmcnt(24)
s_barrier
s_mov_b32 m0, 2048
s_add_u32 s48, s49, 2228352
buffer_load_dwordx4 v10, s[12:15], s48 offen lds
s_mov_b32 m0, 3072
s_add_u32 s48, s49, 2293888
buffer_load_dwordx4 v10, s[12:15], s48 offen lds
s_mov_b32 m0, 10240
s_add_u32 s48, s49, 2228224
buffer_load_dwordx4 v10, s[16:19], s48 offen lds
s_mov_b32 m0, 11264
s_add_u32 s48, s49, 2293760
buffer_load_dwordx4 v10, s[16:19], s48 offen lds
s_mov_b32 m0, 18432
s_add_u32 s48, s49, 2752512
buffer_load_dwordx4 v10, s[8:11], s48 offen lds
s_mov_b32 m0, 19456
s_add_u32 s48, s49, 2818048
buffer_load_dwordx4 v10, s[8:11], s48 offen lds
s_mov_b32 m0, 26624
s_add_u32 s48, s49, 2752640
buffer_load_dwordx4 v10, s[8:11], s48 offen lds
s_mov_b32 m0, 27648
s_add_u32 s48, s49, 2818176
buffer_load_dwordx4 v10, s[8:11], s48 offen lds
ds_read_b64_tr_b16 v[224:225], v4 offset:32768
ds_read_b64_tr_b16 v[226:227], v4 offset:33792
ds_read_b64_tr_b16 v[228:229], v4 offset:36864
ds_read_b64_tr_b16 v[230:231], v4 offset:37888
ds_read_b64_tr_b16 a[0:1], v4 offset:40960
ds_read_b64_tr_b16 a[2:3], v4 offset:41984
ds_read_b64_tr_b16 a[4:5], v4 offset:45056
ds_read_b64_tr_b16 a[6:7], v4 offset:46080
ds_read_b64_tr_b16 a[8:9], v4 offset:49152
ds_read_b64_tr_b16 a[10:11], v4 offset:50176
ds_read_b64_tr_b16 a[12:13], v4 offset:53248
ds_read_b64_tr_b16 a[14:15], v4 offset:54272
ds_read_b64_tr_b16 a[16:17], v4 offset:57344
ds_read_b64_tr_b16 a[18:19], v4 offset:58368
ds_read_b64_tr_b16 a[20:21], v4 offset:61440
ds_read_b64_tr_b16 a[22:23], v4 offset:62464
s_waitcnt lgkmcnt(0)
s_waitcnt vmcnt(24)
s_barrier
s_mov_b32 m0, 34816
s_add_u32 s48, s49, 2752640
buffer_load_dwordx4 v10, s[12:15], s48 offen lds
s_mov_b32 m0, 35840
s_add_u32 s48, s49, 2818176
buffer_load_dwordx4 v10, s[12:15], s48 offen lds
s_mov_b32 m0, 43008
s_add_u32 s48, s49, 2752512
buffer_load_dwordx4 v10, s[16:19], s48 offen lds
s_mov_b32 m0, 44032
s_add_u32 s48, s49, 2818048
buffer_load_dwordx4 v10, s[16:19], s48 offen lds
s_mov_b32 m0, 51200
s_add_u32 s48, s49, 3276928
buffer_load_dwordx4 v10, s[8:11], s48 offen lds
s_mov_b32 m0, 52224
s_add_u32 s48, s49, 3342464
buffer_load_dwordx4 v10, s[8:11], s48 offen lds
s_mov_b32 m0, 59392
s_add_u32 s48, s49, 3801088
buffer_load_dwordx4 v10, s[8:11], s48 offen lds
s_mov_b32 m0, 60416
s_add_u32 s48, s49, 3866624
buffer_load_dwordx4 v10, s[8:11], s48 offen lds
ds_read_b64_tr_b16 v[16:17], v5 offset:0
ds_read_b64_tr_b16 v[18:19], v5 offset:1024
ds_read_b64_tr_b16 v[20:21], v5 offset:4096
ds_read_b64_tr_b16 v[22:23], v5 offset:5120
ds_read_b64_tr_b16 v[24:25], v5 offset:8192
ds_read_b64_tr_b16 v[26:27], v5 offset:9216
ds_read_b64_tr_b16 v[28:29], v5 offset:12288
ds_read_b64_tr_b16 v[30:31], v5 offset:13312
ds_read_b64_tr_b16 a[144:145], v5 offset:16384
ds_read_b64_tr_b16 a[146:147], v5 offset:17408
ds_read_b64_tr_b16 a[148:149], v5 offset:20480
ds_read_b64_tr_b16 a[150:151], v5 offset:21504
ds_read_b64_tr_b16 a[152:153], v5 offset:24576
ds_read_b64_tr_b16 a[154:155], v5 offset:25600
ds_read_b64_tr_b16 a[156:157], v5 offset:28672
ds_read_b64_tr_b16 a[158:159], v5 offset:29696
s_waitcnt lgkmcnt(0)
buffer_store_dwordx4 v[16:19], v0, s[4:7], s60 offen offset:0
buffer_store_dwordx4 v[20:23], v0, s[4:7], s60 offen offset:1024
buffer_store_dwordx4 v[24:27], v0, s[4:7], s60 offen offset:2048
buffer_store_dwordx4 v[28:31], v0, s[4:7], s60 offen offset:3072
s_waitcnt vmcnt(28)
s_barrier
s_mov_b32 m0, 67584
s_add_u32 s48, s49, 3801216
buffer_load_dwordx4 v10, s[8:11], s48 offen lds
s_mov_b32 m0, 68608
s_add_u32 s48, s49, 3866752
buffer_load_dwordx4 v10, s[8:11], s48 offen lds
s_mov_b32 m0, 75776
s_add_u32 s48, s49, 4325376
buffer_load_dwordx4 v10, s[8:11], s48 offen lds
s_mov_b32 m0, 76800
s_add_u32 s48, s49, 4390912
buffer_load_dwordx4 v10, s[8:11], s48 offen lds
s_mov_b32 m0, 83968
s_add_u32 s48, s49, 4325504
buffer_load_dwordx4 v10, s[8:11], s48 offen lds
s_mov_b32 m0, 84992
s_add_u32 s48, s49, 4391040
buffer_load_dwordx4 v10, s[8:11], s48 offen lds
s_mov_b32 m0, 92160
s_add_u32 s48, s49, 4849664
buffer_load_dwordx4 v10, s[8:11], s48 offen lds
s_mov_b32 m0, 93184
s_add_u32 s48, s49, 4915200
buffer_load_dwordx4 v10, s[8:11], s48 offen lds
ds_read_b64_tr_b16 a[160:161], v5 offset:32768
ds_read_b64_tr_b16 a[162:163], v5 offset:33792
ds_read_b64_tr_b16 a[164:165], v5 offset:36864
ds_read_b64_tr_b16 a[166:167], v5 offset:37888
ds_read_b64_tr_b16 a[168:169], v5 offset:40960
ds_read_b64_tr_b16 a[170:171], v5 offset:41984
ds_read_b64_tr_b16 a[172:173], v5 offset:45056
ds_read_b64_tr_b16 a[174:175], v5 offset:46080
ds_read_b64_tr_b16 a[48:49], v5 offset:49152
ds_read_b64_tr_b16 a[50:51], v5 offset:50176
ds_read_b64_tr_b16 a[52:53], v5 offset:53248
ds_read_b64_tr_b16 a[54:55], v5 offset:54272
ds_read_b64_tr_b16 a[56:57], v5 offset:57344
ds_read_b64_tr_b16 a[58:59], v5 offset:58368
ds_read_b64_tr_b16 a[60:61], v5 offset:61440
ds_read_b64_tr_b16 a[62:63], v5 offset:62464
s_waitcnt lgkmcnt(0)
s_waitcnt vmcnt(28)
s_barrier
s_mov_b32 m0, 100352
s_add_u32 s48, s49, 4849792
buffer_load_dwordx4 v10, s[8:11], s48 offen lds
s_mov_b32 m0, 101376
s_add_u32 s48, s49, 4915328
buffer_load_dwordx4 v10, s[8:11], s48 offen lds
s_mov_b32 m0, 108544
s_add_u32 s48, s49, 3276800
buffer_load_dwordx4 v10, s[12:15], s48 offen lds
s_mov_b32 m0, 109568
s_add_u32 s48, s49, 3342336
buffer_load_dwordx4 v10, s[12:15], s48 offen lds
s_mov_b32 m0, 116736
s_add_u32 s48, s49, 3276928
buffer_load_dwordx4 v10, s[12:15], s48 offen lds
s_mov_b32 m0, 117760
s_add_u32 s48, s49, 3342464
buffer_load_dwordx4 v10, s[12:15], s48 offen lds
s_mov_b32 m0, 124928
s_add_u32 s48, s49, 3801088
buffer_load_dwordx4 v10, s[12:15], s48 offen lds
s_mov_b32 m0, 125952
s_add_u32 s48, s49, 3866624
buffer_load_dwordx4 v10, s[12:15], s48 offen lds
ds_read_b64_tr_b16 a[64:65], v6 offset:0
ds_read_b64_tr_b16 a[66:67], v6 offset:1024
ds_read_b64_tr_b16 a[68:69], v6 offset:4096
ds_read_b64_tr_b16 a[70:71], v6 offset:5120
ds_read_b64_tr_b16 a[72:73], v6 offset:8192
ds_read_b64_tr_b16 a[74:75], v6 offset:9216
ds_read_b64_tr_b16 a[76:77], v6 offset:12288
ds_read_b64_tr_b16 a[78:79], v6 offset:13312
ds_read_b64_tr_b16 a[80:81], v6 offset:16384
ds_read_b64_tr_b16 a[82:83], v6 offset:17408
ds_read_b64_tr_b16 a[84:85], v6 offset:20480
ds_read_b64_tr_b16 a[86:87], v6 offset:21504
ds_read_b64_tr_b16 a[88:89], v6 offset:24576
ds_read_b64_tr_b16 a[90:91], v6 offset:25600
ds_read_b64_tr_b16 a[92:93], v6 offset:28672
ds_read_b64_tr_b16 a[94:95], v6 offset:29696
s_waitcnt lgkmcnt(0)
s_waitcnt vmcnt(28)
s_barrier
s_mov_b32 m0, 133120
s_add_u32 s48, s49, 3801216
buffer_load_dwordx4 v10, s[12:15], s48 offen lds
s_mov_b32 m0, 134144
s_add_u32 s48, s49, 3866752
buffer_load_dwordx4 v10, s[12:15], s48 offen lds
s_mov_b32 m0, 141312
s_add_u32 s48, s49, 4325376
buffer_load_dwordx4 v10, s[12:15], s48 offen lds
s_mov_b32 m0, 142336
s_add_u32 s48, s49, 4390912
buffer_load_dwordx4 v10, s[12:15], s48 offen lds
s_mov_b32 m0, 149504
s_add_u32 s48, s49, 4325504
buffer_load_dwordx4 v10, s[12:15], s48 offen lds
s_mov_b32 m0, 150528
s_add_u32 s48, s49, 4391040
buffer_load_dwordx4 v10, s[12:15], s48 offen lds
s_mov_b32 m0, 157696
s_add_u32 s48, s49, 4849664
buffer_load_dwordx4 v10, s[12:15], s48 offen lds
s_mov_b32 m0, 158720
s_add_u32 s48, s49, 4915200
buffer_load_dwordx4 v10, s[12:15], s48 offen lds
ds_read_b64_tr_b16 a[96:97], v4 offset:0
ds_read_b64_tr_b16 a[98:99], v4 offset:1024
ds_read_b64_tr_b16 a[100:101], v4 offset:4096
ds_read_b64_tr_b16 a[102:103], v4 offset:5120
ds_read_b64_tr_b16 a[104:105], v4 offset:8192
ds_read_b64_tr_b16 a[106:107], v4 offset:9216
ds_read_b64_tr_b16 a[108:109], v4 offset:12288
ds_read_b64_tr_b16 a[110:111], v4 offset:13312
ds_read_b64_tr_b16 a[112:113], v4 offset:16384
ds_read_b64_tr_b16 a[114:115], v4 offset:17408
ds_read_b64_tr_b16 a[116:117], v4 offset:20480
ds_read_b64_tr_b16 a[118:119], v4 offset:21504
ds_read_b64_tr_b16 a[120:121], v4 offset:24576
ds_read_b64_tr_b16 a[122:123], v4 offset:25600
ds_read_b64_tr_b16 a[124:125], v4 offset:28672
ds_read_b64_tr_b16 a[126:127], v4 offset:29696
s_waitcnt lgkmcnt(0)
s_waitcnt vmcnt(28)
s_barrier
s_mov_b32 m0, 2048
s_add_u32 s48, s49, 4849792
buffer_load_dwordx4 v10, s[12:15], s48 offen lds
s_mov_b32 m0, 3072
s_add_u32 s48, s49, 4915328
buffer_load_dwordx4 v10, s[12:15], s48 offen lds
s_mov_b32 m0, 10240
s_add_u32 s48, s49, 3276800
buffer_load_dwordx4 v10, s[16:19], s48 offen lds
s_mov_b32 m0, 11264
s_add_u32 s48, s49, 3342336
buffer_load_dwordx4 v10, s[16:19], s48 offen lds
s_mov_b32 m0, 18432
s_add_u32 s48, s49, 3276928
buffer_load_dwordx4 v10, s[16:19], s48 offen lds
s_mov_b32 m0, 19456
s_add_u32 s48, s49, 3342464
buffer_load_dwordx4 v10, s[16:19], s48 offen lds
s_mov_b32 m0, 26624
s_add_u32 s48, s49, 3801088
buffer_load_dwordx4 v10, s[16:19], s48 offen lds
s_mov_b32 m0, 27648
s_add_u32 s48, s49, 3866624
buffer_load_dwordx4 v10, s[16:19], s48 offen lds
ds_read_b64_tr_b16 a[128:129], v4 offset:32768
ds_read_b64_tr_b16 a[130:131], v4 offset:33792
ds_read_b64_tr_b16 a[132:133], v4 offset:36864
ds_read_b64_tr_b16 a[134:135], v4 offset:37888
ds_read_b64_tr_b16 a[136:137], v4 offset:40960
ds_read_b64_tr_b16 a[138:139], v4 offset:41984
ds_read_b64_tr_b16 a[140:141], v4 offset:45056
ds_read_b64_tr_b16 a[142:143], v4 offset:46080
ds_read_b64_tr_b16 a[232:233], v4 offset:49152
ds_read_b64_tr_b16 a[234:235], v4 offset:50176
ds_read_b64_tr_b16 a[236:237], v4 offset:53248
ds_read_b64_tr_b16 a[238:239], v4 offset:54272
ds_read_b64_tr_b16 a[184:185], v4 offset:57344
ds_read_b64_tr_b16 a[186:187], v4 offset:58368
ds_read_b64_tr_b16 a[188:189], v4 offset:61440
ds_read_b64_tr_b16 a[190:191], v4 offset:62464
s_waitcnt lgkmcnt(0)
s_waitcnt vmcnt(24)
s_barrier
s_mov_b32 m0, 34816
s_add_u32 s48, s49, 3801216
buffer_load_dwordx4 v10, s[16:19], s48 offen lds
s_mov_b32 m0, 35840
s_add_u32 s48, s49, 3866752
buffer_load_dwordx4 v10, s[16:19], s48 offen lds
s_mov_b32 m0, 43008
s_add_u32 s48, s49, 4325376
buffer_load_dwordx4 v10, s[16:19], s48 offen lds
s_mov_b32 m0, 44032
s_add_u32 s48, s49, 4390912
buffer_load_dwordx4 v10, s[16:19], s48 offen lds
s_mov_b32 m0, 51200
s_add_u32 s48, s49, 4325504
buffer_load_dwordx4 v10, s[16:19], s48 offen lds
s_mov_b32 m0, 52224
s_add_u32 s48, s49, 4391040
buffer_load_dwordx4 v10, s[16:19], s48 offen lds
s_mov_b32 m0, 59392
s_add_u32 s48, s49, 4849664
buffer_load_dwordx4 v10, s[16:19], s48 offen lds
s_mov_b32 m0, 60416
s_add_u32 s48, s49, 4915200
buffer_load_dwordx4 v10, s[16:19], s48 offen lds
ds_read_b64_tr_b16 a[192:193], v5 offset:0
ds_read_b64_tr_b16 a[194:195], v5 offset:1024
ds_read_b64_tr_b16 a[196:197], v5 offset:4096
ds_read_b64_tr_b16 a[198:199], v5 offset:5120
ds_read_b64_tr_b16 v[248:249], v5 offset:8192
ds_read_b64_tr_b16 v[250:251], v5 offset:9216
ds_read_b64_tr_b16 v[252:253], v5 offset:12288
ds_read_b64_tr_b16 v[254:255], v5 offset:13312
ds_read_b64_tr_b16 a[200:201], v5 offset:16384
ds_read_b64_tr_b16 a[202:203], v5 offset:17408
ds_read_b64_tr_b16 a[204:205], v5 offset:20480
ds_read_b64_tr_b16 a[206:207], v5 offset:21504
ds_read_b64_tr_b16 a[208:209], v5 offset:24576
ds_read_b64_tr_b16 a[210:211], v5 offset:25600
ds_read_b64_tr_b16 a[212:213], v5 offset:28672
ds_read_b64_tr_b16 a[214:215], v5 offset:29696
s_waitcnt lgkmcnt(0)
s_waitcnt vmcnt(24)
s_barrier
s_mov_b32 m0, 67584
s_add_u32 s48, s49, 4849792
buffer_load_dwordx4 v10, s[16:19], s48 offen lds
s_mov_b32 m0, 68608
s_add_u32 s48, s49, 4915328
buffer_load_dwordx4 v10, s[16:19], s48 offen lds
s_mov_b32 m0, 75776
s_add_u32 s48, s50, 10240
buffer_load_dwordx4 v11, s[20:23], s48 offen lds
s_mov_b32 m0, 76800
s_add_u32 s48, s50, 15360
buffer_load_dwordx4 v11, s[20:23], s48 offen lds
s_mov_b32 m0, 83968
s_add_u32 s48, s50, 30720
buffer_load_dwordx4 v11, s[20:23], s48 offen lds
s_mov_b32 m0, 84992
s_add_u32 s48, s50, 35840
buffer_load_dwordx4 v11, s[20:23], s48 offen lds
s_mov_b32 m0, 92160
s_add_u32 s48, s50, 51200
buffer_load_dwordx4 v11, s[20:23], s48 offen lds
s_mov_b32 m0, 93184
s_add_u32 s48, s50, 56320
buffer_load_dwordx4 v11, s[20:23], s48 offen lds
ds_read_b64_tr_b16 a[216:217], v5 offset:32768
ds_read_b64_tr_b16 a[218:219], v5 offset:33792
ds_read_b64_tr_b16 a[220:221], v5 offset:36864
ds_read_b64_tr_b16 a[222:223], v5 offset:37888
ds_read_b64_tr_b16 v[96:97], v5 offset:40960
ds_read_b64_tr_b16 v[98:99], v5 offset:41984
ds_read_b64_tr_b16 v[100:101], v5 offset:45056
ds_read_b64_tr_b16 v[102:103], v5 offset:46080
ds_read_b64_tr_b16 v[104:105], v5 offset:49152
ds_read_b64_tr_b16 v[106:107], v5 offset:50176
ds_read_b64_tr_b16 v[108:109], v5 offset:53248
ds_read_b64_tr_b16 v[110:111], v5 offset:54272
ds_read_b64_tr_b16 v[240:241], v5 offset:57344
ds_read_b64_tr_b16 v[242:243], v5 offset:58368
ds_read_b64_tr_b16 v[244:245], v5 offset:61440
ds_read_b64_tr_b16 v[246:247], v5 offset:62464
s_waitcnt lgkmcnt(0)
s_waitcnt vmcnt(24)
s_barrier
s_mov_b32 m0, 100352
s_add_u32 s48, s50, 71680
buffer_load_dwordx4 v11, s[20:23], s48 offen lds
s_mov_b32 m0, 101376
s_add_u32 s48, s50, 76800
buffer_load_dwordx4 v11, s[20:23], s48 offen lds
s_mov_b32 m0, 108544
s_add_u32 s48, s50, 10496
buffer_load_dwordx4 v11, s[20:23], s48 offen lds
s_mov_b32 m0, 109568
s_add_u32 s48, s50, 15616
buffer_load_dwordx4 v11, s[20:23], s48 offen lds
s_mov_b32 m0, 116736
s_add_u32 s48, s50, 30976
buffer_load_dwordx4 v11, s[20:23], s48 offen lds
s_mov_b32 m0, 117760
s_add_u32 s48, s50, 36096
buffer_load_dwordx4 v11, s[20:23], s48 offen lds
s_mov_b32 m0, 124928
s_add_u32 s48, s50, 51456
buffer_load_dwordx4 v11, s[20:23], s48 offen lds
s_mov_b32 m0, 125952
s_add_u32 s48, s50, 56576
buffer_load_dwordx4 v11, s[20:23], s48 offen lds
ds_read_b64_tr_b16 a[240:241], v6 offset:0
ds_read_b64_tr_b16 a[242:243], v6 offset:1024
ds_read_b64_tr_b16 a[244:245], v6 offset:4096
ds_read_b64_tr_b16 a[246:247], v6 offset:5120
ds_read_b64_tr_b16 a[248:249], v6 offset:8192
ds_read_b64_tr_b16 a[250:251], v6 offset:9216
ds_read_b64_tr_b16 a[252:253], v6 offset:12288
ds_read_b64_tr_b16 a[254:255], v6 offset:13312
ds_read_b64_tr_b16 v[72:73], v6 offset:16384
ds_read_b64_tr_b16 v[74:75], v6 offset:17408
ds_read_b64_tr_b16 v[76:77], v6 offset:20480
ds_read_b64_tr_b16 v[78:79], v6 offset:21504
ds_read_b64_tr_b16 v[80:81], v6 offset:24576
ds_read_b64_tr_b16 v[82:83], v6 offset:25600
ds_read_b64_tr_b16 v[84:85], v6 offset:28672
ds_read_b64_tr_b16 v[86:87], v6 offset:29696
s_waitcnt lgkmcnt(0)
s_waitcnt vmcnt(24)
s_barrier
s_mov_b32 m0, 133120
s_add_u32 s48, s50, 71936
buffer_load_dwordx4 v11, s[20:23], s48 offen lds
s_mov_b32 m0, 134144
s_add_u32 s48, s50, 77056
buffer_load_dwordx4 v11, s[20:23], s48 offen lds
s_mov_b32 m0, 141312
s_add_u32 s48, s50, 10752
buffer_load_dwordx4 v11, s[20:23], s48 offen lds
s_mov_b32 m0, 142336
s_add_u32 s48, s50, 15872
buffer_load_dwordx4 v11, s[20:23], s48 offen lds
s_mov_b32 m0, 149504
s_add_u32 s48, s50, 31232
buffer_load_dwordx4 v11, s[20:23], s48 offen lds
s_mov_b32 m0, 150528
s_add_u32 s48, s50, 36352
buffer_load_dwordx4 v11, s[20:23], s48 offen lds
s_mov_b32 m0, 157696
s_add_u32 s48, s50, 51712
buffer_load_dwordx4 v11, s[20:23], s48 offen lds
s_mov_b32 m0, 158720
s_add_u32 s48, s50, 56832
buffer_load_dwordx4 v11, s[20:23], s48 offen lds
ds_read_b64_tr_b16 v[88:89], v4 offset:0
ds_read_b64_tr_b16 v[90:91], v4 offset:1024
ds_read_b64_tr_b16 v[92:93], v4 offset:4096
ds_read_b64_tr_b16 v[94:95], v4 offset:5120
ds_read_b64_tr_b16 v[160:161], v4 offset:8192
ds_read_b64_tr_b16 v[162:163], v4 offset:9216
ds_read_b64_tr_b16 v[164:165], v4 offset:12288
ds_read_b64_tr_b16 v[166:167], v4 offset:13312
ds_read_b64_tr_b16 v[168:169], v4 offset:16384
ds_read_b64_tr_b16 v[170:171], v4 offset:17408
ds_read_b64_tr_b16 v[172:173], v4 offset:20480
ds_read_b64_tr_b16 v[174:175], v4 offset:21504
ds_read_b64_tr_b16 v[112:113], v4 offset:24576
ds_read_b64_tr_b16 v[114:115], v4 offset:25600
ds_read_b64_tr_b16 v[116:117], v4 offset:28672
ds_read_b64_tr_b16 v[118:119], v4 offset:29696
s_waitcnt lgkmcnt(0)
s_waitcnt vmcnt(24)
s_barrier
s_mov_b32 m0, 2048
s_add_u32 s48, s50, 72192
buffer_load_dwordx4 v11, s[20:23], s48 offen lds
s_mov_b32 m0, 3072
s_add_u32 s48, s50, 77312
buffer_load_dwordx4 v11, s[20:23], s48 offen lds
s_mov_b32 m0, 10240
s_add_u32 s48, s49, 131072
buffer_load_dwordx4 v10, s[12:15], s48 offen lds
s_mov_b32 m0, 11264
s_add_u32 s48, s49, 196608
buffer_load_dwordx4 v10, s[12:15], s48 offen lds
s_mov_b32 m0, 18432
s_add_u32 s48, s49, 655360
buffer_load_dwordx4 v10, s[12:15], s48 offen lds
s_mov_b32 m0, 19456
s_add_u32 s48, s49, 720896
buffer_load_dwordx4 v10, s[12:15], s48 offen lds
s_mov_b32 m0, 26624
s_add_u32 s48, s49, 1179648
buffer_load_dwordx4 v10, s[12:15], s48 offen lds
s_mov_b32 m0, 27648
s_add_u32 s48, s49, 1245184
buffer_load_dwordx4 v10, s[12:15], s48 offen lds
ds_read_b64_tr_b16 v[120:121], v4 offset:32768
ds_read_b64_tr_b16 v[122:123], v4 offset:33792
ds_read_b64_tr_b16 v[124:125], v4 offset:36864
ds_read_b64_tr_b16 v[126:127], v4 offset:37888
ds_read_b64_tr_b16 v[128:129], v4 offset:40960
ds_read_b64_tr_b16 v[130:131], v4 offset:41984
ds_read_b64_tr_b16 v[132:133], v4 offset:45056
ds_read_b64_tr_b16 v[134:135], v4 offset:46080
ds_read_b64_tr_b16 v[136:137], v4 offset:49152
ds_read_b64_tr_b16 v[138:139], v4 offset:50176
ds_read_b64_tr_b16 v[140:141], v4 offset:53248
ds_read_b64_tr_b16 v[142:143], v4 offset:54272
ds_read_b64_tr_b16 v[144:145], v4 offset:57344
ds_read_b64_tr_b16 v[146:147], v4 offset:58368
ds_read_b64_tr_b16 v[148:149], v4 offset:61440
ds_read_b64_tr_b16 v[150:151], v4 offset:62464
s_waitcnt lgkmcnt(0)
s_waitcnt vmcnt(24)
s_barrier
s_mov_b32 m0, 34816
s_add_u32 s48, s49, 1703936
buffer_load_dwordx4 v10, s[12:15], s48 offen lds
s_mov_b32 m0, 35840
s_add_u32 s48, s49, 1769472
buffer_load_dwordx4 v10, s[12:15], s48 offen lds
s_mov_b32 m0, 43008
s_add_u32 s48, s49, 2228224
buffer_load_dwordx4 v10, s[12:15], s48 offen lds
s_mov_b32 m0, 44032
s_add_u32 s48, s49, 2293760
buffer_load_dwordx4 v10, s[12:15], s48 offen lds
s_mov_b32 m0, 51200
s_add_u32 s48, s49, 2752512
buffer_load_dwordx4 v10, s[12:15], s48 offen lds
s_mov_b32 m0, 52224
s_add_u32 s48, s49, 2818048
buffer_load_dwordx4 v10, s[12:15], s48 offen lds
s_mov_b32 m0, 59392
s_add_u32 s48, s49, 1179776
buffer_load_dwordx4 v10, s[16:19], s48 offen lds
s_mov_b32 m0, 60416
s_add_u32 s48, s49, 1245312
buffer_load_dwordx4 v10, s[16:19], s48 offen lds
ds_read_b64_tr_b16 v[152:153], v5 offset:0
ds_read_b64_tr_b16 v[154:155], v5 offset:1024
ds_read_b64_tr_b16 v[156:157], v5 offset:4096
ds_read_b64_tr_b16 v[158:159], v5 offset:5120
ds_read_b64_tr_b16 v[192:193], v8 offset:8192
ds_read_b64_tr_b16 v[194:195], v8 offset:8704
ds_read_b64_tr_b16 v[196:197], v8 offset:10240
ds_read_b64_tr_b16 v[198:199], v8 offset:10752
v_xor_b32 v12, v15, v8
ds_read_b64_tr_b16 v[32:33], v12 offset:16384
ds_read_b64_tr_b16 v[34:35], v12 offset:16896
ds_read_b64_tr_b16 v[36:37], v12 offset:18432
ds_read_b64_tr_b16 v[38:39], v12 offset:18944
ds_read_b64_tr_b16 v[176:177], v8 offset:24576
ds_read_b64_tr_b16 v[178:179], v8 offset:25088
ds_read_b64_tr_b16 v[180:181], v8 offset:26624
ds_read_b64_tr_b16 v[182:183], v8 offset:27136
s_waitcnt lgkmcnt(0)
buffer_store_dwordx4 v[32:35], v0, s[4:7], s61 offen offset:0
buffer_store_dwordx4 v[36:39], v0, s[4:7], s61 offen offset:1024
s_waitcnt vmcnt(26)
s_barrier
s_mov_b32 m0, 67584
s_add_u32 s48, s49, 1704064
buffer_load_dwordx4 v10, s[16:19], s48 offen lds
s_mov_b32 m0, 68608
s_add_u32 s48, s49, 1769600
buffer_load_dwordx4 v10, s[16:19], s48 offen lds
s_mov_b32 m0, 75776
s_add_u32 s48, s49, 2228352
buffer_load_dwordx4 v10, s[16:19], s48 offen lds
s_mov_b32 m0, 76800
s_add_u32 s48, s49, 2293888
buffer_load_dwordx4 v10, s[16:19], s48 offen lds
s_mov_b32 m0, 83968
s_add_u32 s48, s49, 2752640
buffer_load_dwordx4 v10, s[16:19], s48 offen lds
s_mov_b32 m0, 84992
s_add_u32 s48, s49, 2818176
buffer_load_dwordx4 v10, s[16:19], s48 offen lds
s_mov_b32 m0, 92160
s_add_u32 s48, s50, 11008
buffer_load_dwordx4 v11, s[20:23], s48 offen lds
s_mov_b32 m0, 93184
s_add_u32 s48, s50, 16128
buffer_load_dwordx4 v11, s[20:23], s48 offen lds
ds_read_b64_tr_b16 v[184:185], v8 offset:32768
ds_read_b64_tr_b16 v[186:187], v8 offset:33280
ds_read_b64_tr_b16 v[188:189], v8 offset:34816
ds_read_b64_tr_b16 v[190:191], v8 offset:35328
ds_read_b64_tr_b16 v[24:25], v8 offset:40960
ds_read_b64_tr_b16 v[26:27], v8 offset:41472
ds_read_b64_tr_b16 v[28:29], v8 offset:43008
ds_read_b64_tr_b16 v[30:31], v8 offset:43520
v_xor_b32 v12, v15, v8
ds_read_b64_tr_b16 v[32:33], v12 offset:49152
ds_read_b64_tr_b16 v[34:35], v12 offset:49664
ds_read_b64_tr_b16 v[36:37], v12 offset:51200
ds_read_b64_tr_b16 v[38:39], v12 offset:51712
ds_read_b64_tr_b16 a[224:225], v8 offset:57344
ds_read_b64_tr_b16 a[226:227], v8 offset:57856
ds_read_b64_tr_b16 a[228:229], v8 offset:59392
ds_read_b64_tr_b16 a[230:231], v8 offset:59904
s_waitcnt lgkmcnt(0)
buffer_store_dwordx4 v[24:27], v0, s[4:7], s62 offen offset:0
buffer_store_dwordx4 v[28:31], v0, s[4:7], s62 offen offset:1024
buffer_store_dwordx4 v[32:35], v0, s[4:7], s61 offen offset:2048
buffer_store_dwordx4 v[36:39], v0, s[4:7], s61 offen offset:3072
s_waitcnt vmcnt(30)
s_barrier
s_mov_b32 m0, 100352
s_add_u32 s48, s50, 31488
buffer_load_dwordx4 v11, s[20:23], s48 offen lds
s_mov_b32 m0, 101376
s_add_u32 s48, s50, 36608
buffer_load_dwordx4 v11, s[20:23], s48 offen lds
s_mov_b32 m0, 108544
s_add_u32 s48, s50, 51968
buffer_load_dwordx4 v11, s[20:23], s48 offen lds
s_mov_b32 m0, 109568
s_add_u32 s48, s50, 57088
buffer_load_dwordx4 v11, s[20:23], s48 offen lds
s_mov_b32 m0, 116736
s_add_u32 s48, s50, 72448
buffer_load_dwordx4 v11, s[20:23], s48 offen lds
s_mov_b32 m0, 117760
s_add_u32 s48, s50, 77568
buffer_load_dwordx4 v11, s[20:23], s48 offen lds
s_mov_b32 m0, 124928
s_add_u32 s48, s50, 11264
buffer_load_dwordx4 v11, s[20:23], s48 offen lds
s_mov_b32 m0, 125952
s_add_u32 s48, s50, 16384
buffer_load_dwordx4 v11, s[20:23], s48 offen lds
ds_read_b64_tr_b16 v[232:233], v9 offset:0
ds_read_b64_tr_b16 v[234:235], v9 offset:512
ds_read_b64_tr_b16 v[236:237], v9 offset:2048
ds_read_b64_tr_b16 v[238:239], v9 offset:2560
ds_read_b64_tr_b16 v[216:217], v9 offset:8192
ds_read_b64_tr_b16 v[218:219], v9 offset:8704
ds_read_b64_tr_b16 v[220:221], v9 offset:10240
ds_read_b64_tr_b16 v[222:223], v9 offset:10752
v_xor_b32 v12, v15, v9
ds_read_b64_tr_b16 v[200:201], v12 offset:16384
ds_read_b64_tr_b16 v[202:203], v12 offset:16896
ds_read_b64_tr_b16 v[204:205], v12 offset:18432
ds_read_b64_tr_b16 v[206:207], v12 offset:18944
ds_read_b64_tr_b16 v[40:41], v9 offset:24576
ds_read_b64_tr_b16 v[42:43], v9 offset:25088
ds_read_b64_tr_b16 v[44:45], v9 offset:26624
ds_read_b64_tr_b16 v[46:47], v9 offset:27136
s_waitcnt lgkmcnt(0)
buffer_store_dwordx4 v[40:43], v0, s[4:7], s62 offen offset:2048
buffer_store_dwordx4 v[44:47], v0, s[4:7], s62 offen offset:3072
s_waitcnt vmcnt(38)
s_barrier
s_mov_b32 m0, 133120
s_add_u32 s48, s50, 31744
buffer_load_dwordx4 v11, s[20:23], s48 offen lds
s_mov_b32 m0, 134144
s_add_u32 s48, s50, 36864
buffer_load_dwordx4 v11, s[20:23], s48 offen lds
s_mov_b32 m0, 141312
s_add_u32 s48, s50, 52224
buffer_load_dwordx4 v11, s[20:23], s48 offen lds
s_mov_b32 m0, 142336
s_add_u32 s48, s50, 57344
buffer_load_dwordx4 v11, s[20:23], s48 offen lds
s_mov_b32 m0, 149504
s_add_u32 s48, s50, 72704
buffer_load_dwordx4 v11, s[20:23], s48 offen lds
s_mov_b32 m0, 150528
s_add_u32 s48, s50, 77824
buffer_load_dwordx4 v11, s[20:23], s48 offen lds
s_mov_b32 m0, 157696
s_add_u32 s48, s49, 3276800
buffer_load_dwordx4 v10, s[8:11], s48 offen lds
s_mov_b32 m0, 158720
s_add_u32 s48, s49, 3342336
buffer_load_dwordx4 v10, s[8:11], s48 offen lds
ds_read_b64_tr_b16 v[208:209], v7 offset:0
ds_read_b64_tr_b16 v[210:211], v7 offset:512
ds_read_b64_tr_b16 v[212:213], v7 offset:2048
ds_read_b64_tr_b16 v[214:215], v7 offset:2560
s_waitcnt lgkmcnt(0)
s_waitcnt vmcnt(32)
s_barrier
ds_read_b64_tr_b16 v[16:17], v4 offset:8192
ds_read_b64_tr_b16 v[18:19], v4 offset:9216
ds_read_b64_tr_b16 v[20:21], v4 offset:12288
ds_read_b64_tr_b16 v[22:23], v4 offset:13312
ds_read_b64_tr_b16 v[24:25], v4 offset:16384
ds_read_b64_tr_b16 v[26:27], v4 offset:17408
ds_read_b64_tr_b16 v[28:29], v4 offset:20480
ds_read_b64_tr_b16 v[30:31], v4 offset:21504
ds_read_b64_tr_b16 v[32:33], v4 offset:24576
ds_read_b64_tr_b16 v[34:35], v4 offset:25600
ds_read_b64_tr_b16 v[36:37], v4 offset:28672
ds_read_b64_tr_b16 v[38:39], v4 offset:29696
ds_read_b64_tr_b16 v[40:41], v4 offset:32768
ds_read_b64_tr_b16 v[42:43], v4 offset:33792
ds_read_b64_tr_b16 v[44:45], v4 offset:36864
ds_read_b64_tr_b16 v[46:47], v4 offset:37888
ds_read_b64_tr_b16 v[48:49], v4 offset:40960
ds_read_b64_tr_b16 v[50:51], v4 offset:41984
ds_read_b64_tr_b16 v[52:53], v4 offset:45056
ds_read_b64_tr_b16 v[54:55], v4 offset:46080
ds_read_b64_tr_b16 v[56:57], v4 offset:49152
ds_read_b64_tr_b16 v[58:59], v4 offset:50176
ds_read_b64_tr_b16 v[60:61], v4 offset:53248
ds_read_b64_tr_b16 v[62:63], v4 offset:54272
ds_read_b64_tr_b16 v[64:65], v4 offset:57344
ds_read_b64_tr_b16 v[66:67], v4 offset:58368
ds_read_b64_tr_b16 v[68:69], v4 offset:61440
ds_read_b64_tr_b16 v[70:71], v4 offset:62464
s_waitcnt lgkmcnt(0)
s_barrier
ds_write_b128 v0, v[16:19] offset:22528
ds_write_b128 v0, v[20:23] offset:23552
ds_write_b128 v0, v[24:27] offset:24576
ds_write_b128 v0, v[28:31] offset:25600
ds_write_b128 v0, v[32:35] offset:26624
ds_write_b128 v0, v[36:39] offset:27648
ds_write_b128 v0, v[40:43] offset:28672
ds_write_b128 v0, v[44:47] offset:29696
ds_write_b128 v0, v[48:51] offset:30720
ds_write_b128 v0, v[52:55] offset:31744
ds_write_b128 v0, v[56:59] offset:32768
ds_write_b128 v0, v[60:63] offset:33792
ds_write_b128 v0, a[176:179] offset:34816
ds_write_b128 v0, a[180:183] offset:35840
s_waitcnt lgkmcnt(0)
v_accvgpr_write_b32 a176, v64
v_accvgpr_write_b32 a177, v65
v_accvgpr_write_b32 a178, v66
v_accvgpr_write_b32 a179, v67
v_accvgpr_write_b32 a180, v68
v_accvgpr_write_b32 a181, v69
v_accvgpr_write_b32 a182, v70
v_accvgpr_write_b32 a183, v71
s_waitcnt vmcnt(6)
s_barrier
ds_read_b64_tr_b16 v[16:17], v8 offset:24576
ds_read_b64_tr_b16 v[18:19], v8 offset:25088
ds_read_b64_tr_b16 v[20:21], v8 offset:26624
ds_read_b64_tr_b16 v[22:23], v8 offset:27136
v_xor_b32 v12, v15, v8
ds_read_b64_tr_b16 v[24:25], v12 offset:32768
ds_read_b64_tr_b16 v[26:27], v12 offset:33280
ds_read_b64_tr_b16 v[28:29], v12 offset:34816
ds_read_b64_tr_b16 v[30:31], v12 offset:35328
ds_read_b64_tr_b16 v[32:33], v8 offset:40960
ds_read_b64_tr_b16 v[34:35], v8 offset:41472
ds_read_b64_tr_b16 v[36:37], v8 offset:43008
ds_read_b64_tr_b16 v[38:39], v8 offset:43520
ds_read_b64_tr_b16 v[40:41], v8 offset:49152
ds_read_b64_tr_b16 v[42:43], v8 offset:49664
ds_read_b64_tr_b16 v[44:45], v8 offset:51200
ds_read_b64_tr_b16 v[46:47], v8 offset:51712
ds_read_b64_tr_b16 v[48:49], v8 offset:57344
ds_read_b64_tr_b16 v[50:51], v8 offset:57856
ds_read_b64_tr_b16 v[52:53], v8 offset:59392
ds_read_b64_tr_b16 v[54:55], v8 offset:59904
v_xor_b32 v12, v15, v9
ds_read_b64_tr_b16 v[56:57], v12 offset:0
ds_read_b64_tr_b16 v[58:59], v12 offset:512
ds_read_b64_tr_b16 v[60:61], v12 offset:2048
ds_read_b64_tr_b16 v[62:63], v12 offset:2560
s_waitcnt lgkmcnt(0)
s_barrier
ds_write_b128 v2, v[232:235] offset:28672
ds_write_b128 v2, v[236:239] offset:29696
ds_write_b128 v2, v[224:227] offset:30720
ds_write_b128 v2, v[228:231] offset:31744
ds_write_b128 v2, v[32:35] offset:32768
ds_write_b128 v2, v[36:39] offset:33792
ds_write_b128 v2, v[40:43] offset:34816
ds_write_b128 v2, v[44:47] offset:35840
ds_write_b128 v2, v[248:251] offset:36864
ds_write_b128 v2, v[252:255] offset:37888
ds_write_b128 v2, v[240:243] offset:38912
ds_write_b128 v2, v[244:247] offset:39936
s_waitcnt lgkmcnt(0)
v_mov_b32 v232, v16
v_mov_b32 v233, v17
v_mov_b32 v234, v18
v_mov_b32 v235, v19
v_mov_b32 v236, v20
v_mov_b32 v237, v21
v_mov_b32 v238, v22
v_mov_b32 v239, v23
v_mov_b32 v224, v24
v_mov_b32 v225, v25
v_mov_b32 v226, v26
v_mov_b32 v227, v27
v_mov_b32 v228, v28
v_mov_b32 v229, v29
v_mov_b32 v230, v30
v_mov_b32 v231, v31
v_mov_b32 v248, v48
v_mov_b32 v249, v49
v_mov_b32 v250, v50
v_mov_b32 v251, v51
v_mov_b32 v252, v52
v_mov_b32 v253, v53
v_mov_b32 v254, v54
v_mov_b32 v255, v55
v_mov_b32 v240, v56
v_mov_b32 v241, v57
v_mov_b32 v242, v58
v_mov_b32 v243, v59
v_mov_b32 v244, v60
v_mov_b32 v245, v61
v_mov_b32 v246, v62
v_mov_b32 v247, v63
s_waitcnt vmcnt(0)
s_barrier
ds_read_b64_tr_b16 v[16:17], v5 offset:0
ds_read_b64_tr_b16 v[18:19], v5 offset:1024
ds_read_b64_tr_b16 v[20:21], v5 offset:4096
ds_read_b64_tr_b16 v[22:23], v5 offset:5120
ds_read_b64_tr_b16 v[24:25], v5 offset:8192
ds_read_b64_tr_b16 v[26:27], v5 offset:9216
ds_read_b64_tr_b16 v[28:29], v5 offset:12288
ds_read_b64_tr_b16 v[30:31], v5 offset:13312
ds_read_b64_tr_b16 v[32:33], v5 offset:16384
ds_read_b64_tr_b16 v[34:35], v5 offset:17408
ds_read_b64_tr_b16 v[36:37], v5 offset:20480
ds_read_b64_tr_b16 v[38:39], v5 offset:21504
ds_read_b64_tr_b16 v[40:41], v9 offset:8192
ds_read_b64_tr_b16 v[42:43], v9 offset:8704
ds_read_b64_tr_b16 v[44:45], v9 offset:10240
ds_read_b64_tr_b16 v[46:47], v9 offset:10752
ds_read_b64_tr_b16 v[48:49], v9 offset:16384
ds_read_b64_tr_b16 v[50:51], v9 offset:16896
ds_read_b64_tr_b16 v[52:53], v9 offset:18432
ds_read_b64_tr_b16 v[54:55], v9 offset:18944
ds_read_b64_tr_b16 v[56:57], v6 offset:24576
ds_read_b64_tr_b16 v[58:59], v6 offset:25600
ds_read_b64_tr_b16 v[60:61], v6 offset:28672
ds_read_b64_tr_b16 v[62:63], v6 offset:29696
s_waitcnt lgkmcnt(0)
s_barrier
ds_write_b128 v2, v[16:19] offset:53248
ds_write_b128 v2, v[20:23] offset:54272
ds_write_b128 v2, v[24:27] offset:55296
ds_write_b128 v2, v[28:31] offset:56320
ds_write_b128 v2, v[32:35] offset:57344
ds_write_b128 v2, v[36:39] offset:58368
ds_write_b128 v2, v[40:43] offset:59392
ds_write_b128 v2, v[44:47] offset:60416
ds_write_b128 v2, v[48:51] offset:61440
ds_write_b128 v2, v[52:55] offset:62464
ds_write_b128 v2, a[224:227] offset:63488
ds_write_b128 v2, a[228:231] offset:64512
s_waitcnt lgkmcnt(0)
v_accvgpr_write_b32 a224, v56
v_accvgpr_write_b32 a225, v57
v_accvgpr_write_b32 a226, v58
v_accvgpr_write_b32 a227, v59
v_accvgpr_write_b32 a228, v60
v_accvgpr_write_b32 a229, v61
v_accvgpr_write_b32 a230, v62
v_accvgpr_write_b32 a231, v63
s_mov_b32 s90, 0x300003
s_mov_b32 s91, 0x300003
s_mov_b32 s12, 0x3030303
s_mov_b32 s13, 0x3030303
s_mov_b32 s92, 0xc0000c
s_mov_b32 s93, 0xc0000c
s_mov_b32 s14, 0xc0c0c0c
s_mov_b32 s15, 0xc0c0c0c
s_mov_b32 s94, 0x30000300
s_mov_b32 s95, 0x30000300
s_mov_b32 s16, 0x30303030
s_mov_b32 s17, 0x30303030
s_mov_b32 s96, 0xc0000c00
s_mov_b32 s97, 0xc0000c00
s_mov_b32 s18, 0xc0c0c0c0
s_mov_b32 s19, 0xc0c0c0c0
s_mov_b32 s98, 0xff00ff00
s_mov_b32 s99, 0xff00ff00
v_mov_b32 v1, 0x4444
v_mov_b32 v4, 0xeeee
v_cndmask_b32 v1, v1, v4, s[98:99]
v_lshrrev_b32 v4, 8, v0
v_lshl_or_b32 v1, v4, 28, v1
v_bfe_u32 v4, v0, 4, 4
v_lshl_or_b32 v1, v4, 19, v1
s_mov_b32 s51, 0x3e0293ee
s_mov_b32 s52, 0x3f803f80
s_mov_b32 s53, 0x3f803f80
s_mov_b32 s54, 0x3f003f00
s_mov_b32 s55, 0x3f003f00
s_mov_b32 s56, 0xff800000
s_mov_b32 s57, 0xff800000
s_mov_b32 s58, 0x3f80
s_mov_b32 s8, s4
s_mov_b32 s9, s5
s_cmp_eq_u32 s30, 29
s_cselect_b32 s10, s6, 0
s_mov_b32 s31, 0
s_mov_b32 s45, -2
s_lshl_b32 s46, s30, 6
s_add_u32 s46, s46, 222330880
s_lshl_b32 s48, s30, 7
s_and_b32 s49, s30, 31
s_lshl_b32 s49, s49, 12
s_add_u32 s43, s49, 119603200
v_mov_b64 v[12:13], -1
s_add_u32 s38, s48, 119554048
s_add_u32 s39, s48, 119619584
s_add_u32 s40, s48, 119685120
s_add_u32 s41, s48, 119750656
s_add_u32 s42, s48, 119816192
v_lshrrev_b32 v4, 16, v1
buffer_store_dwordx2 v[12:13], v4, s[4:7], s38 offen sc1
buffer_store_dwordx2 v[12:13], v4, s[4:7], s39 offen sc1
buffer_store_dwordx2 v[12:13], v4, s[4:7], s40 offen sc1
buffer_store_dwordx2 v[12:13], v4, s[4:7], s41 offen sc1
buffer_store_dwordx2 v[12:13], v4, s[4:7], s42 offen sc1
k_lay_173:
s_add_u32 s47, s31, 63
s_mov_b32 s33, 120324096
s_mov_b32 s34, 120327168
s_mov_b32 s35, 120331264
s_mul_i32 s48, s31, 655360
s_lshl_b32 s36, s30, 14
s_add_u32 s36, s36, s48
s_add_u32 s36, s36, 4096
v_mov_b32 v12, -1
s_and_b32 s48, s30, 31
s_add_u32 s48, s48, 16
s_lshr_b32 s49, s48, 1
s_and_b32 s48, s48, 1
s_lshl_b32 s44, s49, 8
s_lshl_b32 s50, s48, 6
s_add_u32 s44, s44, s50
s_add_u32 s44, s44, s33
s_mul_i32 s48, s48, 5120
s_lshl_b32 s49, s49, 5
s_add_u32 s48, s48, s49
v_lshrrev_b32 v8, 4, v0
v_and_b32 v9, 3, v8
v_mul_u32_u24 v9, 1280, v9
v_bfe_u32 v10, v8, 2, 1
v_lshl_add_u32 v9, v10, 1, v9
v_bfe_u32 v10, v8, 4, 1
v_lshl_add_u32 v9, v10, 4, v9
v_bfe_u32 v10, v8, 5, 1
v_lshl_add_u32 v9, v10, 2, v9
buffer_load_ushort v10, v9, s[24:27], s48 offen
buffer_load_ushort v11, v9, s[24:27], s48 offen offset:8
v_and_b32 v45, 0x30, v0
v_lshrrev_b32 v46, 8, v0
v_lshl_or_b32 v45, v46, 2, v45
v_bfe_u32 v46, v0, 6, 1
v_lshl_or_b32 v45, v46, 7, v45
v_cndmask_b32 v45, v45, 2.0, s[98:99]
s_waitcnt vmcnt(0)
v_lshl_or_b32 v10, v11, 16, v10
s_lshl_b32 s63, s30, 10
s_add_u32 s63, s63, 120356864
s_lshl_b32 s37, s31, 14
s_add_u32 s37, s37, 117441536
s_add_u32 s59, s37, 4096
s_cmp_eq_u32 s31, 0
s_cbranch_scc1 k_l0_174
s_waitcnt vmcnt(0)
s_barrier
v_mov_b32 v8, 160
s_barrier
ds_read_b32 v9, v8
s_waitcnt lgkmcnt(0)
v_readfirstlane_b32 s64, v9
k_l0_174:
buffer_store_dword v10, v45, s[4:7], s44 offen sc1
s_add_u32 s44, s44, 16384
buffer_store_dword v12, v45, s[4:7], s44 offen sc1
s_waitcnt vmcnt(0)
s_barrier
v_mov_b32 v8, 160
s_barrier
ds_read_b32 v9, v8
s_waitcnt lgkmcnt(0)
v_readfirstlane_b32 s64, v9
v_lshlrev_b32 v23, v0, s58
v_cndmask_b32 v20, 0, v23, s[90:91]
v_cndmask_b32 v21, 0, v23, s[92:93]
v_cndmask_b32 v22, 0, v23, s[94:95]
v_cndmask_b32 v23, 0, v23, s[96:97]
s_cmp_lg_u32 s64, 0
s_cbranch_scc1 k_far_179
s_branch k_cold2_183
k_T0_181:
s_waitcnt vmcnt(2)
v_smfmac_f32_16x16x64_bf16 v[40:43], v[4:7], v[48:55], v1
s_waitcnt vmcnt(1)
v_cmp_u_f32 vcc, v4, v8
v_smfmac_f32_16x16x64_bf16 v[24:27], v[8:11], a[24:31], v1
v_smfmac_f32_16x16x64_bf16 v[28:31], v[8:11], a[32:39], v1
s_cbranch_vccnz k_cold_182
k_okC_184:
s_waitcnt vmcnt(1)
v_smfmac_f32_16x16x64_bf16 v[36:39], v[8:11], a[40:47], v1
s_waitcnt lgkmcnt(0)
ds_read_b128 v[48:51], v0 offset:34816
v_smfmac_f32_16x16x64_bf16 v[32:35], v[4:7], v[64:71], v1
ds_read_b128 v[52:55], v0 offset:35840
ds_read_b128 v[64:67], v0 offset:22528
v_smfmac_f32_16x16x64_bf16 v[44:47], v[4:7], v[56:63], v1
ds_read_b128 v[68:71], v0 offset:23552
v_smfmac_f32_16x16x64_bf16 v[28:31], v[4:7], a[8:15], v1
v_smfmac_f32_16x16x64_bf16 v[24:27], v[4:7], a[0:7], v1
ds_read_b128 v[56:59], v2 offset:30720
v_smfmac_f32_16x16x64_bf16 v[36:39], v[4:7], a[16:23], v1
ds_read_b128 v[60:63], v2 offset:31744
s_waitcnt lgkmcnt(4)
v_smfmac_f32_16x16x64_bf16 v[40:43], v[8:11], v[48:55], v1
s_waitcnt vmcnt(0)
ds_write_b128 v0, v[12:15] offset:1024
s_waitcnt lgkmcnt(3)
v_smfmac_f32_16x16x64_bf16 v[32:35], v[8:11], v[64:71], v1
buffer_load_dwordx4 v[16:19], v0, s[4:7], s35 offen offset:0 sc1
v_cmp_u_f32 vcc, v12, v12
s_waitcnt lgkmcnt(1)
v_smfmac_f32_16x16x64_bf16 v[44:47], v[8:11], v[56:63], v1
ds_read_b128 v[56:59], v2 offset:53248
ds_read_b128 v[60:63], v2 offset:54272
ds_read_b128 v[64:67], v0 offset:28672
s_cbranch_vccnz k_coldA_185
k_okA_186:
v_smfmac_f32_16x16x64_bf16 v[36:39], v[12:15], a[64:71], v1
ds_read_b128 v[68:71], v0 offset:29696
s_waitcnt lgkmcnt(4)
v_smfmac_f32_16x16x64_bf16 v[40:43], v[12:15], a[72:79], v1
s_barrier
v_smfmac_f32_16x16x64_bf16 v[28:31], v[12:15], a[56:63], v1
ds_read_b128 v[8:11], v0 offset:2048
buffer_load_dwordx4 v[48:51], v0, s[4:7], s36 offen offset:0 sc1
s_waitcnt lgkmcnt(3)
v_smfmac_f32_16x16x64_bf16 v[44:47], v[12:15], v[56:63], v1
ds_read_b128 v[56:59], v2 offset:55296
v_smfmac_f32_16x16x64_bf16 v[24:27], v[12:15], a[48:55], v1
ds_read_b128 v[60:63], v2 offset:56320
s_waitcnt lgkmcnt(3)
v_smfmac_f32_16x16x64_bf16 v[32:35], v[12:15], v[64:71], v1
buffer_load_dwordx4 v[52:55], v0, s[4:7], s36 offen offset:1024 sc1
s_waitcnt lgkmcnt(2)
v_smfmac_f32_16x16x64_bf16 v[24:27], v[8:11], a[80:87], v1
ds_read_b128 v[64:67], v0 offset:30720
ds_read_b128 v[68:71], v0 offset:31744
v_smfmac_f32_16x16x64_bf16 v[36:39], v[8:11], a[96:103], v1
buffer_store_dwordx4 v[4:7], v0, s[8:11], s37 offen offset:0 sc1
s_waitcnt lgkmcnt(2)
s_nop 0
ds_read_b128 v[4:7], v0 offset:3072
v_smfmac_f32_16x16x64_bf16 v[44:47], v[8:11], v[56:63], v1
ds_read_b128 v[56:59], v2 offset:57344
ds_read_b128 v[60:63], v2 offset:58368
v_smfmac_f32_16x16x64_bf16 v[28:31], v[8:11], a[88:95], v1
buffer_store_dwordx4 v[12:15], v0, s[8:11], s37 offen offset:2048 sc1
v_smfmac_f32_16x16x64_bf16 v[40:43], v[8:11], a[104:111], v1
s_waitcnt lgkmcnt(3)
s_waitcnt lgkmcnt(2)
v_smfmac_f32_16x16x64_bf16 v[32:35], v[8:11], v[64:71], v1
ds_read_b128 v[64:67], v0 offset:32768
ds_read_b128 v[12:15], v0 offset:0
v_smfmac_f32_16x16x64_bf16 v[36:39], v[4:7], a[128:135], v1
s_waitcnt lgkmcnt(2)
v_smfmac_f32_16x16x64_bf16 v[44:47], v[4:7], v[56:63], v1
ds_read_b128 v[68:71], v0 offset:33792
buffer_load_dwordx4 v[56:59], v0, s[4:7], s36 offen offset:2048 sc1
v_smfmac_f32_16x16x64_bf16 v[28:31], v[4:7], a[120:127], v1
v_smfmac_f32_16x16x64_bf16 v[24:27], v[4:7], a[112:119], v1
s_waitcnt vmcnt(5)
ds_write_b128 v0, v[16:19] offset:5120
v_smfmac_f32_16x16x64_bf16 v[40:43], v[4:7], a[136:143], v1
s_waitcnt lgkmcnt(1)
buffer_load_dwordx4 v[60:63], v0, s[4:7], s36 offen offset:3072 sc1
v_cmp_u_f32 vcc, v16, v16
v_smfmac_f32_16x16x64_bf16 v[32:35], v[4:7], v[64:71], v1
ds_read_b128 v[64:67], v0 offset:26624
ds_read_b128 v[68:71], v0 offset:27648
v_smfmac_f32_16x16x64_bf16 v[28:31], v[12:15], a[152:159], v1
v_smfmac_f32_16x16x64_bf16 v[24:27], v[12:15], a[144:151], v1
s_cbranch_vccnz k_coldB_187
k_okB_188:
v_smfmac_f32_16x16x64_bf16 v[36:39], v[12:15], a[160:167], v1
s_waitcnt lgkmcnt(2)
buffer_store_dwordx4 v[16:19], v0, s[8:11], s59 offen offset:2048 sc1
s_barrier
ds_read_b128 v[4:7], v0 offset:7168
v_smfmac_f32_16x16x64_bf16 v[44:47], v[12:15], a[176:183], v1
ds_read_b128 v[8:11], v0 offset:6144
s_waitcnt lgkmcnt(2)
v_smfmac_f32_16x16x64_bf16 v[32:35], v[12:15], v[64:71], v1
ds_read_b128 v[64:67], v2 offset:36864
ds_read_b128 v[68:71], v2 offset:37888
v_smfmac_f32_16x16x64_bf16 v[24:27], v[16:19], a[184:191], v1
v_smfmac_f32_16x16x64_bf16 v[40:43], v[12:15], a[168:175], v1
s_waitcnt lgkmcnt(3)
ds_read_b128 v[12:15], v0 offset:4096
v_smfmac_f32_16x16x64_bf16 v[24:27], v[4:7], a[208:215], v1
s_waitcnt lgkmcnt(3)
v_smfmac_f32_16x16x64_bf16 v[28:31], v[4:7], a[216:223], v1
v_smfmac_f32_16x16x64_bf16 v[28:31], v[8:11], a[200:207], v1
s_waitcnt lgkmcnt(1)
v_smfmac_f32_16x16x64_bf16 v[24:27], v[8:11], v[64:71], v1
ds_read_b128 v[64:67], v2 offset:38912
s_waitcnt lgkmcnt(1)
v_smfmac_f32_16x16x64_bf16 v[24:27], v[12:15], a[224:231], v1
ds_read_b128 v[68:71], v2 offset:39936
v_smfmac_f32_16x16x64_bf16 v[28:31], v[12:15], a[232:239], v1
v_smfmac_f32_16x16x64_bf16 v[28:31], v[16:19], a[192:199], v1
v_cvt_pk_bf16_f32 v24, v24, v25
v_cvt_pk_bf16_f32 v25, v26, v27
v_smfmac_f32_16x16x64_bf16 v[32:35], v[4:7], v[80:87], v1
v_cvt_pk_bf16_f32 v26, v28, v29
v_cvt_pk_bf16_f32 v27, v30, v31
v_smfmac_f32_16x16x64_bf16 v[32:35], v[8:11], a[248:255], v1
s_waitcnt lgkmcnt(0)
v_mfma_f32_16x16x32_bf16 v[28:31], v[24:27], v[20:23], 0
v_and_b32 v26, 0xffffff7f, v0
v_smfmac_f32_16x16x64_bf16 v[32:35], v[16:19], v[64:71], v1
v_and_or_b32 v26, v1, 8, v26
v_mul_f32 v28, s51, v28
v_mul_f32 v29, s51, v29
v_mul_f32 v31, s51, v31
v_cvt_pk_bf16_f32 v24, v28, v29
v_mul_f32 v30, s51, v30
v_cvt_pk_bf16_f32 v25, v30, v31
v_smfmac_f32_16x16x64_bf16 v[32:35], v[12:15], v[96:103], v1
ds_write_b64 v26, v[24:25] offset:128
v_smfmac_f32_16x16x64_bf16 v[36:39], v[8:11], v[72:79], v1
v_cvt_pk_bf16_f32 v32, v32, v33
v_smfmac_f32_16x16x64_bf16 v[36:39], v[16:19], a[240:247], v1
buffer_load_dwordx4 v[64:67], v0, s[4:7], s61 offen offset:0
v_cvt_pk_bf16_f32 v33, v34, v35
v_smfmac_f32_16x16x64_bf16 v[36:39], v[12:15], v[104:111], v1
s_waitcnt lgkmcnt(0)
v_smfmac_f32_16x16x64_bf16 v[36:39], v[4:7], v[88:95], v1
s_barrier
ds_read_b128 v[24:27], v0 offset:0
v_smfmac_f32_16x16x64_bf16 v[40:43], v[4:7], v[144:151], v1
ds_read_b128 v[28:31], v0 offset:1024
s_nop 0
v_cvt_pk_bf16_f32 v34, v36, v37
v_cvt_pk_bf16_f32 v35, v38, v39
s_nop 1
v_mfma_f32_16x16x32_bf16 v[36:39], v[32:35], v[20:23], 0
s_waitcnt vmcnt(6)
buffer_load_dwordx4 v[68:71], v0, s[4:7], s61 offen offset:1024
v_and_b32 v34, 0xffffff7f, v0
v_and_or_b32 v34, v1, 8, v34
s_waitcnt lgkmcnt(1)
v_mfma_f32_16x16x32_bf16 v[48:51], v[48:51], v[24:27], 0
v_cvt_pk_bf16_f32 v32, v36, v37
s_waitcnt lgkmcnt(0)
v_mfma_f32_16x16x32_bf16 v[48:51], v[52:55], v[28:31], v[48:51]
v_mov_b64 v[52:53], s[56:57]
v_cvt_pk_bf16_f32 v33, v38, v39
v_smfmac_f32_16x16x64_bf16 v[44:47], v[4:7], v[152:159], v1
ds_write_b64 v34, v[32:33] offset:2176
v_permlane32_swap_b32 v48, v50
v_permlane32_swap_b32 v49, v51
v_add_f32_dpp v52, v50, v48 row_ror:8 row_mask:0xf bank_mask:0x3
v_exp_f32 v52, v52
v_add_f32_dpp v53, v51, v49 row_ror:8 row_mask:0xf bank_mask:0x3
v_exp_f32 v53, v53
s_nop 0
v_cvt_pk_bf16_f32 v48, v52, v53
v_smfmac_f32_16x16x64_bf16 v[44:47], v[16:19], v[120:127], v1
ds_write_b32 v0, v48 offset:4100
v_smfmac_f32_16x16x64_bf16 v[44:47], v[12:15], v[168:175], v1
buffer_load_dwordx4 v[48:51], v0, s[4:7], s61 offen offset:2048
v_smfmac_f32_16x16x64_bf16 v[40:43], v[12:15], v[160:167], v1
s_waitcnt lgkmcnt(1)
v_xor_b32 v12, 0x80, v0
v_smfmac_f32_16x16x64_bf16 v[40:43], v[8:11], v[128:135], v1
s_waitcnt lgkmcnt(0)
s_barrier
ds_read_b128 v[32:35], v0 offset:2048
v_mov_b64 v[22:23], s[52:53]
v_smfmac_f32_16x16x64_bf16 v[40:43], v[16:19], v[112:119], v1
ds_read_b128 v[36:39], v0 offset:3072
ds_read_b128 v[16:19], v0 offset:4096
buffer_load_dwordx4 v[52:55], v0, s[4:7], s61 offen offset:3072
v_smfmac_f32_16x16x64_bf16 v[44:47], v[8:11], v[136:143], v1
ds_read_b128 v[12:15], v12 offset:4096
v_cvt_pk_bf16_f32 v40, v40, v41
v_mov_b64 v[20:21], s[52:53]
s_waitcnt lgkmcnt(3)
v_mfma_f32_16x16x32_bf16 v[24:27], v[32:35], v[24:27], 0
v_cvt_pk_bf16_f32 v41, v42, v43
s_waitcnt lgkmcnt(2)
v_mfma_f32_16x16x32_bf16 v[24:27], v[36:39], v[28:31], v[24:27]
s_waitcnt vmcnt(5)
s_waitcnt lgkmcnt(1)
v_mfma_f32_16x16x32_bf16 v[8:11], v[56:59], v[16:19], 0
buffer_load_dwordx4 v[56:59], v0, s[4:7], s62 offen offset:0
v_mov_b64 v[28:29], s[56:57]
v_cvt_pk_bf16_f32 v43, v46, v47
v_cvt_pk_bf16_f32 v42, v44, v45
v_permlane32_swap_b32 v25, v27
v_permlane32_swap_b32 v24, v26
v_mfma_f32_16x16x32_bf16 v[4:7], v[20:23], v[16:19], 0
s_waitcnt lgkmcnt(0)
v_add_f32_dpp v28, v26, v24 row_ror:8 row_mask:0xf bank_mask:0x3
v_add_f32_dpp v29, v27, v25 row_ror:8 row_mask:0xf bank_mask:0x3
v_exp_f32 v28, v28
v_mfma_f32_16x16x32_bf16 v[8:11], v[60:63], v[12:15], v[8:11]
buffer_load_dwordx4 v[60:63], v0, s[4:7], s62 offen offset:1024
v_exp_f32 v29, v29
v_permlane32_swap_b32 v42, v43
v_cvt_pk_bf16_f32 v24, v28, v29
v_mov_b64 v[44:45], s[54:55]
v_cvt_pk_bf16_f32 v25, v28, v29
v_mov_b32_dpp v26, v24 row_ror:8 row_mask:0xf bank_mask:0xf
v_mov_b32_dpp v27, v24 row_ror:8 row_mask:0xf bank_mask:0xf
v_mfma_f32_16x16x16_bf16 v[4:7], v[44:45], v[24:25], v[4:7]
v_permlane32_swap_b32 v40, v41
v_mov_b64 v[36:37], 0
v_mov_b64 v[38:39], 0
v_mov_b64 v[30:31], 0
v_mfma_f32_16x16x32_bf16 v[8:11], v[40:43], v[24:27], v[8:11]
buffer_load_dwordx4 v[16:19], v0, s[4:7], s62 offen offset:2048
v_rcp_f32 v6, v4
v_and_b32 v12, 0xffffff7f, v0
v_and_or_b32 v13, v1, 8, v12
v_rcp_f32_dpp v6, v4 row_ror:8 row_mask:0xf bank_mask:0xc
v_mov_b64 v[26:27], 0
v_pk_mul_f32 v[8:9], v[8:9], v[6:7] op_sel_hi:[1,0]
v_cvt_pk_bf16_f32 v44, v8, v9
v_pk_mul_f32 v[10:11], v[10:11], v[6:7] op_sel_hi:[1,0]
v_cvt_pk_bf16_f32 v45, v10, v11
s_waitcnt vmcnt(5)
ds_write_b64 v13, v[44:45] offset:6272
buffer_load_dwordx4 v[20:23], v0, s[4:7], s62 offen offset:3072
v_add_u32 v6, 0xd4800000, v6
v_cmp_lt_u32 vcc, 0x28000000, v6
v_mov_b64 v[34:35], 0
v_mov_b32_dpp v46, v44 row_ror:8 row_mask:0xf bank_mask:0xf
v_mov_b32_dpp v47, v45 row_ror:8 row_mask:0xf bank_mask:0xf
v_mov_b64 v[28:29], 0
v_mov_b64 v[32:33], 0
s_cbranch_vccnz k_slow_189
k_okS_190:
v_smfmac_f32_16x16x64_bf16 v[36:39], v[44:47], v[224:231], v1
s_waitcnt lgkmcnt(0)
s_barrier
ds_read_b128 v[8:11], v12 offset:7296
v_smfmac_f32_16x16x64_bf16 v[32:35], v[44:47], v[200:207], v1
s_waitcnt vmcnt(4)
ds_read_b128 v[4:7], v12 offset:7168
v_mov_b64 v[24:25], 0
v_smfmac_f32_16x16x64_bf16 v[28:31], v[44:47], v[48:55], v1
ds_read_b128 v[12:15], v12 offset:6144
ds_read_b128 v[48:51], v2 offset:28672
v_smfmac_f32_16x16x64_bf16 v[24:27], v[44:47], v[64:71], v1
ds_read_b128 v[52:55], v2 offset:29696
v_mov_b64 v[42:43], 0
s_waitcnt lgkmcnt(4)
v_smfmac_f32_16x16x64_bf16 v[24:27], v[8:11], v[184:191], v1
s_waitcnt lgkmcnt(3)
v_mov_b64 v[40:41], 0
v_smfmac_f32_16x16x64_bf16 v[24:27], v[4:7], v[176:183], v1
s_waitcnt lgkmcnt(2)
ds_read_b128 v[64:67], v2 offset:63488
v_smfmac_f32_16x16x64_bf16 v[24:27], v[12:15], v[192:199], v1
ds_read_b128 v[68:71], v2 offset:64512
v_smfmac_f32_16x16x64_bf16 v[40:43], v[44:47], v[240:247], v1
s_waitcnt vmcnt(2)
s_waitcnt lgkmcnt(2)
v_lshrrev_b32 v44, 16, v1
v_cvt_pk_bf16_f32 v24, v24, v25
v_bfi_b32 v24, 1, s45, v24
v_cvt_pk_bf16_f32 v25, v26, v27
v_smfmac_f32_16x16x64_bf16 v[28:31], v[8:11], v[48:55], v1
buffer_store_dwordx2 v[24:25], v44, s[4:7], s38 offen
ds_read_b128 v[48:51], v2 offset:34816
ds_read_b128 v[52:55], v2 offset:35840
v_smfmac_f32_16x16x64_bf16 v[28:31], v[12:15], v[56:63], v1
s_waitcnt lgkmcnt(2)
ds_read_b128 v[56:59], v2 offset:59392
v_smfmac_f32_16x16x64_bf16 v[28:31], v[4:7], v[64:71], v1
ds_read_b128 v[60:63], v2 offset:60416
v_smfmac_f32_16x16x64_bf16 v[32:35], v[8:11], v[208:215], v1
ds_read_b128 v[64:67], v2 offset:32768
s_nop 0
v_cvt_pk_bf16_f32 v28, v28, v29
v_bfi_b32 v28, 1, s45, v28
v_cvt_pk_bf16_f32 v29, v30, v31
v_smfmac_f32_16x16x64_bf16 v[32:35], v[12:15], v[216:223], v1
buffer_store_dwordx2 v[28:29], v44, s[4:7], s39 offen
v_smfmac_f32_16x16x64_bf16 v[40:43], v[12:15], v[248:255], v1
ds_read_b128 v[68:71], v2 offset:33792
s_waitcnt vmcnt(2)
v_smfmac_f32_16x16x64_bf16 v[32:35], v[4:7], v[16:23], v1
s_waitcnt lgkmcnt(2)
v_smfmac_f32_16x16x64_bf16 v[36:39], v[12:15], v[232:239], v1
ds_read_b128 v[16:19], v2 offset:61440
ds_read_b128 v[20:23], v2 offset:62464
v_cvt_pk_bf16_f32 v32, v32, v33
v_bfi_b32 v32, 1, s45, v32
v_cvt_pk_bf16_f32 v33, v34, v35
v_smfmac_f32_16x16x64_bf16 v[36:39], v[8:11], v[48:55], v1
buffer_store_dwordx2 v[32:33], v44, s[4:7], s40 offen
s_waitcnt lgkmcnt(2)
v_smfmac_f32_16x16x64_bf16 v[36:39], v[4:7], v[64:71], v1
s_nop 6
v_cvt_pk_bf16_f32 v36, v36, v37
v_cvt_pk_bf16_f32 v37, v38, v39
s_waitcnt lgkmcnt(0)
v_bfi_b32 v36, 1, s45, v36
v_smfmac_f32_16x16x64_bf16 v[40:43], v[8:11], v[16:23], v1
buffer_store_dwordx2 v[36:37], v44, s[4:7], s41 offen
v_smfmac_f32_16x16x64_bf16 v[40:43], v[4:7], v[56:63], v1
s_nop 6
v_cvt_pk_bf16_f32 v40, v40, v41
v_bfi_b32 v40, 1, s45, v40
v_cvt_pk_bf16_f32 v41, v42, v43
buffer_store_dwordx2 v[40:41], v44, s[4:7], s42 offen
s_barrier
buffer_load_dwordx4 v[24:27], v0, s[4:7], s43 offen offset:0 sc1
buffer_load_dwordx4 v[28:31], v0, s[4:7], s43 offen offset:1024 sc1
buffer_load_dwordx4 v[32:35], v0, s[4:7], s43 offen offset:2048 sc1
buffer_load_dwordx4 v[36:39], v0, s[4:7], s43 offen offset:3072 sc1
buffer_load_dwordx4 v[48:51], v0, s[4:7], s60 offen offset:0
buffer_load_dwordx4 v[52:55], v0, s[4:7], s60 offen offset:1024
buffer_load_dwordx4 v[56:59], v0, s[4:7], s60 offen offset:2048
buffer_load_dwordx4 v[60:63], v0, s[4:7], s60 offen offset:3072
v_lshlrev_b32 v23, v0, s58
v_cndmask_b32 v16, 0, v23, s[12:13]
v_cndmask_b32 v17, 0, v23, s[14:15]
v_cndmask_b32 v18, 0, v23, s[16:17]
v_cndmask_b32 v19, 0, v23, s[18:19]
v_and_b32 v45, 0x30, v0
v_lshrrev_b32 v46, 8, v0
v_lshl_or_b32 v45, v46, 2, v45
v_bfe_u32 v46, v0, 6, 1
v_lshl_or_b32 v45, v46, 7, v45
v_cndmask_b32 v45, v45, 2.0, s[98:99]
v_cndmask_b32 v20, 0, v23, s[90:91]
v_cndmask_b32 v21, 0, v23, s[92:93]
v_cndmask_b32 v22, 0, v23, s[94:95]
v_cndmask_b32 v23, 0, v23, s[96:97]
s_add_u32 s33, s33, 16384
s_bitset0_b32 s33, 16
s_waitcnt vmcnt(7)
v_mfma_f32_16x16x32_bf16 v[40:43], v[24:27], v[16:19], 0
s_waitcnt vmcnt(6)
v_mfma_f32_16x16x32_bf16 v[40:43], v[28:31], v[16:19], v[40:43]
v_bitop3_b32 v46, v24, v28, s45 bitop3:0x7e
s_waitcnt vmcnt(5)
v_mfma_f32_16x16x32_bf16 v[40:43], v[32:35], v[16:19], v[40:43]
s_waitcnt vmcnt(4)
v_mfma_f32_16x16x32_bf16 v[40:43], v[36:39], v[16:19], v[40:43]
v_bitop3_b32 v47, v32, v36, s45 bitop3:0x7e
v_bitop3_b32 v46, v46, v47, 1 bitop3:0xa8
v_cmp_ne_u32 vcc, 0, v46
v_mov_b64 v[24:25], 0
v_mov_b64 v[26:27], 0
v_mov_b64 v[28:29], 0
v_mov_b64 v[30:31], 0
v_permlane32_swap_b32 v40, v41
v_permlane32_swap_b32 v42, v43
v_add_f32 v40, v40, v41
v_add_f32 v41, v42, v43
v_cvt_pk_bf16_f32 v42, v40, v41
s_cbranch_vccnz k_r1_192
k_ok1_193:
buffer_store_dword v42, v45, s[4:7], s44 offen
s_barrier
buffer_load_dwordx4 v[4:7], v0, s[4:7], s33 offen offset:1024 sc1
buffer_load_dwordx4 v[8:11], v0, s[4:7], s33 offen offset:0 sc1
s_add_u32 s34, s33, 3072
s_add_u32 s35, s33, 7168
s_add_u32 s36, s36, 524288
s_add_u32 s37, s37, 10240
s_add_u32 s59, s59, 10240
v_mov_b64 v[32:33], 0
v_mov_b64 v[34:35], 0
v_mov_b64 v[36:37], 0
v_mov_b64 v[38:39], 0
v_mov_b64 v[40:41], 0
v_mov_b64 v[42:43], 0
v_mov_b64 v[44:45], 0
v_mov_b64 v[46:47], 0
s_add_u32 s44, s44, 16384
s_bitset0_b32 s44, 16
s_sub_u32 s45, s45, 1
s_add_u32 s31, s31, 1
ds_read_b128 v[64:67], v0 offset:24576
ds_read_b128 v[68:71], v0 offset:25600
buffer_load_dwordx4 v[12:15], v0, s[4:7], s34 offen offset:0 sc1
s_cmp_lg_u32 s31, s47
s_cbranch_scc1 k_T0_181
s_branch k_done_191
k_cold2_183:
s_barrier
buffer_load_dwordx4 v[48:51], v0, s[4:7], s60 offen offset:0
buffer_load_dwordx4 v[52:55], v0, s[4:7], s60 offen offset:1024
buffer_load_dwordx4 v[56:59], v0, s[4:7], s60 offen offset:2048
buffer_load_dwordx4 v[60:63], v0, s[4:7], s60 offen offset:3072
ds_read_b128 v[64:67], v0 offset:24576
ds_read_b128 v[68:71], v0 offset:25600
k_cold_182:
buffer_load_dwordx4 v[4:7], v0, s[4:7], s33 offen offset:1024 sc1
buffer_load_dwordx4 v[8:11], v0, s[4:7], s33 offen offset:0 sc1
buffer_load_dwordx4 v[12:15], v0, s[4:7], s34 offen offset:0 sc1
s_sub_u32 s32, s32, 1
s_cmp_gt_i32 s32, 0
s_cbranch_scc0 k_okC_184
v_mov_b64 v[24:25], 0
v_mov_b64 v[26:27], 0
v_mov_b64 v[28:29], 0
v_mov_b64 v[30:31], 0
v_mov_b64 v[32:33], 0
v_mov_b64 v[34:35], 0
v_mov_b64 v[36:37], 0
v_mov_b64 v[38:39], 0
v_mov_b64 v[40:41], 0
v_mov_b64 v[42:43], 0
v_mov_b64 v[44:45], 0
v_mov_b64 v[46:47], 0
s_branch k_T0_181
k_coldA_185:
buffer_load_dwordx4 v[12:15], v0, s[4:7], s34 offen offset:0 sc1
s_sub_u32 s32, s32, 1
s_cmp_gt_i32 s32, 0
s_waitcnt vmcnt(0)
v_cmp_u_f32 vcc, v12, v12
ds_write_b128 v0, v[12:15] offset:1024
s_waitcnt lgkmcnt(0)
s_cbranch_vccz k_okA_186
s_cbranch_scc1 k_coldA_185
s_branch k_okA_186
k_coldB_187:
buffer_load_dwordx4 v[16:19], v0, s[4:7], s35 offen offset:0 sc1
s_sub_u32 s32, s32, 1
s_cmp_gt_i32 s32, 0
s_waitcnt vmcnt(0)
v_cmp_u_f32 vcc, v16, v16
ds_write_b128 v0, v[16:19] offset:5120
s_waitcnt lgkmcnt(0)
s_cbranch_vccz k_okB_188
s_cbranch_scc1 k_coldB_187
s_branch k_okB_188
k_r1_192:
buffer_load_dwordx4 v[24:27], v0, s[4:7], s43 offen offset:0 sc1
buffer_load_dwordx4 v[28:31], v0, s[4:7], s43 offen offset:1024 sc1
buffer_load_dwordx4 v[32:35], v0, s[4:7], s43 offen offset:2048 sc1
buffer_load_dwordx4 v[36:39], v0, s[4:7], s43 offen offset:3072 sc1
s_sub_u32 s32, s32, 1
s_cmp_gt_i32 s32, 0
s_waitcnt vmcnt(3)
v_mfma_f32_16x16x32_bf16 v[40:43], v[24:27], v[16:19], 0
s_waitcnt vmcnt(2)
v_mfma_f32_16x16x32_bf16 v[40:43], v[28:31], v[16:19], v[40:43]
v_bitop3_b32 v46, v24, v28, s45 bitop3:0x7e
s_waitcnt vmcnt(1)
v_mfma_f32_16x16x32_bf16 v[40:43], v[32:35], v[16:19], v[40:43]
s_waitcnt vmcnt(0)
v_mfma_f32_16x16x32_bf16 v[40:43], v[36:39], v[16:19], v[40:43]
v_bitop3_b32 v47, v32, v36, s45 bitop3:0x7e
v_bitop3_b32 v46, v46, v47, 1 bitop3:0xa8
v_cmp_ne_u32 vcc, 0, v46
v_mov_b64 v[24:25], 0
v_mov_b64 v[26:27], 0
v_mov_b64 v[28:29], 0
v_mov_b64 v[30:31], 0
v_permlane32_swap_b32 v40, v41
v_permlane32_swap_b32 v42, v43
v_add_f32 v40, v40, v41
v_add_f32 v41, v42, v43
v_cvt_pk_bf16_f32 v42, v40, v41
s_cbranch_vccz k_ok1_193
s_cbranch_scc1 k_r1_192
s_branch k_ok1_193
k_slow_189:
ds_read_b128 v[24:27], v0 offset:0
ds_read_b128 v[28:31], v0 offset:1024
v_mov_b32 v46, 0xff7fffff
s_add_u32 s48, s36, 0xfffff000
buffer_load_dwordx4 v[32:35], v0, s[4:7], s48 offen offset:0 sc1
buffer_load_dwordx4 v[36:39], v0, s[4:7], s48 offen offset:1024 sc1
s_waitcnt vmcnt(1) lgkmcnt(1)
v_mfma_f32_16x16x32_bf16 v[4:7], v[32:35], v[24:27], 0
s_waitcnt vmcnt(0) lgkmcnt(0)
v_mfma_f32_16x16x32_bf16 v[4:7], v[36:39], v[28:31], v[4:7]
v_mov_b64 v[8:9], s[56:57]
s_nop 5
v_permlane32_swap_b32 v4, v6
v_permlane32_swap_b32 v5, v7
v_add_f32_dpp v8, v6, v4 row_ror:8 row_mask:0xf bank_mask:0x3
s_nop 0
v_add_f32_dpp v9, v7, v5 row_ror:8 row_mask:0xf bank_mask:0x3
v_max3_f32 v46, v46, v8, v9
s_add_u32 s48, s36, 0x0
buffer_load_dwordx4 v[32:35], v0, s[4:7], s48 offen offset:0 sc1
buffer_load_dwordx4 v[36:39], v0, s[4:7], s48 offen offset:1024 sc1
s_waitcnt vmcnt(1)
v_mfma_f32_16x16x32_bf16 v[4:7], v[32:35], v[24:27], 0
s_waitcnt vmcnt(0)
v_mfma_f32_16x16x32_bf16 v[4:7], v[36:39], v[28:31], v[4:7]
v_mov_b64 v[10:11], s[56:57]
s_nop 5
v_permlane32_swap_b32 v4, v6
v_permlane32_swap_b32 v5, v7
v_add_f32_dpp v10, v6, v4 row_ror:8 row_mask:0xf bank_mask:0x3
s_nop 0
v_add_f32_dpp v11, v7, v5 row_ror:8 row_mask:0xf bank_mask:0x3
v_max3_f32 v46, v46, v10, v11
s_add_u32 s48, s36, 0x1000
buffer_load_dwordx4 v[32:35], v0, s[4:7], s48 offen offset:0 sc1
buffer_load_dwordx4 v[36:39], v0, s[4:7], s48 offen offset:1024 sc1
s_waitcnt vmcnt(1)
v_mfma_f32_16x16x32_bf16 v[4:7], v[32:35], v[24:27], 0
s_waitcnt vmcnt(0)
v_mfma_f32_16x16x32_bf16 v[4:7], v[36:39], v[28:31], v[4:7]
v_mov_b64 v[12:13], s[56:57]
s_nop 5
v_permlane32_swap_b32 v4, v6
v_permlane32_swap_b32 v5, v7
v_add_f32_dpp v12, v6, v4 row_ror:8 row_mask:0xf bank_mask:0x3
s_nop 0
v_add_f32_dpp v13, v7, v5 row_ror:8 row_mask:0xf bank_mask:0x3
v_max3_f32 v46, v46, v12, v13
s_add_u32 s48, s36, 0x2000
buffer_load_dwordx4 v[32:35], v0, s[4:7], s48 offen offset:0 sc1
buffer_load_dwordx4 v[36:39], v0, s[4:7], s48 offen offset:1024 sc1
s_waitcnt vmcnt(1)
v_mfma_f32_16x16x32_bf16 v[4:7], v[32:35], v[24:27], 0
s_waitcnt vmcnt(0)
v_mfma_f32_16x16x32_bf16 v[4:7], v[36:39], v[28:31], v[4:7]
v_mov_b64 v[14:15], s[56:57]
s_nop 5
v_permlane32_swap_b32 v4, v6
v_permlane32_swap_b32 v5, v7
v_add_f32_dpp v14, v6, v4 row_ror:8 row_mask:0xf bank_mask:0x3
s_nop 0
v_add_f32_dpp v15, v7, v5 row_ror:8 row_mask:0xf bank_mask:0x3
v_max3_f32 v46, v46, v14, v15
ds_read_b128 v[32:35], v0 offset:2048
ds_read_b128 v[36:39], v0 offset:3072
s_waitcnt lgkmcnt(1)
v_mfma_f32_16x16x32_bf16 v[4:7], v[32:35], v[24:27], 0
s_waitcnt lgkmcnt(0)
v_mfma_f32_16x16x32_bf16 v[4:7], v[36:39], v[28:31], v[4:7]
v_mov_b64 v[44:45], s[56:57]
s_nop 5
v_permlane32_swap_b32 v4, v6
v_permlane32_swap_b32 v5, v7
v_add_f32_dpp v44, v6, v4 row_ror:8 row_mask:0xf bank_mask:0x3
s_nop 0
v_add_f32_dpp v45, v7, v5 row_ror:8 row_mask:0xf bank_mask:0x3
v_max3_f32 v46, v46, v44, v45
buffer_load_dwordx4 v[32:35], v0, s[4:7], s36 offen offset:2048 sc1
buffer_load_dwordx4 v[36:39], v0, s[4:7], s36 offen offset:3072 sc1
v_mov_b32 v47, v46
s_nop 1
v_permlane32_swap_b32 v46, v47
v_max_f32 v46, v46, v47
v_mov_b32 v47, v46
s_nop 1
v_permlane16_swap_b32 v46, v47
v_max_f32 v46, v46, v47
v_sub_f32 v8, v8, v46
v_exp_f32 v8, v8
v_sub_f32 v9, v9, v46
v_exp_f32 v9, v9
v_sub_f32 v10, v10, v46
v_exp_f32 v10, v10
v_sub_f32 v11, v11, v46
v_exp_f32 v11, v11
v_sub_f32 v12, v12, v46
v_exp_f32 v12, v12
v_sub_f32 v13, v13, v46
v_exp_f32 v13, v13
v_sub_f32 v14, v14, v46
v_exp_f32 v14, v14
v_sub_f32 v15, v15, v46
v_exp_f32 v15, v15
v_sub_f32 v44, v44, v46
v_exp_f32 v44, v44
v_sub_f32 v45, v45, v46
v_exp_f32 v45, v45
v_cvt_pk_bf16_f32 v4, v8, v9
v_cvt_pk_bf16_f32 v5, v10, v11
v_cvt_pk_bf16_f32 v6, v12, v13
v_cvt_pk_bf16_f32 v7, v14, v15
v_mov_b32_dpp v8, v4 row_ror:8 row_mask:0xf bank_mask:0xf
v_mov_b32_dpp v9, v5 row_ror:8 row_mask:0xf bank_mask:0xf
v_mov_b32_dpp v10, v6 row_ror:8 row_mask:0xf bank_mask:0xf
v_mov_b32_dpp v11, v7 row_ror:8 row_mask:0xf bank_mask:0xf
v_cvt_pk_bf16_f32 v24, v44, v45
v_cvt_pk_bf16_f32 v25, v44, v45
s_nop 0
v_mov_b32_dpp v26, v24 row_ror:8 row_mask:0xf bank_mask:0xf
v_mov_b32_dpp v27, v24 row_ror:8 row_mask:0xf bank_mask:0xf
v_mov_b64 v[28:29], s[52:53]
v_mov_b64 v[30:31], s[52:53]
s_nop 1
v_mfma_f32_16x16x32_bf16 v[44:47], v[28:31], v[4:7], 0
s_waitcnt vmcnt(1)
v_mfma_f32_16x16x32_bf16 v[12:15], v[32:35], v[4:7], 0
s_waitcnt vmcnt(0)
v_mfma_f32_16x16x32_bf16 v[12:15], v[36:39], v[8:11], v[12:15]
v_mfma_f32_16x16x32_bf16 v[12:15], v[40:43], v[24:27], v[12:15]
v_mov_b64 v[28:29], s[54:55]
s_nop 1
v_mfma_f32_16x16x16_bf16 v[44:47], v[28:29], v[24:25], v[44:47]
s_nop 6
v_rcp_f32 v4, v44
s_nop 1
v_rcp_f32_dpp v4, v44 row_ror:8 row_mask:0xf bank_mask:0xc
s_nop 0
v_mul_f32 v12, v4, v12
v_mul_f32 v13, v4, v13
v_mul_f32 v14, v4, v14
v_mul_f32 v15, v4, v15
v_cvt_pk_bf16_f32 v44, v12, v13
v_cvt_pk_bf16_f32 v45, v14, v15
v_and_b32 v12, 0xffffff7f, v0
v_and_or_b32 v8, v1, 8, v12
ds_write_b64 v8, v[44:45] offset:6272
v_mov_b32_dpp v46, v44 row_ror:8 row_mask:0xf bank_mask:0xf
v_mov_b32_dpp v47, v45 row_ror:8 row_mask:0xf bank_mask:0xf
v_mov_b64 v[24:25], 0
v_mov_b64 v[26:27], 0
v_mov_b64 v[28:29], 0
v_mov_b64 v[30:31], 0
v_mov_b64 v[32:33], 0
v_mov_b64 v[34:35], 0
v_mov_b64 v[36:37], 0
v_mov_b64 v[38:39], 0
s_waitcnt lgkmcnt(0)
s_branch k_okS_190
k_done_191:
buffer_load_dwordx4 v[16:19], v0, s[4:7], s35 offen offset:0 sc1
k_xs_197:
s_waitcnt vmcnt(1)
v_cmp_u_f32 vcc, v4, v12
s_waitcnt vmcnt(0)
v_cmp_u_f32 s[66:67], v16, v16
s_or_b64 vcc, vcc, s[66:67]
s_cbranch_vccz k_xd_198
buffer_load_dwordx4 v[4:7], v0, s[4:7], s33 offen offset:1024 sc1
buffer_load_dwordx4 v[8:11], v0, s[4:7], s33 offen offset:0 sc1
buffer_load_dwordx4 v[12:15], v0, s[4:7], s34 offen offset:0 sc1
buffer_load_dwordx4 v[16:19], v0, s[4:7], s35 offen offset:0 sc1
s_sub_u32 s32, s32, 1
s_cmp_gt_i32 s32, 0
s_cbranch_scc1 k_xs_197
k_xd_198:
s_waitcnt vmcnt(3)
buffer_store_dwordx4 v[4:7], v0, s[8:11], s37 offen offset:0 sc1
s_waitcnt vmcnt(2)
buffer_store_dwordx4 v[12:15], v0, s[8:11], s37 offen offset:2048 sc1
s_waitcnt vmcnt(2)
buffer_store_dwordx4 v[16:19], v0, s[8:11], s59 offen offset:2048 sc1
s_add_u32 s31, s31, 1
s_branch k_jn_180
k_far_179:
s_branch k_cold2_201
k_T0_199:
s_waitcnt vmcnt(2)
v_smfmac_f32_16x16x64_bf16 v[40:43], v[4:7], v[48:55], v1
s_waitcnt vmcnt(1)
v_cmp_u_f32 vcc, v4, v8
v_smfmac_f32_16x16x64_bf16 v[24:27], v[8:11], a[24:31], v1
v_smfmac_f32_16x16x64_bf16 v[28:31], v[8:11], a[32:39], v1
s_cbranch_vccnz k_cold_200
k_okC_202:
s_waitcnt vmcnt(1)
v_smfmac_f32_16x16x64_bf16 v[36:39], v[8:11], a[40:47], v1
s_waitcnt lgkmcnt(0)
ds_read_b128 v[48:51], v0 offset:34816
v_smfmac_f32_16x16x64_bf16 v[32:35], v[4:7], v[64:71], v1
ds_read_b128 v[52:55], v0 offset:35840
ds_read_b128 v[64:67], v0 offset:22528
v_smfmac_f32_16x16x64_bf16 v[44:47], v[4:7], v[56:63], v1
ds_read_b128 v[68:71], v0 offset:23552
v_smfmac_f32_16x16x64_bf16 v[28:31], v[4:7], a[8:15], v1
v_smfmac_f32_16x16x64_bf16 v[24:27], v[4:7], a[0:7], v1
ds_read_b128 v[56:59], v2 offset:30720
v_smfmac_f32_16x16x64_bf16 v[36:39], v[4:7], a[16:23], v1
ds_read_b128 v[60:63], v2 offset:31744
s_waitcnt lgkmcnt(4)
v_smfmac_f32_16x16x64_bf16 v[40:43], v[8:11], v[48:55], v1
s_waitcnt vmcnt(0)
ds_write_b128 v0, v[12:15] offset:1024
s_waitcnt lgkmcnt(3)
v_smfmac_f32_16x16x64_bf16 v[32:35], v[8:11], v[64:71], v1
buffer_load_dwordx4 v[16:19], v0, s[4:7], s35 offen offset:0 sc1
v_cmp_u_f32 vcc, v12, v12
s_waitcnt lgkmcnt(1)
v_smfmac_f32_16x16x64_bf16 v[44:47], v[8:11], v[56:63], v1
ds_read_b128 v[56:59], v2 offset:53248
ds_read_b128 v[60:63], v2 offset:54272
ds_read_b128 v[64:67], v0 offset:28672
s_cbranch_vccnz k_coldA_203
k_okA_204:
v_smfmac_f32_16x16x64_bf16 v[36:39], v[12:15], a[64:71], v1
ds_read_b128 v[68:71], v0 offset:29696
s_waitcnt lgkmcnt(4)
v_smfmac_f32_16x16x64_bf16 v[40:43], v[12:15], a[72:79], v1
s_barrier
v_smfmac_f32_16x16x64_bf16 v[28:31], v[12:15], a[56:63], v1
ds_read_b128 v[8:11], v0 offset:2048
buffer_load_dwordx4 v[48:51], v0, s[4:7], s36 offen offset:0 sc1
s_waitcnt lgkmcnt(3)
v_smfmac_f32_16x16x64_bf16 v[44:47], v[12:15], v[56:63], v1
ds_read_b128 v[56:59], v2 offset:55296
v_smfmac_f32_16x16x64_bf16 v[24:27], v[12:15], a[48:55], v1
ds_read_b128 v[60:63], v2 offset:56320
s_waitcnt lgkmcnt(3)
v_smfmac_f32_16x16x64_bf16 v[32:35], v[12:15], v[64:71], v1
buffer_load_dwordx4 v[52:55], v0, s[4:7], s36 offen offset:1024 sc1
s_waitcnt lgkmcnt(2)
v_smfmac_f32_16x16x64_bf16 v[24:27], v[8:11], a[80:87], v1
ds_read_b128 v[64:67], v0 offset:30720
ds_read_b128 v[68:71], v0 offset:31744
v_smfmac_f32_16x16x64_bf16 v[36:39], v[8:11], a[96:103], v1
buffer_store_dwordx4 v[4:7], v0, s[8:11], s37 offen offset:0 sc1
s_waitcnt lgkmcnt(2)
s_nop 0
ds_read_b128 v[4:7], v0 offset:3072
v_smfmac_f32_16x16x64_bf16 v[44:47], v[8:11], v[56:63], v1
ds_read_b128 v[56:59], v2 offset:57344
ds_read_b128 v[60:63], v2 offset:58368
v_smfmac_f32_16x16x64_bf16 v[28:31], v[8:11], a[88:95], v1
buffer_store_dwordx4 v[12:15], v0, s[8:11], s37 offen offset:2048 sc1
v_smfmac_f32_16x16x64_bf16 v[40:43], v[8:11], a[104:111], v1
s_waitcnt lgkmcnt(3)
s_waitcnt lgkmcnt(2)
v_smfmac_f32_16x16x64_bf16 v[32:35], v[8:11], v[64:71], v1
ds_read_b128 v[64:67], v0 offset:32768
ds_read_b128 v[12:15], v0 offset:0
v_smfmac_f32_16x16x64_bf16 v[36:39], v[4:7], a[128:135], v1
s_waitcnt lgkmcnt(2)
v_smfmac_f32_16x16x64_bf16 v[44:47], v[4:7], v[56:63], v1
ds_read_b128 v[68:71], v0 offset:33792
buffer_load_dwordx4 v[56:59], v0, s[4:7], s36 offen offset:2048 sc1
v_smfmac_f32_16x16x64_bf16 v[28:31], v[4:7], a[120:127], v1
v_smfmac_f32_16x16x64_bf16 v[24:27], v[4:7], a[112:119], v1
s_waitcnt vmcnt(5)
ds_write_b128 v0, v[16:19] offset:5120
v_smfmac_f32_16x16x64_bf16 v[40:43], v[4:7], a[136:143], v1
s_waitcnt lgkmcnt(1)
buffer_load_dwordx4 v[60:63], v0, s[4:7], s36 offen offset:3072 sc1
v_cmp_u_f32 vcc, v16, v16
v_smfmac_f32_16x16x64_bf16 v[32:35], v[4:7], v[64:71], v1
ds_read_b128 v[64:67], v0 offset:26624
ds_read_b128 v[68:71], v0 offset:27648
v_smfmac_f32_16x16x64_bf16 v[28:31], v[12:15], a[152:159], v1
v_smfmac_f32_16x16x64_bf16 v[24:27], v[12:15], a[144:151], v1
s_cbranch_vccnz k_coldB_205
k_okB_206:
v_smfmac_f32_16x16x64_bf16 v[36:39], v[12:15], a[160:167], v1
s_waitcnt lgkmcnt(2)
buffer_store_dwordx4 v[16:19], v0, s[8:11], s59 offen offset:2048 sc1
s_barrier
ds_read_b128 v[4:7], v0 offset:7168
v_smfmac_f32_16x16x64_bf16 v[44:47], v[12:15], a[176:183], v1
ds_read_b128 v[8:11], v0 offset:6144
s_waitcnt lgkmcnt(2)
v_smfmac_f32_16x16x64_bf16 v[32:35], v[12:15], v[64:71], v1
ds_read_b128 v[64:67], v2 offset:36864
ds_read_b128 v[68:71], v2 offset:37888
v_smfmac_f32_16x16x64_bf16 v[24:27], v[16:19], a[184:191], v1
v_smfmac_f32_16x16x64_bf16 v[40:43], v[12:15], a[168:175], v1
s_waitcnt lgkmcnt(3)
ds_read_b128 v[12:15], v0 offset:4096
v_smfmac_f32_16x16x64_bf16 v[24:27], v[4:7], a[208:215], v1
s_waitcnt lgkmcnt(3)
v_smfmac_f32_16x16x64_bf16 v[28:31], v[4:7], a[216:223], v1
v_smfmac_f32_16x16x64_bf16 v[28:31], v[8:11], a[200:207], v1
s_waitcnt lgkmcnt(1)
v_smfmac_f32_16x16x64_bf16 v[24:27], v[8:11], v[64:71], v1
ds_read_b128 v[64:67], v2 offset:38912
s_waitcnt lgkmcnt(1)
v_smfmac_f32_16x16x64_bf16 v[24:27], v[12:15], a[224:231], v1
ds_read_b128 v[68:71], v2 offset:39936
v_smfmac_f32_16x16x64_bf16 v[28:31], v[12:15], a[232:239], v1
v_smfmac_f32_16x16x64_bf16 v[28:31], v[16:19], a[192:199], v1
v_cvt_pk_bf16_f32 v24, v24, v25
v_cvt_pk_bf16_f32 v25, v26, v27
v_smfmac_f32_16x16x64_bf16 v[32:35], v[4:7], v[80:87], v1
v_cvt_pk_bf16_f32 v26, v28, v29
v_cvt_pk_bf16_f32 v27, v30, v31
v_smfmac_f32_16x16x64_bf16 v[32:35], v[8:11], a[248:255], v1
s_waitcnt lgkmcnt(0)
v_mfma_f32_16x16x32_bf16 v[28:31], v[24:27], v[20:23], 0
v_and_b32 v26, 0xffffff7f, v0
v_smfmac_f32_16x16x64_bf16 v[32:35], v[16:19], v[64:71], v1
v_and_or_b32 v26, v1, 8, v26
v_mul_f32 v28, s51, v28
v_mul_f32 v29, s51, v29
v_mul_f32 v31, s51, v31
v_cvt_pk_bf16_f32 v24, v28, v29
v_mul_f32 v30, s51, v30
v_cvt_pk_bf16_f32 v25, v30, v31
v_smfmac_f32_16x16x64_bf16 v[32:35], v[12:15], v[96:103], v1
ds_write_b64 v26, v[24:25] offset:128
v_smfmac_f32_16x16x64_bf16 v[36:39], v[8:11], v[72:79], v1
v_cvt_pk_bf16_f32 v32, v32, v33
v_smfmac_f32_16x16x64_bf16 v[36:39], v[16:19], a[240:247], v1
buffer_load_dwordx4 v[64:67], v0, s[4:7], s61 offen offset:0
v_cvt_pk_bf16_f32 v33, v34, v35
v_smfmac_f32_16x16x64_bf16 v[36:39], v[12:15], v[104:111], v1
s_waitcnt lgkmcnt(0)
v_smfmac_f32_16x16x64_bf16 v[36:39], v[4:7], v[88:95], v1
s_barrier
ds_read_b128 v[24:27], v0 offset:0
v_smfmac_f32_16x16x64_bf16 v[40:43], v[4:7], v[144:151], v1
ds_read_b128 v[28:31], v0 offset:1024
s_nop 0
v_cvt_pk_bf16_f32 v34, v36, v37
v_cvt_pk_bf16_f32 v35, v38, v39
s_nop 1
v_mfma_f32_16x16x32_bf16 v[36:39], v[32:35], v[20:23], 0
s_waitcnt vmcnt(6)
buffer_load_dwordx4 v[68:71], v0, s[4:7], s61 offen offset:1024
v_and_b32 v34, 0xffffff7f, v0
v_and_or_b32 v34, v1, 8, v34
s_waitcnt lgkmcnt(1)
v_mfma_f32_16x16x32_bf16 v[48:51], v[48:51], v[24:27], 0
v_cvt_pk_bf16_f32 v32, v36, v37
s_waitcnt lgkmcnt(0)
v_mfma_f32_16x16x32_bf16 v[48:51], v[52:55], v[28:31], v[48:51]
v_mov_b64 v[52:53], s[56:57]
v_cvt_pk_bf16_f32 v33, v38, v39
v_smfmac_f32_16x16x64_bf16 v[44:47], v[4:7], v[152:159], v1
ds_write_b64 v34, v[32:33] offset:2176
v_permlane32_swap_b32 v48, v50
v_permlane32_swap_b32 v49, v51
v_add_f32_dpp v52, v50, v48 row_ror:8 row_mask:0xf bank_mask:0x3
v_exp_f32 v52, v52
v_add_f32_dpp v53, v51, v49 row_ror:8 row_mask:0xf bank_mask:0x3
v_exp_f32 v53, v53
s_nop 0
v_cvt_pk_bf16_f32 v48, v52, v53
v_smfmac_f32_16x16x64_bf16 v[44:47], v[16:19], v[120:127], v1
ds_write_b32 v0, v48 offset:4100
v_smfmac_f32_16x16x64_bf16 v[44:47], v[12:15], v[168:175], v1
buffer_load_dwordx4 v[48:51], v0, s[4:7], s61 offen offset:2048
v_smfmac_f32_16x16x64_bf16 v[40:43], v[12:15], v[160:167], v1
s_waitcnt lgkmcnt(1)
v_xor_b32 v12, 0x80, v0
v_smfmac_f32_16x16x64_bf16 v[40:43], v[8:11], v[128:135], v1
s_waitcnt lgkmcnt(0)
s_barrier
ds_read_b128 v[32:35], v0 offset:2048
v_mov_b64 v[22:23], s[52:53]
v_smfmac_f32_16x16x64_bf16 v[40:43], v[16:19], v[112:119], v1
ds_read_b128 v[36:39], v0 offset:3072
ds_read_b128 v[16:19], v0 offset:4096
buffer_load_dwordx4 v[52:55], v0, s[4:7], s61 offen offset:3072
v_smfmac_f32_16x16x64_bf16 v[44:47], v[8:11], v[136:143], v1
ds_read_b128 v[12:15], v12 offset:4096
v_cvt_pk_bf16_f32 v40, v40, v41
v_mov_b64 v[20:21], s[52:53]
s_waitcnt lgkmcnt(3)
v_mfma_f32_16x16x32_bf16 v[24:27], v[32:35], v[24:27], 0
v_cvt_pk_bf16_f32 v41, v42, v43
s_waitcnt lgkmcnt(2)
v_mfma_f32_16x16x32_bf16 v[24:27], v[36:39], v[28:31], v[24:27]
s_waitcnt vmcnt(5)
s_waitcnt lgkmcnt(1)
v_mfma_f32_16x16x32_bf16 v[8:11], v[56:59], v[16:19], 0
buffer_load_dwordx4 v[56:59], v0, s[4:7], s62 offen offset:0
v_mov_b64 v[28:29], s[56:57]
v_cvt_pk_bf16_f32 v43, v46, v47
v_cvt_pk_bf16_f32 v42, v44, v45
v_permlane32_swap_b32 v25, v27
v_permlane32_swap_b32 v24, v26
v_mfma_f32_16x16x32_bf16 v[4:7], v[20:23], v[16:19], 0
s_waitcnt lgkmcnt(0)
v_add_f32_dpp v28, v26, v24 row_ror:8 row_mask:0xf bank_mask:0x3
v_add_f32_dpp v29, v27, v25 row_ror:8 row_mask:0xf bank_mask:0x3
v_exp_f32 v28, v28
v_mfma_f32_16x16x32_bf16 v[8:11], v[60:63], v[12:15], v[8:11]
buffer_load_dwordx4 v[60:63], v0, s[4:7], s62 offen offset:1024
v_exp_f32 v29, v29
v_permlane32_swap_b32 v42, v43
v_cvt_pk_bf16_f32 v24, v28, v29
v_mov_b64 v[44:45], s[54:55]
v_cvt_pk_bf16_f32 v25, v28, v29
v_mov_b32_dpp v26, v24 row_ror:8 row_mask:0xf bank_mask:0xf
v_mov_b32_dpp v27, v24 row_ror:8 row_mask:0xf bank_mask:0xf
v_mfma_f32_16x16x16_bf16 v[4:7], v[44:45], v[24:25], v[4:7]
v_permlane32_swap_b32 v40, v41
v_mov_b64 v[36:37], 0
v_mov_b64 v[38:39], 0
v_mov_b64 v[30:31], 0
v_mfma_f32_16x16x32_bf16 v[8:11], v[40:43], v[24:27], v[8:11]
buffer_load_dwordx4 v[16:19], v0, s[4:7], s62 offen offset:2048
v_rcp_f32 v6, v4
v_and_b32 v12, 0xffffff7f, v0
v_and_or_b32 v13, v1, 8, v12
v_rcp_f32_dpp v6, v4 row_ror:8 row_mask:0xf bank_mask:0xc
v_mov_b64 v[26:27], 0
v_pk_mul_f32 v[8:9], v[8:9], v[6:7] op_sel_hi:[1,0]
v_cvt_pk_bf16_f32 v44, v8, v9
v_pk_mul_f32 v[10:11], v[10:11], v[6:7] op_sel_hi:[1,0]
v_cvt_pk_bf16_f32 v45, v10, v11
s_waitcnt vmcnt(5)
ds_write_b64 v13, v[44:45] offset:6272
buffer_load_dwordx4 v[20:23], v0, s[4:7], s62 offen offset:3072
v_add_u32 v6, 0xd4800000, v6
v_cmp_lt_u32 vcc, 0x28000000, v6
v_mov_b64 v[34:35], 0
v_mov_b32_dpp v46, v44 row_ror:8 row_mask:0xf bank_mask:0xf
v_mov_b32_dpp v47, v45 row_ror:8 row_mask:0xf bank_mask:0xf
v_mov_b64 v[28:29], 0
v_mov_b64 v[32:33], 0
s_cbranch_vccnz k_slow_207
k_okS_208:
v_smfmac_f32_16x16x64_bf16 v[36:39], v[44:47], v[224:231], v1
s_waitcnt lgkmcnt(0)
s_barrier
ds_read_b128 v[8:11], v12 offset:7296
v_smfmac_f32_16x16x64_bf16 v[32:35], v[44:47], v[200:207], v1
s_waitcnt vmcnt(4)
ds_read_b128 v[4:7], v12 offset:7168
v_mov_b64 v[24:25], 0
v_smfmac_f32_16x16x64_bf16 v[28:31], v[44:47], v[48:55], v1
ds_read_b128 v[12:15], v12 offset:6144
ds_read_b128 v[48:51], v2 offset:28672
v_smfmac_f32_16x16x64_bf16 v[24:27], v[44:47], v[64:71], v1
ds_read_b128 v[52:55], v2 offset:29696
v_mov_b64 v[42:43], 0
s_waitcnt lgkmcnt(4)
v_smfmac_f32_16x16x64_bf16 v[24:27], v[8:11], v[184:191], v1
s_waitcnt lgkmcnt(3)
v_mov_b64 v[40:41], 0
v_smfmac_f32_16x16x64_bf16 v[24:27], v[4:7], v[176:183], v1
s_waitcnt lgkmcnt(2)
ds_read_b128 v[64:67], v2 offset:63488
v_smfmac_f32_16x16x64_bf16 v[24:27], v[12:15], v[192:199], v1
ds_read_b128 v[68:71], v2 offset:64512
v_smfmac_f32_16x16x64_bf16 v[40:43], v[44:47], v[240:247], v1
s_waitcnt vmcnt(2)
s_waitcnt lgkmcnt(2)
v_lshrrev_b32 v44, 16, v1
v_cvt_pk_bf16_f32 v24, v24, v25
v_bfi_b32 v24, 1, s45, v24
v_cvt_pk_bf16_f32 v25, v26, v27
v_smfmac_f32_16x16x64_bf16 v[28:31], v[8:11], v[48:55], v1
buffer_store_dwordx2 v[24:25], v44, s[4:7], s38 offen sc1
ds_read_b128 v[48:51], v2 offset:34816
ds_read_b128 v[52:55], v2 offset:35840
v_smfmac_f32_16x16x64_bf16 v[28:31], v[12:15], v[56:63], v1
s_waitcnt lgkmcnt(2)
ds_read_b128 v[56:59], v2 offset:59392
v_smfmac_f32_16x16x64_bf16 v[28:31], v[4:7], v[64:71], v1
ds_read_b128 v[60:63], v2 offset:60416
v_smfmac_f32_16x16x64_bf16 v[32:35], v[8:11], v[208:215], v1
ds_read_b128 v[64:67], v2 offset:32768
s_nop 0
v_cvt_pk_bf16_f32 v28, v28, v29
v_bfi_b32 v28, 1, s45, v28
v_cvt_pk_bf16_f32 v29, v30, v31
v_smfmac_f32_16x16x64_bf16 v[32:35], v[12:15], v[216:223], v1
buffer_store_dwordx2 v[28:29], v44, s[4:7], s39 offen sc1
v_smfmac_f32_16x16x64_bf16 v[40:43], v[12:15], v[248:255], v1
ds_read_b128 v[68:71], v2 offset:33792
s_waitcnt vmcnt(2)
v_smfmac_f32_16x16x64_bf16 v[32:35], v[4:7], v[16:23], v1
s_waitcnt lgkmcnt(2)
v_smfmac_f32_16x16x64_bf16 v[36:39], v[12:15], v[232:239], v1
ds_read_b128 v[16:19], v2 offset:61440
ds_read_b128 v[20:23], v2 offset:62464
v_cvt_pk_bf16_f32 v32, v32, v33
v_bfi_b32 v32, 1, s45, v32
v_cvt_pk_bf16_f32 v33, v34, v35
v_smfmac_f32_16x16x64_bf16 v[36:39], v[8:11], v[48:55], v1
buffer_store_dwordx2 v[32:33], v44, s[4:7], s40 offen sc1
s_waitcnt lgkmcnt(2)
v_smfmac_f32_16x16x64_bf16 v[36:39], v[4:7], v[64:71], v1
s_nop 6
v_cvt_pk_bf16_f32 v36, v36, v37
v_cvt_pk_bf16_f32 v37, v38, v39
s_waitcnt lgkmcnt(0)
v_bfi_b32 v36, 1, s45, v36
v_smfmac_f32_16x16x64_bf16 v[40:43], v[8:11], v[16:23], v1
buffer_store_dwordx2 v[36:37], v44, s[4:7], s41 offen sc1
v_smfmac_f32_16x16x64_bf16 v[40:43], v[4:7], v[56:63], v1
s_nop 6
v_cvt_pk_bf16_f32 v40, v40, v41
v_bfi_b32 v40, 1, s45, v40
v_cvt_pk_bf16_f32 v41, v42, v43
buffer_store_dwordx2 v[40:41], v44, s[4:7], s42 offen sc1
s_barrier
buffer_load_dwordx4 v[24:27], v0, s[4:7], s43 offen offset:0 sc1
buffer_load_dwordx4 v[28:31], v0, s[4:7], s43 offen offset:1024 sc1
buffer_load_dwordx4 v[32:35], v0, s[4:7], s43 offen offset:2048 sc1
buffer_load_dwordx4 v[36:39], v0, s[4:7], s43 offen offset:3072 sc1
buffer_load_dwordx4 v[48:51], v0, s[4:7], s60 offen offset:0
buffer_load_dwordx4 v[52:55], v0, s[4:7], s60 offen offset:1024
buffer_load_dwordx4 v[56:59], v0, s[4:7], s60 offen offset:2048
buffer_load_dwordx4 v[60:63], v0, s[4:7], s60 offen offset:3072
v_lshlrev_b32 v23, v0, s58
v_cndmask_b32 v16, 0, v23, s[12:13]
v_cndmask_b32 v17, 0, v23, s[14:15]
v_cndmask_b32 v18, 0, v23, s[16:17]
v_cndmask_b32 v19, 0, v23, s[18:19]
v_and_b32 v45, 0x30, v0
v_lshrrev_b32 v46, 8, v0
v_lshl_or_b32 v45, v46, 2, v45
v_bfe_u32 v46, v0, 6, 1
v_lshl_or_b32 v45, v46, 7, v45
v_cndmask_b32 v45, v45, 2.0, s[98:99]
v_cndmask_b32 v20, 0, v23, s[90:91]
v_cndmask_b32 v21, 0, v23, s[92:93]
v_cndmask_b32 v22, 0, v23, s[94:95]
v_cndmask_b32 v23, 0, v23, s[96:97]
s_add_u32 s33, s33, 16384
s_bitset0_b32 s33, 16
s_waitcnt vmcnt(7)
v_mfma_f32_16x16x32_bf16 v[40:43], v[24:27], v[16:19], 0
s_waitcnt vmcnt(6)
v_mfma_f32_16x16x32_bf16 v[40:43], v[28:31], v[16:19], v[40:43]
v_bitop3_b32 v46, v24, v28, s45 bitop3:0x7e
s_waitcnt vmcnt(5)
v_mfma_f32_16x16x32_bf16 v[40:43], v[32:35], v[16:19], v[40:43]
s_waitcnt vmcnt(4)
v_mfma_f32_16x16x32_bf16 v[40:43], v[36:39], v[16:19], v[40:43]
v_bitop3_b32 v47, v32, v36, s45 bitop3:0x7e
v_bitop3_b32 v46, v46, v47, 1 bitop3:0xa8
v_cmp_ne_u32 vcc, 0, v46
v_mov_b64 v[24:25], 0
v_mov_b64 v[26:27], 0
v_mov_b64 v[28:29], 0
v_mov_b64 v[30:31], 0
v_permlane32_swap_b32 v40, v41
v_permlane32_swap_b32 v42, v43
v_add_f32 v40, v40, v41
v_add_f32 v41, v42, v43
v_cvt_pk_bf16_f32 v42, v40, v41
s_cbranch_vccnz k_r1_210
k_ok1_211:
buffer_store_dword v42, v45, s[4:7], s44 offen sc1
s_barrier
buffer_load_dwordx4 v[4:7], v0, s[4:7], s33 offen offset:1024 sc1
buffer_load_dwordx4 v[8:11], v0, s[4:7], s33 offen offset:0 sc1
s_add_u32 s34, s33, 3072
s_add_u32 s35, s33, 7168
s_add_u32 s36, s36, 524288
s_add_u32 s37, s37, 10240
s_add_u32 s59, s59, 10240
v_mov_b64 v[32:33], 0
v_mov_b64 v[34:35], 0
v_mov_b64 v[36:37], 0
v_mov_b64 v[38:39], 0
v_mov_b64 v[40:41], 0
v_mov_b64 v[42:43], 0
v_mov_b64 v[44:45], 0
v_mov_b64 v[46:47], 0
s_add_u32 s44, s44, 16384
s_bitset0_b32 s44, 16
s_sub_u32 s45, s45, 1
s_add_u32 s31, s31, 1
ds_read_b128 v[64:67], v0 offset:24576
ds_read_b128 v[68:71], v0 offset:25600
buffer_load_dwordx4 v[12:15], v0, s[4:7], s34 offen offset:0 sc1
s_cmp_lg_u32 s31, s47
s_cbranch_scc1 k_T0_199
s_branch k_done_209
k_cold2_201:
s_barrier
buffer_load_dwordx4 v[48:51], v0, s[4:7], s60 offen offset:0
buffer_load_dwordx4 v[52:55], v0, s[4:7], s60 offen offset:1024
buffer_load_dwordx4 v[56:59], v0, s[4:7], s60 offen offset:2048
buffer_load_dwordx4 v[60:63], v0, s[4:7], s60 offen offset:3072
ds_read_b128 v[64:67], v0 offset:24576
ds_read_b128 v[68:71], v0 offset:25600
k_cold_200:
buffer_load_dwordx4 v[4:7], v0, s[4:7], s33 offen offset:1024 sc1
buffer_load_dwordx4 v[8:11], v0, s[4:7], s33 offen offset:0 sc1
buffer_load_dwordx4 v[12:15], v0, s[4:7], s34 offen offset:0 sc1
s_sub_u32 s32, s32, 1
s_cmp_gt_i32 s32, 0
s_cbranch_scc0 k_okC_202
v_mov_b64 v[24:25], 0
v_mov_b64 v[26:27], 0
v_mov_b64 v[28:29], 0
v_mov_b64 v[30:31], 0
v_mov_b64 v[32:33], 0
v_mov_b64 v[34:35], 0
v_mov_b64 v[36:37], 0
v_mov_b64 v[38:39], 0
v_mov_b64 v[40:41], 0
v_mov_b64 v[42:43], 0
v_mov_b64 v[44:45], 0
v_mov_b64 v[46:47], 0
s_branch k_T0_199
k_coldA_203:
buffer_load_dwordx4 v[12:15], v0, s[4:7], s34 offen offset:0 sc1
s_sub_u32 s32, s32, 1
s_cmp_gt_i32 s32, 0
s_waitcnt vmcnt(0)
v_cmp_u_f32 vcc, v12, v12
ds_write_b128 v0, v[12:15] offset:1024
s_waitcnt lgkmcnt(0)
s_cbranch_vccz k_okA_204
s_cbranch_scc1 k_coldA_203
s_branch k_okA_204
k_coldB_205:
buffer_load_dwordx4 v[16:19], v0, s[4:7], s35 offen offset:0 sc1
s_sub_u32 s32, s32, 1
s_cmp_gt_i32 s32, 0
s_waitcnt vmcnt(0)
v_cmp_u_f32 vcc, v16, v16
ds_write_b128 v0, v[16:19] offset:5120
s_waitcnt lgkmcnt(0)
s_cbranch_vccz k_okB_206
s_cbranch_scc1 k_coldB_205
s_branch k_okB_206
k_r1_210:
buffer_load_dwordx4 v[24:27], v0, s[4:7], s43 offen offset:0 sc1
buffer_load_dwordx4 v[28:31], v0, s[4:7], s43 offen offset:1024 sc1
buffer_load_dwordx4 v[32:35], v0, s[4:7], s43 offen offset:2048 sc1
buffer_load_dwordx4 v[36:39], v0, s[4:7], s43 offen offset:3072 sc1
s_sub_u32 s32, s32, 1
s_cmp_gt_i32 s32, 0
s_waitcnt vmcnt(3)
v_mfma_f32_16x16x32_bf16 v[40:43], v[24:27], v[16:19], 0
s_waitcnt vmcnt(2)
v_mfma_f32_16x16x32_bf16 v[40:43], v[28:31], v[16:19], v[40:43]
v_bitop3_b32 v46, v24, v28, s45 bitop3:0x7e
s_waitcnt vmcnt(1)
v_mfma_f32_16x16x32_bf16 v[40:43], v[32:35], v[16:19], v[40:43]
s_waitcnt vmcnt(0)
v_mfma_f32_16x16x32_bf16 v[40:43], v[36:39], v[16:19], v[40:43]
v_bitop3_b32 v47, v32, v36, s45 bitop3:0x7e
v_bitop3_b32 v46, v46, v47, 1 bitop3:0xa8
v_cmp_ne_u32 vcc, 0, v46
v_mov_b64 v[24:25], 0
v_mov_b64 v[26:27], 0
v_mov_b64 v[28:29], 0
v_mov_b64 v[30:31], 0
v_permlane32_swap_b32 v40, v41
v_permlane32_swap_b32 v42, v43
v_add_f32 v40, v40, v41
v_add_f32 v41, v42, v43
v_cvt_pk_bf16_f32 v42, v40, v41
s_cbranch_vccz k_ok1_211
s_cbranch_scc1 k_r1_210
s_branch k_ok1_211
k_slow_207:
ds_read_b128 v[24:27], v0 offset:0
ds_read_b128 v[28:31], v0 offset:1024
v_mov_b32 v46, 0xff7fffff
s_add_u32 s48, s36, 0xfffff000
buffer_load_dwordx4 v[32:35], v0, s[4:7], s48 offen offset:0 sc1
buffer_load_dwordx4 v[36:39], v0, s[4:7], s48 offen offset:1024 sc1
s_waitcnt vmcnt(1) lgkmcnt(1)
v_mfma_f32_16x16x32_bf16 v[4:7], v[32:35], v[24:27], 0
s_waitcnt vmcnt(0) lgkmcnt(0)
v_mfma_f32_16x16x32_bf16 v[4:7], v[36:39], v[28:31], v[4:7]
v_mov_b64 v[8:9], s[56:57]
s_nop 5
v_permlane32_swap_b32 v4, v6
v_permlane32_swap_b32 v5, v7
v_add_f32_dpp v8, v6, v4 row_ror:8 row_mask:0xf bank_mask:0x3
s_nop 0
v_add_f32_dpp v9, v7, v5 row_ror:8 row_mask:0xf bank_mask:0x3
v_max3_f32 v46, v46, v8, v9
s_add_u32 s48, s36, 0x0
buffer_load_dwordx4 v[32:35], v0, s[4:7], s48 offen offset:0 sc1
buffer_load_dwordx4 v[36:39], v0, s[4:7], s48 offen offset:1024 sc1
s_waitcnt vmcnt(1)
v_mfma_f32_16x16x32_bf16 v[4:7], v[32:35], v[24:27], 0
s_waitcnt vmcnt(0)
v_mfma_f32_16x16x32_bf16 v[4:7], v[36:39], v[28:31], v[4:7]
v_mov_b64 v[10:11], s[56:57]
s_nop 5
v_permlane32_swap_b32 v4, v6
v_permlane32_swap_b32 v5, v7
v_add_f32_dpp v10, v6, v4 row_ror:8 row_mask:0xf bank_mask:0x3
s_nop 0
v_add_f32_dpp v11, v7, v5 row_ror:8 row_mask:0xf bank_mask:0x3
v_max3_f32 v46, v46, v10, v11
s_add_u32 s48, s36, 0x1000
buffer_load_dwordx4 v[32:35], v0, s[4:7], s48 offen offset:0 sc1
buffer_load_dwordx4 v[36:39], v0, s[4:7], s48 offen offset:1024 sc1
s_waitcnt vmcnt(1)
v_mfma_f32_16x16x32_bf16 v[4:7], v[32:35], v[24:27], 0
s_waitcnt vmcnt(0)
v_mfma_f32_16x16x32_bf16 v[4:7], v[36:39], v[28:31], v[4:7]
v_mov_b64 v[12:13], s[56:57]
s_nop 5
v_permlane32_swap_b32 v4, v6
v_permlane32_swap_b32 v5, v7
v_add_f32_dpp v12, v6, v4 row_ror:8 row_mask:0xf bank_mask:0x3
s_nop 0
v_add_f32_dpp v13, v7, v5 row_ror:8 row_mask:0xf bank_mask:0x3
v_max3_f32 v46, v46, v12, v13
s_add_u32 s48, s36, 0x2000
buffer_load_dwordx4 v[32:35], v0, s[4:7], s48 offen offset:0 sc1
buffer_load_dwordx4 v[36:39], v0, s[4:7], s48 offen offset:1024 sc1
s_waitcnt vmcnt(1)
v_mfma_f32_16x16x32_bf16 v[4:7], v[32:35], v[24:27], 0
s_waitcnt vmcnt(0)
v_mfma_f32_16x16x32_bf16 v[4:7], v[36:39], v[28:31], v[4:7]
v_mov_b64 v[14:15], s[56:57]
s_nop 5
v_permlane32_swap_b32 v4, v6
v_permlane32_swap_b32 v5, v7
v_add_f32_dpp v14, v6, v4 row_ror:8 row_mask:0xf bank_mask:0x3
s_nop 0
v_add_f32_dpp v15, v7, v5 row_ror:8 row_mask:0xf bank_mask:0x3
v_max3_f32 v46, v46, v14, v15
ds_read_b128 v[32:35], v0 offset:2048
ds_read_b128 v[36:39], v0 offset:3072
s_waitcnt lgkmcnt(1)
v_mfma_f32_16x16x32_bf16 v[4:7], v[32:35], v[24:27], 0
s_waitcnt lgkmcnt(0)
v_mfma_f32_16x16x32_bf16 v[4:7], v[36:39], v[28:31], v[4:7]
v_mov_b64 v[44:45], s[56:57]
s_nop 5
v_permlane32_swap_b32 v4, v6
v_permlane32_swap_b32 v5, v7
v_add_f32_dpp v44, v6, v4 row_ror:8 row_mask:0xf bank_mask:0x3
s_nop 0
v_add_f32_dpp v45, v7, v5 row_ror:8 row_mask:0xf bank_mask:0x3
v_max3_f32 v46, v46, v44, v45
buffer_load_dwordx4 v[32:35], v0, s[4:7], s36 offen offset:2048 sc1
buffer_load_dwordx4 v[36:39], v0, s[4:7], s36 offen offset:3072 sc1
v_mov_b32 v47, v46
s_nop 1
v_permlane32_swap_b32 v46, v47
v_max_f32 v46, v46, v47
v_mov_b32 v47, v46
s_nop 1
v_permlane16_swap_b32 v46, v47
v_max_f32 v46, v46, v47
v_sub_f32 v8, v8, v46
v_exp_f32 v8, v8
v_sub_f32 v9, v9, v46
v_exp_f32 v9, v9
v_sub_f32 v10, v10, v46
v_exp_f32 v10, v10
v_sub_f32 v11, v11, v46
v_exp_f32 v11, v11
v_sub_f32 v12, v12, v46
v_exp_f32 v12, v12
v_sub_f32 v13, v13, v46
v_exp_f32 v13, v13
v_sub_f32 v14, v14, v46
v_exp_f32 v14, v14
v_sub_f32 v15, v15, v46
v_exp_f32 v15, v15
v_sub_f32 v44, v44, v46
v_exp_f32 v44, v44
v_sub_f32 v45, v45, v46
v_exp_f32 v45, v45
v_cvt_pk_bf16_f32 v4, v8, v9
v_cvt_pk_bf16_f32 v5, v10, v11
v_cvt_pk_bf16_f32 v6, v12, v13
v_cvt_pk_bf16_f32 v7, v14, v15
v_mov_b32_dpp v8, v4 row_ror:8 row_mask:0xf bank_mask:0xf
v_mov_b32_dpp v9, v5 row_ror:8 row_mask:0xf bank_mask:0xf
v_mov_b32_dpp v10, v6 row_ror:8 row_mask:0xf bank_mask:0xf
v_mov_b32_dpp v11, v7 row_ror:8 row_mask:0xf bank_mask:0xf
v_cvt_pk_bf16_f32 v24, v44, v45
v_cvt_pk_bf16_f32 v25, v44, v45
s_nop 0
v_mov_b32_dpp v26, v24 row_ror:8 row_mask:0xf bank_mask:0xf
v_mov_b32_dpp v27, v24 row_ror:8 row_mask:0xf bank_mask:0xf
v_mov_b64 v[28:29], s[52:53]
v_mov_b64 v[30:31], s[52:53]
s_nop 1
v_mfma_f32_16x16x32_bf16 v[44:47], v[28:31], v[4:7], 0
s_waitcnt vmcnt(1)
v_mfma_f32_16x16x32_bf16 v[12:15], v[32:35], v[4:7], 0
s_waitcnt vmcnt(0)
v_mfma_f32_16x16x32_bf16 v[12:15], v[36:39], v[8:11], v[12:15]
v_mfma_f32_16x16x32_bf16 v[12:15], v[40:43], v[24:27], v[12:15]
v_mov_b64 v[28:29], s[54:55]
s_nop 1
v_mfma_f32_16x16x16_bf16 v[44:47], v[28:29], v[24:25], v[44:47]
s_nop 6
v_rcp_f32 v4, v44
s_nop 1
v_rcp_f32_dpp v4, v44 row_ror:8 row_mask:0xf bank_mask:0xc
s_nop 0
v_mul_f32 v12, v4, v12
v_mul_f32 v13, v4, v13
v_mul_f32 v14, v4, v14
v_mul_f32 v15, v4, v15
v_cvt_pk_bf16_f32 v44, v12, v13
v_cvt_pk_bf16_f32 v45, v14, v15
v_and_b32 v12, 0xffffff7f, v0
v_and_or_b32 v8, v1, 8, v12
ds_write_b64 v8, v[44:45] offset:6272
v_mov_b32_dpp v46, v44 row_ror:8 row_mask:0xf bank_mask:0xf
v_mov_b32_dpp v47, v45 row_ror:8 row_mask:0xf bank_mask:0xf
v_mov_b64 v[24:25], 0
v_mov_b64 v[26:27], 0
v_mov_b64 v[28:29], 0
v_mov_b64 v[30:31], 0
v_mov_b64 v[32:33], 0
v_mov_b64 v[34:35], 0
v_mov_b64 v[36:37], 0
v_mov_b64 v[38:39], 0
s_waitcnt lgkmcnt(0)
s_branch k_okS_208
k_done_209:
buffer_load_dwordx4 v[16:19], v0, s[4:7], s35 offen offset:0 sc1
k_xs_215:
s_waitcnt vmcnt(1)
v_cmp_u_f32 vcc, v4, v12
s_waitcnt vmcnt(0)
v_cmp_u_f32 s[66:67], v16, v16
s_or_b64 vcc, vcc, s[66:67]
s_cbranch_vccz k_xd_216
buffer_load_dwordx4 v[4:7], v0, s[4:7], s33 offen offset:1024 sc1
buffer_load_dwordx4 v[8:11], v0, s[4:7], s33 offen offset:0 sc1
buffer_load_dwordx4 v[12:15], v0, s[4:7], s34 offen offset:0 sc1
buffer_load_dwordx4 v[16:19], v0, s[4:7], s35 offen offset:0 sc1
s_sub_u32 s32, s32, 1
s_cmp_gt_i32 s32, 0
s_cbranch_scc1 k_xs_215
k_xd_216:
s_waitcnt vmcnt(3)
buffer_store_dwordx4 v[4:7], v0, s[8:11], s37 offen offset:0 sc1
s_waitcnt vmcnt(2)
buffer_store_dwordx4 v[12:15], v0, s[8:11], s37 offen offset:2048 sc1
s_waitcnt vmcnt(2)
buffer_store_dwordx4 v[16:19], v0, s[8:11], s59 offen offset:2048 sc1
s_add_u32 s31, s31, 1
k_jn_180:
s_cmp_lt_u32 s31, 128
s_cbranch_scc1 k_lay_173
s_add_u32 s30, s30, 112
s_waitcnt vmcnt(0) lgkmcnt(0)
s_barrier
s_branch k_fin_7
k_w2_127:
v_lshrrev_b32 v12, 3, v0
v_lshlrev_b32 v10, 13, v12
v_bfe_u32 v12, v0, 1, 2
v_lshrrev_b32 v13, 4, v0
v_xor_b32 v12, v12, v13
v_lshl_add_u32 v10, v12, 5, v10
v_and_b32 v14, 1, v0
v_lshl_add_u32 v10, v14, 4, v10
v_mul_u32_u24 v11, 1280, v13
v_bfe_u32 v12, v0, 1, 3
v_and_b32 v13, 1, v13
v_lshlrev_b32 v13, 1, v13
v_xor_b32 v12, v12, v13
v_xor_b32 v12, 4, v12
v_lshl_add_u32 v11, v12, 5, v11
v_lshl_add_u32 v11, v14, 4, v11
v_bfe_u32 v12, v0, 5, 1
v_lshlrev_b32 v12, 4, v12
v_bfe_u32 v13, v0, 4, 1
v_lshl_add_u32 v12, v13, 1, v12
v_bfe_u32 v13, v0, 2, 1
v_lshl_add_u32 v12, v13, 2, v12
v_bfe_u32 v13, v0, 3, 1
v_mul_u32_u24 v15, 4224, v13
v_add_u32 v12, v13, v12
v_bfe_u32 v13, v12, 1, 2
v_xor_b32 v13, 2, v13
v_lshlrev_b32 v13, 5, v13
v_lshl_add_u32 v4, v12, 7, v13
v_and_b32 v14, 3, v0
v_lshl_add_u32 v4, v14, 3, v4
v_add_u32 v5, 0x10000, v4
v_add_u32 v6, 0x20000, v4
v_bfe_u32 v12, v0, 4, 1
v_lshlrev_b32 v13, 4, v12
v_lshlrev_b32 v12, 2, v12
v_bfe_u32 v8, v0, 5, 1
v_lshl_add_u32 v13, v8, 2, v13
v_bfe_u32 v8, v0, 2, 1
v_add_u32 v13, v8, v13
v_lshl_add_u32 v12, v8, 1, v12
v_bfe_u32 v8, v0, 3, 1
v_add_u32 v8, 4, v8
v_xor_b32 v12, v12, v8
v_lshlrev_b32 v12, 5, v12
v_lshl_add_u32 v7, v13, 8, v12
v_lshl_add_u32 v7, v14, 3, v7
v_add_u32 v8, 0x10000, v7
v_add_u32 v9, 0x20000, v7
v_lshlrev_b32 v0, 4, v0
v_add_u32 v2, 65536, v0
s_lshl_b32 s49, s30, 8
s_mul_i32 s50, s30, 163840
s_mul_i32 s60, s30, 131072
s_add_u32 s60, s60, 120651776
s_add_u32 s61, s60, 4096
s_add_u32 s62, s60, 8192
s_mov_b32 m0, 4096
s_add_u32 s48, s49, 262144
buffer_load_dwordx4 v10, s[8:11], s48 offen lds
s_mov_b32 m0, 5120
s_add_u32 s48, s49, 327680
buffer_load_dwordx4 v10, s[8:11], s48 offen lds
s_mov_b32 m0, 12288
s_add_u32 s48, s49, 262272
buffer_load_dwordx4 v10, s[8:11], s48 offen lds
s_mov_b32 m0, 13312
s_add_u32 s48, s49, 327808
buffer_load_dwordx4 v10, s[8:11], s48 offen lds
s_mov_b32 m0, 20480
s_add_u32 s48, s49, 262272
buffer_load_dwordx4 v10, s[12:15], s48 offen lds
s_mov_b32 m0, 21504
s_add_u32 s48, s49, 327808
buffer_load_dwordx4 v10, s[12:15], s48 offen lds
s_mov_b32 m0, 28672
s_add_u32 s48, s49, 262144
buffer_load_dwordx4 v10, s[16:19], s48 offen lds
s_mov_b32 m0, 29696
s_add_u32 s48, s49, 327680
buffer_load_dwordx4 v10, s[16:19], s48 offen lds
s_mov_b32 m0, 36864
s_add_u32 s48, s49, 262272
buffer_load_dwordx4 v10, s[16:19], s48 offen lds
s_mov_b32 m0, 37888
s_add_u32 s48, s49, 327808
buffer_load_dwordx4 v10, s[16:19], s48 offen lds
s_mov_b32 m0, 45056
s_add_u32 s48, s49, 786432
buffer_load_dwordx4 v10, s[8:11], s48 offen lds
s_mov_b32 m0, 46080
s_add_u32 s48, s49, 851968
buffer_load_dwordx4 v10, s[8:11], s48 offen lds
s_mov_b32 m0, 53248
s_add_u32 s48, s49, 786560
buffer_load_dwordx4 v10, s[8:11], s48 offen lds
s_mov_b32 m0, 54272
s_add_u32 s48, s49, 852096
buffer_load_dwordx4 v10, s[8:11], s48 offen lds
s_mov_b32 m0, 61440
s_add_u32 s48, s49, 786560
buffer_load_dwordx4 v10, s[12:15], s48 offen lds
s_mov_b32 m0, 62464
s_add_u32 s48, s49, 852096
buffer_load_dwordx4 v10, s[12:15], s48 offen lds
s_mov_b32 m0, 69632
s_add_u32 s48, s49, 786432
buffer_load_dwordx4 v10, s[16:19], s48 offen lds
s_mov_b32 m0, 70656
s_add_u32 s48, s49, 851968
buffer_load_dwordx4 v10, s[16:19], s48 offen lds
s_mov_b32 m0, 77824
s_add_u32 s48, s49, 786560
buffer_load_dwordx4 v10, s[16:19], s48 offen lds
s_mov_b32 m0, 78848
s_add_u32 s48, s49, 852096
buffer_load_dwordx4 v10, s[16:19], s48 offen lds
s_mov_b32 m0, 86016
s_add_u32 s48, s49, 1310720
buffer_load_dwordx4 v10, s[8:11], s48 offen lds
s_mov_b32 m0, 87040
s_add_u32 s48, s49, 1376256
buffer_load_dwordx4 v10, s[8:11], s48 offen lds
s_mov_b32 m0, 94208
s_add_u32 s48, s49, 1310848
buffer_load_dwordx4 v10, s[8:11], s48 offen lds
s_mov_b32 m0, 95232
s_add_u32 s48, s49, 1376384
buffer_load_dwordx4 v10, s[8:11], s48 offen lds
s_mov_b32 m0, 102400
s_add_u32 s48, s49, 1310848
buffer_load_dwordx4 v10, s[12:15], s48 offen lds
s_mov_b32 m0, 103424
s_add_u32 s48, s49, 1376384
buffer_load_dwordx4 v10, s[12:15], s48 offen lds
s_mov_b32 m0, 110592
s_add_u32 s48, s49, 1310720
buffer_load_dwordx4 v10, s[16:19], s48 offen lds
s_mov_b32 m0, 111616
s_add_u32 s48, s49, 1376256
buffer_load_dwordx4 v10, s[16:19], s48 offen lds
s_mov_b32 m0, 118784
s_add_u32 s48, s49, 1835008
buffer_load_dwordx4 v10, s[8:11], s48 offen lds
s_mov_b32 m0, 119808
s_add_u32 s48, s49, 1900544
buffer_load_dwordx4 v10, s[8:11], s48 offen lds
s_mov_b32 m0, 126976
s_add_u32 s48, s49, 1835136
buffer_load_dwordx4 v10, s[8:11], s48 offen lds
s_mov_b32 m0, 128000
s_add_u32 s48, s49, 1900672
buffer_load_dwordx4 v10, s[8:11], s48 offen lds
s_waitcnt vmcnt(24)
s_barrier
s_mov_b32 m0, 135168
s_add_u32 s48, s49, 1835136
buffer_load_dwordx4 v10, s[12:15], s48 offen lds
s_mov_b32 m0, 136192
s_add_u32 s48, s49, 1900672
buffer_load_dwordx4 v10, s[12:15], s48 offen lds
s_mov_b32 m0, 143360
s_add_u32 s48, s49, 1835008
buffer_load_dwordx4 v10, s[16:19], s48 offen lds
s_mov_b32 m0, 144384
s_add_u32 s48, s49, 1900544
buffer_load_dwordx4 v10, s[16:19], s48 offen lds
s_mov_b32 m0, 151552
s_add_u32 s48, s49, 2359296
buffer_load_dwordx4 v10, s[8:11], s48 offen lds
s_mov_b32 m0, 152576
s_add_u32 s48, s49, 2424832
buffer_load_dwordx4 v10, s[8:11], s48 offen lds
s_mov_b32 m0, 159744
s_add_u32 s48, s49, 2359424
buffer_load_dwordx4 v10, s[8:11], s48 offen lds
s_mov_b32 m0, 160768
s_add_u32 s48, s49, 2424960
buffer_load_dwordx4 v10, s[8:11], s48 offen lds
ds_read_b64_tr_b16 a[0:1], v4 offset:0
ds_read_b64_tr_b16 a[2:3], v4 offset:1024
ds_read_b64_tr_b16 a[4:5], v4 offset:4096
ds_read_b64_tr_b16 a[6:7], v4 offset:5120
ds_read_b64_tr_b16 a[8:9], v4 offset:8192
ds_read_b64_tr_b16 a[10:11], v4 offset:9216
ds_read_b64_tr_b16 a[12:13], v4 offset:12288
ds_read_b64_tr_b16 a[14:15], v4 offset:13312
ds_read_b64_tr_b16 a[16:17], v4 offset:16384
ds_read_b64_tr_b16 a[18:19], v4 offset:17408
ds_read_b64_tr_b16 a[20:21], v4 offset:20480
ds_read_b64_tr_b16 a[22:23], v4 offset:21504
ds_read_b64_tr_b16 v[40:41], v4 offset:24576
ds_read_b64_tr_b16 v[42:43], v4 offset:25600
ds_read_b64_tr_b16 v[44:45], v4 offset:28672
ds_read_b64_tr_b16 v[46:47], v4 offset:29696
s_waitcnt lgkmcnt(0)
buffer_store_dwordx4 v[40:43], v0, s[4:7], s60 offen offset:0
buffer_store_dwordx4 v[44:47], v0, s[4:7], s60 offen offset:1024
s_waitcnt vmcnt(26)
s_barrier
s_mov_b32 m0, 4096
s_add_u32 s48, s49, 2359424
buffer_load_dwordx4 v10, s[12:15], s48 offen lds
s_mov_b32 m0, 5120
s_add_u32 s48, s49, 2424960
buffer_load_dwordx4 v10, s[12:15], s48 offen lds
s_mov_b32 m0, 12288
s_add_u32 s48, s49, 2359296
buffer_load_dwordx4 v10, s[16:19], s48 offen lds
s_mov_b32 m0, 13312
s_add_u32 s48, s49, 2424832
buffer_load_dwordx4 v10, s[16:19], s48 offen lds
s_mov_b32 m0, 20480
s_add_u32 s48, s49, 2883584
buffer_load_dwordx4 v10, s[8:11], s48 offen lds
s_mov_b32 m0, 21504
s_add_u32 s48, s49, 2949120
buffer_load_dwordx4 v10, s[8:11], s48 offen lds
s_mov_b32 m0, 28672
s_add_u32 s48, s49, 2883712
buffer_load_dwordx4 v10, s[8:11], s48 offen lds
s_mov_b32 m0, 29696
s_add_u32 s48, s49, 2949248
buffer_load_dwordx4 v10, s[8:11], s48 offen lds
ds_read_b64_tr_b16 v[16:17], v4 offset:32768
ds_read_b64_tr_b16 v[18:19], v4 offset:33792
ds_read_b64_tr_b16 v[20:21], v4 offset:36864
ds_read_b64_tr_b16 v[22:23], v4 offset:37888
ds_read_b64_tr_b16 a[24:25], v4 offset:40960
ds_read_b64_tr_b16 a[26:27], v4 offset:41984
ds_read_b64_tr_b16 a[28:29], v4 offset:45056
ds_read_b64_tr_b16 a[30:31], v4 offset:46080
ds_read_b64_tr_b16 a[32:33], v4 offset:49152
ds_read_b64_tr_b16 a[34:35], v4 offset:50176
ds_read_b64_tr_b16 a[36:37], v4 offset:53248
ds_read_b64_tr_b16 a[38:39], v4 offset:54272
ds_read_b64_tr_b16 a[40:41], v4 offset:57344
ds_read_b64_tr_b16 a[42:43], v4 offset:58368
ds_read_b64_tr_b16 a[44:45], v4 offset:61440
ds_read_b64_tr_b16 a[46:47], v4 offset:62464
s_waitcnt lgkmcnt(0)
buffer_store_dwordx4 v[16:19], v0, s[4:7], s60 offen offset:2048
buffer_store_dwordx4 v[20:23], v0, s[4:7], s60 offen offset:3072
s_waitcnt vmcnt(28)
s_barrier
s_mov_b32 m0, 36864
s_add_u32 s48, s49, 2883712
buffer_load_dwordx4 v10, s[12:15], s48 offen lds
s_mov_b32 m0, 37888
s_add_u32 s48, s49, 2949248
buffer_load_dwordx4 v10, s[12:15], s48 offen lds
s_mov_b32 m0, 45056
s_add_u32 s48, s49, 2883584
buffer_load_dwordx4 v10, s[16:19], s48 offen lds
s_mov_b32 m0, 46080
s_add_u32 s48, s49, 2949120
buffer_load_dwordx4 v10, s[16:19], s48 offen lds
s_mov_b32 m0, 53248
s_add_u32 s48, s49, 3408000
buffer_load_dwordx4 v10, s[8:11], s48 offen lds
s_mov_b32 m0, 54272
s_add_u32 s48, s49, 3473536
buffer_load_dwordx4 v10, s[8:11], s48 offen lds
s_mov_b32 m0, 61440
s_add_u32 s48, s49, 3932160
buffer_load_dwordx4 v10, s[8:11], s48 offen lds
s_mov_b32 m0, 62464
s_add_u32 s48, s49, 3997696
buffer_load_dwordx4 v10, s[8:11], s48 offen lds
ds_read_b64_tr_b16 a[176:177], v5 offset:0
ds_read_b64_tr_b16 a[178:179], v5 offset:1024
ds_read_b64_tr_b16 a[180:181], v5 offset:4096
ds_read_b64_tr_b16 a[182:183], v5 offset:5120
ds_read_b64_tr_b16 v[224:225], v5 offset:8192
ds_read_b64_tr_b16 v[226:227], v5 offset:9216
ds_read_b64_tr_b16 v[228:229], v5 offset:12288
ds_read_b64_tr_b16 v[230:231], v5 offset:13312
ds_read_b64_tr_b16 a[112:113], v5 offset:16384
ds_read_b64_tr_b16 a[114:115], v5 offset:17408
ds_read_b64_tr_b16 a[116:117], v5 offset:20480
ds_read_b64_tr_b16 a[118:119], v5 offset:21504
ds_read_b64_tr_b16 a[120:121], v5 offset:24576
ds_read_b64_tr_b16 a[122:123], v5 offset:25600
ds_read_b64_tr_b16 a[124:125], v5 offset:28672
ds_read_b64_tr_b16 a[126:127], v5 offset:29696
s_waitcnt lgkmcnt(0)
s_waitcnt vmcnt(28)
s_barrier
s_mov_b32 m0, 69632
s_add_u32 s48, s49, 3932288
buffer_load_dwordx4 v10, s[8:11], s48 offen lds
s_mov_b32 m0, 70656
s_add_u32 s48, s49, 3997824
buffer_load_dwordx4 v10, s[8:11], s48 offen lds
s_mov_b32 m0, 77824
s_add_u32 s48, s49, 4456448
buffer_load_dwordx4 v10, s[8:11], s48 offen lds
s_mov_b32 m0, 78848
s_add_u32 s48, s49, 4521984
buffer_load_dwordx4 v10, s[8:11], s48 offen lds
s_mov_b32 m0, 86016
s_add_u32 s48, s49, 4456576
buffer_load_dwordx4 v10, s[8:11], s48 offen lds
s_mov_b32 m0, 87040
s_add_u32 s48, s49, 4522112
buffer_load_dwordx4 v10, s[8:11], s48 offen lds
s_mov_b32 m0, 94208
s_add_u32 s48, s49, 4980736
buffer_load_dwordx4 v10, s[8:11], s48 offen lds
s_mov_b32 m0, 95232
s_add_u32 s48, s49, 5046272
buffer_load_dwordx4 v10, s[8:11], s48 offen lds
ds_read_b64_tr_b16 a[128:129], v5 offset:32768
ds_read_b64_tr_b16 a[130:131], v5 offset:33792
ds_read_b64_tr_b16 a[132:133], v5 offset:36864
ds_read_b64_tr_b16 a[134:135], v5 offset:37888
ds_read_b64_tr_b16 a[136:137], v5 offset:40960
ds_read_b64_tr_b16 a[138:139], v5 offset:41984
ds_read_b64_tr_b16 a[140:141], v5 offset:45056
ds_read_b64_tr_b16 a[142:143], v5 offset:46080
ds_read_b64_tr_b16 a[144:145], v5 offset:49152
ds_read_b64_tr_b16 a[146:147], v5 offset:50176
ds_read_b64_tr_b16 a[148:149], v5 offset:53248
ds_read_b64_tr_b16 a[150:151], v5 offset:54272
ds_read_b64_tr_b16 a[152:153], v5 offset:57344
ds_read_b64_tr_b16 a[154:155], v5 offset:58368
ds_read_b64_tr_b16 a[156:157], v5 offset:61440
ds_read_b64_tr_b16 a[158:159], v5 offset:62464
s_waitcnt lgkmcnt(0)
s_waitcnt vmcnt(28)
s_barrier
s_mov_b32 m0, 102400
s_add_u32 s48, s49, 4980864
buffer_load_dwordx4 v10, s[8:11], s48 offen lds
s_mov_b32 m0, 103424
s_add_u32 s48, s49, 5046400
buffer_load_dwordx4 v10, s[8:11], s48 offen lds
s_mov_b32 m0, 110592
s_add_u32 s48, s49, 3407872
buffer_load_dwordx4 v10, s[12:15], s48 offen lds
s_mov_b32 m0, 111616
s_add_u32 s48, s49, 3473408
buffer_load_dwordx4 v10, s[12:15], s48 offen lds
s_mov_b32 m0, 118784
s_add_u32 s48, s49, 3408000
buffer_load_dwordx4 v10, s[12:15], s48 offen lds
s_mov_b32 m0, 119808
s_add_u32 s48, s49, 3473536
buffer_load_dwordx4 v10, s[12:15], s48 offen lds
s_mov_b32 m0, 126976
s_add_u32 s48, s49, 3932160
buffer_load_dwordx4 v10, s[12:15], s48 offen lds
s_mov_b32 m0, 128000
s_add_u32 s48, s49, 3997696
buffer_load_dwordx4 v10, s[12:15], s48 offen lds
ds_read_b64_tr_b16 a[160:161], v6 offset:0
ds_read_b64_tr_b16 a[162:163], v6 offset:1024
ds_read_b64_tr_b16 a[164:165], v6 offset:4096
ds_read_b64_tr_b16 a[166:167], v6 offset:5120
ds_read_b64_tr_b16 a[168:169], v6 offset:8192
ds_read_b64_tr_b16 a[170:171], v6 offset:9216
ds_read_b64_tr_b16 a[172:173], v6 offset:12288
ds_read_b64_tr_b16 a[174:175], v6 offset:13312
ds_read_b64_tr_b16 a[48:49], v6 offset:16384
ds_read_b64_tr_b16 a[50:51], v6 offset:17408
ds_read_b64_tr_b16 a[52:53], v6 offset:20480
ds_read_b64_tr_b16 a[54:55], v6 offset:21504
ds_read_b64_tr_b16 a[56:57], v6 offset:24576
ds_read_b64_tr_b16 a[58:59], v6 offset:25600
ds_read_b64_tr_b16 a[60:61], v6 offset:28672
ds_read_b64_tr_b16 a[62:63], v6 offset:29696
s_waitcnt lgkmcnt(0)
s_waitcnt vmcnt(26)
s_barrier
s_mov_b32 m0, 135168
s_add_u32 s48, s49, 3932288
buffer_load_dwordx4 v10, s[12:15], s48 offen lds
s_mov_b32 m0, 136192
s_add_u32 s48, s49, 3997824
buffer_load_dwordx4 v10, s[12:15], s48 offen lds
s_mov_b32 m0, 143360
s_add_u32 s48, s49, 4456448
buffer_load_dwordx4 v10, s[12:15], s48 offen lds
s_mov_b32 m0, 144384
s_add_u32 s48, s49, 4521984
buffer_load_dwordx4 v10, s[12:15], s48 offen lds
s_mov_b32 m0, 151552
s_add_u32 s48, s49, 4456576
buffer_load_dwordx4 v10, s[12:15], s48 offen lds
s_mov_b32 m0, 152576
s_add_u32 s48, s49, 4522112
buffer_load_dwordx4 v10, s[12:15], s48 offen lds
s_mov_b32 m0, 159744
s_add_u32 s48, s49, 4980736
buffer_load_dwordx4 v10, s[12:15], s48 offen lds
s_mov_b32 m0, 160768
s_add_u32 s48, s49, 5046272
buffer_load_dwordx4 v10, s[12:15], s48 offen lds
ds_read_b64_tr_b16 a[64:65], v4 offset:0
ds_read_b64_tr_b16 a[66:67], v4 offset:1024
ds_read_b64_tr_b16 a[68:69], v4 offset:4096
ds_read_b64_tr_b16 a[70:71], v4 offset:5120
ds_read_b64_tr_b16 a[72:73], v4 offset:8192
ds_read_b64_tr_b16 a[74:75], v4 offset:9216
ds_read_b64_tr_b16 a[76:77], v4 offset:12288
ds_read_b64_tr_b16 a[78:79], v4 offset:13312
ds_read_b64_tr_b16 a[80:81], v4 offset:16384
ds_read_b64_tr_b16 a[82:83], v4 offset:17408
ds_read_b64_tr_b16 a[84:85], v4 offset:20480
ds_read_b64_tr_b16 a[86:87], v4 offset:21504
ds_read_b64_tr_b16 a[88:89], v4 offset:24576
ds_read_b64_tr_b16 a[90:91], v4 offset:25600
ds_read_b64_tr_b16 a[92:93], v4 offset:28672
ds_read_b64_tr_b16 a[94:95], v4 offset:29696
s_waitcnt lgkmcnt(0)
s_waitcnt vmcnt(24)
s_barrier
s_mov_b32 m0, 4096
s_add_u32 s48, s49, 4980864
buffer_load_dwordx4 v10, s[12:15], s48 offen lds
s_mov_b32 m0, 5120
s_add_u32 s48, s49, 5046400
buffer_load_dwordx4 v10, s[12:15], s48 offen lds
s_mov_b32 m0, 12288
s_add_u32 s48, s49, 3407872
buffer_load_dwordx4 v10, s[16:19], s48 offen lds
s_mov_b32 m0, 13312
s_add_u32 s48, s49, 3473408
buffer_load_dwordx4 v10, s[16:19], s48 offen lds
s_mov_b32 m0, 20480
s_add_u32 s48, s49, 3408000
buffer_load_dwordx4 v10, s[16:19], s48 offen lds
s_mov_b32 m0, 21504
s_add_u32 s48, s49, 3473536
buffer_load_dwordx4 v10, s[16:19], s48 offen lds
s_mov_b32 m0, 28672
s_add_u32 s48, s49, 3932160
buffer_load_dwordx4 v10, s[16:19], s48 offen lds
s_mov_b32 m0, 29696
s_add_u32 s48, s49, 3997696
buffer_load_dwordx4 v10, s[16:19], s48 offen lds
ds_read_b64_tr_b16 a[96:97], v4 offset:32768
ds_read_b64_tr_b16 a[98:99], v4 offset:33792
ds_read_b64_tr_b16 a[100:101], v4 offset:36864
ds_read_b64_tr_b16 a[102:103], v4 offset:37888
ds_read_b64_tr_b16 a[104:105], v4 offset:40960
ds_read_b64_tr_b16 a[106:107], v4 offset:41984
ds_read_b64_tr_b16 a[108:109], v4 offset:45056
ds_read_b64_tr_b16 a[110:111], v4 offset:46080
ds_read_b64_tr_b16 a[216:217], v4 offset:49152
ds_read_b64_tr_b16 a[218:219], v4 offset:50176
ds_read_b64_tr_b16 a[220:221], v4 offset:53248
ds_read_b64_tr_b16 a[222:223], v4 offset:54272
ds_read_b64_tr_b16 a[224:225], v4 offset:57344
ds_read_b64_tr_b16 a[226:227], v4 offset:58368
ds_read_b64_tr_b16 a[228:229], v4 offset:61440
ds_read_b64_tr_b16 a[230:231], v4 offset:62464
s_waitcnt lgkmcnt(0)
s_waitcnt vmcnt(24)
s_barrier
s_mov_b32 m0, 36864
s_add_u32 s48, s49, 3932288
buffer_load_dwordx4 v10, s[16:19], s48 offen lds
s_mov_b32 m0, 37888
s_add_u32 s48, s49, 3997824
buffer_load_dwordx4 v10, s[16:19], s48 offen lds
s_mov_b32 m0, 45056
s_add_u32 s48, s49, 4456448
buffer_load_dwordx4 v10, s[16:19], s48 offen lds
s_mov_b32 m0, 46080
s_add_u32 s48, s49, 4521984
buffer_load_dwordx4 v10, s[16:19], s48 offen lds
s_mov_b32 m0, 53248
s_add_u32 s48, s49, 4456576
buffer_load_dwordx4 v10, s[16:19], s48 offen lds
s_mov_b32 m0, 54272
s_add_u32 s48, s49, 4522112
buffer_load_dwordx4 v10, s[16:19], s48 offen lds
s_mov_b32 m0, 61440
s_add_u32 s48, s49, 4980736
buffer_load_dwordx4 v10, s[16:19], s48 offen lds
s_mov_b32 m0, 62464
s_add_u32 s48, s49, 5046272
buffer_load_dwordx4 v10, s[16:19], s48 offen lds
ds_read_b64_tr_b16 a[232:233], v5 offset:0
ds_read_b64_tr_b16 a[234:235], v5 offset:1024
ds_read_b64_tr_b16 a[236:237], v5 offset:4096
ds_read_b64_tr_b16 a[238:239], v5 offset:5120
ds_read_b64_tr_b16 a[184:185], v5 offset:8192
ds_read_b64_tr_b16 a[186:187], v5 offset:9216
ds_read_b64_tr_b16 a[188:189], v5 offset:12288
ds_read_b64_tr_b16 a[190:191], v5 offset:13312
ds_read_b64_tr_b16 a[192:193], v5 offset:16384
ds_read_b64_tr_b16 a[194:195], v5 offset:17408
ds_read_b64_tr_b16 a[196:197], v5 offset:20480
ds_read_b64_tr_b16 a[198:199], v5 offset:21504
ds_read_b64_tr_b16 v[248:249], v5 offset:24576
ds_read_b64_tr_b16 v[250:251], v5 offset:25600
ds_read_b64_tr_b16 v[252:253], v5 offset:28672
ds_read_b64_tr_b16 v[254:255], v5 offset:29696
s_waitcnt lgkmcnt(0)
s_waitcnt vmcnt(24)
s_barrier
s_mov_b32 m0, 69632
s_add_u32 s48, s49, 4980864
buffer_load_dwordx4 v10, s[16:19], s48 offen lds
s_mov_b32 m0, 70656
s_add_u32 s48, s49, 5046400
buffer_load_dwordx4 v10, s[16:19], s48 offen lds
s_mov_b32 m0, 77824
s_add_u32 s48, s50, 81920
buffer_load_dwordx4 v11, s[20:23], s48 offen lds
s_mov_b32 m0, 78848
s_add_u32 s48, s50, 87040
buffer_load_dwordx4 v11, s[20:23], s48 offen lds
s_mov_b32 m0, 86016
s_add_u32 s48, s50, 102400
buffer_load_dwordx4 v11, s[20:23], s48 offen lds
s_mov_b32 m0, 87040
s_add_u32 s48, s50, 107520
buffer_load_dwordx4 v11, s[20:23], s48 offen lds
s_mov_b32 m0, 94208
s_add_u32 s48, s50, 122880
buffer_load_dwordx4 v11, s[20:23], s48 offen lds
s_mov_b32 m0, 95232
s_add_u32 s48, s50, 128000
buffer_load_dwordx4 v11, s[20:23], s48 offen lds
ds_read_b64_tr_b16 a[200:201], v5 offset:32768
ds_read_b64_tr_b16 a[202:203], v5 offset:33792
ds_read_b64_tr_b16 a[204:205], v5 offset:36864
ds_read_b64_tr_b16 a[206:207], v5 offset:37888
ds_read_b64_tr_b16 v[80:81], v5 offset:40960
ds_read_b64_tr_b16 v[82:83], v5 offset:41984
ds_read_b64_tr_b16 v[84:85], v5 offset:45056
ds_read_b64_tr_b16 v[86:87], v5 offset:46080
ds_read_b64_tr_b16 v[88:89], v5 offset:49152
ds_read_b64_tr_b16 v[90:91], v5 offset:50176
ds_read_b64_tr_b16 v[92:93], v5 offset:53248
ds_read_b64_tr_b16 v[94:95], v5 offset:54272
ds_read_b64_tr_b16 v[96:97], v5 offset:57344
ds_read_b64_tr_b16 v[98:99], v5 offset:58368
ds_read_b64_tr_b16 v[100:101], v5 offset:61440
ds_read_b64_tr_b16 v[102:103], v5 offset:62464
s_waitcnt lgkmcnt(0)
s_waitcnt vmcnt(24)
s_barrier
s_mov_b32 m0, 102400
s_add_u32 s48, s50, 143360
buffer_load_dwordx4 v11, s[20:23], s48 offen lds
s_mov_b32 m0, 103424
s_add_u32 s48, s50, 148480
buffer_load_dwordx4 v11, s[20:23], s48 offen lds
s_mov_b32 m0, 110592
s_add_u32 s48, s50, 82176
buffer_load_dwordx4 v11, s[20:23], s48 offen lds
s_mov_b32 m0, 111616
s_add_u32 s48, s50, 87296
buffer_load_dwordx4 v11, s[20:23], s48 offen lds
s_mov_b32 m0, 118784
s_add_u32 s48, s50, 102656
buffer_load_dwordx4 v11, s[20:23], s48 offen lds
s_mov_b32 m0, 119808
s_add_u32 s48, s50, 107776
buffer_load_dwordx4 v11, s[20:23], s48 offen lds
s_mov_b32 m0, 126976
s_add_u32 s48, s50, 123136
buffer_load_dwordx4 v11, s[20:23], s48 offen lds
s_mov_b32 m0, 128000
s_add_u32 s48, s50, 128256
buffer_load_dwordx4 v11, s[20:23], s48 offen lds
ds_read_b64_tr_b16 v[104:105], v6 offset:0
ds_read_b64_tr_b16 v[106:107], v6 offset:1024
ds_read_b64_tr_b16 v[108:109], v6 offset:4096
ds_read_b64_tr_b16 v[110:111], v6 offset:5120
ds_read_b64_tr_b16 v[240:241], v6 offset:8192
ds_read_b64_tr_b16 v[242:243], v6 offset:9216
ds_read_b64_tr_b16 v[244:245], v6 offset:12288
ds_read_b64_tr_b16 v[246:247], v6 offset:13312
ds_read_b64_tr_b16 a[240:241], v6 offset:16384
ds_read_b64_tr_b16 a[242:243], v6 offset:17408
ds_read_b64_tr_b16 a[244:245], v6 offset:20480
ds_read_b64_tr_b16 a[246:247], v6 offset:21504
ds_read_b64_tr_b16 a[248:249], v6 offset:24576
ds_read_b64_tr_b16 a[250:251], v6 offset:25600
ds_read_b64_tr_b16 a[252:253], v6 offset:28672
ds_read_b64_tr_b16 a[254:255], v6 offset:29696
s_waitcnt lgkmcnt(0)
s_waitcnt vmcnt(24)
s_barrier
s_mov_b32 m0, 135168
s_add_u32 s48, s50, 143616
buffer_load_dwordx4 v11, s[20:23], s48 offen lds
s_mov_b32 m0, 136192
s_add_u32 s48, s50, 148736
buffer_load_dwordx4 v11, s[20:23], s48 offen lds
s_mov_b32 m0, 143360
s_add_u32 s48, s50, 82432
buffer_load_dwordx4 v11, s[20:23], s48 offen lds
s_mov_b32 m0, 144384
s_add_u32 s48, s50, 87552
buffer_load_dwordx4 v11, s[20:23], s48 offen lds
s_mov_b32 m0, 151552
s_add_u32 s48, s50, 102912
buffer_load_dwordx4 v11, s[20:23], s48 offen lds
s_mov_b32 m0, 152576
s_add_u32 s48, s50, 108032
buffer_load_dwordx4 v11, s[20:23], s48 offen lds
s_mov_b32 m0, 159744
s_add_u32 s48, s50, 123392
buffer_load_dwordx4 v11, s[20:23], s48 offen lds
s_mov_b32 m0, 160768
s_add_u32 s48, s50, 128512
buffer_load_dwordx4 v11, s[20:23], s48 offen lds
ds_read_b64_tr_b16 v[72:73], v4 offset:0
ds_read_b64_tr_b16 v[74:75], v4 offset:1024
ds_read_b64_tr_b16 v[76:77], v4 offset:4096
ds_read_b64_tr_b16 v[78:79], v4 offset:5120
ds_read_b64_tr_b16 v[144:145], v4 offset:8192
ds_read_b64_tr_b16 v[146:147], v4 offset:9216
ds_read_b64_tr_b16 v[148:149], v4 offset:12288
ds_read_b64_tr_b16 v[150:151], v4 offset:13312
ds_read_b64_tr_b16 v[152:153], v4 offset:16384
ds_read_b64_tr_b16 v[154:155], v4 offset:17408
ds_read_b64_tr_b16 v[156:157], v4 offset:20480
ds_read_b64_tr_b16 v[158:159], v4 offset:21504
ds_read_b64_tr_b16 v[160:161], v4 offset:24576
ds_read_b64_tr_b16 v[162:163], v4 offset:25600
ds_read_b64_tr_b16 v[164:165], v4 offset:28672
ds_read_b64_tr_b16 v[166:167], v4 offset:29696
s_waitcnt lgkmcnt(0)
s_waitcnt vmcnt(24)
s_barrier
s_mov_b32 m0, 4096
s_add_u32 s48, s50, 143872
buffer_load_dwordx4 v11, s[20:23], s48 offen lds
s_mov_b32 m0, 5120
s_add_u32 s48, s50, 148992
buffer_load_dwordx4 v11, s[20:23], s48 offen lds
s_mov_b32 m0, 12288
s_add_u32 s48, s49, 262144
buffer_load_dwordx4 v10, s[12:15], s48 offen lds
s_mov_b32 m0, 13312
s_add_u32 s48, s49, 327680
buffer_load_dwordx4 v10, s[12:15], s48 offen lds
s_mov_b32 m0, 20480
s_add_u32 s48, s49, 786432
buffer_load_dwordx4 v10, s[12:15], s48 offen lds
s_mov_b32 m0, 21504
s_add_u32 s48, s49, 851968
buffer_load_dwordx4 v10, s[12:15], s48 offen lds
s_mov_b32 m0, 28672
s_add_u32 s48, s49, 1310720
buffer_load_dwordx4 v10, s[12:15], s48 offen lds
s_mov_b32 m0, 29696
s_add_u32 s48, s49, 1376256
buffer_load_dwordx4 v10, s[12:15], s48 offen lds
ds_read_b64_tr_b16 v[168:169], v4 offset:32768
ds_read_b64_tr_b16 v[170:171], v4 offset:33792
ds_read_b64_tr_b16 v[172:173], v4 offset:36864
ds_read_b64_tr_b16 v[174:175], v4 offset:37888
ds_read_b64_tr_b16 v[112:113], v4 offset:40960
ds_read_b64_tr_b16 v[114:115], v4 offset:41984
ds_read_b64_tr_b16 v[116:117], v4 offset:45056
ds_read_b64_tr_b16 v[118:119], v4 offset:46080
ds_read_b64_tr_b16 v[120:121], v4 offset:49152
ds_read_b64_tr_b16 v[122:123], v4 offset:50176
ds_read_b64_tr_b16 v[124:125], v4 offset:53248
ds_read_b64_tr_b16 v[126:127], v4 offset:54272
ds_read_b64_tr_b16 v[128:129], v4 offset:57344
ds_read_b64_tr_b16 v[130:131], v4 offset:58368
ds_read_b64_tr_b16 v[132:133], v4 offset:61440
ds_read_b64_tr_b16 v[134:135], v4 offset:62464
s_waitcnt lgkmcnt(0)
s_waitcnt vmcnt(24)
s_barrier
s_mov_b32 m0, 36864
s_add_u32 s48, s49, 1835008
buffer_load_dwordx4 v10, s[12:15], s48 offen lds
s_mov_b32 m0, 37888
s_add_u32 s48, s49, 1900544
buffer_load_dwordx4 v10, s[12:15], s48 offen lds
s_mov_b32 m0, 45056
s_add_u32 s48, s49, 2359296
buffer_load_dwordx4 v10, s[12:15], s48 offen lds
s_mov_b32 m0, 46080
s_add_u32 s48, s49, 2424832
buffer_load_dwordx4 v10, s[12:15], s48 offen lds
s_mov_b32 m0, 53248
s_add_u32 s48, s49, 2883584
buffer_load_dwordx4 v10, s[12:15], s48 offen lds
s_mov_b32 m0, 54272
s_add_u32 s48, s49, 2949120
buffer_load_dwordx4 v10, s[12:15], s48 offen lds
s_mov_b32 m0, 61440
s_add_u32 s48, s49, 1310848
buffer_load_dwordx4 v10, s[16:19], s48 offen lds
s_mov_b32 m0, 62464
s_add_u32 s48, s49, 1376384
buffer_load_dwordx4 v10, s[16:19], s48 offen lds
ds_read_b64_tr_b16 v[136:137], v5 offset:0
ds_read_b64_tr_b16 v[138:139], v5 offset:1024
ds_read_b64_tr_b16 v[140:141], v5 offset:4096
ds_read_b64_tr_b16 v[142:143], v5 offset:5120
ds_read_b64_tr_b16 v[184:185], v8 offset:8192
ds_read_b64_tr_b16 v[186:187], v8 offset:8704
ds_read_b64_tr_b16 v[188:189], v8 offset:10240
ds_read_b64_tr_b16 v[190:191], v8 offset:10752
ds_read_b64_tr_b16 v[192:193], v8 offset:16384
ds_read_b64_tr_b16 v[194:195], v8 offset:16896
ds_read_b64_tr_b16 v[196:197], v8 offset:18432
ds_read_b64_tr_b16 v[198:199], v8 offset:18944
v_xor_b32 v12, v15, v8
ds_read_b64_tr_b16 v[40:41], v12 offset:24576
ds_read_b64_tr_b16 v[42:43], v12 offset:25088
ds_read_b64_tr_b16 v[44:45], v12 offset:26624
ds_read_b64_tr_b16 v[46:47], v12 offset:27136
s_waitcnt lgkmcnt(0)
buffer_store_dwordx4 v[40:43], v0, s[4:7], s61 offen offset:0
buffer_store_dwordx4 v[44:47], v0, s[4:7], s61 offen offset:1024
s_waitcnt vmcnt(26)
s_barrier
s_mov_b32 m0, 69632
s_add_u32 s48, s49, 1835136
buffer_load_dwordx4 v10, s[16:19], s48 offen lds
s_mov_b32 m0, 70656
s_add_u32 s48, s49, 1900672
buffer_load_dwordx4 v10, s[16:19], s48 offen lds
s_mov_b32 m0, 77824
s_add_u32 s48, s49, 2359424
buffer_load_dwordx4 v10, s[16:19], s48 offen lds
s_mov_b32 m0, 78848
s_add_u32 s48, s49, 2424960
buffer_load_dwordx4 v10, s[16:19], s48 offen lds
s_mov_b32 m0, 86016
s_add_u32 s48, s49, 2883712
buffer_load_dwordx4 v10, s[16:19], s48 offen lds
s_mov_b32 m0, 87040
s_add_u32 s48, s49, 2949248
buffer_load_dwordx4 v10, s[16:19], s48 offen lds
s_mov_b32 m0, 94208
s_add_u32 s48, s50, 82688
buffer_load_dwordx4 v11, s[20:23], s48 offen lds
s_mov_b32 m0, 95232
s_add_u32 s48, s50, 87808
buffer_load_dwordx4 v11, s[20:23], s48 offen lds
ds_read_b64_tr_b16 v[176:177], v8 offset:32768
ds_read_b64_tr_b16 v[178:179], v8 offset:33280
ds_read_b64_tr_b16 v[180:181], v8 offset:34816
ds_read_b64_tr_b16 v[182:183], v8 offset:35328
ds_read_b64_tr_b16 v[232:233], v8 offset:40960
ds_read_b64_tr_b16 v[234:235], v8 offset:41472
ds_read_b64_tr_b16 v[236:237], v8 offset:43008
ds_read_b64_tr_b16 v[238:239], v8 offset:43520
ds_read_b64_tr_b16 v[32:33], v8 offset:49152
ds_read_b64_tr_b16 v[34:35], v8 offset:49664
ds_read_b64_tr_b16 v[36:37], v8 offset:51200
ds_read_b64_tr_b16 v[38:39], v8 offset:51712
v_xor_b32 v12, v15, v8
ds_read_b64_tr_b16 v[40:41], v12 offset:57344
ds_read_b64_tr_b16 v[42:43], v12 offset:57856
ds_read_b64_tr_b16 v[44:45], v12 offset:59392
ds_read_b64_tr_b16 v[46:47], v12 offset:59904
s_waitcnt lgkmcnt(0)
buffer_store_dwordx4 v[32:35], v0, s[4:7], s62 offen offset:0
buffer_store_dwordx4 v[36:39], v0, s[4:7], s62 offen offset:1024
buffer_store_dwordx4 v[40:43], v0, s[4:7], s61 offen offset:2048
buffer_store_dwordx4 v[44:47], v0, s[4:7], s61 offen offset:3072
s_waitcnt vmcnt(30)
s_barrier
s_mov_b32 m0, 102400
s_add_u32 s48, s50, 103168
buffer_load_dwordx4 v11, s[20:23], s48 offen lds
s_mov_b32 m0, 103424
s_add_u32 s48, s50, 108288
buffer_load_dwordx4 v11, s[20:23], s48 offen lds
s_mov_b32 m0, 110592
s_add_u32 s48, s50, 123648
buffer_load_dwordx4 v11, s[20:23], s48 offen lds
s_mov_b32 m0, 111616
s_add_u32 s48, s50, 128768
buffer_load_dwordx4 v11, s[20:23], s48 offen lds
s_mov_b32 m0, 118784
s_add_u32 s48, s50, 144128
buffer_load_dwordx4 v11, s[20:23], s48 offen lds
s_mov_b32 m0, 119808
s_add_u32 s48, s50, 149248
buffer_load_dwordx4 v11, s[20:23], s48 offen lds
s_mov_b32 m0, 126976
s_add_u32 s48, s50, 82944
buffer_load_dwordx4 v11, s[20:23], s48 offen lds
s_mov_b32 m0, 128000
s_add_u32 s48, s50, 88064
buffer_load_dwordx4 v11, s[20:23], s48 offen lds
ds_read_b64_tr_b16 a[208:209], v9 offset:0
ds_read_b64_tr_b16 a[210:211], v9 offset:512
ds_read_b64_tr_b16 a[212:213], v9 offset:2048
ds_read_b64_tr_b16 a[214:215], v9 offset:2560
ds_read_b64_tr_b16 v[208:209], v9 offset:8192
ds_read_b64_tr_b16 v[210:211], v9 offset:8704
ds_read_b64_tr_b16 v[212:213], v9 offset:10240
ds_read_b64_tr_b16 v[214:215], v9 offset:10752
ds_read_b64_tr_b16 v[216:217], v9 offset:16384
ds_read_b64_tr_b16 v[218:219], v9 offset:16896
ds_read_b64_tr_b16 v[220:221], v9 offset:18432
ds_read_b64_tr_b16 v[222:223], v9 offset:18944
v_xor_b32 v12, v15, v9
ds_read_b64_tr_b16 v[200:201], v12 offset:24576
ds_read_b64_tr_b16 v[202:203], v12 offset:25088
ds_read_b64_tr_b16 v[204:205], v12 offset:26624
ds_read_b64_tr_b16 v[206:207], v12 offset:27136
s_waitcnt lgkmcnt(0)
s_waitcnt vmcnt(36)
s_barrier
s_mov_b32 m0, 135168
s_add_u32 s48, s50, 103424
buffer_load_dwordx4 v11, s[20:23], s48 offen lds
s_mov_b32 m0, 136192
s_add_u32 s48, s50, 108544
buffer_load_dwordx4 v11, s[20:23], s48 offen lds
s_mov_b32 m0, 143360
s_add_u32 s48, s50, 123904
buffer_load_dwordx4 v11, s[20:23], s48 offen lds
s_mov_b32 m0, 144384
s_add_u32 s48, s50, 129024
buffer_load_dwordx4 v11, s[20:23], s48 offen lds
s_mov_b32 m0, 151552
s_add_u32 s48, s50, 144384
buffer_load_dwordx4 v11, s[20:23], s48 offen lds
s_mov_b32 m0, 152576
s_add_u32 s48, s50, 149504
buffer_load_dwordx4 v11, s[20:23], s48 offen lds
s_mov_b32 m0, 159744
s_add_u32 s48, s49, 3407872
buffer_load_dwordx4 v10, s[8:11], s48 offen lds
s_mov_b32 m0, 160768
s_add_u32 s48, s49, 3473408
buffer_load_dwordx4 v10, s[8:11], s48 offen lds
ds_read_b64_tr_b16 v[16:17], v7 offset:0
ds_read_b64_tr_b16 v[18:19], v7 offset:512
ds_read_b64_tr_b16 v[20:21], v7 offset:2048
ds_read_b64_tr_b16 v[22:23], v7 offset:2560
s_waitcnt lgkmcnt(0)
buffer_store_dwordx4 v[16:19], v0, s[4:7], s62 offen offset:2048
buffer_store_dwordx4 v[20:23], v0, s[4:7], s62 offen offset:3072
s_waitcnt vmcnt(32)
s_barrier
ds_read_b64_tr_b16 v[16:17], v4 offset:8192
ds_read_b64_tr_b16 v[18:19], v4 offset:9216
ds_read_b64_tr_b16 v[20:21], v4 offset:12288
ds_read_b64_tr_b16 v[22:23], v4 offset:13312
ds_read_b64_tr_b16 v[24:25], v4 offset:16384
ds_read_b64_tr_b16 v[26:27], v4 offset:17408
ds_read_b64_tr_b16 v[28:29], v4 offset:20480
ds_read_b64_tr_b16 v[30:31], v4 offset:21504
ds_read_b64_tr_b16 v[32:33], v4 offset:24576
ds_read_b64_tr_b16 v[34:35], v4 offset:25600
ds_read_b64_tr_b16 v[36:37], v4 offset:28672
ds_read_b64_tr_b16 v[38:39], v4 offset:29696
ds_read_b64_tr_b16 v[40:41], v4 offset:32768
ds_read_b64_tr_b16 v[42:43], v4 offset:33792
ds_read_b64_tr_b16 v[44:45], v4 offset:36864
ds_read_b64_tr_b16 v[46:47], v4 offset:37888
ds_read_b64_tr_b16 v[48:49], v4 offset:40960
ds_read_b64_tr_b16 v[50:51], v4 offset:41984
ds_read_b64_tr_b16 v[52:53], v4 offset:45056
ds_read_b64_tr_b16 v[54:55], v4 offset:46080
ds_read_b64_tr_b16 v[56:57], v4 offset:49152
ds_read_b64_tr_b16 v[58:59], v4 offset:50176
ds_read_b64_tr_b16 v[60:61], v4 offset:53248
ds_read_b64_tr_b16 v[62:63], v4 offset:54272
ds_read_b64_tr_b16 v[64:65], v4 offset:57344
ds_read_b64_tr_b16 v[66:67], v4 offset:58368
ds_read_b64_tr_b16 v[68:69], v4 offset:61440
ds_read_b64_tr_b16 v[70:71], v4 offset:62464
s_waitcnt lgkmcnt(0)
s_barrier
ds_write_b128 v0, v[16:19] offset:36864
ds_write_b128 v0, v[20:23] offset:37888
ds_write_b128 v0, v[24:27] offset:38912
ds_write_b128 v0, v[28:31] offset:39936
ds_write_b128 v0, v[32:35] offset:40960
ds_write_b128 v0, v[36:39] offset:41984
ds_write_b128 v0, v[40:43] offset:43008
ds_write_b128 v0, v[44:47] offset:44032
ds_write_b128 v0, v[48:51] offset:45056
ds_write_b128 v0, v[52:55] offset:46080
ds_write_b128 v0, v[56:59] offset:47104
ds_write_b128 v0, v[60:63] offset:48128
ds_write_b128 v0, v[64:67] offset:49152
ds_write_b128 v0, v[68:71] offset:50176
s_waitcnt lgkmcnt(0)
s_waitcnt vmcnt(8)
s_barrier
ds_read_b64_tr_b16 v[16:17], v8 offset:24576
ds_read_b64_tr_b16 v[18:19], v8 offset:25088
ds_read_b64_tr_b16 v[20:21], v8 offset:26624
ds_read_b64_tr_b16 v[22:23], v8 offset:27136
ds_read_b64_tr_b16 v[24:25], v8 offset:32768
ds_read_b64_tr_b16 v[26:27], v8 offset:33280
ds_read_b64_tr_b16 v[28:29], v8 offset:34816
ds_read_b64_tr_b16 v[30:31], v8 offset:35328
v_xor_b32 v12, v15, v8
ds_read_b64_tr_b16 v[32:33], v12 offset:40960
ds_read_b64_tr_b16 v[34:35], v12 offset:41472
ds_read_b64_tr_b16 v[36:37], v12 offset:43008
ds_read_b64_tr_b16 v[38:39], v12 offset:43520
ds_read_b64_tr_b16 v[40:41], v8 offset:49152
ds_read_b64_tr_b16 v[42:43], v8 offset:49664
ds_read_b64_tr_b16 v[44:45], v8 offset:51200
ds_read_b64_tr_b16 v[46:47], v8 offset:51712
ds_read_b64_tr_b16 v[48:49], v8 offset:57344
ds_read_b64_tr_b16 v[50:51], v8 offset:57856
ds_read_b64_tr_b16 v[52:53], v8 offset:59392
ds_read_b64_tr_b16 v[54:55], v8 offset:59904
ds_read_b64_tr_b16 v[56:57], v9 offset:0
ds_read_b64_tr_b16 v[58:59], v9 offset:512
ds_read_b64_tr_b16 v[60:61], v9 offset:2048
ds_read_b64_tr_b16 v[62:63], v9 offset:2560
s_waitcnt lgkmcnt(0)
s_barrier
ds_write_b128 v2, v[16:19] offset:24576
ds_write_b128 v2, v[20:23] offset:25600
ds_write_b128 v2, v[232:235] offset:26624
ds_write_b128 v2, v[236:239] offset:27648
ds_write_b128 v2, v[224:227] offset:28672
ds_write_b128 v2, v[228:231] offset:29696
ds_write_b128 v2, v[40:43] offset:30720
ds_write_b128 v2, v[44:47] offset:31744
ds_write_b128 v2, v[48:51] offset:32768
ds_write_b128 v2, v[52:55] offset:33792
ds_write_b128 v2, v[248:251] offset:34816
ds_write_b128 v2, v[252:255] offset:35840
s_waitcnt lgkmcnt(0)
v_mov_b32 v232, v24
v_mov_b32 v233, v25
v_mov_b32 v234, v26
v_mov_b32 v235, v27
v_mov_b32 v236, v28
v_mov_b32 v237, v29
v_mov_b32 v238, v30
v_mov_b32 v239, v31
v_mov_b32 v224, v32
v_mov_b32 v225, v33
v_mov_b32 v226, v34
v_mov_b32 v227, v35
v_mov_b32 v228, v36
v_mov_b32 v229, v37
v_mov_b32 v230, v38
v_mov_b32 v231, v39
v_mov_b32 v248, v56
v_mov_b32 v249, v57
v_mov_b32 v250, v58
v_mov_b32 v251, v59
v_mov_b32 v252, v60
v_mov_b32 v253, v61
v_mov_b32 v254, v62
v_mov_b32 v255, v63
s_waitcnt vmcnt(2)
s_barrier
ds_read_b64_tr_b16 v[16:17], v5 offset:0
ds_read_b64_tr_b16 v[18:19], v5 offset:1024
ds_read_b64_tr_b16 v[20:21], v5 offset:4096
ds_read_b64_tr_b16 v[22:23], v5 offset:5120
ds_read_b64_tr_b16 v[24:25], v5 offset:8192
ds_read_b64_tr_b16 v[26:27], v5 offset:9216
ds_read_b64_tr_b16 v[28:29], v5 offset:12288
ds_read_b64_tr_b16 v[30:31], v5 offset:13312
ds_read_b64_tr_b16 v[32:33], v5 offset:16384
ds_read_b64_tr_b16 v[34:35], v5 offset:17408
ds_read_b64_tr_b16 v[36:37], v5 offset:20480
ds_read_b64_tr_b16 v[38:39], v5 offset:21504
v_xor_b32 v12, v15, v9
ds_read_b64_tr_b16 v[40:41], v12 offset:8192
ds_read_b64_tr_b16 v[42:43], v12 offset:8704
ds_read_b64_tr_b16 v[44:45], v12 offset:10240
ds_read_b64_tr_b16 v[46:47], v12 offset:10752
ds_read_b64_tr_b16 v[48:49], v9 offset:16384
ds_read_b64_tr_b16 v[50:51], v9 offset:16896
ds_read_b64_tr_b16 v[52:53], v9 offset:18432
ds_read_b64_tr_b16 v[54:55], v9 offset:18944
ds_read_b64_tr_b16 v[56:57], v6 offset:24576
ds_read_b64_tr_b16 v[58:59], v6 offset:25600
ds_read_b64_tr_b16 v[60:61], v6 offset:28672
ds_read_b64_tr_b16 v[62:63], v6 offset:29696
s_waitcnt lgkmcnt(0)
s_barrier
ds_write_b128 v2, a[176:179] offset:0
ds_write_b128 v2, a[180:183] offset:1024
ds_write_b128 v2, v[24:27] offset:2048
ds_write_b128 v2, v[28:31] offset:3072
ds_write_b128 v2, v[32:35] offset:4096
ds_write_b128 v2, v[36:39] offset:5120
ds_write_b128 v2, v[240:243] offset:6144
ds_write_b128 v2, v[244:247] offset:7168
ds_write_b128 v2, v[48:51] offset:8192
ds_write_b128 v2, v[52:55] offset:9216
ds_write_b128 v2, a[208:211] offset:10240
ds_write_b128 v2, a[212:215] offset:11264
s_waitcnt lgkmcnt(0)
v_accvgpr_write_b32 a176, v16
v_accvgpr_write_b32 a177, v17
v_accvgpr_write_b32 a178, v18
v_accvgpr_write_b32 a179, v19
v_accvgpr_write_b32 a180, v20
v_accvgpr_write_b32 a181, v21
v_accvgpr_write_b32 a182, v22
v_accvgpr_write_b32 a183, v23
v_mov_b32 v240, v40
v_mov_b32 v241, v41
v_mov_b32 v242, v42
v_mov_b32 v243, v43
v_mov_b32 v244, v44
v_mov_b32 v245, v45
v_mov_b32 v246, v46
v_mov_b32 v247, v47
v_accvgpr_write_b32 a208, v56
v_accvgpr_write_b32 a209, v57
v_accvgpr_write_b32 a210, v58
v_accvgpr_write_b32 a211, v59
v_accvgpr_write_b32 a212, v60
v_accvgpr_write_b32 a213, v61
v_accvgpr_write_b32 a214, v62
v_accvgpr_write_b32 a215, v63
s_mov_b32 s90, 0x300003
s_mov_b32 s91, 0x300003
s_mov_b32 s12, 0x3030303
s_mov_b32 s13, 0x3030303
s_mov_b32 s92, 0xc0000c
s_mov_b32 s93, 0xc0000c
s_mov_b32 s14, 0xc0c0c0c
s_mov_b32 s15, 0xc0c0c0c
s_mov_b32 s94, 0x30000300
s_mov_b32 s95, 0x30000300
s_mov_b32 s16, 0x30303030
s_mov_b32 s17, 0x30303030
s_mov_b32 s96, 0xc0000c00
s_mov_b32 s97, 0xc0000c00
s_mov_b32 s18, 0xc0c0c0c0
s_mov_b32 s19, 0xc0c0c0c0
s_mov_b32 s98, 0xff00ff00
s_mov_b32 s99, 0xff00ff00
v_mov_b32 v1, 0x4444
v_mov_b32 v4, 0xeeee
v_cndmask_b32 v1, v1, v4, s[98:99]
v_lshrrev_b32 v4, 8, v0
v_lshl_or_b32 v1, v4, 28, v1
v_bfe_u32 v4, v0, 4, 4
v_lshl_or_b32 v1, v4, 19, v1
s_mov_b32 s51, 0x3e0293ee
s_mov_b32 s52, 0x3f803f80
s_mov_b32 s53, 0x3f803f80
s_mov_b32 s54, 0x3f003f00
s_mov_b32 s55, 0x3f003f00
s_mov_b32 s56, 0xff800000
s_mov_b32 s57, 0xff800000
s_mov_b32 s58, 0x3f80
s_mov_b32 s8, s4
s_mov_b32 s9, s5
s_cmp_eq_u32 s30, 30
s_cselect_b32 s10, s6, 0
s_mov_b32 s31, 0
s_mov_b32 s45, -2
s_lshl_b32 s46, s30, 6
s_add_u32 s46, s46, 222330880
s_mov_b32 s20, s4
s_mov_b32 s21, s5
s_cmp_lt_u32 s30, 10
s_cselect_b32 s22, s6, 0
v_mov_b32 v3, -1
s_lshl_b32 s48, s30, 7
s_and_b32 s49, s30, 31
s_lshl_b32 s49, s49, 12
s_add_u32 s43, s49, 119734272
v_mov_b64 v[12:13], -1
s_add_u32 s38, s48, 119570432
s_add_u32 s39, s48, 119635968
s_add_u32 s40, s48, 119701504
s_add_u32 s41, s48, 119767040
s_add_u32 s42, s48, 119832576
v_lshrrev_b32 v4, 16, v1
buffer_store_dwordx2 v[12:13], v4, s[4:7], s38 offen sc1
buffer_store_dwordx2 v[12:13], v4, s[4:7], s39 offen sc1
buffer_store_dwordx2 v[12:13], v4, s[4:7], s40 offen sc1
buffer_store_dwordx2 v[12:13], v4, s[4:7], s41 offen sc1
buffer_store_dwordx2 v[12:13], v4, s[4:7], s42 offen sc1
k_lay_217:
s_add_u32 s47, s31, 63
s_mov_b32 s33, 120324096
s_mov_b32 s34, 120328192
s_mov_b32 s35, 120332288
s_mul_i32 s48, s31, 655360
s_lshl_b32 s36, s30, 14
s_add_u32 s36, s36, s48
s_add_u32 s36, s36, 8192
v_mov_b32 v12, -1
s_and_b32 s48, s30, 31
s_add_u32 s48, s48, 48
s_lshr_b32 s49, s48, 1
s_and_b32 s48, s48, 1
s_lshl_b32 s44, s49, 8
s_lshl_b32 s50, s48, 6
s_add_u32 s44, s44, s50
s_add_u32 s44, s44, s33
s_mul_i32 s48, s48, 5120
s_lshl_b32 s49, s49, 5
s_add_u32 s48, s48, s49
v_lshrrev_b32 v8, 4, v0
v_and_b32 v9, 3, v8
v_mul_u32_u24 v9, 1280, v9
v_bfe_u32 v10, v8, 2, 1
v_lshl_add_u32 v9, v10, 1, v9
v_bfe_u32 v10, v8, 4, 1
v_lshl_add_u32 v9, v10, 4, v9
v_bfe_u32 v10, v8, 5, 1
v_lshl_add_u32 v9, v10, 2, v9
buffer_load_ushort v10, v9, s[24:27], s48 offen
buffer_load_ushort v11, v9, s[24:27], s48 offen offset:8
v_and_b32 v45, 0x30, v0
v_lshrrev_b32 v46, 8, v0
v_lshl_or_b32 v45, v46, 2, v45
v_bfe_u32 v46, v0, 6, 1
v_lshl_or_b32 v45, v46, 7, v45
v_cndmask_b32 v45, v45, 2.0, s[98:99]
s_waitcnt vmcnt(0)
v_lshl_or_b32 v10, v11, 16, v10
s_lshl_b32 s63, s30, 10
s_add_u32 s63, s63, 120356864
s_lshl_b32 s37, s31, 14
s_add_u32 s37, s37, 117442560
s_add_u32 s59, s37, 4096
s_cmp_eq_u32 s31, 0
s_cbranch_scc1 k_l0_218
s_waitcnt vmcnt(0)
s_barrier
v_mov_b32 v8, 160
s_barrier
ds_read_b32 v9, v8
s_waitcnt lgkmcnt(0)
v_readfirstlane_b32 s64, v9
k_l0_218:
buffer_store_dword v10, v45, s[4:7], s44 offen sc1
s_add_u32 s44, s44, 16384
buffer_store_dword v12, v45, s[4:7], s44 offen sc1
s_waitcnt vmcnt(0)
s_barrier
v_mov_b32 v8, 160
s_barrier
ds_read_b32 v9, v8
s_waitcnt lgkmcnt(0)
v_readfirstlane_b32 s64, v9
v_lshlrev_b32 v23, v0, s58
v_cndmask_b32 v20, 0, v23, s[90:91]
v_cndmask_b32 v21, 0, v23, s[92:93]
v_cndmask_b32 v22, 0, v23, s[94:95]
v_cndmask_b32 v23, 0, v23, s[96:97]
s_cmp_lg_u32 s64, 0
s_cbranch_scc1 k_far_223
s_branch k_cold2_227
k_T0_225:
s_waitcnt vmcnt(2)
v_smfmac_f32_16x16x64_bf16 v[40:43], v[4:7], v[48:55], v1
s_waitcnt vmcnt(1)
v_cmp_u_f32 vcc, v4, v8
v_smfmac_f32_16x16x64_bf16 v[24:27], v[8:11], a[24:31], v1
v_smfmac_f32_16x16x64_bf16 v[28:31], v[8:11], a[32:39], v1
s_cbranch_vccnz k_cold_226
k_okC_228:
s_waitcnt vmcnt(1)
v_smfmac_f32_16x16x64_bf16 v[36:39], v[8:11], a[40:47], v1
s_waitcnt lgkmcnt(0)
ds_read_b128 v[48:51], v2 offset:0
v_smfmac_f32_16x16x64_bf16 v[32:35], v[4:7], v[64:71], v1
ds_read_b128 v[52:55], v2 offset:1024
ds_read_b128 v[64:67], v0 offset:38912
v_smfmac_f32_16x16x64_bf16 v[44:47], v[4:7], v[56:63], v1
ds_read_b128 v[68:71], v0 offset:39936
v_smfmac_f32_16x16x64_bf16 v[28:31], v[4:7], a[8:15], v1
v_smfmac_f32_16x16x64_bf16 v[24:27], v[4:7], a[0:7], v1
ds_read_b128 v[56:59], v2 offset:28672
v_smfmac_f32_16x16x64_bf16 v[36:39], v[4:7], a[16:23], v1
ds_read_b128 v[60:63], v2 offset:29696
s_waitcnt lgkmcnt(4)
v_smfmac_f32_16x16x64_bf16 v[40:43], v[8:11], v[48:55], v1
s_waitcnt vmcnt(0)
ds_write_b128 v0, v[12:15] offset:2048
s_waitcnt lgkmcnt(3)
v_smfmac_f32_16x16x64_bf16 v[32:35], v[8:11], v[64:71], v1
buffer_load_dwordx4 v[16:19], v0, s[4:7], s35 offen offset:0 sc1
v_cmp_u_f32 vcc, v12, v12
s_waitcnt lgkmcnt(1)
v_smfmac_f32_16x16x64_bf16 v[44:47], v[8:11], v[56:63], v1
ds_read_b128 v[56:59], v2 offset:2048
ds_read_b128 v[60:63], v2 offset:3072
ds_read_b128 v[64:67], v0 offset:45056
s_cbranch_vccnz k_coldA_229
k_okA_230:
v_smfmac_f32_16x16x64_bf16 v[36:39], v[12:15], a[64:71], v1
ds_read_b128 v[68:71], v0 offset:46080
s_waitcnt lgkmcnt(4)
v_smfmac_f32_16x16x64_bf16 v[40:43], v[12:15], a[72:79], v1
s_barrier
v_smfmac_f32_16x16x64_bf16 v[28:31], v[12:15], a[56:63], v1
ds_read_b128 v[8:11], v0 offset:3072
buffer_load_dwordx4 v[48:51], v0, s[4:7], s36 offen offset:0 sc1
s_waitcnt lgkmcnt(3)
v_smfmac_f32_16x16x64_bf16 v[44:47], v[12:15], v[56:63], v1
ds_read_b128 v[56:59], v2 offset:4096
v_smfmac_f32_16x16x64_bf16 v[24:27], v[12:15], a[48:55], v1
ds_read_b128 v[60:63], v2 offset:5120
s_waitcnt lgkmcnt(3)
v_smfmac_f32_16x16x64_bf16 v[32:35], v[12:15], v[64:71], v1
buffer_load_dwordx4 v[52:55], v0, s[4:7], s36 offen offset:1024 sc1
s_waitcnt lgkmcnt(2)
v_smfmac_f32_16x16x64_bf16 v[24:27], v[8:11], a[80:87], v1
ds_read_b128 v[64:67], v0 offset:47104
ds_read_b128 v[68:71], v0 offset:48128
v_smfmac_f32_16x16x64_bf16 v[36:39], v[8:11], a[96:103], v1
buffer_store_dword v3, v0, s[20:23], s63 offen
s_waitcnt lgkmcnt(2)
ds_read_b128 v[4:7], v0 offset:0
v_smfmac_f32_16x16x64_bf16 v[44:47], v[8:11], v[56:63], v1
ds_read_b128 v[56:59], v0 offset:49152
ds_read_b128 v[60:63], v0 offset:50176
v_smfmac_f32_16x16x64_bf16 v[28:31], v[8:11], a[88:95], v1
buffer_store_dwordx4 v[12:15], v0, s[8:11], s37 offen offset:2048 sc1
v_smfmac_f32_16x16x64_bf16 v[40:43], v[8:11], a[104:111], v1
s_waitcnt lgkmcnt(3)
s_waitcnt lgkmcnt(2)
v_smfmac_f32_16x16x64_bf16 v[32:35], v[8:11], v[64:71], v1
ds_read_b128 v[64:67], v0 offset:40960
ds_read_b128 v[12:15], v0 offset:1024
v_smfmac_f32_16x16x64_bf16 v[36:39], v[4:7], a[128:135], v1
s_waitcnt lgkmcnt(2)
v_smfmac_f32_16x16x64_bf16 v[44:47], v[4:7], v[56:63], v1
ds_read_b128 v[68:71], v0 offset:41984
buffer_load_dwordx4 v[56:59], v0, s[4:7], s36 offen offset:2048 sc1
v_smfmac_f32_16x16x64_bf16 v[28:31], v[4:7], a[120:127], v1
v_smfmac_f32_16x16x64_bf16 v[24:27], v[4:7], a[112:119], v1
s_waitcnt vmcnt(5)
ds_write_b128 v0, v[16:19] offset:6144
v_smfmac_f32_16x16x64_bf16 v[40:43], v[4:7], a[136:143], v1
s_waitcnt lgkmcnt(1)
buffer_load_dwordx4 v[60:63], v0, s[4:7], s36 offen offset:3072 sc1
v_cmp_u_f32 vcc, v16, v16
v_smfmac_f32_16x16x64_bf16 v[32:35], v[4:7], v[64:71], v1
ds_read_b128 v[64:67], v0 offset:43008
ds_read_b128 v[68:71], v0 offset:44032
v_smfmac_f32_16x16x64_bf16 v[28:31], v[12:15], a[152:159], v1
v_smfmac_f32_16x16x64_bf16 v[24:27], v[12:15], a[144:151], v1
s_cbranch_vccnz k_coldB_231
k_okB_232:
v_smfmac_f32_16x16x64_bf16 v[36:39], v[12:15], a[160:167], v1
s_waitcnt lgkmcnt(2)
buffer_store_dwordx4 v[16:19], v0, s[8:11], s59 offen offset:2048 sc1
s_barrier
ds_read_b128 v[4:7], v0 offset:4096
v_smfmac_f32_16x16x64_bf16 v[44:47], v[12:15], a[176:183], v1
ds_read_b128 v[8:11], v0 offset:7168
s_waitcnt lgkmcnt(2)
v_smfmac_f32_16x16x64_bf16 v[32:35], v[12:15], v[64:71], v1
ds_read_b128 v[64:67], v2 offset:34816
ds_read_b128 v[68:71], v2 offset:35840
v_smfmac_f32_16x16x64_bf16 v[24:27], v[16:19], a[184:191], v1
v_smfmac_f32_16x16x64_bf16 v[40:43], v[12:15], a[168:175], v1
s_waitcnt lgkmcnt(3)
ds_read_b128 v[12:15], v0 offset:5120
v_smfmac_f32_16x16x64_bf16 v[24:27], v[4:7], a[208:215], v1
s_waitcnt lgkmcnt(3)
v_smfmac_f32_16x16x64_bf16 v[28:31], v[4:7], a[216:223], v1
v_smfmac_f32_16x16x64_bf16 v[28:31], v[8:11], a[200:207], v1
s_waitcnt lgkmcnt(1)
v_smfmac_f32_16x16x64_bf16 v[24:27], v[8:11], v[64:71], v1
ds_read_b128 v[64:67], v2 offset:6144
s_waitcnt lgkmcnt(1)
v_smfmac_f32_16x16x64_bf16 v[24:27], v[12:15], a[224:231], v1
ds_read_b128 v[68:71], v2 offset:7168
v_smfmac_f32_16x16x64_bf16 v[28:31], v[12:15], a[232:239], v1
v_smfmac_f32_16x16x64_bf16 v[28:31], v[16:19], a[192:199], v1
v_cvt_pk_bf16_f32 v24, v24, v25
v_cvt_pk_bf16_f32 v25, v26, v27
v_smfmac_f32_16x16x64_bf16 v[32:35], v[4:7], v[80:87], v1
v_cvt_pk_bf16_f32 v26, v28, v29
v_cvt_pk_bf16_f32 v27, v30, v31
v_smfmac_f32_16x16x64_bf16 v[32:35], v[8:11], a[248:255], v1
s_waitcnt lgkmcnt(0)
v_mfma_f32_16x16x32_bf16 v[28:31], v[24:27], v[20:23], 0
v_and_b32 v26, 0xffffff7f, v0
v_smfmac_f32_16x16x64_bf16 v[32:35], v[16:19], v[64:71], v1
v_and_or_b32 v26, v1, 8, v26
v_mul_f32 v28, s51, v28
v_mul_f32 v29, s51, v29
v_mul_f32 v31, s51, v31
v_cvt_pk_bf16_f32 v24, v28, v29
v_mul_f32 v30, s51, v30
v_cvt_pk_bf16_f32 v25, v30, v31
v_smfmac_f32_16x16x64_bf16 v[32:35], v[12:15], v[96:103], v1
ds_write_b64 v26, v[24:25] offset:1024
v_smfmac_f32_16x16x64_bf16 v[36:39], v[8:11], v[72:79], v1
v_cvt_pk_bf16_f32 v32, v32, v33
v_smfmac_f32_16x16x64_bf16 v[36:39], v[16:19], a[240:247], v1
buffer_load_dwordx4 v[64:67], v0, s[4:7], s61 offen offset:0
v_cvt_pk_bf16_f32 v33, v34, v35
v_smfmac_f32_16x16x64_bf16 v[36:39], v[12:15], v[104:111], v1
s_waitcnt lgkmcnt(0)
v_smfmac_f32_16x16x64_bf16 v[36:39], v[4:7], v[88:95], v1
s_barrier
ds_read_b128 v[24:27], v0 offset:0
v_smfmac_f32_16x16x64_bf16 v[40:43], v[4:7], v[144:151], v1
ds_read_b128 v[28:31], v0 offset:1024
s_nop 0
v_cvt_pk_bf16_f32 v34, v36, v37
v_cvt_pk_bf16_f32 v35, v38, v39
s_nop 1
v_mfma_f32_16x16x32_bf16 v[36:39], v[32:35], v[20:23], 0
s_waitcnt vmcnt(6)
buffer_load_dwordx4 v[68:71], v0, s[4:7], s61 offen offset:1024
v_and_b32 v34, 0xffffff7f, v0
v_and_or_b32 v34, v1, 8, v34
s_waitcnt lgkmcnt(1)
v_mfma_f32_16x16x32_bf16 v[48:51], v[48:51], v[24:27], 0
v_cvt_pk_bf16_f32 v32, v36, v37
s_waitcnt lgkmcnt(0)
v_mfma_f32_16x16x32_bf16 v[48:51], v[52:55], v[28:31], v[48:51]
v_mov_b64 v[52:53], s[56:57]
v_cvt_pk_bf16_f32 v33, v38, v39
v_smfmac_f32_16x16x64_bf16 v[44:47], v[4:7], v[152:159], v1
ds_write_b64 v34, v[32:33] offset:3072
v_permlane32_swap_b32 v48, v50
v_permlane32_swap_b32 v49, v51
v_add_f32_dpp v52, v50, v48 row_ror:8 row_mask:0xf bank_mask:0x3
v_exp_f32 v52, v52
v_add_f32_dpp v53, v51, v49 row_ror:8 row_mask:0xf bank_mask:0x3
v_exp_f32 v53, v53
s_nop 0
v_cvt_pk_bf16_f32 v48, v52, v53
v_smfmac_f32_16x16x64_bf16 v[44:47], v[16:19], v[120:127], v1
ds_write_b32 v0, v48 offset:4104
v_smfmac_f32_16x16x64_bf16 v[44:47], v[12:15], v[168:175], v1
buffer_load_dwordx4 v[48:51], v0, s[4:7], s61 offen offset:2048
v_smfmac_f32_16x16x64_bf16 v[40:43], v[12:15], v[160:167], v1
s_waitcnt lgkmcnt(1)
v_xor_b32 v12, 0x80, v0
v_smfmac_f32_16x16x64_bf16 v[40:43], v[8:11], v[128:135], v1
s_waitcnt lgkmcnt(0)
s_barrier
ds_read_b128 v[32:35], v0 offset:2048
v_mov_b64 v[22:23], s[52:53]
v_smfmac_f32_16x16x64_bf16 v[40:43], v[16:19], v[112:119], v1
ds_read_b128 v[36:39], v0 offset:3072
ds_read_b128 v[16:19], v0 offset:4096
buffer_load_dwordx4 v[52:55], v0, s[4:7], s61 offen offset:3072
v_smfmac_f32_16x16x64_bf16 v[44:47], v[8:11], v[136:143], v1
ds_read_b128 v[12:15], v12 offset:4096
v_cvt_pk_bf16_f32 v40, v40, v41
v_mov_b64 v[20:21], s[52:53]
s_waitcnt lgkmcnt(3)
v_mfma_f32_16x16x32_bf16 v[24:27], v[32:35], v[24:27], 0
v_cvt_pk_bf16_f32 v41, v42, v43
s_waitcnt lgkmcnt(2)
v_mfma_f32_16x16x32_bf16 v[24:27], v[36:39], v[28:31], v[24:27]
s_waitcnt vmcnt(5)
s_waitcnt lgkmcnt(1)
v_mfma_f32_16x16x32_bf16 v[8:11], v[56:59], v[16:19], 0
buffer_load_dwordx4 v[56:59], v0, s[4:7], s62 offen offset:0
v_mov_b64 v[28:29], s[56:57]
v_cvt_pk_bf16_f32 v43, v46, v47
v_cvt_pk_bf16_f32 v42, v44, v45
v_permlane32_swap_b32 v25, v27
v_permlane32_swap_b32 v24, v26
v_mfma_f32_16x16x32_bf16 v[4:7], v[20:23], v[16:19], 0
s_waitcnt lgkmcnt(0)
v_add_f32_dpp v28, v26, v24 row_ror:8 row_mask:0xf bank_mask:0x3
v_add_f32_dpp v29, v27, v25 row_ror:8 row_mask:0xf bank_mask:0x3
v_exp_f32 v28, v28
v_mfma_f32_16x16x32_bf16 v[8:11], v[60:63], v[12:15], v[8:11]
buffer_load_dwordx4 v[60:63], v0, s[4:7], s62 offen offset:1024
v_exp_f32 v29, v29
v_permlane32_swap_b32 v42, v43
v_cvt_pk_bf16_f32 v24, v28, v29
v_mov_b64 v[44:45], s[54:55]
v_cvt_pk_bf16_f32 v25, v28, v29
v_mov_b32_dpp v26, v24 row_ror:8 row_mask:0xf bank_mask:0xf
v_mov_b32_dpp v27, v24 row_ror:8 row_mask:0xf bank_mask:0xf
v_mfma_f32_16x16x16_bf16 v[4:7], v[44:45], v[24:25], v[4:7]
v_permlane32_swap_b32 v40, v41
v_mov_b64 v[36:37], 0
v_mov_b64 v[38:39], 0
v_mov_b64 v[30:31], 0
v_mfma_f32_16x16x32_bf16 v[8:11], v[40:43], v[24:27], v[8:11]
buffer_load_dwordx4 v[16:19], v0, s[4:7], s62 offen offset:2048
v_rcp_f32 v6, v4
v_and_b32 v12, 0xffffff7f, v0
v_and_or_b32 v13, v1, 8, v12
v_rcp_f32_dpp v6, v4 row_ror:8 row_mask:0xf bank_mask:0xc
v_mov_b64 v[26:27], 0
v_pk_mul_f32 v[8:9], v[8:9], v[6:7] op_sel_hi:[1,0]
v_cvt_pk_bf16_f32 v44, v8, v9
v_pk_mul_f32 v[10:11], v[10:11], v[6:7] op_sel_hi:[1,0]
v_cvt_pk_bf16_f32 v45, v10, v11
s_waitcnt vmcnt(5)
ds_write_b64 v13, v[44:45] offset:7168
buffer_load_dwordx4 v[20:23], v0, s[4:7], s62 offen offset:3072
v_add_u32 v6, 0xd4800000, v6
v_cmp_lt_u32 vcc, 0x28000000, v6
v_mov_b64 v[34:35], 0
v_mov_b32_dpp v46, v44 row_ror:8 row_mask:0xf bank_mask:0xf
v_mov_b32_dpp v47, v45 row_ror:8 row_mask:0xf bank_mask:0xf
v_mov_b64 v[28:29], 0
v_mov_b64 v[32:33], 0
s_cbranch_vccnz k_slow_233
k_okS_234:
v_smfmac_f32_16x16x64_bf16 v[36:39], v[44:47], v[224:231], v1
s_waitcnt lgkmcnt(0)
s_barrier
ds_read_b128 v[8:11], v12 offset:6144
v_smfmac_f32_16x16x64_bf16 v[32:35], v[44:47], v[200:207], v1
s_waitcnt vmcnt(4)
ds_read_b128 v[4:7], v12 offset:7296
v_mov_b64 v[24:25], 0
v_smfmac_f32_16x16x64_bf16 v[28:31], v[44:47], v[48:55], v1
ds_read_b128 v[12:15], v12 offset:6272
ds_read_b128 v[48:51], v2 offset:26624
v_smfmac_f32_16x16x64_bf16 v[24:27], v[44:47], v[64:71], v1
ds_read_b128 v[52:55], v2 offset:27648
v_mov_b64 v[42:43], 0
s_waitcnt lgkmcnt(4)
v_smfmac_f32_16x16x64_bf16 v[24:27], v[8:11], v[184:191], v1
s_waitcnt lgkmcnt(3)
v_mov_b64 v[40:41], 0
v_smfmac_f32_16x16x64_bf16 v[24:27], v[4:7], v[176:183], v1
s_waitcnt lgkmcnt(2)
ds_read_b128 v[64:67], v2 offset:10240
v_smfmac_f32_16x16x64_bf16 v[24:27], v[12:15], v[192:199], v1
ds_read_b128 v[68:71], v2 offset:11264
v_smfmac_f32_16x16x64_bf16 v[40:43], v[44:47], v[240:247], v1
s_waitcnt vmcnt(2)
s_waitcnt lgkmcnt(2)
v_lshrrev_b32 v44, 16, v1
v_cvt_pk_bf16_f32 v24, v24, v25
v_bfi_b32 v24, 1, s45, v24
v_cvt_pk_bf16_f32 v25, v26, v27
v_smfmac_f32_16x16x64_bf16 v[28:31], v[8:11], v[48:55], v1
buffer_store_dwordx2 v[24:25], v44, s[4:7], s38 offen
ds_read_b128 v[48:51], v2 offset:24576
ds_read_b128 v[52:55], v2 offset:25600
v_smfmac_f32_16x16x64_bf16 v[28:31], v[12:15], v[56:63], v1
s_waitcnt lgkmcnt(2)
ds_read_b128 v[56:59], v2 offset:8192
v_smfmac_f32_16x16x64_bf16 v[28:31], v[4:7], v[64:71], v1
ds_read_b128 v[60:63], v2 offset:9216
v_smfmac_f32_16x16x64_bf16 v[32:35], v[8:11], v[208:215], v1
ds_read_b128 v[64:67], v2 offset:30720
s_nop 0
v_cvt_pk_bf16_f32 v28, v28, v29
v_bfi_b32 v28, 1, s45, v28
v_cvt_pk_bf16_f32 v29, v30, v31
v_smfmac_f32_16x16x64_bf16 v[32:35], v[12:15], v[216:223], v1
buffer_store_dwordx2 v[28:29], v44, s[4:7], s39 offen
v_smfmac_f32_16x16x64_bf16 v[40:43], v[12:15], v[248:255], v1
ds_read_b128 v[68:71], v2 offset:31744
s_waitcnt vmcnt(2)
v_smfmac_f32_16x16x64_bf16 v[32:35], v[4:7], v[16:23], v1
s_waitcnt lgkmcnt(2)
v_smfmac_f32_16x16x64_bf16 v[36:39], v[12:15], v[232:239], v1
ds_read_b128 v[16:19], v2 offset:32768
ds_read_b128 v[20:23], v2 offset:33792
v_cvt_pk_bf16_f32 v32, v32, v33
v_bfi_b32 v32, 1, s45, v32
v_cvt_pk_bf16_f32 v33, v34, v35
v_smfmac_f32_16x16x64_bf16 v[36:39], v[8:11], v[48:55], v1
buffer_store_dwordx2 v[32:33], v44, s[4:7], s40 offen
s_waitcnt lgkmcnt(2)
v_smfmac_f32_16x16x64_bf16 v[36:39], v[4:7], v[64:71], v1
s_nop 6
v_cvt_pk_bf16_f32 v36, v36, v37
v_cvt_pk_bf16_f32 v37, v38, v39
s_waitcnt lgkmcnt(0)
v_bfi_b32 v36, 1, s45, v36
v_smfmac_f32_16x16x64_bf16 v[40:43], v[8:11], v[16:23], v1
buffer_store_dwordx2 v[36:37], v44, s[4:7], s41 offen
v_smfmac_f32_16x16x64_bf16 v[40:43], v[4:7], v[56:63], v1
s_nop 6
v_cvt_pk_bf16_f32 v40, v40, v41
v_bfi_b32 v40, 1, s45, v40
v_cvt_pk_bf16_f32 v41, v42, v43
buffer_store_dwordx2 v[40:41], v44, s[4:7], s42 offen
s_barrier
v_lshlrev_b32 v23, v0, s58
v_cndmask_b32 v16, 0, v23, s[12:13]
v_cndmask_b32 v17, 0, v23, s[14:15]
v_cndmask_b32 v18, 0, v23, s[16:17]
v_cndmask_b32 v19, 0, v23, s[18:19]
v_and_b32 v45, 0x30, v0
v_lshrrev_b32 v46, 8, v0
v_lshl_or_b32 v45, v46, 2, v45
v_bfe_u32 v46, v0, 6, 1
v_lshl_or_b32 v45, v46, 7, v45
v_cndmask_b32 v45, v45, 2.0, s[98:99]
buffer_load_dwordx4 v[48:51], v0, s[4:7], s60 offen offset:0
buffer_load_dwordx4 v[52:55], v0, s[4:7], s60 offen offset:1024
buffer_load_dwordx4 v[56:59], v0, s[4:7], s60 offen offset:2048
buffer_load_dwordx4 v[60:63], v0, s[4:7], s60 offen offset:3072
v_cndmask_b32 v20, 0, v23, s[90:91]
v_cndmask_b32 v21, 0, v23, s[92:93]
v_cndmask_b32 v22, 0, v23, s[94:95]
v_cndmask_b32 v23, 0, v23, s[96:97]
s_waitcnt vmcnt(4)
buffer_load_dwordx4 v[24:27], v0, s[4:7], s43 offen offset:0 sc1
buffer_load_dwordx4 v[28:31], v0, s[4:7], s43 offen offset:1024 sc1
buffer_load_dwordx4 v[32:35], v0, s[4:7], s43 offen offset:2048 sc1
buffer_load_dwordx4 v[36:39], v0, s[4:7], s43 offen offset:3072 sc1
s_add_u32 s33, s33, 16384
s_bitset0_b32 s33, 16
s_waitcnt vmcnt(3)
v_mfma_f32_16x16x32_bf16 v[40:43], v[24:27], v[16:19], 0
s_waitcnt vmcnt(2)
v_mfma_f32_16x16x32_bf16 v[40:43], v[28:31], v[16:19], v[40:43]
v_bitop3_b32 v46, v24, v28, s45 bitop3:0x7e
s_waitcnt vmcnt(1)
v_mfma_f32_16x16x32_bf16 v[40:43], v[32:35], v[16:19], v[40:43]
s_waitcnt vmcnt(0)
v_mfma_f32_16x16x32_bf16 v[40:43], v[36:39], v[16:19], v[40:43]
v_bitop3_b32 v47, v32, v36, s45 bitop3:0x7e
v_bitop3_b32 v46, v46, v47, 1 bitop3:0xa8
v_cmp_ne_u32 vcc, 0, v46
v_mov_b64 v[24:25], 0
v_mov_b64 v[26:27], 0
v_mov_b64 v[28:29], 0
v_mov_b64 v[30:31], 0
v_permlane32_swap_b32 v40, v41
v_permlane32_swap_b32 v42, v43
v_add_f32 v40, v40, v41
v_add_f32 v41, v42, v43
v_cvt_pk_bf16_f32 v42, v40, v41
s_cbranch_vccnz k_r1_236
k_ok1_237:
buffer_store_dword v42, v45, s[4:7], s44 offen
s_barrier
buffer_load_dwordx4 v[4:7], v0, s[4:7], s33 offen offset:0 sc1
buffer_load_dwordx4 v[8:11], v0, s[4:7], s33 offen offset:1024 sc1
s_add_u32 s34, s33, 4096
s_add_u32 s35, s33, 8192
s_add_u32 s36, s36, 524288
s_add_u32 s37, s37, 10240
s_add_u32 s59, s59, 10240
s_add_u32 s63, s63, 16384
s_bitset0_b32 s63, 16
v_mov_b64 v[32:33], 0
v_mov_b64 v[34:35], 0
v_mov_b64 v[36:37], 0
v_mov_b64 v[38:39], 0
v_mov_b64 v[40:41], 0
v_mov_b64 v[42:43], 0
v_mov_b64 v[44:45], 0
v_mov_b64 v[46:47], 0
s_add_u32 s44, s44, 16384
s_bitset0_b32 s44, 16
s_sub_u32 s45, s45, 1
s_add_u32 s31, s31, 1
ds_read_b128 v[64:67], v0 offset:36864
ds_read_b128 v[68:71], v0 offset:37888
s_waitcnt lgkmcnt(0)
buffer_load_dwordx4 v[12:15], v0, s[4:7], s34 offen offset:0 sc1
s_cmp_lg_u32 s31, s47
s_cbranch_scc1 k_T0_225
s_branch k_done_235
k_cold2_227:
s_barrier
buffer_load_dwordx4 v[48:51], v0, s[4:7], s60 offen offset:0
buffer_load_dwordx4 v[52:55], v0, s[4:7], s60 offen offset:1024
buffer_load_dwordx4 v[56:59], v0, s[4:7], s60 offen offset:2048
buffer_load_dwordx4 v[60:63], v0, s[4:7], s60 offen offset:3072
ds_read_b128 v[64:67], v0 offset:36864
ds_read_b128 v[68:71], v0 offset:37888
k_cold_226:
buffer_load_dwordx4 v[4:7], v0, s[4:7], s33 offen offset:0 sc1
buffer_load_dwordx4 v[8:11], v0, s[4:7], s33 offen offset:1024 sc1
buffer_load_dwordx4 v[12:15], v0, s[4:7], s34 offen offset:0 sc1
s_sub_u32 s32, s32, 1
s_cmp_gt_i32 s32, 0
s_cbranch_scc0 k_okC_228
v_mov_b64 v[24:25], 0
v_mov_b64 v[26:27], 0
v_mov_b64 v[28:29], 0
v_mov_b64 v[30:31], 0
v_mov_b64 v[32:33], 0
v_mov_b64 v[34:35], 0
v_mov_b64 v[36:37], 0
v_mov_b64 v[38:39], 0
v_mov_b64 v[40:41], 0
v_mov_b64 v[42:43], 0
v_mov_b64 v[44:45], 0
v_mov_b64 v[46:47], 0
s_branch k_T0_225
k_coldA_229:
buffer_load_dwordx4 v[12:15], v0, s[4:7], s34 offen offset:0 sc1
s_sub_u32 s32, s32, 1
s_cmp_gt_i32 s32, 0
s_waitcnt vmcnt(0)
v_cmp_u_f32 vcc, v12, v12
ds_write_b128 v0, v[12:15] offset:2048
s_waitcnt lgkmcnt(0)
s_cbranch_vccz k_okA_230
s_cbranch_scc1 k_coldA_229
s_branch k_okA_230
k_coldB_231:
buffer_load_dwordx4 v[16:19], v0, s[4:7], s35 offen offset:0 sc1
s_sub_u32 s32, s32, 1
s_cmp_gt_i32 s32, 0
s_waitcnt vmcnt(0)
v_cmp_u_f32 vcc, v16, v16
ds_write_b128 v0, v[16:19] offset:6144
s_waitcnt lgkmcnt(0)
s_cbranch_vccz k_okB_232
s_cbranch_scc1 k_coldB_231
s_branch k_okB_232
k_r1_236:
buffer_load_dwordx4 v[24:27], v0, s[4:7], s43 offen offset:0 sc1
buffer_load_dwordx4 v[28:31], v0, s[4:7], s43 offen offset:1024 sc1
buffer_load_dwordx4 v[32:35], v0, s[4:7], s43 offen offset:2048 sc1
buffer_load_dwordx4 v[36:39], v0, s[4:7], s43 offen offset:3072 sc1
s_sub_u32 s32, s32, 1
s_cmp_gt_i32 s32, 0
s_waitcnt vmcnt(3)
v_mfma_f32_16x16x32_bf16 v[40:43], v[24:27], v[16:19], 0
s_waitcnt vmcnt(2)
v_mfma_f32_16x16x32_bf16 v[40:43], v[28:31], v[16:19], v[40:43]
v_bitop3_b32 v46, v24, v28, s45 bitop3:0x7e
s_waitcnt vmcnt(1)
v_mfma_f32_16x16x32_bf16 v[40:43], v[32:35], v[16:19], v[40:43]
s_waitcnt vmcnt(0)
v_mfma_f32_16x16x32_bf16 v[40:43], v[36:39], v[16:19], v[40:43]
v_bitop3_b32 v47, v32, v36, s45 bitop3:0x7e
v_bitop3_b32 v46, v46, v47, 1 bitop3:0xa8
v_cmp_ne_u32 vcc, 0, v46
v_mov_b64 v[24:25], 0
v_mov_b64 v[26:27], 0
v_mov_b64 v[28:29], 0
v_mov_b64 v[30:31], 0
v_permlane32_swap_b32 v40, v41
v_permlane32_swap_b32 v42, v43
v_add_f32 v40, v40, v41
v_add_f32 v41, v42, v43
v_cvt_pk_bf16_f32 v42, v40, v41
s_cbranch_vccz k_ok1_237
s_cbranch_scc1 k_r1_236
s_branch k_ok1_237
k_slow_233:
ds_read_b128 v[24:27], v0 offset:0
ds_read_b128 v[28:31], v0 offset:1024
v_mov_b32 v46, 0xff7fffff
s_add_u32 s48, s36, 0xffffe000
buffer_load_dwordx4 v[32:35], v0, s[4:7], s48 offen offset:0 sc1
buffer_load_dwordx4 v[36:39], v0, s[4:7], s48 offen offset:1024 sc1
s_waitcnt vmcnt(1) lgkmcnt(1)
v_mfma_f32_16x16x32_bf16 v[4:7], v[32:35], v[24:27], 0
s_waitcnt vmcnt(0) lgkmcnt(0)
v_mfma_f32_16x16x32_bf16 v[4:7], v[36:39], v[28:31], v[4:7]
v_mov_b64 v[8:9], s[56:57]
s_nop 5
v_permlane32_swap_b32 v4, v6
v_permlane32_swap_b32 v5, v7
v_add_f32_dpp v8, v6, v4 row_ror:8 row_mask:0xf bank_mask:0x3
s_nop 0
v_add_f32_dpp v9, v7, v5 row_ror:8 row_mask:0xf bank_mask:0x3
v_max3_f32 v46, v46, v8, v9
s_add_u32 s48, s36, 0xfffff000
buffer_load_dwordx4 v[32:35], v0, s[4:7], s48 offen offset:0 sc1
buffer_load_dwordx4 v[36:39], v0, s[4:7], s48 offen offset:1024 sc1
s_waitcnt vmcnt(1)
v_mfma_f32_16x16x32_bf16 v[4:7], v[32:35], v[24:27], 0
s_waitcnt vmcnt(0)
v_mfma_f32_16x16x32_bf16 v[4:7], v[36:39], v[28:31], v[4:7]
v_mov_b64 v[10:11], s[56:57]
s_nop 5
v_permlane32_swap_b32 v4, v6
v_permlane32_swap_b32 v5, v7
v_add_f32_dpp v10, v6, v4 row_ror:8 row_mask:0xf bank_mask:0x3
s_nop 0
v_add_f32_dpp v11, v7, v5 row_ror:8 row_mask:0xf bank_mask:0x3
v_max3_f32 v46, v46, v10, v11
s_add_u32 s48, s36, 0x0
buffer_load_dwordx4 v[32:35], v0, s[4:7], s48 offen offset:0 sc1
buffer_load_dwordx4 v[36:39], v0, s[4:7], s48 offen offset:1024 sc1
s_waitcnt vmcnt(1)
v_mfma_f32_16x16x32_bf16 v[4:7], v[32:35], v[24:27], 0
s_waitcnt vmcnt(0)
v_mfma_f32_16x16x32_bf16 v[4:7], v[36:39], v[28:31], v[4:7]
v_mov_b64 v[12:13], s[56:57]
s_nop 5
v_permlane32_swap_b32 v4, v6
v_permlane32_swap_b32 v5, v7
v_add_f32_dpp v12, v6, v4 row_ror:8 row_mask:0xf bank_mask:0x3
s_nop 0
v_add_f32_dpp v13, v7, v5 row_ror:8 row_mask:0xf bank_mask:0x3
v_max3_f32 v46, v46, v12, v13
s_add_u32 s48, s36, 0x1000
buffer_load_dwordx4 v[32:35], v0, s[4:7], s48 offen offset:0 sc1
buffer_load_dwordx4 v[36:39], v0, s[4:7], s48 offen offset:1024 sc1
s_waitcnt vmcnt(1)
v_mfma_f32_16x16x32_bf16 v[4:7], v[32:35], v[24:27], 0
s_waitcnt vmcnt(0)
v_mfma_f32_16x16x32_bf16 v[4:7], v[36:39], v[28:31], v[4:7]
v_mov_b64 v[14:15], s[56:57]
s_nop 5
v_permlane32_swap_b32 v4, v6
v_permlane32_swap_b32 v5, v7
v_add_f32_dpp v14, v6, v4 row_ror:8 row_mask:0xf bank_mask:0x3
s_nop 0
v_add_f32_dpp v15, v7, v5 row_ror:8 row_mask:0xf bank_mask:0x3
v_max3_f32 v46, v46, v14, v15
ds_read_b128 v[32:35], v0 offset:2048
ds_read_b128 v[36:39], v0 offset:3072
s_waitcnt lgkmcnt(1)
v_mfma_f32_16x16x32_bf16 v[4:7], v[32:35], v[24:27], 0
s_waitcnt lgkmcnt(0)
v_mfma_f32_16x16x32_bf16 v[4:7], v[36:39], v[28:31], v[4:7]
v_mov_b64 v[44:45], s[56:57]
s_nop 5
v_permlane32_swap_b32 v4, v6
v_permlane32_swap_b32 v5, v7
v_add_f32_dpp v44, v6, v4 row_ror:8 row_mask:0xf bank_mask:0x3
s_nop 0
v_add_f32_dpp v45, v7, v5 row_ror:8 row_mask:0xf bank_mask:0x3
v_max3_f32 v46, v46, v44, v45
buffer_load_dwordx4 v[32:35], v0, s[4:7], s36 offen offset:2048 sc1
buffer_load_dwordx4 v[36:39], v0, s[4:7], s36 offen offset:3072 sc1
v_mov_b32 v47, v46
s_nop 1
v_permlane32_swap_b32 v46, v47
v_max_f32 v46, v46, v47
v_mov_b32 v47, v46
s_nop 1
v_permlane16_swap_b32 v46, v47
v_max_f32 v46, v46, v47
v_sub_f32 v8, v8, v46
v_exp_f32 v8, v8
v_sub_f32 v9, v9, v46
v_exp_f32 v9, v9
v_sub_f32 v10, v10, v46
v_exp_f32 v10, v10
v_sub_f32 v11, v11, v46
v_exp_f32 v11, v11
v_sub_f32 v12, v12, v46
v_exp_f32 v12, v12
v_sub_f32 v13, v13, v46
v_exp_f32 v13, v13
v_sub_f32 v14, v14, v46
v_exp_f32 v14, v14
v_sub_f32 v15, v15, v46
v_exp_f32 v15, v15
v_sub_f32 v44, v44, v46
v_exp_f32 v44, v44
v_sub_f32 v45, v45, v46
v_exp_f32 v45, v45
v_cvt_pk_bf16_f32 v4, v8, v9
v_cvt_pk_bf16_f32 v5, v10, v11
v_cvt_pk_bf16_f32 v6, v12, v13
v_cvt_pk_bf16_f32 v7, v14, v15
v_mov_b32_dpp v8, v4 row_ror:8 row_mask:0xf bank_mask:0xf
v_mov_b32_dpp v9, v5 row_ror:8 row_mask:0xf bank_mask:0xf
v_mov_b32_dpp v10, v6 row_ror:8 row_mask:0xf bank_mask:0xf
v_mov_b32_dpp v11, v7 row_ror:8 row_mask:0xf bank_mask:0xf
v_cvt_pk_bf16_f32 v24, v44, v45
v_cvt_pk_bf16_f32 v25, v44, v45
s_nop 0
v_mov_b32_dpp v26, v24 row_ror:8 row_mask:0xf bank_mask:0xf
v_mov_b32_dpp v27, v24 row_ror:8 row_mask:0xf bank_mask:0xf
v_mov_b64 v[28:29], s[52:53]
v_mov_b64 v[30:31], s[52:53]
s_nop 1
v_mfma_f32_16x16x32_bf16 v[44:47], v[28:31], v[4:7], 0
s_waitcnt vmcnt(1)
v_mfma_f32_16x16x32_bf16 v[12:15], v[32:35], v[4:7], 0
s_waitcnt vmcnt(0)
v_mfma_f32_16x16x32_bf16 v[12:15], v[36:39], v[8:11], v[12:15]
v_mfma_f32_16x16x32_bf16 v[12:15], v[40:43], v[24:27], v[12:15]
v_mov_b64 v[28:29], s[54:55]
s_nop 1
v_mfma_f32_16x16x16_bf16 v[44:47], v[28:29], v[24:25], v[44:47]
s_nop 6
v_rcp_f32 v4, v44
s_nop 1
v_rcp_f32_dpp v4, v44 row_ror:8 row_mask:0xf bank_mask:0xc
s_nop 0
v_mul_f32 v12, v4, v12
v_mul_f32 v13, v4, v13
v_mul_f32 v14, v4, v14
v_mul_f32 v15, v4, v15
v_cvt_pk_bf16_f32 v44, v12, v13
v_cvt_pk_bf16_f32 v45, v14, v15
v_and_b32 v12, 0xffffff7f, v0
v_and_or_b32 v8, v1, 8, v12
ds_write_b64 v8, v[44:45] offset:7168
v_mov_b32_dpp v46, v44 row_ror:8 row_mask:0xf bank_mask:0xf
v_mov_b32_dpp v47, v45 row_ror:8 row_mask:0xf bank_mask:0xf
v_mov_b64 v[24:25], 0
v_mov_b64 v[26:27], 0
v_mov_b64 v[28:29], 0
v_mov_b64 v[30:31], 0
v_mov_b64 v[32:33], 0
v_mov_b64 v[34:35], 0
v_mov_b64 v[36:37], 0
v_mov_b64 v[38:39], 0
s_waitcnt lgkmcnt(0)
s_branch k_okS_234
k_done_235:
buffer_load_dwordx4 v[16:19], v0, s[4:7], s35 offen offset:0 sc1
k_xs_241:
s_waitcnt vmcnt(1)
v_cmp_u_f32 vcc, v4, v12
s_waitcnt vmcnt(0)
v_cmp_u_f32 s[66:67], v16, v16
s_or_b64 vcc, vcc, s[66:67]
s_cbranch_vccz k_xd_242
buffer_load_dwordx4 v[4:7], v0, s[4:7], s33 offen offset:0 sc1
buffer_load_dwordx4 v[8:11], v0, s[4:7], s33 offen offset:1024 sc1
buffer_load_dwordx4 v[12:15], v0, s[4:7], s34 offen offset:0 sc1
buffer_load_dwordx4 v[16:19], v0, s[4:7], s35 offen offset:0 sc1
s_sub_u32 s32, s32, 1
s_cmp_gt_i32 s32, 0
s_cbranch_scc1 k_xs_241
k_xd_242:
s_waitcnt vmcnt(1)
buffer_store_dwordx4 v[12:15], v0, s[8:11], s37 offen offset:2048 sc1
s_waitcnt vmcnt(1)
buffer_store_dwordx4 v[16:19], v0, s[8:11], s59 offen offset:2048 sc1
s_add_u32 s31, s31, 1
s_branch k_jn_224
k_far_223:
s_branch k_cold2_245
k_T0_243:
s_waitcnt vmcnt(2)
v_smfmac_f32_16x16x64_bf16 v[40:43], v[4:7], v[48:55], v1
s_waitcnt vmcnt(1)
v_cmp_u_f32 vcc, v4, v8
v_smfmac_f32_16x16x64_bf16 v[24:27], v[8:11], a[24:31], v1
v_smfmac_f32_16x16x64_bf16 v[28:31], v[8:11], a[32:39], v1
s_cbranch_vccnz k_cold_244
k_okC_246:
s_waitcnt vmcnt(1)
v_smfmac_f32_16x16x64_bf16 v[36:39], v[8:11], a[40:47], v1
s_waitcnt lgkmcnt(0)
ds_read_b128 v[48:51], v2 offset:0
v_smfmac_f32_16x16x64_bf16 v[32:35], v[4:7], v[64:71], v1
ds_read_b128 v[52:55], v2 offset:1024
ds_read_b128 v[64:67], v0 offset:38912
v_smfmac_f32_16x16x64_bf16 v[44:47], v[4:7], v[56:63], v1
ds_read_b128 v[68:71], v0 offset:39936
v_smfmac_f32_16x16x64_bf16 v[28:31], v[4:7], a[8:15], v1
v_smfmac_f32_16x16x64_bf16 v[24:27], v[4:7], a[0:7], v1
ds_read_b128 v[56:59], v2 offset:28672
v_smfmac_f32_16x16x64_bf16 v[36:39], v[4:7], a[16:23], v1
ds_read_b128 v[60:63], v2 offset:29696
s_waitcnt lgkmcnt(4)
v_smfmac_f32_16x16x64_bf16 v[40:43], v[8:11], v[48:55], v1
s_waitcnt vmcnt(0)
ds_write_b128 v0, v[12:15] offset:2048
s_waitcnt lgkmcnt(3)
v_smfmac_f32_16x16x64_bf16 v[32:35], v[8:11], v[64:71], v1
buffer_load_dwordx4 v[16:19], v0, s[4:7], s35 offen offset:0 sc1
v_cmp_u_f32 vcc, v12, v12
s_waitcnt lgkmcnt(1)
v_smfmac_f32_16x16x64_bf16 v[44:47], v[8:11], v[56:63], v1
ds_read_b128 v[56:59], v2 offset:2048
ds_read_b128 v[60:63], v2 offset:3072
ds_read_b128 v[64:67], v0 offset:45056
s_cbranch_vccnz k_coldA_247
k_okA_248:
v_smfmac_f32_16x16x64_bf16 v[36:39], v[12:15], a[64:71], v1
ds_read_b128 v[68:71], v0 offset:46080
s_waitcnt lgkmcnt(4)
v_smfmac_f32_16x16x64_bf16 v[40:43], v[12:15], a[72:79], v1
s_barrier
v_smfmac_f32_16x16x64_bf16 v[28:31], v[12:15], a[56:63], v1
ds_read_b128 v[8:11], v0 offset:3072
buffer_load_dwordx4 v[48:51], v0, s[4:7], s36 offen offset:0 sc1
s_waitcnt lgkmcnt(3)
v_smfmac_f32_16x16x64_bf16 v[44:47], v[12:15], v[56:63], v1
ds_read_b128 v[56:59], v2 offset:4096
v_smfmac_f32_16x16x64_bf16 v[24:27], v[12:15], a[48:55], v1
ds_read_b128 v[60:63], v2 offset:5120
s_waitcnt lgkmcnt(3)
v_smfmac_f32_16x16x64_bf16 v[32:35], v[12:15], v[64:71], v1
buffer_load_dwordx4 v[52:55], v0, s[4:7], s36 offen offset:1024 sc1
s_waitcnt lgkmcnt(2)
v_smfmac_f32_16x16x64_bf16 v[24:27], v[8:11], a[80:87], v1
ds_read_b128 v[64:67], v0 offset:47104
ds_read_b128 v[68:71], v0 offset:48128
v_smfmac_f32_16x16x64_bf16 v[36:39], v[8:11], a[96:103], v1
buffer_store_dword v3, v0, s[20:23], s63 offen sc1
s_waitcnt lgkmcnt(2)
ds_read_b128 v[4:7], v0 offset:0
v_smfmac_f32_16x16x64_bf16 v[44:47], v[8:11], v[56:63], v1
ds_read_b128 v[56:59], v0 offset:49152
ds_read_b128 v[60:63], v0 offset:50176
v_smfmac_f32_16x16x64_bf16 v[28:31], v[8:11], a[88:95], v1
buffer_store_dwordx4 v[12:15], v0, s[8:11], s37 offen offset:2048 sc1
v_smfmac_f32_16x16x64_bf16 v[40:43], v[8:11], a[104:111], v1
s_waitcnt lgkmcnt(3)
s_waitcnt lgkmcnt(2)
v_smfmac_f32_16x16x64_bf16 v[32:35], v[8:11], v[64:71], v1
ds_read_b128 v[64:67], v0 offset:40960
ds_read_b128 v[12:15], v0 offset:1024
v_smfmac_f32_16x16x64_bf16 v[36:39], v[4:7], a[128:135], v1
s_waitcnt lgkmcnt(2)
v_smfmac_f32_16x16x64_bf16 v[44:47], v[4:7], v[56:63], v1
ds_read_b128 v[68:71], v0 offset:41984
buffer_load_dwordx4 v[56:59], v0, s[4:7], s36 offen offset:2048 sc1
v_smfmac_f32_16x16x64_bf16 v[28:31], v[4:7], a[120:127], v1
v_smfmac_f32_16x16x64_bf16 v[24:27], v[4:7], a[112:119], v1
s_waitcnt vmcnt(5)
ds_write_b128 v0, v[16:19] offset:6144
v_smfmac_f32_16x16x64_bf16 v[40:43], v[4:7], a[136:143], v1
s_waitcnt lgkmcnt(1)
buffer_load_dwordx4 v[60:63], v0, s[4:7], s36 offen offset:3072 sc1
v_cmp_u_f32 vcc, v16, v16
v_smfmac_f32_16x16x64_bf16 v[32:35], v[4:7], v[64:71], v1
ds_read_b128 v[64:67], v0 offset:43008
ds_read_b128 v[68:71], v0 offset:44032
v_smfmac_f32_16x16x64_bf16 v[28:31], v[12:15], a[152:159], v1
v_smfmac_f32_16x16x64_bf16 v[24:27], v[12:15], a[144:151], v1
s_cbranch_vccnz k_coldB_249
k_okB_250:
v_smfmac_f32_16x16x64_bf16 v[36:39], v[12:15], a[160:167], v1
s_waitcnt lgkmcnt(2)
buffer_store_dwordx4 v[16:19], v0, s[8:11], s59 offen offset:2048 sc1
s_barrier
ds_read_b128 v[4:7], v0 offset:4096
v_smfmac_f32_16x16x64_bf16 v[44:47], v[12:15], a[176:183], v1
ds_read_b128 v[8:11], v0 offset:7168
s_waitcnt lgkmcnt(2)
v_smfmac_f32_16x16x64_bf16 v[32:35], v[12:15], v[64:71], v1
ds_read_b128 v[64:67], v2 offset:34816
ds_read_b128 v[68:71], v2 offset:35840
v_smfmac_f32_16x16x64_bf16 v[24:27], v[16:19], a[184:191], v1
v_smfmac_f32_16x16x64_bf16 v[40:43], v[12:15], a[168:175], v1
s_waitcnt lgkmcnt(3)
ds_read_b128 v[12:15], v0 offset:5120
v_smfmac_f32_16x16x64_bf16 v[24:27], v[4:7], a[208:215], v1
s_waitcnt lgkmcnt(3)
v_smfmac_f32_16x16x64_bf16 v[28:31], v[4:7], a[216:223], v1
v_smfmac_f32_16x16x64_bf16 v[28:31], v[8:11], a[200:207], v1
s_waitcnt lgkmcnt(1)
v_smfmac_f32_16x16x64_bf16 v[24:27], v[8:11], v[64:71], v1
ds_read_b128 v[64:67], v2 offset:6144
s_waitcnt lgkmcnt(1)
v_smfmac_f32_16x16x64_bf16 v[24:27], v[12:15], a[224:231], v1
ds_read_b128 v[68:71], v2 offset:7168
v_smfmac_f32_16x16x64_bf16 v[28:31], v[12:15], a[232:239], v1
v_smfmac_f32_16x16x64_bf16 v[28:31], v[16:19], a[192:199], v1
v_cvt_pk_bf16_f32 v24, v24, v25
v_cvt_pk_bf16_f32 v25, v26, v27
v_smfmac_f32_16x16x64_bf16 v[32:35], v[4:7], v[80:87], v1
v_cvt_pk_bf16_f32 v26, v28, v29
v_cvt_pk_bf16_f32 v27, v30, v31
v_smfmac_f32_16x16x64_bf16 v[32:35], v[8:11], a[248:255], v1
s_waitcnt lgkmcnt(0)
v_mfma_f32_16x16x32_bf16 v[28:31], v[24:27], v[20:23], 0
v_and_b32 v26, 0xffffff7f, v0
v_smfmac_f32_16x16x64_bf16 v[32:35], v[16:19], v[64:71], v1
v_and_or_b32 v26, v1, 8, v26
v_mul_f32 v28, s51, v28
v_mul_f32 v29, s51, v29
v_mul_f32 v31, s51, v31
v_cvt_pk_bf16_f32 v24, v28, v29
v_mul_f32 v30, s51, v30
v_cvt_pk_bf16_f32 v25, v30, v31
v_smfmac_f32_16x16x64_bf16 v[32:35], v[12:15], v[96:103], v1
ds_write_b64 v26, v[24:25] offset:1024
v_smfmac_f32_16x16x64_bf16 v[36:39], v[8:11], v[72:79], v1
v_cvt_pk_bf16_f32 v32, v32, v33
v_smfmac_f32_16x16x64_bf16 v[36:39], v[16:19], a[240:247], v1
buffer_load_dwordx4 v[64:67], v0, s[4:7], s61 offen offset:0
v_cvt_pk_bf16_f32 v33, v34, v35
v_smfmac_f32_16x16x64_bf16 v[36:39], v[12:15], v[104:111], v1
s_waitcnt lgkmcnt(0)
v_smfmac_f32_16x16x64_bf16 v[36:39], v[4:7], v[88:95], v1
s_barrier
ds_read_b128 v[24:27], v0 offset:0
v_smfmac_f32_16x16x64_bf16 v[40:43], v[4:7], v[144:151], v1
ds_read_b128 v[28:31], v0 offset:1024
s_nop 0
v_cvt_pk_bf16_f32 v34, v36, v37
v_cvt_pk_bf16_f32 v35, v38, v39
s_nop 1
v_mfma_f32_16x16x32_bf16 v[36:39], v[32:35], v[20:23], 0
s_waitcnt vmcnt(6)
buffer_load_dwordx4 v[68:71], v0, s[4:7], s61 offen offset:1024
v_and_b32 v34, 0xffffff7f, v0
v_and_or_b32 v34, v1, 8, v34
s_waitcnt lgkmcnt(1)
v_mfma_f32_16x16x32_bf16 v[48:51], v[48:51], v[24:27], 0
v_cvt_pk_bf16_f32 v32, v36, v37
s_waitcnt lgkmcnt(0)
v_mfma_f32_16x16x32_bf16 v[48:51], v[52:55], v[28:31], v[48:51]
v_mov_b64 v[52:53], s[56:57]
v_cvt_pk_bf16_f32 v33, v38, v39
v_smfmac_f32_16x16x64_bf16 v[44:47], v[4:7], v[152:159], v1
ds_write_b64 v34, v[32:33] offset:3072
v_permlane32_swap_b32 v48, v50
v_permlane32_swap_b32 v49, v51
v_add_f32_dpp v52, v50, v48 row_ror:8 row_mask:0xf bank_mask:0x3
v_exp_f32 v52, v52
v_add_f32_dpp v53, v51, v49 row_ror:8 row_mask:0xf bank_mask:0x3
v_exp_f32 v53, v53
s_nop 0
v_cvt_pk_bf16_f32 v48, v52, v53
v_smfmac_f32_16x16x64_bf16 v[44:47], v[16:19], v[120:127], v1
ds_write_b32 v0, v48 offset:4104
v_smfmac_f32_16x16x64_bf16 v[44:47], v[12:15], v[168:175], v1
buffer_load_dwordx4 v[48:51], v0, s[4:7], s61 offen offset:2048
v_smfmac_f32_16x16x64_bf16 v[40:43], v[12:15], v[160:167], v1
s_waitcnt lgkmcnt(1)
v_xor_b32 v12, 0x80, v0
v_smfmac_f32_16x16x64_bf16 v[40:43], v[8:11], v[128:135], v1
s_waitcnt lgkmcnt(0)
s_barrier
ds_read_b128 v[32:35], v0 offset:2048
v_mov_b64 v[22:23], s[52:53]
v_smfmac_f32_16x16x64_bf16 v[40:43], v[16:19], v[112:119], v1
ds_read_b128 v[36:39], v0 offset:3072
ds_read_b128 v[16:19], v0 offset:4096
buffer_load_dwordx4 v[52:55], v0, s[4:7], s61 offen offset:3072
v_smfmac_f32_16x16x64_bf16 v[44:47], v[8:11], v[136:143], v1
ds_read_b128 v[12:15], v12 offset:4096
v_cvt_pk_bf16_f32 v40, v40, v41
v_mov_b64 v[20:21], s[52:53]
s_waitcnt lgkmcnt(3)
v_mfma_f32_16x16x32_bf16 v[24:27], v[32:35], v[24:27], 0
v_cvt_pk_bf16_f32 v41, v42, v43
s_waitcnt lgkmcnt(2)
v_mfma_f32_16x16x32_bf16 v[24:27], v[36:39], v[28:31], v[24:27]
s_waitcnt vmcnt(5)
s_waitcnt lgkmcnt(1)
v_mfma_f32_16x16x32_bf16 v[8:11], v[56:59], v[16:19], 0
buffer_load_dwordx4 v[56:59], v0, s[4:7], s62 offen offset:0
v_mov_b64 v[28:29], s[56:57]
v_cvt_pk_bf16_f32 v43, v46, v47
v_cvt_pk_bf16_f32 v42, v44, v45
v_permlane32_swap_b32 v25, v27
v_permlane32_swap_b32 v24, v26
v_mfma_f32_16x16x32_bf16 v[4:7], v[20:23], v[16:19], 0
s_waitcnt lgkmcnt(0)
v_add_f32_dpp v28, v26, v24 row_ror:8 row_mask:0xf bank_mask:0x3
v_add_f32_dpp v29, v27, v25 row_ror:8 row_mask:0xf bank_mask:0x3
v_exp_f32 v28, v28
v_mfma_f32_16x16x32_bf16 v[8:11], v[60:63], v[12:15], v[8:11]
buffer_load_dwordx4 v[60:63], v0, s[4:7], s62 offen offset:1024
v_exp_f32 v29, v29
v_permlane32_swap_b32 v42, v43
v_cvt_pk_bf16_f32 v24, v28, v29
v_mov_b64 v[44:45], s[54:55]
v_cvt_pk_bf16_f32 v25, v28, v29
v_mov_b32_dpp v26, v24 row_ror:8 row_mask:0xf bank_mask:0xf
v_mov_b32_dpp v27, v24 row_ror:8 row_mask:0xf bank_mask:0xf
v_mfma_f32_16x16x16_bf16 v[4:7], v[44:45], v[24:25], v[4:7]
v_permlane32_swap_b32 v40, v41
v_mov_b64 v[36:37], 0
v_mov_b64 v[38:39], 0
v_mov_b64 v[30:31], 0
v_mfma_f32_16x16x32_bf16 v[8:11], v[40:43], v[24:27], v[8:11]
buffer_load_dwordx4 v[16:19], v0, s[4:7], s62 offen offset:2048
v_rcp_f32 v6, v4
v_and_b32 v12, 0xffffff7f, v0
v_and_or_b32 v13, v1, 8, v12
v_rcp_f32_dpp v6, v4 row_ror:8 row_mask:0xf bank_mask:0xc
v_mov_b64 v[26:27], 0
v_pk_mul_f32 v[8:9], v[8:9], v[6:7] op_sel_hi:[1,0]
v_cvt_pk_bf16_f32 v44, v8, v9
v_pk_mul_f32 v[10:11], v[10:11], v[6:7] op_sel_hi:[1,0]
v_cvt_pk_bf16_f32 v45, v10, v11
s_waitcnt vmcnt(5)
ds_write_b64 v13, v[44:45] offset:7168
buffer_load_dwordx4 v[20:23], v0, s[4:7], s62 offen offset:3072
v_add_u32 v6, 0xd4800000, v6
v_cmp_lt_u32 vcc, 0x28000000, v6
v_mov_b64 v[34:35], 0
v_mov_b32_dpp v46, v44 row_ror:8 row_mask:0xf bank_mask:0xf
v_mov_b32_dpp v47, v45 row_ror:8 row_mask:0xf bank_mask:0xf
v_mov_b64 v[28:29], 0
v_mov_b64 v[32:33], 0
s_cbranch_vccnz k_slow_251
k_okS_252:
v_smfmac_f32_16x16x64_bf16 v[36:39], v[44:47], v[224:231], v1
s_waitcnt lgkmcnt(0)
s_barrier
ds_read_b128 v[8:11], v12 offset:6144
v_smfmac_f32_16x16x64_bf16 v[32:35], v[44:47], v[200:207], v1
s_waitcnt vmcnt(4)
ds_read_b128 v[4:7], v12 offset:7296
v_mov_b64 v[24:25], 0
v_smfmac_f32_16x16x64_bf16 v[28:31], v[44:47], v[48:55], v1
ds_read_b128 v[12:15], v12 offset:6272
ds_read_b128 v[48:51], v2 offset:26624
v_smfmac_f32_16x16x64_bf16 v[24:27], v[44:47], v[64:71], v1
ds_read_b128 v[52:55], v2 offset:27648
v_mov_b64 v[42:43], 0
s_waitcnt lgkmcnt(4)
v_smfmac_f32_16x16x64_bf16 v[24:27], v[8:11], v[184:191], v1
s_waitcnt lgkmcnt(3)
v_mov_b64 v[40:41], 0
v_smfmac_f32_16x16x64_bf16 v[24:27], v[4:7], v[176:183], v1
s_waitcnt lgkmcnt(2)
ds_read_b128 v[64:67], v2 offset:10240
v_smfmac_f32_16x16x64_bf16 v[24:27], v[12:15], v[192:199], v1
ds_read_b128 v[68:71], v2 offset:11264
v_smfmac_f32_16x16x64_bf16 v[40:43], v[44:47], v[240:247], v1
s_waitcnt vmcnt(2)
s_waitcnt lgkmcnt(2)
v_lshrrev_b32 v44, 16, v1
v_cvt_pk_bf16_f32 v24, v24, v25
v_bfi_b32 v24, 1, s45, v24
v_cvt_pk_bf16_f32 v25, v26, v27
v_smfmac_f32_16x16x64_bf16 v[28:31], v[8:11], v[48:55], v1
buffer_store_dwordx2 v[24:25], v44, s[4:7], s38 offen sc1
ds_read_b128 v[48:51], v2 offset:24576
ds_read_b128 v[52:55], v2 offset:25600
v_smfmac_f32_16x16x64_bf16 v[28:31], v[12:15], v[56:63], v1
s_waitcnt lgkmcnt(2)
ds_read_b128 v[56:59], v2 offset:8192
v_smfmac_f32_16x16x64_bf16 v[28:31], v[4:7], v[64:71], v1
ds_read_b128 v[60:63], v2 offset:9216
v_smfmac_f32_16x16x64_bf16 v[32:35], v[8:11], v[208:215], v1
ds_read_b128 v[64:67], v2 offset:30720
s_nop 0
v_cvt_pk_bf16_f32 v28, v28, v29
v_bfi_b32 v28, 1, s45, v28
v_cvt_pk_bf16_f32 v29, v30, v31
v_smfmac_f32_16x16x64_bf16 v[32:35], v[12:15], v[216:223], v1
buffer_store_dwordx2 v[28:29], v44, s[4:7], s39 offen sc1
v_smfmac_f32_16x16x64_bf16 v[40:43], v[12:15], v[248:255], v1
ds_read_b128 v[68:71], v2 offset:31744
s_waitcnt vmcnt(2)
v_smfmac_f32_16x16x64_bf16 v[32:35], v[4:7], v[16:23], v1
s_waitcnt lgkmcnt(2)
v_smfmac_f32_16x16x64_bf16 v[36:39], v[12:15], v[232:239], v1
ds_read_b128 v[16:19], v2 offset:32768
ds_read_b128 v[20:23], v2 offset:33792
v_cvt_pk_bf16_f32 v32, v32, v33
v_bfi_b32 v32, 1, s45, v32
v_cvt_pk_bf16_f32 v33, v34, v35
v_smfmac_f32_16x16x64_bf16 v[36:39], v[8:11], v[48:55], v1
buffer_store_dwordx2 v[32:33], v44, s[4:7], s40 offen sc1
s_waitcnt lgkmcnt(2)
v_smfmac_f32_16x16x64_bf16 v[36:39], v[4:7], v[64:71], v1
s_nop 6
v_cvt_pk_bf16_f32 v36, v36, v37
v_cvt_pk_bf16_f32 v37, v38, v39
s_waitcnt lgkmcnt(0)
v_bfi_b32 v36, 1, s45, v36
v_smfmac_f32_16x16x64_bf16 v[40:43], v[8:11], v[16:23], v1
buffer_store_dwordx2 v[36:37], v44, s[4:7], s41 offen sc1
v_smfmac_f32_16x16x64_bf16 v[40:43], v[4:7], v[56:63], v1
s_nop 6
v_cvt_pk_bf16_f32 v40, v40, v41
v_bfi_b32 v40, 1, s45, v40
v_cvt_pk_bf16_f32 v41, v42, v43
buffer_store_dwordx2 v[40:41], v44, s[4:7], s42 offen sc1
s_barrier
v_lshlrev_b32 v23, v0, s58
v_cndmask_b32 v16, 0, v23, s[12:13]
v_cndmask_b32 v17, 0, v23, s[14:15]
v_cndmask_b32 v18, 0, v23, s[16:17]
v_cndmask_b32 v19, 0, v23, s[18:19]
v_and_b32 v45, 0x30, v0
v_lshrrev_b32 v46, 8, v0
v_lshl_or_b32 v45, v46, 2, v45
v_bfe_u32 v46, v0, 6, 1
v_lshl_or_b32 v45, v46, 7, v45
v_cndmask_b32 v45, v45, 2.0, s[98:99]
buffer_load_dwordx4 v[48:51], v0, s[4:7], s60 offen offset:0
buffer_load_dwordx4 v[52:55], v0, s[4:7], s60 offen offset:1024
buffer_load_dwordx4 v[56:59], v0, s[4:7], s60 offen offset:2048
buffer_load_dwordx4 v[60:63], v0, s[4:7], s60 offen offset:3072
v_cndmask_b32 v20, 0, v23, s[90:91]
v_cndmask_b32 v21, 0, v23, s[92:93]
v_cndmask_b32 v22, 0, v23, s[94:95]
v_cndmask_b32 v23, 0, v23, s[96:97]
s_waitcnt vmcnt(4)
buffer_load_dwordx4 v[24:27], v0, s[4:7], s43 offen offset:0 sc1
buffer_load_dwordx4 v[28:31], v0, s[4:7], s43 offen offset:1024 sc1
buffer_load_dwordx4 v[32:35], v0, s[4:7], s43 offen offset:2048 sc1
buffer_load_dwordx4 v[36:39], v0, s[4:7], s43 offen offset:3072 sc1
s_add_u32 s33, s33, 16384
s_bitset0_b32 s33, 16
s_waitcnt vmcnt(3)
v_mfma_f32_16x16x32_bf16 v[40:43], v[24:27], v[16:19], 0
s_waitcnt vmcnt(2)
v_mfma_f32_16x16x32_bf16 v[40:43], v[28:31], v[16:19], v[40:43]
v_bitop3_b32 v46, v24, v28, s45 bitop3:0x7e
s_waitcnt vmcnt(1)
v_mfma_f32_16x16x32_bf16 v[40:43], v[32:35], v[16:19], v[40:43]
s_waitcnt vmcnt(0)
v_mfma_f32_16x16x32_bf16 v[40:43], v[36:39], v[16:19], v[40:43]
v_bitop3_b32 v47, v32, v36, s45 bitop3:0x7e
v_bitop3_b32 v46, v46, v47, 1 bitop3:0xa8
v_cmp_ne_u32 vcc, 0, v46
v_mov_b64 v[24:25], 0
v_mov_b64 v[26:27], 0
v_mov_b64 v[28:29], 0
v_mov_b64 v[30:31], 0
v_permlane32_swap_b32 v40, v41
v_permlane32_swap_b32 v42, v43
v_add_f32 v40, v40, v41
v_add_f32 v41, v42, v43
v_cvt_pk_bf16_f32 v42, v40, v41
s_cbranch_vccnz k_r1_254
k_ok1_255:
buffer_store_dword v42, v45, s[4:7], s44 offen sc1
s_barrier
buffer_load_dwordx4 v[4:7], v0, s[4:7], s33 offen offset:0 sc1
buffer_load_dwordx4 v[8:11], v0, s[4:7], s33 offen offset:1024 sc1
s_add_u32 s34, s33, 4096
s_add_u32 s35, s33, 8192
s_add_u32 s36, s36, 524288
s_add_u32 s37, s37, 10240
s_add_u32 s59, s59, 10240
s_add_u32 s63, s63, 16384
s_bitset0_b32 s63, 16
v_mov_b64 v[32:33], 0
v_mov_b64 v[34:35], 0
v_mov_b64 v[36:37], 0
v_mov_b64 v[38:39], 0
v_mov_b64 v[40:41], 0
v_mov_b64 v[42:43], 0
v_mov_b64 v[44:45], 0
v_mov_b64 v[46:47], 0
s_add_u32 s44, s44, 16384
s_bitset0_b32 s44, 16
s_sub_u32 s45, s45, 1
s_add_u32 s31, s31, 1
ds_read_b128 v[64:67], v0 offset:36864
ds_read_b128 v[68:71], v0 offset:37888
s_waitcnt lgkmcnt(0)
buffer_load_dwordx4 v[12:15], v0, s[4:7], s34 offen offset:0 sc1
s_cmp_lg_u32 s31, s47
s_cbranch_scc1 k_T0_243
s_branch k_done_253
k_cold2_245:
s_barrier
buffer_load_dwordx4 v[48:51], v0, s[4:7], s60 offen offset:0
buffer_load_dwordx4 v[52:55], v0, s[4:7], s60 offen offset:1024
buffer_load_dwordx4 v[56:59], v0, s[4:7], s60 offen offset:2048
buffer_load_dwordx4 v[60:63], v0, s[4:7], s60 offen offset:3072
ds_read_b128 v[64:67], v0 offset:36864
ds_read_b128 v[68:71], v0 offset:37888
k_cold_244:
buffer_load_dwordx4 v[4:7], v0, s[4:7], s33 offen offset:0 sc1
buffer_load_dwordx4 v[8:11], v0, s[4:7], s33 offen offset:1024 sc1
buffer_load_dwordx4 v[12:15], v0, s[4:7], s34 offen offset:0 sc1
s_sub_u32 s32, s32, 1
s_cmp_gt_i32 s32, 0
s_cbranch_scc0 k_okC_246
v_mov_b64 v[24:25], 0
v_mov_b64 v[26:27], 0
v_mov_b64 v[28:29], 0
v_mov_b64 v[30:31], 0
v_mov_b64 v[32:33], 0
v_mov_b64 v[34:35], 0
v_mov_b64 v[36:37], 0
v_mov_b64 v[38:39], 0
v_mov_b64 v[40:41], 0
v_mov_b64 v[42:43], 0
v_mov_b64 v[44:45], 0
v_mov_b64 v[46:47], 0
s_branch k_T0_243
k_coldA_247:
buffer_load_dwordx4 v[12:15], v0, s[4:7], s34 offen offset:0 sc1
s_sub_u32 s32, s32, 1
s_cmp_gt_i32 s32, 0
s_waitcnt vmcnt(0)
v_cmp_u_f32 vcc, v12, v12
ds_write_b128 v0, v[12:15] offset:2048
s_waitcnt lgkmcnt(0)
s_cbranch_vccz k_okA_248
s_cbranch_scc1 k_coldA_247
s_branch k_okA_248
k_coldB_249:
buffer_load_dwordx4 v[16:19], v0, s[4:7], s35 offen offset:0 sc1
s_sub_u32 s32, s32, 1
s_cmp_gt_i32 s32, 0
s_waitcnt vmcnt(0)
v_cmp_u_f32 vcc, v16, v16
ds_write_b128 v0, v[16:19] offset:6144
s_waitcnt lgkmcnt(0)
s_cbranch_vccz k_okB_250
s_cbranch_scc1 k_coldB_249
s_branch k_okB_250
k_r1_254:
buffer_load_dwordx4 v[24:27], v0, s[4:7], s43 offen offset:0 sc1
buffer_load_dwordx4 v[28:31], v0, s[4:7], s43 offen offset:1024 sc1
buffer_load_dwordx4 v[32:35], v0, s[4:7], s43 offen offset:2048 sc1
buffer_load_dwordx4 v[36:39], v0, s[4:7], s43 offen offset:3072 sc1
s_sub_u32 s32, s32, 1
s_cmp_gt_i32 s32, 0
s_waitcnt vmcnt(3)
v_mfma_f32_16x16x32_bf16 v[40:43], v[24:27], v[16:19], 0
s_waitcnt vmcnt(2)
v_mfma_f32_16x16x32_bf16 v[40:43], v[28:31], v[16:19], v[40:43]
v_bitop3_b32 v46, v24, v28, s45 bitop3:0x7e
s_waitcnt vmcnt(1)
v_mfma_f32_16x16x32_bf16 v[40:43], v[32:35], v[16:19], v[40:43]
s_waitcnt vmcnt(0)
v_mfma_f32_16x16x32_bf16 v[40:43], v[36:39], v[16:19], v[40:43]
v_bitop3_b32 v47, v32, v36, s45 bitop3:0x7e
v_bitop3_b32 v46, v46, v47, 1 bitop3:0xa8
v_cmp_ne_u32 vcc, 0, v46
v_mov_b64 v[24:25], 0
v_mov_b64 v[26:27], 0
v_mov_b64 v[28:29], 0
v_mov_b64 v[30:31], 0
v_permlane32_swap_b32 v40, v41
v_permlane32_swap_b32 v42, v43
v_add_f32 v40, v40, v41
v_add_f32 v41, v42, v43
v_cvt_pk_bf16_f32 v42, v40, v41
s_cbranch_vccz k_ok1_255
s_cbranch_scc1 k_r1_254
s_branch k_ok1_255
k_slow_251:
ds_read_b128 v[24:27], v0 offset:0
ds_read_b128 v[28:31], v0 offset:1024
v_mov_b32 v46, 0xff7fffff
s_add_u32 s48, s36, 0xffffe000
buffer_load_dwordx4 v[32:35], v0, s[4:7], s48 offen offset:0 sc1
buffer_load_dwordx4 v[36:39], v0, s[4:7], s48 offen offset:1024 sc1
s_waitcnt vmcnt(1) lgkmcnt(1)
v_mfma_f32_16x16x32_bf16 v[4:7], v[32:35], v[24:27], 0
s_waitcnt vmcnt(0) lgkmcnt(0)
v_mfma_f32_16x16x32_bf16 v[4:7], v[36:39], v[28:31], v[4:7]
v_mov_b64 v[8:9], s[56:57]
s_nop 5
v_permlane32_swap_b32 v4, v6
v_permlane32_swap_b32 v5, v7
v_add_f32_dpp v8, v6, v4 row_ror:8 row_mask:0xf bank_mask:0x3
s_nop 0
v_add_f32_dpp v9, v7, v5 row_ror:8 row_mask:0xf bank_mask:0x3
v_max3_f32 v46, v46, v8, v9
s_add_u32 s48, s36, 0xfffff000
buffer_load_dwordx4 v[32:35], v0, s[4:7], s48 offen offset:0 sc1
buffer_load_dwordx4 v[36:39], v0, s[4:7], s48 offen offset:1024 sc1
s_waitcnt vmcnt(1)
v_mfma_f32_16x16x32_bf16 v[4:7], v[32:35], v[24:27], 0
s_waitcnt vmcnt(0)
v_mfma_f32_16x16x32_bf16 v[4:7], v[36:39], v[28:31], v[4:7]
v_mov_b64 v[10:11], s[56:57]
s_nop 5
v_permlane32_swap_b32 v4, v6
v_permlane32_swap_b32 v5, v7
v_add_f32_dpp v10, v6, v4 row_ror:8 row_mask:0xf bank_mask:0x3
s_nop 0
v_add_f32_dpp v11, v7, v5 row_ror:8 row_mask:0xf bank_mask:0x3
v_max3_f32 v46, v46, v10, v11
s_add_u32 s48, s36, 0x0
buffer_load_dwordx4 v[32:35], v0, s[4:7], s48 offen offset:0 sc1
buffer_load_dwordx4 v[36:39], v0, s[4:7], s48 offen offset:1024 sc1
s_waitcnt vmcnt(1)
v_mfma_f32_16x16x32_bf16 v[4:7], v[32:35], v[24:27], 0
s_waitcnt vmcnt(0)
v_mfma_f32_16x16x32_bf16 v[4:7], v[36:39], v[28:31], v[4:7]
v_mov_b64 v[12:13], s[56:57]
s_nop 5
v_permlane32_swap_b32 v4, v6
v_permlane32_swap_b32 v5, v7
v_add_f32_dpp v12, v6, v4 row_ror:8 row_mask:0xf bank_mask:0x3
s_nop 0
v_add_f32_dpp v13, v7, v5 row_ror:8 row_mask:0xf bank_mask:0x3
v_max3_f32 v46, v46, v12, v13
s_add_u32 s48, s36, 0x1000
buffer_load_dwordx4 v[32:35], v0, s[4:7], s48 offen offset:0 sc1
buffer_load_dwordx4 v[36:39], v0, s[4:7], s48 offen offset:1024 sc1
s_waitcnt vmcnt(1)
v_mfma_f32_16x16x32_bf16 v[4:7], v[32:35], v[24:27], 0
s_waitcnt vmcnt(0)
v_mfma_f32_16x16x32_bf16 v[4:7], v[36:39], v[28:31], v[4:7]
v_mov_b64 v[14:15], s[56:57]
s_nop 5
v_permlane32_swap_b32 v4, v6
v_permlane32_swap_b32 v5, v7
v_add_f32_dpp v14, v6, v4 row_ror:8 row_mask:0xf bank_mask:0x3
s_nop 0
v_add_f32_dpp v15, v7, v5 row_ror:8 row_mask:0xf bank_mask:0x3
v_max3_f32 v46, v46, v14, v15
ds_read_b128 v[32:35], v0 offset:2048
ds_read_b128 v[36:39], v0 offset:3072
s_waitcnt lgkmcnt(1)
v_mfma_f32_16x16x32_bf16 v[4:7], v[32:35], v[24:27], 0
s_waitcnt lgkmcnt(0)
v_mfma_f32_16x16x32_bf16 v[4:7], v[36:39], v[28:31], v[4:7]
v_mov_b64 v[44:45], s[56:57]
s_nop 5
v_permlane32_swap_b32 v4, v6
v_permlane32_swap_b32 v5, v7
v_add_f32_dpp v44, v6, v4 row_ror:8 row_mask:0xf bank_mask:0x3
s_nop 0
v_add_f32_dpp v45, v7, v5 row_ror:8 row_mask:0xf bank_mask:0x3
v_max3_f32 v46, v46, v44, v45
buffer_load_dwordx4 v[32:35], v0, s[4:7], s36 offen offset:2048 sc1
buffer_load_dwordx4 v[36:39], v0, s[4:7], s36 offen offset:3072 sc1
v_mov_b32 v47, v46
s_nop 1
v_permlane32_swap_b32 v46, v47
v_max_f32 v46, v46, v47
v_mov_b32 v47, v46
s_nop 1
v_permlane16_swap_b32 v46, v47
v_max_f32 v46, v46, v47
v_sub_f32 v8, v8, v46
v_exp_f32 v8, v8
v_sub_f32 v9, v9, v46
v_exp_f32 v9, v9
v_sub_f32 v10, v10, v46
v_exp_f32 v10, v10
v_sub_f32 v11, v11, v46
v_exp_f32 v11, v11
v_sub_f32 v12, v12, v46
v_exp_f32 v12, v12
v_sub_f32 v13, v13, v46
v_exp_f32 v13, v13
v_sub_f32 v14, v14, v46
v_exp_f32 v14, v14
v_sub_f32 v15, v15, v46
v_exp_f32 v15, v15
v_sub_f32 v44, v44, v46
v_exp_f32 v44, v44
v_sub_f32 v45, v45, v46
v_exp_f32 v45, v45
v_cvt_pk_bf16_f32 v4, v8, v9
v_cvt_pk_bf16_f32 v5, v10, v11
v_cvt_pk_bf16_f32 v6, v12, v13
v_cvt_pk_bf16_f32 v7, v14, v15
v_mov_b32_dpp v8, v4 row_ror:8 row_mask:0xf bank_mask:0xf
v_mov_b32_dpp v9, v5 row_ror:8 row_mask:0xf bank_mask:0xf
v_mov_b32_dpp v10, v6 row_ror:8 row_mask:0xf bank_mask:0xf
v_mov_b32_dpp v11, v7 row_ror:8 row_mask:0xf bank_mask:0xf
v_cvt_pk_bf16_f32 v24, v44, v45
v_cvt_pk_bf16_f32 v25, v44, v45
s_nop 0
v_mov_b32_dpp v26, v24 row_ror:8 row_mask:0xf bank_mask:0xf
v_mov_b32_dpp v27, v24 row_ror:8 row_mask:0xf bank_mask:0xf
v_mov_b64 v[28:29], s[52:53]
v_mov_b64 v[30:31], s[52:53]
s_nop 1
v_mfma_f32_16x16x32_bf16 v[44:47], v[28:31], v[4:7], 0
s_waitcnt vmcnt(1)
v_mfma_f32_16x16x32_bf16 v[12:15], v[32:35], v[4:7], 0
s_waitcnt vmcnt(0)
v_mfma_f32_16x16x32_bf16 v[12:15], v[36:39], v[8:11], v[12:15]
v_mfma_f32_16x16x32_bf16 v[12:15], v[40:43], v[24:27], v[12:15]
v_mov_b64 v[28:29], s[54:55]
s_nop 1
v_mfma_f32_16x16x16_bf16 v[44:47], v[28:29], v[24:25], v[44:47]
s_nop 6
v_rcp_f32 v4, v44
s_nop 1
v_rcp_f32_dpp v4, v44 row_ror:8 row_mask:0xf bank_mask:0xc
s_nop 0
v_mul_f32 v12, v4, v12
v_mul_f32 v13, v4, v13
v_mul_f32 v14, v4, v14
v_mul_f32 v15, v4, v15
v_cvt_pk_bf16_f32 v44, v12, v13
v_cvt_pk_bf16_f32 v45, v14, v15
v_and_b32 v12, 0xffffff7f, v0
v_and_or_b32 v8, v1, 8, v12
ds_write_b64 v8, v[44:45] offset:7168
v_mov_b32_dpp v46, v44 row_ror:8 row_mask:0xf bank_mask:0xf
v_mov_b32_dpp v47, v45 row_ror:8 row_mask:0xf bank_mask:0xf
v_mov_b64 v[24:25], 0
v_mov_b64 v[26:27], 0
v_mov_b64 v[28:29], 0
v_mov_b64 v[30:31], 0
v_mov_b64 v[32:33], 0
v_mov_b64 v[34:35], 0
v_mov_b64 v[36:37], 0
v_mov_b64 v[38:39], 0
s_waitcnt lgkmcnt(0)
s_branch k_okS_252
k_done_253:
buffer_load_dwordx4 v[16:19], v0, s[4:7], s35 offen offset:0 sc1
k_xs_259:
s_waitcnt vmcnt(1)
v_cmp_u_f32 vcc, v4, v12
s_waitcnt vmcnt(0)
v_cmp_u_f32 s[66:67], v16, v16
s_or_b64 vcc, vcc, s[66:67]
s_cbranch_vccz k_xd_260
buffer_load_dwordx4 v[4:7], v0, s[4:7], s33 offen offset:0 sc1
buffer_load_dwordx4 v[8:11], v0, s[4:7], s33 offen offset:1024 sc1
buffer_load_dwordx4 v[12:15], v0, s[4:7], s34 offen offset:0 sc1
buffer_load_dwordx4 v[16:19], v0, s[4:7], s35 offen offset:0 sc1
s_sub_u32 s32, s32, 1
s_cmp_gt_i32 s32, 0
s_cbranch_scc1 k_xs_259
k_xd_260:
s_waitcnt vmcnt(1)
buffer_store_dwordx4 v[12:15], v0, s[8:11], s37 offen offset:2048 sc1
s_waitcnt vmcnt(1)
buffer_store_dwordx4 v[16:19], v0, s[8:11], s59 offen offset:2048 sc1
s_add_u32 s31, s31, 1
k_jn_224:
s_cmp_lt_u32 s31, 128
s_cbranch_scc1 k_lay_217
s_add_u32 s30, s30, 112
s_waitcnt vmcnt(0) lgkmcnt(0)
s_barrier
s_branch k_fin_7
k_w3_128:
v_lshrrev_b32 v12, 3, v0
v_lshlrev_b32 v10, 13, v12
v_bfe_u32 v12, v0, 1, 2
v_lshrrev_b32 v13, 4, v0
v_xor_b32 v12, v12, v13
v_lshl_add_u32 v10, v12, 5, v10
v_and_b32 v14, 1, v0
v_lshl_add_u32 v10, v14, 4, v10
v_mul_u32_u24 v11, 1280, v13
v_bfe_u32 v12, v0, 1, 3
v_and_b32 v13, 1, v13
v_lshlrev_b32 v13, 1, v13
v_xor_b32 v12, v12, v13
v_xor_b32 v12, 4, v12
v_lshl_add_u32 v11, v12, 5, v11
v_lshl_add_u32 v11, v14, 4, v11
v_bfe_u32 v12, v0, 5, 1
v_lshlrev_b32 v12, 4, v12
v_bfe_u32 v13, v0, 4, 1
v_lshl_add_u32 v12, v13, 1, v12
v_bfe_u32 v13, v0, 2, 1
v_lshl_add_u32 v12, v13, 2, v12
v_bfe_u32 v13, v0, 3, 1
v_mul_u32_u24 v15, 4224, v13
v_add_u32 v12, v13, v12
v_bfe_u32 v13, v12, 1, 2
v_xor_b32 v13, 3, v13
v_lshlrev_b32 v13, 5, v13
v_lshl_add_u32 v4, v12, 7, v13
v_and_b32 v14, 3, v0
v_lshl_add_u32 v4, v14, 3, v4
v_add_u32 v5, 0x10000, v4
v_add_u32 v6, 0x20000, v4
v_bfe_u32 v12, v0, 4, 1
v_lshlrev_b32 v13, 4, v12
v_lshlrev_b32 v12, 2, v12
v_bfe_u32 v8, v0, 5, 1
v_lshl_add_u32 v13, v8, 2, v13
v_bfe_u32 v8, v0, 2, 1
v_add_u32 v13, v8, v13
v_lshl_add_u32 v12, v8, 1, v12
v_bfe_u32 v8, v0, 3, 1
v_add_u32 v8, 6, v8
v_xor_b32 v12, v12, v8
v_lshlrev_b32 v12, 5, v12
v_lshl_add_u32 v7, v13, 8, v12
v_lshl_add_u32 v7, v14, 3, v7
v_add_u32 v8, 0x10000, v7
v_add_u32 v9, 0x20000, v7
v_lshlrev_b32 v0, 4, v0
v_add_u32 v2, 65536, v0
s_lshl_b32 s49, s30, 8
s_mul_i32 s50, s30, 163840
s_mul_i32 s60, s30, 131072
s_add_u32 s60, s60, 120684544
s_add_u32 s61, s60, 4096
s_add_u32 s62, s60, 8192
s_mov_b32 m0, 6144
s_add_u32 s48, s49, 393216
buffer_load_dwordx4 v10, s[8:11], s48 offen lds
s_mov_b32 m0, 7168
s_add_u32 s48, s49, 458752
buffer_load_dwordx4 v10, s[8:11], s48 offen lds
s_mov_b32 m0, 14336
s_add_u32 s48, s49, 393344
buffer_load_dwordx4 v10, s[8:11], s48 offen lds
s_mov_b32 m0, 15360
s_add_u32 s48, s49, 458880
buffer_load_dwordx4 v10, s[8:11], s48 offen lds
s_mov_b32 m0, 22528
s_add_u32 s48, s49, 393344
buffer_load_dwordx4 v10, s[12:15], s48 offen lds
s_mov_b32 m0, 23552
s_add_u32 s48, s49, 458880
buffer_load_dwordx4 v10, s[12:15], s48 offen lds
s_mov_b32 m0, 30720
s_add_u32 s48, s49, 393216
buffer_load_dwordx4 v10, s[16:19], s48 offen lds
s_mov_b32 m0, 31744
s_add_u32 s48, s49, 458752
buffer_load_dwordx4 v10, s[16:19], s48 offen lds
s_mov_b32 m0, 38912
s_add_u32 s48, s49, 393344
buffer_load_dwordx4 v10, s[16:19], s48 offen lds
s_mov_b32 m0, 39936
s_add_u32 s48, s49, 458880
buffer_load_dwordx4 v10, s[16:19], s48 offen lds
s_mov_b32 m0, 47104
s_add_u32 s48, s49, 917504
buffer_load_dwordx4 v10, s[8:11], s48 offen lds
s_mov_b32 m0, 48128
s_add_u32 s48, s49, 983040
buffer_load_dwordx4 v10, s[8:11], s48 offen lds
s_mov_b32 m0, 55296
s_add_u32 s48, s49, 917632
buffer_load_dwordx4 v10, s[8:11], s48 offen lds
s_mov_b32 m0, 56320
s_add_u32 s48, s49, 983168
buffer_load_dwordx4 v10, s[8:11], s48 offen lds
s_mov_b32 m0, 63488
s_add_u32 s48, s49, 917632
buffer_load_dwordx4 v10, s[12:15], s48 offen lds
s_mov_b32 m0, 64512
s_add_u32 s48, s49, 983168
buffer_load_dwordx4 v10, s[12:15], s48 offen lds
s_mov_b32 m0, 71680
s_add_u32 s48, s49, 917504
buffer_load_dwordx4 v10, s[16:19], s48 offen lds
s_mov_b32 m0, 72704
s_add_u32 s48, s49, 983040
buffer_load_dwordx4 v10, s[16:19], s48 offen lds
s_mov_b32 m0, 79872
s_add_u32 s48, s49, 917632
buffer_load_dwordx4 v10, s[16:19], s48 offen lds
s_mov_b32 m0, 80896
s_add_u32 s48, s49, 983168
buffer_load_dwordx4 v10, s[16:19], s48 offen lds
s_mov_b32 m0, 88064
s_add_u32 s48, s49, 1441792
buffer_load_dwordx4 v10, s[8:11], s48 offen lds
s_mov_b32 m0, 89088
s_add_u32 s48, s49, 1507328
buffer_load_dwordx4 v10, s[8:11], s48 offen lds
s_mov_b32 m0, 96256
s_add_u32 s48, s49, 1441920
buffer_load_dwordx4 v10, s[8:11], s48 offen lds
s_mov_b32 m0, 97280
s_add_u32 s48, s49, 1507456
buffer_load_dwordx4 v10, s[8:11], s48 offen lds
s_mov_b32 m0, 104448
s_add_u32 s48, s49, 1441920
buffer_load_dwordx4 v10, s[12:15], s48 offen lds
s_mov_b32 m0, 105472
s_add_u32 s48, s49, 1507456
buffer_load_dwordx4 v10, s[12:15], s48 offen lds
s_mov_b32 m0, 112640
s_add_u32 s48, s49, 1441792
buffer_load_dwordx4 v10, s[16:19], s48 offen lds
s_mov_b32 m0, 113664
s_add_u32 s48, s49, 1507328
buffer_load_dwordx4 v10, s[16:19], s48 offen lds
s_mov_b32 m0, 120832
s_add_u32 s48, s49, 1966080
buffer_load_dwordx4 v10, s[8:11], s48 offen lds
s_mov_b32 m0, 121856
s_add_u32 s48, s49, 2031616
buffer_load_dwordx4 v10, s[8:11], s48 offen lds
s_mov_b32 m0, 129024
s_add_u32 s48, s49, 1966208
buffer_load_dwordx4 v10, s[8:11], s48 offen lds
s_mov_b32 m0, 130048
s_add_u32 s48, s49, 2031744
buffer_load_dwordx4 v10, s[8:11], s48 offen lds
s_waitcnt vmcnt(24)
s_barrier
s_mov_b32 m0, 137216
s_add_u32 s48, s49, 1966208
buffer_load_dwordx4 v10, s[12:15], s48 offen lds
s_mov_b32 m0, 138240
s_add_u32 s48, s49, 2031744
buffer_load_dwordx4 v10, s[12:15], s48 offen lds
s_mov_b32 m0, 145408
s_add_u32 s48, s49, 1966080
buffer_load_dwordx4 v10, s[16:19], s48 offen lds
s_mov_b32 m0, 146432
s_add_u32 s48, s49, 2031616
buffer_load_dwordx4 v10, s[16:19], s48 offen lds
s_mov_b32 m0, 153600
s_add_u32 s48, s49, 2490368
buffer_load_dwordx4 v10, s[8:11], s48 offen lds
s_mov_b32 m0, 154624
s_add_u32 s48, s49, 2555904
buffer_load_dwordx4 v10, s[8:11], s48 offen lds
s_mov_b32 m0, 161792
s_add_u32 s48, s49, 2490496
buffer_load_dwordx4 v10, s[8:11], s48 offen lds
s_mov_b32 m0, 162816
s_add_u32 s48, s49, 2556032
buffer_load_dwordx4 v10, s[8:11], s48 offen lds
ds_read_b64_tr_b16 a[24:25], v4 offset:0
ds_read_b64_tr_b16 a[26:27], v4 offset:1024
ds_read_b64_tr_b16 a[28:29], v4 offset:4096
ds_read_b64_tr_b16 a[30:31], v4 offset:5120
ds_read_b64_tr_b16 a[32:33], v4 offset:8192
ds_read_b64_tr_b16 a[34:35], v4 offset:9216
ds_read_b64_tr_b16 a[36:37], v4 offset:12288
ds_read_b64_tr_b16 a[38:39], v4 offset:13312
ds_read_b64_tr_b16 a[40:41], v4 offset:16384
ds_read_b64_tr_b16 a[42:43], v4 offset:17408
ds_read_b64_tr_b16 a[44:45], v4 offset:20480
ds_read_b64_tr_b16 a[46:47], v4 offset:21504
ds_read_b64_tr_b16 a[176:177], v4 offset:24576
ds_read_b64_tr_b16 a[178:179], v4 offset:25600
ds_read_b64_tr_b16 a[180:181], v4 offset:28672
ds_read_b64_tr_b16 a[182:183], v4 offset:29696
s_waitcnt lgkmcnt(0)
s_waitcnt vmcnt(24)
s_barrier
s_mov_b32 m0, 6144
s_add_u32 s48, s49, 2490496
buffer_load_dwordx4 v10, s[12:15], s48 offen lds
s_mov_b32 m0, 7168
s_add_u32 s48, s49, 2556032
buffer_load_dwordx4 v10, s[12:15], s48 offen lds
s_mov_b32 m0, 14336
s_add_u32 s48, s49, 2490368
buffer_load_dwordx4 v10, s[16:19], s48 offen lds
s_mov_b32 m0, 15360
s_add_u32 s48, s49, 2555904
buffer_load_dwordx4 v10, s[16:19], s48 offen lds
s_mov_b32 m0, 22528
s_add_u32 s48, s49, 3014656
buffer_load_dwordx4 v10, s[8:11], s48 offen lds
s_mov_b32 m0, 23552
s_add_u32 s48, s49, 3080192
buffer_load_dwordx4 v10, s[8:11], s48 offen lds
s_mov_b32 m0, 30720
s_add_u32 s48, s49, 3014784
buffer_load_dwordx4 v10, s[8:11], s48 offen lds
s_mov_b32 m0, 31744
s_add_u32 s48, s49, 3080320
buffer_load_dwordx4 v10, s[8:11], s48 offen lds
ds_read_b64_tr_b16 v[224:225], v4 offset:32768
ds_read_b64_tr_b16 v[226:227], v4 offset:33792
ds_read_b64_tr_b16 v[228:229], v4 offset:36864
ds_read_b64_tr_b16 v[230:231], v4 offset:37888
ds_read_b64_tr_b16 a[0:1], v4 offset:40960
ds_read_b64_tr_b16 a[2:3], v4 offset:41984
ds_read_b64_tr_b16 a[4:5], v4 offset:45056
ds_read_b64_tr_b16 a[6:7], v4 offset:46080
ds_read_b64_tr_b16 a[8:9], v4 offset:49152
ds_read_b64_tr_b16 a[10:11], v4 offset:50176
ds_read_b64_tr_b16 a[12:13], v4 offset:53248
ds_read_b64_tr_b16 a[14:15], v4 offset:54272
ds_read_b64_tr_b16 a[16:17], v4 offset:57344
ds_read_b64_tr_b16 a[18:19], v4 offset:58368
ds_read_b64_tr_b16 a[20:21], v4 offset:61440
ds_read_b64_tr_b16 a[22:23], v4 offset:62464
s_waitcnt lgkmcnt(0)
s_waitcnt vmcnt(24)
s_barrier
s_mov_b32 m0, 38912
s_add_u32 s48, s49, 3014784
buffer_load_dwordx4 v10, s[12:15], s48 offen lds
s_mov_b32 m0, 39936
s_add_u32 s48, s49, 3080320
buffer_load_dwordx4 v10, s[12:15], s48 offen lds
s_mov_b32 m0, 47104
s_add_u32 s48, s49, 3014656
buffer_load_dwordx4 v10, s[16:19], s48 offen lds
s_mov_b32 m0, 48128
s_add_u32 s48, s49, 3080192
buffer_load_dwordx4 v10, s[16:19], s48 offen lds
s_mov_b32 m0, 55296
s_add_u32 s48, s49, 3539072
buffer_load_dwordx4 v10, s[8:11], s48 offen lds
s_mov_b32 m0, 56320
s_add_u32 s48, s49, 3604608
buffer_load_dwordx4 v10, s[8:11], s48 offen lds
s_mov_b32 m0, 63488
s_add_u32 s48, s49, 4063232
buffer_load_dwordx4 v10, s[8:11], s48 offen lds
s_mov_b32 m0, 64512
s_add_u32 s48, s49, 4128768
buffer_load_dwordx4 v10, s[8:11], s48 offen lds
ds_read_b64_tr_b16 v[16:17], v5 offset:0
ds_read_b64_tr_b16 v[18:19], v5 offset:1024
ds_read_b64_tr_b16 v[20:21], v5 offset:4096
ds_read_b64_tr_b16 v[22:23], v5 offset:5120
ds_read_b64_tr_b16 v[24:25], v5 offset:8192
ds_read_b64_tr_b16 v[26:27], v5 offset:9216
ds_read_b64_tr_b16 v[28:29], v5 offset:12288
ds_read_b64_tr_b16 v[30:31], v5 offset:13312
ds_read_b64_tr_b16 a[80:81], v5 offset:16384
ds_read_b64_tr_b16 a[82:83], v5 offset:17408
ds_read_b64_tr_b16 a[84:85], v5 offset:20480
ds_read_b64_tr_b16 a[86:87], v5 offset:21504
ds_read_b64_tr_b16 a[88:89], v5 offset:24576
ds_read_b64_tr_b16 a[90:91], v5 offset:25600
ds_read_b64_tr_b16 a[92:93], v5 offset:28672
ds_read_b64_tr_b16 a[94:95], v5 offset:29696
s_waitcnt lgkmcnt(0)
buffer_store_dwordx4 v[16:19], v0, s[4:7], s60 offen offset:0
buffer_store_dwordx4 v[20:23], v0, s[4:7], s60 offen offset:1024
buffer_store_dwordx4 v[24:27], v0, s[4:7], s60 offen offset:2048
buffer_store_dwordx4 v[28:31], v0, s[4:7], s60 offen offset:3072
s_waitcnt vmcnt(28)
s_barrier
s_mov_b32 m0, 71680
s_add_u32 s48, s49, 4063360
buffer_load_dwordx4 v10, s[8:11], s48 offen lds
s_mov_b32 m0, 72704
s_add_u32 s48, s49, 4128896
buffer_load_dwordx4 v10, s[8:11], s48 offen lds
s_mov_b32 m0, 79872
s_add_u32 s48, s49, 4587520
buffer_load_dwordx4 v10, s[8:11], s48 offen lds
s_mov_b32 m0, 80896
s_add_u32 s48, s49, 4653056
buffer_load_dwordx4 v10, s[8:11], s48 offen lds
s_mov_b32 m0, 88064
s_add_u32 s48, s49, 4587648
buffer_load_dwordx4 v10, s[8:11], s48 offen lds
s_mov_b32 m0, 89088
s_add_u32 s48, s49, 4653184
buffer_load_dwordx4 v10, s[8:11], s48 offen lds
s_mov_b32 m0, 96256
s_add_u32 s48, s49, 5111808
buffer_load_dwordx4 v10, s[8:11], s48 offen lds
s_mov_b32 m0, 97280
s_add_u32 s48, s49, 5177344
buffer_load_dwordx4 v10, s[8:11], s48 offen lds
ds_read_b64_tr_b16 a[96:97], v5 offset:32768
ds_read_b64_tr_b16 a[98:99], v5 offset:33792
ds_read_b64_tr_b16 a[100:101], v5 offset:36864
ds_read_b64_tr_b16 a[102:103], v5 offset:37888
ds_read_b64_tr_b16 a[104:105], v5 offset:40960
ds_read_b64_tr_b16 a[106:107], v5 offset:41984
ds_read_b64_tr_b16 a[108:109], v5 offset:45056
ds_read_b64_tr_b16 a[110:111], v5 offset:46080
ds_read_b64_tr_b16 a[112:113], v5 offset:49152
ds_read_b64_tr_b16 a[114:115], v5 offset:50176
ds_read_b64_tr_b16 a[116:117], v5 offset:53248
ds_read_b64_tr_b16 a[118:119], v5 offset:54272
ds_read_b64_tr_b16 a[120:121], v5 offset:57344
ds_read_b64_tr_b16 a[122:123], v5 offset:58368
ds_read_b64_tr_b16 a[124:125], v5 offset:61440
ds_read_b64_tr_b16 a[126:127], v5 offset:62464
s_waitcnt lgkmcnt(0)
s_waitcnt vmcnt(28)
s_barrier
s_mov_b32 m0, 104448
s_add_u32 s48, s49, 5111936
buffer_load_dwordx4 v10, s[8:11], s48 offen lds
s_mov_b32 m0, 105472
s_add_u32 s48, s49, 5177472
buffer_load_dwordx4 v10, s[8:11], s48 offen lds
s_mov_b32 m0, 112640
s_add_u32 s48, s49, 3538944
buffer_load_dwordx4 v10, s[12:15], s48 offen lds
s_mov_b32 m0, 113664
s_add_u32 s48, s49, 3604480
buffer_load_dwordx4 v10, s[12:15], s48 offen lds
s_mov_b32 m0, 120832
s_add_u32 s48, s49, 3539072
buffer_load_dwordx4 v10, s[12:15], s48 offen lds
s_mov_b32 m0, 121856
s_add_u32 s48, s49, 3604608
buffer_load_dwordx4 v10, s[12:15], s48 offen lds
s_mov_b32 m0, 129024
s_add_u32 s48, s49, 4063232
buffer_load_dwordx4 v10, s[12:15], s48 offen lds
s_mov_b32 m0, 130048
s_add_u32 s48, s49, 4128768
buffer_load_dwordx4 v10, s[12:15], s48 offen lds
ds_read_b64_tr_b16 a[128:129], v6 offset:0
ds_read_b64_tr_b16 a[130:131], v6 offset:1024
ds_read_b64_tr_b16 a[132:133], v6 offset:4096
ds_read_b64_tr_b16 a[134:135], v6 offset:5120
ds_read_b64_tr_b16 a[136:137], v6 offset:8192
ds_read_b64_tr_b16 a[138:139], v6 offset:9216
ds_read_b64_tr_b16 a[140:141], v6 offset:12288
ds_read_b64_tr_b16 a[142:143], v6 offset:13312
ds_read_b64_tr_b16 a[144:145], v6 offset:16384
ds_read_b64_tr_b16 a[146:147], v6 offset:17408
ds_read_b64_tr_b16 a[148:149], v6 offset:20480
ds_read_b64_tr_b16 a[150:151], v6 offset:21504
ds_read_b64_tr_b16 a[152:153], v6 offset:24576
ds_read_b64_tr_b16 a[154:155], v6 offset:25600
ds_read_b64_tr_b16 a[156:157], v6 offset:28672
ds_read_b64_tr_b16 a[158:159], v6 offset:29696
s_waitcnt lgkmcnt(0)
s_waitcnt vmcnt(28)
s_barrier
s_mov_b32 m0, 137216
s_add_u32 s48, s49, 4063360
buffer_load_dwordx4 v10, s[12:15], s48 offen lds
s_mov_b32 m0, 138240
s_add_u32 s48, s49, 4128896
buffer_load_dwordx4 v10, s[12:15], s48 offen lds
s_mov_b32 m0, 145408
s_add_u32 s48, s49, 4587520
buffer_load_dwordx4 v10, s[12:15], s48 offen lds
s_mov_b32 m0, 146432
s_add_u32 s48, s49, 4653056
buffer_load_dwordx4 v10, s[12:15], s48 offen lds
s_mov_b32 m0, 153600
s_add_u32 s48, s49, 4587648
buffer_load_dwordx4 v10, s[12:15], s48 offen lds
s_mov_b32 m0, 154624
s_add_u32 s48, s49, 4653184
buffer_load_dwordx4 v10, s[12:15], s48 offen lds
s_mov_b32 m0, 161792
s_add_u32 s48, s49, 5111808
buffer_load_dwordx4 v10, s[12:15], s48 offen lds
s_mov_b32 m0, 162816
s_add_u32 s48, s49, 5177344
buffer_load_dwordx4 v10, s[12:15], s48 offen lds
ds_read_b64_tr_b16 a[160:161], v4 offset:0
ds_read_b64_tr_b16 a[162:163], v4 offset:1024
ds_read_b64_tr_b16 a[164:165], v4 offset:4096
ds_read_b64_tr_b16 a[166:167], v4 offset:5120
ds_read_b64_tr_b16 a[168:169], v4 offset:8192
ds_read_b64_tr_b16 a[170:171], v4 offset:9216
ds_read_b64_tr_b16 a[172:173], v4 offset:12288
ds_read_b64_tr_b16 a[174:175], v4 offset:13312
ds_read_b64_tr_b16 a[48:49], v4 offset:16384
ds_read_b64_tr_b16 a[50:51], v4 offset:17408
ds_read_b64_tr_b16 a[52:53], v4 offset:20480
ds_read_b64_tr_b16 a[54:55], v4 offset:21504
ds_read_b64_tr_b16 a[56:57], v4 offset:24576
ds_read_b64_tr_b16 a[58:59], v4 offset:25600
ds_read_b64_tr_b16 a[60:61], v4 offset:28672
ds_read_b64_tr_b16 a[62:63], v4 offset:29696
s_waitcnt lgkmcnt(0)
s_waitcnt vmcnt(28)
s_barrier
s_mov_b32 m0, 6144
s_add_u32 s48, s49, 5111936
buffer_load_dwordx4 v10, s[12:15], s48 offen lds
s_mov_b32 m0, 7168
s_add_u32 s48, s49, 5177472
buffer_load_dwordx4 v10, s[12:15], s48 offen lds
s_mov_b32 m0, 14336
s_add_u32 s48, s49, 3538944
buffer_load_dwordx4 v10, s[16:19], s48 offen lds
s_mov_b32 m0, 15360
s_add_u32 s48, s49, 3604480
buffer_load_dwordx4 v10, s[16:19], s48 offen lds
s_mov_b32 m0, 22528
s_add_u32 s48, s49, 3539072
buffer_load_dwordx4 v10, s[16:19], s48 offen lds
s_mov_b32 m0, 23552
s_add_u32 s48, s49, 3604608
buffer_load_dwordx4 v10, s[16:19], s48 offen lds
s_mov_b32 m0, 30720
s_add_u32 s48, s49, 4063232
buffer_load_dwordx4 v10, s[16:19], s48 offen lds
s_mov_b32 m0, 31744
s_add_u32 s48, s49, 4128768
buffer_load_dwordx4 v10, s[16:19], s48 offen lds
ds_read_b64_tr_b16 a[64:65], v4 offset:32768
ds_read_b64_tr_b16 a[66:67], v4 offset:33792
ds_read_b64_tr_b16 a[68:69], v4 offset:36864
ds_read_b64_tr_b16 a[70:71], v4 offset:37888
ds_read_b64_tr_b16 a[72:73], v4 offset:40960
ds_read_b64_tr_b16 a[74:75], v4 offset:41984
ds_read_b64_tr_b16 a[76:77], v4 offset:45056
ds_read_b64_tr_b16 a[78:79], v4 offset:46080
ds_read_b64_tr_b16 a[200:201], v4 offset:49152
ds_read_b64_tr_b16 a[202:203], v4 offset:50176
ds_read_b64_tr_b16 a[204:205], v4 offset:53248
ds_read_b64_tr_b16 a[206:207], v4 offset:54272
ds_read_b64_tr_b16 a[208:209], v4 offset:57344
ds_read_b64_tr_b16 a[210:211], v4 offset:58368
ds_read_b64_tr_b16 a[212:213], v4 offset:61440
ds_read_b64_tr_b16 a[214:215], v4 offset:62464
s_waitcnt lgkmcnt(0)
s_waitcnt vmcnt(24)
s_barrier
s_mov_b32 m0, 38912
s_add_u32 s48, s49, 4063360
buffer_load_dwordx4 v10, s[16:19], s48 offen lds
s_mov_b32 m0, 39936
s_add_u32 s48, s49, 4128896
buffer_load_dwordx4 v10, s[16:19], s48 offen lds
s_mov_b32 m0, 47104
s_add_u32 s48, s49, 4587520
buffer_load_dwordx4 v10, s[16:19], s48 offen lds
s_mov_b32 m0, 48128
s_add_u32 s48, s49, 4653056
buffer_load_dwordx4 v10, s[16:19], s48 offen lds
s_mov_b32 m0, 55296
s_add_u32 s48, s49, 4587648
buffer_load_dwordx4 v10, s[16:19], s48 offen lds
s_mov_b32 m0, 56320
s_add_u32 s48, s49, 4653184
buffer_load_dwordx4 v10, s[16:19], s48 offen lds
s_mov_b32 m0, 63488
s_add_u32 s48, s49, 5111808
buffer_load_dwordx4 v10, s[16:19], s48 offen lds
s_mov_b32 m0, 64512
s_add_u32 s48, s49, 5177344
buffer_load_dwordx4 v10, s[16:19], s48 offen lds
ds_read_b64_tr_b16 a[216:217], v5 offset:0
ds_read_b64_tr_b16 a[218:219], v5 offset:1024
ds_read_b64_tr_b16 a[220:221], v5 offset:4096
ds_read_b64_tr_b16 a[222:223], v5 offset:5120
ds_read_b64_tr_b16 a[224:225], v5 offset:8192
ds_read_b64_tr_b16 a[226:227], v5 offset:9216
ds_read_b64_tr_b16 a[228:229], v5 offset:12288
ds_read_b64_tr_b16 a[230:231], v5 offset:13312
ds_read_b64_tr_b16 a[232:233], v5 offset:16384
ds_read_b64_tr_b16 a[234:235], v5 offset:17408
ds_read_b64_tr_b16 a[236:237], v5 offset:20480
ds_read_b64_tr_b16 a[238:239], v5 offset:21504
ds_read_b64_tr_b16 a[184:185], v5 offset:24576
ds_read_b64_tr_b16 a[186:187], v5 offset:25600
ds_read_b64_tr_b16 a[188:189], v5 offset:28672
ds_read_b64_tr_b16 a[190:191], v5 offset:29696
s_waitcnt lgkmcnt(0)
s_waitcnt vmcnt(24)
s_barrier
s_mov_b32 m0, 71680
s_add_u32 s48, s49, 5111936
buffer_load_dwordx4 v10, s[16:19], s48 offen lds
s_mov_b32 m0, 72704
s_add_u32 s48, s49, 5177472
buffer_load_dwordx4 v10, s[16:19], s48 offen lds
s_mov_b32 m0, 79872
s_add_u32 s48, s50, 92160
buffer_load_dwordx4 v11, s[20:23], s48 offen lds
s_mov_b32 m0, 80896
s_add_u32 s48, s50, 97280
buffer_load_dwordx4 v11, s[20:23], s48 offen lds
s_mov_b32 m0, 88064
s_add_u32 s48, s50, 112640
buffer_load_dwordx4 v11, s[20:23], s48 offen lds
s_mov_b32 m0, 89088
s_add_u32 s48, s50, 117760
buffer_load_dwordx4 v11, s[20:23], s48 offen lds
s_mov_b32 m0, 96256
s_add_u32 s48, s50, 133120
buffer_load_dwordx4 v11, s[20:23], s48 offen lds
s_mov_b32 m0, 97280
s_add_u32 s48, s50, 138240
buffer_load_dwordx4 v11, s[20:23], s48 offen lds
ds_read_b64_tr_b16 a[192:193], v5 offset:32768
ds_read_b64_tr_b16 a[194:195], v5 offset:33792
ds_read_b64_tr_b16 a[196:197], v5 offset:36864
ds_read_b64_tr_b16 a[198:199], v5 offset:37888
ds_read_b64_tr_b16 a[248:249], v5 offset:40960
ds_read_b64_tr_b16 a[250:251], v5 offset:41984
ds_read_b64_tr_b16 a[252:253], v5 offset:45056
ds_read_b64_tr_b16 a[254:255], v5 offset:46080
ds_read_b64_tr_b16 v[72:73], v5 offset:49152
ds_read_b64_tr_b16 v[74:75], v5 offset:50176
ds_read_b64_tr_b16 v[76:77], v5 offset:53248
ds_read_b64_tr_b16 v[78:79], v5 offset:54272
ds_read_b64_tr_b16 v[80:81], v5 offset:57344
ds_read_b64_tr_b16 v[82:83], v5 offset:58368
ds_read_b64_tr_b16 v[84:85], v5 offset:61440
ds_read_b64_tr_b16 v[86:87], v5 offset:62464
s_waitcnt lgkmcnt(0)
s_waitcnt vmcnt(24)
s_barrier
s_mov_b32 m0, 104448
s_add_u32 s48, s50, 153600
buffer_load_dwordx4 v11, s[20:23], s48 offen lds
s_mov_b32 m0, 105472
s_add_u32 s48, s50, 158720
buffer_load_dwordx4 v11, s[20:23], s48 offen lds
s_mov_b32 m0, 112640
s_add_u32 s48, s50, 92416
buffer_load_dwordx4 v11, s[20:23], s48 offen lds
s_mov_b32 m0, 113664
s_add_u32 s48, s50, 97536
buffer_load_dwordx4 v11, s[20:23], s48 offen lds
s_mov_b32 m0, 120832
s_add_u32 s48, s50, 112896
buffer_load_dwordx4 v11, s[20:23], s48 offen lds
s_mov_b32 m0, 121856
s_add_u32 s48, s50, 118016
buffer_load_dwordx4 v11, s[20:23], s48 offen lds
s_mov_b32 m0, 129024
s_add_u32 s48, s50, 133376
buffer_load_dwordx4 v11, s[20:23], s48 offen lds
s_mov_b32 m0, 130048
s_add_u32 s48, s50, 138496
buffer_load_dwordx4 v11, s[20:23], s48 offen lds
ds_read_b64_tr_b16 v[88:89], v6 offset:0
ds_read_b64_tr_b16 v[90:91], v6 offset:1024
ds_read_b64_tr_b16 v[92:93], v6 offset:4096
ds_read_b64_tr_b16 v[94:95], v6 offset:5120
ds_read_b64_tr_b16 v[96:97], v6 offset:8192
ds_read_b64_tr_b16 v[98:99], v6 offset:9216
ds_read_b64_tr_b16 v[100:101], v6 offset:12288
ds_read_b64_tr_b16 v[102:103], v6 offset:13312
ds_read_b64_tr_b16 v[104:105], v6 offset:16384
ds_read_b64_tr_b16 v[106:107], v6 offset:17408
ds_read_b64_tr_b16 v[108:109], v6 offset:20480
ds_read_b64_tr_b16 v[110:111], v6 offset:21504
ds_read_b64_tr_b16 v[248:249], v6 offset:24576
ds_read_b64_tr_b16 v[250:251], v6 offset:25600
ds_read_b64_tr_b16 v[252:253], v6 offset:28672
ds_read_b64_tr_b16 v[254:255], v6 offset:29696
s_waitcnt lgkmcnt(0)
s_waitcnt vmcnt(24)
s_barrier
s_mov_b32 m0, 137216
s_add_u32 s48, s50, 153856
buffer_load_dwordx4 v11, s[20:23], s48 offen lds
s_mov_b32 m0, 138240
s_add_u32 s48, s50, 158976
buffer_load_dwordx4 v11, s[20:23], s48 offen lds
s_mov_b32 m0, 145408
s_add_u32 s48, s50, 92672
buffer_load_dwordx4 v11, s[20:23], s48 offen lds
s_mov_b32 m0, 146432
s_add_u32 s48, s50, 97792
buffer_load_dwordx4 v11, s[20:23], s48 offen lds
s_mov_b32 m0, 153600
s_add_u32 s48, s50, 113152
buffer_load_dwordx4 v11, s[20:23], s48 offen lds
s_mov_b32 m0, 154624
s_add_u32 s48, s50, 118272
buffer_load_dwordx4 v11, s[20:23], s48 offen lds
s_mov_b32 m0, 161792
s_add_u32 s48, s50, 133632
buffer_load_dwordx4 v11, s[20:23], s48 offen lds
s_mov_b32 m0, 162816
s_add_u32 s48, s50, 138752
buffer_load_dwordx4 v11, s[20:23], s48 offen lds
ds_read_b64_tr_b16 a[240:241], v4 offset:0
ds_read_b64_tr_b16 a[242:243], v4 offset:1024
ds_read_b64_tr_b16 a[244:245], v4 offset:4096
ds_read_b64_tr_b16 a[246:247], v4 offset:5120
ds_read_b64_tr_b16 v[128:129], v4 offset:8192
ds_read_b64_tr_b16 v[130:131], v4 offset:9216
ds_read_b64_tr_b16 v[132:133], v4 offset:12288
ds_read_b64_tr_b16 v[134:135], v4 offset:13312
ds_read_b64_tr_b16 v[136:137], v4 offset:16384
ds_read_b64_tr_b16 v[138:139], v4 offset:17408
ds_read_b64_tr_b16 v[140:141], v4 offset:20480
ds_read_b64_tr_b16 v[142:143], v4 offset:21504
ds_read_b64_tr_b16 v[144:145], v4 offset:24576
ds_read_b64_tr_b16 v[146:147], v4 offset:25600
ds_read_b64_tr_b16 v[148:149], v4 offset:28672
ds_read_b64_tr_b16 v[150:151], v4 offset:29696
s_waitcnt lgkmcnt(0)
s_waitcnt vmcnt(24)
s_barrier
s_mov_b32 m0, 6144
s_add_u32 s48, s50, 154112
buffer_load_dwordx4 v11, s[20:23], s48 offen lds
s_mov_b32 m0, 7168
s_add_u32 s48, s50, 159232
buffer_load_dwordx4 v11, s[20:23], s48 offen lds
s_mov_b32 m0, 14336
s_add_u32 s48, s49, 393216
buffer_load_dwordx4 v10, s[12:15], s48 offen lds
s_mov_b32 m0, 15360
s_add_u32 s48, s49, 458752
buffer_load_dwordx4 v10, s[12:15], s48 offen lds
s_mov_b32 m0, 22528
s_add_u32 s48, s49, 917504
buffer_load_dwordx4 v10, s[12:15], s48 offen lds
s_mov_b32 m0, 23552
s_add_u32 s48, s49, 983040
buffer_load_dwordx4 v10, s[12:15], s48 offen lds
s_mov_b32 m0, 30720
s_add_u32 s48, s49, 1441792
buffer_load_dwordx4 v10, s[12:15], s48 offen lds
s_mov_b32 m0, 31744
s_add_u32 s48, s49, 1507328
buffer_load_dwordx4 v10, s[12:15], s48 offen lds
ds_read_b64_tr_b16 v[152:153], v4 offset:32768
ds_read_b64_tr_b16 v[154:155], v4 offset:33792
ds_read_b64_tr_b16 v[156:157], v4 offset:36864
ds_read_b64_tr_b16 v[158:159], v4 offset:37888
ds_read_b64_tr_b16 v[160:161], v4 offset:40960
ds_read_b64_tr_b16 v[162:163], v4 offset:41984
ds_read_b64_tr_b16 v[164:165], v4 offset:45056
ds_read_b64_tr_b16 v[166:167], v4 offset:46080
ds_read_b64_tr_b16 v[168:169], v4 offset:49152
ds_read_b64_tr_b16 v[170:171], v4 offset:50176
ds_read_b64_tr_b16 v[172:173], v4 offset:53248
ds_read_b64_tr_b16 v[174:175], v4 offset:54272
ds_read_b64_tr_b16 v[112:113], v4 offset:57344
ds_read_b64_tr_b16 v[114:115], v4 offset:58368
ds_read_b64_tr_b16 v[116:117], v4 offset:61440
ds_read_b64_tr_b16 v[118:119], v4 offset:62464
s_waitcnt lgkmcnt(0)
s_waitcnt vmcnt(24)
s_barrier
s_mov_b32 m0, 38912
s_add_u32 s48, s49, 1966080
buffer_load_dwordx4 v10, s[12:15], s48 offen lds
s_mov_b32 m0, 39936
s_add_u32 s48, s49, 2031616
buffer_load_dwordx4 v10, s[12:15], s48 offen lds
s_mov_b32 m0, 47104
s_add_u32 s48, s49, 2490368
buffer_load_dwordx4 v10, s[12:15], s48 offen lds
s_mov_b32 m0, 48128
s_add_u32 s48, s49, 2555904
buffer_load_dwordx4 v10, s[12:15], s48 offen lds
s_mov_b32 m0, 55296
s_add_u32 s48, s49, 3014656
buffer_load_dwordx4 v10, s[12:15], s48 offen lds
s_mov_b32 m0, 56320
s_add_u32 s48, s49, 3080192
buffer_load_dwordx4 v10, s[12:15], s48 offen lds
s_mov_b32 m0, 63488
s_add_u32 s48, s49, 1441920
buffer_load_dwordx4 v10, s[16:19], s48 offen lds
s_mov_b32 m0, 64512
s_add_u32 s48, s49, 1507456
buffer_load_dwordx4 v10, s[16:19], s48 offen lds
ds_read_b64_tr_b16 v[120:121], v5 offset:0
ds_read_b64_tr_b16 v[122:123], v5 offset:1024
ds_read_b64_tr_b16 v[124:125], v5 offset:4096
ds_read_b64_tr_b16 v[126:127], v5 offset:5120
ds_read_b64_tr_b16 v[176:177], v8 offset:8192
ds_read_b64_tr_b16 v[178:179], v8 offset:8704
ds_read_b64_tr_b16 v[180:181], v8 offset:10240
ds_read_b64_tr_b16 v[182:183], v8 offset:10752
ds_read_b64_tr_b16 v[184:185], v8 offset:16384
ds_read_b64_tr_b16 v[186:187], v8 offset:16896
ds_read_b64_tr_b16 v[188:189], v8 offset:18432
ds_read_b64_tr_b16 v[190:191], v8 offset:18944
ds_read_b64_tr_b16 v[192:193], v8 offset:24576
ds_read_b64_tr_b16 v[194:195], v8 offset:25088
ds_read_b64_tr_b16 v[196:197], v8 offset:26624
ds_read_b64_tr_b16 v[198:199], v8 offset:27136
s_waitcnt lgkmcnt(0)
s_waitcnt vmcnt(24)
s_barrier
s_mov_b32 m0, 71680
s_add_u32 s48, s49, 1966208
buffer_load_dwordx4 v10, s[16:19], s48 offen lds
s_mov_b32 m0, 72704
s_add_u32 s48, s49, 2031744
buffer_load_dwordx4 v10, s[16:19], s48 offen lds
s_mov_b32 m0, 79872
s_add_u32 s48, s49, 2490496
buffer_load_dwordx4 v10, s[16:19], s48 offen lds
s_mov_b32 m0, 80896
s_add_u32 s48, s49, 2556032
buffer_load_dwordx4 v10, s[16:19], s48 offen lds
s_mov_b32 m0, 88064
s_add_u32 s48, s49, 3014784
buffer_load_dwordx4 v10, s[16:19], s48 offen lds
s_mov_b32 m0, 89088
s_add_u32 s48, s49, 3080320
buffer_load_dwordx4 v10, s[16:19], s48 offen lds
s_mov_b32 m0, 96256
s_add_u32 s48, s50, 92928
buffer_load_dwordx4 v11, s[20:23], s48 offen lds
s_mov_b32 m0, 97280
s_add_u32 s48, s50, 98048
buffer_load_dwordx4 v11, s[20:23], s48 offen lds
v_xor_b32 v12, v15, v8
ds_read_b64_tr_b16 v[16:17], v12 offset:32768
ds_read_b64_tr_b16 v[18:19], v12 offset:33280
ds_read_b64_tr_b16 v[20:21], v12 offset:34816
ds_read_b64_tr_b16 v[22:23], v12 offset:35328
ds_read_b64_tr_b16 v[240:241], v8 offset:40960
ds_read_b64_tr_b16 v[242:243], v8 offset:41472
ds_read_b64_tr_b16 v[244:245], v8 offset:43008
ds_read_b64_tr_b16 v[246:247], v8 offset:43520
ds_read_b64_tr_b16 v[232:233], v8 offset:49152
ds_read_b64_tr_b16 v[234:235], v8 offset:49664
ds_read_b64_tr_b16 v[236:237], v8 offset:51200
ds_read_b64_tr_b16 v[238:239], v8 offset:51712
ds_read_b64_tr_b16 v[40:41], v8 offset:57344
ds_read_b64_tr_b16 v[42:43], v8 offset:57856
ds_read_b64_tr_b16 v[44:45], v8 offset:59392
ds_read_b64_tr_b16 v[46:47], v8 offset:59904
s_waitcnt lgkmcnt(0)
buffer_store_dwordx4 v[16:19], v0, s[4:7], s61 offen offset:0
buffer_store_dwordx4 v[20:23], v0, s[4:7], s61 offen offset:1024
buffer_store_dwordx4 v[40:43], v0, s[4:7], s62 offen offset:0
buffer_store_dwordx4 v[44:47], v0, s[4:7], s62 offen offset:1024
s_waitcnt vmcnt(28)
s_barrier
s_mov_b32 m0, 104448
s_add_u32 s48, s50, 113408
buffer_load_dwordx4 v11, s[20:23], s48 offen lds
s_mov_b32 m0, 105472
s_add_u32 s48, s50, 118528
buffer_load_dwordx4 v11, s[20:23], s48 offen lds
s_mov_b32 m0, 112640
s_add_u32 s48, s50, 133888
buffer_load_dwordx4 v11, s[20:23], s48 offen lds
s_mov_b32 m0, 113664
s_add_u32 s48, s50, 139008
buffer_load_dwordx4 v11, s[20:23], s48 offen lds
s_mov_b32 m0, 120832
s_add_u32 s48, s50, 154368
buffer_load_dwordx4 v11, s[20:23], s48 offen lds
s_mov_b32 m0, 121856
s_add_u32 s48, s50, 159488
buffer_load_dwordx4 v11, s[20:23], s48 offen lds
s_mov_b32 m0, 129024
s_add_u32 s48, s50, 93184
buffer_load_dwordx4 v11, s[20:23], s48 offen lds
s_mov_b32 m0, 130048
s_add_u32 s48, s50, 98304
buffer_load_dwordx4 v11, s[20:23], s48 offen lds
v_xor_b32 v12, v15, v9
ds_read_b64_tr_b16 v[16:17], v12 offset:0
ds_read_b64_tr_b16 v[18:19], v12 offset:512
ds_read_b64_tr_b16 v[20:21], v12 offset:2048
ds_read_b64_tr_b16 v[22:23], v12 offset:2560
ds_read_b64_tr_b16 v[24:25], v9 offset:8192
ds_read_b64_tr_b16 v[26:27], v9 offset:8704
ds_read_b64_tr_b16 v[28:29], v9 offset:10240
ds_read_b64_tr_b16 v[30:31], v9 offset:10752
ds_read_b64_tr_b16 v[208:209], v9 offset:16384
ds_read_b64_tr_b16 v[210:211], v9 offset:16896
ds_read_b64_tr_b16 v[212:213], v9 offset:18432
ds_read_b64_tr_b16 v[214:215], v9 offset:18944
ds_read_b64_tr_b16 v[216:217], v9 offset:24576
ds_read_b64_tr_b16 v[218:219], v9 offset:25088
ds_read_b64_tr_b16 v[220:221], v9 offset:26624
ds_read_b64_tr_b16 v[222:223], v9 offset:27136
s_waitcnt lgkmcnt(0)
buffer_store_dwordx4 v[16:19], v0, s[4:7], s61 offen offset:2048
buffer_store_dwordx4 v[20:23], v0, s[4:7], s61 offen offset:3072
buffer_store_dwordx4 v[24:27], v0, s[4:7], s62 offen offset:2048
buffer_store_dwordx4 v[28:31], v0, s[4:7], s62 offen offset:3072
s_waitcnt vmcnt(38)
s_barrier
s_mov_b32 m0, 137216
s_add_u32 s48, s50, 113664
buffer_load_dwordx4 v11, s[20:23], s48 offen lds
s_mov_b32 m0, 138240
s_add_u32 s48, s50, 118784
buffer_load_dwordx4 v11, s[20:23], s48 offen lds
s_mov_b32 m0, 145408
s_add_u32 s48, s50, 134144
buffer_load_dwordx4 v11, s[20:23], s48 offen lds
s_mov_b32 m0, 146432
s_add_u32 s48, s50, 139264
buffer_load_dwordx4 v11, s[20:23], s48 offen lds
s_mov_b32 m0, 153600
s_add_u32 s48, s50, 154624
buffer_load_dwordx4 v11, s[20:23], s48 offen lds
s_mov_b32 m0, 154624
s_add_u32 s48, s50, 159744
buffer_load_dwordx4 v11, s[20:23], s48 offen lds
s_mov_b32 m0, 161792
s_add_u32 s48, s49, 3538944
buffer_load_dwordx4 v10, s[8:11], s48 offen lds
s_mov_b32 m0, 162816
s_add_u32 s48, s49, 3604480
buffer_load_dwordx4 v10, s[8:11], s48 offen lds
v_xor_b32 v12, v15, v7
ds_read_b64_tr_b16 v[200:201], v12 offset:0
ds_read_b64_tr_b16 v[202:203], v12 offset:512
ds_read_b64_tr_b16 v[204:205], v12 offset:2048
ds_read_b64_tr_b16 v[206:207], v12 offset:2560
s_waitcnt lgkmcnt(0)
s_waitcnt vmcnt(32)
s_barrier
ds_read_b64_tr_b16 v[16:17], v4 offset:8192
ds_read_b64_tr_b16 v[18:19], v4 offset:9216
ds_read_b64_tr_b16 v[20:21], v4 offset:12288
ds_read_b64_tr_b16 v[22:23], v4 offset:13312
ds_read_b64_tr_b16 v[24:25], v4 offset:16384
ds_read_b64_tr_b16 v[26:27], v4 offset:17408
ds_read_b64_tr_b16 v[28:29], v4 offset:20480
ds_read_b64_tr_b16 v[30:31], v4 offset:21504
ds_read_b64_tr_b16 v[32:33], v4 offset:24576
ds_read_b64_tr_b16 v[34:35], v4 offset:25600
ds_read_b64_tr_b16 v[36:37], v4 offset:28672
ds_read_b64_tr_b16 v[38:39], v4 offset:29696
ds_read_b64_tr_b16 v[40:41], v4 offset:32768
ds_read_b64_tr_b16 v[42:43], v4 offset:33792
ds_read_b64_tr_b16 v[44:45], v4 offset:36864
ds_read_b64_tr_b16 v[46:47], v4 offset:37888
ds_read_b64_tr_b16 v[48:49], v4 offset:40960
ds_read_b64_tr_b16 v[50:51], v4 offset:41984
ds_read_b64_tr_b16 v[52:53], v4 offset:45056
ds_read_b64_tr_b16 v[54:55], v4 offset:46080
ds_read_b64_tr_b16 v[56:57], v4 offset:49152
ds_read_b64_tr_b16 v[58:59], v4 offset:50176
ds_read_b64_tr_b16 v[60:61], v4 offset:53248
ds_read_b64_tr_b16 v[62:63], v4 offset:54272
ds_read_b64_tr_b16 v[64:65], v4 offset:57344
ds_read_b64_tr_b16 v[66:67], v4 offset:58368
ds_read_b64_tr_b16 v[68:69], v4 offset:61440
ds_read_b64_tr_b16 v[70:71], v4 offset:62464
s_waitcnt lgkmcnt(0)
s_barrier
ds_write_b128 v0, v[16:19] offset:51200
ds_write_b128 v0, v[20:23] offset:52224
ds_write_b128 v0, v[24:27] offset:53248
ds_write_b128 v0, v[28:31] offset:54272
ds_write_b128 v0, v[32:35] offset:55296
ds_write_b128 v0, v[36:39] offset:56320
ds_write_b128 v0, v[40:43] offset:57344
ds_write_b128 v0, v[44:47] offset:58368
ds_write_b128 v0, v[48:51] offset:59392
ds_write_b128 v0, v[52:55] offset:60416
ds_write_b128 v0, v[56:59] offset:61440
ds_write_b128 v0, v[60:63] offset:62464
ds_write_b128 v0, v[64:67] offset:63488
ds_write_b128 v0, v[68:71] offset:64512
s_waitcnt lgkmcnt(0)
s_waitcnt vmcnt(6)
s_barrier
ds_read_b64_tr_b16 v[16:17], v8 offset:24576
ds_read_b64_tr_b16 v[18:19], v8 offset:25088
ds_read_b64_tr_b16 v[20:21], v8 offset:26624
ds_read_b64_tr_b16 v[22:23], v8 offset:27136
ds_read_b64_tr_b16 v[24:25], v8 offset:32768
ds_read_b64_tr_b16 v[26:27], v8 offset:33280
ds_read_b64_tr_b16 v[28:29], v8 offset:34816
ds_read_b64_tr_b16 v[30:31], v8 offset:35328
ds_read_b64_tr_b16 v[32:33], v8 offset:40960
ds_read_b64_tr_b16 v[34:35], v8 offset:41472
ds_read_b64_tr_b16 v[36:37], v8 offset:43008
ds_read_b64_tr_b16 v[38:39], v8 offset:43520
v_xor_b32 v12, v15, v8
ds_read_b64_tr_b16 v[40:41], v12 offset:49152
ds_read_b64_tr_b16 v[42:43], v12 offset:49664
ds_read_b64_tr_b16 v[44:45], v12 offset:51200
ds_read_b64_tr_b16 v[46:47], v12 offset:51712
ds_read_b64_tr_b16 v[48:49], v8 offset:57344
ds_read_b64_tr_b16 v[50:51], v8 offset:57856
ds_read_b64_tr_b16 v[52:53], v8 offset:59392
ds_read_b64_tr_b16 v[54:55], v8 offset:59904
ds_read_b64_tr_b16 v[56:57], v9 offset:0
ds_read_b64_tr_b16 v[58:59], v9 offset:512
ds_read_b64_tr_b16 v[60:61], v9 offset:2048
ds_read_b64_tr_b16 v[62:63], v9 offset:2560
s_waitcnt lgkmcnt(0)
s_barrier
ds_write_b128 v2, v[16:19] offset:36864
ds_write_b128 v2, v[20:23] offset:37888
ds_write_b128 v2, v[24:27] offset:38912
ds_write_b128 v2, v[28:31] offset:39936
ds_write_b128 v2, v[232:235] offset:40960
ds_write_b128 v2, v[236:239] offset:41984
ds_write_b128 v2, v[224:227] offset:43008
ds_write_b128 v2, v[228:231] offset:44032
ds_write_b128 v2, v[48:51] offset:45056
ds_write_b128 v2, v[52:55] offset:46080
ds_write_b128 v2, v[56:59] offset:47104
ds_write_b128 v2, v[60:63] offset:48128
s_waitcnt lgkmcnt(0)
v_mov_b32 v232, v32
v_mov_b32 v233, v33
v_mov_b32 v234, v34
v_mov_b32 v235, v35
v_mov_b32 v236, v36
v_mov_b32 v237, v37
v_mov_b32 v238, v38
v_mov_b32 v239, v39
v_mov_b32 v224, v40
v_mov_b32 v225, v41
v_mov_b32 v226, v42
v_mov_b32 v227, v43
v_mov_b32 v228, v44
v_mov_b32 v229, v45
v_mov_b32 v230, v46
v_mov_b32 v231, v47
s_waitcnt vmcnt(0)
s_barrier
ds_read_b64_tr_b16 v[16:17], v5 offset:0
ds_read_b64_tr_b16 v[18:19], v5 offset:1024
ds_read_b64_tr_b16 v[20:21], v5 offset:4096
ds_read_b64_tr_b16 v[22:23], v5 offset:5120
ds_read_b64_tr_b16 v[24:25], v5 offset:8192
ds_read_b64_tr_b16 v[26:27], v5 offset:9216
ds_read_b64_tr_b16 v[28:29], v5 offset:12288
ds_read_b64_tr_b16 v[30:31], v5 offset:13312
ds_read_b64_tr_b16 v[32:33], v5 offset:16384
ds_read_b64_tr_b16 v[34:35], v5 offset:17408
ds_read_b64_tr_b16 v[36:37], v5 offset:20480
ds_read_b64_tr_b16 v[38:39], v5 offset:21504
ds_read_b64_tr_b16 v[40:41], v9 offset:8192
ds_read_b64_tr_b16 v[42:43], v9 offset:8704
ds_read_b64_tr_b16 v[44:45], v9 offset:10240
ds_read_b64_tr_b16 v[46:47], v9 offset:10752
v_xor_b32 v12, v15, v9
ds_read_b64_tr_b16 v[48:49], v12 offset:16384
ds_read_b64_tr_b16 v[50:51], v12 offset:16896
ds_read_b64_tr_b16 v[52:53], v12 offset:18432
ds_read_b64_tr_b16 v[54:55], v12 offset:18944
ds_read_b64_tr_b16 v[56:57], v6 offset:24576
ds_read_b64_tr_b16 v[58:59], v6 offset:25600
ds_read_b64_tr_b16 v[60:61], v6 offset:28672
ds_read_b64_tr_b16 v[62:63], v6 offset:29696
s_waitcnt lgkmcnt(0)
s_barrier
ds_write_b128 v2, v[16:19] offset:12288
ds_write_b128 v2, v[20:23] offset:13312
ds_write_b128 v2, a[176:179] offset:14336
ds_write_b128 v2, a[180:183] offset:15360
ds_write_b128 v2, v[32:35] offset:16384
ds_write_b128 v2, v[36:39] offset:17408
ds_write_b128 v2, v[248:251] offset:18432
ds_write_b128 v2, v[252:255] offset:19456
ds_write_b128 v2, v[240:243] offset:20480
ds_write_b128 v2, v[244:247] offset:21504
ds_write_b128 v2, v[56:59] offset:22528
ds_write_b128 v2, v[60:63] offset:23552
s_waitcnt lgkmcnt(0)
v_accvgpr_write_b32 a176, v24
v_accvgpr_write_b32 a177, v25
v_accvgpr_write_b32 a178, v26
v_accvgpr_write_b32 a179, v27
v_accvgpr_write_b32 a180, v28
v_accvgpr_write_b32 a181, v29
v_accvgpr_write_b32 a182, v30
v_accvgpr_write_b32 a183, v31
v_mov_b32 v248, v40
v_mov_b32 v249, v41
v_mov_b32 v250, v42
v_mov_b32 v251, v43
v_mov_b32 v252, v44
v_mov_b32 v253, v45
v_mov_b32 v254, v46
v_mov_b32 v255, v47
v_mov_b32 v240, v48
v_mov_b32 v241, v49
v_mov_b32 v242, v50
v_mov_b32 v243, v51
v_mov_b32 v244, v52
v_mov_b32 v245, v53
v_mov_b32 v246, v54
v_mov_b32 v247, v55
s_mov_b32 s90, 0x300003
s_mov_b32 s91, 0x300003
s_mov_b32 s12, 0x3030303
s_mov_b32 s13, 0x3030303
s_mov_b32 s92, 0xc0000c
s_mov_b32 s93, 0xc0000c
s_mov_b32 s14, 0xc0c0c0c
s_mov_b32 s15, 0xc0c0c0c
s_mov_b32 s94, 0x30000300
s_mov_b32 s95, 0x30000300
s_mov_b32 s16, 0x30303030
s_mov_b32 s17, 0x30303030
s_mov_b32 s96, 0xc0000c00
s_mov_b32 s97, 0xc0000c00
s_mov_b32 s18, 0xc0c0c0c0
s_mov_b32 s19, 0xc0c0c0c0
s_mov_b32 s98, 0xff00ff00
s_mov_b32 s99, 0xff00ff00
v_mov_b32 v1, 0x4444
v_mov_b32 v4, 0xeeee
v_cndmask_b32 v1, v1, v4, s[98:99]
v_lshrrev_b32 v4, 8, v0
v_lshl_or_b32 v1, v4, 28, v1
v_bfe_u32 v4, v0, 4, 4
v_lshl_or_b32 v1, v4, 19, v1
s_mov_b32 s51, 0x3e0293ee
s_mov_b32 s52, 0x3f803f80
s_mov_b32 s53, 0x3f803f80
s_mov_b32 s54, 0x3f003f00
s_mov_b32 s55, 0x3f003f00
s_mov_b32 s56, 0xff800000
s_mov_b32 s57, 0xff800000
s_mov_b32 s58, 0x3f80
s_mov_b32 s8, s4
s_mov_b32 s9, s5
s_cmp_eq_u32 s30, 31
s_cselect_b32 s10, s6, 0
s_mov_b32 s31, 0
s_mov_b32 s45, -2
s_lshl_b32 s46, s30, 6
s_add_u32 s46, s46, 222330880
s_lshl_b32 s48, s30, 7
s_and_b32 s49, s30, 31
s_lshl_b32 s49, s49, 12
s_add_u32 s43, s49, 119537664
v_mov_b64 v[12:13], -1
s_add_u32 s38, s48, 119586816
s_add_u32 s39, s48, 119652352
s_add_u32 s40, s48, 119717888
s_add_u32 s41, s48, 119783424
s_add_u32 s42, s48, 119848960
v_lshrrev_b32 v4, 16, v1
buffer_store_dwordx2 v[12:13], v4, s[4:7], s38 offen sc1
buffer_store_dwordx2 v[12:13], v4, s[4:7], s39 offen sc1
buffer_store_dwordx2 v[12:13], v4, s[4:7], s40 offen sc1
buffer_store_dwordx2 v[12:13], v4, s[4:7], s41 offen sc1
buffer_store_dwordx2 v[12:13], v4, s[4:7], s42 offen sc1
k_lay_261:
s_add_u32 s47, s31, 63
s_mov_b32 s33, 120324096
s_mov_b32 s34, 120329216
s_mov_b32 s35, 120333312
s_mul_i32 s48, s31, 655360
s_lshl_b32 s36, s30, 14
s_add_u32 s36, s36, s48
s_add_u32 s36, s36, 12288
v_mov_b32 v12, -1
s_lshl_b32 s63, s30, 10
s_add_u32 s63, s63, 120356864
s_lshl_b32 s37, s31, 14
s_add_u32 s37, s37, 117443584
s_add_u32 s59, s37, 4096
s_cmp_eq_u32 s31, 0
s_cbranch_scc1 k_l0_262
s_waitcnt vmcnt(0)
s_barrier
v_mov_b32 v8, 160
s_barrier
ds_read_b32 v9, v8
s_waitcnt lgkmcnt(0)
v_readfirstlane_b32 s64, v9
k_l0_262:
s_waitcnt vmcnt(0)
s_barrier
v_mov_b32 v8, 160
s_barrier
ds_read_b32 v9, v8
s_waitcnt lgkmcnt(0)
v_readfirstlane_b32 s64, v9
v_lshlrev_b32 v23, v0, s58
v_cndmask_b32 v20, 0, v23, s[90:91]
v_cndmask_b32 v21, 0, v23, s[92:93]
v_cndmask_b32 v22, 0, v23, s[94:95]
v_cndmask_b32 v23, 0, v23, s[96:97]
s_cmp_lg_u32 s64, 0
s_cbranch_scc1 k_far_267
s_mov_b32 s66, 0
k_fl2_283:
buffer_load_dwordx2 v[46:47], off, s[4:7], s46 sc1
s_waitcnt vmcnt(0)
v_min_u32 v46, v46, v47
v_cmp_lt_u32 vcc, s31, v46
v_mov_b64 v[46:47], 0
s_cbranch_vccnz k_cold2_271
s_sub_u32 s32, s32, 1
s_cmp_gt_i32 s32, 0
s_cbranch_scc1 k_fl2_283
s_branch k_cold2_271
k_T0_269:
s_waitcnt vmcnt(2)
v_smfmac_f32_16x16x64_bf16 v[40:43], v[4:7], v[48:55], v1
s_waitcnt vmcnt(1)
v_cmp_u_f32 vcc, v4, v8
v_smfmac_f32_16x16x64_bf16 v[24:27], v[8:11], a[24:31], v1
v_smfmac_f32_16x16x64_bf16 v[28:31], v[8:11], a[32:39], v1
s_cbranch_vccnz k_cold_270
k_okC_272:
s_waitcnt vmcnt(1)
v_smfmac_f32_16x16x64_bf16 v[36:39], v[8:11], a[40:47], v1
s_waitcnt lgkmcnt(0)
ds_read_b128 v[48:51], v2 offset:14336
v_smfmac_f32_16x16x64_bf16 v[32:35], v[4:7], v[64:71], v1
ds_read_b128 v[52:55], v2 offset:15360
ds_read_b128 v[64:67], v0 offset:51200
v_smfmac_f32_16x16x64_bf16 v[44:47], v[4:7], v[56:63], v1
ds_read_b128 v[68:71], v0 offset:52224
v_smfmac_f32_16x16x64_bf16 v[28:31], v[4:7], a[8:15], v1
v_smfmac_f32_16x16x64_bf16 v[24:27], v[4:7], a[0:7], v1
ds_read_b128 v[56:59], v2 offset:43008
v_smfmac_f32_16x16x64_bf16 v[36:39], v[4:7], a[16:23], v1
ds_read_b128 v[60:63], v2 offset:44032
s_waitcnt lgkmcnt(4)
v_smfmac_f32_16x16x64_bf16 v[40:43], v[8:11], v[48:55], v1
s_waitcnt vmcnt(0)
ds_write_b128 v0, v[12:15] offset:3072
s_waitcnt lgkmcnt(3)
v_smfmac_f32_16x16x64_bf16 v[32:35], v[8:11], v[64:71], v1
buffer_load_dwordx4 v[16:19], v0, s[4:7], s35 offen offset:0 sc1
v_cmp_u_f32 vcc, v12, v12
s_waitcnt lgkmcnt(1)
v_smfmac_f32_16x16x64_bf16 v[44:47], v[8:11], v[56:63], v1
ds_read_b128 v[56:59], v2 offset:16384
ds_read_b128 v[60:63], v2 offset:17408
ds_read_b128 v[64:67], v0 offset:61440
s_cbranch_vccnz k_coldA_273
k_okA_274:
v_smfmac_f32_16x16x64_bf16 v[36:39], v[12:15], a[64:71], v1
ds_read_b128 v[68:71], v0 offset:62464
s_waitcnt lgkmcnt(4)
v_smfmac_f32_16x16x64_bf16 v[40:43], v[12:15], a[72:79], v1
s_barrier
v_smfmac_f32_16x16x64_bf16 v[28:31], v[12:15], a[56:63], v1
ds_read_b128 v[8:11], v0 offset:0
buffer_load_dwordx4 v[48:51], v0, s[4:7], s36 offen offset:0 sc1
s_waitcnt lgkmcnt(3)
v_smfmac_f32_16x16x64_bf16 v[44:47], v[12:15], v[56:63], v1
ds_read_b128 v[56:59], v0 offset:63488
v_smfmac_f32_16x16x64_bf16 v[24:27], v[12:15], a[48:55], v1
ds_read_b128 v[60:63], v0 offset:64512
s_waitcnt lgkmcnt(3)
v_smfmac_f32_16x16x64_bf16 v[32:35], v[12:15], v[64:71], v1
buffer_load_dwordx4 v[52:55], v0, s[4:7], s36 offen offset:1024 sc1
s_waitcnt lgkmcnt(2)
v_smfmac_f32_16x16x64_bf16 v[24:27], v[8:11], a[80:87], v1
ds_read_b128 v[64:67], v0 offset:55296
ds_read_b128 v[68:71], v0 offset:56320
v_smfmac_f32_16x16x64_bf16 v[36:39], v[8:11], a[96:103], v1
s_waitcnt lgkmcnt(2)
ds_read_b128 v[4:7], v0 offset:1024
v_smfmac_f32_16x16x64_bf16 v[44:47], v[8:11], v[56:63], v1
ds_read_b128 v[56:59], v2 offset:12288
ds_read_b128 v[60:63], v2 offset:13312
v_smfmac_f32_16x16x64_bf16 v[28:31], v[8:11], a[88:95], v1
buffer_store_dwordx4 v[12:15], v0, s[8:11], s37 offen offset:2048 sc1
v_smfmac_f32_16x16x64_bf16 v[40:43], v[8:11], a[104:111], v1
s_waitcnt lgkmcnt(3)
s_waitcnt lgkmcnt(2)
v_smfmac_f32_16x16x64_bf16 v[32:35], v[8:11], v[64:71], v1
ds_read_b128 v[64:67], v0 offset:57344
ds_read_b128 v[12:15], v0 offset:2048
v_smfmac_f32_16x16x64_bf16 v[36:39], v[4:7], a[128:135], v1
s_waitcnt lgkmcnt(2)
v_smfmac_f32_16x16x64_bf16 v[44:47], v[4:7], v[56:63], v1
ds_read_b128 v[68:71], v0 offset:58368
buffer_load_dwordx4 v[56:59], v0, s[4:7], s36 offen offset:2048 sc1
v_smfmac_f32_16x16x64_bf16 v[28:31], v[4:7], a[120:127], v1
v_smfmac_f32_16x16x64_bf16 v[24:27], v[4:7], a[112:119], v1
s_waitcnt vmcnt(4)
ds_write_b128 v0, v[16:19] offset:7168
v_smfmac_f32_16x16x64_bf16 v[40:43], v[4:7], a[136:143], v1
s_waitcnt lgkmcnt(1)
buffer_load_dwordx4 v[60:63], v0, s[4:7], s36 offen offset:3072 sc1
v_cmp_u_f32 vcc, v16, v16
v_smfmac_f32_16x16x64_bf16 v[32:35], v[4:7], v[64:71], v1
ds_read_b128 v[64:67], v0 offset:59392
ds_read_b128 v[68:71], v0 offset:60416
v_smfmac_f32_16x16x64_bf16 v[28:31], v[12:15], a[152:159], v1
v_smfmac_f32_16x16x64_bf16 v[24:27], v[12:15], a[144:151], v1
s_cbranch_vccnz k_coldB_275
k_okB_276:
v_smfmac_f32_16x16x64_bf16 v[36:39], v[12:15], a[160:167], v1
s_waitcnt lgkmcnt(2)
buffer_store_dwordx4 v[16:19], v0, s[8:11], s59 offen offset:2048 sc1
s_barrier
ds_read_b128 v[4:7], v0 offset:5120
v_smfmac_f32_16x16x64_bf16 v[44:47], v[12:15], a[176:183], v1
ds_read_b128 v[8:11], v0 offset:4096
s_waitcnt lgkmcnt(2)
v_smfmac_f32_16x16x64_bf16 v[32:35], v[12:15], v[64:71], v1
ds_read_b128 v[64:67], v2 offset:22528
ds_read_b128 v[68:71], v2 offset:23552
v_smfmac_f32_16x16x64_bf16 v[24:27], v[16:19], a[184:191], v1
v_smfmac_f32_16x16x64_bf16 v[40:43], v[12:15], a[168:175], v1
s_waitcnt lgkmcnt(3)
ds_read_b128 v[12:15], v0 offset:6144
v_smfmac_f32_16x16x64_bf16 v[24:27], v[4:7], a[208:215], v1
s_waitcnt lgkmcnt(3)
v_smfmac_f32_16x16x64_bf16 v[28:31], v[4:7], a[216:223], v1
v_smfmac_f32_16x16x64_bf16 v[28:31], v[8:11], a[200:207], v1
s_waitcnt lgkmcnt(1)
v_smfmac_f32_16x16x64_bf16 v[24:27], v[8:11], v[64:71], v1
ds_read_b128 v[64:67], v2 offset:18432
s_waitcnt lgkmcnt(1)
v_smfmac_f32_16x16x64_bf16 v[24:27], v[12:15], a[224:231], v1
ds_read_b128 v[68:71], v2 offset:19456
v_smfmac_f32_16x16x64_bf16 v[28:31], v[12:15], a[232:239], v1
v_smfmac_f32_16x16x64_bf16 v[28:31], v[16:19], a[192:199], v1
v_cvt_pk_bf16_f32 v24, v24, v25
v_cvt_pk_bf16_f32 v25, v26, v27
v_smfmac_f32_16x16x64_bf16 v[32:35], v[4:7], v[80:87], v1
v_cvt_pk_bf16_f32 v26, v28, v29
v_cvt_pk_bf16_f32 v27, v30, v31
v_smfmac_f32_16x16x64_bf16 v[32:35], v[8:11], a[248:255], v1
s_waitcnt lgkmcnt(0)
v_mfma_f32_16x16x32_bf16 v[28:31], v[24:27], v[20:23], 0
v_and_b32 v26, 0xffffff7f, v0
v_smfmac_f32_16x16x64_bf16 v[32:35], v[16:19], v[64:71], v1
v_and_or_b32 v26, v1, 8, v26
v_mul_f32 v28, s51, v28
v_mul_f32 v29, s51, v29
v_mul_f32 v31, s51, v31
v_cvt_pk_bf16_f32 v24, v28, v29
v_mul_f32 v30, s51, v30
v_cvt_pk_bf16_f32 v25, v30, v31
v_smfmac_f32_16x16x64_bf16 v[32:35], v[12:15], v[96:103], v1
ds_write_b64 v26, v[24:25] offset:1152
v_smfmac_f32_16x16x64_bf16 v[36:39], v[8:11], v[72:79], v1
v_cvt_pk_bf16_f32 v32, v32, v33
v_smfmac_f32_16x16x64_bf16 v[36:39], v[16:19], a[240:247], v1
buffer_load_dwordx4 v[64:67], v0, s[4:7], s61 offen offset:0
v_cvt_pk_bf16_f32 v33, v34, v35
v_smfmac_f32_16x16x64_bf16 v[36:39], v[12:15], v[104:111], v1
s_waitcnt lgkmcnt(0)
v_smfmac_f32_16x16x64_bf16 v[36:39], v[4:7], v[88:95], v1
s_barrier
ds_read_b128 v[24:27], v0 offset:0
v_smfmac_f32_16x16x64_bf16 v[40:43], v[4:7], v[144:151], v1
ds_read_b128 v[28:31], v0 offset:1024
s_nop 0
v_cvt_pk_bf16_f32 v34, v36, v37
v_cvt_pk_bf16_f32 v35, v38, v39
s_nop 1
v_mfma_f32_16x16x32_bf16 v[36:39], v[32:35], v[20:23], 0
s_waitcnt vmcnt(5)
buffer_load_dwordx4 v[68:71], v0, s[4:7], s61 offen offset:1024
v_and_b32 v34, 0xffffff7f, v0
v_and_or_b32 v34, v1, 8, v34
s_waitcnt lgkmcnt(1)
v_mfma_f32_16x16x32_bf16 v[48:51], v[48:51], v[24:27], 0
v_cvt_pk_bf16_f32 v32, v36, v37
s_waitcnt lgkmcnt(0)
v_mfma_f32_16x16x32_bf16 v[48:51], v[52:55], v[28:31], v[48:51]
v_mov_b64 v[52:53], s[56:57]
v_cvt_pk_bf16_f32 v33, v38, v39
v_smfmac_f32_16x16x64_bf16 v[44:47], v[4:7], v[152:159], v1
ds_write_b64 v34, v[32:33] offset:3200
v_permlane32_swap_b32 v48, v50
v_permlane32_swap_b32 v49, v51
v_add_f32_dpp v52, v50, v48 row_ror:8 row_mask:0xf bank_mask:0x3
v_exp_f32 v52, v52
v_add_f32_dpp v53, v51, v49 row_ror:8 row_mask:0xf bank_mask:0x3
v_exp_f32 v53, v53
s_nop 0
v_cvt_pk_bf16_f32 v48, v52, v53
v_smfmac_f32_16x16x64_bf16 v[44:47], v[16:19], v[120:127], v1
ds_write_b32 v0, v48 offset:4108
v_smfmac_f32_16x16x64_bf16 v[44:47], v[12:15], v[168:175], v1
buffer_load_dwordx4 v[48:51], v0, s[4:7], s61 offen offset:2048
v_smfmac_f32_16x16x64_bf16 v[40:43], v[12:15], v[160:167], v1
s_waitcnt lgkmcnt(1)
v_xor_b32 v12, 0x80, v0
v_smfmac_f32_16x16x64_bf16 v[40:43], v[8:11], v[128:135], v1
s_waitcnt lgkmcnt(0)
s_barrier
ds_read_b128 v[32:35], v0 offset:2048
v_mov_b64 v[22:23], s[52:53]
v_smfmac_f32_16x16x64_bf16 v[40:43], v[16:19], v[112:119], v1
ds_read_b128 v[36:39], v0 offset:3072
ds_read_b128 v[16:19], v0 offset:4096
buffer_load_dwordx4 v[52:55], v0, s[4:7], s61 offen offset:3072
v_smfmac_f32_16x16x64_bf16 v[44:47], v[8:11], v[136:143], v1
ds_read_b128 v[12:15], v12 offset:4096
v_cvt_pk_bf16_f32 v40, v40, v41
v_mov_b64 v[20:21], s[52:53]
s_waitcnt lgkmcnt(3)
v_mfma_f32_16x16x32_bf16 v[24:27], v[32:35], v[24:27], 0
v_cvt_pk_bf16_f32 v41, v42, v43
s_waitcnt lgkmcnt(2)
v_mfma_f32_16x16x32_bf16 v[24:27], v[36:39], v[28:31], v[24:27]
s_waitcnt vmcnt(5)
s_waitcnt lgkmcnt(1)
v_mfma_f32_16x16x32_bf16 v[8:11], v[56:59], v[16:19], 0
buffer_load_dwordx4 v[56:59], v0, s[4:7], s62 offen offset:0
v_mov_b64 v[28:29], s[56:57]
v_cvt_pk_bf16_f32 v43, v46, v47
v_cvt_pk_bf16_f32 v42, v44, v45
v_permlane32_swap_b32 v25, v27
v_permlane32_swap_b32 v24, v26
v_mfma_f32_16x16x32_bf16 v[4:7], v[20:23], v[16:19], 0
s_waitcnt lgkmcnt(0)
v_add_f32_dpp v28, v26, v24 row_ror:8 row_mask:0xf bank_mask:0x3
v_add_f32_dpp v29, v27, v25 row_ror:8 row_mask:0xf bank_mask:0x3
v_exp_f32 v28, v28
v_mfma_f32_16x16x32_bf16 v[8:11], v[60:63], v[12:15], v[8:11]
buffer_load_dwordx4 v[60:63], v0, s[4:7], s62 offen offset:1024
v_exp_f32 v29, v29
v_permlane32_swap_b32 v42, v43
v_cvt_pk_bf16_f32 v24, v28, v29
v_mov_b64 v[44:45], s[54:55]
v_cvt_pk_bf16_f32 v25, v28, v29
v_mov_b32_dpp v26, v24 row_ror:8 row_mask:0xf bank_mask:0xf
v_mov_b32_dpp v27, v24 row_ror:8 row_mask:0xf bank_mask:0xf
v_mfma_f32_16x16x16_bf16 v[4:7], v[44:45], v[24:25], v[4:7]
v_permlane32_swap_b32 v40, v41
v_mov_b64 v[36:37], 0
v_mov_b64 v[38:39], 0
v_mov_b64 v[30:31], 0
v_mfma_f32_16x16x32_bf16 v[8:11], v[40:43], v[24:27], v[8:11]
buffer_load_dwordx4 v[16:19], v0, s[4:7], s62 offen offset:2048
v_rcp_f32 v6, v4
v_and_b32 v12, 0xffffff7f, v0
v_and_or_b32 v13, v1, 8, v12
v_rcp_f32_dpp v6, v4 row_ror:8 row_mask:0xf bank_mask:0xc
v_mov_b64 v[26:27], 0
v_pk_mul_f32 v[8:9], v[8:9], v[6:7] op_sel_hi:[1,0]
v_cvt_pk_bf16_f32 v44, v8, v9
v_pk_mul_f32 v[10:11], v[10:11], v[6:7] op_sel_hi:[1,0]
v_cvt_pk_bf16_f32 v45, v10, v11
s_waitcnt vmcnt(5)
ds_write_b64 v13, v[44:45] offset:7296
buffer_load_dwordx4 v[20:23], v0, s[4:7], s62 offen offset:3072
v_add_u32 v6, 0xd4800000, v6
v_cmp_lt_u32 vcc, 0x28000000, v6
v_mov_b64 v[34:35], 0
v_mov_b32_dpp v46, v44 row_ror:8 row_mask:0xf bank_mask:0xf
v_mov_b32_dpp v47, v45 row_ror:8 row_mask:0xf bank_mask:0xf
v_mov_b64 v[28:29], 0
v_mov_b64 v[32:33], 0
s_cbranch_vccnz k_slow_277
k_okS_278:
v_smfmac_f32_16x16x64_bf16 v[36:39], v[44:47], v[224:231], v1
s_waitcnt lgkmcnt(0)
s_barrier
ds_read_b128 v[8:11], v12 offset:6272
v_smfmac_f32_16x16x64_bf16 v[32:35], v[44:47], v[200:207], v1
s_waitcnt vmcnt(4)
ds_read_b128 v[4:7], v12 offset:6144
v_mov_b64 v[24:25], 0
v_smfmac_f32_16x16x64_bf16 v[28:31], v[44:47], v[48:55], v1
ds_read_b128 v[12:15], v12 offset:7168
ds_read_b128 v[48:51], v2 offset:40960
v_smfmac_f32_16x16x64_bf16 v[24:27], v[44:47], v[64:71], v1
ds_read_b128 v[52:55], v2 offset:41984
v_mov_b64 v[42:43], 0
s_waitcnt lgkmcnt(4)
v_smfmac_f32_16x16x64_bf16 v[24:27], v[8:11], v[184:191], v1
s_waitcnt lgkmcnt(3)
v_mov_b64 v[40:41], 0
v_smfmac_f32_16x16x64_bf16 v[24:27], v[4:7], v[176:183], v1
s_waitcnt lgkmcnt(2)
ds_read_b128 v[64:67], v2 offset:20480
v_smfmac_f32_16x16x64_bf16 v[24:27], v[12:15], v[192:199], v1
ds_read_b128 v[68:71], v2 offset:21504
v_smfmac_f32_16x16x64_bf16 v[40:43], v[44:47], v[240:247], v1
s_waitcnt vmcnt(2)
s_waitcnt lgkmcnt(2)
v_lshrrev_b32 v44, 16, v1
v_cvt_pk_bf16_f32 v24, v24, v25
v_bfi_b32 v24, 1, s45, v24
v_cvt_pk_bf16_f32 v25, v26, v27
v_smfmac_f32_16x16x64_bf16 v[28:31], v[8:11], v[48:55], v1
buffer_store_dwordx2 v[24:25], v44, s[4:7], s38 offen
ds_read_b128 v[48:51], v2 offset:38912
ds_read_b128 v[52:55], v2 offset:39936
v_smfmac_f32_16x16x64_bf16 v[28:31], v[12:15], v[56:63], v1
s_waitcnt lgkmcnt(2)
ds_read_b128 v[56:59], v2 offset:45056
v_smfmac_f32_16x16x64_bf16 v[28:31], v[4:7], v[64:71], v1
ds_read_b128 v[60:63], v2 offset:46080
v_smfmac_f32_16x16x64_bf16 v[32:35], v[8:11], v[208:215], v1
ds_read_b128 v[64:67], v2 offset:36864
s_nop 0
v_cvt_pk_bf16_f32 v28, v28, v29
v_bfi_b32 v28, 1, s45, v28
v_cvt_pk_bf16_f32 v29, v30, v31
v_smfmac_f32_16x16x64_bf16 v[32:35], v[12:15], v[216:223], v1
buffer_store_dwordx2 v[28:29], v44, s[4:7], s39 offen
v_smfmac_f32_16x16x64_bf16 v[40:43], v[12:15], v[248:255], v1
ds_read_b128 v[68:71], v2 offset:37888
s_waitcnt vmcnt(2)
v_smfmac_f32_16x16x64_bf16 v[32:35], v[4:7], v[16:23], v1
s_waitcnt lgkmcnt(2)
v_smfmac_f32_16x16x64_bf16 v[36:39], v[12:15], v[232:239], v1
ds_read_b128 v[16:19], v2 offset:47104
ds_read_b128 v[20:23], v2 offset:48128
v_cvt_pk_bf16_f32 v32, v32, v33
v_bfi_b32 v32, 1, s45, v32
v_cvt_pk_bf16_f32 v33, v34, v35
v_smfmac_f32_16x16x64_bf16 v[36:39], v[8:11], v[48:55], v1
buffer_store_dwordx2 v[32:33], v44, s[4:7], s40 offen
s_waitcnt lgkmcnt(2)
v_smfmac_f32_16x16x64_bf16 v[36:39], v[4:7], v[64:71], v1
s_nop 6
v_cvt_pk_bf16_f32 v36, v36, v37
v_cvt_pk_bf16_f32 v37, v38, v39
s_waitcnt lgkmcnt(0)
v_bfi_b32 v36, 1, s45, v36
v_smfmac_f32_16x16x64_bf16 v[40:43], v[8:11], v[16:23], v1
buffer_store_dwordx2 v[36:37], v44, s[4:7], s41 offen
v_smfmac_f32_16x16x64_bf16 v[40:43], v[4:7], v[56:63], v1
s_nop 6
v_cvt_pk_bf16_f32 v40, v40, v41
v_bfi_b32 v40, 1, s45, v40
v_cvt_pk_bf16_f32 v41, v42, v43
buffer_store_dwordx2 v[40:41], v44, s[4:7], s42 offen
s_barrier
buffer_load_dwordx4 v[48:51], v0, s[4:7], s60 offen offset:0
buffer_load_dwordx4 v[52:55], v0, s[4:7], s60 offen offset:1024
buffer_load_dwordx4 v[56:59], v0, s[4:7], s60 offen offset:2048
buffer_load_dwordx4 v[60:63], v0, s[4:7], s60 offen offset:3072
s_add_u32 s31, s31, 1
s_min_u32 s66, s66, s67
s_cmp_gt_u32 s66, s31
s_cbranch_scc0 k_fl_282
k_okF_284:
s_buffer_load_dwordx2 s[66:67], s[4:7], s46 glc
s_add_u32 s33, s33, 16384
s_bitset0_b32 s33, 16
s_barrier
buffer_load_dwordx4 v[4:7], v0, s[4:7], s33 offen offset:1024 sc1
buffer_load_dwordx4 v[8:11], v0, s[4:7], s33 offen offset:0 sc1
s_add_u32 s34, s33, 5120
s_add_u32 s35, s33, 9216
s_add_u32 s36, s36, 524288
s_add_u32 s37, s37, 10240
s_add_u32 s59, s59, 10240
v_mov_b64 v[32:33], 0
v_mov_b64 v[34:35], 0
v_mov_b64 v[36:37], 0
v_mov_b64 v[38:39], 0
v_mov_b64 v[40:41], 0
v_mov_b64 v[42:43], 0
v_mov_b64 v[44:45], 0
v_mov_b64 v[46:47], 0
s_sub_u32 s45, s45, 1
v_mov_b64 v[24:25], 0
v_mov_b64 v[26:27], 0
v_mov_b64 v[28:29], 0
v_mov_b64 v[30:31], 0
v_lshlrev_b32 v23, v0, s58
v_cndmask_b32 v20, 0, v23, s[90:91]
v_cndmask_b32 v21, 0, v23, s[92:93]
v_cndmask_b32 v22, 0, v23, s[94:95]
v_cndmask_b32 v23, 0, v23, s[96:97]
ds_read_b128 v[64:67], v0 offset:53248
ds_read_b128 v[68:71], v0 offset:54272
s_waitcnt lgkmcnt(0)
buffer_load_dwordx4 v[12:15], v0, s[4:7], s34 offen offset:0 sc1
s_cmp_lg_u32 s31, s47
s_cbranch_scc1 k_T0_269
s_branch k_done_279
k_cold2_271:
s_barrier
buffer_load_dwordx4 v[48:51], v0, s[4:7], s60 offen offset:0
buffer_load_dwordx4 v[52:55], v0, s[4:7], s60 offen offset:1024
buffer_load_dwordx4 v[56:59], v0, s[4:7], s60 offen offset:2048
buffer_load_dwordx4 v[60:63], v0, s[4:7], s60 offen offset:3072
ds_read_b128 v[64:67], v0 offset:53248
ds_read_b128 v[68:71], v0 offset:54272
k_cold_270:
buffer_load_dwordx4 v[4:7], v0, s[4:7], s33 offen offset:1024 sc1
buffer_load_dwordx4 v[8:11], v0, s[4:7], s33 offen offset:0 sc1
buffer_load_dwordx4 v[12:15], v0, s[4:7], s34 offen offset:0 sc1
s_sub_u32 s32, s32, 1
s_cmp_gt_i32 s32, 0
s_cbranch_scc0 k_okC_272
v_mov_b64 v[24:25], 0
v_mov_b64 v[26:27], 0
v_mov_b64 v[28:29], 0
v_mov_b64 v[30:31], 0
v_mov_b64 v[32:33], 0
v_mov_b64 v[34:35], 0
v_mov_b64 v[36:37], 0
v_mov_b64 v[38:39], 0
v_mov_b64 v[40:41], 0
v_mov_b64 v[42:43], 0
v_mov_b64 v[44:45], 0
v_mov_b64 v[46:47], 0
s_branch k_T0_269
k_coldA_273:
buffer_load_dwordx4 v[12:15], v0, s[4:7], s34 offen offset:0 sc1
s_sub_u32 s32, s32, 1
s_cmp_gt_i32 s32, 0
s_waitcnt vmcnt(0)
v_cmp_u_f32 vcc, v12, v12
ds_write_b128 v0, v[12:15] offset:3072
s_waitcnt lgkmcnt(0)
s_cbranch_vccz k_okA_274
s_cbranch_scc1 k_coldA_273
s_branch k_okA_274
k_coldB_275:
buffer_load_dwordx4 v[16:19], v0, s[4:7], s35 offen offset:0 sc1
s_sub_u32 s32, s32, 1
s_cmp_gt_i32 s32, 0
s_waitcnt vmcnt(0)
v_cmp_u_f32 vcc, v16, v16
ds_write_b128 v0, v[16:19] offset:7168
s_waitcnt lgkmcnt(0)
s_cbranch_vccz k_okB_276
s_cbranch_scc1 k_coldB_275
s_branch k_okB_276
k_fl_282:
buffer_load_dwordx2 v[46:47], off, s[4:7], s46 sc1
s_waitcnt vmcnt(0)
v_min_u32 v46, v46, v47
v_cmp_lt_u32 vcc, s31, v46
v_mov_b64 v[46:47], 0
s_cbranch_vccnz k_okF_284
s_sub_u32 s32, s32, 1
s_cmp_gt_i32 s32, 0
s_cbranch_scc1 k_fl_282
s_branch k_okF_284
k_slow_277:
ds_read_b128 v[24:27], v0 offset:0
ds_read_b128 v[28:31], v0 offset:1024
v_mov_b32 v46, 0xff7fffff
s_add_u32 s48, s36, 0xffffd000
buffer_load_dwordx4 v[32:35], v0, s[4:7], s48 offen offset:0 sc1
buffer_load_dwordx4 v[36:39], v0, s[4:7], s48 offen offset:1024 sc1
s_waitcnt vmcnt(1) lgkmcnt(1)
v_mfma_f32_16x16x32_bf16 v[4:7], v[32:35], v[24:27], 0
s_waitcnt vmcnt(0) lgkmcnt(0)
v_mfma_f32_16x16x32_bf16 v[4:7], v[36:39], v[28:31], v[4:7]
v_mov_b64 v[8:9], s[56:57]
s_nop 5
v_permlane32_swap_b32 v4, v6
v_permlane32_swap_b32 v5, v7
v_add_f32_dpp v8, v6, v4 row_ror:8 row_mask:0xf bank_mask:0x3
s_nop 0
v_add_f32_dpp v9, v7, v5 row_ror:8 row_mask:0xf bank_mask:0x3
v_max3_f32 v46, v46, v8, v9
s_add_u32 s48, s36, 0xffffe000
buffer_load_dwordx4 v[32:35], v0, s[4:7], s48 offen offset:0 sc1
buffer_load_dwordx4 v[36:39], v0, s[4:7], s48 offen offset:1024 sc1
s_waitcnt vmcnt(1)
v_mfma_f32_16x16x32_bf16 v[4:7], v[32:35], v[24:27], 0
s_waitcnt vmcnt(0)
v_mfma_f32_16x16x32_bf16 v[4:7], v[36:39], v[28:31], v[4:7]
v_mov_b64 v[10:11], s[56:57]
s_nop 5
v_permlane32_swap_b32 v4, v6
v_permlane32_swap_b32 v5, v7
v_add_f32_dpp v10, v6, v4 row_ror:8 row_mask:0xf bank_mask:0x3
s_nop 0
v_add_f32_dpp v11, v7, v5 row_ror:8 row_mask:0xf bank_mask:0x3
v_max3_f32 v46, v46, v10, v11
s_add_u32 s48, s36, 0xfffff000
buffer_load_dwordx4 v[32:35], v0, s[4:7], s48 offen offset:0 sc1
buffer_load_dwordx4 v[36:39], v0, s[4:7], s48 offen offset:1024 sc1
s_waitcnt vmcnt(1)
v_mfma_f32_16x16x32_bf16 v[4:7], v[32:35], v[24:27], 0
s_waitcnt vmcnt(0)
v_mfma_f32_16x16x32_bf16 v[4:7], v[36:39], v[28:31], v[4:7]
v_mov_b64 v[12:13], s[56:57]
s_nop 5
v_permlane32_swap_b32 v4, v6
v_permlane32_swap_b32 v5, v7
v_add_f32_dpp v12, v6, v4 row_ror:8 row_mask:0xf bank_mask:0x3
s_nop 0
v_add_f32_dpp v13, v7, v5 row_ror:8 row_mask:0xf bank_mask:0x3
v_max3_f32 v46, v46, v12, v13
s_add_u32 s48, s36, 0x0
buffer_load_dwordx4 v[32:35], v0, s[4:7], s48 offen offset:0 sc1
buffer_load_dwordx4 v[36:39], v0, s[4:7], s48 offen offset:1024 sc1
s_waitcnt vmcnt(1)
v_mfma_f32_16x16x32_bf16 v[4:7], v[32:35], v[24:27], 0
s_waitcnt vmcnt(0)
v_mfma_f32_16x16x32_bf16 v[4:7], v[36:39], v[28:31], v[4:7]
v_mov_b64 v[14:15], s[56:57]
s_nop 5
v_permlane32_swap_b32 v4, v6
v_permlane32_swap_b32 v5, v7
v_add_f32_dpp v14, v6, v4 row_ror:8 row_mask:0xf bank_mask:0x3
s_nop 0
v_add_f32_dpp v15, v7, v5 row_ror:8 row_mask:0xf bank_mask:0x3
v_max3_f32 v46, v46, v14, v15
ds_read_b128 v[32:35], v0 offset:2048
ds_read_b128 v[36:39], v0 offset:3072
s_waitcnt lgkmcnt(1)
v_mfma_f32_16x16x32_bf16 v[4:7], v[32:35], v[24:27], 0
s_waitcnt lgkmcnt(0)
v_mfma_f32_16x16x32_bf16 v[4:7], v[36:39], v[28:31], v[4:7]
v_mov_b64 v[44:45], s[56:57]
s_nop 5
v_permlane32_swap_b32 v4, v6
v_permlane32_swap_b32 v5, v7
v_add_f32_dpp v44, v6, v4 row_ror:8 row_mask:0xf bank_mask:0x3
s_nop 0
v_add_f32_dpp v45, v7, v5 row_ror:8 row_mask:0xf bank_mask:0x3
v_max3_f32 v46, v46, v44, v45
buffer_load_dwordx4 v[32:35], v0, s[4:7], s36 offen offset:2048 sc1
buffer_load_dwordx4 v[36:39], v0, s[4:7], s36 offen offset:3072 sc1
v_mov_b32 v47, v46
s_nop 1
v_permlane32_swap_b32 v46, v47
v_max_f32 v46, v46, v47
v_mov_b32 v47, v46
s_nop 1
v_permlane16_swap_b32 v46, v47
v_max_f32 v46, v46, v47
v_sub_f32 v8, v8, v46
v_exp_f32 v8, v8
v_sub_f32 v9, v9, v46
v_exp_f32 v9, v9
v_sub_f32 v10, v10, v46
v_exp_f32 v10, v10
v_sub_f32 v11, v11, v46
v_exp_f32 v11, v11
v_sub_f32 v12, v12, v46
v_exp_f32 v12, v12
v_sub_f32 v13, v13, v46
v_exp_f32 v13, v13
v_sub_f32 v14, v14, v46
v_exp_f32 v14, v14
v_sub_f32 v15, v15, v46
v_exp_f32 v15, v15
v_sub_f32 v44, v44, v46
v_exp_f32 v44, v44
v_sub_f32 v45, v45, v46
v_exp_f32 v45, v45
v_cvt_pk_bf16_f32 v4, v8, v9
v_cvt_pk_bf16_f32 v5, v10, v11
v_cvt_pk_bf16_f32 v6, v12, v13
v_cvt_pk_bf16_f32 v7, v14, v15
v_mov_b32_dpp v8, v4 row_ror:8 row_mask:0xf bank_mask:0xf
v_mov_b32_dpp v9, v5 row_ror:8 row_mask:0xf bank_mask:0xf
v_mov_b32_dpp v10, v6 row_ror:8 row_mask:0xf bank_mask:0xf
v_mov_b32_dpp v11, v7 row_ror:8 row_mask:0xf bank_mask:0xf
v_cvt_pk_bf16_f32 v24, v44, v45
v_cvt_pk_bf16_f32 v25, v44, v45
s_nop 0
v_mov_b32_dpp v26, v24 row_ror:8 row_mask:0xf bank_mask:0xf
v_mov_b32_dpp v27, v24 row_ror:8 row_mask:0xf bank_mask:0xf
v_mov_b64 v[28:29], s[52:53]
v_mov_b64 v[30:31], s[52:53]
s_nop 1
v_mfma_f32_16x16x32_bf16 v[44:47], v[28:31], v[4:7], 0
s_waitcnt vmcnt(1)
v_mfma_f32_16x16x32_bf16 v[12:15], v[32:35], v[4:7], 0
s_waitcnt vmcnt(0)
v_mfma_f32_16x16x32_bf16 v[12:15], v[36:39], v[8:11], v[12:15]
v_mfma_f32_16x16x32_bf16 v[12:15], v[40:43], v[24:27], v[12:15]
v_mov_b64 v[28:29], s[54:55]
s_nop 1
v_mfma_f32_16x16x16_bf16 v[44:47], v[28:29], v[24:25], v[44:47]
s_nop 6
v_rcp_f32 v4, v44
s_nop 1
v_rcp_f32_dpp v4, v44 row_ror:8 row_mask:0xf bank_mask:0xc
s_nop 0
v_mul_f32 v12, v4, v12
v_mul_f32 v13, v4, v13
v_mul_f32 v14, v4, v14
v_mul_f32 v15, v4, v15
v_cvt_pk_bf16_f32 v44, v12, v13
v_cvt_pk_bf16_f32 v45, v14, v15
v_and_b32 v12, 0xffffff7f, v0
v_and_or_b32 v8, v1, 8, v12
ds_write_b64 v8, v[44:45] offset:7296
v_mov_b32_dpp v46, v44 row_ror:8 row_mask:0xf bank_mask:0xf
v_mov_b32_dpp v47, v45 row_ror:8 row_mask:0xf bank_mask:0xf
v_mov_b64 v[24:25], 0
v_mov_b64 v[26:27], 0
v_mov_b64 v[28:29], 0
v_mov_b64 v[30:31], 0
v_mov_b64 v[32:33], 0
v_mov_b64 v[34:35], 0
v_mov_b64 v[36:37], 0
v_mov_b64 v[38:39], 0
s_waitcnt lgkmcnt(0)
s_branch k_okS_278
k_done_279:
buffer_load_dwordx4 v[16:19], v0, s[4:7], s35 offen offset:0 sc1
k_xs_285:
s_waitcnt vmcnt(1)
v_cmp_u_f32 vcc, v4, v12
s_waitcnt vmcnt(0)
v_cmp_u_f32 s[66:67], v16, v16
s_or_b64 vcc, vcc, s[66:67]
s_cbranch_vccz k_xd_286
buffer_load_dwordx4 v[4:7], v0, s[4:7], s33 offen offset:1024 sc1
buffer_load_dwordx4 v[8:11], v0, s[4:7], s33 offen offset:0 sc1
buffer_load_dwordx4 v[12:15], v0, s[4:7], s34 offen offset:0 sc1
buffer_load_dwordx4 v[16:19], v0, s[4:7], s35 offen offset:0 sc1
s_sub_u32 s32, s32, 1
s_cmp_gt_i32 s32, 0
s_cbranch_scc1 k_xs_285
k_xd_286:
s_waitcnt vmcnt(1)
buffer_store_dwordx4 v[12:15], v0, s[8:11], s37 offen offset:2048 sc1
s_waitcnt vmcnt(1)
buffer_store_dwordx4 v[16:19], v0, s[8:11], s59 offen offset:2048 sc1
s_add_u32 s31, s31, 1
s_branch k_jn_268
k_far_267:
s_mov_b32 s66, 0
k_fl2_301:
buffer_load_dwordx2 v[46:47], off, s[4:7], s46 sc1
s_waitcnt vmcnt(0)
v_min_u32 v46, v46, v47
v_cmp_lt_u32 vcc, s31, v46
v_mov_b64 v[46:47], 0
s_cbranch_vccnz k_cold2_289
s_sub_u32 s32, s32, 1
s_cmp_gt_i32 s32, 0
s_cbranch_scc1 k_fl2_301
s_branch k_cold2_289
k_T0_287:
s_waitcnt vmcnt(2)
v_smfmac_f32_16x16x64_bf16 v[40:43], v[4:7], v[48:55], v1
s_waitcnt vmcnt(1)
v_cmp_u_f32 vcc, v4, v8
v_smfmac_f32_16x16x64_bf16 v[24:27], v[8:11], a[24:31], v1
v_smfmac_f32_16x16x64_bf16 v[28:31], v[8:11], a[32:39], v1
s_cbranch_vccnz k_cold_288
k_okC_290:
s_waitcnt vmcnt(1)
v_smfmac_f32_16x16x64_bf16 v[36:39], v[8:11], a[40:47], v1
s_waitcnt lgkmcnt(0)
ds_read_b128 v[48:51], v2 offset:14336
v_smfmac_f32_16x16x64_bf16 v[32:35], v[4:7], v[64:71], v1
ds_read_b128 v[52:55], v2 offset:15360
ds_read_b128 v[64:67], v0 offset:51200
v_smfmac_f32_16x16x64_bf16 v[44:47], v[4:7], v[56:63], v1
ds_read_b128 v[68:71], v0 offset:52224
v_smfmac_f32_16x16x64_bf16 v[28:31], v[4:7], a[8:15], v1
v_smfmac_f32_16x16x64_bf16 v[24:27], v[4:7], a[0:7], v1
ds_read_b128 v[56:59], v2 offset:43008
v_smfmac_f32_16x16x64_bf16 v[36:39], v[4:7], a[16:23], v1
ds_read_b128 v[60:63], v2 offset:44032
s_waitcnt lgkmcnt(4)
v_smfmac_f32_16x16x64_bf16 v[40:43], v[8:11], v[48:55], v1
s_waitcnt vmcnt(0)
ds_write_b128 v0, v[12:15] offset:3072
s_waitcnt lgkmcnt(3)
v_smfmac_f32_16x16x64_bf16 v[32:35], v[8:11], v[64:71], v1
buffer_load_dwordx4 v[16:19], v0, s[4:7], s35 offen offset:0 sc1
v_cmp_u_f32 vcc, v12, v12
s_waitcnt lgkmcnt(1)
v_smfmac_f32_16x16x64_bf16 v[44:47], v[8:11], v[56:63], v1
ds_read_b128 v[56:59], v2 offset:16384
ds_read_b128 v[60:63], v2 offset:17408
ds_read_b128 v[64:67], v0 offset:61440
s_cbranch_vccnz k_coldA_291
k_okA_292:
v_smfmac_f32_16x16x64_bf16 v[36:39], v[12:15], a[64:71], v1
ds_read_b128 v[68:71], v0 offset:62464
s_waitcnt lgkmcnt(4)
v_smfmac_f32_16x16x64_bf16 v[40:43], v[12:15], a[72:79], v1
s_barrier
v_smfmac_f32_16x16x64_bf16 v[28:31], v[12:15], a[56:63], v1
ds_read_b128 v[8:11], v0 offset:0
buffer_load_dwordx4 v[48:51], v0, s[4:7], s36 offen offset:0 sc1
s_waitcnt lgkmcnt(3)
v_smfmac_f32_16x16x64_bf16 v[44:47], v[12:15], v[56:63], v1
ds_read_b128 v[56:59], v0 offset:63488
v_smfmac_f32_16x16x64_bf16 v[24:27], v[12:15], a[48:55], v1
ds_read_b128 v[60:63], v0 offset:64512
s_waitcnt lgkmcnt(3)
v_smfmac_f32_16x16x64_bf16 v[32:35], v[12:15], v[64:71], v1
buffer_load_dwordx4 v[52:55], v0, s[4:7], s36 offen offset:1024 sc1
s_waitcnt lgkmcnt(2)
v_smfmac_f32_16x16x64_bf16 v[24:27], v[8:11], a[80:87], v1
ds_read_b128 v[64:67], v0 offset:55296
ds_read_b128 v[68:71], v0 offset:56320
v_smfmac_f32_16x16x64_bf16 v[36:39], v[8:11], a[96:103], v1
s_waitcnt lgkmcnt(2)
ds_read_b128 v[4:7], v0 offset:1024
v_smfmac_f32_16x16x64_bf16 v[44:47], v[8:11], v[56:63], v1
ds_read_b128 v[56:59], v2 offset:12288
ds_read_b128 v[60:63], v2 offset:13312
v_smfmac_f32_16x16x64_bf16 v[28:31], v[8:11], a[88:95], v1
buffer_store_dwordx4 v[12:15], v0, s[8:11], s37 offen offset:2048 sc1
v_smfmac_f32_16x16x64_bf16 v[40:43], v[8:11], a[104:111], v1
s_waitcnt lgkmcnt(3)
s_waitcnt lgkmcnt(2)
v_smfmac_f32_16x16x64_bf16 v[32:35], v[8:11], v[64:71], v1
ds_read_b128 v[64:67], v0 offset:57344
ds_read_b128 v[12:15], v0 offset:2048
v_smfmac_f32_16x16x64_bf16 v[36:39], v[4:7], a[128:135], v1
s_waitcnt lgkmcnt(2)
v_smfmac_f32_16x16x64_bf16 v[44:47], v[4:7], v[56:63], v1
ds_read_b128 v[68:71], v0 offset:58368
buffer_load_dwordx4 v[56:59], v0, s[4:7], s36 offen offset:2048 sc1
v_smfmac_f32_16x16x64_bf16 v[28:31], v[4:7], a[120:127], v1
v_smfmac_f32_16x16x64_bf16 v[24:27], v[4:7], a[112:119], v1
s_waitcnt vmcnt(4)
ds_write_b128 v0, v[16:19] offset:7168
v_smfmac_f32_16x16x64_bf16 v[40:43], v[4:7], a[136:143], v1
s_waitcnt lgkmcnt(1)
buffer_load_dwordx4 v[60:63], v0, s[4:7], s36 offen offset:3072 sc1
v_cmp_u_f32 vcc, v16, v16
v_smfmac_f32_16x16x64_bf16 v[32:35], v[4:7], v[64:71], v1
ds_read_b128 v[64:67], v0 offset:59392
ds_read_b128 v[68:71], v0 offset:60416
v_smfmac_f32_16x16x64_bf16 v[28:31], v[12:15], a[152:159], v1
v_smfmac_f32_16x16x64_bf16 v[24:27], v[12:15], a[144:151], v1
s_cbranch_vccnz k_coldB_293
k_okB_294:
v_smfmac_f32_16x16x64_bf16 v[36:39], v[12:15], a[160:167], v1
s_waitcnt lgkmcnt(2)
buffer_store_dwordx4 v[16:19], v0, s[8:11], s59 offen offset:2048 sc1
s_barrier
ds_read_b128 v[4:7], v0 offset:5120
v_smfmac_f32_16x16x64_bf16 v[44:47], v[12:15], a[176:183], v1
ds_read_b128 v[8:11], v0 offset:4096
s_waitcnt lgkmcnt(2)
v_smfmac_f32_16x16x64_bf16 v[32:35], v[12:15], v[64:71], v1
ds_read_b128 v[64:67], v2 offset:22528
ds_read_b128 v[68:71], v2 offset:23552
v_smfmac_f32_16x16x64_bf16 v[24:27], v[16:19], a[184:191], v1
v_smfmac_f32_16x16x64_bf16 v[40:43], v[12:15], a[168:175], v1
s_waitcnt lgkmcnt(3)
ds_read_b128 v[12:15], v0 offset:6144
v_smfmac_f32_16x16x64_bf16 v[24:27], v[4:7], a[208:215], v1
s_waitcnt lgkmcnt(3)
v_smfmac_f32_16x16x64_bf16 v[28:31], v[4:7], a[216:223], v1
v_smfmac_f32_16x16x64_bf16 v[28:31], v[8:11], a[200:207], v1
s_waitcnt lgkmcnt(1)
v_smfmac_f32_16x16x64_bf16 v[24:27], v[8:11], v[64:71], v1
ds_read_b128 v[64:67], v2 offset:18432
s_waitcnt lgkmcnt(1)
v_smfmac_f32_16x16x64_bf16 v[24:27], v[12:15], a[224:231], v1
ds_read_b128 v[68:71], v2 offset:19456
v_smfmac_f32_16x16x64_bf16 v[28:31], v[12:15], a[232:239], v1
v_smfmac_f32_16x16x64_bf16 v[28:31], v[16:19], a[192:199], v1
v_cvt_pk_bf16_f32 v24, v24, v25
v_cvt_pk_bf16_f32 v25, v26, v27
v_smfmac_f32_16x16x64_bf16 v[32:35], v[4:7], v[80:87], v1
v_cvt_pk_bf16_f32 v26, v28, v29
v_cvt_pk_bf16_f32 v27, v30, v31
v_smfmac_f32_16x16x64_bf16 v[32:35], v[8:11], a[248:255], v1
s_waitcnt lgkmcnt(0)
v_mfma_f32_16x16x32_bf16 v[28:31], v[24:27], v[20:23], 0
v_and_b32 v26, 0xffffff7f, v0
v_smfmac_f32_16x16x64_bf16 v[32:35], v[16:19], v[64:71], v1
v_and_or_b32 v26, v1, 8, v26
v_mul_f32 v28, s51, v28
v_mul_f32 v29, s51, v29
v_mul_f32 v31, s51, v31
v_cvt_pk_bf16_f32 v24, v28, v29
v_mul_f32 v30, s51, v30
v_cvt_pk_bf16_f32 v25, v30, v31
v_smfmac_f32_16x16x64_bf16 v[32:35], v[12:15], v[96:103], v1
ds_write_b64 v26, v[24:25] offset:1152
v_smfmac_f32_16x16x64_bf16 v[36:39], v[8:11], v[72:79], v1
v_cvt_pk_bf16_f32 v32, v32, v33
v_smfmac_f32_16x16x64_bf16 v[36:39], v[16:19], a[240:247], v1
buffer_load_dwordx4 v[64:67], v0, s[4:7], s61 offen offset:0
v_cvt_pk_bf16_f32 v33, v34, v35
v_smfmac_f32_16x16x64_bf16 v[36:39], v[12:15], v[104:111], v1
s_waitcnt lgkmcnt(0)
v_smfmac_f32_16x16x64_bf16 v[36:39], v[4:7], v[88:95], v1
s_barrier
ds_read_b128 v[24:27], v0 offset:0
v_smfmac_f32_16x16x64_bf16 v[40:43], v[4:7], v[144:151], v1
ds_read_b128 v[28:31], v0 offset:1024
s_nop 0
v_cvt_pk_bf16_f32 v34, v36, v37
v_cvt_pk_bf16_f32 v35, v38, v39
s_nop 1
v_mfma_f32_16x16x32_bf16 v[36:39], v[32:35], v[20:23], 0
s_waitcnt vmcnt(5)
buffer_load_dwordx4 v[68:71], v0, s[4:7], s61 offen offset:1024
v_and_b32 v34, 0xffffff7f, v0
v_and_or_b32 v34, v1, 8, v34
s_waitcnt lgkmcnt(1)
v_mfma_f32_16x16x32_bf16 v[48:51], v[48:51], v[24:27], 0
v_cvt_pk_bf16_f32 v32, v36, v37
s_waitcnt lgkmcnt(0)
v_mfma_f32_16x16x32_bf16 v[48:51], v[52:55], v[28:31], v[48:51]
v_mov_b64 v[52:53], s[56:57]
v_cvt_pk_bf16_f32 v33, v38, v39
v_smfmac_f32_16x16x64_bf16 v[44:47], v[4:7], v[152:159], v1
ds_write_b64 v34, v[32:33] offset:3200
v_permlane32_swap_b32 v48, v50
v_permlane32_swap_b32 v49, v51
v_add_f32_dpp v52, v50, v48 row_ror:8 row_mask:0xf bank_mask:0x3
v_exp_f32 v52, v52
v_add_f32_dpp v53, v51, v49 row_ror:8 row_mask:0xf bank_mask:0x3
v_exp_f32 v53, v53
s_nop 0
v_cvt_pk_bf16_f32 v48, v52, v53
v_smfmac_f32_16x16x64_bf16 v[44:47], v[16:19], v[120:127], v1
ds_write_b32 v0, v48 offset:4108
v_smfmac_f32_16x16x64_bf16 v[44:47], v[12:15], v[168:175], v1
buffer_load_dwordx4 v[48:51], v0, s[4:7], s61 offen offset:2048
v_smfmac_f32_16x16x64_bf16 v[40:43], v[12:15], v[160:167], v1
s_waitcnt lgkmcnt(1)
v_xor_b32 v12, 0x80, v0
v_smfmac_f32_16x16x64_bf16 v[40:43], v[8:11], v[128:135], v1
s_waitcnt lgkmcnt(0)
s_barrier
ds_read_b128 v[32:35], v0 offset:2048
v_mov_b64 v[22:23], s[52:53]
v_smfmac_f32_16x16x64_bf16 v[40:43], v[16:19], v[112:119], v1
ds_read_b128 v[36:39], v0 offset:3072
ds_read_b128 v[16:19], v0 offset:4096
buffer_load_dwordx4 v[52:55], v0, s[4:7], s61 offen offset:3072
v_smfmac_f32_16x16x64_bf16 v[44:47], v[8:11], v[136:143], v1
ds_read_b128 v[12:15], v12 offset:4096
v_cvt_pk_bf16_f32 v40, v40, v41
v_mov_b64 v[20:21], s[52:53]
s_waitcnt lgkmcnt(3)
v_mfma_f32_16x16x32_bf16 v[24:27], v[32:35], v[24:27], 0
v_cvt_pk_bf16_f32 v41, v42, v43
s_waitcnt lgkmcnt(2)
v_mfma_f32_16x16x32_bf16 v[24:27], v[36:39], v[28:31], v[24:27]
s_waitcnt vmcnt(5)
s_waitcnt lgkmcnt(1)
v_mfma_f32_16x16x32_bf16 v[8:11], v[56:59], v[16:19], 0
buffer_load_dwordx4 v[56:59], v0, s[4:7], s62 offen offset:0
v_mov_b64 v[28:29], s[56:57]
v_cvt_pk_bf16_f32 v43, v46, v47
v_cvt_pk_bf16_f32 v42, v44, v45
v_permlane32_swap_b32 v25, v27
v_permlane32_swap_b32 v24, v26
v_mfma_f32_16x16x32_bf16 v[4:7], v[20:23], v[16:19], 0
s_waitcnt lgkmcnt(0)
v_add_f32_dpp v28, v26, v24 row_ror:8 row_mask:0xf bank_mask:0x3
v_add_f32_dpp v29, v27, v25 row_ror:8 row_mask:0xf bank_mask:0x3
v_exp_f32 v28, v28
v_mfma_f32_16x16x32_bf16 v[8:11], v[60:63], v[12:15], v[8:11]
buffer_load_dwordx4 v[60:63], v0, s[4:7], s62 offen offset:1024
v_exp_f32 v29, v29
v_permlane32_swap_b32 v42, v43
v_cvt_pk_bf16_f32 v24, v28, v29
v_mov_b64 v[44:45], s[54:55]
v_cvt_pk_bf16_f32 v25, v28, v29
v_mov_b32_dpp v26, v24 row_ror:8 row_mask:0xf bank_mask:0xf
v_mov_b32_dpp v27, v24 row_ror:8 row_mask:0xf bank_mask:0xf
v_mfma_f32_16x16x16_bf16 v[4:7], v[44:45], v[24:25], v[4:7]
v_permlane32_swap_b32 v40, v41
v_mov_b64 v[36:37], 0
v_mov_b64 v[38:39], 0
v_mov_b64 v[30:31], 0
v_mfma_f32_16x16x32_bf16 v[8:11], v[40:43], v[24:27], v[8:11]
buffer_load_dwordx4 v[16:19], v0, s[4:7], s62 offen offset:2048
v_rcp_f32 v6, v4
v_and_b32 v12, 0xffffff7f, v0
v_and_or_b32 v13, v1, 8, v12
v_rcp_f32_dpp v6, v4 row_ror:8 row_mask:0xf bank_mask:0xc
v_mov_b64 v[26:27], 0
v_pk_mul_f32 v[8:9], v[8:9], v[6:7] op_sel_hi:[1,0]
v_cvt_pk_bf16_f32 v44, v8, v9
v_pk_mul_f32 v[10:11], v[10:11], v[6:7] op_sel_hi:[1,0]
v_cvt_pk_bf16_f32 v45, v10, v11
s_waitcnt vmcnt(5)
ds_write_b64 v13, v[44:45] offset:7296
buffer_load_dwordx4 v[20:23], v0, s[4:7], s62 offen offset:3072
v_add_u32 v6, 0xd4800000, v6
v_cmp_lt_u32 vcc, 0x28000000, v6
v_mov_b64 v[34:35], 0
v_mov_b32_dpp v46, v44 row_ror:8 row_mask:0xf bank_mask:0xf
v_mov_b32_dpp v47, v45 row_ror:8 row_mask:0xf bank_mask:0xf
v_mov_b64 v[28:29], 0
v_mov_b64 v[32:33], 0
s_cbranch_vccnz k_slow_295
k_okS_296:
v_smfmac_f32_16x16x64_bf16 v[36:39], v[44:47], v[224:231], v1
s_waitcnt lgkmcnt(0)
s_barrier
ds_read_b128 v[8:11], v12 offset:6272
v_smfmac_f32_16x16x64_bf16 v[32:35], v[44:47], v[200:207], v1
s_waitcnt vmcnt(4)
ds_read_b128 v[4:7], v12 offset:6144
v_mov_b64 v[24:25], 0
v_smfmac_f32_16x16x64_bf16 v[28:31], v[44:47], v[48:55], v1
ds_read_b128 v[12:15], v12 offset:7168
ds_read_b128 v[48:51], v2 offset:40960
v_smfmac_f32_16x16x64_bf16 v[24:27], v[44:47], v[64:71], v1
ds_read_b128 v[52:55], v2 offset:41984
v_mov_b64 v[42:43], 0
s_waitcnt lgkmcnt(4)
v_smfmac_f32_16x16x64_bf16 v[24:27], v[8:11], v[184:191], v1
s_waitcnt lgkmcnt(3)
v_mov_b64 v[40:41], 0
v_smfmac_f32_16x16x64_bf16 v[24:27], v[4:7], v[176:183], v1
s_waitcnt lgkmcnt(2)
ds_read_b128 v[64:67], v2 offset:20480
v_smfmac_f32_16x16x64_bf16 v[24:27], v[12:15], v[192:199], v1
ds_read_b128 v[68:71], v2 offset:21504
v_smfmac_f32_16x16x64_bf16 v[40:43], v[44:47], v[240:247], v1
s_waitcnt vmcnt(2)
s_waitcnt lgkmcnt(2)
v_lshrrev_b32 v44, 16, v1
v_cvt_pk_bf16_f32 v24, v24, v25
v_bfi_b32 v24, 1, s45, v24
v_cvt_pk_bf16_f32 v25, v26, v27
v_smfmac_f32_16x16x64_bf16 v[28:31], v[8:11], v[48:55], v1
buffer_store_dwordx2 v[24:25], v44, s[4:7], s38 offen sc1
ds_read_b128 v[48:51], v2 offset:38912
ds_read_b128 v[52:55], v2 offset:39936
v_smfmac_f32_16x16x64_bf16 v[28:31], v[12:15], v[56:63], v1
s_waitcnt lgkmcnt(2)
ds_read_b128 v[56:59], v2 offset:45056
v_smfmac_f32_16x16x64_bf16 v[28:31], v[4:7], v[64:71], v1
ds_read_b128 v[60:63], v2 offset:46080
v_smfmac_f32_16x16x64_bf16 v[32:35], v[8:11], v[208:215], v1
ds_read_b128 v[64:67], v2 offset:36864
s_nop 0
v_cvt_pk_bf16_f32 v28, v28, v29
v_bfi_b32 v28, 1, s45, v28
v_cvt_pk_bf16_f32 v29, v30, v31
v_smfmac_f32_16x16x64_bf16 v[32:35], v[12:15], v[216:223], v1
buffer_store_dwordx2 v[28:29], v44, s[4:7], s39 offen sc1
v_smfmac_f32_16x16x64_bf16 v[40:43], v[12:15], v[248:255], v1
ds_read_b128 v[68:71], v2 offset:37888
s_waitcnt vmcnt(2)
v_smfmac_f32_16x16x64_bf16 v[32:35], v[4:7], v[16:23], v1
s_waitcnt lgkmcnt(2)
v_smfmac_f32_16x16x64_bf16 v[36:39], v[12:15], v[232:239], v1
ds_read_b128 v[16:19], v2 offset:47104
ds_read_b128 v[20:23], v2 offset:48128
v_cvt_pk_bf16_f32 v32, v32, v33
v_bfi_b32 v32, 1, s45, v32
v_cvt_pk_bf16_f32 v33, v34, v35
v_smfmac_f32_16x16x64_bf16 v[36:39], v[8:11], v[48:55], v1
buffer_store_dwordx2 v[32:33], v44, s[4:7], s40 offen sc1
s_waitcnt lgkmcnt(2)
v_smfmac_f32_16x16x64_bf16 v[36:39], v[4:7], v[64:71], v1
s_nop 6
v_cvt_pk_bf16_f32 v36, v36, v37
v_cvt_pk_bf16_f32 v37, v38, v39
s_waitcnt lgkmcnt(0)
v_bfi_b32 v36, 1, s45, v36
v_smfmac_f32_16x16x64_bf16 v[40:43], v[8:11], v[16:23], v1
buffer_store_dwordx2 v[36:37], v44, s[4:7], s41 offen sc1
v_smfmac_f32_16x16x64_bf16 v[40:43], v[4:7], v[56:63], v1
s_nop 6
v_cvt_pk_bf16_f32 v40, v40, v41
v_bfi_b32 v40, 1, s45, v40
v_cvt_pk_bf16_f32 v41, v42, v43
buffer_store_dwordx2 v[40:41], v44, s[4:7], s42 offen sc1
s_barrier
buffer_load_dwordx4 v[48:51], v0, s[4:7], s60 offen offset:0
buffer_load_dwordx4 v[52:55], v0, s[4:7], s60 offen offset:1024
buffer_load_dwordx4 v[56:59], v0, s[4:7], s60 offen offset:2048
buffer_load_dwordx4 v[60:63], v0, s[4:7], s60 offen offset:3072
s_add_u32 s31, s31, 1
s_min_u32 s66, s66, s67
s_cmp_gt_u32 s66, s31
s_cbranch_scc0 k_fl_300
k_okF_302:
s_buffer_load_dwordx2 s[66:67], s[4:7], s46 glc
s_add_u32 s33, s33, 16384
s_bitset0_b32 s33, 16
s_barrier
buffer_load_dwordx4 v[4:7], v0, s[4:7], s33 offen offset:1024 sc1
buffer_load_dwordx4 v[8:11], v0, s[4:7], s33 offen offset:0 sc1
s_add_u32 s34, s33, 5120
s_add_u32 s35, s33, 9216
s_add_u32 s36, s36, 524288
s_add_u32 s37, s37, 10240
s_add_u32 s59, s59, 10240
v_mov_b64 v[32:33], 0
v_mov_b64 v[34:35], 0
v_mov_b64 v[36:37], 0
v_mov_b64 v[38:39], 0
v_mov_b64 v[40:41], 0
v_mov_b64 v[42:43], 0
v_mov_b64 v[44:45], 0
v_mov_b64 v[46:47], 0
s_sub_u32 s45, s45, 1
v_mov_b64 v[24:25], 0
v_mov_b64 v[26:27], 0
v_mov_b64 v[28:29], 0
v_mov_b64 v[30:31], 0
v_lshlrev_b32 v23, v0, s58
v_cndmask_b32 v20, 0, v23, s[90:91]
v_cndmask_b32 v21, 0, v23, s[92:93]
v_cndmask_b32 v22, 0, v23, s[94:95]
v_cndmask_b32 v23, 0, v23, s[96:97]
ds_read_b128 v[64:67], v0 offset:53248
ds_read_b128 v[68:71], v0 offset:54272
s_waitcnt lgkmcnt(0)
buffer_load_dwordx4 v[12:15], v0, s[4:7], s34 offen offset:0 sc1
s_cmp_lg_u32 s31, s47
s_cbranch_scc1 k_T0_287
s_branch k_done_297
k_cold2_289:
s_barrier
buffer_load_dwordx4 v[48:51], v0, s[4:7], s60 offen offset:0
buffer_load_dwordx4 v[52:55], v0, s[4:7], s60 offen offset:1024
buffer_load_dwordx4 v[56:59], v0, s[4:7], s60 offen offset:2048
buffer_load_dwordx4 v[60:63], v0, s[4:7], s60 offen offset:3072
ds_read_b128 v[64:67], v0 offset:53248
ds_read_b128 v[68:71], v0 offset:54272
k_cold_288:
buffer_load_dwordx4 v[4:7], v0, s[4:7], s33 offen offset:1024 sc1
buffer_load_dwordx4 v[8:11], v0, s[4:7], s33 offen offset:0 sc1
buffer_load_dwordx4 v[12:15], v0, s[4:7], s34 offen offset:0 sc1
s_sub_u32 s32, s32, 1
s_cmp_gt_i32 s32, 0
s_cbranch_scc0 k_okC_290
v_mov_b64 v[24:25], 0
v_mov_b64 v[26:27], 0
v_mov_b64 v[28:29], 0
v_mov_b64 v[30:31], 0
v_mov_b64 v[32:33], 0
v_mov_b64 v[34:35], 0
v_mov_b64 v[36:37], 0
v_mov_b64 v[38:39], 0
v_mov_b64 v[40:41], 0
v_mov_b64 v[42:43], 0
v_mov_b64 v[44:45], 0
v_mov_b64 v[46:47], 0
s_branch k_T0_287
k_coldA_291:
buffer_load_dwordx4 v[12:15], v0, s[4:7], s34 offen offset:0 sc1
s_sub_u32 s32, s32, 1
s_cmp_gt_i32 s32, 0
s_waitcnt vmcnt(0)
v_cmp_u_f32 vcc, v12, v12
ds_write_b128 v0, v[12:15] offset:3072
s_waitcnt lgkmcnt(0)
s_cbranch_vccz k_okA_292
s_cbranch_scc1 k_coldA_291
s_branch k_okA_292
k_coldB_293:
buffer_load_dwordx4 v[16:19], v0, s[4:7], s35 offen offset:0 sc1
s_sub_u32 s32, s32, 1
s_cmp_gt_i32 s32, 0
s_waitcnt vmcnt(0)
v_cmp_u_f32 vcc, v16, v16
ds_write_b128 v0, v[16:19] offset:7168
s_waitcnt lgkmcnt(0)
s_cbranch_vccz k_okB_294
s_cbranch_scc1 k_coldB_293
s_branch k_okB_294
k_fl_300:
buffer_load_dwordx2 v[46:47], off, s[4:7], s46 sc1
s_waitcnt vmcnt(0)
v_min_u32 v46, v46, v47
v_cmp_lt_u32 vcc, s31, v46
v_mov_b64 v[46:47], 0
s_cbranch_vccnz k_okF_302
s_sub_u32 s32, s32, 1
s_cmp_gt_i32 s32, 0
s_cbranch_scc1 k_fl_300
s_branch k_okF_302
k_slow_295:
ds_read_b128 v[24:27], v0 offset:0
ds_read_b128 v[28:31], v0 offset:1024
v_mov_b32 v46, 0xff7fffff
s_add_u32 s48, s36, 0xffffd000
buffer_load_dwordx4 v[32:35], v0, s[4:7], s48 offen offset:0 sc1
buffer_load_dwordx4 v[36:39], v0, s[4:7], s48 offen offset:1024 sc1
s_waitcnt vmcnt(1) lgkmcnt(1)
v_mfma_f32_16x16x32_bf16 v[4:7], v[32:35], v[24:27], 0
s_waitcnt vmcnt(0) lgkmcnt(0)
v_mfma_f32_16x16x32_bf16 v[4:7], v[36:39], v[28:31], v[4:7]
v_mov_b64 v[8:9], s[56:57]
s_nop 5
v_permlane32_swap_b32 v4, v6
v_permlane32_swap_b32 v5, v7
v_add_f32_dpp v8, v6, v4 row_ror:8 row_mask:0xf bank_mask:0x3
s_nop 0
v_add_f32_dpp v9, v7, v5 row_ror:8 row_mask:0xf bank_mask:0x3
v_max3_f32 v46, v46, v8, v9
s_add_u32 s48, s36, 0xffffe000
buffer_load_dwordx4 v[32:35], v0, s[4:7], s48 offen offset:0 sc1
buffer_load_dwordx4 v[36:39], v0, s[4:7], s48 offen offset:1024 sc1
s_waitcnt vmcnt(1)
v_mfma_f32_16x16x32_bf16 v[4:7], v[32:35], v[24:27], 0
s_waitcnt vmcnt(0)
v_mfma_f32_16x16x32_bf16 v[4:7], v[36:39], v[28:31], v[4:7]
v_mov_b64 v[10:11], s[56:57]
s_nop 5
v_permlane32_swap_b32 v4, v6
v_permlane32_swap_b32 v5, v7
v_add_f32_dpp v10, v6, v4 row_ror:8 row_mask:0xf bank_mask:0x3
s_nop 0
v_add_f32_dpp v11, v7, v5 row_ror:8 row_mask:0xf bank_mask:0x3
v_max3_f32 v46, v46, v10, v11
s_add_u32 s48, s36, 0xfffff000
buffer_load_dwordx4 v[32:35], v0, s[4:7], s48 offen offset:0 sc1
buffer_load_dwordx4 v[36:39], v0, s[4:7], s48 offen offset:1024 sc1
s_waitcnt vmcnt(1)
v_mfma_f32_16x16x32_bf16 v[4:7], v[32:35], v[24:27], 0
s_waitcnt vmcnt(0)
v_mfma_f32_16x16x32_bf16 v[4:7], v[36:39], v[28:31], v[4:7]
v_mov_b64 v[12:13], s[56:57]
s_nop 5
v_permlane32_swap_b32 v4, v6
v_permlane32_swap_b32 v5, v7
v_add_f32_dpp v12, v6, v4 row_ror:8 row_mask:0xf bank_mask:0x3
s_nop 0
v_add_f32_dpp v13, v7, v5 row_ror:8 row_mask:0xf bank_mask:0x3
v_max3_f32 v46, v46, v12, v13
s_add_u32 s48, s36, 0x0
buffer_load_dwordx4 v[32:35], v0, s[4:7], s48 offen offset:0 sc1
buffer_load_dwordx4 v[36:39], v0, s[4:7], s48 offen offset:1024 sc1
s_waitcnt vmcnt(1)
v_mfma_f32_16x16x32_bf16 v[4:7], v[32:35], v[24:27], 0
s_waitcnt vmcnt(0)
v_mfma_f32_16x16x32_bf16 v[4:7], v[36:39], v[28:31], v[4:7]
v_mov_b64 v[14:15], s[56:57]
s_nop 5
v_permlane32_swap_b32 v4, v6
v_permlane32_swap_b32 v5, v7
v_add_f32_dpp v14, v6, v4 row_ror:8 row_mask:0xf bank_mask:0x3
s_nop 0
v_add_f32_dpp v15, v7, v5 row_ror:8 row_mask:0xf bank_mask:0x3
v_max3_f32 v46, v46, v14, v15
ds_read_b128 v[32:35], v0 offset:2048
ds_read_b128 v[36:39], v0 offset:3072
s_waitcnt lgkmcnt(1)
v_mfma_f32_16x16x32_bf16 v[4:7], v[32:35], v[24:27], 0
s_waitcnt lgkmcnt(0)
v_mfma_f32_16x16x32_bf16 v[4:7], v[36:39], v[28:31], v[4:7]
v_mov_b64 v[44:45], s[56:57]
s_nop 5
v_permlane32_swap_b32 v4, v6
v_permlane32_swap_b32 v5, v7
v_add_f32_dpp v44, v6, v4 row_ror:8 row_mask:0xf bank_mask:0x3
s_nop 0
v_add_f32_dpp v45, v7, v5 row_ror:8 row_mask:0xf bank_mask:0x3
v_max3_f32 v46, v46, v44, v45
buffer_load_dwordx4 v[32:35], v0, s[4:7], s36 offen offset:2048 sc1
buffer_load_dwordx4 v[36:39], v0, s[4:7], s36 offen offset:3072 sc1
v_mov_b32 v47, v46
s_nop 1
v_permlane32_swap_b32 v46, v47
v_max_f32 v46, v46, v47
v_mov_b32 v47, v46
s_nop 1
v_permlane16_swap_b32 v46, v47
v_max_f32 v46, v46, v47
v_sub_f32 v8, v8, v46
v_exp_f32 v8, v8
v_sub_f32 v9, v9, v46
v_exp_f32 v9, v9
v_sub_f32 v10, v10, v46
v_exp_f32 v10, v10
v_sub_f32 v11, v11, v46
v_exp_f32 v11, v11
v_sub_f32 v12, v12, v46
v_exp_f32 v12, v12
v_sub_f32 v13, v13, v46
v_exp_f32 v13, v13
v_sub_f32 v14, v14, v46
v_exp_f32 v14, v14
v_sub_f32 v15, v15, v46
v_exp_f32 v15, v15
v_sub_f32 v44, v44, v46
v_exp_f32 v44, v44
v_sub_f32 v45, v45, v46
v_exp_f32 v45, v45
v_cvt_pk_bf16_f32 v4, v8, v9
v_cvt_pk_bf16_f32 v5, v10, v11
v_cvt_pk_bf16_f32 v6, v12, v13
v_cvt_pk_bf16_f32 v7, v14, v15
v_mov_b32_dpp v8, v4 row_ror:8 row_mask:0xf bank_mask:0xf
v_mov_b32_dpp v9, v5 row_ror:8 row_mask:0xf bank_mask:0xf
v_mov_b32_dpp v10, v6 row_ror:8 row_mask:0xf bank_mask:0xf
v_mov_b32_dpp v11, v7 row_ror:8 row_mask:0xf bank_mask:0xf
v_cvt_pk_bf16_f32 v24, v44, v45
v_cvt_pk_bf16_f32 v25, v44, v45
s_nop 0
v_mov_b32_dpp v26, v24 row_ror:8 row_mask:0xf bank_mask:0xf
v_mov_b32_dpp v27, v24 row_ror:8 row_mask:0xf bank_mask:0xf
v_mov_b64 v[28:29], s[52:53]
v_mov_b64 v[30:31], s[52:53]
s_nop 1
v_mfma_f32_16x16x32_bf16 v[44:47], v[28:31], v[4:7], 0
s_waitcnt vmcnt(1)
v_mfma_f32_16x16x32_bf16 v[12:15], v[32:35], v[4:7], 0
s_waitcnt vmcnt(0)
v_mfma_f32_16x16x32_bf16 v[12:15], v[36:39], v[8:11], v[12:15]
v_mfma_f32_16x16x32_bf16 v[12:15], v[40:43], v[24:27], v[12:15]
v_mov_b64 v[28:29], s[54:55]
s_nop 1
v_mfma_f32_16x16x16_bf16 v[44:47], v[28:29], v[24:25], v[44:47]
s_nop 6
v_rcp_f32 v4, v44
s_nop 1
v_rcp_f32_dpp v4, v44 row_ror:8 row_mask:0xf bank_mask:0xc
s_nop 0
v_mul_f32 v12, v4, v12
v_mul_f32 v13, v4, v13
v_mul_f32 v14, v4, v14
v_mul_f32 v15, v4, v15
v_cvt_pk_bf16_f32 v44, v12, v13
v_cvt_pk_bf16_f32 v45, v14, v15
v_and_b32 v12, 0xffffff7f, v0
v_and_or_b32 v8, v1, 8, v12
ds_write_b64 v8, v[44:45] offset:7296
v_mov_b32_dpp v46, v44 row_ror:8 row_mask:0xf bank_mask:0xf
v_mov_b32_dpp v47, v45 row_ror:8 row_mask:0xf bank_mask:0xf
v_mov_b64 v[24:25], 0
v_mov_b64 v[26:27], 0
v_mov_b64 v[28:29], 0
v_mov_b64 v[30:31], 0
v_mov_b64 v[32:33], 0
v_mov_b64 v[34:35], 0
v_mov_b64 v[36:37], 0
v_mov_b64 v[38:39], 0
s_waitcnt lgkmcnt(0)
s_branch k_okS_296
k_done_297:
buffer_load_dwordx4 v[16:19], v0, s[4:7], s35 offen offset:0 sc1
k_xs_303:
s_waitcnt vmcnt(1)
v_cmp_u_f32 vcc, v4, v12
s_waitcnt vmcnt(0)
v_cmp_u_f32 s[66:67], v16, v16
s_or_b64 vcc, vcc, s[66:67]
s_cbranch_vccz k_xd_304
buffer_load_dwordx4 v[4:7], v0, s[4:7], s33 offen offset:1024 sc1
buffer_load_dwordx4 v[8:11], v0, s[4:7], s33 offen offset:0 sc1
buffer_load_dwordx4 v[12:15], v0, s[4:7], s34 offen offset:0 sc1
buffer_load_dwordx4 v[16:19], v0, s[4:7], s35 offen offset:0 sc1
s_sub_u32 s32, s32, 1
s_cmp_gt_i32 s32, 0
s_cbranch_scc1 k_xs_303
k_xd_304:
s_waitcnt vmcnt(1)
buffer_store_dwordx4 v[12:15], v0, s[8:11], s37 offen offset:2048 sc1
s_waitcnt vmcnt(1)
buffer_store_dwordx4 v[16:19], v0, s[8:11], s59 offen offset:2048 sc1
s_add_u32 s31, s31, 1
k_jn_268:
s_cmp_lt_u32 s31, 128
s_cbranch_scc1 k_lay_261
s_add_u32 s30, s30, 112
s_waitcnt vmcnt(0) lgkmcnt(0)
s_barrier
s_branch k_fin_7
.section .rodata,"a"
.p2align 6
.amdhsa_kernel interleave_layers__memory_aug_recurrent_mem_tr__spectral_gfnet__prompt_kernel
  .amdhsa_next_free_vgpr 512
  .amdhsa_next_free_sgpr 102
  .amdhsa_accum_offset 256
  .amdhsa_group_segment_fixed_size 0
  .amdhsa_kernarg_size 104
  .amdhsa_user_sgpr_count 2
  .amdhsa_user_sgpr_kernarg_segment_ptr 1
  .amdhsa_system_sgpr_workgroup_id_x 1
  .amdhsa_float_denorm_mode_32 3
.end_amdhsa_kernel
```

```asm
; @launch grid=(256,1,1) block=(256,1,1) lds=163840
.amdgcn_target "amdgcn-amd-amdhsa--gfx950"
.text
.globl interleave_layers__memory_aug_recurrent_mem_tr__spectral_gfnet__prompt_kernel
.p2align 8
.type interleave_layers__memory_aug_recurrent_mem_tr__spectral_gfnet__prompt_kernel,@function
interleave_layers__memory_aug_recurrent_mem_tr__spectral_gfnet__prompt_kernel:
s_load_dwordx2 s[72:73], s[0:1], 8
s_load_dwordx4 s[76:79], s[0:1], 16
s_load_dwordx4 s[80:83], s[0:1], 32
s_load_dwordx2 s[28:29], s[0:1], 88
s_load_dwordx2 s[74:75], s[0:1], 96
v_lshrrev_b32 v1, 6, v0
v_and_b32 v0, 63, v0
v_readfirstlane_b32 s3, v1
s_waitcnt lgkmcnt(0)
s_mov_b32 s4, s74
s_mov_b32 s5, s75
s_mov_b32 s6, 268435456
s_mov_b32 s7, 0x20000
s_mov_b32 s8, s76
s_mov_b32 s9, s77
s_mov_b32 s10, 5242880
s_mov_b32 s11, 0x20000
s_mov_b32 s12, s78
s_mov_b32 s13, s79
s_mov_b32 s14, 5242880
s_mov_b32 s15, 0x20000
s_mov_b32 s16, s80
s_mov_b32 s17, s81
s_mov_b32 s18, 5242880
s_mov_b32 s19, 0x20000
s_mov_b32 s20, s82
s_mov_b32 s21, s83
s_mov_b32 s22, 5242880
s_mov_b32 s23, 0x20000
s_mov_b32 s24, s72
s_mov_b32 s25, s73
s_mov_b32 s26, 10240
s_mov_b32 s27, 0x20000
s_mov_b32 s32, 400000
s_getreg_b32 s52, hwreg(HW_REG_XCC_ID, 0, 4)
s_cmp_lg_u32 s3, 0
s_cbranch_scc1 k_skip_1
s_mov_b32 s55, s52
s_mov_b32 s54, 400
v_mov_b32 v4, 0
s_mov_b64 exec, 0xff
v_mov_b32 v4, 30
v_writelane_b32 v4, 32, 0
v_writelane_b32 v4, 28, 7
v_lshlrev_b32 v5, 2, v0
v_mov_b32 v2, 1
k_clm_9:
s_mov_b64 exec, 1
s_lshl_b32 s53, s52, 2
v_mov_b32 v1, s53
global_atomic_add v3, v1, v2, s[28:29] sc0 sc1
v_readlane_b32 s53, v4, s52
s_nop 3
s_waitcnt vmcnt(0)
v_cmp_gt_u32 vcc, s53, v3
s_cbranch_vccnz k_got_11
s_mov_b64 exec, 0xff
k_spr_10:
global_load_dword v6, v5, s[28:29] sc1
v_mov_b32 v3, 99
s_waitcnt vmcnt(0)
v_cmp_lt_u32 vcc, v6, v4
s_cbranch_vccz k_got_11
s_sub_u32 s54, s54, 1
s_cmp_gt_i32 s54, 0
s_cbranch_scc1 k_spr_10
s_ff1_i32_b32 s52, vcc_lo
s_branch k_clm_9
k_got_11:
s_mov_b64 exec, 1
s_cmp_lg_u32 s52, s55
s_cselect_b32 s53, 0x10000, 0
v_lshl_or_b32 v3, s52, 8, v3
v_or_b32 v3, s53, v3
v_mov_b32 v1, 0
ds_write_b32 v1, v3
s_mov_b64 exec, -1
s_waitcnt lgkmcnt(0)
k_skip_1:
s_barrier
v_mov_b32 v1, 0
ds_read_b32 v2, v1
s_waitcnt lgkmcnt(0)
v_readfirstlane_b32 s53, v2
s_barrier
s_and_b32 s30, s53, 255
s_bfe_u32 s52, s53, 0x80008
s_and_b32 s64, s53, 0x10000
s_cmp_gt_u32 s30, 31
s_cbranch_scc1 k_end_2
s_cmp_eq_u32 s52, 0
s_cbranch_scc1 k_team_3
v_lshlrev_b32 v0, 4, v0
s_cmp_gt_u32 s52, 4
s_cbranch_scc1 k_nb_8
s_mul_i32 s53, s52, 20
s_add_u32 s53, s53, s30
s_sub_u32 s53, s53, 20
s_cmp_lt_u32 s30, 20
s_cmov_b32 s30, s53
s_cbranch_scc1 k_o_4
s_mul_i32 s53, s52, 10
s_add_u32 s30, s30, s53
s_sub_u32 s30, s30, 30
s_branch k_p_6
k_nb_8:
s_mul_i32 s53, s52, 11
s_add_u32 s53, s53, s30
s_sub_u32 s53, s53, 74
s_cmp_ge_u32 s30, 19
s_cmov_b32 s30, s53
s_cbranch_scc1 k_at_5
s_mul_i32 s53, s52, 19
s_add_u32 s30, s30, s53
s_sub_u32 s30, s30, 55
s_cmp_lt_u32 s30, 96
s_cbranch_scc1 k_p_6
s_mov_b32 s30, 31
s_branch k_at_5
k_end_2:
s_endpgm
k_at_5:
s_lshl_b32 s52, s30, 2
s_add_u32 s52, s52, s3
s_lshl_b32 s52, s52, 9
s_add_u32 s52, s52, 222298112
v_mov_b64 v[2:3], 0
v_lshrrev_b32 v1, 1, v0
buffer_store_dwordx2 v[2:3], v1, s[4:7], s52 offen sc1
s_lshl_b32 s47, s30, 2
s_add_u32 s47, s47, s3
v_bfe_u32 v6, v0, 4, 5
v_lshrrev_b32 v2, 9, v0
v_bfe_u32 v8, v6, 2, 1
s_mov_b32 s56, 0x3acccccd
v_bfe_u32 v9, v6, 3, 1
v_and_b32 v1, 0x13, v6
v_lshl_add_u32 v1, v8, 3, v1
v_lshl_add_u32 v1, v9, 2, v1
k_gt_12:
s_mul_i32 s52, s47, 1639
s_lshr_b32 s52, s52, 16
s_mul_i32 s53, s52, 40
s_sub_u32 s53, s47, s53
s_lshl_b32 s52, s52, 5
s_lshl_b32 s53, s53, 1
v_add_u32 v3, s52, v1
v_add_u32 v6, s53, v2
v_and_b32 v4, 1, v3
v_cvt_f32_u32 v4, v4
v_mul_f32 v4, 0.5, v4
v_mul_f32 v4, 0.5, v4
v_cmp_gt_u32 vcc, 2, v3
s_nop 1
v_cndmask_b32 v4, v4, 0, vcc
v_mov_b32 v5, 0x3d64f92e
v_mov_b32 v8, 0x3d21e89b
v_cndmask_b32 v5, v5, v8, vcc
v_cmp_eq_u32 vcc, 0, v3
v_lshrrev_b32 v3, 1, v3
v_mov_b32 v8, 320
v_cndmask_b32 v3, v3, v8, vcc
v_lshlrev_b32 v6, 3, v6
v_mul_u32_u24 v6, v6, v3
v_cvt_f32_u32 v6, v6
v_cvt_f32_u32 v3, v3
v_fma_f32 v8, v6, s56, v4
v_add_f32 v6, v6, v3
v_fract_f32 v8, v8
v_cos_f32 v8, v8
v_fma_f32 v9, v6, s56, v4
v_add_f32 v6, v6, v3
v_fract_f32 v9, v9
v_cos_f32 v9, v9
v_fma_f32 v10, v6, s56, v4
v_add_f32 v6, v6, v3
v_fract_f32 v10, v10
v_cos_f32 v10, v10
v_fma_f32 v11, v6, s56, v4
v_add_f32 v6, v6, v3
v_fract_f32 v11, v11
v_cos_f32 v11, v11
v_fma_f32 v12, v6, s56, v4
v_add_f32 v6, v6, v3
v_fract_f32 v12, v12
v_cos_f32 v12, v12
v_fma_f32 v13, v6, s56, v4
v_add_f32 v6, v6, v3
v_fract_f32 v13, v13
v_cos_f32 v13, v13
v_fma_f32 v14, v6, s56, v4
v_add_f32 v6, v6, v3
v_fract_f32 v14, v14
v_cos_f32 v14, v14
v_fma_f32 v15, v6, s56, v4
v_add_f32 v6, v6, v3
v_fract_f32 v15, v15
v_cos_f32 v15, v15
v_mul_f32 v8, v5, v8
v_mul_f32 v9, v5, v9
v_mul_f32 v10, v5, v10
v_mul_f32 v11, v5, v11
v_mul_f32 v12, v5, v12
v_mul_f32 v13, v5, v13
v_mul_f32 v14, v5, v14
v_mul_f32 v15, v5, v15
v_cvt_pk_bf16_f32 v16, v8, v9
v_cvt_pk_bf16_f32 v17, v10, v11
v_cvt_pk_bf16_f32 v18, v12, v13
v_cvt_pk_bf16_f32 v19, v14, v15
s_lshl_b32 s52, s47, 10
s_add_u32 s52, s52, 213909504
buffer_store_dwordx4 v[16:19], v0, s[4:7], s52 offen sc1
s_add_u32 s47, s47, 128
s_cmp_lt_u32 s47, 800
s_cbranch_scc1 k_gt_12
s_waitcnt vmcnt(0)
s_barrier
s_cmp_lg_u32 s3, 0
s_cbranch_scc1 k_sd_14
s_mov_b64 exec, 1
v_mov_b32 v2, 128
v_mov_b32 v3, 1
global_atomic_add v2, v3, s[28:29] sc1
s_mov_b64 exec, -1
k_sd_14:
s_lshl_b32 s47, s30, 2
s_add_u32 s47, s47, s3
v_bfe_u32 v6, v0, 4, 5
v_lshrrev_b32 v2, 9, v0
v_bfe_u32 v8, v6, 2, 1
s_mov_b32 s56, 0x3acccccd
v_lshrrev_b32 v9, 3, v6
v_and_b32 v1, 3, v6
v_lshl_add_u32 v1, v8, 4, v1
v_lshl_add_u32 v1, v9, 2, v1
k_gt_15:
s_mul_i32 s52, s47, 1639
s_lshr_b32 s52, s52, 16
s_mul_i32 s53, s52, 40
s_sub_u32 s53, s47, s53
s_lshl_b32 s52, s52, 5
s_lshl_b32 s53, s53, 1
v_add_u32 v3, s52, v1
v_add_u32 v6, s53, v2
v_cmp_eq_u32 vcc, 0, v6
v_lshlrev_b32 v6, 2, v6
v_mul_u32_u24 v6, v6, v3
v_cvt_f32_u32 v6, v6
v_lshlrev_b32 v4, 31, v3
v_cvt_f32_u32 v3, v3
v_mul_f32 v8, s56, v6
v_add_f32 v6, v6, v3
v_fract_f32 v8, v8
v_sin_f32 v9, v8
v_cos_f32 v8, v8
v_mul_f32 v10, s56, v6
v_add_f32 v6, v6, v3
v_fract_f32 v10, v10
v_sin_f32 v11, v10
v_cos_f32 v10, v10
v_mul_f32 v12, s56, v6
v_add_f32 v6, v6, v3
v_fract_f32 v12, v12
v_sin_f32 v13, v12
v_cos_f32 v12, v12
v_mul_f32 v14, s56, v6
v_add_f32 v6, v6, v3
v_fract_f32 v14, v14
v_sin_f32 v15, v14
v_cos_f32 v14, v14
v_mul_f32 v8, 0x3d64f92e, v8
v_mul_f32 v9, 0xbd64f92e, v9
v_mul_f32 v10, 0x3d64f92e, v10
v_mul_f32 v11, 0xbd64f92e, v11
v_mul_f32 v12, 0x3d64f92e, v12
v_mul_f32 v13, 0xbd64f92e, v13
v_mul_f32 v14, 0x3d64f92e, v14
v_mul_f32 v15, 0xbd64f92e, v15
v_mov_b32 v5, 0x3d21e89b
v_xor_b32 v4, v4, v5
v_cndmask_b32 v8, v8, v4, vcc
v_cndmask_b32 v9, v9, v5, vcc
v_cvt_pk_bf16_f32 v16, v8, v9
v_cvt_pk_bf16_f32 v17, v10, v11
v_cvt_pk_bf16_f32 v18, v12, v13
v_cvt_pk_bf16_f32 v19, v14, v15
s_lshl_b32 s52, s47, 10
s_add_u32 s52, s52, 214958080
buffer_store_dwordx4 v[16:19], v0, s[4:7], s52 offen sc1
s_add_u32 s47, s47, 128
s_cmp_lt_u32 s47, 800
s_cbranch_scc1 k_gt_15
s_lshl_b32 s52, s30, 2
s_add_u32 s52, s52, s3
s_lshr_b32 s53, s52, 6
s_mul_i32 s53, s53, 393216
s_mul_i32 s52, s52, 10240
s_add_u32 s52, s52, s53
s_add_u32 s52, s52, 117440512
v_mov_b64 v[4:5], -1
v_mov_b64 v[6:7], -1
buffer_store_dwordx4 v[4:7], v0, s[4:7], s52 offen offset:0 sc1
buffer_store_dwordx4 v[4:7], v0, s[4:7], s52 offen offset:1024 sc1
buffer_store_dwordx4 v[4:7], v0, s[4:7], s52 offen offset:2048 sc1
buffer_store_dwordx4 v[4:7], v0, s[4:7], s52 offen offset:3072 sc1
s_add_u32 s52, s52, 4096
buffer_store_dwordx4 v[4:7], v0, s[4:7], s52 offen offset:0 sc1
buffer_store_dwordx4 v[4:7], v0, s[4:7], s52 offen offset:1024 sc1
buffer_store_dwordx4 v[4:7], v0, s[4:7], s52 offen offset:2048 sc1
buffer_store_dwordx4 v[4:7], v0, s[4:7], s52 offen offset:3072 sc1
s_add_u32 s52, s52, 4096
buffer_store_dwordx4 v[4:7], v0, s[4:7], s52 offen offset:0 sc1
buffer_store_dwordx4 v[4:7], v0, s[4:7], s52 offen offset:1024 sc1
s_waitcnt vmcnt(0)
s_barrier
s_cmp_lg_u32 s3, 0
s_cbranch_scc1 k_sd_17
s_mov_b64 exec, 1
v_mov_b32 v2, 192
v_mov_b32 v3, 1
global_atomic_add v2, v3, s[28:29] sc1
s_mov_b64 exec, -1
k_sd_17:
v_lshrrev_b32 v1, 8, v0
v_and_b32 v2, 0xf0, v0
v_lshl_add_u32 v8, v1, 13, v2
v_bfe_u32 v2, v0, 6, 4
v_and_b32 v3, 7, v2
v_xor_b32 v3, s3, v3
v_lshlrev_b32 v3, 5, v3
v_lshl_add_u32 v16, v2, 10, v3
v_bfe_u32 v2, v0, 4, 2
v_lshl_add_u32 v16, v2, 3, v16
v_xor_b32 v19, 0x80, v16
v_xor_b32 v9, 32, v8
v_xor_b32 v10, 64, v8
v_xor_b32 v11, 96, v8
v_xor_b32 v12, 128, v8
v_xor_b32 v13, 160, v8
v_xor_b32 v14, 192, v8
v_xor_b32 v15, 224, v8
v_add_u32 v17, 65536, v16
v_add_u32 v18, 131072, v16
v_add_u32 v20, 65536, v19
v_add_u32 v21, 131072, v19
s_mul_i32 s52, s3, 1310720
s_lshl_b32 s53, s30, 8
s_add_u32 s52, s52, s53
s_mul_i32 s53, s3, 40960
s_add_u32 m0, s53, 0
s_add_u32 s54, s52, 0
buffer_load_dwordx4 v8, s[12:15], s54 offen lds
s_add_u32 m0, s53, 1024
s_add_u32 s54, s52, 32768
buffer_load_dwordx4 v9, s[12:15], s54 offen lds
s_add_u32 m0, s53, 2048
s_add_u32 s54, s52, 65536
buffer_load_dwordx4 v10, s[12:15], s54 offen lds
s_add_u32 m0, s53, 3072
s_add_u32 s54, s52, 98304
buffer_load_dwordx4 v11, s[12:15], s54 offen lds
s_add_u32 m0, s53, 4096
s_add_u32 s54, s52, 131072
buffer_load_dwordx4 v12, s[12:15], s54 offen lds
s_add_u32 m0, s53, 5120
s_add_u32 s54, s52, 163840
buffer_load_dwordx4 v13, s[12:15], s54 offen lds
s_add_u32 m0, s53, 6144
s_add_u32 s54, s52, 196608
buffer_load_dwordx4 v14, s[12:15], s54 offen lds
s_add_u32 m0, s53, 7168
s_add_u32 s54, s52, 229376
buffer_load_dwordx4 v15, s[12:15], s54 offen lds
s_add_u32 m0, s53, 8192
s_add_u32 s54, s52, 262144
buffer_load_dwordx4 v8, s[12:15], s54 offen lds
s_add_u32 m0, s53, 9216
s_add_u32 s54, s52, 294912
buffer_load_dwordx4 v9, s[12:15], s54 offen lds
s_add_u32 m0, s53, 10240
s_add_u32 s54, s52, 327680
buffer_load_dwordx4 v10, s[12:15], s54 offen lds
s_add_u32 m0, s53, 11264
s_add_u32 s54, s52, 360448
buffer_load_dwordx4 v11, s[12:15], s54 offen lds
s_add_u32 m0, s53, 12288
s_add_u32 s54, s52, 393216
buffer_load_dwordx4 v12, s[12:15], s54 offen lds
s_add_u32 m0, s53, 13312
s_add_u32 s54, s52, 425984
buffer_load_dwordx4 v13, s[12:15], s54 offen lds
s_add_u32 m0, s53, 14336
s_add_u32 s54, s52, 458752
buffer_load_dwordx4 v14, s[12:15], s54 offen lds
s_add_u32 m0, s53, 15360
s_add_u32 s54, s52, 491520
buffer_load_dwordx4 v15, s[12:15], s54 offen lds
s_add_u32 m0, s53, 16384
s_add_u32 s54, s52, 524288
buffer_load_dwordx4 v8, s[12:15], s54 offen lds
s_add_u32 m0, s53, 17408
s_add_u32 s54, s52, 557056
buffer_load_dwordx4 v9, s[12:15], s54 offen lds
s_add_u32 m0, s53, 18432
s_add_u32 s54, s52, 589824
buffer_load_dwordx4 v10, s[12:15], s54 offen lds
s_add_u32 m0, s53, 19456
s_add_u32 s54, s52, 622592
buffer_load_dwordx4 v11, s[12:15], s54 offen lds
s_add_u32 m0, s53, 20480
s_add_u32 s54, s52, 655360
buffer_load_dwordx4 v12, s[12:15], s54 offen lds
s_add_u32 m0, s53, 21504
s_add_u32 s54, s52, 688128
buffer_load_dwordx4 v13, s[12:15], s54 offen lds
s_add_u32 m0, s53, 22528
s_add_u32 s54, s52, 720896
buffer_load_dwordx4 v14, s[12:15], s54 offen lds
s_add_u32 m0, s53, 23552
s_add_u32 s54, s52, 753664
buffer_load_dwordx4 v15, s[12:15], s54 offen lds
s_add_u32 m0, s53, 24576
s_add_u32 s54, s52, 786432
buffer_load_dwordx4 v8, s[12:15], s54 offen lds
s_add_u32 m0, s53, 25600
s_add_u32 s54, s52, 819200
buffer_load_dwordx4 v9, s[12:15], s54 offen lds
s_add_u32 m0, s53, 26624
s_add_u32 s54, s52, 851968
buffer_load_dwordx4 v10, s[12:15], s54 offen lds
s_add_u32 m0, s53, 27648
s_add_u32 s54, s52, 884736
buffer_load_dwordx4 v11, s[12:15], s54 offen lds
s_add_u32 m0, s53, 28672
s_add_u32 s54, s52, 917504
buffer_load_dwordx4 v12, s[12:15], s54 offen lds
s_add_u32 m0, s53, 29696
s_add_u32 s54, s52, 950272
buffer_load_dwordx4 v13, s[12:15], s54 offen lds
s_add_u32 m0, s53, 30720
s_add_u32 s54, s52, 983040
buffer_load_dwordx4 v14, s[12:15], s54 offen lds
s_add_u32 m0, s53, 31744
s_add_u32 s54, s52, 1015808
buffer_load_dwordx4 v15, s[12:15], s54 offen lds
s_add_u32 m0, s53, 32768
s_add_u32 s54, s52, 1048576
buffer_load_dwordx4 v8, s[12:15], s54 offen lds
s_add_u32 m0, s53, 33792
s_add_u32 s54, s52, 1081344
buffer_load_dwordx4 v9, s[12:15], s54 offen lds
s_add_u32 m0, s53, 34816
s_add_u32 s54, s52, 1114112
buffer_load_dwordx4 v10, s[12:15], s54 offen lds
s_add_u32 m0, s53, 35840
s_add_u32 s54, s52, 1146880
buffer_load_dwordx4 v11, s[12:15], s54 offen lds
s_add_u32 m0, s53, 36864
s_add_u32 s54, s52, 1179648
buffer_load_dwordx4 v12, s[12:15], s54 offen lds
s_add_u32 m0, s53, 37888
s_add_u32 s54, s52, 1212416
buffer_load_dwordx4 v13, s[12:15], s54 offen lds
s_add_u32 m0, s53, 38912
s_add_u32 s54, s52, 1245184
buffer_load_dwordx4 v14, s[12:15], s54 offen lds
s_add_u32 m0, s53, 39936
s_add_u32 s54, s52, 1277952
buffer_load_dwordx4 v15, s[12:15], s54 offen lds
s_waitcnt vmcnt(0)
s_barrier
ds_read_b64_tr_b16 a[0:1], v16 offset:0
ds_read_b64_tr_b16 a[2:3], v16 offset:512
ds_read_b64_tr_b16 a[4:5], v19 offset:0
ds_read_b64_tr_b16 a[6:7], v19 offset:512
ds_read_b64_tr_b16 a[16:17], v16 offset:256
ds_read_b64_tr_b16 a[18:19], v16 offset:768
ds_read_b64_tr_b16 a[20:21], v19 offset:256
ds_read_b64_tr_b16 a[22:23], v19 offset:768
ds_read_b64_tr_b16 a[32:33], v16 offset:16384
ds_read_b64_tr_b16 a[34:35], v16 offset:16896
ds_read_b64_tr_b16 a[36:37], v19 offset:16384
ds_read_b64_tr_b16 a[38:39], v19 offset:16896
ds_read_b64_tr_b16 a[48:49], v16 offset:16640
ds_read_b64_tr_b16 a[50:51], v16 offset:17152
ds_read_b64_tr_b16 a[52:53], v19 offset:16640
ds_read_b64_tr_b16 a[54:55], v19 offset:17152
ds_read_b64_tr_b16 a[64:65], v16 offset:32768
ds_read_b64_tr_b16 a[66:67], v16 offset:33280
ds_read_b64_tr_b16 a[68:69], v19 offset:32768
ds_read_b64_tr_b16 a[70:71], v19 offset:33280
ds_read_b64_tr_b16 a[80:81], v16 offset:33024
ds_read_b64_tr_b16 a[82:83], v16 offset:33536
ds_read_b64_tr_b16 a[84:85], v19 offset:33024
ds_read_b64_tr_b16 a[86:87], v19 offset:33536
ds_read_b64_tr_b16 a[96:97], v16 offset:49152
ds_read_b64_tr_b16 a[98:99], v16 offset:49664
ds_read_b64_tr_b16 a[100:101], v19 offset:49152
ds_read_b64_tr_b16 a[102:103], v19 offset:49664
ds_read_b64_tr_b16 a[112:113], v16 offset:49408
ds_read_b64_tr_b16 a[114:115], v16 offset:49920
ds_read_b64_tr_b16 a[116:117], v19 offset:49408
ds_read_b64_tr_b16 a[118:119], v19 offset:49920
ds_read_b64_tr_b16 a[128:129], v17 offset:0
ds_read_b64_tr_b16 a[130:131], v17 offset:512
ds_read_b64_tr_b16 a[132:133], v20 offset:0
ds_read_b64_tr_b16 a[134:135], v20 offset:512
ds_read_b64_tr_b16 a[144:145], v17 offset:256
ds_read_b64_tr_b16 a[146:147], v17 offset:768
ds_read_b64_tr_b16 a[148:149], v20 offset:256
ds_read_b64_tr_b16 a[150:151], v20 offset:768
ds_read_b64_tr_b16 a[160:161], v17 offset:16384
ds_read_b64_tr_b16 a[162:163], v17 offset:16896
ds_read_b64_tr_b16 a[164:165], v20 offset:16384
ds_read_b64_tr_b16 a[166:167], v20 offset:16896
ds_read_b64_tr_b16 a[176:177], v17 offset:16640
ds_read_b64_tr_b16 a[178:179], v17 offset:17152
ds_read_b64_tr_b16 a[180:181], v20 offset:16640
ds_read_b64_tr_b16 a[182:183], v20 offset:17152
ds_read_b64_tr_b16 a[192:193], v17 offset:32768
ds_read_b64_tr_b16 a[194:195], v17 offset:33280
ds_read_b64_tr_b16 a[196:197], v20 offset:32768
ds_read_b64_tr_b16 a[198:199], v20 offset:33280
ds_read_b64_tr_b16 a[208:209], v17 offset:33024
ds_read_b64_tr_b16 a[210:211], v17 offset:33536
ds_read_b64_tr_b16 a[212:213], v20 offset:33024
ds_read_b64_tr_b16 a[214:215], v20 offset:33536
ds_read_b64_tr_b16 a[224:225], v17 offset:49152
ds_read_b64_tr_b16 a[226:227], v17 offset:49664
ds_read_b64_tr_b16 a[228:229], v20 offset:49152
ds_read_b64_tr_b16 a[230:231], v20 offset:49664
ds_read_b64_tr_b16 a[240:241], v17 offset:49408
ds_read_b64_tr_b16 a[242:243], v17 offset:49920
ds_read_b64_tr_b16 a[244:245], v20 offset:49408
ds_read_b64_tr_b16 a[246:247], v20 offset:49920
ds_read_b64_tr_b16 v[192:193], v18 offset:0
ds_read_b64_tr_b16 v[194:195], v18 offset:512
ds_read_b64_tr_b16 v[196:197], v21 offset:0
ds_read_b64_tr_b16 v[198:199], v21 offset:512
ds_read_b64_tr_b16 v[208:209], v18 offset:256
ds_read_b64_tr_b16 v[210:211], v18 offset:768
ds_read_b64_tr_b16 v[212:213], v21 offset:256
ds_read_b64_tr_b16 v[214:215], v21 offset:768
ds_read_b64_tr_b16 v[224:225], v18 offset:16384
ds_read_b64_tr_b16 v[226:227], v18 offset:16896
ds_read_b64_tr_b16 v[228:229], v21 offset:16384
ds_read_b64_tr_b16 v[230:231], v21 offset:16896
ds_read_b64_tr_b16 v[240:241], v18 offset:16640
ds_read_b64_tr_b16 v[242:243], v18 offset:17152
ds_read_b64_tr_b16 v[244:245], v21 offset:16640
ds_read_b64_tr_b16 v[246:247], v21 offset:17152
s_waitcnt lgkmcnt(0)
s_barrier
s_mul_i32 s52, s3, 1310720
s_lshl_b32 s53, s30, 8
s_add_u32 s52, s52, s53
s_mul_i32 s53, s3, 40960
s_add_u32 m0, s53, 0
s_add_u32 s54, s52, 0
buffer_load_dwordx4 v8, s[16:19], s54 offen lds
s_add_u32 m0, s53, 1024
s_add_u32 s54, s52, 32768
buffer_load_dwordx4 v9, s[16:19], s54 offen lds
s_add_u32 m0, s53, 2048
s_add_u32 s54, s52, 65536
buffer_load_dwordx4 v10, s[16:19], s54 offen lds
s_add_u32 m0, s53, 3072
s_add_u32 s54, s52, 98304
buffer_load_dwordx4 v11, s[16:19], s54 offen lds
s_add_u32 m0, s53, 4096
s_add_u32 s54, s52, 131072
buffer_load_dwordx4 v12, s[16:19], s54 offen lds
s_add_u32 m0, s53, 5120
s_add_u32 s54, s52, 163840
buffer_load_dwordx4 v13, s[16:19], s54 offen lds
s_add_u32 m0, s53, 6144
s_add_u32 s54, s52, 196608
buffer_load_dwordx4 v14, s[16:19], s54 offen lds
s_add_u32 m0, s53, 7168
s_add_u32 s54, s52, 229376
buffer_load_dwordx4 v15, s[16:19], s54 offen lds
s_add_u32 m0, s53, 8192
s_add_u32 s54, s52, 262144
buffer_load_dwordx4 v8, s[16:19], s54 offen lds
s_add_u32 m0, s53, 9216
s_add_u32 s54, s52, 294912
buffer_load_dwordx4 v9, s[16:19], s54 offen lds
s_add_u32 m0, s53, 10240
s_add_u32 s54, s52, 327680
buffer_load_dwordx4 v10, s[16:19], s54 offen lds
s_add_u32 m0, s53, 11264
s_add_u32 s54, s52, 360448
buffer_load_dwordx4 v11, s[16:19], s54 offen lds
s_add_u32 m0, s53, 12288
s_add_u32 s54, s52, 393216
buffer_load_dwordx4 v12, s[16:19], s54 offen lds
s_add_u32 m0, s53, 13312
s_add_u32 s54, s52, 425984
buffer_load_dwordx4 v13, s[16:19], s54 offen lds
s_add_u32 m0, s53, 14336
s_add_u32 s54, s52, 458752
buffer_load_dwordx4 v14, s[16:19], s54 offen lds
s_add_u32 m0, s53, 15360
s_add_u32 s54, s52, 491520
buffer_load_dwordx4 v15, s[16:19], s54 offen lds
s_add_u32 m0, s53, 16384
s_add_u32 s54, s52, 524288
buffer_load_dwordx4 v8, s[16:19], s54 offen lds
s_add_u32 m0, s53, 17408
s_add_u32 s54, s52, 557056
buffer_load_dwordx4 v9, s[16:19], s54 offen lds
s_add_u32 m0, s53, 18432
s_add_u32 s54, s52, 589824
buffer_load_dwordx4 v10, s[16:19], s54 offen lds
s_add_u32 m0, s53, 19456
s_add_u32 s54, s52, 622592
buffer_load_dwordx4 v11, s[16:19], s54 offen lds
s_add_u32 m0, s53, 20480
s_add_u32 s54, s52, 655360
buffer_load_dwordx4 v12, s[16:19], s54 offen lds
s_add_u32 m0, s53, 21504
s_add_u32 s54, s52, 688128
buffer_load_dwordx4 v13, s[16:19], s54 offen lds
s_add_u32 m0, s53, 22528
s_add_u32 s54, s52, 720896
buffer_load_dwordx4 v14, s[16:19], s54 offen lds
s_add_u32 m0, s53, 23552
s_add_u32 s54, s52, 753664
buffer_load_dwordx4 v15, s[16:19], s54 offen lds
s_add_u32 m0, s53, 24576
s_add_u32 s54, s52, 786432
buffer_load_dwordx4 v8, s[16:19], s54 offen lds
s_add_u32 m0, s53, 25600
s_add_u32 s54, s52, 819200
buffer_load_dwordx4 v9, s[16:19], s54 offen lds
s_add_u32 m0, s53, 26624
s_add_u32 s54, s52, 851968
buffer_load_dwordx4 v10, s[16:19], s54 offen lds
s_add_u32 m0, s53, 27648
s_add_u32 s54, s52, 884736
buffer_load_dwordx4 v11, s[16:19], s54 offen lds
s_add_u32 m0, s53, 28672
s_add_u32 s54, s52, 917504
buffer_load_dwordx4 v12, s[16:19], s54 offen lds
s_add_u32 m0, s53, 29696
s_add_u32 s54, s52, 950272
buffer_load_dwordx4 v13, s[16:19], s54 offen lds
s_add_u32 m0, s53, 30720
s_add_u32 s54, s52, 983040
buffer_load_dwordx4 v14, s[16:19], s54 offen lds
s_add_u32 m0, s53, 31744
s_add_u32 s54, s52, 1015808
buffer_load_dwordx4 v15, s[16:19], s54 offen lds
s_add_u32 m0, s53, 32768
s_add_u32 s54, s52, 1048576
buffer_load_dwordx4 v8, s[16:19], s54 offen lds
s_add_u32 m0, s53, 33792
s_add_u32 s54, s52, 1081344
buffer_load_dwordx4 v9, s[16:19], s54 offen lds
s_add_u32 m0, s53, 34816
s_add_u32 s54, s52, 1114112
buffer_load_dwordx4 v10, s[16:19], s54 offen lds
s_add_u32 m0, s53, 35840
s_add_u32 s54, s52, 1146880
buffer_load_dwordx4 v11, s[16:19], s54 offen lds
s_add_u32 m0, s53, 36864
s_add_u32 s54, s52, 1179648
buffer_load_dwordx4 v12, s[16:19], s54 offen lds
s_add_u32 m0, s53, 37888
s_add_u32 s54, s52, 1212416
buffer_load_dwordx4 v13, s[16:19], s54 offen lds
s_add_u32 m0, s53, 38912
s_add_u32 s54, s52, 1245184
buffer_load_dwordx4 v14, s[16:19], s54 offen lds
s_add_u32 m0, s53, 39936
s_add_u32 s54, s52, 1277952
buffer_load_dwordx4 v15, s[16:19], s54 offen lds
s_waitcnt vmcnt(0)
s_barrier
ds_read_b64_tr_b16 a[8:9], v16 offset:0
ds_read_b64_tr_b16 a[10:11], v16 offset:512
ds_read_b64_tr_b16 a[12:13], v19 offset:0
ds_read_b64_tr_b16 a[14:15], v19 offset:512
ds_read_b64_tr_b16 a[24:25], v16 offset:256
ds_read_b64_tr_b16 a[26:27], v16 offset:768
ds_read_b64_tr_b16 a[28:29], v19 offset:256
ds_read_b64_tr_b16 a[30:31], v19 offset:768
ds_read_b64_tr_b16 a[40:41], v16 offset:16384
ds_read_b64_tr_b16 a[42:43], v16 offset:16896
ds_read_b64_tr_b16 a[44:45], v19 offset:16384
ds_read_b64_tr_b16 a[46:47], v19 offset:16896
ds_read_b64_tr_b16 a[56:57], v16 offset:16640
ds_read_b64_tr_b16 a[58:59], v16 offset:17152
ds_read_b64_tr_b16 a[60:61], v19 offset:16640
ds_read_b64_tr_b16 a[62:63], v19 offset:17152
ds_read_b64_tr_b16 a[72:73], v16 offset:32768
ds_read_b64_tr_b16 a[74:75], v16 offset:33280
ds_read_b64_tr_b16 a[76:77], v19 offset:32768
ds_read_b64_tr_b16 a[78:79], v19 offset:33280
ds_read_b64_tr_b16 a[88:89], v16 offset:33024
ds_read_b64_tr_b16 a[90:91], v16 offset:33536
ds_read_b64_tr_b16 a[92:93], v19 offset:33024
ds_read_b64_tr_b16 a[94:95], v19 offset:33536
ds_read_b64_tr_b16 a[104:105], v16 offset:49152
ds_read_b64_tr_b16 a[106:107], v16 offset:49664
ds_read_b64_tr_b16 a[108:109], v19 offset:49152
ds_read_b64_tr_b16 a[110:111], v19 offset:49664
ds_read_b64_tr_b16 a[120:121], v16 offset:49408
ds_read_b64_tr_b16 a[122:123], v16 offset:49920
ds_read_b64_tr_b16 a[124:125], v19 offset:49408
ds_read_b64_tr_b16 a[126:127], v19 offset:49920
ds_read_b64_tr_b16 a[136:137], v17 offset:0
ds_read_b64_tr_b16 a[138:139], v17 offset:512
ds_read_b64_tr_b16 a[140:141], v20 offset:0
ds_read_b64_tr_b16 a[142:143], v20 offset:512
ds_read_b64_tr_b16 a[152:153], v17 offset:256
ds_read_b64_tr_b16 a[154:155], v17 offset:768
ds_read_b64_tr_b16 a[156:157], v20 offset:256
ds_read_b64_tr_b16 a[158:159], v20 offset:768
ds_read_b64_tr_b16 a[168:169], v17 offset:16384
ds_read_b64_tr_b16 a[170:171], v17 offset:16896
ds_read_b64_tr_b16 a[172:173], v20 offset:16384
ds_read_b64_tr_b16 a[174:175], v20 offset:16896
ds_read_b64_tr_b16 a[184:185], v17 offset:16640
ds_read_b64_tr_b16 a[186:187], v17 offset:17152
ds_read_b64_tr_b16 a[188:189], v20 offset:16640
ds_read_b64_tr_b16 a[190:191], v20 offset:17152
ds_read_b64_tr_b16 a[200:201], v17 offset:32768
ds_read_b64_tr_b16 a[202:203], v17 offset:33280
ds_read_b64_tr_b16 a[204:205], v20 offset:32768
ds_read_b64_tr_b16 a[206:207], v20 offset:33280
ds_read_b64_tr_b16 a[216:217], v17 offset:33024
ds_read_b64_tr_b16 a[218:219], v17 offset:33536
ds_read_b64_tr_b16 a[220:221], v20 offset:33024
ds_read_b64_tr_b16 a[222:223], v20 offset:33536
ds_read_b64_tr_b16 a[232:233], v17 offset:49152
ds_read_b64_tr_b16 a[234:235], v17 offset:49664
ds_read_b64_tr_b16 a[236:237], v20 offset:49152
ds_read_b64_tr_b16 a[238:239], v20 offset:49664
ds_read_b64_tr_b16 a[248:249], v17 offset:49408
ds_read_b64_tr_b16 a[250:251], v17 offset:49920
ds_read_b64_tr_b16 a[252:253], v20 offset:49408
ds_read_b64_tr_b16 a[254:255], v20 offset:49920
ds_read_b64_tr_b16 v[200:201], v18 offset:0
ds_read_b64_tr_b16 v[202:203], v18 offset:512
ds_read_b64_tr_b16 v[204:205], v21 offset:0
ds_read_b64_tr_b16 v[206:207], v21 offset:512
ds_read_b64_tr_b16 v[216:217], v18 offset:256
ds_read_b64_tr_b16 v[218:219], v18 offset:768
ds_read_b64_tr_b16 v[220:221], v21 offset:256
ds_read_b64_tr_b16 v[222:223], v21 offset:768
ds_read_b64_tr_b16 v[232:233], v18 offset:16384
ds_read_b64_tr_b16 v[234:235], v18 offset:16896
ds_read_b64_tr_b16 v[236:237], v21 offset:16384
ds_read_b64_tr_b16 v[238:239], v21 offset:16896
ds_read_b64_tr_b16 v[248:249], v18 offset:16640
ds_read_b64_tr_b16 v[250:251], v18 offset:17152
ds_read_b64_tr_b16 v[252:253], v21 offset:16640
ds_read_b64_tr_b16 v[254:255], v21 offset:17152
s_waitcnt lgkmcnt(0)
s_barrier
s_and_b32 s47, s3, 1
s_lshr_b32 s52, s3, 1
s_add_u32 s50, s52, 1
v_lshrrev_b32 v20, 9, v0
v_mov_b32 v21, 0xff800000
v_cmp_eq_u32 vcc, s52, v20
s_lshl_b32 s46, s52, 10
s_lshl_b32 s53, s47, 7
s_add_u32 s46, s46, s53
s_add_u32 s46, s46, 117440512
s_lshl_b32 s53, s52, 5
s_add_u32 s53, s53, s30
s_lshl_b32 s44, s53, 14
s_add_u32 s44, s44, 0
s_lshl_b32 s53, s53, 13
s_lshl_b32 s45, s47, 10
s_add_u32 s45, s45, s53
s_add_u32 s45, s45, 125829120
s_lshl_b32 s48, s3, 17
s_lshl_b32 s53, s30, 11
s_add_u32 s48, s48, s53
s_add_u32 s48, s48, 159383552
s_lshl_b32 s56, s30, 6
s_add_u32 s56, s56, 222330880
s_lshl_b32 s57, s3, 8
s_lshl_b32 s53, s30, 2
s_add_u32 s57, s57, s53
s_add_u32 s57, s57, 222339072
s_mov_b32 s58, 0x3e0293ee
v_cndmask_b32 v156, v21, 0, vcc
v_cndmask_b32 v157, v21, 0, vcc
v_cndmask_b32 v158, v21, 0, vcc
v_cndmask_b32 v159, v21, 0, vcc
v_bfe_u32 v20, v0, 7, 1
v_and_b32 v1, 0x370, v0
v_mul_u32_u24 v23, 10240, v20
v_add_u32 v23, v23, v1
v_lshl_add_u32 v1, v20, 16, v1
v_and_b32 v16, 0x350, v0
v_lshl_add_u32 v16, v20, 5, v16
v_bfe_u32 v20, v0, 5, 1
v_lshl_add_u32 v16, v20, 12, v16
v_add_u32 v17, 8192, v16
s_lshl_b32 s52, s3, 10
v_add_u32 v155, s52, v0
v_mov_b32 v2, 2146435072
v_cmp_eq_u32 vcc, 0, v0
s_nop 1
v_cndmask_b32 v2, v2, 0, vcc
v_bfe_u32 v20, v0, 4, 4
s_lshl_b32 s52, s47, 4
v_add_u32 v20, s52, v20
v_lshrrev_b32 v22, 8, v0
v_lshlrev_b32 v22, 2, v22
v_sub_u32 v20, v20, v22
v_add_u32 v3, 4096, v0
v_add_u32 v18, 8192, v0
v_add_u32 v19, 12288, v0
v_cmp_le_i32 vcc, 0, v20
s_nop 1
v_cndmask_b32 v4, v21, 0, vcc
v_cmp_le_i32 vcc, 1, v20
s_nop 1
v_cndmask_b32 v5, v21, 0, vcc
v_cmp_le_i32 vcc, 2, v20
s_nop 1
v_cndmask_b32 v6, v21, 0, vcc
v_cmp_le_i32 vcc, 3, v20
s_nop 1
v_cndmask_b32 v7, v21, 0, vcc
v_cmp_le_i32 vcc, 16, v20
s_nop 1
v_cndmask_b32 v8, v21, 0, vcc
v_cmp_le_i32 vcc, 17, v20
s_nop 1
v_cndmask_b32 v9, v21, 0, vcc
v_cmp_le_i32 vcc, 18, v20
s_nop 1
v_cndmask_b32 v10, v21, 0, vcc
v_cmp_le_i32 vcc, 19, v20
s_nop 1
v_cndmask_b32 v11, v21, 0, vcc
v_mov_b32 v12, 0x3f803f80
v_mov_b32 v13, 0x3f803f80
v_mov_b32 v14, 0x3f803f80
v_mov_b32 v15, 0x3f803f80
s_cmp_lg_u32 s3, 0
s_cbranch_scc1 k_wdd_19
v_mov_b32 v20, 192
k_wd_18:
global_load_dword v21, v20, s[28:29] sc1
s_waitcnt vmcnt(0)
v_readfirstlane_b32 s52, v21
s_cmp_ge_u32 s52, 32
s_cbranch_scc1 k_wdd_19
s_sleep 2
s_sub_u32 s32, s32, 1
s_cmp_gt_i32 s32, 0
s_cbranch_scc1 k_wd_18
k_wdd_19:
s_barrier
v_mov_b32 v154, 0
k_top_20:
s_waitcnt vmcnt(0)
buffer_store_dword v154, v2, s[4:7], s57 offen sc1
s_cmp_gt_u32 s50, 128
s_cbranch_scc1 k_out_27
k_ck_21:
buffer_load_dwordx3 v[20:22], off, s[4:7], s56 sc1
s_waitcnt vmcnt(0)
v_min3_u32 v20, v20, v21, v22
v_cmp_le_u32 vcc, s50, v20
s_cbranch_vccnz k_cd_22
s_sleep 4
s_sub_u32 s32, s32, 1
s_cmp_gt_i32 s32, 0
s_cbranch_scc1 k_ck_21
k_cd_22:
s_add_u32 s52, s46, 4096
s_add_u32 s53, s46, 8192
buffer_load_dwordx4 v[160:163], v23, s[4:7], s46 offen offset:0 sc1
buffer_load_dwordx4 v[164:167], v23, s[4:7], s46 offen offset:2048 sc1
buffer_load_dwordx4 v[168:171], v23, s[4:7], s52 offen offset:0 sc1
buffer_load_dwordx4 v[172:175], v23, s[4:7], s52 offen offset:2048 sc1
buffer_load_dwordx4 v[176:179], v23, s[4:7], s53 offen offset:0 sc1
buffer_load_dwordx4 v[24:27], v0, s[4:7], s45 offen offset:0 sc1
buffer_load_dwordx4 v[40:43], v16, s[4:7], s44 offen offset:0 sc1
buffer_load_dwordx4 v[44:47], v17, s[4:7], s44 offen offset:0 sc1
buffer_load_dwordx4 v[28:31], v0, s[4:7], s45 offen offset:2048 sc1
buffer_load_dwordx4 v[48:51], v16, s[4:7], s44 offen offset:128 sc1
buffer_load_dwordx4 v[52:55], v17, s[4:7], s44 offen offset:128 sc1
buffer_load_dwordx4 v[32:35], v3, s[4:7], s45 offen offset:0 sc1
buffer_load_dwordx4 v[56:59], v16, s[4:7], s44 offen offset:1024 sc1
buffer_load_dwordx4 v[60:63], v17, s[4:7], s44 offen offset:1024 sc1
buffer_load_dwordx4 v[36:39], v3, s[4:7], s45 offen offset:2048 sc1
buffer_load_dwordx4 v[64:67], v16, s[4:7], s44 offen offset:1152 sc1
buffer_load_dwordx4 v[68:71], v17, s[4:7], s44 offen offset:1152 sc1
buffer_load_dwordx4 v[72:75], v0, s[4:7], s44 offen offset:2048 sc1
buffer_load_dwordx4 v[76:79], v0, s[4:7], s44 offen offset:3072 sc1
buffer_load_dwordx4 v[80:83], v3, s[4:7], s44 offen offset:2048 sc1
buffer_load_dwordx4 v[84:87], v3, s[4:7], s44 offen offset:3072 sc1
buffer_load_dwordx4 v[88:91], v18, s[4:7], s44 offen offset:2048 sc1
buffer_load_dwordx4 v[92:95], v18, s[4:7], s44 offen offset:3072 sc1
buffer_load_dwordx4 v[96:99], v19, s[4:7], s44 offen offset:2048 sc1
buffer_load_dwordx4 v[100:103], v19, s[4:7], s44 offen offset:3072 sc1
s_waitcnt vmcnt(22)
v_max3_u32 v20, v160, v164, v168
s_waitcnt vmcnt(20)
v_max3_u32 v20, v20, v172, v176
v_cmp_eq_u32 vcc, -1, v20
buffer_store_dword v154, v2, s[4:7], s57 offen sc1
s_cbranch_vccz k_pmd_25
s_add_u32 s52, s46, 10240
k_pr_23:
buffer_load_dword v20, off, s[4:7], s52 sc1
s_waitcnt vmcnt(0)
v_cmp_eq_u32 vcc, -1, v20
s_cbranch_vccz k_pm_24
s_sleep 2
s_sub_u32 s32, s32, 1
s_cmp_gt_i32 s32, 0
s_cbranch_scc1 k_pr_23
k_pm_24:
s_add_u32 s52, s46, 4096
s_add_u32 s53, s46, 8192
buffer_load_dwordx4 v[160:163], v23, s[4:7], s46 offen offset:0 sc1
buffer_load_dwordx4 v[164:167], v23, s[4:7], s46 offen offset:2048 sc1
buffer_load_dwordx4 v[168:171], v23, s[4:7], s52 offen offset:0 sc1
buffer_load_dwordx4 v[172:175], v23, s[4:7], s52 offen offset:2048 sc1
buffer_load_dwordx4 v[176:179], v23, s[4:7], s53 offen offset:0 sc1
s_waitcnt vmcnt(2)
v_max3_u32 v20, v160, v164, v168
s_waitcnt vmcnt(0)
v_max3_u32 v20, v20, v172, v176
v_cmp_eq_u32 vcc, -1, v20
s_cbranch_vccz k_pmd_25
s_sleep 2
s_sub_u32 s32, s32, 1
s_cmp_gt_i32 s32, 0
s_cbranch_scc1 k_pm_24
k_pmd_25:
ds_write_b128 v155, v[160:163] offset:0
ds_write_b128 v155, v[164:167] offset:4096
ds_write_b128 v155, v[168:171] offset:8192
ds_write_b128 v155, v[172:175] offset:12288
ds_write_b128 v155, v[176:179] offset:16384
s_waitcnt lgkmcnt(0)
s_barrier
ds_read_b128 v[160:163], v0 offset:0
ds_read_b128 v[164:167], v0 offset:1024
ds_read_b128 v[168:171], v0 offset:2048
ds_read_b128 v[172:175], v0 offset:3072
buffer_load_dwordx3 v[20:22], off, s[4:7], s56 sc1
s_waitcnt lgkmcnt(3)
v_mfma_f32_16x16x32_bf16 v[104:107], a[0:3], v[160:163], 0
ds_read_b128 v[176:179], v0 offset:4096
v_mfma_f32_16x16x32_bf16 v[108:111], a[4:7], v[160:163], 0
v_mfma_f32_16x16x32_bf16 v[112:115], v[160:163], a[8:11], 0
v_mfma_f32_16x16x32_bf16 v[116:119], v[160:163], a[12:15], 0
s_waitcnt lgkmcnt(3)
v_mfma_f32_16x16x32_bf16 v[104:107], a[16:19], v[164:167], v[104:107]
ds_read_b128 v[180:183], v0 offset:5120
v_mfma_f32_16x16x32_bf16 v[108:111], a[20:23], v[164:167], v[108:111]
v_mfma_f32_16x16x32_bf16 v[112:115], v[164:167], a[24:27], v[112:115]
v_mfma_f32_16x16x32_bf16 v[116:119], v[164:167], a[28:31], v[116:119]
s_waitcnt lgkmcnt(3)
v_mfma_f32_16x16x32_bf16 v[104:107], a[32:35], v[168:171], v[104:107]
ds_read_b128 v[184:187], v0 offset:6144
v_mfma_f32_16x16x32_bf16 v[108:111], a[36:39], v[168:171], v[108:111]
v_mfma_f32_16x16x32_bf16 v[112:115], v[168:171], a[40:43], v[112:115]
v_mfma_f32_16x16x32_bf16 v[116:119], v[168:171], a[44:47], v[116:119]
s_waitcnt lgkmcnt(3)
v_mfma_f32_16x16x32_bf16 v[104:107], a[48:51], v[172:175], v[104:107]
ds_read_b128 v[188:191], v0 offset:7168
v_mfma_f32_16x16x32_bf16 v[108:111], a[52:55], v[172:175], v[108:111]
v_mfma_f32_16x16x32_bf16 v[112:115], v[172:175], a[56:59], v[112:115]
v_mfma_f32_16x16x32_bf16 v[116:119], v[172:175], a[60:63], v[116:119]
s_waitcnt lgkmcnt(3)
v_mfma_f32_16x16x32_bf16 v[104:107], a[64:67], v[176:179], v[104:107]
ds_read_b128 v[160:163], v0 offset:8192
v_mfma_f32_16x16x32_bf16 v[108:111], a[68:71], v[176:179], v[108:111]
v_mfma_f32_16x16x32_bf16 v[112:115], v[176:179], a[72:75], v[112:115]
v_mfma_f32_16x16x32_bf16 v[116:119], v[176:179], a[76:79], v[116:119]
s_waitcnt lgkmcnt(3)
v_mfma_f32_16x16x32_bf16 v[104:107], a[80:83], v[180:183], v[104:107]
ds_read_b128 v[164:167], v0 offset:9216
v_mfma_f32_16x16x32_bf16 v[108:111], a[84:87], v[180:183], v[108:111]
v_mfma_f32_16x16x32_bf16 v[112:115], v[180:183], a[88:91], v[112:115]
v_mfma_f32_16x16x32_bf16 v[116:119], v[180:183], a[92:95], v[116:119]
s_waitcnt lgkmcnt(3)
v_mfma_f32_16x16x32_bf16 v[104:107], a[96:99], v[184:187], v[104:107]
ds_read_b128 v[168:171], v0 offset:10240
v_mfma_f32_16x16x32_bf16 v[108:111], a[100:103], v[184:187], v[108:111]
v_mfma_f32_16x16x32_bf16 v[112:115], v[184:187], a[104:107], v[112:115]
v_mfma_f32_16x16x32_bf16 v[116:119], v[184:187], a[108:111], v[116:119]
s_waitcnt lgkmcnt(3)
v_mfma_f32_16x16x32_bf16 v[104:107], a[112:115], v[188:191], v[104:107]
ds_read_b128 v[172:175], v0 offset:11264
v_mfma_f32_16x16x32_bf16 v[108:111], a[116:119], v[188:191], v[108:111]
v_mfma_f32_16x16x32_bf16 v[112:115], v[188:191], a[120:123], v[112:115]
v_mfma_f32_16x16x32_bf16 v[116:119], v[188:191], a[124:127], v[116:119]
s_waitcnt lgkmcnt(3)
v_mfma_f32_16x16x32_bf16 v[104:107], a[128:131], v[160:163], v[104:107]
ds_read_b128 v[176:179], v0 offset:12288
v_mfma_f32_16x16x32_bf16 v[108:111], a[132:135], v[160:163], v[108:111]
v_mfma_f32_16x16x32_bf16 v[112:115], v[160:163], a[136:139], v[112:115]
v_mfma_f32_16x16x32_bf16 v[116:119], v[160:163], a[140:143], v[116:119]
s_waitcnt lgkmcnt(3)
v_mfma_f32_16x16x32_bf16 v[104:107], a[144:147], v[164:167], v[104:107]
ds_read_b128 v[180:183], v0 offset:13312
v_mfma_f32_16x16x32_bf16 v[108:111], a[148:151], v[164:167], v[108:111]
v_mfma_f32_16x16x32_bf16 v[112:115], v[164:167], a[152:155], v[112:115]
v_mfma_f32_16x16x32_bf16 v[116:119], v[164:167], a[156:159], v[116:119]
s_waitcnt lgkmcnt(3)
v_mfma_f32_16x16x32_bf16 v[104:107], a[160:163], v[168:171], v[104:107]
ds_read_b128 v[184:187], v0 offset:14336
v_mfma_f32_16x16x32_bf16 v[108:111], a[164:167], v[168:171], v[108:111]
v_mfma_f32_16x16x32_bf16 v[112:115], v[168:171], a[168:171], v[112:115]
v_mfma_f32_16x16x32_bf16 v[116:119], v[168:171], a[172:175], v[116:119]
s_waitcnt lgkmcnt(3)
v_mfma_f32_16x16x32_bf16 v[104:107], a[176:179], v[172:175], v[104:107]
ds_read_b128 v[188:191], v0 offset:15360
v_mfma_f32_16x16x32_bf16 v[108:111], a[180:183], v[172:175], v[108:111]
v_mfma_f32_16x16x32_bf16 v[112:115], v[172:175], a[184:187], v[112:115]
v_mfma_f32_16x16x32_bf16 v[116:119], v[172:175], a[188:191], v[116:119]
s_waitcnt lgkmcnt(3)
v_mfma_f32_16x16x32_bf16 v[104:107], a[192:195], v[176:179], v[104:107]
ds_read_b128 v[160:163], v0 offset:16384
v_mfma_f32_16x16x32_bf16 v[108:111], a[196:199], v[176:179], v[108:111]
v_mfma_f32_16x16x32_bf16 v[112:115], v[176:179], a[200:203], v[112:115]
v_mfma_f32_16x16x32_bf16 v[116:119], v[176:179], a[204:207], v[116:119]
s_waitcnt lgkmcnt(3)
v_mfma_f32_16x16x32_bf16 v[104:107], a[208:211], v[180:183], v[104:107]
ds_read_b128 v[164:167], v0 offset:17408
v_mfma_f32_16x16x32_bf16 v[108:111], a[212:215], v[180:183], v[108:111]
v_mfma_f32_16x16x32_bf16 v[112:115], v[180:183], a[216:219], v[112:115]
v_mfma_f32_16x16x32_bf16 v[116:119], v[180:183], a[220:223], v[116:119]
s_waitcnt lgkmcnt(3)
v_mfma_f32_16x16x32_bf16 v[104:107], a[224:227], v[184:187], v[104:107]
ds_read_b128 v[168:171], v0 offset:18432
v_mfma_f32_16x16x32_bf16 v[108:111], a[228:231], v[184:187], v[108:111]
v_mfma_f32_16x16x32_bf16 v[112:115], v[184:187], a[232:235], v[112:115]
v_mfma_f32_16x16x32_bf16 v[116:119], v[184:187], a[236:239], v[116:119]
s_waitcnt lgkmcnt(3)
v_mfma_f32_16x16x32_bf16 v[104:107], a[240:243], v[188:191], v[104:107]
ds_read_b128 v[172:175], v0 offset:19456
v_mfma_f32_16x16x32_bf16 v[108:111], a[244:247], v[188:191], v[108:111]
v_mfma_f32_16x16x32_bf16 v[112:115], v[188:191], a[248:251], v[112:115]
v_mfma_f32_16x16x32_bf16 v[116:119], v[188:191], a[252:255], v[116:119]
s_waitcnt lgkmcnt(3)
v_mfma_f32_16x16x32_bf16 v[104:107], v[192:195], v[160:163], v[104:107]
v_mfma_f32_16x16x32_bf16 v[108:111], v[196:199], v[160:163], v[108:111]
v_mfma_f32_16x16x32_bf16 v[112:115], v[160:163], v[200:203], v[112:115]
v_mfma_f32_16x16x32_bf16 v[116:119], v[160:163], v[204:207], v[116:119]
s_waitcnt lgkmcnt(2)
v_mfma_f32_16x16x32_bf16 v[104:107], v[208:211], v[164:167], v[104:107]
v_mfma_f32_16x16x32_bf16 v[108:111], v[212:215], v[164:167], v[108:111]
v_mfma_f32_16x16x32_bf16 v[112:115], v[164:167], v[216:219], v[112:115]
v_mfma_f32_16x16x32_bf16 v[116:119], v[164:167], v[220:223], v[116:119]
s_waitcnt lgkmcnt(1)
v_mfma_f32_16x16x32_bf16 v[104:107], v[224:227], v[168:171], v[104:107]
v_mfma_f32_16x16x32_bf16 v[108:111], v[228:231], v[168:171], v[108:111]
v_mfma_f32_16x16x32_bf16 v[112:115], v[168:171], v[232:235], v[112:115]
v_mfma_f32_16x16x32_bf16 v[116:119], v[168:171], v[236:239], v[116:119]
s_waitcnt lgkmcnt(0)
v_mfma_f32_16x16x32_bf16 v[104:107], v[240:243], v[172:175], v[104:107]
v_mfma_f32_16x16x32_bf16 v[108:111], v[244:247], v[172:175], v[108:111]
v_mfma_f32_16x16x32_bf16 v[112:115], v[172:175], v[248:251], v[112:115]
v_mfma_f32_16x16x32_bf16 v[116:119], v[172:175], v[252:255], v[116:119]
v_cvt_pk_bf16_f32 v104, v104, v105
v_cvt_pk_bf16_f32 v105, v106, v107
v_cvt_pk_bf16_f32 v106, v108, v109
v_cvt_pk_bf16_f32 v107, v110, v111
ds_write_b128 v155, v[104:107] offset:20480
v_cvt_pk_bf16_f32 v112, v112, v113
v_cvt_pk_bf16_f32 v113, v114, v115
v_cvt_pk_bf16_f32 v114, v116, v117
v_cvt_pk_bf16_f32 v115, v118, v119
ds_write_b128 v155, v[112:115] offset:24576
s_waitcnt vmcnt(20)
v_mfma_f32_16x16x32_bf16 v[136:139], v[40:43], v[24:27], v[4:7]
s_waitcnt vmcnt(19)
v_mfma_f32_16x16x32_bf16 v[140:143], v[44:47], v[24:27], v[8:11]
s_waitcnt vmcnt(17)
v_mfma_f32_16x16x32_bf16 v[136:139], v[48:51], v[28:31], v[136:139]
s_waitcnt vmcnt(16)
v_mfma_f32_16x16x32_bf16 v[140:143], v[52:55], v[28:31], v[140:143]
s_waitcnt lgkmcnt(0)
s_barrier
ds_read_b128 v[104:107], v0 offset:20480
ds_read_b128 v[108:111], v0 offset:21504
ds_read_b128 v[112:115], v0 offset:22528
ds_read_b128 v[116:119], v0 offset:23552
ds_read_b128 v[120:123], v0 offset:24576
ds_read_b128 v[124:127], v0 offset:25600
ds_read_b128 v[128:131], v0 offset:26624
ds_read_b128 v[132:135], v0 offset:27648
s_waitcnt vmcnt(14)
v_mfma_f32_16x16x32_bf16 v[136:139], v[56:59], v[32:35], v[136:139]
s_waitcnt vmcnt(13)
v_mfma_f32_16x16x32_bf16 v[140:143], v[60:63], v[32:35], v[140:143]
s_waitcnt vmcnt(11)
v_mfma_f32_16x16x32_bf16 v[136:139], v[64:67], v[36:39], v[136:139]
s_waitcnt vmcnt(10)
v_mfma_f32_16x16x32_bf16 v[140:143], v[68:71], v[36:39], v[140:143]
s_waitcnt lgkmcnt(7)
v_mfma_f32_16x16x32_bf16 v[144:147], v[104:107], v[24:27], v[156:159]
s_waitcnt lgkmcnt(6)
v_mfma_f32_16x16x32_bf16 v[144:147], v[108:111], v[28:31], v[144:147]
s_waitcnt lgkmcnt(5)
v_mfma_f32_16x16x32_bf16 v[144:147], v[112:115], v[32:35], v[144:147]
s_waitcnt lgkmcnt(4)
v_mfma_f32_16x16x32_bf16 v[144:147], v[116:119], v[36:39], v[144:147]
v_max3_f32 v44, v136, v137, v138
v_max3_f32 v44, v44, v139, v140
v_max3_f32 v44, v44, v141, v142
s_nop 2
v_max3_f32 v44, v44, v143, v144
v_max3_f32 v44, v44, v145, v146
v_max_f32 v44, v44, v147
v_mov_b32 v45, v44
s_nop 1
v_permlane32_swap_b32 v44, v45
v_max_f32 v44, v44, v45
v_mov_b32 v45, v44
s_nop 1
v_permlane16_swap_b32 v44, v45
v_max_f32 v44, v44, v45
v_mul_f32 v44, s58, v44
v_fma_f32 v136, v136, s58, -v44
v_exp_f32 v136, v136
v_fma_f32 v137, v137, s58, -v44
v_exp_f32 v137, v137
v_fma_f32 v138, v138, s58, -v44
v_exp_f32 v138, v138
v_fma_f32 v139, v139, s58, -v44
v_exp_f32 v139, v139
v_fma_f32 v140, v140, s58, -v44
v_exp_f32 v140, v140
v_fma_f32 v141, v141, s58, -v44
v_exp_f32 v141, v141
v_fma_f32 v142, v142, s58, -v44
v_exp_f32 v142, v142
v_fma_f32 v143, v143, s58, -v44
v_exp_f32 v143, v143
v_fma_f32 v144, v144, s58, -v44
v_exp_f32 v144, v144
v_fma_f32 v145, v145, s58, -v44
v_exp_f32 v145, v145
v_fma_f32 v146, v146, s58, -v44
v_exp_f32 v146, v146
v_fma_f32 v147, v147, s58, -v44
v_exp_f32 v147, v147
v_cvt_pk_bf16_f32 v148, v136, v137
v_cvt_pk_bf16_f32 v149, v138, v139
v_cvt_pk_bf16_f32 v150, v140, v141
v_cvt_pk_bf16_f32 v151, v142, v143
v_cvt_pk_bf16_f32 v152, v144, v145
v_cvt_pk_bf16_f32 v153, v146, v147
v_mfma_f32_16x16x32_bf16 v[40:43], v[12:15], v[148:151], 0
s_waitcnt vmcnt(9)
v_mfma_f32_16x16x32_bf16 v[160:163], v[72:75], v[148:151], 0
s_waitcnt vmcnt(8)
v_mfma_f32_16x16x32_bf16 v[164:167], v[76:79], v[148:151], 0
v_mfma_f32_16x16x16_bf16 v[40:43], v[12:13], v[152:153], v[40:43]
s_waitcnt vmcnt(7)
v_mfma_f32_16x16x32_bf16 v[168:171], v[80:83], v[148:151], 0
s_waitcnt vmcnt(6)
v_mfma_f32_16x16x32_bf16 v[172:175], v[84:87], v[148:151], 0
s_waitcnt vmcnt(5)
v_mfma_f32_16x16x32_bf16 v[176:179], v[88:91], v[148:151], 0
s_waitcnt vmcnt(4)
v_mfma_f32_16x16x32_bf16 v[180:183], v[92:95], v[148:151], 0
s_waitcnt vmcnt(3)
v_mfma_f32_16x16x32_bf16 v[184:187], v[96:99], v[148:151], 0
s_waitcnt vmcnt(2)
v_mfma_f32_16x16x32_bf16 v[188:191], v[100:103], v[148:151], 0
v_rcp_f32 v40, v40
s_waitcnt lgkmcnt(3)
v_mfma_f32_16x16x16_bf16 v[160:163], v[120:121], v[152:153], v[160:163]
v_mfma_f32_16x16x16_bf16 v[164:167], v[122:123], v[152:153], v[164:167]
s_waitcnt lgkmcnt(2)
v_mfma_f32_16x16x16_bf16 v[168:171], v[124:125], v[152:153], v[168:171]
v_mfma_f32_16x16x16_bf16 v[172:175], v[126:127], v[152:153], v[172:175]
s_waitcnt lgkmcnt(1)
v_mfma_f32_16x16x16_bf16 v[176:179], v[128:129], v[152:153], v[176:179]
v_mfma_f32_16x16x16_bf16 v[180:183], v[130:131], v[152:153], v[180:183]
s_waitcnt lgkmcnt(0)
v_mfma_f32_16x16x16_bf16 v[184:187], v[132:133], v[152:153], v[184:187]
v_mfma_f32_16x16x16_bf16 v[188:191], v[134:135], v[152:153], v[188:191]
v_mul_f32 v160, v40, v160
v_mul_f32 v161, v40, v161
v_mul_f32 v162, v40, v162
v_mul_f32 v163, v40, v163
v_mul_f32 v164, v40, v164
v_mul_f32 v165, v40, v165
v_mul_f32 v166, v40, v166
v_mul_f32 v167, v40, v167
v_cvt_pk_bf16_f32 v104, v160, v161
v_cvt_pk_bf16_f32 v105, v162, v163
v_cvt_pk_bf16_f32 v106, v164, v165
v_cvt_pk_bf16_f32 v107, v166, v167
buffer_store_dwordx4 v[104:107], v1, s[4:7], s48 offen offset:0 sc1
v_mul_f32 v168, v40, v168
v_mul_f32 v169, v40, v169
v_mul_f32 v170, v40, v170
v_mul_f32 v171, v40, v171
v_mul_f32 v172, v40, v172
v_mul_f32 v173, v40, v173
v_mul_f32 v174, v40, v174
v_mul_f32 v175, v40, v175
v_cvt_pk_bf16_f32 v108, v168, v169
v_cvt_pk_bf16_f32 v109, v170, v171
v_cvt_pk_bf16_f32 v110, v172, v173
v_cvt_pk_bf16_f32 v111, v174, v175
buffer_store_dwordx4 v[108:111], v1, s[4:7], s48 offen offset:128 sc1
v_mul_f32 v176, v40, v176
v_mul_f32 v177, v40, v177
v_mul_f32 v178, v40, v178
v_mul_f32 v179, v40, v179
v_mul_f32 v180, v40, v180
v_mul_f32 v181, v40, v181
v_mul_f32 v182, v40, v182
v_mul_f32 v183, v40, v183
v_cvt_pk_bf16_f32 v112, v176, v177
v_cvt_pk_bf16_f32 v113, v178, v179
v_cvt_pk_bf16_f32 v114, v180, v181
v_cvt_pk_bf16_f32 v115, v182, v183
buffer_store_dwordx4 v[112:115], v1, s[4:7], s48 offen offset:1024 sc1
v_mul_f32 v184, v40, v184
v_mul_f32 v185, v40, v185
v_mul_f32 v186, v40, v186
v_mul_f32 v187, v40, v187
v_mul_f32 v188, v40, v188
v_mul_f32 v189, v40, v189
v_mul_f32 v190, v40, v190
v_mul_f32 v191, v40, v191
v_cvt_pk_bf16_f32 v116, v184, v185
v_cvt_pk_bf16_f32 v117, v186, v187
v_cvt_pk_bf16_f32 v118, v188, v189
v_cvt_pk_bf16_f32 v119, v190, v191
buffer_store_dwordx4 v[116:119], v1, s[4:7], s48 offen offset:1152 sc1
v_mov_b32 v154, s50
s_add_u32 s44, s44, 1048576
s_add_u32 s45, s45, 524288
s_add_u32 s46, s46, 20480
s_add_u32 s48, s48, 524288
s_add_u32 s50, s50, 2
s_sub_u32 s52, s50, 65
s_cmp_lt_u32 s52, 2
s_cbranch_scc0 k_nosw_26
s_add_u32 s44, s44, 8388608
s_add_u32 s48, s48, 1048576
s_add_u32 s46, s46, 393216
k_nosw_26:
s_waitcnt vmcnt(4)
v_min3_u32 v20, v20, v21, v22
v_cmp_le_u32 vcc, s50, v20
s_cbranch_vccnz k_cd_22
s_branch k_top_20
k_out_27:
s_waitcnt vmcnt(0) lgkmcnt(0)
s_barrier
s_add_u32 s30, s30, 80
s_branch k_fin_7
k_p_6:
s_mul_i32 s57, s30, 21846
s_lshr_b32 s57, s57, 16
s_mul_i32 s52, s57, 3
s_sub_u32 s58, s30, s52
s_cmp_eq_u32 s58, 1
s_cselect_b32 s12, s16, s12
s_cselect_b32 s13, s17, s13
s_cmp_eq_u32 s58, 2
s_cselect_b32 s12, s8, s12
s_cselect_b32 s13, s9, s13
v_lshrrev_b32 v1, 8, v0
v_and_b32 v2, 0xf0, v0
v_lshlrev_b32 v3, 5, v1
v_xor_b32 v2, v2, v3
v_lshl_add_u32 v1, v1, 13, v2
s_mul_i32 s52, s3, 1310720
s_lshl_b32 s53, s57, 8
s_add_u32 s52, s52, s53
s_mul_i32 s53, s3, 40960
s_add_u32 m0, s53, 0
s_add_u32 s54, s52, 0
buffer_load_dwordx4 v1, s[12:15], s54 offen lds
s_add_u32 m0, s53, 1024
s_add_u32 s54, s52, 32768
buffer_load_dwordx4 v1, s[12:15], s54 offen lds
s_add_u32 m0, s53, 2048
s_add_u32 s54, s52, 65536
buffer_load_dwordx4 v1, s[12:15], s54 offen lds
s_add_u32 m0, s53, 3072
s_add_u32 s54, s52, 98304
buffer_load_dwordx4 v1, s[12:15], s54 offen lds
s_add_u32 m0, s53, 4096
s_add_u32 s54, s52, 131072
buffer_load_dwordx4 v1, s[12:15], s54 offen lds
s_add_u32 m0, s53, 5120
s_add_u32 s54, s52, 163840
buffer_load_dwordx4 v1, s[12:15], s54 offen lds
s_add_u32 m0, s53, 6144
s_add_u32 s54, s52, 196608
buffer_load_dwordx4 v1, s[12:15], s54 offen lds
s_add_u32 m0, s53, 7168
s_add_u32 s54, s52, 229376
buffer_load_dwordx4 v1, s[12:15], s54 offen lds
s_add_u32 m0, s53, 8192
s_add_u32 s54, s52, 262144
buffer_load_dwordx4 v1, s[12:15], s54 offen lds
s_add_u32 m0, s53, 9216
s_add_u32 s54, s52, 294912
buffer_load_dwordx4 v1, s[12:15], s54 offen lds
s_add_u32 m0, s53, 10240
s_add_u32 s54, s52, 327680
buffer_load_dwordx4 v1, s[12:15], s54 offen lds
s_add_u32 m0, s53, 11264
s_add_u32 s54, s52, 360448
buffer_load_dwordx4 v1, s[12:15], s54 offen lds
s_add_u32 m0, s53, 12288
s_add_u32 s54, s52, 393216
buffer_load_dwordx4 v1, s[12:15], s54 offen lds
s_add_u32 m0, s53, 13312
s_add_u32 s54, s52, 425984
buffer_load_dwordx4 v1, s[12:15], s54 offen lds
s_add_u32 m0, s53, 14336
s_add_u32 s54, s52, 458752
buffer_load_dwordx4 v1, s[12:15], s54 offen lds
s_add_u32 m0, s53, 15360
s_add_u32 s54, s52, 491520
buffer_load_dwordx4 v1, s[12:15], s54 offen lds
s_add_u32 m0, s53, 16384
s_add_u32 s54, s52, 524288
buffer_load_dwordx4 v1, s[12:15], s54 offen lds
s_add_u32 m0, s53, 17408
s_add_u32 s54, s52, 557056
buffer_load_dwordx4 v1, s[12:15], s54 offen lds
s_add_u32 m0, s53, 18432
s_add_u32 s54, s52, 589824
buffer_load_dwordx4 v1, s[12:15], s54 offen lds
s_add_u32 m0, s53, 19456
s_add_u32 s54, s52, 622592
buffer_load_dwordx4 v1, s[12:15], s54 offen lds
s_add_u32 m0, s53, 20480
s_add_u32 s54, s52, 655360
buffer_load_dwordx4 v1, s[12:15], s54 offen lds
s_add_u32 m0, s53, 21504
s_add_u32 s54, s52, 688128
buffer_load_dwordx4 v1, s[12:15], s54 offen lds
s_add_u32 m0, s53, 22528
s_add_u32 s54, s52, 720896
buffer_load_dwordx4 v1, s[12:15], s54 offen lds
s_add_u32 m0, s53, 23552
s_add_u32 s54, s52, 753664
buffer_load_dwordx4 v1, s[12:15], s54 offen lds
s_add_u32 m0, s53, 24576
s_add_u32 s54, s52, 786432
buffer_load_dwordx4 v1, s[12:15], s54 offen lds
s_add_u32 m0, s53, 25600
s_add_u32 s54, s52, 819200
buffer_load_dwordx4 v1, s[12:15], s54 offen lds
s_add_u32 m0, s53, 26624
s_add_u32 s54, s52, 851968
buffer_load_dwordx4 v1, s[12:15], s54 offen lds
s_add_u32 m0, s53, 27648
s_add_u32 s54, s52, 884736
buffer_load_dwordx4 v1, s[12:15], s54 offen lds
s_add_u32 m0, s53, 28672
s_add_u32 s54, s52, 917504
buffer_load_dwordx4 v1, s[12:15], s54 offen lds
s_add_u32 m0, s53, 29696
s_add_u32 s54, s52, 950272
buffer_load_dwordx4 v1, s[12:15], s54 offen lds
s_add_u32 m0, s53, 30720
s_add_u32 s54, s52, 983040
buffer_load_dwordx4 v1, s[12:15], s54 offen lds
s_add_u32 m0, s53, 31744
s_add_u32 s54, s52, 1015808
buffer_load_dwordx4 v1, s[12:15], s54 offen lds
s_add_u32 m0, s53, 32768
s_add_u32 s54, s52, 1048576
buffer_load_dwordx4 v1, s[12:15], s54 offen lds
s_add_u32 m0, s53, 33792
s_add_u32 s54, s52, 1081344
buffer_load_dwordx4 v1, s[12:15], s54 offen lds
s_add_u32 m0, s53, 34816
s_add_u32 s54, s52, 1114112
buffer_load_dwordx4 v1, s[12:15], s54 offen lds
s_add_u32 m0, s53, 35840
s_add_u32 s54, s52, 1146880
buffer_load_dwordx4 v1, s[12:15], s54 offen lds
s_add_u32 m0, s53, 36864
s_add_u32 s54, s52, 1179648
buffer_load_dwordx4 v1, s[12:15], s54 offen lds
s_add_u32 m0, s53, 37888
s_add_u32 s54, s52, 1212416
buffer_load_dwordx4 v1, s[12:15], s54 offen lds
s_add_u32 m0, s53, 38912
s_add_u32 s54, s52, 1245184
buffer_load_dwordx4 v1, s[12:15], s54 offen lds
s_add_u32 m0, s53, 39936
s_add_u32 s54, s52, 1277952
buffer_load_dwordx4 v1, s[12:15], s54 offen lds
v_bfe_u32 v2, v0, 8, 1
v_bfe_u32 v3, v0, 5, 1
s_cmp_eq_u32 s58, 1
s_cselect_b32 s52, 7, 4
s_cselect_b32 s53, 4, 7
v_lshlrev_b32 v2, s52, v2
v_lshlrev_b32 v3, s53, v3
v_add_u32 v2, v2, v3
v_bfe_u32 v3, v0, 4, 1
v_lshl_add_u32 v2, v3, 3, v2
v_bfe_u32 v3, v0, 6, 2
v_xor_b32 v4, s3, v3
v_lshl_add_u32 v2, v4, 5, v2
v_lshl_add_u32 v2, v3, 8, v2
v_lshrrev_b32 v3, 9, v0
v_lshl_add_u32 v2, v3, 11, v2
v_add_u32 v3, 0x10000, v2
v_add_u32 v4, 0x20000, v2
s_waitcnt vmcnt(0)
s_barrier
ds_read_b64_tr_b16 v[96:97], v2 offset:0
ds_read_b64_tr_b16 v[98:99], v2 offset:1024
ds_read_b64_tr_b16 v[100:101], v2 offset:4096
ds_read_b64_tr_b16 v[102:103], v2 offset:5120
ds_read_b64_tr_b16 v[104:105], v2 offset:8192
ds_read_b64_tr_b16 v[106:107], v2 offset:9216
ds_read_b64_tr_b16 v[108:109], v2 offset:12288
ds_read_b64_tr_b16 v[110:111], v2 offset:13312
ds_read_b64_tr_b16 v[112:113], v2 offset:16384
ds_read_b64_tr_b16 v[114:115], v2 offset:17408
ds_read_b64_tr_b16 v[116:117], v2 offset:20480
ds_read_b64_tr_b16 v[118:119], v2 offset:21504
ds_read_b64_tr_b16 v[120:121], v2 offset:24576
ds_read_b64_tr_b16 v[122:123], v2 offset:25600
ds_read_b64_tr_b16 v[124:125], v2 offset:28672
ds_read_b64_tr_b16 v[126:127], v2 offset:29696
ds_read_b64_tr_b16 v[128:129], v2 offset:32768
ds_read_b64_tr_b16 v[130:131], v2 offset:33792
ds_read_b64_tr_b16 v[132:133], v2 offset:36864
ds_read_b64_tr_b16 v[134:135], v2 offset:37888
ds_read_b64_tr_b16 v[136:137], v2 offset:40960
ds_read_b64_tr_b16 v[138:139], v2 offset:41984
ds_read_b64_tr_b16 v[140:141], v2 offset:45056
ds_read_b64_tr_b16 v[142:143], v2 offset:46080
ds_read_b64_tr_b16 v[144:145], v2 offset:49152
ds_read_b64_tr_b16 v[146:147], v2 offset:50176
ds_read_b64_tr_b16 v[148:149], v2 offset:53248
ds_read_b64_tr_b16 v[150:151], v2 offset:54272
ds_read_b64_tr_b16 v[152:153], v2 offset:57344
ds_read_b64_tr_b16 v[154:155], v2 offset:58368
ds_read_b64_tr_b16 v[156:157], v2 offset:61440
ds_read_b64_tr_b16 v[158:159], v2 offset:62464
ds_read_b64_tr_b16 v[160:161], v3 offset:0
ds_read_b64_tr_b16 v[162:163], v3 offset:1024
ds_read_b64_tr_b16 v[164:165], v3 offset:4096
ds_read_b64_tr_b16 v[166:167], v3 offset:5120
ds_read_b64_tr_b16 v[168:169], v3 offset:8192
ds_read_b64_tr_b16 v[170:171], v3 offset:9216
ds_read_b64_tr_b16 v[172:173], v3 offset:12288
ds_read_b64_tr_b16 v[174:175], v3 offset:13312
ds_read_b64_tr_b16 v[176:177], v3 offset:16384
ds_read_b64_tr_b16 v[178:179], v3 offset:17408
ds_read_b64_tr_b16 v[180:181], v3 offset:20480
ds_read_b64_tr_b16 v[182:183], v3 offset:21504
ds_read_b64_tr_b16 v[184:185], v3 offset:24576
ds_read_b64_tr_b16 v[186:187], v3 offset:25600
ds_read_b64_tr_b16 v[188:189], v3 offset:28672
ds_read_b64_tr_b16 v[190:191], v3 offset:29696
ds_read_b64_tr_b16 v[192:193], v3 offset:32768
ds_read_b64_tr_b16 v[194:195], v3 offset:33792
ds_read_b64_tr_b16 v[196:197], v3 offset:36864
ds_read_b64_tr_b16 v[198:199], v3 offset:37888
ds_read_b64_tr_b16 v[200:201], v3 offset:40960
ds_read_b64_tr_b16 v[202:203], v3 offset:41984
ds_read_b64_tr_b16 v[204:205], v3 offset:45056
ds_read_b64_tr_b16 v[206:207], v3 offset:46080
ds_read_b64_tr_b16 v[208:209], v3 offset:49152
ds_read_b64_tr_b16 v[210:211], v3 offset:50176
ds_read_b64_tr_b16 v[212:213], v3 offset:53248
ds_read_b64_tr_b16 v[214:215], v3 offset:54272
ds_read_b64_tr_b16 v[216:217], v3 offset:57344
ds_read_b64_tr_b16 v[218:219], v3 offset:58368
ds_read_b64_tr_b16 v[220:221], v3 offset:61440
ds_read_b64_tr_b16 v[222:223], v3 offset:62464
ds_read_b64_tr_b16 v[224:225], v4 offset:0
ds_read_b64_tr_b16 v[226:227], v4 offset:1024
ds_read_b64_tr_b16 v[228:229], v4 offset:4096
ds_read_b64_tr_b16 v[230:231], v4 offset:5120
ds_read_b64_tr_b16 v[232:233], v4 offset:8192
ds_read_b64_tr_b16 v[234:235], v4 offset:9216
ds_read_b64_tr_b16 v[236:237], v4 offset:12288
ds_read_b64_tr_b16 v[238:239], v4 offset:13312
ds_read_b64_tr_b16 v[240:241], v4 offset:16384
ds_read_b64_tr_b16 v[242:243], v4 offset:17408
ds_read_b64_tr_b16 v[244:245], v4 offset:20480
ds_read_b64_tr_b16 v[246:247], v4 offset:21504
ds_read_b64_tr_b16 v[248:249], v4 offset:24576
ds_read_b64_tr_b16 v[250:251], v4 offset:25600
ds_read_b64_tr_b16 v[252:253], v4 offset:28672
ds_read_b64_tr_b16 v[254:255], v4 offset:29696
s_waitcnt lgkmcnt(0)
s_cmp_lg_u32 s3, 0
s_cbranch_scc1 k_wdd_29
v_mov_b32 v2, 128
k_wd_28:
global_load_dword v3, v2, s[28:29] sc1
s_waitcnt vmcnt(0)
v_readfirstlane_b32 s52, v3
s_cmp_ge_u32 s52, 32
s_cbranch_scc1 k_wdd_29
s_sleep 2
s_sub_u32 s32, s32, 1
s_cmp_gt_i32 s32, 0
s_cbranch_scc1 k_wd_28
k_wdd_29:
s_barrier
v_accvgpr_write_b32 a0, v96
v_accvgpr_write_b32 a1, v97
v_accvgpr_write_b32 a2, v98
v_accvgpr_write_b32 a3, v99
v_accvgpr_write_b32 a4, v100
v_accvgpr_write_b32 a5, v101
v_accvgpr_write_b32 a6, v102
v_accvgpr_write_b32 a7, v103
v_accvgpr_write_b32 a8, v104
v_accvgpr_write_b32 a9, v105
v_accvgpr_write_b32 a10, v106
v_accvgpr_write_b32 a11, v107
v_accvgpr_write_b32 a12, v108
v_accvgpr_write_b32 a13, v109
v_accvgpr_write_b32 a14, v110
v_accvgpr_write_b32 a15, v111
v_accvgpr_write_b32 a16, v112
v_accvgpr_write_b32 a17, v113
v_accvgpr_write_b32 a18, v114
v_accvgpr_write_b32 a19, v115
v_accvgpr_write_b32 a20, v116
v_accvgpr_write_b32 a21, v117
v_accvgpr_write_b32 a22, v118
v_accvgpr_write_b32 a23, v119
v_accvgpr_write_b32 a24, v120
v_accvgpr_write_b32 a25, v121
v_accvgpr_write_b32 a26, v122
v_accvgpr_write_b32 a27, v123
v_accvgpr_write_b32 a28, v124
v_accvgpr_write_b32 a29, v125
v_accvgpr_write_b32 a30, v126
v_accvgpr_write_b32 a31, v127
v_accvgpr_write_b32 a32, v128
v_accvgpr_write_b32 a33, v129
v_accvgpr_write_b32 a34, v130
v_accvgpr_write_b32 a35, v131
v_accvgpr_write_b32 a36, v132
v_accvgpr_write_b32 a37, v133
v_accvgpr_write_b32 a38, v134
v_accvgpr_write_b32 a39, v135
v_accvgpr_write_b32 a40, v136
v_accvgpr_write_b32 a41, v137
v_accvgpr_write_b32 a42, v138
v_accvgpr_write_b32 a43, v139
v_accvgpr_write_b32 a44, v140
v_accvgpr_write_b32 a45, v141
v_accvgpr_write_b32 a46, v142
v_accvgpr_write_b32 a47, v143
v_accvgpr_write_b32 a48, v144
v_accvgpr_write_b32 a49, v145
v_accvgpr_write_b32 a50, v146
v_accvgpr_write_b32 a51, v147
v_accvgpr_write_b32 a52, v148
v_accvgpr_write_b32 a53, v149
v_accvgpr_write_b32 a54, v150
v_accvgpr_write_b32 a55, v151
v_accvgpr_write_b32 a56, v152
v_accvgpr_write_b32 a57, v153
v_accvgpr_write_b32 a58, v154
v_accvgpr_write_b32 a59, v155
v_accvgpr_write_b32 a60, v156
v_accvgpr_write_b32 a61, v157
v_accvgpr_write_b32 a62, v158
v_accvgpr_write_b32 a63, v159
v_accvgpr_write_b32 a64, v160
v_accvgpr_write_b32 a65, v161
v_accvgpr_write_b32 a66, v162
v_accvgpr_write_b32 a67, v163
v_accvgpr_write_b32 a68, v164
v_accvgpr_write_b32 a69, v165
v_accvgpr_write_b32 a70, v166
v_accvgpr_write_b32 a71, v167
v_accvgpr_write_b32 a72, v168
v_accvgpr_write_b32 a73, v169
v_accvgpr_write_b32 a74, v170
v_accvgpr_write_b32 a75, v171
v_accvgpr_write_b32 a76, v172
v_accvgpr_write_b32 a77, v173
v_accvgpr_write_b32 a78, v174
v_accvgpr_write_b32 a79, v175
v_accvgpr_write_b32 a80, v176
v_accvgpr_write_b32 a81, v177
v_accvgpr_write_b32 a82, v178
v_accvgpr_write_b32 a83, v179
v_accvgpr_write_b32 a84, v180
v_accvgpr_write_b32 a85, v181
v_accvgpr_write_b32 a86, v182
v_accvgpr_write_b32 a87, v183
v_accvgpr_write_b32 a88, v184
v_accvgpr_write_b32 a89, v185
v_accvgpr_write_b32 a90, v186
v_accvgpr_write_b32 a91, v187
v_accvgpr_write_b32 a92, v188
v_accvgpr_write_b32 a93, v189
v_accvgpr_write_b32 a94, v190
v_accvgpr_write_b32 a95, v191
v_accvgpr_write_b32 a96, v192
v_accvgpr_write_b32 a97, v193
v_accvgpr_write_b32 a98, v194
v_accvgpr_write_b32 a99, v195
v_accvgpr_write_b32 a100, v196
v_accvgpr_write_b32 a101, v197
v_accvgpr_write_b32 a102, v198
v_accvgpr_write_b32 a103, v199
v_accvgpr_write_b32 a104, v200
v_accvgpr_write_b32 a105, v201
v_accvgpr_write_b32 a106, v202
v_accvgpr_write_b32 a107, v203
v_accvgpr_write_b32 a108, v204
v_accvgpr_write_b32 a109, v205
v_accvgpr_write_b32 a110, v206
v_accvgpr_write_b32 a111, v207
v_accvgpr_write_b32 a112, v208
v_accvgpr_write_b32 a113, v209
v_accvgpr_write_b32 a114, v210
v_accvgpr_write_b32 a115, v211
v_accvgpr_write_b32 a116, v212
v_accvgpr_write_b32 a117, v213
v_accvgpr_write_b32 a118, v214
v_accvgpr_write_b32 a119, v215
v_accvgpr_write_b32 a120, v216
v_accvgpr_write_b32 a121, v217
v_accvgpr_write_b32 a122, v218
v_accvgpr_write_b32 a123, v219
v_accvgpr_write_b32 a124, v220
v_accvgpr_write_b32 a125, v221
v_accvgpr_write_b32 a126, v222
v_accvgpr_write_b32 a127, v223
v_accvgpr_write_b32 a128, v224
v_accvgpr_write_b32 a129, v225
v_accvgpr_write_b32 a130, v226
v_accvgpr_write_b32 a131, v227
v_accvgpr_write_b32 a132, v228
v_accvgpr_write_b32 a133, v229
v_accvgpr_write_b32 a134, v230
v_accvgpr_write_b32 a135, v231
v_accvgpr_write_b32 a136, v232
v_accvgpr_write_b32 a137, v233
v_accvgpr_write_b32 a138, v234
v_accvgpr_write_b32 a139, v235
v_accvgpr_write_b32 a140, v236
v_accvgpr_write_b32 a141, v237
v_accvgpr_write_b32 a142, v238
v_accvgpr_write_b32 a143, v239
v_accvgpr_write_b32 a144, v240
v_accvgpr_write_b32 a145, v241
v_accvgpr_write_b32 a146, v242
v_accvgpr_write_b32 a147, v243
v_accvgpr_write_b32 a148, v244
v_accvgpr_write_b32 a149, v245
v_accvgpr_write_b32 a150, v246
v_accvgpr_write_b32 a151, v247
v_accvgpr_write_b32 a152, v248
v_accvgpr_write_b32 a153, v249
v_accvgpr_write_b32 a154, v250
v_accvgpr_write_b32 a155, v251
v_accvgpr_write_b32 a156, v252
v_accvgpr_write_b32 a157, v253
v_accvgpr_write_b32 a158, v254
v_accvgpr_write_b32 a159, v255
s_cmp_lg_u32 s3, 0
s_cbranch_scc1 k_wdd_31
v_mov_b32 v2, 64
k_wd_30:
global_load_dword v3, v2, s[28:29] sc1
s_waitcnt vmcnt(0)
v_readfirstlane_b32 s52, v3
s_cmp_ge_u32 s52, 80
s_cbranch_scc1 k_wdd_31
s_sleep 2
s_sub_u32 s32, s32, 1
s_cmp_gt_i32 s32, 0
s_cbranch_scc1 k_wd_30
k_wdd_31:
s_barrier
v_bfe_u32 v72, v0, 8, 1
v_and_b32 v1, 0xf0, v0
v_lshl_add_u32 v1, v72, 10, v1
v_and_b32 v2, 0x50, v0
v_lshl_add_u32 v2, v72, 13, v2
v_bfe_u32 v72, v0, 7, 1
v_lshl_add_u32 v2, v72, 5, v2
v_bfe_u32 v72, v0, 5, 1
v_lshl_add_u32 v2, v72, 12, v2
s_cmp_eq_u32 s58, 0
s_cselect_b64 vcc, -1, 0
v_cndmask_b32 v1, v1, v2, vcc
v_lshrrev_b32 v72, 9, v0
v_lshl_add_u32 v1, v72, 8, v1
s_lshl_b32 s52, s3, 10
v_add_u32 v73, s52, v0
v_mov_b32 v2, 2146435072
v_cmp_eq_u32 vcc, 0, v73
s_nop 1
v_cndmask_b32 v2, v2, 0, vcc
v_mov_b32 v3, -1
v_and_b32 v7, 0x1f0, v0
v_lshrrev_b32 v28, 2, v7
v_lshlrev_b32 v7, 1, v7
v_add_u32 v7, 122880, v7
s_lshl_b32 s52, s3, 3
v_lshl_add_u32 v6, v72, 2, v7
v_add_u32 v6, s52, v6
s_lshl_b32 s52, s3, 7
s_add_u32 s52, s52, 124928
v_add_u32 v28, s52, v28
v_lshlrev_b32 v29, 4, v72
v_add_u32 v29, s52, v29
s_mov_b32 s51, 0
s_mov_b32 s50, 0
s_branch k_l0_35
k_lay_32:
s_mov_b32 s54, 222306304
s_waitcnt vmcnt(0) lgkmcnt(0)
s_cmp_lg_u32 s3, 0
s_cbranch_scc1 k_w8d_37
v_lshlrev_b32 v8, 2, v0
k_w8_36:
buffer_load_dword v9, v8, s[4:7], s54 offen sc1
buffer_load_dword v10, v8, s[4:7], s54 offen offset:1024 sc1
s_waitcnt vmcnt(0)
v_and_b32 v9, v9, v10
v_cmp_eq_u32 vcc, 0, v9
s_cbranch_vccz k_w8d_37
s_sleep 1
s_sub_u32 s32, s32, 1
s_cmp_gt_i32 s32, 0
s_cbranch_scc1 k_w8_36
k_w8d_37:
s_barrier
k_l0_35:
s_mul_i32 s52, s3, 10240
v_add_u32 v5, s52, v0
s_mul_i32 s46, s51, 114294784
s_add_u32 s46, s46, s52
s_add_u32 s46, s46, 83886080
s_lshl_b32 s52, s57, 2
s_add_u32 s52, s52, s3
s_cmp_eq_u32 s58, 2
s_cselect_b32 s53, 11, 12
s_mov_b32 s49, 524288
s_cmov_b32 s49, 262144
s_lshl_b32 s48, s52, s53
s_lshr_b32 s52, s3, 1
s_mul_i32 s52, s52, 768
s_mul_i32 s53, s3, 3968
s_sub_u32 s52, s53, s52
s_cmp_eq_u32 s58, 0
s_cselect_b32 s52, s52, 0
s_sub_u32 s48, s48, s52
s_cmp_eq_u32 s58, 2
s_mov_b32 s52, 41943040
s_cmov_b32 s52, 16777216
s_cselect_b32 s53, 125829120, 0
s_mul_i32 s52, s52, s51
s_add_u32 s48, s48, s52
s_add_u32 s48, s48, s53
s_lshl_b32 s60, s57, 6
s_lshl_b32 s52, s58, 2
s_add_u32 s60, s60, s52
s_add_u32 s60, s60, 222330880
s_mov_b32 s61, 0x3acccccd
s_cmp_eq_u32 s58, 1
s_cbranch_scc1 k_isv_33
s_mul_i32 s45, s3, 10240
s_mov_b32 s44, 0
v_mov_b32 v64, v0
s_add_u32 m0, s45, 0
s_add_u32 s55, s46, 0
buffer_load_dwordx4 v0, s[4:7], s55 offen offset:0 sc1 lds
buffer_load_dwordx4 v0, s[4:7], s55 offen offset:1024 sc1 lds
buffer_load_dwordx4 v0, s[4:7], s55 offen offset:2048 sc1 lds
buffer_load_dwordx4 v0, s[4:7], s55 offen offset:3072 sc1 lds
s_add_u32 m0, s45, 4096
s_add_u32 s55, s46, 4096
buffer_load_dwordx4 v0, s[4:7], s55 offen offset:0 sc1 lds
buffer_load_dwordx4 v0, s[4:7], s55 offen offset:1024 sc1 lds
buffer_load_dwordx4 v0, s[4:7], s55 offen offset:2048 sc1 lds
buffer_load_dwordx4 v0, s[4:7], s55 offen offset:3072 sc1 lds
s_add_u32 m0, s45, 8192
s_add_u32 s55, s46, 8192
buffer_load_dwordx4 v0, s[4:7], s55 offen offset:0 sc1 lds
buffer_load_dwordx4 v0, s[4:7], s55 offen offset:1024 sc1 lds
s_add_u32 s45, s45, 40960
s_cmp_ge_u32 s45, 122880
s_cselect_b32 s55, 122880, 0
s_sub_u32 s45, s45, s55
s_add_u32 s46, s46, 40960
s_add_u32 m0, s45, 0
s_add_u32 s55, s46, 0
buffer_load_dwordx4 v0, s[4:7], s55 offen offset:0 sc1 lds
buffer_load_dwordx4 v0, s[4:7], s55 offen offset:1024 sc1 lds
buffer_load_dwordx4 v0, s[4:7], s55 offen offset:2048 sc1 lds
buffer_load_dwordx4 v0, s[4:7], s55 offen offset:3072 sc1 lds
s_add_u32 m0, s45, 4096
s_add_u32 s55, s46, 4096
buffer_load_dwordx4 v0, s[4:7], s55 offen offset:0 sc1 lds
buffer_load_dwordx4 v0, s[4:7], s55 offen offset:1024 sc1 lds
buffer_load_dwordx4 v0, s[4:7], s55 offen offset:2048 sc1 lds
buffer_load_dwordx4 v0, s[4:7], s55 offen offset:3072 sc1 lds
s_add_u32 m0, s45, 8192
s_add_u32 s55, s46, 8192
buffer_load_dwordx4 v0, s[4:7], s55 offen offset:0 sc1 lds
buffer_load_dwordx4 v0, s[4:7], s55 offen offset:1024 sc1 lds
s_add_u32 s45, s45, 40960
s_cmp_ge_u32 s45, 122880
s_cselect_b32 s55, 122880, 0
s_sub_u32 s45, s45, s55
s_add_u32 s46, s46, 40960
s_waitcnt vmcnt(10)
s_barrier
ds_read_b128 v[8:11], v64 offset:0
ds_read_b128 v[12:15], v64 offset:1024
ds_read_b128 v[16:19], v64 offset:2048
ds_read_b128 v[20:23], v64 offset:3072
s_mov_b32 s59, 32
s_waitcnt lgkmcnt(3)
v_mfma_f32_32x32x16_bf16 v[32:47], a[0:3], v[8:11], 0
s_waitcnt lgkmcnt(2)
ds_read_b128 v[24:27], v64 offset:4096
v_mfma_f32_32x32x16_bf16 v[32:47], a[4:7], v[12:15], v[32:47]
s_waitcnt lgkmcnt(2)
ds_read_b128 v[8:11], v64 offset:5120
ds_read_b128 v[72:75], v5
v_mov_b32 v4, 0
ds_read_b128 v[76:79], v5 offset:1024
v_mfma_f32_32x32x16_bf16 v[32:47], a[8:11], v[16:19], v[32:47]
s_waitcnt lgkmcnt(4)
ds_read_b128 v[12:15], v64 offset:6144
s_waitcnt lgkmcnt(2)
v_and_b32 v72, v3, v72
v_dot2c_f32_bf16 v4, v72, v72
v_dot2c_f32_bf16 v4, v73, v73
v_dot2c_f32_bf16 v4, v74, v74
v_dot2c_f32_bf16 v4, v75, v75
v_mfma_f32_32x32x16_bf16 v[32:47], a[12:15], v[20:23], v[32:47]
ds_read_b128 v[16:19], v64 offset:7168
ds_read_b128 v[72:75], v5 offset:2048
s_waitcnt lgkmcnt(3)
v_dot2c_f32_bf16 v4, v76, v76
v_dot2c_f32_bf16 v4, v77, v77
v_dot2c_f32_bf16 v4, v78, v78
v_dot2c_f32_bf16 v4, v79, v79
v_mfma_f32_32x32x16_bf16 v[32:47], a[16:19], v[24:27], v[32:47]
ds_read_b128 v[20:23], v64 offset:8192
ds_read_b128 v[76:79], v5 offset:3072
s_waitcnt lgkmcnt(2)
v_dot2c_f32_bf16 v4, v72, v72
v_dot2c_f32_bf16 v4, v73, v73
v_dot2c_f32_bf16 v4, v74, v74
v_dot2c_f32_bf16 v4, v75, v75
v_mfma_f32_32x32x16_bf16 v[32:47], a[20:23], v[8:11], v[32:47]
ds_read_b128 v[24:27], v64 offset:9216
ds_read_b128 v[72:75], v5 offset:4096
s_waitcnt lgkmcnt(2)
v_dot2c_f32_bf16 v4, v76, v76
v_dot2c_f32_bf16 v4, v77, v77
v_dot2c_f32_bf16 v4, v78, v78
v_dot2c_f32_bf16 v4, v79, v79
v_mfma_f32_32x32x16_bf16 v[32:47], a[24:27], v[12:15], v[32:47]
ds_read_b128 v[8:11], v64 offset:10240
ds_read_b128 v[76:79], v5 offset:5120
s_waitcnt lgkmcnt(2)
v_dot2c_f32_bf16 v4, v72, v72
v_dot2c_f32_bf16 v4, v73, v73
v_dot2c_f32_bf16 v4, v74, v74
v_dot2c_f32_bf16 v4, v75, v75
v_mfma_f32_32x32x16_bf16 v[32:47], a[28:31], v[16:19], v[32:47]
ds_read_b128 v[12:15], v64 offset:11264
ds_read_b128 v[72:75], v5 offset:6144
s_waitcnt lgkmcnt(2)
v_dot2c_f32_bf16 v4, v76, v76
v_dot2c_f32_bf16 v4, v77, v77
v_dot2c_f32_bf16 v4, v78, v78
v_dot2c_f32_bf16 v4, v79, v79
v_mfma_f32_32x32x16_bf16 v[32:47], a[32:35], v[20:23], v[32:47]
ds_read_b128 v[16:19], v64 offset:12288
ds_read_b128 v[76:79], v5 offset:7168
s_waitcnt lgkmcnt(2)
v_dot2c_f32_bf16 v4, v72, v72
v_dot2c_f32_bf16 v4, v73, v73
v_dot2c_f32_bf16 v4, v74, v74
v_dot2c_f32_bf16 v4, v75, v75
v_mfma_f32_32x32x16_bf16 v[32:47], a[36:39], v[24:27], v[32:47]
ds_read_b128 v[20:23], v64 offset:13312
ds_read_b128 v[72:75], v5 offset:8192
s_waitcnt lgkmcnt(2)
v_dot2c_f32_bf16 v4, v76, v76
v_dot2c_f32_bf16 v4, v77, v77
v_dot2c_f32_bf16 v4, v78, v78
v_dot2c_f32_bf16 v4, v79, v79
v_mfma_f32_32x32x16_bf16 v[32:47], a[40:43], v[8:11], v[32:47]
ds_read_b128 v[24:27], v64 offset:14336
ds_read_b128 v[76:79], v5 offset:9216
s_waitcnt lgkmcnt(2)
v_dot2c_f32_bf16 v4, v72, v72
v_dot2c_f32_bf16 v4, v73, v73
v_dot2c_f32_bf16 v4, v74, v74
v_dot2c_f32_bf16 v4, v75, v75
v_mfma_f32_32x32x16_bf16 v[32:47], a[44:47], v[12:15], v[32:47]
ds_read_b128 v[8:11], v64 offset:15360
s_waitcnt lgkmcnt(1)
v_dot2c_f32_bf16 v4, v76, v76
v_dot2c_f32_bf16 v4, v77, v77
v_dot2c_f32_bf16 v4, v78, v78
v_dot2c_f32_bf16 v4, v79, v79
s_nop 2
ds_write_b32 v6, v4 offset:0
v_mfma_f32_32x32x16_bf16 v[32:47], a[48:51], v[16:19], v[32:47]
ds_read_b128 v[12:15], v64 offset:16384
s_add_u32 m0, s45, 0
s_add_u32 s55, s46, 0
buffer_load_dwordx4 v0, s[4:7], s55 offen offset:0 sc1 lds
buffer_load_dwordx4 v0, s[4:7], s55 offen offset:1024 sc1 lds
v_mfma_f32_32x32x16_bf16 v[32:47], a[52:55], v[20:23], v[32:47]
ds_read_b128 v[16:19], v64 offset:17408
buffer_load_dwordx4 v0, s[4:7], s55 offen offset:2048 sc1 lds
buffer_load_dwordx4 v0, s[4:7], s55 offen offset:3072 sc1 lds
v_mfma_f32_32x32x16_bf16 v[32:47], a[56:59], v[24:27], v[32:47]
s_waitcnt lgkmcnt(3)
ds_read_b128 v[20:23], v64 offset:18432
s_add_u32 m0, s45, 4096
s_add_u32 s55, s46, 4096
buffer_load_dwordx4 v0, s[4:7], s55 offen offset:0 sc1 lds
buffer_load_dwordx4 v0, s[4:7], s55 offen offset:1024 sc1 lds
v_mfma_f32_32x32x16_bf16 v[32:47], a[60:63], v[8:11], v[32:47]
s_waitcnt lgkmcnt(2)
ds_read_b128 v[24:27], v64 offset:19456
buffer_load_dwordx4 v0, s[4:7], s55 offen offset:2048 sc1 lds
buffer_load_dwordx4 v0, s[4:7], s55 offen offset:3072 sc1 lds
v_mfma_f32_32x32x16_bf16 v[32:47], a[64:67], v[12:15], v[32:47]
s_waitcnt lgkmcnt(2)
ds_read_b128 v[8:11], v64 offset:20480
s_add_u32 m0, s45, 8192
s_add_u32 s55, s46, 8192
buffer_load_dwordx4 v0, s[4:7], s55 offen offset:0 sc1 lds
buffer_load_dwordx4 v0, s[4:7], s55 offen offset:1024 sc1 lds
v_mfma_f32_32x32x16_bf16 v[32:47], a[68:71], v[16:19], v[32:47]
s_waitcnt lgkmcnt(2)
ds_read_b128 v[12:15], v64 offset:21504
s_add_u32 s45, s45, 40960
s_cmp_ge_u32 s45, 122880
s_cselect_b32 s55, 122880, 0
s_sub_u32 s45, s45, s55
s_add_u32 s46, s46, 40960
v_mfma_f32_32x32x16_bf16 v[32:47], a[72:75], v[20:23], v[32:47]
s_waitcnt lgkmcnt(2)
ds_read_b128 v[16:19], v64 offset:22528
v_mfma_f32_32x32x16_bf16 v[32:47], a[76:79], v[24:27], v[32:47]
s_waitcnt lgkmcnt(2)
ds_read_b128 v[20:23], v64 offset:23552
v_mfma_f32_32x32x16_bf16 v[32:47], a[80:83], v[8:11], v[32:47]
s_waitcnt lgkmcnt(2)
ds_read_b128 v[24:27], v64 offset:24576
v_mfma_f32_32x32x16_bf16 v[32:47], a[84:87], v[12:15], v[32:47]
s_waitcnt lgkmcnt(2)
ds_read_b128 v[8:11], v64 offset:25600
v_mfma_f32_32x32x16_bf16 v[32:47], a[88:91], v[16:19], v[32:47]
s_waitcnt lgkmcnt(2)
ds_read_b128 v[12:15], v64 offset:26624
v_mfma_f32_32x32x16_bf16 v[32:47], a[92:95], v[20:23], v[32:47]
s_waitcnt lgkmcnt(2)
ds_read_b128 v[16:19], v64 offset:27648
v_mfma_f32_32x32x16_bf16 v[32:47], a[96:99], v[24:27], v[32:47]
s_waitcnt lgkmcnt(2)
ds_read_b128 v[20:23], v64 offset:28672
v_mfma_f32_32x32x16_bf16 v[32:47], a[100:103], v[8:11], v[32:47]
s_waitcnt lgkmcnt(2)
ds_read_b128 v[24:27], v64 offset:29696
v_mfma_f32_32x32x16_bf16 v[32:47], a[104:107], v[12:15], v[32:47]
s_waitcnt lgkmcnt(2)
ds_read_b128 v[8:11], v64 offset:30720
v_mfma_f32_32x32x16_bf16 v[32:47], a[108:111], v[16:19], v[32:47]
s_waitcnt lgkmcnt(2)
ds_read_b128 v[12:15], v64 offset:31744
v_mfma_f32_32x32x16_bf16 v[32:47], a[112:115], v[20:23], v[32:47]
s_waitcnt lgkmcnt(2)
ds_read_b128 v[16:19], v64 offset:32768
v_mfma_f32_32x32x16_bf16 v[32:47], a[116:119], v[24:27], v[32:47]
s_waitcnt lgkmcnt(2)
ds_read_b128 v[20:23], v64 offset:33792
v_mfma_f32_32x32x16_bf16 v[32:47], a[120:123], v[8:11], v[32:47]
s_waitcnt lgkmcnt(2)
ds_read_b128 v[24:27], v64 offset:34816
v_mfma_f32_32x32x16_bf16 v[32:47], a[124:127], v[12:15], v[32:47]
s_waitcnt lgkmcnt(2)
ds_read_b128 v[8:11], v64 offset:35840
v_mfma_f32_32x32x16_bf16 v[32:47], a[128:131], v[16:19], v[32:47]
s_waitcnt lgkmcnt(2)
ds_read_b128 v[12:15], v64 offset:36864
v_mfma_f32_32x32x16_bf16 v[32:47], a[132:135], v[20:23], v[32:47]
s_waitcnt lgkmcnt(2)
ds_read_b128 v[16:19], v64 offset:37888
v_mfma_f32_32x32x16_bf16 v[32:47], a[136:139], v[24:27], v[32:47]
s_waitcnt lgkmcnt(2)
ds_read_b128 v[20:23], v64 offset:38912
v_mfma_f32_32x32x16_bf16 v[32:47], a[140:143], v[8:11], v[32:47]
s_waitcnt lgkmcnt(2)
ds_read_b128 v[24:27], v64 offset:39936
v_mfma_f32_32x32x16_bf16 v[32:47], a[144:147], v[12:15], v[32:47]
s_add_u32 s44, s44, 1
s_cmp_eq_u32 s44, 3
s_mov_b32 s56, 40960
s_cmov_b32 s56, -81920
s_cselect_b32 s44, 0, s44
v_add_u32 v64, s56, v64
v_add_u32 v5, s56, v5
s_waitcnt vmcnt(10) lgkmcnt(2)
s_barrier
ds_read_b128 v[8:11], v64 offset:0
v_mfma_f32_32x32x16_bf16 v[32:47], a[148:151], v[16:19], v[32:47]
s_waitcnt lgkmcnt(2)
ds_read_b128 v[12:15], v64 offset:1024
v_mfma_f32_32x32x16_bf16 v[32:47], a[152:155], v[20:23], v[32:47]
s_waitcnt lgkmcnt(2)
ds_read_b128 v[16:19], v64 offset:2048
v_mfma_f32_32x32x16_bf16 v[32:47], a[156:159], v[24:27], v[32:47]
s_waitcnt lgkmcnt(2)
ds_read_b128 v[20:23], v64 offset:3072
ds_read_b128 v[80:83], v7 offset:0
ds_read_b128 v[84:87], v7 offset:16
v_mov_b32 v88, 0x3727c5ac
s_waitcnt lgkmcnt(0)
v_add_f32 v80, v80, v84
v_add_f32 v81, v81, v85
v_add_f32 v82, v82, v86
v_add_f32 v83, v83, v87
v_add_f32 v80, v80, v81
v_add_f32 v82, v82, v83
v_add_f32 v80, v80, v82
v_fma_f32 v80, v80, s61, v88
v_rsq_f32 v80, v80
s_nop 0
v_mul_f32 v32, v80, v32
v_mul_f32 v33, v80, v33
v_cvt_pk_bf16_f32 v32, v32, v33
v_mul_f32 v34, v80, v34
v_mul_f32 v35, v80, v35
v_cvt_pk_bf16_f32 v33, v34, v35
v_mul_f32 v36, v80, v36
v_mul_f32 v37, v80, v37
v_cvt_pk_bf16_f32 v34, v36, v37
v_mul_f32 v38, v80, v38
v_mul_f32 v39, v80, v39
v_cvt_pk_bf16_f32 v35, v38, v39
v_mul_f32 v40, v80, v40
v_mul_f32 v41, v80, v41
v_cvt_pk_bf16_f32 v36, v40, v41
v_mul_f32 v42, v80, v42
v_mul_f32 v43, v80, v43
v_cvt_pk_bf16_f32 v37, v42, v43
v_mul_f32 v44, v80, v44
v_mul_f32 v45, v80, v45
v_cvt_pk_bf16_f32 v38, v44, v45
v_mul_f32 v46, v80, v46
v_mul_f32 v47, v80, v47
v_cvt_pk_bf16_f32 v39, v46, v47
buffer_store_dwordx4 v[32:35], v1, s[4:7], s48 offen offset:0 sc1
buffer_store_dwordx4 v[36:39], v1, s[4:7], s48 offen offset:512 sc1
s_add_u32 s48, s48, s49
s_waitcnt vmcnt(0)
s_barrier
s_add_u32 s50, s50, 1
v_mov_b32 v4, s50
buffer_store_dword v4, v2, s[4:7], s60 offen sc1
v_mfma_f32_32x32x16_bf16 v[48:63], a[0:3], v[8:11], 0
ds_read_b128 v[24:27], v64 offset:4096
v_mfma_f32_32x32x16_bf16 v[48:63], a[4:7], v[12:15], v[48:63]
ds_read_b128 v[8:11], v64 offset:5120
ds_read_b128 v[72:75], v5
v_mov_b32 v4, 0
ds_read_b128 v[76:79], v5 offset:1024
v_mfma_f32_32x32x16_bf16 v[48:63], a[8:11], v[16:19], v[48:63]
ds_read_b128 v[12:15], v64 offset:6144
s_waitcnt lgkmcnt(2)
v_and_b32 v72, v3, v72
v_dot2c_f32_bf16 v4, v72, v72
v_dot2c_f32_bf16 v4, v73, v73
v_dot2c_f32_bf16 v4, v74, v74
v_dot2c_f32_bf16 v4, v75, v75
v_mfma_f32_32x32x16_bf16 v[48:63], a[12:15], v[20:23], v[48:63]
ds_read_b128 v[16:19], v64 offset:7168
ds_read_b128 v[72:75], v5 offset:2048
s_waitcnt lgkmcnt(3)
v_dot2c_f32_bf16 v4, v76, v76
v_dot2c_f32_bf16 v4, v77, v77
v_dot2c_f32_bf16 v4, v78, v78
v_dot2c_f32_bf16 v4, v79, v79
v_mfma_f32_32x32x16_bf16 v[48:63], a[16:19], v[24:27], v[48:63]
ds_read_b128 v[20:23], v64 offset:8192
ds_read_b128 v[76:79], v5 offset:3072
s_waitcnt lgkmcnt(2)
v_dot2c_f32_bf16 v4, v72, v72
v_dot2c_f32_bf16 v4, v73, v73
v_dot2c_f32_bf16 v4, v74, v74
v_dot2c_f32_bf16 v4, v75, v75
v_mfma_f32_32x32x16_bf16 v[48:63], a[20:23], v[8:11], v[48:63]
ds_read_b128 v[24:27], v64 offset:9216
ds_read_b128 v[72:75], v5 offset:4096
s_waitcnt lgkmcnt(2)
v_dot2c_f32_bf16 v4, v76, v76
v_dot2c_f32_bf16 v4, v77, v77
v_dot2c_f32_bf16 v4, v78, v78
v_dot2c_f32_bf16 v4, v79, v79
v_mfma_f32_32x32x16_bf16 v[48:63], a[24:27], v[12:15], v[48:63]
ds_read_b128 v[8:11], v64 offset:10240
ds_read_b128 v[76:79], v5 offset:5120
s_waitcnt lgkmcnt(2)
v_dot2c_f32_bf16 v4, v72, v72
v_dot2c_f32_bf16 v4, v73, v73
v_dot2c_f32_bf16 v4, v74, v74
v_dot2c_f32_bf16 v4, v75, v75
v_mfma_f32_32x32x16_bf16 v[48:63], a[28:31], v[16:19], v[48:63]
ds_read_b128 v[12:15], v64 offset:11264
ds_read_b128 v[72:75], v5 offset:6144
s_waitcnt lgkmcnt(2)
v_dot2c_f32_bf16 v4, v76, v76
v_dot2c_f32_bf16 v4, v77, v77
v_dot2c_f32_bf16 v4, v78, v78
v_dot2c_f32_bf16 v4, v79, v79
v_mfma_f32_32x32x16_bf16 v[48:63], a[32:35], v[20:23], v[48:63]
ds_read_b128 v[16:19], v64 offset:12288
ds_read_b128 v[76:79], v5 offset:7168
s_waitcnt lgkmcnt(2)
v_dot2c_f32_bf16 v4, v72, v72
v_dot2c_f32_bf16 v4, v73, v73
v_dot2c_f32_bf16 v4, v74, v74
v_dot2c_f32_bf16 v4, v75, v75
v_mfma_f32_32x32x16_bf16 v[48:63], a[36:39], v[24:27], v[48:63]
ds_read_b128 v[20:23], v64 offset:13312
ds_read_b128 v[72:75], v5 offset:8192
s_waitcnt lgkmcnt(2)
v_dot2c_f32_bf16 v4, v76, v76
v_dot2c_f32_bf16 v4, v77, v77
v_dot2c_f32_bf16 v4, v78, v78
v_dot2c_f32_bf16 v4, v79, v79
v_mfma_f32_32x32x16_bf16 v[48:63], a[40:43], v[8:11], v[48:63]
ds_read_b128 v[24:27], v64 offset:14336
ds_read_b128 v[76:79], v5 offset:9216
s_waitcnt lgkmcnt(2)
v_dot2c_f32_bf16 v4, v72, v72
v_dot2c_f32_bf16 v4, v73, v73
v_dot2c_f32_bf16 v4, v74, v74
v_dot2c_f32_bf16 v4, v75, v75
v_mfma_f32_32x32x16_bf16 v[48:63], a[44:47], v[12:15], v[48:63]
ds_read_b128 v[8:11], v64 offset:15360
s_waitcnt lgkmcnt(1)
v_dot2c_f32_bf16 v4, v76, v76
v_dot2c_f32_bf16 v4, v77, v77
v_dot2c_f32_bf16 v4, v78, v78
v_dot2c_f32_bf16 v4, v79, v79
s_nop 2
ds_write_b32 v6, v4 offset:1024
v_mfma_f32_32x32x16_bf16 v[48:63], a[48:51], v[16:19], v[48:63]
ds_read_b128 v[12:15], v64 offset:16384
s_add_u32 m0, s45, 0
s_add_u32 s55, s46, 0
buffer_load_dwordx4 v0, s[4:7], s55 offen offset:0 sc1 lds
buffer_load_dwordx4 v0, s[4:7], s55 offen offset:1024 sc1 lds
v_mfma_f32_32x32x16_bf16 v[48:63], a[52:55], v[20:23], v[48:63]
ds_read_b128 v[16:19], v64 offset:17408
buffer_load_dwordx4 v0, s[4:7], s55 offen offset:2048 sc1 lds
buffer_load_dwordx4 v0, s[4:7], s55 offen offset:3072 sc1 lds
v_mfma_f32_32x32x16_bf16 v[48:63], a[56:59], v[24:27], v[48:63]
s_waitcnt lgkmcnt(3)
ds_read_b128 v[20:23], v64 offset:18432
s_add_u32 m0, s45, 4096
s_add_u32 s55, s46, 4096
buffer_load_dwordx4 v0, s[4:7], s55 offen offset:0 sc1 lds
buffer_load_dwordx4 v0, s[4:7], s55 offen offset:1024 sc1 lds
v_mfma_f32_32x32x16_bf16 v[48:63], a[60:63], v[8:11], v[48:63]
s_waitcnt lgkmcnt(2)
ds_read_b128 v[24:27], v64 offset:19456
buffer_load_dwordx4 v0, s[4:7], s55 offen offset:2048 sc1 lds
buffer_load_dwordx4 v0, s[4:7], s55 offen offset:3072 sc1 lds
v_mfma_f32_32x32x16_bf16 v[48:63], a[64:67], v[12:15], v[48:63]
s_waitcnt lgkmcnt(2)
ds_read_b128 v[8:11], v64 offset:20480
s_add_u32 m0, s45, 8192
s_add_u32 s55, s46, 8192
buffer_load_dwordx4 v0, s[4:7], s55 offen offset:0 sc1 lds
buffer_load_dwordx4 v0, s[4:7], s55 offen offset:1024 sc1 lds
v_mfma_f32_32x32x16_bf16 v[48:63], a[68:71], v[16:19], v[48:63]
s_waitcnt lgkmcnt(2)
ds_read_b128 v[12:15], v64 offset:21504
s_add_u32 s45, s45, 40960
s_cmp_ge_u32 s45, 122880
s_cselect_b32 s55, 122880, 0
s_sub_u32 s45, s45, s55
s_add_u32 s46, s46, 40960
v_mfma_f32_32x32x16_bf16 v[48:63], a[72:75], v[20:23], v[48:63]
s_waitcnt lgkmcnt(2)
ds_read_b128 v[16:19], v64 offset:22528
v_mfma_f32_32x32x16_bf16 v[48:63], a[76:79], v[24:27], v[48:63]
s_waitcnt lgkmcnt(2)
ds_read_b128 v[20:23], v64 offset:23552
v_mfma_f32_32x32x16_bf16 v[48:63], a[80:83], v[8:11], v[48:63]
s_waitcnt lgkmcnt(2)
ds_read_b128 v[24:27], v64 offset:24576
v_mfma_f32_32x32x16_bf16 v[48:63], a[84:87], v[12:15], v[48:63]
s_waitcnt lgkmcnt(2)
ds_read_b128 v[8:11], v64 offset:25600
v_mfma_f32_32x32x16_bf16 v[48:63], a[88:91], v[16:19], v[48:63]
s_waitcnt lgkmcnt(2)
ds_read_b128 v[12:15], v64 offset:26624
v_mfma_f32_32x32x16_bf16 v[48:63], a[92:95], v[20:23], v[48:63]
s_waitcnt lgkmcnt(2)
ds_read_b128 v[16:19], v64 offset:27648
v_mfma_f32_32x32x16_bf16 v[48:63], a[96:99], v[24:27], v[48:63]
s_waitcnt lgkmcnt(2)
ds_read_b128 v[20:23], v64 offset:28672
v_mfma_f32_32x32x16_bf16 v[48:63], a[100:103], v[8:11], v[48:63]
s_waitcnt lgkmcnt(2)
ds_read_b128 v[24:27], v64 offset:29696
v_mfma_f32_32x32x16_bf16 v[48:63], a[104:107], v[12:15], v[48:63]
s_waitcnt lgkmcnt(2)
ds_read_b128 v[8:11], v64 offset:30720
v_mfma_f32_32x32x16_bf16 v[48:63], a[108:111], v[16:19], v[48:63]
s_waitcnt lgkmcnt(2)
ds_read_b128 v[12:15], v64 offset:31744
v_mfma_f32_32x32x16_bf16 v[48:63], a[112:115], v[20:23], v[48:63]
s_waitcnt lgkmcnt(2)
ds_read_b128 v[16:19], v64 offset:32768
v_mfma_f32_32x32x16_bf16 v[48:63], a[116:119], v[24:27], v[48:63]
s_waitcnt lgkmcnt(2)
ds_read_b128 v[20:23], v64 offset:33792
v_mfma_f32_32x32x16_bf16 v[48:63], a[120:123], v[8:11], v[48:63]
s_waitcnt lgkmcnt(2)
ds_read_b128 v[24:27], v64 offset:34816
v_mfma_f32_32x32x16_bf16 v[48:63], a[124:127], v[12:15], v[48:63]
s_waitcnt lgkmcnt(2)
ds_read_b128 v[8:11], v64 offset:35840
v_mfma_f32_32x32x16_bf16 v[48:63], a[128:131], v[16:19], v[48:63]
s_waitcnt lgkmcnt(2)
ds_read_b128 v[12:15], v64 offset:36864
v_mfma_f32_32x32x16_bf16 v[48:63], a[132:135], v[20:23], v[48:63]
s_waitcnt lgkmcnt(2)
ds_read_b128 v[16:19], v64 offset:37888
v_mfma_f32_32x32x16_bf16 v[48:63], a[136:139], v[24:27], v[48:63]
s_waitcnt lgkmcnt(2)
ds_read_b128 v[20:23], v64 offset:38912
v_mfma_f32_32x32x16_bf16 v[48:63], a[140:143], v[8:11], v[48:63]
s_waitcnt lgkmcnt(2)
ds_read_b128 v[24:27], v64 offset:39936
v_mfma_f32_32x32x16_bf16 v[48:63], a[144:147], v[12:15], v[48:63]
s_add_u32 s44, s44, 1
s_cmp_eq_u32 s44, 3
s_mov_b32 s56, 40960
s_cmov_b32 s56, -81920
s_cselect_b32 s44, 0, s44
v_add_u32 v64, s56, v64
v_add_u32 v5, s56, v5
s_waitcnt vmcnt(10) lgkmcnt(2)
s_barrier
ds_read_b128 v[8:11], v64 offset:0
v_mfma_f32_32x32x16_bf16 v[48:63], a[148:151], v[16:19], v[48:63]
s_waitcnt lgkmcnt(2)
ds_read_b128 v[12:15], v64 offset:1024
v_mfma_f32_32x32x16_bf16 v[48:63], a[152:155], v[20:23], v[48:63]
s_waitcnt lgkmcnt(2)
ds_read_b128 v[16:19], v64 offset:2048
v_mfma_f32_32x32x16_bf16 v[48:63], a[156:159], v[24:27], v[48:63]
s_waitcnt lgkmcnt(2)
ds_read_b128 v[20:23], v64 offset:3072
s_branch k_sm_40
k_st_38:
v_mfma_f32_32x32x16_bf16 v[48:63], a[0:3], v[8:11], 0
s_waitcnt lgkmcnt(2)
ds_read_b128 v[24:27], v64 offset:4096
v_mfma_f32_32x32x16_bf16 v[48:63], a[4:7], v[12:15], v[48:63]
s_waitcnt lgkmcnt(2)
ds_read_b128 v[8:11], v64 offset:5120
ds_read_b128 v[80:83], v7 offset:0
ds_read_b128 v[84:87], v7 offset:16
v_mov_b32 v88, 0x3727c5ac
v_mfma_f32_32x32x16_bf16 v[48:63], a[8:11], v[16:19], v[48:63]
s_waitcnt lgkmcnt(4)
ds_read_b128 v[12:15], v64 offset:6144
s_waitcnt lgkmcnt(1)
v_add_f32 v80, v80, v84
v_add_f32 v81, v81, v85
v_add_f32 v82, v82, v86
v_add_f32 v83, v83, v87
v_add_f32 v80, v80, v81
v_add_f32 v82, v82, v83
v_add_f32 v80, v80, v82
v_mfma_f32_32x32x16_bf16 v[48:63], a[12:15], v[20:23], v[48:63]
ds_read_b128 v[16:19], v64 offset:7168
v_fma_f32 v80, v80, s61, v88
v_rsq_f32 v80, v80
s_nop 0
v_mul_f32 v32, v80, v32
v_mul_f32 v33, v80, v33
v_cvt_pk_bf16_f32 v32, v32, v33
v_mfma_f32_32x32x16_bf16 v[48:63], a[16:19], v[24:27], v[48:63]
ds_read_b128 v[20:23], v64 offset:8192
v_mul_f32 v34, v80, v34
v_mul_f32 v35, v80, v35
v_cvt_pk_bf16_f32 v33, v34, v35
v_mul_f32 v36, v80, v36
v_mul_f32 v37, v80, v37
v_cvt_pk_bf16_f32 v34, v36, v37
v_mfma_f32_32x32x16_bf16 v[48:63], a[20:23], v[8:11], v[48:63]
s_waitcnt lgkmcnt(2)
ds_read_b128 v[24:27], v64 offset:9216
v_mul_f32 v38, v80, v38
v_mul_f32 v39, v80, v39
v_cvt_pk_bf16_f32 v35, v38, v39
v_mul_f32 v40, v80, v40
v_mul_f32 v41, v80, v41
v_cvt_pk_bf16_f32 v36, v40, v41
v_mfma_f32_32x32x16_bf16 v[48:63], a[24:27], v[12:15], v[48:63]
s_waitcnt lgkmcnt(2)
ds_read_b128 v[8:11], v64 offset:10240
v_mul_f32 v42, v80, v42
v_mul_f32 v43, v80, v43
v_cvt_pk_bf16_f32 v37, v42, v43
v_mul_f32 v44, v80, v44
v_mul_f32 v45, v80, v45
v_cvt_pk_bf16_f32 v38, v44, v45
v_mfma_f32_32x32x16_bf16 v[48:63], a[28:31], v[16:19], v[48:63]
s_waitcnt lgkmcnt(2)
ds_read_b128 v[12:15], v64 offset:11264
v_mul_f32 v46, v80, v46
v_mul_f32 v47, v80, v47
v_cvt_pk_bf16_f32 v39, v46, v47
buffer_store_dwordx4 v[32:35], v1, s[4:7], s48 offen offset:0 sc1
v_mfma_f32_32x32x16_bf16 v[48:63], a[32:35], v[20:23], v[48:63]
s_waitcnt lgkmcnt(2)
ds_read_b128 v[16:19], v64 offset:12288
buffer_store_dwordx4 v[36:39], v1, s[4:7], s48 offen offset:512 sc1
s_add_u32 s48, s48, s49
v_mfma_f32_32x32x16_bf16 v[48:63], a[36:39], v[24:27], v[48:63]
s_waitcnt lgkmcnt(2)
ds_read_b128 v[20:23], v64 offset:13312
ds_read_b128 v[72:75], v5
v_mov_b32 v4, 0
ds_read_b128 v[76:79], v5 offset:1024
v_mfma_f32_32x32x16_bf16 v[48:63], a[40:43], v[8:11], v[48:63]
s_waitcnt lgkmcnt(4)
ds_read_b128 v[24:27], v64 offset:14336
s_waitcnt lgkmcnt(2)
v_and_b32 v72, v3, v72
v_dot2c_f32_bf16 v4, v72, v72
v_dot2c_f32_bf16 v4, v73, v73
v_dot2c_f32_bf16 v4, v74, v74
v_dot2c_f32_bf16 v4, v75, v75
v_mfma_f32_32x32x16_bf16 v[48:63], a[44:47], v[12:15], v[48:63]
ds_read_b128 v[8:11], v64 offset:15360
ds_read_b128 v[72:75], v5 offset:2048
s_waitcnt lgkmcnt(3)
v_dot2c_f32_bf16 v4, v76, v76
v_dot2c_f32_bf16 v4, v77, v77
v_dot2c_f32_bf16 v4, v78, v78
v_dot2c_f32_bf16 v4, v79, v79
v_mfma_f32_32x32x16_bf16 v[48:63], a[48:51], v[16:19], v[48:63]
ds_read_b128 v[12:15], v64 offset:16384
ds_read_b128 v[76:79], v5 offset:3072
s_waitcnt lgkmcnt(2)
v_dot2c_f32_bf16 v4, v72, v72
v_dot2c_f32_bf16 v4, v73, v73
v_dot2c_f32_bf16 v4, v74, v74
v_dot2c_f32_bf16 v4, v75, v75
v_mfma_f32_32x32x16_bf16 v[48:63], a[52:55], v[20:23], v[48:63]
ds_read_b128 v[16:19], v64 offset:17408
ds_read_b128 v[72:75], v5 offset:4096
s_waitcnt lgkmcnt(2)
v_dot2c_f32_bf16 v4, v76, v76
v_dot2c_f32_bf16 v4, v77, v77
v_dot2c_f32_bf16 v4, v78, v78
v_dot2c_f32_bf16 v4, v79, v79
v_mfma_f32_32x32x16_bf16 v[48:63], a[56:59], v[24:27], v[48:63]
ds_read_b128 v[20:23], v64 offset:18432
ds_read_b128 v[76:79], v5 offset:5120
s_waitcnt lgkmcnt(2)
v_dot2c_f32_bf16 v4, v72, v72
v_dot2c_f32_bf16 v4, v73, v73
v_dot2c_f32_bf16 v4, v74, v74
v_dot2c_f32_bf16 v4, v75, v75
v_mfma_f32_32x32x16_bf16 v[48:63], a[60:63], v[8:11], v[48:63]
ds_read_b128 v[24:27], v64 offset:19456
ds_read_b128 v[72:75], v5 offset:6144
s_waitcnt lgkmcnt(2)
v_dot2c_f32_bf16 v4, v76, v76
v_dot2c_f32_bf16 v4, v77, v77
v_dot2c_f32_bf16 v4, v78, v78
v_dot2c_f32_bf16 v4, v79, v79
v_mfma_f32_32x32x16_bf16 v[48:63], a[64:67], v[12:15], v[48:63]
ds_read_b128 v[8:11], v64 offset:20480
ds_read_b128 v[76:79], v5 offset:7168
s_waitcnt lgkmcnt(2)
v_dot2c_f32_bf16 v4, v72, v72
v_dot2c_f32_bf16 v4, v73, v73
v_dot2c_f32_bf16 v4, v74, v74
v_dot2c_f32_bf16 v4, v75, v75
v_mfma_f32_32x32x16_bf16 v[48:63], a[68:71], v[16:19], v[48:63]
ds_read_b128 v[12:15], v64 offset:21504
ds_read_b128 v[72:75], v5 offset:8192
s_waitcnt lgkmcnt(2)
v_dot2c_f32_bf16 v4, v76, v76
v_dot2c_f32_bf16 v4, v77, v77
v_dot2c_f32_bf16 v4, v78, v78
v_dot2c_f32_bf16 v4, v79, v79
v_mfma_f32_32x32x16_bf16 v[48:63], a[72:75], v[20:23], v[48:63]
ds_read_b128 v[16:19], v64 offset:22528
ds_read_b128 v[76:79], v5 offset:9216
s_waitcnt lgkmcnt(2)
v_dot2c_f32_bf16 v4, v72, v72
v_dot2c_f32_bf16 v4, v73, v73
v_dot2c_f32_bf16 v4, v74, v74
v_dot2c_f32_bf16 v4, v75, v75
v_mfma_f32_32x32x16_bf16 v[48:63], a[76:79], v[24:27], v[48:63]
ds_read_b128 v[20:23], v64 offset:23552
s_waitcnt lgkmcnt(1)
v_dot2c_f32_bf16 v4, v76, v76
v_dot2c_f32_bf16 v4, v77, v77
v_dot2c_f32_bf16 v4, v78, v78
v_dot2c_f32_bf16 v4, v79, v79
s_nop 2
ds_write_b32 v6, v4 offset:1024
v_mfma_f32_32x32x16_bf16 v[48:63], a[80:83], v[8:11], v[48:63]
ds_read_b128 v[24:27], v64 offset:24576
s_add_u32 m0, s45, 0
s_add_u32 s55, s46, 0
buffer_load_dwordx4 v0, s[4:7], s55 offen offset:0 sc1 lds
buffer_load_dwordx4 v0, s[4:7], s55 offen offset:1024 sc1 lds
v_mfma_f32_32x32x16_bf16 v[48:63], a[84:87], v[12:15], v[48:63]
ds_read_b128 v[8:11], v64 offset:25600
buffer_load_dwordx4 v0, s[4:7], s55 offen offset:2048 sc1 lds
buffer_load_dwordx4 v0, s[4:7], s55 offen offset:3072 sc1 lds
v_mfma_f32_32x32x16_bf16 v[48:63], a[88:91], v[16:19], v[48:63]
s_waitcnt lgkmcnt(3)
ds_read_b128 v[12:15], v64 offset:26624
s_add_u32 m0, s45, 4096
s_add_u32 s55, s46, 4096
buffer_load_dwordx4 v0, s[4:7], s55 offen offset:0 sc1 lds
buffer_load_dwordx4 v0, s[4:7], s55 offen offset:1024 sc1 lds
v_mfma_f32_32x32x16_bf16 v[48:63], a[92:95], v[20:23], v[48:63]
s_waitcnt lgkmcnt(2)
ds_read_b128 v[16:19], v64 offset:27648
buffer_load_dwordx4 v0, s[4:7], s55 offen offset:2048 sc1 lds
buffer_load_dwordx4 v0, s[4:7], s55 offen offset:3072 sc1 lds
v_mfma_f32_32x32x16_bf16 v[48:63], a[96:99], v[24:27], v[48:63]
s_waitcnt lgkmcnt(2)
ds_read_b128 v[20:23], v64 offset:28672
s_add_u32 m0, s45, 8192
s_add_u32 s55, s46, 8192
buffer_load_dwordx4 v0, s[4:7], s55 offen offset:0 sc1 lds
buffer_load_dwordx4 v0, s[4:7], s55 offen offset:1024 sc1 lds
v_mfma_f32_32x32x16_bf16 v[48:63], a[100:103], v[8:11], v[48:63]
s_waitcnt lgkmcnt(2)
ds_read_b128 v[24:27], v64 offset:29696
s_add_u32 s45, s45, 40960
s_cmp_ge_u32 s45, 122880
s_cselect_b32 s55, 122880, 0
s_sub_u32 s45, s45, s55
s_add_u32 s46, s46, 40960
v_mfma_f32_32x32x16_bf16 v[48:63], a[104:107], v[12:15], v[48:63]
s_waitcnt lgkmcnt(2)
ds_read_b128 v[8:11], v64 offset:30720
v_mfma_f32_32x32x16_bf16 v[48:63], a[108:111], v[16:19], v[48:63]
s_waitcnt lgkmcnt(2)
ds_read_b128 v[12:15], v64 offset:31744
v_mfma_f32_32x32x16_bf16 v[48:63], a[112:115], v[20:23], v[48:63]
s_waitcnt lgkmcnt(2)
ds_read_b128 v[16:19], v64 offset:32768
v_mfma_f32_32x32x16_bf16 v[48:63], a[116:119], v[24:27], v[48:63]
s_waitcnt lgkmcnt(2)
ds_read_b128 v[20:23], v64 offset:33792
v_mfma_f32_32x32x16_bf16 v[48:63], a[120:123], v[8:11], v[48:63]
s_waitcnt lgkmcnt(2)
ds_read_b128 v[24:27], v64 offset:34816
v_mfma_f32_32x32x16_bf16 v[48:63], a[124:127], v[12:15], v[48:63]
s_waitcnt lgkmcnt(2)
ds_read_b128 v[8:11], v64 offset:35840
v_mfma_f32_32x32x16_bf16 v[48:63], a[128:131], v[16:19], v[48:63]
s_waitcnt lgkmcnt(2)
ds_read_b128 v[12:15], v64 offset:36864
v_mfma_f32_32x32x16_bf16 v[48:63], a[132:135], v[20:23], v[48:63]
s_waitcnt lgkmcnt(2)
ds_read_b128 v[16:19], v64 offset:37888
v_mfma_f32_32x32x16_bf16 v[48:63], a[136:139], v[24:27], v[48:63]
s_waitcnt lgkmcnt(2)
ds_read_b128 v[20:23], v64 offset:38912
v_mfma_f32_32x32x16_bf16 v[48:63], a[140:143], v[8:11], v[48:63]
s_waitcnt lgkmcnt(2)
ds_read_b128 v[24:27], v64 offset:39936
v_mfma_f32_32x32x16_bf16 v[48:63], a[144:147], v[12:15], v[48:63]
s_add_u32 s44, s44, 1
s_cmp_eq_u32 s44, 3
s_mov_b32 s56, 40960
s_cmov_b32 s56, -81920
s_cselect_b32 s44, 0, s44
v_add_u32 v64, s56, v64
v_add_u32 v5, s56, v5
s_waitcnt vmcnt(10) lgkmcnt(2)
s_barrier
s_add_u32 s50, s50, 1
v_mov_b32 v4, s50
buffer_store_dword v4, v2, s[4:7], s60 offen sc1
ds_read_b128 v[8:11], v64 offset:0
v_mfma_f32_32x32x16_bf16 v[48:63], a[148:151], v[16:19], v[48:63]
s_waitcnt lgkmcnt(2)
ds_read_b128 v[12:15], v64 offset:1024
v_mfma_f32_32x32x16_bf16 v[48:63], a[152:155], v[20:23], v[48:63]
s_waitcnt lgkmcnt(2)
ds_read_b128 v[16:19], v64 offset:2048
v_mfma_f32_32x32x16_bf16 v[48:63], a[156:159], v[24:27], v[48:63]
s_waitcnt lgkmcnt(2)
ds_read_b128 v[20:23], v64 offset:3072
k_sm_40:
s_sub_u32 s59, s59, 1
s_cmp_eq_u32 s59, 0
s_cbranch_scc1 k_so_39
v_mfma_f32_32x32x16_bf16 v[32:47], a[0:3], v[8:11], 0
s_waitcnt lgkmcnt(2)
ds_read_b128 v[24:27], v64 offset:4096
v_mfma_f32_32x32x16_bf16 v[32:47], a[4:7], v[12:15], v[32:47]
s_waitcnt lgkmcnt(2)
ds_read_b128 v[8:11], v64 offset:5120
ds_read_b128 v[80:83], v7 offset:1024
ds_read_b128 v[84:87], v7 offset:1040
v_mov_b32 v88, 0x3727c5ac
v_mfma_f32_32x32x16_bf16 v[32:47], a[8:11], v[16:19], v[32:47]
s_waitcnt lgkmcnt(4)
ds_read_b128 v[12:15], v64 offset:6144
s_waitcnt lgkmcnt(1)
v_add_f32 v80, v80, v84
v_add_f32 v81, v81, v85
v_add_f32 v82, v82, v86
v_add_f32 v83, v83, v87
v_add_f32 v80, v80, v81
v_add_f32 v82, v82, v83
v_add_f32 v80, v80, v82
v_mfma_f32_32x32x16_bf16 v[32:47], a[12:15], v[20:23], v[32:47]
ds_read_b128 v[16:19], v64 offset:7168
v_fma_f32 v80, v80, s61, v88
v_rsq_f32 v80, v80
s_nop 0
v_mul_f32 v48, v80, v48
v_mul_f32 v49, v80, v49
v_cvt_pk_bf16_f32 v48, v48, v49
v_mfma_f32_32x32x16_bf16 v[32:47], a[16:19], v[24:27], v[32:47]
ds_read_b128 v[20:23], v64 offset:8192
v_mul_f32 v50, v80, v50
v_mul_f32 v51, v80, v51
v_cvt_pk_bf16_f32 v49, v50, v51
v_mul_f32 v52, v80, v52
v_mul_f32 v53, v80, v53
v_cvt_pk_bf16_f32 v50, v52, v53
v_mfma_f32_32x32x16_bf16 v[32:47], a[20:23], v[8:11], v[32:47]
s_waitcnt lgkmcnt(2)
ds_read_b128 v[24:27], v64 offset:9216
v_mul_f32 v54, v80, v54
v_mul_f32 v55, v80, v55
v_cvt_pk_bf16_f32 v51, v54, v55
v_mul_f32 v56, v80, v56
v_mul_f32 v57, v80, v57
v_cvt_pk_bf16_f32 v52, v56, v57
v_mfma_f32_32x32x16_bf16 v[32:47], a[24:27], v[12:15], v[32:47]
s_waitcnt lgkmcnt(2)
ds_read_b128 v[8:11], v64 offset:10240
v_mul_f32 v58, v80, v58
v_mul_f32 v59, v80, v59
v_cvt_pk_bf16_f32 v53, v58, v59
v_mul_f32 v60, v80, v60
v_mul_f32 v61, v80, v61
v_cvt_pk_bf16_f32 v54, v60, v61
v_mfma_f32_32x32x16_bf16 v[32:47], a[28:31], v[16:19], v[32:47]
s_waitcnt lgkmcnt(2)
ds_read_b128 v[12:15], v64 offset:11264
v_mul_f32 v62, v80, v62
v_mul_f32 v63, v80, v63
v_cvt_pk_bf16_f32 v55, v62, v63
buffer_store_dwordx4 v[48:51], v1, s[4:7], s48 offen offset:0 sc1
v_mfma_f32_32x32x16_bf16 v[32:47], a[32:35], v[20:23], v[32:47]
s_waitcnt lgkmcnt(2)
ds_read_b128 v[16:19], v64 offset:12288
buffer_store_dwordx4 v[52:55], v1, s[4:7], s48 offen offset:512 sc1
s_add_u32 s48, s48, s49
v_mfma_f32_32x32x16_bf16 v[32:47], a[36:39], v[24:27], v[32:47]
s_waitcnt lgkmcnt(2)
ds_read_b128 v[20:23], v64 offset:13312
ds_read_b128 v[72:75], v5
v_mov_b32 v4, 0
ds_read_b128 v[76:79], v5 offset:1024
v_mfma_f32_32x32x16_bf16 v[32:47], a[40:43], v[8:11], v[32:47]
s_waitcnt lgkmcnt(4)
ds_read_b128 v[24:27], v64 offset:14336
s_waitcnt lgkmcnt(2)
v_and_b32 v72, v3, v72
v_dot2c_f32_bf16 v4, v72, v72
v_dot2c_f32_bf16 v4, v73, v73
v_dot2c_f32_bf16 v4, v74, v74
v_dot2c_f32_bf16 v4, v75, v75
v_mfma_f32_32x32x16_bf16 v[32:47], a[44:47], v[12:15], v[32:47]
ds_read_b128 v[8:11], v64 offset:15360
ds_read_b128 v[72:75], v5 offset:2048
s_waitcnt lgkmcnt(3)
v_dot2c_f32_bf16 v4, v76, v76
v_dot2c_f32_bf16 v4, v77, v77
v_dot2c_f32_bf16 v4, v78, v78
v_dot2c_f32_bf16 v4, v79, v79
v_mfma_f32_32x32x16_bf16 v[32:47], a[48:51], v[16:19], v[32:47]
ds_read_b128 v[12:15], v64 offset:16384
ds_read_b128 v[76:79], v5 offset:3072
s_waitcnt lgkmcnt(2)
v_dot2c_f32_bf16 v4, v72, v72
v_dot2c_f32_bf16 v4, v73, v73
v_dot2c_f32_bf16 v4, v74, v74
v_dot2c_f32_bf16 v4, v75, v75
v_mfma_f32_32x32x16_bf16 v[32:47], a[52:55], v[20:23], v[32:47]
ds_read_b128 v[16:19], v64 offset:17408
ds_read_b128 v[72:75], v5 offset:4096
s_waitcnt lgkmcnt(2)
v_dot2c_f32_bf16 v4, v76, v76
v_dot2c_f32_bf16 v4, v77, v77
v_dot2c_f32_bf16 v4, v78, v78
v_dot2c_f32_bf16 v4, v79, v79
v_mfma_f32_32x32x16_bf16 v[32:47], a[56:59], v[24:27], v[32:47]
ds_read_b128 v[20:23], v64 offset:18432
ds_read_b128 v[76:79], v5 offset:5120
s_waitcnt lgkmcnt(2)
v_dot2c_f32_bf16 v4, v72, v72
v_dot2c_f32_bf16 v4, v73, v73
v_dot2c_f32_bf16 v4, v74, v74
v_dot2c_f32_bf16 v4, v75, v75
v_mfma_f32_32x32x16_bf16 v[32:47], a[60:63], v[8:11], v[32:47]
ds_read_b128 v[24:27], v64 offset:19456
ds_read_b128 v[72:75], v5 offset:6144
s_waitcnt lgkmcnt(2)
v_dot2c_f32_bf16 v4, v76, v76
v_dot2c_f32_bf16 v4, v77, v77
v_dot2c_f32_bf16 v4, v78, v78
v_dot2c_f32_bf16 v4, v79, v79
v_mfma_f32_32x32x16_bf16 v[32:47], a[64:67], v[12:15], v[32:47]
ds_read_b128 v[8:11], v64 offset:20480
ds_read_b128 v[76:79], v5 offset:7168
s_waitcnt lgkmcnt(2)
v_dot2c_f32_bf16 v4, v72, v72
v_dot2c_f32_bf16 v4, v73, v73
v_dot2c_f32_bf16 v4, v74, v74
v_dot2c_f32_bf16 v4, v75, v75
v_mfma_f32_32x32x16_bf16 v[32:47], a[68:71], v[16:19], v[32:47]
ds_read_b128 v[12:15], v64 offset:21504
ds_read_b128 v[72:75], v5 offset:8192
s_waitcnt lgkmcnt(2)
v_dot2c_f32_bf16 v4, v76, v76
v_dot2c_f32_bf16 v4, v77, v77
v_dot2c_f32_bf16 v4, v78, v78
v_dot2c_f32_bf16 v4, v79, v79
v_mfma_f32_32x32x16_bf16 v[32:47], a[72:75], v[20:23], v[32:47]
ds_read_b128 v[16:19], v64 offset:22528
ds_read_b128 v[76:79], v5 offset:9216
s_waitcnt lgkmcnt(2)
v_dot2c_f32_bf16 v4, v72, v72
v_dot2c_f32_bf16 v4, v73, v73
v_dot2c_f32_bf16 v4, v74, v74
v_dot2c_f32_bf16 v4, v75, v75
v_mfma_f32_32x32x16_bf16 v[32:47], a[76:79], v[24:27], v[32:47]
ds_read_b128 v[20:23], v64 offset:23552
s_waitcnt lgkmcnt(1)
v_dot2c_f32_bf16 v4, v76, v76
v_dot2c_f32_bf16 v4, v77, v77
v_dot2c_f32_bf16 v4, v78, v78
v_dot2c_f32_bf16 v4, v79, v79
s_nop 2
ds_write_b32 v6, v4 offset:0
v_mfma_f32_32x32x16_bf16 v[32:47], a[80:83], v[8:11], v[32:47]
ds_read_b128 v[24:27], v64 offset:24576
s_add_u32 m0, s45, 0
s_add_u32 s55, s46, 0
buffer_load_dwordx4 v0, s[4:7], s55 offen offset:0 sc1 lds
buffer_load_dwordx4 v0, s[4:7], s55 offen offset:1024 sc1 lds
v_mfma_f32_32x32x16_bf16 v[32:47], a[84:87], v[12:15], v[32:47]
ds_read_b128 v[8:11], v64 offset:25600
buffer_load_dwordx4 v0, s[4:7], s55 offen offset:2048 sc1 lds
buffer_load_dwordx4 v0, s[4:7], s55 offen offset:3072 sc1 lds
v_mfma_f32_32x32x16_bf16 v[32:47], a[88:91], v[16:19], v[32:47]
s_waitcnt lgkmcnt(3)
ds_read_b128 v[12:15], v64 offset:26624
s_add_u32 m0, s45, 4096
s_add_u32 s55, s46, 4096
buffer_load_dwordx4 v0, s[4:7], s55 offen offset:0 sc1 lds
buffer_load_dwordx4 v0, s[4:7], s55 offen offset:1024 sc1 lds
v_mfma_f32_32x32x16_bf16 v[32:47], a[92:95], v[20:23], v[32:47]
s_waitcnt lgkmcnt(2)
ds_read_b128 v[16:19], v64 offset:27648
buffer_load_dwordx4 v0, s[4:7], s55 offen offset:2048 sc1 lds
buffer_load_dwordx4 v0, s[4:7], s55 offen offset:3072 sc1 lds
v_mfma_f32_32x32x16_bf16 v[32:47], a[96:99], v[24:27], v[32:47]
s_waitcnt lgkmcnt(2)
ds_read_b128 v[20:23], v64 offset:28672
s_add_u32 m0, s45, 8192
s_add_u32 s55, s46, 8192
buffer_load_dwordx4 v0, s[4:7], s55 offen offset:0 sc1 lds
buffer_load_dwordx4 v0, s[4:7], s55 offen offset:1024 sc1 lds
v_mfma_f32_32x32x16_bf16 v[32:47], a[100:103], v[8:11], v[32:47]
s_waitcnt lgkmcnt(2)
ds_read_b128 v[24:27], v64 offset:29696
s_add_u32 s45, s45, 40960
s_cmp_ge_u32 s45, 122880
s_cselect_b32 s55, 122880, 0
s_sub_u32 s45, s45, s55
s_add_u32 s46, s46, 40960
v_mfma_f32_32x32x16_bf16 v[32:47], a[104:107], v[12:15], v[32:47]
s_waitcnt lgkmcnt(2)
ds_read_b128 v[8:11], v64 offset:30720
v_mfma_f32_32x32x16_bf16 v[32:47], a[108:111], v[16:19], v[32:47]
s_waitcnt lgkmcnt(2)
ds_read_b128 v[12:15], v64 offset:31744
v_mfma_f32_32x32x16_bf16 v[32:47], a[112:115], v[20:23], v[32:47]
s_waitcnt lgkmcnt(2)
ds_read_b128 v[16:19], v64 offset:32768
v_mfma_f32_32x32x16_bf16 v[32:47], a[116:119], v[24:27], v[32:47]
s_waitcnt lgkmcnt(2)
ds_read_b128 v[20:23], v64 offset:33792
v_mfma_f32_32x32x16_bf16 v[32:47], a[120:123], v[8:11], v[32:47]
s_waitcnt lgkmcnt(2)
ds_read_b128 v[24:27], v64 offset:34816
v_mfma_f32_32x32x16_bf16 v[32:47], a[124:127], v[12:15], v[32:47]
s_waitcnt lgkmcnt(2)
ds_read_b128 v[8:11], v64 offset:35840
v_mfma_f32_32x32x16_bf16 v[32:47], a[128:131], v[16:19], v[32:47]
s_waitcnt lgkmcnt(2)
ds_read_b128 v[12:15], v64 offset:36864
v_mfma_f32_32x32x16_bf16 v[32:47], a[132:135], v[20:23], v[32:47]
s_waitcnt lgkmcnt(2)
ds_read_b128 v[16:19], v64 offset:37888
v_mfma_f32_32x32x16_bf16 v[32:47], a[136:139], v[24:27], v[32:47]
s_waitcnt lgkmcnt(2)
ds_read_b128 v[20:23], v64 offset:38912
v_mfma_f32_32x32x16_bf16 v[32:47], a[140:143], v[8:11], v[32:47]
s_waitcnt lgkmcnt(2)
ds_read_b128 v[24:27], v64 offset:39936
v_mfma_f32_32x32x16_bf16 v[32:47], a[144:147], v[12:15], v[32:47]
s_add_u32 s44, s44, 1
s_cmp_eq_u32 s44, 3
s_mov_b32 s56, 40960
s_cmov_b32 s56, -81920
s_cselect_b32 s44, 0, s44
v_add_u32 v64, s56, v64
v_add_u32 v5, s56, v5
s_waitcnt vmcnt(10) lgkmcnt(2)
s_barrier
s_add_u32 s50, s50, 1
v_mov_b32 v4, s50
buffer_store_dword v4, v2, s[4:7], s60 offen sc1
ds_read_b128 v[8:11], v64 offset:0
v_mfma_f32_32x32x16_bf16 v[32:47], a[148:151], v[16:19], v[32:47]
s_waitcnt lgkmcnt(2)
ds_read_b128 v[12:15], v64 offset:1024
v_mfma_f32_32x32x16_bf16 v[32:47], a[152:155], v[20:23], v[32:47]
s_waitcnt lgkmcnt(2)
ds_read_b128 v[16:19], v64 offset:2048
v_mfma_f32_32x32x16_bf16 v[32:47], a[156:159], v[24:27], v[32:47]
s_waitcnt lgkmcnt(2)
ds_read_b128 v[20:23], v64 offset:3072
s_branch k_st_38
k_so_39:
ds_read_b128 v[80:83], v7 offset:1024
ds_read_b128 v[84:87], v7 offset:1040
v_mov_b32 v88, 0x3727c5ac
s_waitcnt lgkmcnt(0)
v_add_f32 v80, v80, v84
v_add_f32 v81, v81, v85
v_add_f32 v82, v82, v86
v_add_f32 v83, v83, v87
v_add_f32 v80, v80, v81
v_add_f32 v82, v82, v83
v_add_f32 v80, v80, v82
v_fma_f32 v80, v80, s61, v88
v_rsq_f32 v80, v80
s_nop 0
v_mul_f32 v48, v80, v48
v_mul_f32 v49, v80, v49
v_cvt_pk_bf16_f32 v48, v48, v49
v_mul_f32 v50, v80, v50
v_mul_f32 v51, v80, v51
v_cvt_pk_bf16_f32 v49, v50, v51
v_mul_f32 v52, v80, v52
v_mul_f32 v53, v80, v53
v_cvt_pk_bf16_f32 v50, v52, v53
v_mul_f32 v54, v80, v54
v_mul_f32 v55, v80, v55
v_cvt_pk_bf16_f32 v51, v54, v55
v_mul_f32 v56, v80, v56
v_mul_f32 v57, v80, v57
v_cvt_pk_bf16_f32 v52, v56, v57
v_mul_f32 v58, v80, v58
v_mul_f32 v59, v80, v59
v_cvt_pk_bf16_f32 v53, v58, v59
v_mul_f32 v60, v80, v60
v_mul_f32 v61, v80, v61
v_cvt_pk_bf16_f32 v54, v60, v61
v_mul_f32 v62, v80, v62
v_mul_f32 v63, v80, v63
v_cvt_pk_bf16_f32 v55, v62, v63
buffer_store_dwordx4 v[48:51], v1, s[4:7], s48 offen offset:0 sc1
buffer_store_dwordx4 v[52:55], v1, s[4:7], s48 offen offset:512 sc1
s_add_u32 s48, s48, s49
s_branch k_join_34
k_isv_33:
s_mul_i32 s45, s3, 10240
s_mov_b32 s44, 0
v_mov_b32 v64, v0
s_add_u32 m0, s45, 0
s_add_u32 s55, s46, 0
buffer_load_dwordx4 v0, s[4:7], s55 offen offset:0 sc1 lds
buffer_load_dwordx4 v0, s[4:7], s55 offen offset:1024 sc1 lds
buffer_load_dwordx4 v0, s[4:7], s55 offen offset:2048 sc1 lds
buffer_load_dwordx4 v0, s[4:7], s55 offen offset:3072 sc1 lds
s_add_u32 m0, s45, 4096
s_add_u32 s55, s46, 4096
buffer_load_dwordx4 v0, s[4:7], s55 offen offset:0 sc1 lds
buffer_load_dwordx4 v0, s[4:7], s55 offen offset:1024 sc1 lds
buffer_load_dwordx4 v0, s[4:7], s55 offen offset:2048 sc1 lds
buffer_load_dwordx4 v0, s[4:7], s55 offen offset:3072 sc1 lds
s_add_u32 m0, s45, 8192
s_add_u32 s55, s46, 8192
buffer_load_dwordx4 v0, s[4:7], s55 offen offset:0 sc1 lds
buffer_load_dwordx4 v0, s[4:7], s55 offen offset:1024 sc1 lds
s_add_u32 s45, s45, 40960
s_cmp_ge_u32 s45, 122880
s_cselect_b32 s55, 122880, 0
s_sub_u32 s45, s45, s55
s_add_u32 s46, s46, 40960
s_add_u32 m0, s45, 0
s_add_u32 s55, s46, 0
buffer_load_dwordx4 v0, s[4:7], s55 offen offset:0 sc1 lds
buffer_load_dwordx4 v0, s[4:7], s55 offen offset:1024 sc1 lds
buffer_load_dwordx4 v0, s[4:7], s55 offen offset:2048 sc1 lds
buffer_load_dwordx4 v0, s[4:7], s55 offen offset:3072 sc1 lds
s_add_u32 m0, s45, 4096
s_add_u32 s55, s46, 4096
buffer_load_dwordx4 v0, s[4:7], s55 offen offset:0 sc1 lds
buffer_load_dwordx4 v0, s[4:7], s55 offen offset:1024 sc1 lds
buffer_load_dwordx4 v0, s[4:7], s55 offen offset:2048 sc1 lds
buffer_load_dwordx4 v0, s[4:7], s55 offen offset:3072 sc1 lds
s_add_u32 m0, s45, 8192
s_add_u32 s55, s46, 8192
buffer_load_dwordx4 v0, s[4:7], s55 offen offset:0 sc1 lds
buffer_load_dwordx4 v0, s[4:7], s55 offen offset:1024 sc1 lds
s_add_u32 s45, s45, 40960
s_cmp_ge_u32 s45, 122880
s_cselect_b32 s55, 122880, 0
s_sub_u32 s45, s45, s55
s_add_u32 s46, s46, 40960
s_waitcnt vmcnt(10)
s_barrier
ds_read_b128 v[8:11], v64 offset:0
ds_read_b128 v[12:15], v64 offset:1024
ds_read_b128 v[16:19], v64 offset:2048
ds_read_b128 v[20:23], v64 offset:3072
s_mov_b32 s59, 32
s_waitcnt lgkmcnt(3)
v_mfma_f32_32x32x16_bf16 v[32:47], v[8:11], a[0:3], 0
s_waitcnt lgkmcnt(2)
ds_read_b128 v[24:27], v64 offset:4096
v_mfma_f32_32x32x16_bf16 v[32:47], v[12:15], a[4:7], v[32:47]
s_waitcnt lgkmcnt(2)
ds_read_b128 v[8:11], v64 offset:5120
ds_read_b128 v[72:75], v5
v_mov_b32 v4, 0
ds_read_b128 v[76:79], v5 offset:1024
v_mfma_f32_32x32x16_bf16 v[32:47], v[16:19], a[8:11], v[32:47]
s_waitcnt lgkmcnt(4)
ds_read_b128 v[12:15], v64 offset:6144
s_waitcnt lgkmcnt(2)
v_and_b32 v72, v3, v72
v_dot2c_f32_bf16 v4, v72, v72
v_dot2c_f32_bf16 v4, v73, v73
v_dot2c_f32_bf16 v4, v74, v74
v_dot2c_f32_bf16 v4, v75, v75
v_mfma_f32_32x32x16_bf16 v[32:47], v[20:23], a[12:15], v[32:47]
ds_read_b128 v[16:19], v64 offset:7168
ds_read_b128 v[72:75], v5 offset:2048
s_waitcnt lgkmcnt(3)
v_dot2c_f32_bf16 v4, v76, v76
v_dot2c_f32_bf16 v4, v77, v77
v_dot2c_f32_bf16 v4, v78, v78
v_dot2c_f32_bf16 v4, v79, v79
v_mfma_f32_32x32x16_bf16 v[32:47], v[24:27], a[16:19], v[32:47]
ds_read_b128 v[20:23], v64 offset:8192
ds_read_b128 v[76:79], v5 offset:3072
s_waitcnt lgkmcnt(2)
v_dot2c_f32_bf16 v4, v72, v72
v_dot2c_f32_bf16 v4, v73, v73
v_dot2c_f32_bf16 v4, v74, v74
v_dot2c_f32_bf16 v4, v75, v75
v_mfma_f32_32x32x16_bf16 v[32:47], v[8:11], a[20:23], v[32:47]
ds_read_b128 v[24:27], v64 offset:9216
ds_read_b128 v[72:75], v5 offset:4096
s_waitcnt lgkmcnt(2)
v_dot2c_f32_bf16 v4, v76, v76
v_dot2c_f32_bf16 v4, v77, v77
v_dot2c_f32_bf16 v4, v78, v78
v_dot2c_f32_bf16 v4, v79, v79
v_mfma_f32_32x32x16_bf16 v[32:47], v[12:15], a[24:27], v[32:47]
ds_read_b128 v[8:11], v64 offset:10240
ds_read_b128 v[76:79], v5 offset:5120
s_waitcnt lgkmcnt(2)
v_dot2c_f32_bf16 v4, v72, v72
v_dot2c_f32_bf16 v4, v73, v73
v_dot2c_f32_bf16 v4, v74, v74
v_dot2c_f32_bf16 v4, v75, v75
v_mfma_f32_32x32x16_bf16 v[32:47], v[16:19], a[28:31], v[32:47]
ds_read_b128 v[12:15], v64 offset:11264
ds_read_b128 v[72:75], v5 offset:6144
s_waitcnt lgkmcnt(2)
v_dot2c_f32_bf16 v4, v76, v76
v_dot2c_f32_bf16 v4, v77, v77
v_dot2c_f32_bf16 v4, v78, v78
v_dot2c_f32_bf16 v4, v79, v79
v_mfma_f32_32x32x16_bf16 v[32:47], v[20:23], a[32:35], v[32:47]
ds_read_b128 v[16:19], v64 offset:12288
ds_read_b128 v[76:79], v5 offset:7168
s_waitcnt lgkmcnt(2)
v_dot2c_f32_bf16 v4, v72, v72
v_dot2c_f32_bf16 v4, v73, v73
v_dot2c_f32_bf16 v4, v74, v74
v_dot2c_f32_bf16 v4, v75, v75
v_mfma_f32_32x32x16_bf16 v[32:47], v[24:27], a[36:39], v[32:47]
ds_read_b128 v[20:23], v64 offset:13312
ds_read_b128 v[72:75], v5 offset:8192
s_waitcnt lgkmcnt(2)
v_dot2c_f32_bf16 v4, v76, v76
v_dot2c_f32_bf16 v4, v77, v77
v_dot2c_f32_bf16 v4, v78, v78
v_dot2c_f32_bf16 v4, v79, v79
v_mfma_f32_32x32x16_bf16 v[32:47], v[8:11], a[40:43], v[32:47]
ds_read_b128 v[24:27], v64 offset:14336
ds_read_b128 v[76:79], v5 offset:9216
s_waitcnt lgkmcnt(2)
v_dot2c_f32_bf16 v4, v72, v72
v_dot2c_f32_bf16 v4, v73, v73
v_dot2c_f32_bf16 v4, v74, v74
v_dot2c_f32_bf16 v4, v75, v75
v_mfma_f32_32x32x16_bf16 v[32:47], v[12:15], a[44:47], v[32:47]
ds_read_b128 v[8:11], v64 offset:15360
s_waitcnt lgkmcnt(1)
v_dot2c_f32_bf16 v4, v76, v76
v_dot2c_f32_bf16 v4, v77, v77
v_dot2c_f32_bf16 v4, v78, v78
v_dot2c_f32_bf16 v4, v79, v79
s_nop 2
ds_write_b32 v6, v4 offset:0
v_mfma_f32_32x32x16_bf16 v[32:47], v[16:19], a[48:51], v[32:47]
ds_read_b128 v[12:15], v64 offset:16384
s_add_u32 m0, s45, 0
s_add_u32 s55, s46, 0
buffer_load_dwordx4 v0, s[4:7], s55 offen offset:0 sc1 lds
buffer_load_dwordx4 v0, s[4:7], s55 offen offset:1024 sc1 lds
v_mfma_f32_32x32x16_bf16 v[32:47], v[20:23], a[52:55], v[32:47]
ds_read_b128 v[16:19], v64 offset:17408
buffer_load_dwordx4 v0, s[4:7], s55 offen offset:2048 sc1 lds
buffer_load_dwordx4 v0, s[4:7], s55 offen offset:3072 sc1 lds
v_mfma_f32_32x32x16_bf16 v[32:47], v[24:27], a[56:59], v[32:47]
s_waitcnt lgkmcnt(3)
ds_read_b128 v[20:23], v64 offset:18432
s_add_u32 m0, s45, 4096
s_add_u32 s55, s46, 4096
buffer_load_dwordx4 v0, s[4:7], s55 offen offset:0 sc1 lds
buffer_load_dwordx4 v0, s[4:7], s55 offen offset:1024 sc1 lds
v_mfma_f32_32x32x16_bf16 v[32:47], v[8:11], a[60:63], v[32:47]
s_waitcnt lgkmcnt(2)
ds_read_b128 v[24:27], v64 offset:19456
buffer_load_dwordx4 v0, s[4:7], s55 offen offset:2048 sc1 lds
buffer_load_dwordx4 v0, s[4:7], s55 offen offset:3072 sc1 lds
v_mfma_f32_32x32x16_bf16 v[32:47], v[12:15], a[64:67], v[32:47]
s_waitcnt lgkmcnt(2)
ds_read_b128 v[8:11], v64 offset:20480
s_add_u32 m0, s45, 8192
s_add_u32 s55, s46, 8192
buffer_load_dwordx4 v0, s[4:7], s55 offen offset:0 sc1 lds
buffer_load_dwordx4 v0, s[4:7], s55 offen offset:1024 sc1 lds
v_mfma_f32_32x32x16_bf16 v[32:47], v[16:19], a[68:71], v[32:47]
s_waitcnt lgkmcnt(2)
ds_read_b128 v[12:15], v64 offset:21504
s_add_u32 s45, s45, 40960
s_cmp_ge_u32 s45, 122880
s_cselect_b32 s55, 122880, 0
s_sub_u32 s45, s45, s55
s_add_u32 s46, s46, 40960
v_mfma_f32_32x32x16_bf16 v[32:47], v[20:23], a[72:75], v[32:47]
s_waitcnt lgkmcnt(2)
ds_read_b128 v[16:19], v64 offset:22528
v_mfma_f32_32x32x16_bf16 v[32:47], v[24:27], a[76:79], v[32:47]
s_waitcnt lgkmcnt(2)
ds_read_b128 v[20:23], v64 offset:23552
v_mfma_f32_32x32x16_bf16 v[32:47], v[8:11], a[80:83], v[32:47]
s_waitcnt lgkmcnt(2)
ds_read_b128 v[24:27], v64 offset:24576
v_mfma_f32_32x32x16_bf16 v[32:47], v[12:15], a[84:87], v[32:47]
s_waitcnt lgkmcnt(2)
ds_read_b128 v[8:11], v64 offset:25600
v_mfma_f32_32x32x16_bf16 v[32:47], v[16:19], a[88:91], v[32:47]
s_waitcnt lgkmcnt(2)
ds_read_b128 v[12:15], v64 offset:26624
v_mfma_f32_32x32x16_bf16 v[32:47], v[20:23], a[92:95], v[32:47]
s_waitcnt lgkmcnt(2)
ds_read_b128 v[16:19], v64 offset:27648
v_mfma_f32_32x32x16_bf16 v[32:47], v[24:27], a[96:99], v[32:47]
s_waitcnt lgkmcnt(2)
ds_read_b128 v[20:23], v64 offset:28672
v_mfma_f32_32x32x16_bf16 v[32:47], v[8:11], a[100:103], v[32:47]
s_waitcnt lgkmcnt(2)
ds_read_b128 v[24:27], v64 offset:29696
v_mfma_f32_32x32x16_bf16 v[32:47], v[12:15], a[104:107], v[32:47]
s_waitcnt lgkmcnt(2)
ds_read_b128 v[8:11], v64 offset:30720
v_mfma_f32_32x32x16_bf16 v[32:47], v[16:19], a[108:111], v[32:47]
s_waitcnt lgkmcnt(2)
ds_read_b128 v[12:15], v64 offset:31744
v_mfma_f32_32x32x16_bf16 v[32:47], v[20:23], a[112:115], v[32:47]
s_waitcnt lgkmcnt(2)
ds_read_b128 v[16:19], v64 offset:32768
v_mfma_f32_32x32x16_bf16 v[32:47], v[24:27], a[116:119], v[32:47]
s_waitcnt lgkmcnt(2)
ds_read_b128 v[20:23], v64 offset:33792
v_mfma_f32_32x32x16_bf16 v[32:47], v[8:11], a[120:123], v[32:47]
s_waitcnt lgkmcnt(2)
ds_read_b128 v[24:27], v64 offset:34816
v_mfma_f32_32x32x16_bf16 v[32:47], v[12:15], a[124:127], v[32:47]
s_waitcnt lgkmcnt(2)
ds_read_b128 v[8:11], v64 offset:35840
v_mfma_f32_32x32x16_bf16 v[32:47], v[16:19], a[128:131], v[32:47]
s_waitcnt lgkmcnt(2)
ds_read_b128 v[12:15], v64 offset:36864
v_mfma_f32_32x32x16_bf16 v[32:47], v[20:23], a[132:135], v[32:47]
s_waitcnt lgkmcnt(2)
ds_read_b128 v[16:19], v64 offset:37888
v_mfma_f32_32x32x16_bf16 v[32:47], v[24:27], a[136:139], v[32:47]
s_waitcnt lgkmcnt(2)
ds_read_b128 v[20:23], v64 offset:38912
v_mfma_f32_32x32x16_bf16 v[32:47], v[8:11], a[140:143], v[32:47]
s_waitcnt lgkmcnt(2)
ds_read_b128 v[24:27], v64 offset:39936
v_mfma_f32_32x32x16_bf16 v[32:47], v[12:15], a[144:147], v[32:47]
s_add_u32 s44, s44, 1
s_cmp_eq_u32 s44, 3
s_mov_b32 s56, 40960
s_cmov_b32 s56, -81920
s_cselect_b32 s44, 0, s44
v_add_u32 v64, s56, v64
v_add_u32 v5, s56, v5
s_waitcnt vmcnt(10) lgkmcnt(2)
s_barrier
ds_read_b128 v[8:11], v64 offset:0
v_mfma_f32_32x32x16_bf16 v[32:47], v[16:19], a[148:151], v[32:47]
s_waitcnt lgkmcnt(2)
ds_read_b128 v[12:15], v64 offset:1024
v_mfma_f32_32x32x16_bf16 v[32:47], v[20:23], a[152:155], v[32:47]
s_waitcnt lgkmcnt(2)
ds_read_b128 v[16:19], v64 offset:2048
v_mfma_f32_32x32x16_bf16 v[32:47], v[24:27], a[156:159], v[32:47]
s_waitcnt lgkmcnt(2)
ds_read_b128 v[20:23], v64 offset:3072
ds_read_b128 v[80:83], v7 offset:0
ds_read_b128 v[84:87], v7 offset:16
v_mov_b32 v88, 0x3727c5ac
s_waitcnt lgkmcnt(0)
v_add_f32 v80, v80, v84
v_add_f32 v81, v81, v85
v_add_f32 v82, v82, v86
v_add_f32 v83, v83, v87
v_add_f32 v80, v80, v81
v_add_f32 v82, v82, v83
v_add_f32 v80, v80, v82
v_fma_f32 v80, v80, s61, v88
v_rsq_f32 v80, v80
ds_write_b32 v28, v80
ds_read_b128 v[80:83], v29 offset:0
ds_read_b128 v[84:87], v29 offset:32
ds_read_b128 v[88:91], v29 offset:64
ds_read_b128 v[92:95], v29 offset:96
s_waitcnt lgkmcnt(3)
v_mul_f32 v80, v80, v32
v_mul_f32 v81, v81, v33
v_mul_f32 v82, v82, v34
v_mul_f32 v83, v83, v35
s_waitcnt lgkmcnt(2)
v_mul_f32 v84, v84, v36
v_mul_f32 v85, v85, v37
v_mul_f32 v86, v86, v38
v_mul_f32 v87, v87, v39
s_waitcnt lgkmcnt(1)
v_mul_f32 v88, v88, v40
v_mul_f32 v89, v89, v41
v_mul_f32 v90, v90, v42
v_mul_f32 v91, v91, v43
s_waitcnt lgkmcnt(0)
v_mul_f32 v92, v92, v44
v_mul_f32 v93, v93, v45
v_mul_f32 v94, v94, v46
v_mul_f32 v95, v95, v47
v_cvt_pk_bf16_f32 v32, v80, v81
v_cvt_pk_bf16_f32 v33, v82, v83
v_cvt_pk_bf16_f32 v36, v84, v85
v_cvt_pk_bf16_f32 v37, v86, v87
v_cvt_pk_bf16_f32 v34, v88, v89
v_cvt_pk_bf16_f32 v35, v90, v91
v_cvt_pk_bf16_f32 v38, v92, v93
v_cvt_pk_bf16_f32 v39, v94, v95
buffer_store_dwordx4 v[32:35], v1, s[4:7], s48 offen offset:2048 sc1
buffer_store_dwordx4 v[36:39], v1, s[4:7], s48 offen offset:2560 sc1
s_add_u32 s48, s48, s49
s_waitcnt vmcnt(0)
s_barrier
s_add_u32 s50, s50, 1
v_mov_b32 v4, s50
buffer_store_dword v4, v2, s[4:7], s60 offen sc1
v_mfma_f32_32x32x16_bf16 v[48:63], v[8:11], a[0:3], 0
ds_read_b128 v[24:27], v64 offset:4096
v_mfma_f32_32x32x16_bf16 v[48:63], v[12:15], a[4:7], v[48:63]
ds_read_b128 v[8:11], v64 offset:5120
ds_read_b128 v[72:75], v5
v_mov_b32 v4, 0
ds_read_b128 v[76:79], v5 offset:1024
v_mfma_f32_32x32x16_bf16 v[48:63], v[16:19], a[8:11], v[48:63]
ds_read_b128 v[12:15], v64 offset:6144
s_waitcnt lgkmcnt(2)
v_and_b32 v72, v3, v72
v_dot2c_f32_bf16 v4, v72, v72
v_dot2c_f32_bf16 v4, v73, v73
v_dot2c_f32_bf16 v4, v74, v74
v_dot2c_f32_bf16 v4, v75, v75
v_mfma_f32_32x32x16_bf16 v[48:63], v[20:23], a[12:15], v[48:63]
ds_read_b128 v[16:19], v64 offset:7168
ds_read_b128 v[72:75], v5 offset:2048
s_waitcnt lgkmcnt(3)
v_dot2c_f32_bf16 v4, v76, v76
v_dot2c_f32_bf16 v4, v77, v77
v_dot2c_f32_bf16 v4, v78, v78
v_dot2c_f32_bf16 v4, v79, v79
v_mfma_f32_32x32x16_bf16 v[48:63], v[24:27], a[16:19], v[48:63]
ds_read_b128 v[20:23], v64 offset:8192
ds_read_b128 v[76:79], v5 offset:3072
s_waitcnt lgkmcnt(2)
v_dot2c_f32_bf16 v4, v72, v72
v_dot2c_f32_bf16 v4, v73, v73
v_dot2c_f32_bf16 v4, v74, v74
v_dot2c_f32_bf16 v4, v75, v75
v_mfma_f32_32x32x16_bf16 v[48:63], v[8:11], a[20:23], v[48:63]
ds_read_b128 v[24:27], v64 offset:9216
ds_read_b128 v[72:75], v5 offset:4096
s_waitcnt lgkmcnt(2)
v_dot2c_f32_bf16 v4, v76, v76
v_dot2c_f32_bf16 v4, v77, v77
v_dot2c_f32_bf16 v4, v78, v78
v_dot2c_f32_bf16 v4, v79, v79
v_mfma_f32_32x32x16_bf16 v[48:63], v[12:15], a[24:27], v[48:63]
ds_read_b128 v[8:11], v64 offset:10240
ds_read_b128 v[76:79], v5 offset:5120
s_waitcnt lgkmcnt(2)
v_dot2c_f32_bf16 v4, v72, v72
v_dot2c_f32_bf16 v4, v73, v73
v_dot2c_f32_bf16 v4, v74, v74
v_dot2c_f32_bf16 v4, v75, v75
v_mfma_f32_32x32x16_bf16 v[48:63], v[16:19], a[28:31], v[48:63]
ds_read_b128 v[12:15], v64 offset:11264
ds_read_b128 v[72:75], v5 offset:6144
s_waitcnt lgkmcnt(2)
v_dot2c_f32_bf16 v4, v76, v76
v_dot2c_f32_bf16 v4, v77, v77
v_dot2c_f32_bf16 v4, v78, v78
v_dot2c_f32_bf16 v4, v79, v79
v_mfma_f32_32x32x16_bf16 v[48:63], v[20:23], a[32:35], v[48:63]
ds_read_b128 v[16:19], v64 offset:12288
ds_read_b128 v[76:79], v5 offset:7168
s_waitcnt lgkmcnt(2)
v_dot2c_f32_bf16 v4, v72, v72
v_dot2c_f32_bf16 v4, v73, v73
v_dot2c_f32_bf16 v4, v74, v74
v_dot2c_f32_bf16 v4, v75, v75
v_mfma_f32_32x32x16_bf16 v[48:63], v[24:27], a[36:39], v[48:63]
ds_read_b128 v[20:23], v64 offset:13312
ds_read_b128 v[72:75], v5 offset:8192
s_waitcnt lgkmcnt(2)
v_dot2c_f32_bf16 v4, v76, v76
v_dot2c_f32_bf16 v4, v77, v77
v_dot2c_f32_bf16 v4, v78, v78
v_dot2c_f32_bf16 v4, v79, v79
v_mfma_f32_32x32x16_bf16 v[48:63], v[8:11], a[40:43], v[48:63]
ds_read_b128 v[24:27], v64 offset:14336
ds_read_b128 v[76:79], v5 offset:9216
s_waitcnt lgkmcnt(2)
v_dot2c_f32_bf16 v4, v72, v72
v_dot2c_f32_bf16 v4, v73, v73
v_dot2c_f32_bf16 v4, v74, v74
v_dot2c_f32_bf16 v4, v75, v75
v_mfma_f32_32x32x16_bf16 v[48:63], v[12:15], a[44:47], v[48:63]
ds_read_b128 v[8:11], v64 offset:15360
s_waitcnt lgkmcnt(1)
v_dot2c_f32_bf16 v4, v76, v76
v_dot2c_f32_bf16 v4, v77, v77
v_dot2c_f32_bf16 v4, v78, v78
v_dot2c_f32_bf16 v4, v79, v79
s_nop 2
ds_write_b32 v6, v4 offset:1024
v_mfma_f32_32x32x16_bf16 v[48:63], v[16:19], a[48:51], v[48:63]
ds_read_b128 v[12:15], v64 offset:16384
s_add_u32 m0, s45, 0
s_add_u32 s55, s46, 0
buffer_load_dwordx4 v0, s[4:7], s55 offen offset:0 sc1 lds
buffer_load_dwordx4 v0, s[4:7], s55 offen offset:1024 sc1 lds
v_mfma_f32_32x32x16_bf16 v[48:63], v[20:23], a[52:55], v[48:63]
ds_read_b128 v[16:19], v64 offset:17408
buffer_load_dwordx4 v0, s[4:7], s55 offen offset:2048 sc1 lds
buffer_load_dwordx4 v0, s[4:7], s55 offen offset:3072 sc1 lds
v_mfma_f32_32x32x16_bf16 v[48:63], v[24:27], a[56:59], v[48:63]
s_waitcnt lgkmcnt(3)
ds_read_b128 v[20:23], v64 offset:18432
s_add_u32 m0, s45, 4096
s_add_u32 s55, s46, 4096
buffer_load_dwordx4 v0, s[4:7], s55 offen offset:0 sc1 lds
buffer_load_dwordx4 v0, s[4:7], s55 offen offset:1024 sc1 lds
v_mfma_f32_32x32x16_bf16 v[48:63], v[8:11], a[60:63], v[48:63]
s_waitcnt lgkmcnt(2)
ds_read_b128 v[24:27], v64 offset:19456
buffer_load_dwordx4 v0, s[4:7], s55 offen offset:2048 sc1 lds
buffer_load_dwordx4 v0, s[4:7], s55 offen offset:3072 sc1 lds
v_mfma_f32_32x32x16_bf16 v[48:63], v[12:15], a[64:67], v[48:63]
s_waitcnt lgkmcnt(2)
ds_read_b128 v[8:11], v64 offset:20480
s_add_u32 m0, s45, 8192
s_add_u32 s55, s46, 8192
buffer_load_dwordx4 v0, s[4:7], s55 offen offset:0 sc1 lds
buffer_load_dwordx4 v0, s[4:7], s55 offen offset:1024 sc1 lds
v_mfma_f32_32x32x16_bf16 v[48:63], v[16:19], a[68:71], v[48:63]
s_waitcnt lgkmcnt(2)
ds_read_b128 v[12:15], v64 offset:21504
s_add_u32 s45, s45, 40960
s_cmp_ge_u32 s45, 122880
s_cselect_b32 s55, 122880, 0
s_sub_u32 s45, s45, s55
s_add_u32 s46, s46, 40960
v_mfma_f32_32x32x16_bf16 v[48:63], v[20:23], a[72:75], v[48:63]
s_waitcnt lgkmcnt(2)
ds_read_b128 v[16:19], v64 offset:22528
v_mfma_f32_32x32x16_bf16 v[48:63], v[24:27], a[76:79], v[48:63]
s_waitcnt lgkmcnt(2)
ds_read_b128 v[20:23], v64 offset:23552
v_mfma_f32_32x32x16_bf16 v[48:63], v[8:11], a[80:83], v[48:63]
s_waitcnt lgkmcnt(2)
ds_read_b128 v[24:27], v64 offset:24576
v_mfma_f32_32x32x16_bf16 v[48:63], v[12:15], a[84:87], v[48:63]
s_waitcnt lgkmcnt(2)
ds_read_b128 v[8:11], v64 offset:25600
v_mfma_f32_32x32x16_bf16 v[48:63], v[16:19], a[88:91], v[48:63]
s_waitcnt lgkmcnt(2)
ds_read_b128 v[12:15], v64 offset:26624
v_mfma_f32_32x32x16_bf16 v[48:63], v[20:23], a[92:95], v[48:63]
s_waitcnt lgkmcnt(2)
ds_read_b128 v[16:19], v64 offset:27648
v_mfma_f32_32x32x16_bf16 v[48:63], v[24:27], a[96:99], v[48:63]
s_waitcnt lgkmcnt(2)
ds_read_b128 v[20:23], v64 offset:28672
v_mfma_f32_32x32x16_bf16 v[48:63], v[8:11], a[100:103], v[48:63]
s_waitcnt lgkmcnt(2)
ds_read_b128 v[24:27], v64 offset:29696
v_mfma_f32_32x32x16_bf16 v[48:63], v[12:15], a[104:107], v[48:63]
s_waitcnt lgkmcnt(2)
ds_read_b128 v[8:11], v64 offset:30720
v_mfma_f32_32x32x16_bf16 v[48:63], v[16:19], a[108:111], v[48:63]
s_waitcnt lgkmcnt(2)
ds_read_b128 v[12:15], v64 offset:31744
v_mfma_f32_32x32x16_bf16 v[48:63], v[20:23], a[112:115], v[48:63]
s_waitcnt lgkmcnt(2)
ds_read_b128 v[16:19], v64 offset:32768
v_mfma_f32_32x32x16_bf16 v[48:63], v[24:27], a[116:119], v[48:63]
s_waitcnt lgkmcnt(2)
ds_read_b128 v[20:23], v64 offset:33792
v_mfma_f32_32x32x16_bf16 v[48:63], v[8:11], a[120:123], v[48:63]
s_waitcnt lgkmcnt(2)
ds_read_b128 v[24:27], v64 offset:34816
v_mfma_f32_32x32x16_bf16 v[48:63], v[12:15], a[124:127], v[48:63]
s_waitcnt lgkmcnt(2)
ds_read_b128 v[8:11], v64 offset:35840
v_mfma_f32_32x32x16_bf16 v[48:63], v[16:19], a[128:131], v[48:63]
s_waitcnt lgkmcnt(2)
ds_read_b128 v[12:15], v64 offset:36864
v_mfma_f32_32x32x16_bf16 v[48:63], v[20:23], a[132:135], v[48:63]
s_waitcnt lgkmcnt(2)
ds_read_b128 v[16:19], v64 offset:37888
v_mfma_f32_32x32x16_bf16 v[48:63], v[24:27], a[136:139], v[48:63]
s_waitcnt lgkmcnt(2)
ds_read_b128 v[20:23], v64 offset:38912
v_mfma_f32_32x32x16_bf16 v[48:63], v[8:11], a[140:143], v[48:63]
s_waitcnt lgkmcnt(2)
ds_read_b128 v[24:27], v64 offset:39936
v_mfma_f32_32x32x16_bf16 v[48:63], v[12:15], a[144:147], v[48:63]
s_add_u32 s44, s44, 1
s_cmp_eq_u32 s44, 3
s_mov_b32 s56, 40960
s_cmov_b32 s56, -81920
s_cselect_b32 s44, 0, s44
v_add_u32 v64, s56, v64
v_add_u32 v5, s56, v5
s_waitcnt vmcnt(10) lgkmcnt(2)
s_barrier
ds_read_b128 v[8:11], v64 offset:0
v_mfma_f32_32x32x16_bf16 v[48:63], v[16:19], a[148:151], v[48:63]
s_waitcnt lgkmcnt(2)
ds_read_b128 v[12:15], v64 offset:1024
v_mfma_f32_32x32x16_bf16 v[48:63], v[20:23], a[152:155], v[48:63]
s_waitcnt lgkmcnt(2)
ds_read_b128 v[16:19], v64 offset:2048
v_mfma_f32_32x32x16_bf16 v[48:63], v[24:27], a[156:159], v[48:63]
s_waitcnt lgkmcnt(2)
ds_read_b128 v[20:23], v64 offset:3072
s_branch k_sm_43
k_st_41:
v_mfma_f32_32x32x16_bf16 v[48:63], v[8:11], a[0:3], 0
s_waitcnt lgkmcnt(2)
ds_read_b128 v[24:27], v64 offset:4096
v_mfma_f32_32x32x16_bf16 v[48:63], v[12:15], a[4:7], v[48:63]
s_waitcnt lgkmcnt(2)
ds_read_b128 v[8:11], v64 offset:5120
ds_read_b128 v[80:83], v7 offset:0
ds_read_b128 v[84:87], v7 offset:16
v_mov_b32 v88, 0x3727c5ac
v_mfma_f32_32x32x16_bf16 v[48:63], v[16:19], a[8:11], v[48:63]
s_waitcnt lgkmcnt(4)
ds_read_b128 v[12:15], v64 offset:6144
s_waitcnt lgkmcnt(1)
v_add_f32 v80, v80, v84
v_add_f32 v81, v81, v85
v_add_f32 v82, v82, v86
v_add_f32 v83, v83, v87
v_add_f32 v80, v80, v81
v_add_f32 v82, v82, v83
v_add_f32 v80, v80, v82
v_mfma_f32_32x32x16_bf16 v[48:63], v[20:23], a[12:15], v[48:63]
ds_read_b128 v[16:19], v64 offset:7168
v_fma_f32 v80, v80, s61, v88
v_rsq_f32 v80, v80
ds_write_b32 v28, v80
v_mfma_f32_32x32x16_bf16 v[48:63], v[24:27], a[16:19], v[48:63]
ds_read_b128 v[20:23], v64 offset:8192
ds_read_b128 v[80:83], v29 offset:0
ds_read_b128 v[84:87], v29 offset:32
ds_read_b128 v[88:91], v29 offset:64
ds_read_b128 v[92:95], v29 offset:96
v_mfma_f32_32x32x16_bf16 v[48:63], v[8:11], a[20:23], v[48:63]
s_waitcnt lgkmcnt(7)
ds_read_b128 v[24:27], v64 offset:9216
s_waitcnt lgkmcnt(4)
v_mul_f32 v80, v80, v32
v_mul_f32 v81, v81, v33
v_mul_f32 v82, v82, v34
v_mul_f32 v83, v83, v35
v_mfma_f32_32x32x16_bf16 v[48:63], v[12:15], a[24:27], v[48:63]
ds_read_b128 v[8:11], v64 offset:10240
s_waitcnt lgkmcnt(4)
v_mul_f32 v84, v84, v36
v_mul_f32 v85, v85, v37
v_mul_f32 v86, v86, v38
v_mul_f32 v87, v87, v39
v_mfma_f32_32x32x16_bf16 v[48:63], v[16:19], a[28:31], v[48:63]
ds_read_b128 v[12:15], v64 offset:11264
s_waitcnt lgkmcnt(4)
v_mul_f32 v88, v88, v40
v_mul_f32 v89, v89, v41
v_mul_f32 v90, v90, v42
v_mul_f32 v91, v91, v43
v_mfma_f32_32x32x16_bf16 v[48:63], v[20:23], a[32:35], v[48:63]
s_waitcnt lgkmcnt(2)
ds_read_b128 v[16:19], v64 offset:12288
v_mul_f32 v92, v92, v44
v_mul_f32 v93, v93, v45
v_mul_f32 v94, v94, v46
v_mul_f32 v95, v95, v47
v_mfma_f32_32x32x16_bf16 v[48:63], v[24:27], a[36:39], v[48:63]
s_waitcnt lgkmcnt(2)
ds_read_b128 v[20:23], v64 offset:13312
v_cvt_pk_bf16_f32 v32, v80, v81
v_cvt_pk_bf16_f32 v33, v82, v83
v_mfma_f32_32x32x16_bf16 v[48:63], v[8:11], a[40:43], v[48:63]
s_waitcnt lgkmcnt(2)
ds_read_b128 v[24:27], v64 offset:14336
v_cvt_pk_bf16_f32 v36, v84, v85
v_cvt_pk_bf16_f32 v37, v86, v87
v_mfma_f32_32x32x16_bf16 v[48:63], v[12:15], a[44:47], v[48:63]
s_waitcnt lgkmcnt(2)
ds_read_b128 v[8:11], v64 offset:15360
v_cvt_pk_bf16_f32 v34, v88, v89
v_cvt_pk_bf16_f32 v35, v90, v91
v_mfma_f32_32x32x16_bf16 v[48:63], v[16:19], a[48:51], v[48:63]
s_waitcnt lgkmcnt(2)
ds_read_b128 v[12:15], v64 offset:16384
v_cvt_pk_bf16_f32 v38, v92, v93
v_cvt_pk_bf16_f32 v39, v94, v95
v_mfma_f32_32x32x16_bf16 v[48:63], v[20:23], a[52:55], v[48:63]
s_waitcnt lgkmcnt(2)
ds_read_b128 v[16:19], v64 offset:17408
buffer_store_dwordx4 v[32:35], v1, s[4:7], s48 offen offset:2048 sc1
buffer_store_dwordx4 v[36:39], v1, s[4:7], s48 offen offset:2560 sc1
v_mfma_f32_32x32x16_bf16 v[48:63], v[24:27], a[56:59], v[48:63]
s_waitcnt lgkmcnt(2)
ds_read_b128 v[20:23], v64 offset:18432
s_add_u32 s48, s48, s49
ds_read_b128 v[72:75], v5
v_mov_b32 v4, 0
v_mfma_f32_32x32x16_bf16 v[48:63], v[8:11], a[60:63], v[48:63]
s_waitcnt lgkmcnt(3)
ds_read_b128 v[24:27], v64 offset:19456
ds_read_b128 v[76:79], v5 offset:1024
s_waitcnt lgkmcnt(2)
v_and_b32 v72, v3, v72
v_mfma_f32_32x32x16_bf16 v[48:63], v[12:15], a[64:67], v[48:63]
ds_read_b128 v[8:11], v64 offset:20480
v_dot2c_f32_bf16 v4, v72, v72
v_dot2c_f32_bf16 v4, v73, v73
v_dot2c_f32_bf16 v4, v74, v74
v_dot2c_f32_bf16 v4, v75, v75
ds_read_b128 v[72:75], v5 offset:2048
v_mfma_f32_32x32x16_bf16 v[48:63], v[16:19], a[68:71], v[48:63]
ds_read_b128 v[12:15], v64 offset:21504
s_waitcnt lgkmcnt(3)
v_dot2c_f32_bf16 v4, v76, v76
v_dot2c_f32_bf16 v4, v77, v77
v_dot2c_f32_bf16 v4, v78, v78
v_dot2c_f32_bf16 v4, v79, v79
ds_read_b128 v[76:79], v5 offset:3072
v_mfma_f32_32x32x16_bf16 v[48:63], v[20:23], a[72:75], v[48:63]
ds_read_b128 v[16:19], v64 offset:22528
s_waitcnt lgkmcnt(3)
v_dot2c_f32_bf16 v4, v72, v72
v_dot2c_f32_bf16 v4, v73, v73
v_dot2c_f32_bf16 v4, v74, v74
v_dot2c_f32_bf16 v4, v75, v75
ds_read_b128 v[72:75], v5 offset:4096
v_mfma_f32_32x32x16_bf16 v[48:63], v[24:27], a[76:79], v[48:63]
ds_read_b128 v[20:23], v64 offset:23552
s_waitcnt lgkmcnt(3)
v_dot2c_f32_bf16 v4, v76, v76
v_dot2c_f32_bf16 v4, v77, v77
v_dot2c_f32_bf16 v4, v78, v78
v_dot2c_f32_bf16 v4, v79, v79
ds_read_b128 v[76:79], v5 offset:5120
v_mfma_f32_32x32x16_bf16 v[48:63], v[8:11], a[80:83], v[48:63]
ds_read_b128 v[24:27], v64 offset:24576
s_waitcnt lgkmcnt(3)
v_dot2c_f32_bf16 v4, v72, v72
v_dot2c_f32_bf16 v4, v73, v73
v_dot2c_f32_bf16 v4, v74, v74
v_dot2c_f32_bf16 v4, v75, v75
ds_read_b128 v[72:75], v5 offset:6144
v_mfma_f32_32x32x16_bf16 v[48:63], v[12:15], a[84:87], v[48:63]
ds_read_b128 v[8:11], v64 offset:25600
s_waitcnt lgkmcnt(3)
v_dot2c_f32_bf16 v4, v76, v76
v_dot2c_f32_bf16 v4, v77, v77
v_dot2c_f32_bf16 v4, v78, v78
v_dot2c_f32_bf16 v4, v79, v79
ds_read_b128 v[76:79], v5 offset:7168
v_mfma_f32_32x32x16_bf16 v[48:63], v[16:19], a[88:91], v[48:63]
ds_read_b128 v[12:15], v64 offset:26624
s_waitcnt lgkmcnt(3)
v_dot2c_f32_bf16 v4, v72, v72
v_dot2c_f32_bf16 v4, v73, v73
v_dot2c_f32_bf16 v4, v74, v74
v_dot2c_f32_bf16 v4, v75, v75
ds_read_b128 v[72:75], v5 offset:8192
v_mfma_f32_32x32x16_bf16 v[48:63], v[20:23], a[92:95], v[48:63]
ds_read_b128 v[16:19], v64 offset:27648
s_waitcnt lgkmcnt(3)
v_dot2c_f32_bf16 v4, v76, v76
v_dot2c_f32_bf16 v4, v77, v77
v_dot2c_f32_bf16 v4, v78, v78
v_dot2c_f32_bf16 v4, v79, v79
ds_read_b128 v[76:79], v5 offset:9216
v_mfma_f32_32x32x16_bf16 v[48:63], v[24:27], a[96:99], v[48:63]
ds_read_b128 v[20:23], v64 offset:28672
s_waitcnt lgkmcnt(3)
v_dot2c_f32_bf16 v4, v72, v72
v_dot2c_f32_bf16 v4, v73, v73
v_dot2c_f32_bf16 v4, v74, v74
v_dot2c_f32_bf16 v4, v75, v75
s_waitcnt lgkmcnt(1)
v_dot2c_f32_bf16 v4, v76, v76
v_dot2c_f32_bf16 v4, v77, v77
v_dot2c_f32_bf16 v4, v78, v78
v_dot2c_f32_bf16 v4, v79, v79
v_mfma_f32_32x32x16_bf16 v[48:63], v[8:11], a[100:103], v[48:63]
ds_read_b128 v[24:27], v64 offset:29696
ds_write_b32 v6, v4 offset:1024
s_add_u32 m0, s45, 0
s_add_u32 s55, s46, 0
buffer_load_dwordx4 v0, s[4:7], s55 offen offset:0 sc1 lds
v_mfma_f32_32x32x16_bf16 v[48:63], v[12:15], a[104:107], v[48:63]
ds_read_b128 v[8:11], v64 offset:30720
buffer_load_dwordx4 v0, s[4:7], s55 offen offset:1024 sc1 lds
buffer_load_dwordx4 v0, s[4:7], s55 offen offset:2048 sc1 lds
v_mfma_f32_32x32x16_bf16 v[48:63], v[16:19], a[108:111], v[48:63]
s_waitcnt lgkmcnt(3)
ds_read_b128 v[12:15], v64 offset:31744
buffer_load_dwordx4 v0, s[4:7], s55 offen offset:3072 sc1 lds
s_add_u32 m0, s45, 4096
s_add_u32 s55, s46, 4096
buffer_load_dwordx4 v0, s[4:7], s55 offen offset:0 sc1 lds
v_mfma_f32_32x32x16_bf16 v[48:63], v[20:23], a[112:115], v[48:63]
s_waitcnt lgkmcnt(3)
ds_read_b128 v[16:19], v64 offset:32768
buffer_load_dwordx4 v0, s[4:7], s55 offen offset:1024 sc1 lds
buffer_load_dwordx4 v0, s[4:7], s55 offen offset:2048 sc1 lds
v_mfma_f32_32x32x16_bf16 v[48:63], v[24:27], a[116:119], v[48:63]
s_waitcnt lgkmcnt(2)
ds_read_b128 v[20:23], v64 offset:33792
buffer_load_dwordx4 v0, s[4:7], s55 offen offset:3072 sc1 lds
s_add_u32 m0, s45, 8192
s_add_u32 s55, s46, 8192
buffer_load_dwordx4 v0, s[4:7], s55 offen offset:0 sc1 lds
v_mfma_f32_32x32x16_bf16 v[48:63], v[8:11], a[120:123], v[48:63]
s_waitcnt lgkmcnt(2)
ds_read_b128 v[24:27], v64 offset:34816
buffer_load_dwordx4 v0, s[4:7], s55 offen offset:1024 sc1 lds
s_add_u32 s45, s45, 40960
s_cmp_ge_u32 s45, 122880
s_cselect_b32 s55, 122880, 0
s_sub_u32 s45, s45, s55
v_mfma_f32_32x32x16_bf16 v[48:63], v[12:15], a[124:127], v[48:63]
s_waitcnt lgkmcnt(2)
ds_read_b128 v[8:11], v64 offset:35840
s_add_u32 s46, s46, 40960
v_mfma_f32_32x32x16_bf16 v[48:63], v[16:19], a[128:131], v[48:63]
s_waitcnt lgkmcnt(2)
ds_read_b128 v[12:15], v64 offset:36864
v_mfma_f32_32x32x16_bf16 v[48:63], v[20:23], a[132:135], v[48:63]
s_waitcnt lgkmcnt(2)
ds_read_b128 v[16:19], v64 offset:37888
v_mfma_f32_32x32x16_bf16 v[48:63], v[24:27], a[136:139], v[48:63]
s_waitcnt lgkmcnt(2)
ds_read_b128 v[20:23], v64 offset:38912
v_mfma_f32_32x32x16_bf16 v[48:63], v[8:11], a[140:143], v[48:63]
s_waitcnt lgkmcnt(2)
ds_read_b128 v[24:27], v64 offset:39936
v_mfma_f32_32x32x16_bf16 v[48:63], v[12:15], a[144:147], v[48:63]
s_add_u32 s44, s44, 1
s_cmp_eq_u32 s44, 3
s_mov_b32 s56, 40960
s_cmov_b32 s56, -81920
s_cselect_b32 s44, 0, s44
v_add_u32 v64, s56, v64
v_add_u32 v5, s56, v5
s_waitcnt vmcnt(10) lgkmcnt(2)
s_barrier
s_add_u32 s50, s50, 1
v_mov_b32 v4, s50
buffer_store_dword v4, v2, s[4:7], s60 offen sc1
ds_read_b128 v[8:11], v64 offset:0
v_mfma_f32_32x32x16_bf16 v[48:63], v[16:19], a[148:151], v[48:63]
s_waitcnt lgkmcnt(2)
ds_read_b128 v[12:15], v64 offset:1024
v_mfma_f32_32x32x16_bf16 v[48:63], v[20:23], a[152:155], v[48:63]
s_waitcnt lgkmcnt(2)
ds_read_b128 v[16:19], v64 offset:2048
v_mfma_f32_32x32x16_bf16 v[48:63], v[24:27], a[156:159], v[48:63]
s_waitcnt lgkmcnt(2)
ds_read_b128 v[20:23], v64 offset:3072
k_sm_43:
s_sub_u32 s59, s59, 1
s_cmp_eq_u32 s59, 0
s_cbranch_scc1 k_so_42
v_mfma_f32_32x32x16_bf16 v[32:47], v[8:11], a[0:3], 0
s_waitcnt lgkmcnt(2)
ds_read_b128 v[24:27], v64 offset:4096
v_mfma_f32_32x32x16_bf16 v[32:47], v[12:15], a[4:7], v[32:47]
s_waitcnt lgkmcnt(2)
ds_read_b128 v[8:11], v64 offset:5120
ds_read_b128 v[80:83], v7 offset:1024
ds_read_b128 v[84:87], v7 offset:1040
v_mov_b32 v88, 0x3727c5ac
v_mfma_f32_32x32x16_bf16 v[32:47], v[16:19], a[8:11], v[32:47]
s_waitcnt lgkmcnt(4)
ds_read_b128 v[12:15], v64 offset:6144
s_waitcnt lgkmcnt(1)
v_add_f32 v80, v80, v84
v_add_f32 v81, v81, v85
v_add_f32 v82, v82, v86
v_add_f32 v83, v83, v87
v_add_f32 v80, v80, v81
v_add_f32 v82, v82, v83
v_add_f32 v80, v80, v82
v_mfma_f32_32x32x16_bf16 v[32:47], v[20:23], a[12:15], v[32:47]
ds_read_b128 v[16:19], v64 offset:7168
v_fma_f32 v80, v80, s61, v88
v_rsq_f32 v80, v80
ds_write_b32 v28, v80
v_mfma_f32_32x32x16_bf16 v[32:47], v[24:27], a[16:19], v[32:47]
ds_read_b128 v[20:23], v64 offset:8192
ds_read_b128 v[80:83], v29 offset:0
ds_read_b128 v[84:87], v29 offset:32
ds_read_b128 v[88:91], v29 offset:64
ds_read_b128 v[92:95], v29 offset:96
v_mfma_f32_32x32x16_bf16 v[32:47], v[8:11], a[20:23], v[32:47]
s_waitcnt lgkmcnt(7)
ds_read_b128 v[24:27], v64 offset:9216
s_waitcnt lgkmcnt(4)
v_mul_f32 v80, v80, v48
v_mul_f32 v81, v81, v49
v_mul_f32 v82, v82, v50
v_mul_f32 v83, v83, v51
v_mfma_f32_32x32x16_bf16 v[32:47], v[12:15], a[24:27], v[32:47]
ds_read_b128 v[8:11], v64 offset:10240
s_waitcnt lgkmcnt(4)
v_mul_f32 v84, v84, v52
v_mul_f32 v85, v85, v53
v_mul_f32 v86, v86, v54
v_mul_f32 v87, v87, v55
v_mfma_f32_32x32x16_bf16 v[32:47], v[16:19], a[28:31], v[32:47]
ds_read_b128 v[12:15], v64 offset:11264
s_waitcnt lgkmcnt(4)
v_mul_f32 v88, v88, v56
v_mul_f32 v89, v89, v57
v_mul_f32 v90, v90, v58
v_mul_f32 v91, v91, v59
v_mfma_f32_32x32x16_bf16 v[32:47], v[20:23], a[32:35], v[32:47]
s_waitcnt lgkmcnt(2)
ds_read_b128 v[16:19], v64 offset:12288
v_mul_f32 v92, v92, v60
v_mul_f32 v93, v93, v61
v_mul_f32 v94, v94, v62
v_mul_f32 v95, v95, v63
v_mfma_f32_32x32x16_bf16 v[32:47], v[24:27], a[36:39], v[32:47]
s_waitcnt lgkmcnt(2)
ds_read_b128 v[20:23], v64 offset:13312
v_cvt_pk_bf16_f32 v48, v80, v81
v_cvt_pk_bf16_f32 v49, v82, v83
v_mfma_f32_32x32x16_bf16 v[32:47], v[8:11], a[40:43], v[32:47]
s_waitcnt lgkmcnt(2)
ds_read_b128 v[24:27], v64 offset:14336
v_cvt_pk_bf16_f32 v52, v84, v85
v_cvt_pk_bf16_f32 v53, v86, v87
v_mfma_f32_32x32x16_bf16 v[32:47], v[12:15], a[44:47], v[32:47]
s_waitcnt lgkmcnt(2)
ds_read_b128 v[8:11], v64 offset:15360
v_cvt_pk_bf16_f32 v50, v88, v89
v_cvt_pk_bf16_f32 v51, v90, v91
v_mfma_f32_32x32x16_bf16 v[32:47], v[16:19], a[48:51], v[32:47]
s_waitcnt lgkmcnt(2)
ds_read_b128 v[12:15], v64 offset:16384
v_cvt_pk_bf16_f32 v54, v92, v93
v_cvt_pk_bf16_f32 v55, v94, v95
v_mfma_f32_32x32x16_bf16 v[32:47], v[20:23], a[52:55], v[32:47]
s_waitcnt lgkmcnt(2)
ds_read_b128 v[16:19], v64 offset:17408
buffer_store_dwordx4 v[48:51], v1, s[4:7], s48 offen offset:2048 sc1
buffer_store_dwordx4 v[52:55], v1, s[4:7], s48 offen offset:2560 sc1
v_mfma_f32_32x32x16_bf16 v[32:47], v[24:27], a[56:59], v[32:47]
s_waitcnt lgkmcnt(2)
ds_read_b128 v[20:23], v64 offset:18432
s_add_u32 s48, s48, s49
ds_read_b128 v[72:75], v5
v_mov_b32 v4, 0
v_mfma_f32_32x32x16_bf16 v[32:47], v[8:11], a[60:63], v[32:47]
s_waitcnt lgkmcnt(3)
ds_read_b128 v[24:27], v64 offset:19456
ds_read_b128 v[76:79], v5 offset:1024
s_waitcnt lgkmcnt(2)
v_and_b32 v72, v3, v72
v_mfma_f32_32x32x16_bf16 v[32:47], v[12:15], a[64:67], v[32:47]
ds_read_b128 v[8:11], v64 offset:20480
v_dot2c_f32_bf16 v4, v72, v72
v_dot2c_f32_bf16 v4, v73, v73
v_dot2c_f32_bf16 v4, v74, v74
v_dot2c_f32_bf16 v4, v75, v75
ds_read_b128 v[72:75], v5 offset:2048
v_mfma_f32_32x32x16_bf16 v[32:47], v[16:19], a[68:71], v[32:47]
ds_read_b128 v[12:15], v64 offset:21504
s_waitcnt lgkmcnt(3)
v_dot2c_f32_bf16 v4, v76, v76
v_dot2c_f32_bf16 v4, v77, v77
v_dot2c_f32_bf16 v4, v78, v78
v_dot2c_f32_bf16 v4, v79, v79
ds_read_b128 v[76:79], v5 offset:3072
v_mfma_f32_32x32x16_bf16 v[32:47], v[20:23], a[72:75], v[32:47]
ds_read_b128 v[16:19], v64 offset:22528
s_waitcnt lgkmcnt(3)
v_dot2c_f32_bf16 v4, v72, v72
v_dot2c_f32_bf16 v4, v73, v73
v_dot2c_f32_bf16 v4, v74, v74
v_dot2c_f32_bf16 v4, v75, v75
ds_read_b128 v[72:75], v5 offset:4096
v_mfma_f32_32x32x16_bf16 v[32:47], v[24:27], a[76:79], v[32:47]
ds_read_b128 v[20:23], v64 offset:23552
s_waitcnt lgkmcnt(3)
v_dot2c_f32_bf16 v4, v76, v76
v_dot2c_f32_bf16 v4, v77, v77
v_dot2c_f32_bf16 v4, v78, v78
v_dot2c_f32_bf16 v4, v79, v79
ds_read_b128 v[76:79], v5 offset:5120
v_mfma_f32_32x32x16_bf16 v[32:47], v[8:11], a[80:83], v[32:47]
ds_read_b128 v[24:27], v64 offset:24576
s_waitcnt lgkmcnt(3)
v_dot2c_f32_bf16 v4, v72, v72
v_dot2c_f32_bf16 v4, v73, v73
v_dot2c_f32_bf16 v4, v74, v74
v_dot2c_f32_bf16 v4, v75, v75
ds_read_b128 v[72:75], v5 offset:6144
v_mfma_f32_32x32x16_bf16 v[32:47], v[12:15], a[84:87], v[32:47]
ds_read_b128 v[8:11], v64 offset:25600
s_waitcnt lgkmcnt(3)
v_dot2c_f32_bf16 v4, v76, v76
v_dot2c_f32_bf16 v4, v77, v77
v_dot2c_f32_bf16 v4, v78, v78
v_dot2c_f32_bf16 v4, v79, v79
ds_read_b128 v[76:79], v5 offset:7168
v_mfma_f32_32x32x16_bf16 v[32:47], v[16:19], a[88:91], v[32:47]
ds_read_b128 v[12:15], v64 offset:26624
s_waitcnt lgkmcnt(3)
v_dot2c_f32_bf16 v4, v72, v72
v_dot2c_f32_bf16 v4, v73, v73
v_dot2c_f32_bf16 v4, v74, v74
v_dot2c_f32_bf16 v4, v75, v75
ds_read_b128 v[72:75], v5 offset:8192
v_mfma_f32_32x32x16_bf16 v[32:47], v[20:23], a[92:95], v[32:47]
ds_read_b128 v[16:19], v64 offset:27648
s_waitcnt lgkmcnt(3)
v_dot2c_f32_bf16 v4, v76, v76
v_dot2c_f32_bf16 v4, v77, v77
v_dot2c_f32_bf16 v4, v78, v78
v_dot2c_f32_bf16 v4, v79, v79
ds_read_b128 v[76:79], v5 offset:9216
v_mfma_f32_32x32x16_bf16 v[32:47], v[24:27], a[96:99], v[32:47]
ds_read_b128 v[20:23], v64 offset:28672
s_waitcnt lgkmcnt(3)
v_dot2c_f32_bf16 v4, v72, v72
v_dot2c_f32_bf16 v4, v73, v73
v_dot2c_f32_bf16 v4, v74, v74
v_dot2c_f32_bf16 v4, v75, v75
s_waitcnt lgkmcnt(1)
v_dot2c_f32_bf16 v4, v76, v76
v_dot2c_f32_bf16 v4, v77, v77
v_dot2c_f32_bf16 v4, v78, v78
v_dot2c_f32_bf16 v4, v79, v79
v_mfma_f32_32x32x16_bf16 v[32:47], v[8:11], a[100:103], v[32:47]
ds_read_b128 v[24:27], v64 offset:29696
ds_write_b32 v6, v4 offset:0
s_add_u32 m0, s45, 0
s_add_u32 s55, s46, 0
buffer_load_dwordx4 v0, s[4:7], s55 offen offset:0 sc1 lds
v_mfma_f32_32x32x16_bf16 v[32:47], v[12:15], a[104:107], v[32:47]
ds_read_b128 v[8:11], v64 offset:30720
buffer_load_dwordx4 v0, s[4:7], s55 offen offset:1024 sc1 lds
buffer_load_dwordx4 v0, s[4:7], s55 offen offset:2048 sc1 lds
v_mfma_f32_32x32x16_bf16 v[32:47], v[16:19], a[108:111], v[32:47]
s_waitcnt lgkmcnt(3)
ds_read_b128 v[12:15], v64 offset:31744
buffer_load_dwordx4 v0, s[4:7], s55 offen offset:3072 sc1 lds
s_add_u32 m0, s45, 4096
s_add_u32 s55, s46, 4096
buffer_load_dwordx4 v0, s[4:7], s55 offen offset:0 sc1 lds
v_mfma_f32_32x32x16_bf16 v[32:47], v[20:23], a[112:115], v[32:47]
s_waitcnt lgkmcnt(3)
ds_read_b128 v[16:19], v64 offset:32768
buffer_load_dwordx4 v0, s[4:7], s55 offen offset:1024 sc1 lds
buffer_load_dwordx4 v0, s[4:7], s55 offen offset:2048 sc1 lds
v_mfma_f32_32x32x16_bf16 v[32:47], v[24:27], a[116:119], v[32:47]
s_waitcnt lgkmcnt(2)
ds_read_b128 v[20:23], v64 offset:33792
buffer_load_dwordx4 v0, s[4:7], s55 offen offset:3072 sc1 lds
s_add_u32 m0, s45, 8192
s_add_u32 s55, s46, 8192
buffer_load_dwordx4 v0, s[4:7], s55 offen offset:0 sc1 lds
v_mfma_f32_32x32x16_bf16 v[32:47], v[8:11], a[120:123], v[32:47]
s_waitcnt lgkmcnt(2)
ds_read_b128 v[24:27], v64 offset:34816
buffer_load_dwordx4 v0, s[4:7], s55 offen offset:1024 sc1 lds
s_add_u32 s45, s45, 40960
s_cmp_ge_u32 s45, 122880
s_cselect_b32 s55, 122880, 0
s_sub_u32 s45, s45, s55
v_mfma_f32_32x32x16_bf16 v[32:47], v[12:15], a[124:127], v[32:47]
s_waitcnt lgkmcnt(2)
ds_read_b128 v[8:11], v64 offset:35840
s_add_u32 s46, s46, 40960
v_mfma_f32_32x32x16_bf16 v[32:47], v[16:19], a[128:131], v[32:47]
s_waitcnt lgkmcnt(2)
ds_read_b128 v[12:15], v64 offset:36864
v_mfma_f32_32x32x16_bf16 v[32:47], v[20:23], a[132:135], v[32:47]
s_waitcnt lgkmcnt(2)
ds_read_b128 v[16:19], v64 offset:37888
v_mfma_f32_32x32x16_bf16 v[32:47], v[24:27], a[136:139], v[32:47]
s_waitcnt lgkmcnt(2)
ds_read_b128 v[20:23], v64 offset:38912
v_mfma_f32_32x32x16_bf16 v[32:47], v[8:11], a[140:143], v[32:47]
s_waitcnt lgkmcnt(2)
ds_read_b128 v[24:27], v64 offset:39936
v_mfma_f32_32x32x16_bf16 v[32:47], v[12:15], a[144:147], v[32:47]
s_add_u32 s44, s44, 1
s_cmp_eq_u32 s44, 3
s_mov_b32 s56, 40960
s_cmov_b32 s56, -81920
s_cselect_b32 s44, 0, s44
v_add_u32 v64, s56, v64
v_add_u32 v5, s56, v5
s_waitcnt vmcnt(10) lgkmcnt(2)
s_barrier
s_add_u32 s50, s50, 1
v_mov_b32 v4, s50
buffer_store_dword v4, v2, s[4:7], s60 offen sc1
ds_read_b128 v[8:11], v64 offset:0
v_mfma_f32_32x32x16_bf16 v[32:47], v[16:19], a[148:151], v[32:47]
s_waitcnt lgkmcnt(2)
ds_read_b128 v[12:15], v64 offset:1024
v_mfma_f32_32x32x16_bf16 v[32:47], v[20:23], a[152:155], v[32:47]
s_waitcnt lgkmcnt(2)
ds_read_b128 v[16:19], v64 offset:2048
v_mfma_f32_32x32x16_bf16 v[32:47], v[24:27], a[156:159], v[32:47]
s_waitcnt lgkmcnt(2)
ds_read_b128 v[20:23], v64 offset:3072
s_branch k_st_41
k_so_42:
ds_read_b128 v[80:83], v7 offset:1024
ds_read_b128 v[84:87], v7 offset:1040
v_mov_b32 v88, 0x3727c5ac
s_waitcnt lgkmcnt(0)
v_add_f32 v80, v80, v84
v_add_f32 v81, v81, v85
v_add_f32 v82, v82, v86
v_add_f32 v83, v83, v87
v_add_f32 v80, v80, v81
v_add_f32 v82, v82, v83
v_add_f32 v80, v80, v82
v_fma_f32 v80, v80, s61, v88
v_rsq_f32 v80, v80
ds_write_b32 v28, v80
ds_read_b128 v[80:83], v29 offset:0
ds_read_b128 v[84:87], v29 offset:32
ds_read_b128 v[88:91], v29 offset:64
ds_read_b128 v[92:95], v29 offset:96
s_waitcnt lgkmcnt(3)
v_mul_f32 v80, v80, v48
v_mul_f32 v81, v81, v49
v_mul_f32 v82, v82, v50
v_mul_f32 v83, v83, v51
s_waitcnt lgkmcnt(2)
v_mul_f32 v84, v84, v52
v_mul_f32 v85, v85, v53
v_mul_f32 v86, v86, v54
v_mul_f32 v87, v87, v55
s_waitcnt lgkmcnt(1)
v_mul_f32 v88, v88, v56
v_mul_f32 v89, v89, v57
v_mul_f32 v90, v90, v58
v_mul_f32 v91, v91, v59
s_waitcnt lgkmcnt(0)
v_mul_f32 v92, v92, v60
v_mul_f32 v93, v93, v61
v_mul_f32 v94, v94, v62
v_mul_f32 v95, v95, v63
v_cvt_pk_bf16_f32 v48, v80, v81
v_cvt_pk_bf16_f32 v49, v82, v83
v_cvt_pk_bf16_f32 v52, v84, v85
v_cvt_pk_bf16_f32 v53, v86, v87
v_cvt_pk_bf16_f32 v50, v88, v89
v_cvt_pk_bf16_f32 v51, v90, v91
v_cvt_pk_bf16_f32 v54, v92, v93
v_cvt_pk_bf16_f32 v55, v94, v95
buffer_store_dwordx4 v[48:51], v1, s[4:7], s48 offen offset:2048 sc1
buffer_store_dwordx4 v[52:55], v1, s[4:7], s48 offen offset:2560 sc1
s_add_u32 s48, s48, s49
k_join_34:
s_waitcnt vmcnt(0) lgkmcnt(0)
s_barrier
s_add_u32 s50, s50, 1
v_mov_b32 v4, s50
buffer_store_dword v4, v2, s[4:7], s60 offen sc1
s_cmp_lg_u32 s51, 0
s_cbranch_scc1 k_nxt_44
s_mul_i32 s46, s3, 10240
s_add_u32 s46, s46, 213909504
s_mul_i32 s45, s3, 10240
s_mov_b32 s44, 0
v_mov_b32 v64, v0
s_add_u32 m0, s45, 0
s_add_u32 s55, s46, 0
buffer_load_dwordx4 v0, s[4:7], s55 offen offset:0 sc1 lds
buffer_load_dwordx4 v0, s[4:7], s55 offen offset:1024 sc1 lds
buffer_load_dwordx4 v0, s[4:7], s55 offen offset:2048 sc1 lds
buffer_load_dwordx4 v0, s[4:7], s55 offen offset:3072 sc1 lds
s_add_u32 m0, s45, 4096
s_add_u32 s55, s46, 4096
buffer_load_dwordx4 v0, s[4:7], s55 offen offset:0 sc1 lds
buffer_load_dwordx4 v0, s[4:7], s55 offen offset:1024 sc1 lds
buffer_load_dwordx4 v0, s[4:7], s55 offen offset:2048 sc1 lds
buffer_load_dwordx4 v0, s[4:7], s55 offen offset:3072 sc1 lds
s_add_u32 m0, s45, 8192
s_add_u32 s55, s46, 8192
buffer_load_dwordx4 v0, s[4:7], s55 offen offset:0 sc1 lds
buffer_load_dwordx4 v0, s[4:7], s55 offen offset:1024 sc1 lds
s_add_u32 s45, s45, 40960
s_cmp_ge_u32 s45, 122880
s_cselect_b32 s55, 122880, 0
s_sub_u32 s45, s45, s55
s_add_u32 s46, s46, 40960
s_add_u32 m0, s45, 0
s_add_u32 s55, s46, 0
buffer_load_dwordx4 v0, s[4:7], s55 offen offset:0 sc1 lds
buffer_load_dwordx4 v0, s[4:7], s55 offen offset:1024 sc1 lds
buffer_load_dwordx4 v0, s[4:7], s55 offen offset:2048 sc1 lds
buffer_load_dwordx4 v0, s[4:7], s55 offen offset:3072 sc1 lds
s_add_u32 m0, s45, 4096
s_add_u32 s55, s46, 4096
buffer_load_dwordx4 v0, s[4:7], s55 offen offset:0 sc1 lds
buffer_load_dwordx4 v0, s[4:7], s55 offen offset:1024 sc1 lds
buffer_load_dwordx4 v0, s[4:7], s55 offen offset:2048 sc1 lds
buffer_load_dwordx4 v0, s[4:7], s55 offen offset:3072 sc1 lds
s_add_u32 m0, s45, 8192
s_add_u32 s55, s46, 8192
buffer_load_dwordx4 v0, s[4:7], s55 offen offset:0 sc1 lds
buffer_load_dwordx4 v0, s[4:7], s55 offen offset:1024 sc1 lds
s_add_u32 s45, s45, 40960
s_cmp_ge_u32 s45, 122880
s_cselect_b32 s55, 122880, 0
s_sub_u32 s45, s45, s55
s_add_u32 s46, s46, 40960
s_waitcnt vmcnt(10)
s_barrier
ds_read_b128 v[8:11], v64 offset:0
ds_read_b128 v[12:15], v64 offset:1024
ds_read_b128 v[16:19], v64 offset:2048
ds_read_b128 v[20:23], v64 offset:3072
v_mov_b32 v30, 0xffff
v_cmp_gt_u32 vcc, 512, v0
s_nop 1
v_cndmask_b32 v30, -1, v30, vcc
s_waitcnt lgkmcnt(3)
v_mfma_f32_32x32x16_bf16 v[32:47], v[8:11], v[96:99], 0
s_waitcnt lgkmcnt(2)
ds_read_b128 v[24:27], v64 offset:4096
v_mfma_f32_32x32x16_bf16 v[32:47], v[12:15], v[100:103], v[32:47]
s_waitcnt lgkmcnt(2)
ds_read_b128 v[8:11], v64 offset:5120
s_add_u32 m0, s45, 0
s_add_u32 s55, s46, 0
buffer_load_dwordx4 v0, s[4:7], s55 offen offset:0 sc1 lds
buffer_load_dwordx4 v0, s[4:7], s55 offen offset:1024 sc1 lds
v_mfma_f32_32x32x16_bf16 v[32:47], v[16:19], v[104:107], v[32:47]
s_waitcnt lgkmcnt(2)
ds_read_b128 v[12:15], v64 offset:6144
buffer_load_dwordx4 v0, s[4:7], s55 offen offset:2048 sc1 lds
buffer_load_dwordx4 v0, s[4:7], s55 offen offset:3072 sc1 lds
v_mfma_f32_32x32x16_bf16 v[32:47], v[20:23], v[108:111], v[32:47]
s_waitcnt lgkmcnt(2)
ds_read_b128 v[16:19], v64 offset:7168
s_add_u32 m0, s45, 4096
s_add_u32 s55, s46, 4096
buffer_load_dwordx4 v0, s[4:7], s55 offen offset:0 sc1 lds
buffer_load_dwordx4 v0, s[4:7], s55 offen offset:1024 sc1 lds
v_mfma_f32_32x32x16_bf16 v[32:47], v[24:27], v[112:115], v[32:47]
s_waitcnt lgkmcnt(2)
ds_read_b128 v[20:23], v64 offset:8192
buffer_load_dwordx4 v0, s[4:7], s55 offen offset:2048 sc1 lds
buffer_load_dwordx4 v0, s[4:7], s55 offen offset:3072 sc1 lds
v_mfma_f32_32x32x16_bf16 v[32:47], v[8:11], v[116:119], v[32:47]
s_waitcnt lgkmcnt(2)
ds_read_b128 v[24:27], v64 offset:9216
s_add_u32 m0, s45, 8192
s_add_u32 s55, s46, 8192
buffer_load_dwordx4 v0, s[4:7], s55 offen offset:0 sc1 lds
buffer_load_dwordx4 v0, s[4:7], s55 offen offset:1024 sc1 lds
v_mfma_f32_32x32x16_bf16 v[32:47], v[12:15], v[120:123], v[32:47]
s_waitcnt lgkmcnt(2)
ds_read_b128 v[8:11], v64 offset:10240
s_add_u32 s45, s45, 40960
s_cmp_ge_u32 s45, 122880
s_cselect_b32 s55, 122880, 0
s_sub_u32 s45, s45, s55
s_add_u32 s46, s46, 40960
v_mfma_f32_32x32x16_bf16 v[32:47], v[16:19], v[124:127], v[32:47]
s_waitcnt lgkmcnt(2)
ds_read_b128 v[12:15], v64 offset:11264
v_mfma_f32_32x32x16_bf16 v[32:47], v[20:23], v[128:131], v[32:47]
s_waitcnt lgkmcnt(2)
ds_read_b128 v[16:19], v64 offset:12288
v_mfma_f32_32x32x16_bf16 v[32:47], v[24:27], v[132:135], v[32:47]
s_waitcnt lgkmcnt(2)
ds_read_b128 v[20:23], v64 offset:13312
v_mfma_f32_32x32x16_bf16 v[32:47], v[8:11], v[136:139], v[32:47]
s_waitcnt lgkmcnt(2)
ds_read_b128 v[24:27], v64 offset:14336
v_mfma_f32_32x32x16_bf16 v[32:47], v[12:15], v[140:143], v[32:47]
s_waitcnt lgkmcnt(2)
ds_read_b128 v[8:11], v64 offset:15360
v_mfma_f32_32x32x16_bf16 v[32:47], v[16:19], v[144:147], v[32:47]
s_waitcnt lgkmcnt(2)
ds_read_b128 v[12:15], v64 offset:16384
v_mfma_f32_32x32x16_bf16 v[32:47], v[20:23], v[148:151], v[32:47]
s_waitcnt lgkmcnt(2)
ds_read_b128 v[16:19], v64 offset:17408
v_mfma_f32_32x32x16_bf16 v[32:47], v[24:27], v[152:155], v[32:47]
s_waitcnt lgkmcnt(2)
ds_read_b128 v[20:23], v64 offset:18432
v_mfma_f32_32x32x16_bf16 v[32:47], v[8:11], v[156:159], v[32:47]
s_waitcnt lgkmcnt(2)
ds_read_b128 v[24:27], v64 offset:19456
v_mfma_f32_32x32x16_bf16 v[32:47], v[12:15], v[160:163], v[32:47]
s_waitcnt lgkmcnt(2)
ds_read_b128 v[8:11], v64 offset:20480
v_mfma_f32_32x32x16_bf16 v[32:47], v[16:19], v[164:167], v[32:47]
s_waitcnt lgkmcnt(2)
ds_read_b128 v[12:15], v64 offset:21504
v_mfma_f32_32x32x16_bf16 v[32:47], v[20:23], v[168:171], v[32:47]
s_waitcnt lgkmcnt(2)
ds_read_b128 v[16:19], v64 offset:22528
v_mfma_f32_32x32x16_bf16 v[32:47], v[24:27], v[172:175], v[32:47]
s_waitcnt lgkmcnt(2)
ds_read_b128 v[20:23], v64 offset:23552
v_mfma_f32_32x32x16_bf16 v[32:47], v[8:11], v[176:179], v[32:47]
s_waitcnt lgkmcnt(2)
ds_read_b128 v[24:27], v64 offset:24576
v_mfma_f32_32x32x16_bf16 v[32:47], v[12:15], v[180:183], v[32:47]
s_waitcnt lgkmcnt(2)
ds_read_b128 v[8:11], v64 offset:25600
v_mfma_f32_32x32x16_bf16 v[32:47], v[16:19], v[184:187], v[32:47]
s_waitcnt lgkmcnt(2)
ds_read_b128 v[12:15], v64 offset:26624
v_mfma_f32_32x32x16_bf16 v[32:47], v[20:23], v[188:191], v[32:47]
s_waitcnt lgkmcnt(2)
ds_read_b128 v[16:19], v64 offset:27648
v_mfma_f32_32x32x16_bf16 v[32:47], v[24:27], v[192:195], v[32:47]
s_waitcnt lgkmcnt(2)
ds_read_b128 v[20:23], v64 offset:28672
v_mfma_f32_32x32x16_bf16 v[32:47], v[8:11], v[196:199], v[32:47]
s_waitcnt lgkmcnt(2)
ds_read_b128 v[24:27], v64 offset:29696
v_mfma_f32_32x32x16_bf16 v[32:47], v[12:15], v[200:203], v[32:47]
s_waitcnt lgkmcnt(2)
ds_read_b128 v[8:11], v64 offset:30720
v_mfma_f32_32x32x16_bf16 v[32:47], v[16:19], v[204:207], v[32:47]
s_waitcnt lgkmcnt(2)
ds_read_b128 v[12:15], v64 offset:31744
v_mfma_f32_32x32x16_bf16 v[32:47], v[20:23], v[208:211], v[32:47]
s_waitcnt lgkmcnt(2)
ds_read_b128 v[16:19], v64 offset:32768
v_mfma_f32_32x32x16_bf16 v[32:47], v[24:27], v[212:215], v[32:47]
s_waitcnt lgkmcnt(2)
ds_read_b128 v[20:23], v64 offset:33792
v_mfma_f32_32x32x16_bf16 v[32:47], v[8:11], v[216:219], v[32:47]
s_waitcnt lgkmcnt(2)
ds_read_b128 v[24:27], v64 offset:34816
v_mfma_f32_32x32x16_bf16 v[32:47], v[12:15], v[220:223], v[32:47]
s_waitcnt lgkmcnt(2)
ds_read_b128 v[8:11], v64 offset:35840
v_mfma_f32_32x32x16_bf16 v[32:47], v[16:19], v[224:227], v[32:47]
s_waitcnt lgkmcnt(2)
ds_read_b128 v[12:15], v64 offset:36864
v_mfma_f32_32x32x16_bf16 v[32:47], v[20:23], v[228:231], v[32:47]
s_waitcnt lgkmcnt(2)
ds_read_b128 v[16:19], v64 offset:37888
v_mfma_f32_32x32x16_bf16 v[32:47], v[24:27], v[232:235], v[32:47]
s_waitcnt lgkmcnt(2)
ds_read_b128 v[20:23], v64 offset:38912
v_mfma_f32_32x32x16_bf16 v[32:47], v[8:11], v[236:239], v[32:47]
s_waitcnt lgkmcnt(2)
ds_read_b128 v[24:27], v64 offset:39936
v_mfma_f32_32x32x16_bf16 v[32:47], v[12:15], v[240:243], v[32:47]
s_add_u32 s44, s44, 1
s_cmp_eq_u32 s44, 3
s_mov_b32 s56, 40960
s_cmov_b32 s56, -81920
s_cselect_b32 s44, 0, s44
v_add_u32 v64, s56, v64
s_waitcnt vmcnt(10) lgkmcnt(2)
s_barrier
ds_read_b128 v[8:11], v64 offset:0
v_mfma_f32_32x32x16_bf16 v[32:47], v[16:19], v[244:247], v[32:47]
s_waitcnt lgkmcnt(2)
ds_read_b128 v[12:15], v64 offset:1024
v_mfma_f32_32x32x16_bf16 v[32:47], v[20:23], v[248:251], v[32:47]
s_waitcnt lgkmcnt(2)
ds_read_b128 v[16:19], v64 offset:2048
v_mfma_f32_32x32x16_bf16 v[32:47], v[24:27], v[252:255], v[32:47]
s_waitcnt lgkmcnt(2)
ds_read_b128 v[20:23], v64 offset:3072
v_mfma_f32_32x32x16_bf16 v[48:63], v[8:11], v[96:99], 0
s_waitcnt lgkmcnt(2)
ds_read_b128 v[24:27], v64 offset:4096
v_mfma_f32_32x32x16_bf16 v[48:63], v[12:15], v[100:103], v[48:63]
s_waitcnt lgkmcnt(2)
ds_read_b128 v[8:11], v64 offset:5120
v_cvt_pk_bf16_f32 v32, v32, v33
v_cvt_pk_bf16_f32 v33, v34, v35
v_mfma_f32_32x32x16_bf16 v[48:63], v[16:19], v[104:107], v[48:63]
s_waitcnt lgkmcnt(2)
ds_read_b128 v[12:15], v64 offset:6144
v_cvt_pk_bf16_f32 v34, v36, v37
v_cvt_pk_bf16_f32 v35, v38, v39
v_mfma_f32_32x32x16_bf16 v[48:63], v[20:23], v[108:111], v[48:63]
s_waitcnt lgkmcnt(2)
ds_read_b128 v[16:19], v64 offset:7168
v_cvt_pk_bf16_f32 v36, v40, v41
v_cvt_pk_bf16_f32 v37, v42, v43
v_mfma_f32_32x32x16_bf16 v[48:63], v[24:27], v[112:115], v[48:63]
s_waitcnt lgkmcnt(2)
ds_read_b128 v[20:23], v64 offset:8192
v_cvt_pk_bf16_f32 v38, v44, v45
v_cvt_pk_bf16_f32 v39, v46, v47
v_mfma_f32_32x32x16_bf16 v[48:63], v[8:11], v[116:119], v[48:63]
s_waitcnt lgkmcnt(2)
ds_read_b128 v[24:27], v64 offset:9216
v_and_b32 v32, v30, v32
v_accvgpr_write_b32 a0, v32
v_mfma_f32_32x32x16_bf16 v[48:63], v[12:15], v[120:123], v[48:63]
s_waitcnt lgkmcnt(2)
ds_read_b128 v[8:11], v64 offset:10240
v_accvgpr_write_b32 a1, v33
v_accvgpr_write_b32 a2, v34
v_mfma_f32_32x32x16_bf16 v[48:63], v[16:19], v[124:127], v[48:63]
s_waitcnt lgkmcnt(2)
ds_read_b128 v[12:15], v64 offset:11264
v_accvgpr_write_b32 a3, v35
v_accvgpr_write_b32 a4, v36
v_mfma_f32_32x32x16_bf16 v[48:63], v[20:23], v[128:131], v[48:63]
s_waitcnt lgkmcnt(2)
ds_read_b128 v[16:19], v64 offset:12288
v_accvgpr_write_b32 a5, v37
v_accvgpr_write_b32 a6, v38
v_mfma_f32_32x32x16_bf16 v[48:63], v[24:27], v[132:135], v[48:63]
s_waitcnt lgkmcnt(2)
ds_read_b128 v[20:23], v64 offset:13312
v_accvgpr_write_b32 a7, v39
s_add_u32 m0, s45, 0
s_add_u32 s55, s46, 0
buffer_load_dwordx4 v0, s[4:7], s55 offen offset:0 sc1 lds
v_mfma_f32_32x32x16_bf16 v[48:63], v[8:11], v[136:139], v[48:63]
s_waitcnt lgkmcnt(2)
ds_read_b128 v[24:27], v64 offset:14336
buffer_load_dwordx4 v0, s[4:7], s55 offen offset:1024 sc1 lds
buffer_load_dwordx4 v0, s[4:7], s55 offen offset:2048 sc1 lds
v_mfma_f32_32x32x16_bf16 v[48:63], v[12:15], v[140:143], v[48:63]
s_waitcnt lgkmcnt(2)
ds_read_b128 v[8:11], v64 offset:15360
buffer_load_dwordx4 v0, s[4:7], s55 offen offset:3072 sc1 lds
s_add_u32 m0, s45, 4096
s_add_u32 s55, s46, 4096
buffer_load_dwordx4 v0, s[4:7], s55 offen offset:0 sc1 lds
v_mfma_f32_32x32x16_bf16 v[48:63], v[16:19], v[144:147], v[48:63]
s_waitcnt lgkmcnt(2)
ds_read_b128 v[12:15], v64 offset:16384
buffer_load_dwordx4 v0, s[4:7], s55 offen offset:1024 sc1 lds
buffer_load_dwordx4 v0, s[4:7], s55 offen offset:2048 sc1 lds
v_mfma_f32_32x32x16_bf16 v[48:63], v[20:23], v[148:151], v[48:63]
s_waitcnt lgkmcnt(2)
ds_read_b128 v[16:19], v64 offset:17408
buffer_load_dwordx4 v0, s[4:7], s55 offen offset:3072 sc1 lds
s_add_u32 m0, s45, 8192
s_add_u32 s55, s46, 8192
buffer_load_dwordx4 v0, s[4:7], s55 offen offset:0 sc1 lds
v_mfma_f32_32x32x16_bf16 v[48:63], v[24:27], v[152:155], v[48:63]
s_waitcnt lgkmcnt(2)
ds_read_b128 v[20:23], v64 offset:18432
buffer_load_dwordx4 v0, s[4:7], s55 offen offset:1024 sc1 lds
s_add_u32 s45, s45, 40960
s_cmp_ge_u32 s45, 122880
s_cselect_b32 s55, 122880, 0
s_sub_u32 s45, s45, s55
v_mfma_f32_32x32x16_bf16 v[48:63], v[8:11], v[156:159], v[48:63]
s_waitcnt lgkmcnt(2)
ds_read_b128 v[24:27], v64 offset:19456
s_add_u32 s46, s46, 40960
v_mfma_f32_32x32x16_bf16 v[48:63], v[12:15], v[160:163], v[48:63]
s_waitcnt lgkmcnt(2)
ds_read_b128 v[8:11], v64 offset:20480
v_mfma_f32_32x32x16_bf16 v[48:63], v[16:19], v[164:167], v[48:63]
s_waitcnt lgkmcnt(2)
ds_read_b128 v[12:15], v64 offset:21504
v_mfma_f32_32x32x16_bf16 v[48:63], v[20:23], v[168:171], v[48:63]
s_waitcnt lgkmcnt(2)
ds_read_b128 v[16:19], v64 offset:22528
v_mfma_f32_32x32x16_bf16 v[48:63], v[24:27], v[172:175], v[48:63]
s_waitcnt lgkmcnt(2)
ds_read_b128 v[20:23], v64 offset:23552
v_mfma_f32_32x32x16_bf16 v[48:63], v[8:11], v[176:179], v[48:63]
s_waitcnt lgkmcnt(2)
ds_read_b128 v[24:27], v64 offset:24576
v_mfma_f32_32x32x16_bf16 v[48:63], v[12:15], v[180:183], v[48:63]
s_waitcnt lgkmcnt(2)
ds_read_b128 v[8:11], v64 offset:25600
v_mfma_f32_32x32x16_bf16 v[48:63], v[16:19], v[184:187], v[48:63]
s_waitcnt lgkmcnt(2)
ds_read_b128 v[12:15], v64 offset:26624
v_mfma_f32_32x32x16_bf16 v[48:63], v[20:23], v[188:191], v[48:63]
s_waitcnt lgkmcnt(2)
ds_read_b128 v[16:19], v64 offset:27648
v_mfma_f32_32x32x16_bf16 v[48:63], v[24:27], v[192:195], v[48:63]
s_waitcnt lgkmcnt(2)
ds_read_b128 v[20:23], v64 offset:28672
v_mfma_f32_32x32x16_bf16 v[48:63], v[8:11], v[196:199], v[48:63]
s_waitcnt lgkmcnt(2)
ds_read_b128 v[24:27], v64 offset:29696
v_mfma_f32_32x32x16_bf16 v[48:63], v[12:15], v[200:203], v[48:63]
s_waitcnt lgkmcnt(2)
ds_read_b128 v[8:11], v64 offset:30720
v_mfma_f32_32x32x16_bf16 v[48:63], v[16:19], v[204:207], v[48:63]
s_waitcnt lgkmcnt(2)
ds_read_b128 v[12:15], v64 offset:31744
v_mfma_f32_32x32x16_bf16 v[48:63], v[20:23], v[208:211], v[48:63]
s_waitcnt lgkmcnt(2)
ds_read_b128 v[16:19], v64 offset:32768
v_mfma_f32_32x32x16_bf16 v[48:63], v[24:27], v[212:215], v[48:63]
s_waitcnt lgkmcnt(2)
ds_read_b128 v[20:23], v64 offset:33792
v_mfma_f32_32x32x16_bf16 v[48:63], v[8:11], v[216:219], v[48:63]
s_waitcnt lgkmcnt(2)
ds_read_b128 v[24:27], v64 offset:34816
v_mfma_f32_32x32x16_bf16 v[48:63], v[12:15], v[220:223], v[48:63]
s_waitcnt lgkmcnt(2)
ds_read_b128 v[8:11], v64 offset:35840
v_mfma_f32_32x32x16_bf16 v[48:63], v[16:19], v[224:227], v[48:63]
s_waitcnt lgkmcnt(2)
ds_read_b128 v[12:15], v64 offset:36864
v_mfma_f32_32x32x16_bf16 v[48:63], v[20:23], v[228:231], v[48:63]
s_waitcnt lgkmcnt(2)
ds_read_b128 v[16:19], v64 offset:37888
v_mfma_f32_32x32x16_bf16 v[48:63], v[24:27], v[232:235], v[48:63]
s_waitcnt lgkmcnt(2)
ds_read_b128 v[20:23], v64 offset:38912
v_mfma_f32_32x32x16_bf16 v[48:63], v[8:11], v[236:239], v[48:63]
s_waitcnt lgkmcnt(2)
ds_read_b128 v[24:27], v64 offset:39936
v_mfma_f32_32x32x16_bf16 v[48:63], v[12:15], v[240:243], v[48:63]
s_add_u32 s44, s44, 1
s_cmp_eq_u32 s44, 3
s_mov_b32 s56, 40960
s_cmov_b32 s56, -81920
s_cselect_b32 s44, 0, s44
v_add_u32 v64, s56, v64
s_waitcnt vmcnt(10) lgkmcnt(2)
s_barrier
ds_read_b128 v[8:11], v64 offset:0
v_mfma_f32_32x32x16_bf16 v[48:63], v[16:19], v[244:247], v[48:63]
s_waitcnt lgkmcnt(2)
ds_read_b128 v[12:15], v64 offset:1024
v_mfma_f32_32x32x16_bf16 v[48:63], v[20:23], v[248:251], v[48:63]
s_waitcnt lgkmcnt(2)
ds_read_b128 v[16:19], v64 offset:2048
v_mfma_f32_32x32x16_bf16 v[48:63], v[24:27], v[252:255], v[48:63]
s_waitcnt lgkmcnt(2)
ds_read_b128 v[20:23], v64 offset:3072
v_mfma_f32_32x32x16_bf16 v[32:47], v[8:11], v[96:99], 0
s_waitcnt lgkmcnt(2)
ds_read_b128 v[24:27], v64 offset:4096
v_mfma_f32_32x32x16_bf16 v[32:47], v[12:15], v[100:103], v[32:47]
s_waitcnt lgkmcnt(2)
ds_read_b128 v[8:11], v64 offset:5120
v_cvt_pk_bf16_f32 v48, v48, v49
v_cvt_pk_bf16_f32 v49, v50, v51
v_mfma_f32_32x32x16_bf16 v[32:47], v[16:19], v[104:107], v[32:47]
s_waitcnt lgkmcnt(2)
ds_read_b128 v[12:15], v64 offset:6144
v_cvt_pk_bf16_f32 v50, v52, v53
v_cvt_pk_bf16_f32 v51, v54, v55
v_mfma_f32_32x32x16_bf16 v[32:47], v[20:23], v[108:111], v[32:47]
s_waitcnt lgkmcnt(2)
ds_read_b128 v[16:19], v64 offset:7168
v_cvt_pk_bf16_f32 v52, v56, v57
v_cvt_pk_bf16_f32 v53, v58, v59
v_mfma_f32_32x32x16_bf16 v[32:47], v[24:27], v[112:115], v[32:47]
s_waitcnt lgkmcnt(2)
ds_read_b128 v[20:23], v64 offset:8192
v_cvt_pk_bf16_f32 v54, v60, v61
v_cvt_pk_bf16_f32 v55, v62, v63
v_mfma_f32_32x32x16_bf16 v[32:47], v[8:11], v[116:119], v[32:47]
s_waitcnt lgkmcnt(2)
ds_read_b128 v[24:27], v64 offset:9216
v_accvgpr_write_b32 a8, v48
v_accvgpr_write_b32 a9, v49
v_mfma_f32_32x32x16_bf16 v[32:47], v[12:15], v[120:123], v[32:47]
s_waitcnt lgkmcnt(2)
ds_read_b128 v[8:11], v64 offset:10240
v_accvgpr_write_b32 a10, v50
v_accvgpr_write_b32 a11, v51
v_mfma_f32_32x32x16_bf16 v[32:47], v[16:19], v[124:127], v[32:47]
s_waitcnt lgkmcnt(2)
ds_read_b128 v[12:15], v64 offset:11264
v_accvgpr_write_b32 a12, v52
v_accvgpr_write_b32 a13, v53
v_mfma_f32_32x32x16_bf16 v[32:47], v[20:23], v[128:131], v[32:47]
s_waitcnt lgkmcnt(2)
ds_read_b128 v[16:19], v64 offset:12288
v_accvgpr_write_b32 a14, v54
v_accvgpr_write_b32 a15, v55
v_mfma_f32_32x32x16_bf16 v[32:47], v[24:27], v[132:135], v[32:47]
s_waitcnt lgkmcnt(2)
ds_read_b128 v[20:23], v64 offset:13312
s_add_u32 m0, s45, 0
s_add_u32 s55, s46, 0
buffer_load_dwordx4 v0, s[4:7], s55 offen offset:0 sc1 lds
buffer_load_dwordx4 v0, s[4:7], s55 offen offset:1024 sc1 lds
v_mfma_f32_32x32x16_bf16 v[32:47], v[8:11], v[136:139], v[32:47]
s_waitcnt lgkmcnt(2)
ds_read_b128 v[24:27], v64 offset:14336
buffer_load_dwordx4 v0, s[4:7], s55 offen offset:2048 sc1 lds
buffer_load_dwordx4 v0, s[4:7], s55 offen offset:3072 sc1 lds
v_mfma_f32_32x32x16_bf16 v[32:47], v[12:15], v[140:143], v[32:47]
s_waitcnt lgkmcnt(2)
ds_read_b128 v[8:11], v64 offset:15360
s_add_u32 m0, s45, 4096
s_add_u32 s55, s46, 4096
buffer_load_dwordx4 v0, s[4:7], s55 offen offset:0 sc1 lds
buffer_load_dwordx4 v0, s[4:7], s55 offen offset:1024 sc1 lds
v_mfma_f32_32x32x16_bf16 v[32:47], v[16:19], v[144:147], v[32:47]
s_waitcnt lgkmcnt(2)
ds_read_b128 v[12:15], v64 offset:16384
buffer_load_dwordx4 v0, s[4:7], s55 offen offset:2048 sc1 lds
buffer_load_dwordx4 v0, s[4:7], s55 offen offset:3072 sc1 lds
v_mfma_f32_32x32x16_bf16 v[32:47], v[20:23], v[148:151], v[32:47]
s_waitcnt lgkmcnt(2)
ds_read_b128 v[16:19], v64 offset:17408
s_add_u32 m0, s45, 8192
s_add_u32 s55, s46, 8192
buffer_load_dwordx4 v0, s[4:7], s55 offen offset:0 sc1 lds
buffer_load_dwordx4 v0, s[4:7], s55 offen offset:1024 sc1 lds
v_mfma_f32_32x32x16_bf16 v[32:47], v[24:27], v[152:155], v[32:47]
s_waitcnt lgkmcnt(2)
ds_read_b128 v[20:23], v64 offset:18432
s_add_u32 s45, s45, 40960
s_cmp_ge_u32 s45, 122880
s_cselect_b32 s55, 122880, 0
s_sub_u32 s45, s45, s55
s_add_u32 s46, s46, 40960
v_mfma_f32_32x32x16_bf16 v[32:47], v[8:11], v[156:159], v[32:47]
s_waitcnt lgkmcnt(2)
ds_read_b128 v[24:27], v64 offset:19456
v_mfma_f32_32x32x16_bf16 v[32:47], v[12:15], v[160:163], v[32:47]
s_waitcnt lgkmcnt(2)
ds_read_b128 v[8:11], v64 offset:20480
v_mfma_f32_32x32x16_bf16 v[32:47], v[16:19], v[164:167], v[32:47]
s_waitcnt lgkmcnt(2)
ds_read_b128 v[12:15], v64 offset:21504
v_mfma_f32_32x32x16_bf16 v[32:47], v[20:23], v[168:171], v[32:47]
s_waitcnt lgkmcnt(2)
ds_read_b128 v[16:19], v64 offset:22528
v_mfma_f32_32x32x16_bf16 v[32:47], v[24:27], v[172:175], v[32:47]
s_waitcnt lgkmcnt(2)
ds_read_b128 v[20:23], v64 offset:23552
v_mfma_f32_32x32x16_bf16 v[32:47], v[8:11], v[176:179], v[32:47]
s_waitcnt lgkmcnt(2)
ds_read_b128 v[24:27], v64 offset:24576
v_mfma_f32_32x32x16_bf16 v[32:47], v[12:15], v[180:183], v[32:47]
s_waitcnt lgkmcnt(2)
ds_read_b128 v[8:11], v64 offset:25600
v_mfma_f32_32x32x16_bf16 v[32:47], v[16:19], v[184:187], v[32:47]
s_waitcnt lgkmcnt(2)
ds_read_b128 v[12:15], v64 offset:26624
v_mfma_f32_32x32x16_bf16 v[32:47], v[20:23], v[188:191], v[32:47]
s_waitcnt lgkmcnt(2)
ds_read_b128 v[16:19], v64 offset:27648
v_mfma_f32_32x32x16_bf16 v[32:47], v[24:27], v[192:195], v[32:47]
s_waitcnt lgkmcnt(2)
ds_read_b128 v[20:23], v64 offset:28672
v_mfma_f32_32x32x16_bf16 v[32:47], v[8:11], v[196:199], v[32:47]
s_waitcnt lgkmcnt(2)
ds_read_b128 v[24:27], v64 offset:29696
v_mfma_f32_32x32x16_bf16 v[32:47], v[12:15], v[200:203], v[32:47]
s_waitcnt lgkmcnt(2)
ds_read_b128 v[8:11], v64 offset:30720
v_mfma_f32_32x32x16_bf16 v[32:47], v[16:19], v[204:207], v[32:47]
s_waitcnt lgkmcnt(2)
ds_read_b128 v[12:15], v64 offset:31744
v_mfma_f32_32x32x16_bf16 v[32:47], v[20:23], v[208:211], v[32:47]
s_waitcnt lgkmcnt(2)
ds_read_b128 v[16:19], v64 offset:32768
v_mfma_f32_32x32x16_bf16 v[32:47], v[24:27], v[212:215], v[32:47]
s_waitcnt lgkmcnt(2)
ds_read_b128 v[20:23], v64 offset:33792
v_mfma_f32_32x32x16_bf16 v[32:47], v[8:11], v[216:219], v[32:47]
s_waitcnt lgkmcnt(2)
ds_read_b128 v[24:27], v64 offset:34816
v_mfma_f32_32x32x16_bf16 v[32:47], v[12:15], v[220:223], v[32:47]
s_waitcnt lgkmcnt(2)
ds_read_b128 v[8:11], v64 offset:35840
v_mfma_f32_32x32x16_bf16 v[32:47], v[16:19], v[224:227], v[32:47]
s_waitcnt lgkmcnt(2)
ds_read_b128 v[12:15], v64 offset:36864
v_mfma_f32_32x32x16_bf16 v[32:47], v[20:23], v[228:231], v[32:47]
s_waitcnt lgkmcnt(2)
ds_read_b128 v[16:19], v64 offset:37888
v_mfma_f32_32x32x16_bf16 v[32:47], v[24:27], v[232:235], v[32:47]
s_waitcnt lgkmcnt(2)
ds_read_b128 v[20:23], v64 offset:38912
v_mfma_f32_32x32x16_bf16 v[32:47], v[8:11], v[236:239], v[32:47]
s_waitcnt lgkmcnt(2)
ds_read_b128 v[24:27], v64 offset:39936
v_mfma_f32_32x32x16_bf16 v[32:47], v[12:15], v[240:243], v[32:47]
s_add_u32 s44, s44, 1
s_cmp_eq_u32 s44, 3
s_mov_b32 s56, 40960
s_cmov_b32 s56, -81920
s_cselect_b32 s44, 0, s44
v_add_u32 v64, s56, v64
s_waitcnt vmcnt(10) lgkmcnt(2)
s_barrier
ds_read_b128 v[8:11], v64 offset:0
v_mfma_f32_32x32x16_bf16 v[32:47], v[16:19], v[244:247], v[32:47]
s_waitcnt lgkmcnt(2)
ds_read_b128 v[12:15], v64 offset:1024
v_mfma_f32_32x32x16_bf16 v[32:47], v[20:23], v[248:251], v[32:47]
s_waitcnt lgkmcnt(2)
ds_read_b128 v[16:19], v64 offset:2048
v_mfma_f32_32x32x16_bf16 v[32:47], v[24:27], v[252:255], v[32:47]
s_waitcnt lgkmcnt(2)
ds_read_b128 v[20:23], v64 offset:3072
v_mfma_f32_32x32x16_bf16 v[48:63], v[8:11], v[96:99], 0
s_waitcnt lgkmcnt(2)
ds_read_b128 v[24:27], v64 offset:4096
v_mfma_f32_32x32x16_bf16 v[48:63], v[12:15], v[100:103], v[48:63]
s_waitcnt lgkmcnt(2)
ds_read_b128 v[8:11], v64 offset:5120
v_cvt_pk_bf16_f32 v32, v32, v33
v_cvt_pk_bf16_f32 v33, v34, v35
v_mfma_f32_32x32x16_bf16 v[48:63], v[16:19], v[104:107], v[48:63]
s_waitcnt lgkmcnt(2)
ds_read_b128 v[12:15], v64 offset:6144
v_cvt_pk_bf16_f32 v34, v36, v37
v_cvt_pk_bf16_f32 v35, v38, v39
v_mfma_f32_32x32x16_bf16 v[48:63], v[20:23], v[108:111], v[48:63]
s_waitcnt lgkmcnt(2)
ds_read_b128 v[16:19], v64 offset:7168
v_cvt_pk_bf16_f32 v36, v40, v41
v_cvt_pk_bf16_f32 v37, v42, v43
v_mfma_f32_32x32x16_bf16 v[48:63], v[24:27], v[112:115], v[48:63]
s_waitcnt lgkmcnt(2)
ds_read_b128 v[20:23], v64 offset:8192
v_cvt_pk_bf16_f32 v38, v44, v45
v_cvt_pk_bf16_f32 v39, v46, v47
v_mfma_f32_32x32x16_bf16 v[48:63], v[8:11], v[116:119], v[48:63]
s_waitcnt lgkmcnt(2)
ds_read_b128 v[24:27], v64 offset:9216
v_accvgpr_write_b32 a16, v32
v_accvgpr_write_b32 a17, v33
v_mfma_f32_32x32x16_bf16 v[48:63], v[12:15], v[120:123], v[48:63]
s_waitcnt lgkmcnt(2)
ds_read_b128 v[8:11], v64 offset:10240
v_accvgpr_write_b32 a18, v34
v_accvgpr_write_b32 a19, v35
v_mfma_f32_32x32x16_bf16 v[48:63], v[16:19], v[124:127], v[48:63]
s_waitcnt lgkmcnt(2)
ds_read_b128 v[12:15], v64 offset:11264
v_accvgpr_write_b32 a20, v36
v_accvgpr_write_b32 a21, v37
v_mfma_f32_32x32x16_bf16 v[48:63], v[20:23], v[128:131], v[48:63]
s_waitcnt lgkmcnt(2)
ds_read_b128 v[16:19], v64 offset:12288
v_accvgpr_write_b32 a22, v38
v_accvgpr_write_b32 a23, v39
v_mfma_f32_32x32x16_bf16 v[48:63], v[24:27], v[132:135], v[48:63]
s_waitcnt lgkmcnt(2)
ds_read_b128 v[20:23], v64 offset:13312
s_add_u32 m0, s45, 0
s_add_u32 s55, s46, 0
buffer_load_dwordx4 v0, s[4:7], s55 offen offset:0 sc1 lds
buffer_load_dwordx4 v0, s[4:7], s55 offen offset:1024 sc1 lds
v_mfma_f32_32x32x16_bf16 v[48:63], v[8:11], v[136:139], v[48:63]
s_waitcnt lgkmcnt(2)
ds_read_b128 v[24:27], v64 offset:14336
buffer_load_dwordx4 v0, s[4:7], s55 offen offset:2048 sc1 lds
buffer_load_dwordx4 v0, s[4:7], s55 offen offset:3072 sc1 lds
v_mfma_f32_32x32x16_bf16 v[48:63], v[12:15], v[140:143], v[48:63]
s_waitcnt lgkmcnt(2)
ds_read_b128 v[8:11], v64 offset:15360
s_add_u32 m0, s45, 4096
s_add_u32 s55, s46, 4096
buffer_load_dwordx4 v0, s[4:7], s55 offen offset:0 sc1 lds
buffer_load_dwordx4 v0, s[4:7], s55 offen offset:1024 sc1 lds
v_mfma_f32_32x32x16_bf16 v[48:63], v[16:19], v[144:147], v[48:63]
s_waitcnt lgkmcnt(2)
ds_read_b128 v[12:15], v64 offset:16384
buffer_load_dwordx4 v0, s[4:7], s55 offen offset:2048 sc1 lds
buffer_load_dwordx4 v0, s[4:7], s55 offen offset:3072 sc1 lds
v_mfma_f32_32x32x16_bf16 v[48:63], v[20:23], v[148:151], v[48:63]
s_waitcnt lgkmcnt(2)
ds_read_b128 v[16:19], v64 offset:17408
s_add_u32 m0, s45, 8192
s_add_u32 s55, s46, 8192
buffer_load_dwordx4 v0, s[4:7], s55 offen offset:0 sc1 lds
buffer_load_dwordx4 v0, s[4:7], s55 offen offset:1024 sc1 lds
v_mfma_f32_32x32x16_bf16 v[48:63], v[24:27], v[152:155], v[48:63]
s_waitcnt lgkmcnt(2)
ds_read_b128 v[20:23], v64 offset:18432
s_add_u32 s45, s45, 40960
s_cmp_ge_u32 s45, 122880
s_cselect_b32 s55, 122880, 0
s_sub_u32 s45, s45, s55
s_add_u32 s46, s46, 40960
v_mfma_f32_32x32x16_bf16 v[48:63], v[8:11], v[156:159], v[48:63]
s_waitcnt lgkmcnt(2)
ds_read_b128 v[24:27], v64 offset:19456
v_mfma_f32_32x32x16_bf16 v[48:63], v[12:15], v[160:163], v[48:63]
s_waitcnt lgkmcnt(2)
ds_read_b128 v[8:11], v64 offset:20480
v_mfma_f32_32x32x16_bf16 v[48:63], v[16:19], v[164:167], v[48:63]
s_waitcnt lgkmcnt(2)
ds_read_b128 v[12:15], v64 offset:21504
v_mfma_f32_32x32x16_bf16 v[48:63], v[20:23], v[168:171], v[48:63]
s_waitcnt lgkmcnt(2)
ds_read_b128 v[16:19], v64 offset:22528
v_mfma_f32_32x32x16_bf16 v[48:63], v[24:27], v[172:175], v[48:63]
s_waitcnt lgkmcnt(2)
ds_read_b128 v[20:23], v64 offset:23552
v_mfma_f32_32x32x16_bf16 v[48:63], v[8:11], v[176:179], v[48:63]
s_waitcnt lgkmcnt(2)
ds_read_b128 v[24:27], v64 offset:24576
v_mfma_f32_32x32x16_bf16 v[48:63], v[12:15], v[180:183], v[48:63]
s_waitcnt lgkmcnt(2)
ds_read_b128 v[8:11], v64 offset:25600
v_mfma_f32_32x32x16_bf16 v[48:63], v[16:19], v[184:187], v[48:63]
s_waitcnt lgkmcnt(2)
ds_read_b128 v[12:15], v64 offset:26624
v_mfma_f32_32x32x16_bf16 v[48:63], v[20:23], v[188:191], v[48:63]
s_waitcnt lgkmcnt(2)
ds_read_b128 v[16:19], v64 offset:27648
v_mfma_f32_32x32x16_bf16 v[48:63], v[24:27], v[192:195], v[48:63]
s_waitcnt lgkmcnt(2)
ds_read_b128 v[20:23], v64 offset:28672
v_mfma_f32_32x32x16_bf16 v[48:63], v[8:11], v[196:199], v[48:63]
s_waitcnt lgkmcnt(2)
ds_read_b128 v[24:27], v64 offset:29696
v_mfma_f32_32x32x16_bf16 v[48:63], v[12:15], v[200:203], v[48:63]
s_waitcnt lgkmcnt(2)
ds_read_b128 v[8:11], v64 offset:30720
v_mfma_f32_32x32x16_bf16 v[48:63], v[16:19], v[204:207], v[48:63]
s_waitcnt lgkmcnt(2)
ds_read_b128 v[12:15], v64 offset:31744
v_mfma_f32_32x32x16_bf16 v[48:63], v[20:23], v[208:211], v[48:63]
s_waitcnt lgkmcnt(2)
ds_read_b128 v[16:19], v64 offset:32768
v_mfma_f32_32x32x16_bf16 v[48:63], v[24:27], v[212:215], v[48:63]
s_waitcnt lgkmcnt(2)
ds_read_b128 v[20:23], v64 offset:33792
v_mfma_f32_32x32x16_bf16 v[48:63], v[8:11], v[216:219], v[48:63]
s_waitcnt lgkmcnt(2)
ds_read_b128 v[24:27], v64 offset:34816
v_mfma_f32_32x32x16_bf16 v[48:63], v[12:15], v[220:223], v[48:63]
s_waitcnt lgkmcnt(2)
ds_read_b128 v[8:11], v64 offset:35840
v_mfma_f32_32x32x16_bf16 v[48:63], v[16:19], v[224:227], v[48:63]
s_waitcnt lgkmcnt(2)
ds_read_b128 v[12:15], v64 offset:36864
v_mfma_f32_32x32x16_bf16 v[48:63], v[20:23], v[228:231], v[48:63]
s_waitcnt lgkmcnt(2)
ds_read_b128 v[16:19], v64 offset:37888
v_mfma_f32_32x32x16_bf16 v[48:63], v[24:27], v[232:235], v[48:63]
s_waitcnt lgkmcnt(2)
ds_read_b128 v[20:23], v64 offset:38912
v_mfma_f32_32x32x16_bf16 v[48:63], v[8:11], v[236:239], v[48:63]
s_waitcnt lgkmcnt(2)
ds_read_b128 v[24:27], v64 offset:39936
v_mfma_f32_32x32x16_bf16 v[48:63], v[12:15], v[240:243], v[48:63]
s_add_u32 s44, s44, 1
s_cmp_eq_u32 s44, 3
s_mov_b32 s56, 40960
s_cmov_b32 s56, -81920
s_cselect_b32 s44, 0, s44
v_add_u32 v64, s56, v64
s_waitcnt vmcnt(10) lgkmcnt(2)
s_barrier
ds_read_b128 v[8:11], v64 offset:0
v_mfma_f32_32x32x16_bf16 v[48:63], v[16:19], v[244:247], v[48:63]
s_waitcnt lgkmcnt(2)
ds_read_b128 v[12:15], v64 offset:1024
v_mfma_f32_32x32x16_bf16 v[48:63], v[20:23], v[248:251], v[48:63]
s_waitcnt lgkmcnt(2)
ds_read_b128 v[16:19], v64 offset:2048
v_mfma_f32_32x32x16_bf16 v[48:63], v[24:27], v[252:255], v[48:63]
s_waitcnt lgkmcnt(2)
ds_read_b128 v[20:23], v64 offset:3072
v_mfma_f32_32x32x16_bf16 v[32:47], v[8:11], v[96:99], 0
s_waitcnt lgkmcnt(2)
ds_read_b128 v[24:27], v64 offset:4096
v_mfma_f32_32x32x16_bf16 v[32:47], v[12:15], v[100:103], v[32:47]
s_waitcnt lgkmcnt(2)
ds_read_b128 v[8:11], v64 offset:5120
v_cvt_pk_bf16_f32 v48, v48, v49
v_cvt_pk_bf16_f32 v49, v50, v51
v_mfma_f32_32x32x16_bf16 v[32:47], v[16:19], v[104:107], v[32:47]
s_waitcnt lgkmcnt(2)
ds_read_b128 v[12:15], v64 offset:6144
v_cvt_pk_bf16_f32 v50, v52, v53
v_cvt_pk_bf16_f32 v51, v54, v55
v_mfma_f32_32x32x16_bf16 v[32:47], v[20:23], v[108:111], v[32:47]
s_waitcnt lgkmcnt(2)
ds_read_b128 v[16:19], v64 offset:7168
v_cvt_pk_bf16_f32 v52, v56, v57
v_cvt_pk_bf16_f32 v53, v58, v59
v_mfma_f32_32x32x16_bf16 v[32:47], v[24:27], v[112:115], v[32:47]
s_waitcnt lgkmcnt(2)
ds_read_b128 v[20:23], v64 offset:8192
v_cvt_pk_bf16_f32 v54, v60, v61
v_cvt_pk_bf16_f32 v55, v62, v63
v_mfma_f32_32x32x16_bf16 v[32:47], v[8:11], v[116:119], v[32:47]
s_waitcnt lgkmcnt(2)
ds_read_b128 v[24:27], v64 offset:9216
v_accvgpr_write_b32 a24, v48
v_accvgpr_write_b32 a25, v49
v_mfma_f32_32x32x16_bf16 v[32:47], v[12:15], v[120:123], v[32:47]
s_waitcnt lgkmcnt(2)
ds_read_b128 v[8:11], v64 offset:10240
v_accvgpr_write_b32 a26, v50
v_accvgpr_write_b32 a27, v51
v_mfma_f32_32x32x16_bf16 v[32:47], v[16:19], v[124:127], v[32:47]
s_waitcnt lgkmcnt(2)
ds_read_b128 v[12:15], v64 offset:11264
v_accvgpr_write_b32 a28, v52
v_accvgpr_write_b32 a29, v53
v_mfma_f32_32x32x16_bf16 v[32:47], v[20:23], v[128:131], v[32:47]
s_waitcnt lgkmcnt(2)
ds_read_b128 v[16:19], v64 offset:12288
v_accvgpr_write_b32 a30, v54
v_accvgpr_write_b32 a31, v55
v_mfma_f32_32x32x16_bf16 v[32:47], v[24:27], v[132:135], v[32:47]
s_waitcnt lgkmcnt(2)
ds_read_b128 v[20:23], v64 offset:13312
s_add_u32 m0, s45, 0
s_add_u32 s55, s46, 0
buffer_load_dwordx4 v0, s[4:7], s55 offen offset:0 sc1 lds
buffer_load_dwordx4 v0, s[4:7], s55 offen offset:1024 sc1 lds
v_mfma_f32_32x32x16_bf16 v[32:47], v[8:11], v[136:139], v[32:47]
s_waitcnt lgkmcnt(2)
ds_read_b128 v[24:27], v64 offset:14336
buffer_load_dwordx4 v0, s[4:7], s55 offen offset:2048 sc1 lds
buffer_load_dwordx4 v0, s[4:7], s55 offen offset:3072 sc1 lds
v_mfma_f32_32x32x16_bf16 v[32:47], v[12:15], v[140:143], v[32:47]
s_waitcnt lgkmcnt(2)
ds_read_b128 v[8:11], v64 offset:15360
s_add_u32 m0, s45, 4096
s_add_u32 s55, s46, 4096
buffer_load_dwordx4 v0, s[4:7], s55 offen offset:0 sc1 lds
buffer_load_dwordx4 v0, s[4:7], s55 offen offset:1024 sc1 lds
v_mfma_f32_32x32x16_bf16 v[32:47], v[16:19], v[144:147], v[32:47]
s_waitcnt lgkmcnt(2)
ds_read_b128 v[12:15], v64 offset:16384
buffer_load_dwordx4 v0, s[4:7], s55 offen offset:2048 sc1 lds
buffer_load_dwordx4 v0, s[4:7], s55 offen offset:3072 sc1 lds
v_mfma_f32_32x32x16_bf16 v[32:47], v[20:23], v[148:151], v[32:47]
s_waitcnt lgkmcnt(2)
ds_read_b128 v[16:19], v64 offset:17408
s_add_u32 m0, s45, 8192
s_add_u32 s55, s46, 8192
buffer_load_dwordx4 v0, s[4:7], s55 offen offset:0 sc1 lds
buffer_load_dwordx4 v0, s[4:7], s55 offen offset:1024 sc1 lds
v_mfma_f32_32x32x16_bf16 v[32:47], v[24:27], v[152:155], v[32:47]
s_waitcnt lgkmcnt(2)
ds_read_b128 v[20:23], v64 offset:18432
s_add_u32 s45, s45, 40960
s_cmp_ge_u32 s45, 122880
s_cselect_b32 s55, 122880, 0
s_sub_u32 s45, s45, s55
s_add_u32 s46, s46, 40960
v_mfma_f32_32x32x16_bf16 v[32:47], v[8:11], v[156:159], v[32:47]
s_waitcnt lgkmcnt(2)
ds_read_b128 v[24:27], v64 offset:19456
v_mfma_f32_32x32x16_bf16 v[32:47], v[12:15], v[160:163], v[32:47]
s_waitcnt lgkmcnt(2)
ds_read_b128 v[8:11], v64 offset:20480
v_mfma_f32_32x32x16_bf16 v[32:47], v[16:19], v[164:167], v[32:47]
s_waitcnt lgkmcnt(2)
ds_read_b128 v[12:15], v64 offset:21504
v_mfma_f32_32x32x16_bf16 v[32:47], v[20:23], v[168:171], v[32:47]
s_waitcnt lgkmcnt(2)
ds_read_b128 v[16:19], v64 offset:22528
v_mfma_f32_32x32x16_bf16 v[32:47], v[24:27], v[172:175], v[32:47]
s_waitcnt lgkmcnt(2)
ds_read_b128 v[20:23], v64 offset:23552
v_mfma_f32_32x32x16_bf16 v[32:47], v[8:11], v[176:179], v[32:47]
s_waitcnt lgkmcnt(2)
ds_read_b128 v[24:27], v64 offset:24576
v_mfma_f32_32x32x16_bf16 v[32:47], v[12:15], v[180:183], v[32:47]
s_waitcnt lgkmcnt(2)
ds_read_b128 v[8:11], v64 offset:25600
v_mfma_f32_32x32x16_bf16 v[32:47], v[16:19], v[184:187], v[32:47]
s_waitcnt lgkmcnt(2)
ds_read_b128 v[12:15], v64 offset:26624
v_mfma_f32_32x32x16_bf16 v[32:47], v[20:23], v[188:191], v[32:47]
s_waitcnt lgkmcnt(2)
ds_read_b128 v[16:19], v64 offset:27648
v_mfma_f32_32x32x16_bf16 v[32:47], v[24:27], v[192:195], v[32:47]
s_waitcnt lgkmcnt(2)
ds_read_b128 v[20:23], v64 offset:28672
v_mfma_f32_32x32x16_bf16 v[32:47], v[8:11], v[196:199], v[32:47]
s_waitcnt lgkmcnt(2)
ds_read_b128 v[24:27], v64 offset:29696
v_mfma_f32_32x32x16_bf16 v[32:47], v[12:15], v[200:203], v[32:47]
s_waitcnt lgkmcnt(2)
ds_read_b128 v[8:11], v64 offset:30720
v_mfma_f32_32x32x16_bf16 v[32:47], v[16:19], v[204:207], v[32:47]
s_waitcnt lgkmcnt(2)
ds_read_b128 v[12:15], v64 offset:31744
v_mfma_f32_32x32x16_bf16 v[32:47], v[20:23], v[208:211], v[32:47]
s_waitcnt lgkmcnt(2)
ds_read_b128 v[16:19], v64 offset:32768
v_mfma_f32_32x32x16_bf16 v[32:47], v[24:27], v[212:215], v[32:47]
s_waitcnt lgkmcnt(2)
ds_read_b128 v[20:23], v64 offset:33792
v_mfma_f32_32x32x16_bf16 v[32:47], v[8:11], v[216:219], v[32:47]
s_waitcnt lgkmcnt(2)
ds_read_b128 v[24:27], v64 offset:34816
v_mfma_f32_32x32x16_bf16 v[32:47], v[12:15], v[220:223], v[32:47]
s_waitcnt lgkmcnt(2)
ds_read_b128 v[8:11], v64 offset:35840
v_mfma_f32_32x32x16_bf16 v[32:47], v[16:19], v[224:227], v[32:47]
s_waitcnt lgkmcnt(2)
ds_read_b128 v[12:15], v64 offset:36864
v_mfma_f32_32x32x16_bf16 v[32:47], v[20:23], v[228:231], v[32:47]
s_waitcnt lgkmcnt(2)
ds_read_b128 v[16:19], v64 offset:37888
v_mfma_f32_32x32x16_bf16 v[32:47], v[24:27], v[232:235], v[32:47]
s_waitcnt lgkmcnt(2)
ds_read_b128 v[20:23], v64 offset:38912
v_mfma_f32_32x32x16_bf16 v[32:47], v[8:11], v[236:239], v[32:47]
s_waitcnt lgkmcnt(2)
ds_read_b128 v[24:27], v64 offset:39936
v_mfma_f32_32x32x16_bf16 v[32:47], v[12:15], v[240:243], v[32:47]
s_add_u32 s44, s44, 1
s_cmp_eq_u32 s44, 3
s_mov_b32 s56, 40960
s_cmov_b32 s56, -81920
s_cselect_b32 s44, 0, s44
v_add_u32 v64, s56, v64
s_waitcnt vmcnt(10) lgkmcnt(2)
s_barrier
ds_read_b128 v[8:11], v64 offset:0
v_mfma_f32_32x32x16_bf16 v[32:47], v[16:19], v[244:247], v[32:47]
s_waitcnt lgkmcnt(2)
ds_read_b128 v[12:15], v64 offset:1024
v_mfma_f32_32x32x16_bf16 v[32:47], v[20:23], v[248:251], v[32:47]
s_waitcnt lgkmcnt(2)
ds_read_b128 v[16:19], v64 offset:2048
v_mfma_f32_32x32x16_bf16 v[32:47], v[24:27], v[252:255], v[32:47]
s_waitcnt lgkmcnt(2)
ds_read_b128 v[20:23], v64 offset:3072
v_mfma_f32_32x32x16_bf16 v[48:63], v[8:11], v[96:99], 0
s_waitcnt lgkmcnt(2)
ds_read_b128 v[24:27], v64 offset:4096
v_mfma_f32_32x32x16_bf16 v[48:63], v[12:15], v[100:103], v[48:63]
s_waitcnt lgkmcnt(2)
ds_read_b128 v[8:11], v64 offset:5120
v_cvt_pk_bf16_f32 v32, v32, v33
v_cvt_pk_bf16_f32 v33, v34, v35
v_mfma_f32_32x32x16_bf16 v[48:63], v[16:19], v[104:107], v[48:63]
s_waitcnt lgkmcnt(2)
ds_read_b128 v[12:15], v64 offset:6144
v_cvt_pk_bf16_f32 v34, v36, v37
v_cvt_pk_bf16_f32 v35, v38, v39
v_mfma_f32_32x32x16_bf16 v[48:63], v[20:23], v[108:111], v[48:63]
s_waitcnt lgkmcnt(2)
ds_read_b128 v[16:19], v64 offset:7168
v_cvt_pk_bf16_f32 v36, v40, v41
v_cvt_pk_bf16_f32 v37, v42, v43
v_mfma_f32_32x32x16_bf16 v[48:63], v[24:27], v[112:115], v[48:63]
s_waitcnt lgkmcnt(2)
ds_read_b128 v[20:23], v64 offset:8192
v_cvt_pk_bf16_f32 v38, v44, v45
v_cvt_pk_bf16_f32 v39, v46, v47
v_mfma_f32_32x32x16_bf16 v[48:63], v[8:11], v[116:119], v[48:63]
s_waitcnt lgkmcnt(2)
ds_read_b128 v[24:27], v64 offset:9216
v_accvgpr_write_b32 a32, v32
v_accvgpr_write_b32 a33, v33
v_mfma_f32_32x32x16_bf16 v[48:63], v[12:15], v[120:123], v[48:63]
s_waitcnt lgkmcnt(2)
ds_read_b128 v[8:11], v64 offset:10240
v_accvgpr_write_b32 a34, v34
v_accvgpr_write_b32 a35, v35
v_mfma_f32_32x32x16_bf16 v[48:63], v[16:19], v[124:127], v[48:63]
s_waitcnt lgkmcnt(2)
ds_read_b128 v[12:15], v64 offset:11264
v_accvgpr_write_b32 a36, v36
v_accvgpr_write_b32 a37, v37
v_mfma_f32_32x32x16_bf16 v[48:63], v[20:23], v[128:131], v[48:63]
s_waitcnt lgkmcnt(2)
ds_read_b128 v[16:19], v64 offset:12288
v_accvgpr_write_b32 a38, v38
v_accvgpr_write_b32 a39, v39
v_mfma_f32_32x32x16_bf16 v[48:63], v[24:27], v[132:135], v[48:63]
s_waitcnt lgkmcnt(2)
ds_read_b128 v[20:23], v64 offset:13312
s_add_u32 m0, s45, 0
s_add_u32 s55, s46, 0
buffer_load_dwordx4 v0, s[4:7], s55 offen offset:0 sc1 lds
buffer_load_dwordx4 v0, s[4:7], s55 offen offset:1024 sc1 lds
v_mfma_f32_32x32x16_bf16 v[48:63], v[8:11], v[136:139], v[48:63]
s_waitcnt lgkmcnt(2)
ds_read_b128 v[24:27], v64 offset:14336
buffer_load_dwordx4 v0, s[4:7], s55 offen offset:2048 sc1 lds
buffer_load_dwordx4 v0, s[4:7], s55 offen offset:3072 sc1 lds
v_mfma_f32_32x32x16_bf16 v[48:63], v[12:15], v[140:143], v[48:63]
s_waitcnt lgkmcnt(2)
ds_read_b128 v[8:11], v64 offset:15360
s_add_u32 m0, s45, 4096
s_add_u32 s55, s46, 4096
buffer_load_dwordx4 v0, s[4:7], s55 offen offset:0 sc1 lds
buffer_load_dwordx4 v0, s[4:7], s55 offen offset:1024 sc1 lds
v_mfma_f32_32x32x16_bf16 v[48:63], v[16:19], v[144:147], v[48:63]
s_waitcnt lgkmcnt(2)
ds_read_b128 v[12:15], v64 offset:16384
buffer_load_dwordx4 v0, s[4:7], s55 offen offset:2048 sc1 lds
buffer_load_dwordx4 v0, s[4:7], s55 offen offset:3072 sc1 lds
v_mfma_f32_32x32x16_bf16 v[48:63], v[20:23], v[148:151], v[48:63]
s_waitcnt lgkmcnt(2)
ds_read_b128 v[16:19], v64 offset:17408
s_add_u32 m0, s45, 8192
s_add_u32 s55, s46, 8192
buffer_load_dwordx4 v0, s[4:7], s55 offen offset:0 sc1 lds
buffer_load_dwordx4 v0, s[4:7], s55 offen offset:1024 sc1 lds
v_mfma_f32_32x32x16_bf16 v[48:63], v[24:27], v[152:155], v[48:63]
s_waitcnt lgkmcnt(2)
ds_read_b128 v[20:23], v64 offset:18432
s_add_u32 s45, s45, 40960
s_cmp_ge_u32 s45, 122880
s_cselect_b32 s55, 122880, 0
s_sub_u32 s45, s45, s55
s_add_u32 s46, s46, 40960
v_mfma_f32_32x32x16_bf16 v[48:63], v[8:11], v[156:159], v[48:63]
s_waitcnt lgkmcnt(2)
ds_read_b128 v[24:27], v64 offset:19456
v_mfma_f32_32x32x16_bf16 v[48:63], v[12:15], v[160:163], v[48:63]
s_waitcnt lgkmcnt(2)
ds_read_b128 v[8:11], v64 offset:20480
v_mfma_f32_32x32x16_bf16 v[48:63], v[16:19], v[164:167], v[48:63]
s_waitcnt lgkmcnt(2)
ds_read_b128 v[12:15], v64 offset:21504
v_mfma_f32_32x32x16_bf16 v[48:63], v[20:23], v[168:171], v[48:63]
s_waitcnt lgkmcnt(2)
ds_read_b128 v[16:19], v64 offset:22528
v_mfma_f32_32x32x16_bf16 v[48:63], v[24:27], v[172:175], v[48:63]
s_waitcnt lgkmcnt(2)
ds_read_b128 v[20:23], v64 offset:23552
v_mfma_f32_32x32x16_bf16 v[48:63], v[8:11], v[176:179], v[48:63]
s_waitcnt lgkmcnt(2)
ds_read_b128 v[24:27], v64 offset:24576
v_mfma_f32_32x32x16_bf16 v[48:63], v[12:15], v[180:183], v[48:63]
s_waitcnt lgkmcnt(2)
ds_read_b128 v[8:11], v64 offset:25600
v_mfma_f32_32x32x16_bf16 v[48:63], v[16:19], v[184:187], v[48:63]
s_waitcnt lgkmcnt(2)
ds_read_b128 v[12:15], v64 offset:26624
v_mfma_f32_32x32x16_bf16 v[48:63], v[20:23], v[188:191], v[48:63]
s_waitcnt lgkmcnt(2)
ds_read_b128 v[16:19], v64 offset:27648
v_mfma_f32_32x32x16_bf16 v[48:63], v[24:27], v[192:195], v[48:63]
s_waitcnt lgkmcnt(2)
ds_read_b128 v[20:23], v64 offset:28672
v_mfma_f32_32x32x16_bf16 v[48:63], v[8:11], v[196:199], v[48:63]
s_waitcnt lgkmcnt(2)
ds_read_b128 v[24:27], v64 offset:29696
v_mfma_f32_32x32x16_bf16 v[48:63], v[12:15], v[200:203], v[48:63]
s_waitcnt lgkmcnt(2)
ds_read_b128 v[8:11], v64 offset:30720
v_mfma_f32_32x32x16_bf16 v[48:63], v[16:19], v[204:207], v[48:63]
s_waitcnt lgkmcnt(2)
ds_read_b128 v[12:15], v64 offset:31744
v_mfma_f32_32x32x16_bf16 v[48:63], v[20:23], v[208:211], v[48:63]
s_waitcnt lgkmcnt(2)
ds_read_b128 v[16:19], v64 offset:32768
v_mfma_f32_32x32x16_bf16 v[48:63], v[24:27], v[212:215], v[48:63]
s_waitcnt lgkmcnt(2)
ds_read_b128 v[20:23], v64 offset:33792
v_mfma_f32_32x32x16_bf16 v[48:63], v[8:11], v[216:219], v[48:63]
s_waitcnt lgkmcnt(2)
ds_read_b128 v[24:27], v64 offset:34816
v_mfma_f32_32x32x16_bf16 v[48:63], v[12:15], v[220:223], v[48:63]
s_waitcnt lgkmcnt(2)
ds_read_b128 v[8:11], v64 offset:35840
v_mfma_f32_32x32x16_bf16 v[48:63], v[16:19], v[224:227], v[48:63]
s_waitcnt lgkmcnt(2)
ds_read_b128 v[12:15], v64 offset:36864
v_mfma_f32_32x32x16_bf16 v[48:63], v[20:23], v[228:231], v[48:63]
s_waitcnt lgkmcnt(2)
ds_read_b128 v[16:19], v64 offset:37888
v_mfma_f32_32x32x16_bf16 v[48:63], v[24:27], v[232:235], v[48:63]
s_waitcnt lgkmcnt(2)
ds_read_b128 v[20:23], v64 offset:38912
v_mfma_f32_32x32x16_bf16 v[48:63], v[8:11], v[236:239], v[48:63]
s_waitcnt lgkmcnt(2)
ds_read_b128 v[24:27], v64 offset:39936
v_mfma_f32_32x32x16_bf16 v[48:63], v[12:15], v[240:243], v[48:63]
s_add_u32 s44, s44, 1
s_cmp_eq_u32 s44, 3
s_mov_b32 s56, 40960
s_cmov_b32 s56, -81920
s_cselect_b32 s44, 0, s44
v_add_u32 v64, s56, v64
s_waitcnt vmcnt(10) lgkmcnt(2)
s_barrier
ds_read_b128 v[8:11], v64 offset:0
v_mfma_f32_32x32x16_bf16 v[48:63], v[16:19], v[244:247], v[48:63]
s_waitcnt lgkmcnt(2)
ds_read_b128 v[12:15], v64 offset:1024
v_mfma_f32_32x32x16_bf16 v[48:63], v[20:23], v[248:251], v[48:63]
s_waitcnt lgkmcnt(2)
ds_read_b128 v[16:19], v64 offset:2048
v_mfma_f32_32x32x16_bf16 v[48:63], v[24:27], v[252:255], v[48:63]
s_waitcnt lgkmcnt(2)
ds_read_b128 v[20:23], v64 offset:3072
v_mfma_f32_32x32x16_bf16 v[32:47], v[8:11], v[96:99], 0
s_waitcnt lgkmcnt(2)
ds_read_b128 v[24:27], v64 offset:4096
v_mfma_f32_32x32x16_bf16 v[32:47], v[12:15], v[100:103], v[32:47]
s_waitcnt lgkmcnt(2)
ds_read_b128 v[8:11], v64 offset:5120
v_cvt_pk_bf16_f32 v48, v48, v49
v_cvt_pk_bf16_f32 v49, v50, v51
v_mfma_f32_32x32x16_bf16 v[32:47], v[16:19], v[104:107], v[32:47]
s_waitcnt lgkmcnt(2)
ds_read_b128 v[12:15], v64 offset:6144
v_cvt_pk_bf16_f32 v50, v52, v53
v_cvt_pk_bf16_f32 v51, v54, v55
v_mfma_f32_32x32x16_bf16 v[32:47], v[20:23], v[108:111], v[32:47]
s_waitcnt lgkmcnt(2)
ds_read_b128 v[16:19], v64 offset:7168
v_cvt_pk_bf16_f32 v52, v56, v57
v_cvt_pk_bf16_f32 v53, v58, v59
v_mfma_f32_32x32x16_bf16 v[32:47], v[24:27], v[112:115], v[32:47]
s_waitcnt lgkmcnt(2)
ds_read_b128 v[20:23], v64 offset:8192
v_cvt_pk_bf16_f32 v54, v60, v61
v_cvt_pk_bf16_f32 v55, v62, v63
v_mfma_f32_32x32x16_bf16 v[32:47], v[8:11], v[116:119], v[32:47]
s_waitcnt lgkmcnt(2)
ds_read_b128 v[24:27], v64 offset:9216
v_accvgpr_write_b32 a40, v48
v_accvgpr_write_b32 a41, v49
v_mfma_f32_32x32x16_bf16 v[32:47], v[12:15], v[120:123], v[32:47]
s_waitcnt lgkmcnt(2)
ds_read_b128 v[8:11], v64 offset:10240
v_accvgpr_write_b32 a42, v50
v_accvgpr_write_b32 a43, v51
v_mfma_f32_32x32x16_bf16 v[32:47], v[16:19], v[124:127], v[32:47]
s_waitcnt lgkmcnt(2)
ds_read_b128 v[12:15], v64 offset:11264
v_accvgpr_write_b32 a44, v52
v_accvgpr_write_b32 a45, v53
v_mfma_f32_32x32x16_bf16 v[32:47], v[20:23], v[128:131], v[32:47]
s_waitcnt lgkmcnt(2)
ds_read_b128 v[16:19], v64 offset:12288
v_accvgpr_write_b32 a46, v54
v_accvgpr_write_b32 a47, v55
v_mfma_f32_32x32x16_bf16 v[32:47], v[24:27], v[132:135], v[32:47]
s_waitcnt lgkmcnt(2)
ds_read_b128 v[20:23], v64 offset:13312
s_add_u32 m0, s45, 0
s_add_u32 s55, s46, 0
buffer_load_dwordx4 v0, s[4:7], s55 offen offset:0 sc1 lds
buffer_load_dwordx4 v0, s[4:7], s55 offen offset:1024 sc1 lds
v_mfma_f32_32x32x16_bf16 v[32:47], v[8:11], v[136:139], v[32:47]
s_waitcnt lgkmcnt(2)
ds_read_b128 v[24:27], v64 offset:14336
buffer_load_dwordx4 v0, s[4:7], s55 offen offset:2048 sc1 lds
buffer_load_dwordx4 v0, s[4:7], s55 offen offset:3072 sc1 lds
v_mfma_f32_32x32x16_bf16 v[32:47], v[12:15], v[140:143], v[32:47]
s_waitcnt lgkmcnt(2)
ds_read_b128 v[8:11], v64 offset:15360
s_add_u32 m0, s45, 4096
s_add_u32 s55, s46, 4096
buffer_load_dwordx4 v0, s[4:7], s55 offen offset:0 sc1 lds
buffer_load_dwordx4 v0, s[4:7], s55 offen offset:1024 sc1 lds
v_mfma_f32_32x32x16_bf16 v[32:47], v[16:19], v[144:147], v[32:47]
s_waitcnt lgkmcnt(2)
ds_read_b128 v[12:15], v64 offset:16384
buffer_load_dwordx4 v0, s[4:7], s55 offen offset:2048 sc1 lds
buffer_load_dwordx4 v0, s[4:7], s55 offen offset:3072 sc1 lds
v_mfma_f32_32x32x16_bf16 v[32:47], v[20:23], v[148:151], v[32:47]
s_waitcnt lgkmcnt(2)
ds_read_b128 v[16:19], v64 offset:17408
s_add_u32 m0, s45, 8192
s_add_u32 s55, s46, 8192
buffer_load_dwordx4 v0, s[4:7], s55 offen offset:0 sc1 lds
buffer_load_dwordx4 v0, s[4:7], s55 offen offset:1024 sc1 lds
v_mfma_f32_32x32x16_bf16 v[32:47], v[24:27], v[152:155], v[32:47]
s_waitcnt lgkmcnt(2)
ds_read_b128 v[20:23], v64 offset:18432
s_add_u32 s45, s45, 40960
s_cmp_ge_u32 s45, 122880
s_cselect_b32 s55, 122880, 0
s_sub_u32 s45, s45, s55
s_add_u32 s46, s46, 40960
v_mfma_f32_32x32x16_bf16 v[32:47], v[8:11], v[156:159], v[32:47]
s_waitcnt lgkmcnt(2)
ds_read_b128 v[24:27], v64 offset:19456
v_mfma_f32_32x32x16_bf16 v[32:47], v[12:15], v[160:163], v[32:47]
s_waitcnt lgkmcnt(2)
ds_read_b128 v[8:11], v64 offset:20480
v_mfma_f32_32x32x16_bf16 v[32:47], v[16:19], v[164:167], v[32:47]
s_waitcnt lgkmcnt(2)
ds_read_b128 v[12:15], v64 offset:21504
v_mfma_f32_32x32x16_bf16 v[32:47], v[20:23], v[168:171], v[32:47]
s_waitcnt lgkmcnt(2)
ds_read_b128 v[16:19], v64 offset:22528
v_mfma_f32_32x32x16_bf16 v[32:47], v[24:27], v[172:175], v[32:47]
s_waitcnt lgkmcnt(2)
ds_read_b128 v[20:23], v64 offset:23552
v_mfma_f32_32x32x16_bf16 v[32:47], v[8:11], v[176:179], v[32:47]
s_waitcnt lgkmcnt(2)
ds_read_b128 v[24:27], v64 offset:24576
v_mfma_f32_32x32x16_bf16 v[32:47], v[12:15], v[180:183], v[32:47]
s_waitcnt lgkmcnt(2)
ds_read_b128 v[8:11], v64 offset:25600
v_mfma_f32_32x32x16_bf16 v[32:47], v[16:19], v[184:187], v[32:47]
s_waitcnt lgkmcnt(2)
ds_read_b128 v[12:15], v64 offset:26624
v_mfma_f32_32x32x16_bf16 v[32:47], v[20:23], v[188:191], v[32:47]
s_waitcnt lgkmcnt(2)
ds_read_b128 v[16:19], v64 offset:27648
v_mfma_f32_32x32x16_bf16 v[32:47], v[24:27], v[192:195], v[32:47]
s_waitcnt lgkmcnt(2)
ds_read_b128 v[20:23], v64 offset:28672
v_mfma_f32_32x32x16_bf16 v[32:47], v[8:11], v[196:199], v[32:47]
s_waitcnt lgkmcnt(2)
ds_read_b128 v[24:27], v64 offset:29696
v_mfma_f32_32x32x16_bf16 v[32:47], v[12:15], v[200:203], v[32:47]
s_waitcnt lgkmcnt(2)
ds_read_b128 v[8:11], v64 offset:30720
v_mfma_f32_32x32x16_bf16 v[32:47], v[16:19], v[204:207], v[32:47]
s_waitcnt lgkmcnt(2)
ds_read_b128 v[12:15], v64 offset:31744
v_mfma_f32_32x32x16_bf16 v[32:47], v[20:23], v[208:211], v[32:47]
s_waitcnt lgkmcnt(2)
ds_read_b128 v[16:19], v64 offset:32768
v_mfma_f32_32x32x16_bf16 v[32:47], v[24:27], v[212:215], v[32:47]
s_waitcnt lgkmcnt(2)
ds_read_b128 v[20:23], v64 offset:33792
v_mfma_f32_32x32x16_bf16 v[32:47], v[8:11], v[216:219], v[32:47]
s_waitcnt lgkmcnt(2)
ds_read_b128 v[24:27], v64 offset:34816
v_mfma_f32_32x32x16_bf16 v[32:47], v[12:15], v[220:223], v[32:47]
s_waitcnt lgkmcnt(2)
ds_read_b128 v[8:11], v64 offset:35840
v_mfma_f32_32x32x16_bf16 v[32:47], v[16:19], v[224:227], v[32:47]
s_waitcnt lgkmcnt(2)
ds_read_b128 v[12:15], v64 offset:36864
v_mfma_f32_32x32x16_bf16 v[32:47], v[20:23], v[228:231], v[32:47]
s_waitcnt lgkmcnt(2)
ds_read_b128 v[16:19], v64 offset:37888
v_mfma_f32_32x32x16_bf16 v[32:47], v[24:27], v[232:235], v[32:47]
s_waitcnt lgkmcnt(2)
ds_read_b128 v[20:23], v64 offset:38912
v_mfma_f32_32x32x16_bf16 v[32:47], v[8:11], v[236:239], v[32:47]
s_waitcnt lgkmcnt(2)
ds_read_b128 v[24:27], v64 offset:39936
v_mfma_f32_32x32x16_bf16 v[32:47], v[12:15], v[240:243], v[32:47]
s_add_u32 s44, s44, 1
s_cmp_eq_u32 s44, 3
s_mov_b32 s56, 40960
s_cmov_b32 s56, -81920
s_cselect_b32 s44, 0, s44
v_add_u32 v64, s56, v64
s_waitcnt vmcnt(10) lgkmcnt(2)
s_barrier
ds_read_b128 v[8:11], v64 offset:0
v_mfma_f32_32x32x16_bf16 v[32:47], v[16:19], v[244:247], v[32:47]
s_waitcnt lgkmcnt(2)
ds_read_b128 v[12:15], v64 offset:1024
v_mfma_f32_32x32x16_bf16 v[32:47], v[20:23], v[248:251], v[32:47]
s_waitcnt lgkmcnt(2)
ds_read_b128 v[16:19], v64 offset:2048
v_mfma_f32_32x32x16_bf16 v[32:47], v[24:27], v[252:255], v[32:47]
s_waitcnt lgkmcnt(2)
ds_read_b128 v[20:23], v64 offset:3072
v_mfma_f32_32x32x16_bf16 v[48:63], v[8:11], v[96:99], 0
s_waitcnt lgkmcnt(2)
ds_read_b128 v[24:27], v64 offset:4096
v_mfma_f32_32x32x16_bf16 v[48:63], v[12:15], v[100:103], v[48:63]
s_waitcnt lgkmcnt(2)
ds_read_b128 v[8:11], v64 offset:5120
v_cvt_pk_bf16_f32 v32, v32, v33
v_cvt_pk_bf16_f32 v33, v34, v35
v_mfma_f32_32x32x16_bf16 v[48:63], v[16:19], v[104:107], v[48:63]
s_waitcnt lgkmcnt(2)
ds_read_b128 v[12:15], v64 offset:6144
v_cvt_pk_bf16_f32 v34, v36, v37
v_cvt_pk_bf16_f32 v35, v38, v39
v_mfma_f32_32x32x16_bf16 v[48:63], v[20:23], v[108:111], v[48:63]
s_waitcnt lgkmcnt(2)
ds_read_b128 v[16:19], v64 offset:7168
v_cvt_pk_bf16_f32 v36, v40, v41
v_cvt_pk_bf16_f32 v37, v42, v43
v_mfma_f32_32x32x16_bf16 v[48:63], v[24:27], v[112:115], v[48:63]
s_waitcnt lgkmcnt(2)
ds_read_b128 v[20:23], v64 offset:8192
v_cvt_pk_bf16_f32 v38, v44, v45
v_cvt_pk_bf16_f32 v39, v46, v47
v_mfma_f32_32x32x16_bf16 v[48:63], v[8:11], v[116:119], v[48:63]
s_waitcnt lgkmcnt(2)
ds_read_b128 v[24:27], v64 offset:9216
v_accvgpr_write_b32 a48, v32
v_accvgpr_write_b32 a49, v33
v_mfma_f32_32x32x16_bf16 v[48:63], v[12:15], v[120:123], v[48:63]
s_waitcnt lgkmcnt(2)
ds_read_b128 v[8:11], v64 offset:10240
v_accvgpr_write_b32 a50, v34
v_accvgpr_write_b32 a51, v35
v_mfma_f32_32x32x16_bf16 v[48:63], v[16:19], v[124:127], v[48:63]
s_waitcnt lgkmcnt(2)
ds_read_b128 v[12:15], v64 offset:11264
v_accvgpr_write_b32 a52, v36
v_accvgpr_write_b32 a53, v37
v_mfma_f32_32x32x16_bf16 v[48:63], v[20:23], v[128:131], v[48:63]
s_waitcnt lgkmcnt(2)
ds_read_b128 v[16:19], v64 offset:12288
v_accvgpr_write_b32 a54, v38
v_accvgpr_write_b32 a55, v39
v_mfma_f32_32x32x16_bf16 v[48:63], v[24:27], v[132:135], v[48:63]
s_waitcnt lgkmcnt(2)
ds_read_b128 v[20:23], v64 offset:13312
s_add_u32 m0, s45, 0
s_add_u32 s55, s46, 0
buffer_load_dwordx4 v0, s[4:7], s55 offen offset:0 sc1 lds
buffer_load_dwordx4 v0, s[4:7], s55 offen offset:1024 sc1 lds
v_mfma_f32_32x32x16_bf16 v[48:63], v[8:11], v[136:139], v[48:63]
s_waitcnt lgkmcnt(2)
ds_read_b128 v[24:27], v64 offset:14336
buffer_load_dwordx4 v0, s[4:7], s55 offen offset:2048 sc1 lds
buffer_load_dwordx4 v0, s[4:7], s55 offen offset:3072 sc1 lds
v_mfma_f32_32x32x16_bf16 v[48:63], v[12:15], v[140:143], v[48:63]
s_waitcnt lgkmcnt(2)
ds_read_b128 v[8:11], v64 offset:15360
s_add_u32 m0, s45, 4096
s_add_u32 s55, s46, 4096
buffer_load_dwordx4 v0, s[4:7], s55 offen offset:0 sc1 lds
buffer_load_dwordx4 v0, s[4:7], s55 offen offset:1024 sc1 lds
v_mfma_f32_32x32x16_bf16 v[48:63], v[16:19], v[144:147], v[48:63]
s_waitcnt lgkmcnt(2)
ds_read_b128 v[12:15], v64 offset:16384
buffer_load_dwordx4 v0, s[4:7], s55 offen offset:2048 sc1 lds
buffer_load_dwordx4 v0, s[4:7], s55 offen offset:3072 sc1 lds
v_mfma_f32_32x32x16_bf16 v[48:63], v[20:23], v[148:151], v[48:63]
s_waitcnt lgkmcnt(2)
ds_read_b128 v[16:19], v64 offset:17408
s_add_u32 m0, s45, 8192
s_add_u32 s55, s46, 8192
buffer_load_dwordx4 v0, s[4:7], s55 offen offset:0 sc1 lds
buffer_load_dwordx4 v0, s[4:7], s55 offen offset:1024 sc1 lds
v_mfma_f32_32x32x16_bf16 v[48:63], v[24:27], v[152:155], v[48:63]
s_waitcnt lgkmcnt(2)
ds_read_b128 v[20:23], v64 offset:18432
s_add_u32 s45, s45, 40960
s_cmp_ge_u32 s45, 122880
s_cselect_b32 s55, 122880, 0
s_sub_u32 s45, s45, s55
s_add_u32 s46, s46, 40960
v_mfma_f32_32x32x16_bf16 v[48:63], v[8:11], v[156:159], v[48:63]
s_waitcnt lgkmcnt(2)
ds_read_b128 v[24:27], v64 offset:19456
v_mfma_f32_32x32x16_bf16 v[48:63], v[12:15], v[160:163], v[48:63]
s_waitcnt lgkmcnt(2)
ds_read_b128 v[8:11], v64 offset:20480
v_mfma_f32_32x32x16_bf16 v[48:63], v[16:19], v[164:167], v[48:63]
s_waitcnt lgkmcnt(2)
ds_read_b128 v[12:15], v64 offset:21504
v_mfma_f32_32x32x16_bf16 v[48:63], v[20:23], v[168:171], v[48:63]
s_waitcnt lgkmcnt(2)
ds_read_b128 v[16:19], v64 offset:22528
v_mfma_f32_32x32x16_bf16 v[48:63], v[24:27], v[172:175], v[48:63]
s_waitcnt lgkmcnt(2)
ds_read_b128 v[20:23], v64 offset:23552
v_mfma_f32_32x32x16_bf16 v[48:63], v[8:11], v[176:179], v[48:63]
s_waitcnt lgkmcnt(2)
ds_read_b128 v[24:27], v64 offset:24576
v_mfma_f32_32x32x16_bf16 v[48:63], v[12:15], v[180:183], v[48:63]
s_waitcnt lgkmcnt(2)
ds_read_b128 v[8:11], v64 offset:25600
v_mfma_f32_32x32x16_bf16 v[48:63], v[16:19], v[184:187], v[48:63]
s_waitcnt lgkmcnt(2)
ds_read_b128 v[12:15], v64 offset:26624
v_mfma_f32_32x32x16_bf16 v[48:63], v[20:23], v[188:191], v[48:63]
s_waitcnt lgkmcnt(2)
ds_read_b128 v[16:19], v64 offset:27648
v_mfma_f32_32x32x16_bf16 v[48:63], v[24:27], v[192:195], v[48:63]
s_waitcnt lgkmcnt(2)
ds_read_b128 v[20:23], v64 offset:28672
v_mfma_f32_32x32x16_bf16 v[48:63], v[8:11], v[196:199], v[48:63]
s_waitcnt lgkmcnt(2)
ds_read_b128 v[24:27], v64 offset:29696
v_mfma_f32_32x32x16_bf16 v[48:63], v[12:15], v[200:203], v[48:63]
s_waitcnt lgkmcnt(2)
ds_read_b128 v[8:11], v64 offset:30720
v_mfma_f32_32x32x16_bf16 v[48:63], v[16:19], v[204:207], v[48:63]
s_waitcnt lgkmcnt(2)
ds_read_b128 v[12:15], v64 offset:31744
v_mfma_f32_32x32x16_bf16 v[48:63], v[20:23], v[208:211], v[48:63]
s_waitcnt lgkmcnt(2)
ds_read_b128 v[16:19], v64 offset:32768
v_mfma_f32_32x32x16_bf16 v[48:63], v[24:27], v[212:215], v[48:63]
s_waitcnt lgkmcnt(2)
ds_read_b128 v[20:23], v64 offset:33792
v_mfma_f32_32x32x16_bf16 v[48:63], v[8:11], v[216:219], v[48:63]
s_waitcnt lgkmcnt(2)
ds_read_b128 v[24:27], v64 offset:34816
v_mfma_f32_32x32x16_bf16 v[48:63], v[12:15], v[220:223], v[48:63]
s_waitcnt lgkmcnt(2)
ds_read_b128 v[8:11], v64 offset:35840
v_mfma_f32_32x32x16_bf16 v[48:63], v[16:19], v[224:227], v[48:63]
s_waitcnt lgkmcnt(2)
ds_read_b128 v[12:15], v64 offset:36864
v_mfma_f32_32x32x16_bf16 v[48:63], v[20:23], v[228:231], v[48:63]
s_waitcnt lgkmcnt(2)
ds_read_b128 v[16:19], v64 offset:37888
v_mfma_f32_32x32x16_bf16 v[48:63], v[24:27], v[232:235], v[48:63]
s_waitcnt lgkmcnt(2)
ds_read_b128 v[20:23], v64 offset:38912
v_mfma_f32_32x32x16_bf16 v[48:63], v[8:11], v[236:239], v[48:63]
s_waitcnt lgkmcnt(2)
ds_read_b128 v[24:27], v64 offset:39936
v_mfma_f32_32x32x16_bf16 v[48:63], v[12:15], v[240:243], v[48:63]
s_add_u32 s44, s44, 1
s_cmp_eq_u32 s44, 3
s_mov_b32 s56, 40960
s_cmov_b32 s56, -81920
s_cselect_b32 s44, 0, s44
v_add_u32 v64, s56, v64
s_waitcnt vmcnt(10) lgkmcnt(2)
s_barrier
ds_read_b128 v[8:11], v64 offset:0
v_mfma_f32_32x32x16_bf16 v[48:63], v[16:19], v[244:247], v[48:63]
s_waitcnt lgkmcnt(2)
ds_read_b128 v[12:15], v64 offset:1024
v_mfma_f32_32x32x16_bf16 v[48:63], v[20:23], v[248:251], v[48:63]
s_waitcnt lgkmcnt(2)
ds_read_b128 v[16:19], v64 offset:2048
v_mfma_f32_32x32x16_bf16 v[48:63], v[24:27], v[252:255], v[48:63]
s_waitcnt lgkmcnt(2)
ds_read_b128 v[20:23], v64 offset:3072
v_mfma_f32_32x32x16_bf16 v[32:47], v[8:11], v[96:99], 0
s_waitcnt lgkmcnt(2)
ds_read_b128 v[24:27], v64 offset:4096
v_mfma_f32_32x32x16_bf16 v[32:47], v[12:15], v[100:103], v[32:47]
s_waitcnt lgkmcnt(2)
ds_read_b128 v[8:11], v64 offset:5120
v_cvt_pk_bf16_f32 v48, v48, v49
v_cvt_pk_bf16_f32 v49, v50, v51
v_mfma_f32_32x32x16_bf16 v[32:47], v[16:19], v[104:107], v[32:47]
s_waitcnt lgkmcnt(2)
ds_read_b128 v[12:15], v64 offset:6144
v_cvt_pk_bf16_f32 v50, v52, v53
v_cvt_pk_bf16_f32 v51, v54, v55
v_mfma_f32_32x32x16_bf16 v[32:47], v[20:23], v[108:111], v[32:47]
s_waitcnt lgkmcnt(2)
ds_read_b128 v[16:19], v64 offset:7168
v_cvt_pk_bf16_f32 v52, v56, v57
v_cvt_pk_bf16_f32 v53, v58, v59
v_mfma_f32_32x32x16_bf16 v[32:47], v[24:27], v[112:115], v[32:47]
s_waitcnt lgkmcnt(2)
ds_read_b128 v[20:23], v64 offset:8192
v_cvt_pk_bf16_f32 v54, v60, v61
v_cvt_pk_bf16_f32 v55, v62, v63
v_mfma_f32_32x32x16_bf16 v[32:47], v[8:11], v[116:119], v[32:47]
s_waitcnt lgkmcnt(2)
ds_read_b128 v[24:27], v64 offset:9216
v_accvgpr_write_b32 a56, v48
v_accvgpr_write_b32 a57, v49
v_mfma_f32_32x32x16_bf16 v[32:47], v[12:15], v[120:123], v[32:47]
s_waitcnt lgkmcnt(2)
ds_read_b128 v[8:11], v64 offset:10240
v_accvgpr_write_b32 a58, v50
v_accvgpr_write_b32 a59, v51
v_mfma_f32_32x32x16_bf16 v[32:47], v[16:19], v[124:127], v[32:47]
s_waitcnt lgkmcnt(2)
ds_read_b128 v[12:15], v64 offset:11264
v_accvgpr_write_b32 a60, v52
v_accvgpr_write_b32 a61, v53
v_mfma_f32_32x32x16_bf16 v[32:47], v[20:23], v[128:131], v[32:47]
s_waitcnt lgkmcnt(2)
ds_read_b128 v[16:19], v64 offset:12288
v_accvgpr_write_b32 a62, v54
v_accvgpr_write_b32 a63, v55
v_mfma_f32_32x32x16_bf16 v[32:47], v[24:27], v[132:135], v[32:47]
s_waitcnt lgkmcnt(2)
ds_read_b128 v[20:23], v64 offset:13312
s_add_u32 m0, s45, 0
s_add_u32 s55, s46, 0
buffer_load_dwordx4 v0, s[4:7], s55 offen offset:0 sc1 lds
buffer_load_dwordx4 v0, s[4:7], s55 offen offset:1024 sc1 lds
v_mfma_f32_32x32x16_bf16 v[32:47], v[8:11], v[136:139], v[32:47]
s_waitcnt lgkmcnt(2)
ds_read_b128 v[24:27], v64 offset:14336
buffer_load_dwordx4 v0, s[4:7], s55 offen offset:2048 sc1 lds
buffer_load_dwordx4 v0, s[4:7], s55 offen offset:3072 sc1 lds
v_mfma_f32_32x32x16_bf16 v[32:47], v[12:15], v[140:143], v[32:47]
s_waitcnt lgkmcnt(2)
ds_read_b128 v[8:11], v64 offset:15360
s_add_u32 m0, s45, 4096
s_add_u32 s55, s46, 4096
buffer_load_dwordx4 v0, s[4:7], s55 offen offset:0 sc1 lds
buffer_load_dwordx4 v0, s[4:7], s55 offen offset:1024 sc1 lds
v_mfma_f32_32x32x16_bf16 v[32:47], v[16:19], v[144:147], v[32:47]
s_waitcnt lgkmcnt(2)
ds_read_b128 v[12:15], v64 offset:16384
buffer_load_dwordx4 v0, s[4:7], s55 offen offset:2048 sc1 lds
buffer_load_dwordx4 v0, s[4:7], s55 offen offset:3072 sc1 lds
v_mfma_f32_32x32x16_bf16 v[32:47], v[20:23], v[148:151], v[32:47]
s_waitcnt lgkmcnt(2)
ds_read_b128 v[16:19], v64 offset:17408
s_add_u32 m0, s45, 8192
s_add_u32 s55, s46, 8192
buffer_load_dwordx4 v0, s[4:7], s55 offen offset:0 sc1 lds
buffer_load_dwordx4 v0, s[4:7], s55 offen offset:1024 sc1 lds
v_mfma_f32_32x32x16_bf16 v[32:47], v[24:27], v[152:155], v[32:47]
s_waitcnt lgkmcnt(2)
ds_read_b128 v[20:23], v64 offset:18432
s_add_u32 s45, s45, 40960
s_cmp_ge_u32 s45, 122880
s_cselect_b32 s55, 122880, 0
s_sub_u32 s45, s45, s55
s_add_u32 s46, s46, 40960
v_mfma_f32_32x32x16_bf16 v[32:47], v[8:11], v[156:159], v[32:47]
s_waitcnt lgkmcnt(2)
ds_read_b128 v[24:27], v64 offset:19456
v_mfma_f32_32x32x16_bf16 v[32:47], v[12:15], v[160:163], v[32:47]
s_waitcnt lgkmcnt(2)
ds_read_b128 v[8:11], v64 offset:20480
v_mfma_f32_32x32x16_bf16 v[32:47], v[16:19], v[164:167], v[32:47]
s_waitcnt lgkmcnt(2)
ds_read_b128 v[12:15], v64 offset:21504
v_mfma_f32_32x32x16_bf16 v[32:47], v[20:23], v[168:171], v[32:47]
s_waitcnt lgkmcnt(2)
ds_read_b128 v[16:19], v64 offset:22528
v_mfma_f32_32x32x16_bf16 v[32:47], v[24:27], v[172:175], v[32:47]
s_waitcnt lgkmcnt(2)
ds_read_b128 v[20:23], v64 offset:23552
v_mfma_f32_32x32x16_bf16 v[32:47], v[8:11], v[176:179], v[32:47]
s_waitcnt lgkmcnt(2)
ds_read_b128 v[24:27], v64 offset:24576
v_mfma_f32_32x32x16_bf16 v[32:47], v[12:15], v[180:183], v[32:47]
s_waitcnt lgkmcnt(2)
ds_read_b128 v[8:11], v64 offset:25600
v_mfma_f32_32x32x16_bf16 v[32:47], v[16:19], v[184:187], v[32:47]
s_waitcnt lgkmcnt(2)
ds_read_b128 v[12:15], v64 offset:26624
v_mfma_f32_32x32x16_bf16 v[32:47], v[20:23], v[188:191], v[32:47]
s_waitcnt lgkmcnt(2)
ds_read_b128 v[16:19], v64 offset:27648
v_mfma_f32_32x32x16_bf16 v[32:47], v[24:27], v[192:195], v[32:47]
s_waitcnt lgkmcnt(2)
ds_read_b128 v[20:23], v64 offset:28672
v_mfma_f32_32x32x16_bf16 v[32:47], v[8:11], v[196:199], v[32:47]
s_waitcnt lgkmcnt(2)
ds_read_b128 v[24:27], v64 offset:29696
v_mfma_f32_32x32x16_bf16 v[32:47], v[12:15], v[200:203], v[32:47]
s_waitcnt lgkmcnt(2)
ds_read_b128 v[8:11], v64 offset:30720
v_mfma_f32_32x32x16_bf16 v[32:47], v[16:19], v[204:207], v[32:47]
s_waitcnt lgkmcnt(2)
ds_read_b128 v[12:15], v64 offset:31744
v_mfma_f32_32x32x16_bf16 v[32:47], v[20:23], v[208:211], v[32:47]
s_waitcnt lgkmcnt(2)
ds_read_b128 v[16:19], v64 offset:32768
v_mfma_f32_32x32x16_bf16 v[32:47], v[24:27], v[212:215], v[32:47]
s_waitcnt lgkmcnt(2)
ds_read_b128 v[20:23], v64 offset:33792
v_mfma_f32_32x32x16_bf16 v[32:47], v[8:11], v[216:219], v[32:47]
s_waitcnt lgkmcnt(2)
ds_read_b128 v[24:27], v64 offset:34816
v_mfma_f32_32x32x16_bf16 v[32:47], v[12:15], v[220:223], v[32:47]
s_waitcnt lgkmcnt(2)
ds_read_b128 v[8:11], v64 offset:35840
v_mfma_f32_32x32x16_bf16 v[32:47], v[16:19], v[224:227], v[32:47]
s_waitcnt lgkmcnt(2)
ds_read_b128 v[12:15], v64 offset:36864
v_mfma_f32_32x32x16_bf16 v[32:47], v[20:23], v[228:231], v[32:47]
s_waitcnt lgkmcnt(2)
ds_read_b128 v[16:19], v64 offset:37888
v_mfma_f32_32x32x16_bf16 v[32:47], v[24:27], v[232:235], v[32:47]
s_waitcnt lgkmcnt(2)
ds_read_b128 v[20:23], v64 offset:38912
v_mfma_f32_32x32x16_bf16 v[32:47], v[8:11], v[236:239], v[32:47]
s_waitcnt lgkmcnt(2)
ds_read_b128 v[24:27], v64 offset:39936
v_mfma_f32_32x32x16_bf16 v[32:47], v[12:15], v[240:243], v[32:47]
s_add_u32 s44, s44, 1
s_cmp_eq_u32 s44, 3
s_mov_b32 s56, 40960
s_cmov_b32 s56, -81920
s_cselect_b32 s44, 0, s44
v_add_u32 v64, s56, v64
s_waitcnt vmcnt(10) lgkmcnt(2)
s_barrier
ds_read_b128 v[8:11], v64 offset:0
v_mfma_f32_32x32x16_bf16 v[32:47], v[16:19], v[244:247], v[32:47]
s_waitcnt lgkmcnt(2)
ds_read_b128 v[12:15], v64 offset:1024
v_mfma_f32_32x32x16_bf16 v[32:47], v[20:23], v[248:251], v[32:47]
s_waitcnt lgkmcnt(2)
ds_read_b128 v[16:19], v64 offset:2048
v_mfma_f32_32x32x16_bf16 v[32:47], v[24:27], v[252:255], v[32:47]
s_waitcnt lgkmcnt(2)
ds_read_b128 v[20:23], v64 offset:3072
v_mfma_f32_32x32x16_bf16 v[48:63], v[8:11], v[96:99], 0
s_waitcnt lgkmcnt(2)
ds_read_b128 v[24:27], v64 offset:4096
v_mfma_f32_32x32x16_bf16 v[48:63], v[12:15], v[100:103], v[48:63]
s_waitcnt lgkmcnt(2)
ds_read_b128 v[8:11], v64 offset:5120
v_cvt_pk_bf16_f32 v32, v32, v33
v_cvt_pk_bf16_f32 v33, v34, v35
v_mfma_f32_32x32x16_bf16 v[48:63], v[16:19], v[104:107], v[48:63]
s_waitcnt lgkmcnt(2)
ds_read_b128 v[12:15], v64 offset:6144
v_cvt_pk_bf16_f32 v34, v36, v37
v_cvt_pk_bf16_f32 v35, v38, v39
v_mfma_f32_32x32x16_bf16 v[48:63], v[20:23], v[108:111], v[48:63]
s_waitcnt lgkmcnt(2)
ds_read_b128 v[16:19], v64 offset:7168
v_cvt_pk_bf16_f32 v36, v40, v41
v_cvt_pk_bf16_f32 v37, v42, v43
v_mfma_f32_32x32x16_bf16 v[48:63], v[24:27], v[112:115], v[48:63]
s_waitcnt lgkmcnt(2)
ds_read_b128 v[20:23], v64 offset:8192
v_cvt_pk_bf16_f32 v38, v44, v45
v_cvt_pk_bf16_f32 v39, v46, v47
v_mfma_f32_32x32x16_bf16 v[48:63], v[8:11], v[116:119], v[48:63]
s_waitcnt lgkmcnt(2)
ds_read_b128 v[24:27], v64 offset:9216
v_accvgpr_write_b32 a64, v32
v_accvgpr_write_b32 a65, v33
v_mfma_f32_32x32x16_bf16 v[48:63], v[12:15], v[120:123], v[48:63]
s_waitcnt lgkmcnt(2)
ds_read_b128 v[8:11], v64 offset:10240
v_accvgpr_write_b32 a66, v34
v_accvgpr_write_b32 a67, v35
v_mfma_f32_32x32x16_bf16 v[48:63], v[16:19], v[124:127], v[48:63]
s_waitcnt lgkmcnt(2)
ds_read_b128 v[12:15], v64 offset:11264
v_accvgpr_write_b32 a68, v36
v_accvgpr_write_b32 a69, v37
v_mfma_f32_32x32x16_bf16 v[48:63], v[20:23], v[128:131], v[48:63]
s_waitcnt lgkmcnt(2)
ds_read_b128 v[16:19], v64 offset:12288
v_accvgpr_write_b32 a70, v38
v_accvgpr_write_b32 a71, v39
v_mfma_f32_32x32x16_bf16 v[48:63], v[24:27], v[132:135], v[48:63]
s_waitcnt lgkmcnt(2)
ds_read_b128 v[20:23], v64 offset:13312
s_add_u32 m0, s45, 0
s_add_u32 s55, s46, 0
buffer_load_dwordx4 v0, s[4:7], s55 offen offset:0 sc1 lds
buffer_load_dwordx4 v0, s[4:7], s55 offen offset:1024 sc1 lds
v_mfma_f32_32x32x16_bf16 v[48:63], v[8:11], v[136:139], v[48:63]
s_waitcnt lgkmcnt(2)
ds_read_b128 v[24:27], v64 offset:14336
buffer_load_dwordx4 v0, s[4:7], s55 offen offset:2048 sc1 lds
buffer_load_dwordx4 v0, s[4:7], s55 offen offset:3072 sc1 lds
v_mfma_f32_32x32x16_bf16 v[48:63], v[12:15], v[140:143], v[48:63]
s_waitcnt lgkmcnt(2)
ds_read_b128 v[8:11], v64 offset:15360
s_add_u32 m0, s45, 4096
s_add_u32 s55, s46, 4096
buffer_load_dwordx4 v0, s[4:7], s55 offen offset:0 sc1 lds
buffer_load_dwordx4 v0, s[4:7], s55 offen offset:1024 sc1 lds
v_mfma_f32_32x32x16_bf16 v[48:63], v[16:19], v[144:147], v[48:63]
s_waitcnt lgkmcnt(2)
ds_read_b128 v[12:15], v64 offset:16384
buffer_load_dwordx4 v0, s[4:7], s55 offen offset:2048 sc1 lds
buffer_load_dwordx4 v0, s[4:7], s55 offen offset:3072 sc1 lds
v_mfma_f32_32x32x16_bf16 v[48:63], v[20:23], v[148:151], v[48:63]
s_waitcnt lgkmcnt(2)
ds_read_b128 v[16:19], v64 offset:17408
s_add_u32 m0, s45, 8192
s_add_u32 s55, s46, 8192
buffer_load_dwordx4 v0, s[4:7], s55 offen offset:0 sc1 lds
buffer_load_dwordx4 v0, s[4:7], s55 offen offset:1024 sc1 lds
v_mfma_f32_32x32x16_bf16 v[48:63], v[24:27], v[152:155], v[48:63]
s_waitcnt lgkmcnt(2)
ds_read_b128 v[20:23], v64 offset:18432
s_add_u32 s45, s45, 40960
s_cmp_ge_u32 s45, 122880
s_cselect_b32 s55, 122880, 0
s_sub_u32 s45, s45, s55
s_add_u32 s46, s46, 40960
v_mfma_f32_32x32x16_bf16 v[48:63], v[8:11], v[156:159], v[48:63]
s_waitcnt lgkmcnt(2)
ds_read_b128 v[24:27], v64 offset:19456
v_mfma_f32_32x32x16_bf16 v[48:63], v[12:15], v[160:163], v[48:63]
s_waitcnt lgkmcnt(2)
ds_read_b128 v[8:11], v64 offset:20480
v_mfma_f32_32x32x16_bf16 v[48:63], v[16:19], v[164:167], v[48:63]
s_waitcnt lgkmcnt(2)
ds_read_b128 v[12:15], v64 offset:21504
v_mfma_f32_32x32x16_bf16 v[48:63], v[20:23], v[168:171], v[48:63]
s_waitcnt lgkmcnt(2)
ds_read_b128 v[16:19], v64 offset:22528
v_mfma_f32_32x32x16_bf16 v[48:63], v[24:27], v[172:175], v[48:63]
s_waitcnt lgkmcnt(2)
ds_read_b128 v[20:23], v64 offset:23552
v_mfma_f32_32x32x16_bf16 v[48:63], v[8:11], v[176:179], v[48:63]
s_waitcnt lgkmcnt(2)
ds_read_b128 v[24:27], v64 offset:24576
v_mfma_f32_32x32x16_bf16 v[48:63], v[12:15], v[180:183], v[48:63]
s_waitcnt lgkmcnt(2)
ds_read_b128 v[8:11], v64 offset:25600
v_mfma_f32_32x32x16_bf16 v[48:63], v[16:19], v[184:187], v[48:63]
s_waitcnt lgkmcnt(2)
ds_read_b128 v[12:15], v64 offset:26624
v_mfma_f32_32x32x16_bf16 v[48:63], v[20:23], v[188:191], v[48:63]
s_waitcnt lgkmcnt(2)
ds_read_b128 v[16:19], v64 offset:27648
v_mfma_f32_32x32x16_bf16 v[48:63], v[24:27], v[192:195], v[48:63]
s_waitcnt lgkmcnt(2)
ds_read_b128 v[20:23], v64 offset:28672
v_mfma_f32_32x32x16_bf16 v[48:63], v[8:11], v[196:199], v[48:63]
s_waitcnt lgkmcnt(2)
ds_read_b128 v[24:27], v64 offset:29696
v_mfma_f32_32x32x16_bf16 v[48:63], v[12:15], v[200:203], v[48:63]
s_waitcnt lgkmcnt(2)
ds_read_b128 v[8:11], v64 offset:30720
v_mfma_f32_32x32x16_bf16 v[48:63], v[16:19], v[204:207], v[48:63]
s_waitcnt lgkmcnt(2)
ds_read_b128 v[12:15], v64 offset:31744
v_mfma_f32_32x32x16_bf16 v[48:63], v[20:23], v[208:211], v[48:63]
s_waitcnt lgkmcnt(2)
ds_read_b128 v[16:19], v64 offset:32768
v_mfma_f32_32x32x16_bf16 v[48:63], v[24:27], v[212:215], v[48:63]
s_waitcnt lgkmcnt(2)
ds_read_b128 v[20:23], v64 offset:33792
v_mfma_f32_32x32x16_bf16 v[48:63], v[8:11], v[216:219], v[48:63]
s_waitcnt lgkmcnt(2)
ds_read_b128 v[24:27], v64 offset:34816
v_mfma_f32_32x32x16_bf16 v[48:63], v[12:15], v[220:223], v[48:63]
s_waitcnt lgkmcnt(2)
ds_read_b128 v[8:11], v64 offset:35840
v_mfma_f32_32x32x16_bf16 v[48:63], v[16:19], v[224:227], v[48:63]
s_waitcnt lgkmcnt(2)
ds_read_b128 v[12:15], v64 offset:36864
v_mfma_f32_32x32x16_bf16 v[48:63], v[20:23], v[228:231], v[48:63]
s_waitcnt lgkmcnt(2)
ds_read_b128 v[16:19], v64 offset:37888
v_mfma_f32_32x32x16_bf16 v[48:63], v[24:27], v[232:235], v[48:63]
s_waitcnt lgkmcnt(2)
ds_read_b128 v[20:23], v64 offset:38912
v_mfma_f32_32x32x16_bf16 v[48:63], v[8:11], v[236:239], v[48:63]
s_waitcnt lgkmcnt(2)
ds_read_b128 v[24:27], v64 offset:39936
v_mfma_f32_32x32x16_bf16 v[48:63], v[12:15], v[240:243], v[48:63]
s_add_u32 s44, s44, 1
s_cmp_eq_u32 s44, 3
s_mov_b32 s56, 40960
s_cmov_b32 s56, -81920
s_cselect_b32 s44, 0, s44
v_add_u32 v64, s56, v64
s_waitcnt vmcnt(10) lgkmcnt(2)
s_barrier
ds_read_b128 v[8:11], v64 offset:0
v_mfma_f32_32x32x16_bf16 v[48:63], v[16:19], v[244:247], v[48:63]
s_waitcnt lgkmcnt(2)
ds_read_b128 v[12:15], v64 offset:1024
v_mfma_f32_32x32x16_bf16 v[48:63], v[20:23], v[248:251], v[48:63]
s_waitcnt lgkmcnt(2)
ds_read_b128 v[16:19], v64 offset:2048
v_mfma_f32_32x32x16_bf16 v[48:63], v[24:27], v[252:255], v[48:63]
s_waitcnt lgkmcnt(2)
ds_read_b128 v[20:23], v64 offset:3072
v_mfma_f32_32x32x16_bf16 v[32:47], v[8:11], v[96:99], 0
s_waitcnt lgkmcnt(2)
ds_read_b128 v[24:27], v64 offset:4096
v_mfma_f32_32x32x16_bf16 v[32:47], v[12:15], v[100:103], v[32:47]
s_waitcnt lgkmcnt(2)
ds_read_b128 v[8:11], v64 offset:5120
v_cvt_pk_bf16_f32 v48, v48, v49
v_cvt_pk_bf16_f32 v49, v50, v51
v_mfma_f32_32x32x16_bf16 v[32:47], v[16:19], v[104:107], v[32:47]
s_waitcnt lgkmcnt(2)
ds_read_b128 v[12:15], v64 offset:6144
v_cvt_pk_bf16_f32 v50, v52, v53
v_cvt_pk_bf16_f32 v51, v54, v55
v_mfma_f32_32x32x16_bf16 v[32:47], v[20:23], v[108:111], v[32:47]
s_waitcnt lgkmcnt(2)
ds_read_b128 v[16:19], v64 offset:7168
v_cvt_pk_bf16_f32 v52, v56, v57
v_cvt_pk_bf16_f32 v53, v58, v59
v_mfma_f32_32x32x16_bf16 v[32:47], v[24:27], v[112:115], v[32:47]
s_waitcnt lgkmcnt(2)
ds_read_b128 v[20:23], v64 offset:8192
v_cvt_pk_bf16_f32 v54, v60, v61
v_cvt_pk_bf16_f32 v55, v62, v63
v_mfma_f32_32x32x16_bf16 v[32:47], v[8:11], v[116:119], v[32:47]
s_waitcnt lgkmcnt(2)
ds_read_b128 v[24:27], v64 offset:9216
v_accvgpr_write_b32 a72, v48
v_accvgpr_write_b32 a73, v49
v_mfma_f32_32x32x16_bf16 v[32:47], v[12:15], v[120:123], v[32:47]
s_waitcnt lgkmcnt(2)
ds_read_b128 v[8:11], v64 offset:10240
v_accvgpr_write_b32 a74, v50
v_accvgpr_write_b32 a75, v51
v_mfma_f32_32x32x16_bf16 v[32:47], v[16:19], v[124:127], v[32:47]
s_waitcnt lgkmcnt(2)
ds_read_b128 v[12:15], v64 offset:11264
v_accvgpr_write_b32 a76, v52
v_accvgpr_write_b32 a77, v53
v_mfma_f32_32x32x16_bf16 v[32:47], v[20:23], v[128:131], v[32:47]
s_waitcnt lgkmcnt(2)
ds_read_b128 v[16:19], v64 offset:12288
v_accvgpr_write_b32 a78, v54
v_accvgpr_write_b32 a79, v55
v_mfma_f32_32x32x16_bf16 v[32:47], v[24:27], v[132:135], v[32:47]
s_waitcnt lgkmcnt(2)
ds_read_b128 v[20:23], v64 offset:13312
s_add_u32 m0, s45, 0
s_add_u32 s55, s46, 0
buffer_load_dwordx4 v0, s[4:7], s55 offen offset:0 sc1 lds
buffer_load_dwordx4 v0, s[4:7], s55 offen offset:1024 sc1 lds
v_mfma_f32_32x32x16_bf16 v[32:47], v[8:11], v[136:139], v[32:47]
s_waitcnt lgkmcnt(2)
ds_read_b128 v[24:27], v64 offset:14336
buffer_load_dwordx4 v0, s[4:7], s55 offen offset:2048 sc1 lds
buffer_load_dwordx4 v0, s[4:7], s55 offen offset:3072 sc1 lds
v_mfma_f32_32x32x16_bf16 v[32:47], v[12:15], v[140:143], v[32:47]
s_waitcnt lgkmcnt(2)
ds_read_b128 v[8:11], v64 offset:15360
s_add_u32 m0, s45, 4096
s_add_u32 s55, s46, 4096
buffer_load_dwordx4 v0, s[4:7], s55 offen offset:0 sc1 lds
buffer_load_dwordx4 v0, s[4:7], s55 offen offset:1024 sc1 lds
v_mfma_f32_32x32x16_bf16 v[32:47], v[16:19], v[144:147], v[32:47]
s_waitcnt lgkmcnt(2)
ds_read_b128 v[12:15], v64 offset:16384
buffer_load_dwordx4 v0, s[4:7], s55 offen offset:2048 sc1 lds
buffer_load_dwordx4 v0, s[4:7], s55 offen offset:3072 sc1 lds
v_mfma_f32_32x32x16_bf16 v[32:47], v[20:23], v[148:151], v[32:47]
s_waitcnt lgkmcnt(2)
ds_read_b128 v[16:19], v64 offset:17408
s_add_u32 m0, s45, 8192
s_add_u32 s55, s46, 8192
buffer_load_dwordx4 v0, s[4:7], s55 offen offset:0 sc1 lds
buffer_load_dwordx4 v0, s[4:7], s55 offen offset:1024 sc1 lds
v_mfma_f32_32x32x16_bf16 v[32:47], v[24:27], v[152:155], v[32:47]
s_waitcnt lgkmcnt(2)
ds_read_b128 v[20:23], v64 offset:18432
s_add_u32 s45, s45, 40960
s_cmp_ge_u32 s45, 122880
s_cselect_b32 s55, 122880, 0
s_sub_u32 s45, s45, s55
s_add_u32 s46, s46, 40960
v_mfma_f32_32x32x16_bf16 v[32:47], v[8:11], v[156:159], v[32:47]
s_waitcnt lgkmcnt(2)
ds_read_b128 v[24:27], v64 offset:19456
v_mfma_f32_32x32x16_bf16 v[32:47], v[12:15], v[160:163], v[32:47]
s_waitcnt lgkmcnt(2)
ds_read_b128 v[8:11], v64 offset:20480
v_mfma_f32_32x32x16_bf16 v[32:47], v[16:19], v[164:167], v[32:47]
s_waitcnt lgkmcnt(2)
ds_read_b128 v[12:15], v64 offset:21504
v_mfma_f32_32x32x16_bf16 v[32:47], v[20:23], v[168:171], v[32:47]
s_waitcnt lgkmcnt(2)
ds_read_b128 v[16:19], v64 offset:22528
v_mfma_f32_32x32x16_bf16 v[32:47], v[24:27], v[172:175], v[32:47]
s_waitcnt lgkmcnt(2)
ds_read_b128 v[20:23], v64 offset:23552
v_mfma_f32_32x32x16_bf16 v[32:47], v[8:11], v[176:179], v[32:47]
s_waitcnt lgkmcnt(2)
ds_read_b128 v[24:27], v64 offset:24576
v_mfma_f32_32x32x16_bf16 v[32:47], v[12:15], v[180:183], v[32:47]
s_waitcnt lgkmcnt(2)
ds_read_b128 v[8:11], v64 offset:25600
v_mfma_f32_32x32x16_bf16 v[32:47], v[16:19], v[184:187], v[32:47]
s_waitcnt lgkmcnt(2)
ds_read_b128 v[12:15], v64 offset:26624
v_mfma_f32_32x32x16_bf16 v[32:47], v[20:23], v[188:191], v[32:47]
s_waitcnt lgkmcnt(2)
ds_read_b128 v[16:19], v64 offset:27648
v_mfma_f32_32x32x16_bf16 v[32:47], v[24:27], v[192:195], v[32:47]
s_waitcnt lgkmcnt(2)
ds_read_b128 v[20:23], v64 offset:28672
v_mfma_f32_32x32x16_bf16 v[32:47], v[8:11], v[196:199], v[32:47]
s_waitcnt lgkmcnt(2)
ds_read_b128 v[24:27], v64 offset:29696
v_mfma_f32_32x32x16_bf16 v[32:47], v[12:15], v[200:203], v[32:47]
s_waitcnt lgkmcnt(2)
ds_read_b128 v[8:11], v64 offset:30720
v_mfma_f32_32x32x16_bf16 v[32:47], v[16:19], v[204:207], v[32:47]
s_waitcnt lgkmcnt(2)
ds_read_b128 v[12:15], v64 offset:31744
v_mfma_f32_32x32x16_bf16 v[32:47], v[20:23], v[208:211], v[32:47]
s_waitcnt lgkmcnt(2)
ds_read_b128 v[16:19], v64 offset:32768
v_mfma_f32_32x32x16_bf16 v[32:47], v[24:27], v[212:215], v[32:47]
s_waitcnt lgkmcnt(2)
ds_read_b128 v[20:23], v64 offset:33792
v_mfma_f32_32x32x16_bf16 v[32:47], v[8:11], v[216:219], v[32:47]
s_waitcnt lgkmcnt(2)
ds_read_b128 v[24:27], v64 offset:34816
v_mfma_f32_32x32x16_bf16 v[32:47], v[12:15], v[220:223], v[32:47]
s_waitcnt lgkmcnt(2)
ds_read_b128 v[8:11], v64 offset:35840
v_mfma_f32_32x32x16_bf16 v[32:47], v[16:19], v[224:227], v[32:47]
s_waitcnt lgkmcnt(2)
ds_read_b128 v[12:15], v64 offset:36864
v_mfma_f32_32x32x16_bf16 v[32:47], v[20:23], v[228:231], v[32:47]
s_waitcnt lgkmcnt(2)
ds_read_b128 v[16:19], v64 offset:37888
v_mfma_f32_32x32x16_bf16 v[32:47], v[24:27], v[232:235], v[32:47]
s_waitcnt lgkmcnt(2)
ds_read_b128 v[20:23], v64 offset:38912
v_mfma_f32_32x32x16_bf16 v[32:47], v[8:11], v[236:239], v[32:47]
s_waitcnt lgkmcnt(2)
ds_read_b128 v[24:27], v64 offset:39936
v_mfma_f32_32x32x16_bf16 v[32:47], v[12:15], v[240:243], v[32:47]
s_add_u32 s44, s44, 1
s_cmp_eq_u32 s44, 3
s_mov_b32 s56, 40960
s_cmov_b32 s56, -81920
s_cselect_b32 s44, 0, s44
v_add_u32 v64, s56, v64
s_waitcnt vmcnt(10) lgkmcnt(2)
s_barrier
ds_read_b128 v[8:11], v64 offset:0
v_mfma_f32_32x32x16_bf16 v[32:47], v[16:19], v[244:247], v[32:47]
s_waitcnt lgkmcnt(2)
ds_read_b128 v[12:15], v64 offset:1024
v_mfma_f32_32x32x16_bf16 v[32:47], v[20:23], v[248:251], v[32:47]
s_waitcnt lgkmcnt(2)
ds_read_b128 v[16:19], v64 offset:2048
v_mfma_f32_32x32x16_bf16 v[32:47], v[24:27], v[252:255], v[32:47]
s_waitcnt lgkmcnt(2)
ds_read_b128 v[20:23], v64 offset:3072
v_mfma_f32_32x32x16_bf16 v[48:63], v[8:11], v[96:99], 0
s_waitcnt lgkmcnt(2)
ds_read_b128 v[24:27], v64 offset:4096
v_mfma_f32_32x32x16_bf16 v[48:63], v[12:15], v[100:103], v[48:63]
s_waitcnt lgkmcnt(2)
ds_read_b128 v[8:11], v64 offset:5120
v_cvt_pk_bf16_f32 v32, v32, v33
v_cvt_pk_bf16_f32 v33, v34, v35
v_mfma_f32_32x32x16_bf16 v[48:63], v[16:19], v[104:107], v[48:63]
s_waitcnt lgkmcnt(2)
ds_read_b128 v[12:15], v64 offset:6144
v_cvt_pk_bf16_f32 v34, v36, v37
v_cvt_pk_bf16_f32 v35, v38, v39
v_mfma_f32_32x32x16_bf16 v[48:63], v[20:23], v[108:111], v[48:63]
s_waitcnt lgkmcnt(2)
ds_read_b128 v[16:19], v64 offset:7168
v_cvt_pk_bf16_f32 v36, v40, v41
v_cvt_pk_bf16_f32 v37, v42, v43
v_mfma_f32_32x32x16_bf16 v[48:63], v[24:27], v[112:115], v[48:63]
s_waitcnt lgkmcnt(2)
ds_read_b128 v[20:23], v64 offset:8192
v_cvt_pk_bf16_f32 v38, v44, v45
v_cvt_pk_bf16_f32 v39, v46, v47
v_mfma_f32_32x32x16_bf16 v[48:63], v[8:11], v[116:119], v[48:63]
s_waitcnt lgkmcnt(2)
ds_read_b128 v[24:27], v64 offset:9216
v_accvgpr_write_b32 a80, v32
v_accvgpr_write_b32 a81, v33
v_mfma_f32_32x32x16_bf16 v[48:63], v[12:15], v[120:123], v[48:63]
s_waitcnt lgkmcnt(2)
ds_read_b128 v[8:11], v64 offset:10240
v_accvgpr_write_b32 a82, v34
v_accvgpr_write_b32 a83, v35
v_mfma_f32_32x32x16_bf16 v[48:63], v[16:19], v[124:127], v[48:63]
s_waitcnt lgkmcnt(2)
ds_read_b128 v[12:15], v64 offset:11264
v_accvgpr_write_b32 a84, v36
v_accvgpr_write_b32 a85, v37
v_mfma_f32_32x32x16_bf16 v[48:63], v[20:23], v[128:131], v[48:63]
s_waitcnt lgkmcnt(2)
ds_read_b128 v[16:19], v64 offset:12288
v_accvgpr_write_b32 a86, v38
v_accvgpr_write_b32 a87, v39
v_mfma_f32_32x32x16_bf16 v[48:63], v[24:27], v[132:135], v[48:63]
s_waitcnt lgkmcnt(2)
ds_read_b128 v[20:23], v64 offset:13312
s_add_u32 m0, s45, 0
s_add_u32 s55, s46, 0
buffer_load_dwordx4 v0, s[4:7], s55 offen offset:0 sc1 lds
buffer_load_dwordx4 v0, s[4:7], s55 offen offset:1024 sc1 lds
v_mfma_f32_32x32x16_bf16 v[48:63], v[8:11], v[136:139], v[48:63]
s_waitcnt lgkmcnt(2)
ds_read_b128 v[24:27], v64 offset:14336
buffer_load_dwordx4 v0, s[4:7], s55 offen offset:2048 sc1 lds
buffer_load_dwordx4 v0, s[4:7], s55 offen offset:3072 sc1 lds
v_mfma_f32_32x32x16_bf16 v[48:63], v[12:15], v[140:143], v[48:63]
s_waitcnt lgkmcnt(2)
ds_read_b128 v[8:11], v64 offset:15360
s_add_u32 m0, s45, 4096
s_add_u32 s55, s46, 4096
buffer_load_dwordx4 v0, s[4:7], s55 offen offset:0 sc1 lds
buffer_load_dwordx4 v0, s[4:7], s55 offen offset:1024 sc1 lds
v_mfma_f32_32x32x16_bf16 v[48:63], v[16:19], v[144:147], v[48:63]
s_waitcnt lgkmcnt(2)
ds_read_b128 v[12:15], v64 offset:16384
buffer_load_dwordx4 v0, s[4:7], s55 offen offset:2048 sc1 lds
buffer_load_dwordx4 v0, s[4:7], s55 offen offset:3072 sc1 lds
v_mfma_f32_32x32x16_bf16 v[48:63], v[20:23], v[148:151], v[48:63]
s_waitcnt lgkmcnt(2)
ds_read_b128 v[16:19], v64 offset:17408
s_add_u32 m0, s45, 8192
s_add_u32 s55, s46, 8192
buffer_load_dwordx4 v0, s[4:7], s55 offen offset:0 sc1 lds
buffer_load_dwordx4 v0, s[4:7], s55 offen offset:1024 sc1 lds
v_mfma_f32_32x32x16_bf16 v[48:63], v[24:27], v[152:155], v[48:63]
s_waitcnt lgkmcnt(2)
ds_read_b128 v[20:23], v64 offset:18432
s_add_u32 s45, s45, 40960
s_cmp_ge_u32 s45, 122880
s_cselect_b32 s55, 122880, 0
s_sub_u32 s45, s45, s55
s_add_u32 s46, s46, 40960
v_mfma_f32_32x32x16_bf16 v[48:63], v[8:11], v[156:159], v[48:63]
s_waitcnt lgkmcnt(2)
ds_read_b128 v[24:27], v64 offset:19456
v_mfma_f32_32x32x16_bf16 v[48:63], v[12:15], v[160:163], v[48:63]
s_waitcnt lgkmcnt(2)
ds_read_b128 v[8:11], v64 offset:20480
v_mfma_f32_32x32x16_bf16 v[48:63], v[16:19], v[164:167], v[48:63]
s_waitcnt lgkmcnt(2)
ds_read_b128 v[12:15], v64 offset:21504
v_mfma_f32_32x32x16_bf16 v[48:63], v[20:23], v[168:171], v[48:63]
s_waitcnt lgkmcnt(2)
ds_read_b128 v[16:19], v64 offset:22528
v_mfma_f32_32x32x16_bf16 v[48:63], v[24:27], v[172:175], v[48:63]
s_waitcnt lgkmcnt(2)
ds_read_b128 v[20:23], v64 offset:23552
v_mfma_f32_32x32x16_bf16 v[48:63], v[8:11], v[176:179], v[48:63]
s_waitcnt lgkmcnt(2)
ds_read_b128 v[24:27], v64 offset:24576
v_mfma_f32_32x32x16_bf16 v[48:63], v[12:15], v[180:183], v[48:63]
s_waitcnt lgkmcnt(2)
ds_read_b128 v[8:11], v64 offset:25600
v_mfma_f32_32x32x16_bf16 v[48:63], v[16:19], v[184:187], v[48:63]
s_waitcnt lgkmcnt(2)
ds_read_b128 v[12:15], v64 offset:26624
v_mfma_f32_32x32x16_bf16 v[48:63], v[20:23], v[188:191], v[48:63]
s_waitcnt lgkmcnt(2)
ds_read_b128 v[16:19], v64 offset:27648
v_mfma_f32_32x32x16_bf16 v[48:63], v[24:27], v[192:195], v[48:63]
s_waitcnt lgkmcnt(2)
ds_read_b128 v[20:23], v64 offset:28672
v_mfma_f32_32x32x16_bf16 v[48:63], v[8:11], v[196:199], v[48:63]
s_waitcnt lgkmcnt(2)
ds_read_b128 v[24:27], v64 offset:29696
v_mfma_f32_32x32x16_bf16 v[48:63], v[12:15], v[200:203], v[48:63]
s_waitcnt lgkmcnt(2)
ds_read_b128 v[8:11], v64 offset:30720
v_mfma_f32_32x32x16_bf16 v[48:63], v[16:19], v[204:207], v[48:63]
s_waitcnt lgkmcnt(2)
ds_read_b128 v[12:15], v64 offset:31744
v_mfma_f32_32x32x16_bf16 v[48:63], v[20:23], v[208:211], v[48:63]
s_waitcnt lgkmcnt(2)
ds_read_b128 v[16:19], v64 offset:32768
v_mfma_f32_32x32x16_bf16 v[48:63], v[24:27], v[212:215], v[48:63]
s_waitcnt lgkmcnt(2)
ds_read_b128 v[20:23], v64 offset:33792
v_mfma_f32_32x32x16_bf16 v[48:63], v[8:11], v[216:219], v[48:63]
s_waitcnt lgkmcnt(2)
ds_read_b128 v[24:27], v64 offset:34816
v_mfma_f32_32x32x16_bf16 v[48:63], v[12:15], v[220:223], v[48:63]
s_waitcnt lgkmcnt(2)
ds_read_b128 v[8:11], v64 offset:35840
v_mfma_f32_32x32x16_bf16 v[48:63], v[16:19], v[224:227], v[48:63]
s_waitcnt lgkmcnt(2)
ds_read_b128 v[12:15], v64 offset:36864
v_mfma_f32_32x32x16_bf16 v[48:63], v[20:23], v[228:231], v[48:63]
s_waitcnt lgkmcnt(2)
ds_read_b128 v[16:19], v64 offset:37888
v_mfma_f32_32x32x16_bf16 v[48:63], v[24:27], v[232:235], v[48:63]
s_waitcnt lgkmcnt(2)
ds_read_b128 v[20:23], v64 offset:38912
v_mfma_f32_32x32x16_bf16 v[48:63], v[8:11], v[236:239], v[48:63]
s_waitcnt lgkmcnt(2)
ds_read_b128 v[24:27], v64 offset:39936
v_mfma_f32_32x32x16_bf16 v[48:63], v[12:15], v[240:243], v[48:63]
s_add_u32 s44, s44, 1
s_cmp_eq_u32 s44, 3
s_mov_b32 s56, 40960
s_cmov_b32 s56, -81920
s_cselect_b32 s44, 0, s44
v_add_u32 v64, s56, v64
s_waitcnt vmcnt(10) lgkmcnt(2)
s_barrier
ds_read_b128 v[8:11], v64 offset:0
v_mfma_f32_32x32x16_bf16 v[48:63], v[16:19], v[244:247], v[48:63]
s_waitcnt lgkmcnt(2)
ds_read_b128 v[12:15], v64 offset:1024
v_mfma_f32_32x32x16_bf16 v[48:63], v[20:23], v[248:251], v[48:63]
s_waitcnt lgkmcnt(2)
ds_read_b128 v[16:19], v64 offset:2048
v_mfma_f32_32x32x16_bf16 v[48:63], v[24:27], v[252:255], v[48:63]
s_waitcnt lgkmcnt(2)
ds_read_b128 v[20:23], v64 offset:3072
v_mfma_f32_32x32x16_bf16 v[32:47], v[8:11], v[96:99], 0
s_waitcnt lgkmcnt(2)
ds_read_b128 v[24:27], v64 offset:4096
v_mfma_f32_32x32x16_bf16 v[32:47], v[12:15], v[100:103], v[32:47]
s_waitcnt lgkmcnt(2)
ds_read_b128 v[8:11], v64 offset:5120
v_cvt_pk_bf16_f32 v48, v48, v49
v_cvt_pk_bf16_f32 v49, v50, v51
v_mfma_f32_32x32x16_bf16 v[32:47], v[16:19], v[104:107], v[32:47]
s_waitcnt lgkmcnt(2)
ds_read_b128 v[12:15], v64 offset:6144
v_cvt_pk_bf16_f32 v50, v52, v53
v_cvt_pk_bf16_f32 v51, v54, v55
v_mfma_f32_32x32x16_bf16 v[32:47], v[20:23], v[108:111], v[32:47]
s_waitcnt lgkmcnt(2)
ds_read_b128 v[16:19], v64 offset:7168
v_cvt_pk_bf16_f32 v52, v56, v57
v_cvt_pk_bf16_f32 v53, v58, v59
v_mfma_f32_32x32x16_bf16 v[32:47], v[24:27], v[112:115], v[32:47]
s_waitcnt lgkmcnt(2)
ds_read_b128 v[20:23], v64 offset:8192
v_cvt_pk_bf16_f32 v54, v60, v61
v_cvt_pk_bf16_f32 v55, v62, v63
v_mfma_f32_32x32x16_bf16 v[32:47], v[8:11], v[116:119], v[32:47]
s_waitcnt lgkmcnt(2)
ds_read_b128 v[24:27], v64 offset:9216
v_accvgpr_write_b32 a88, v48
v_accvgpr_write_b32 a89, v49
v_mfma_f32_32x32x16_bf16 v[32:47], v[12:15], v[120:123], v[32:47]
s_waitcnt lgkmcnt(2)
ds_read_b128 v[8:11], v64 offset:10240
v_accvgpr_write_b32 a90, v50
v_accvgpr_write_b32 a91, v51
v_mfma_f32_32x32x16_bf16 v[32:47], v[16:19], v[124:127], v[32:47]
s_waitcnt lgkmcnt(2)
ds_read_b128 v[12:15], v64 offset:11264
v_accvgpr_write_b32 a92, v52
v_accvgpr_write_b32 a93, v53
v_mfma_f32_32x32x16_bf16 v[32:47], v[20:23], v[128:131], v[32:47]
s_waitcnt lgkmcnt(2)
ds_read_b128 v[16:19], v64 offset:12288
v_accvgpr_write_b32 a94, v54
v_accvgpr_write_b32 a95, v55
v_mfma_f32_32x32x16_bf16 v[32:47], v[24:27], v[132:135], v[32:47]
s_waitcnt lgkmcnt(2)
ds_read_b128 v[20:23], v64 offset:13312
s_add_u32 m0, s45, 0
s_add_u32 s55, s46, 0
buffer_load_dwordx4 v0, s[4:7], s55 offen offset:0 sc1 lds
buffer_load_dwordx4 v0, s[4:7], s55 offen offset:1024 sc1 lds
v_mfma_f32_32x32x16_bf16 v[32:47], v[8:11], v[136:139], v[32:47]
s_waitcnt lgkmcnt(2)
ds_read_b128 v[24:27], v64 offset:14336
buffer_load_dwordx4 v0, s[4:7], s55 offen offset:2048 sc1 lds
buffer_load_dwordx4 v0, s[4:7], s55 offen offset:3072 sc1 lds
v_mfma_f32_32x32x16_bf16 v[32:47], v[12:15], v[140:143], v[32:47]
s_waitcnt lgkmcnt(2)
ds_read_b128 v[8:11], v64 offset:15360
s_add_u32 m0, s45, 4096
s_add_u32 s55, s46, 4096
buffer_load_dwordx4 v0, s[4:7], s55 offen offset:0 sc1 lds
buffer_load_dwordx4 v0, s[4:7], s55 offen offset:1024 sc1 lds
v_mfma_f32_32x32x16_bf16 v[32:47], v[16:19], v[144:147], v[32:47]
s_waitcnt lgkmcnt(2)
ds_read_b128 v[12:15], v64 offset:16384
buffer_load_dwordx4 v0, s[4:7], s55 offen offset:2048 sc1 lds
buffer_load_dwordx4 v0, s[4:7], s55 offen offset:3072 sc1 lds
v_mfma_f32_32x32x16_bf16 v[32:47], v[20:23], v[148:151], v[32:47]
s_waitcnt lgkmcnt(2)
ds_read_b128 v[16:19], v64 offset:17408
s_add_u32 m0, s45, 8192
s_add_u32 s55, s46, 8192
buffer_load_dwordx4 v0, s[4:7], s55 offen offset:0 sc1 lds
buffer_load_dwordx4 v0, s[4:7], s55 offen offset:1024 sc1 lds
v_mfma_f32_32x32x16_bf16 v[32:47], v[24:27], v[152:155], v[32:47]
s_waitcnt lgkmcnt(2)
ds_read_b128 v[20:23], v64 offset:18432
s_add_u32 s45, s45, 40960
s_cmp_ge_u32 s45, 122880
s_cselect_b32 s55, 122880, 0
s_sub_u32 s45, s45, s55
s_add_u32 s46, s46, 40960
v_mfma_f32_32x32x16_bf16 v[32:47], v[8:11], v[156:159], v[32:47]
s_waitcnt lgkmcnt(2)
ds_read_b128 v[24:27], v64 offset:19456
v_mfma_f32_32x32x16_bf16 v[32:47], v[12:15], v[160:163], v[32:47]
s_waitcnt lgkmcnt(2)
ds_read_b128 v[8:11], v64 offset:20480
v_mfma_f32_32x32x16_bf16 v[32:47], v[16:19], v[164:167], v[32:47]
s_waitcnt lgkmcnt(2)
ds_read_b128 v[12:15], v64 offset:21504
v_mfma_f32_32x32x16_bf16 v[32:47], v[20:23], v[168:171], v[32:47]
s_waitcnt lgkmcnt(2)
ds_read_b128 v[16:19], v64 offset:22528
v_mfma_f32_32x32x16_bf16 v[32:47], v[24:27], v[172:175], v[32:47]
s_waitcnt lgkmcnt(2)
ds_read_b128 v[20:23], v64 offset:23552
v_mfma_f32_32x32x16_bf16 v[32:47], v[8:11], v[176:179], v[32:47]
s_waitcnt lgkmcnt(2)
ds_read_b128 v[24:27], v64 offset:24576
v_mfma_f32_32x32x16_bf16 v[32:47], v[12:15], v[180:183], v[32:47]
s_waitcnt lgkmcnt(2)
ds_read_b128 v[8:11], v64 offset:25600
v_mfma_f32_32x32x16_bf16 v[32:47], v[16:19], v[184:187], v[32:47]
s_waitcnt lgkmcnt(2)
ds_read_b128 v[12:15], v64 offset:26624
v_mfma_f32_32x32x16_bf16 v[32:47], v[20:23], v[188:191], v[32:47]
s_waitcnt lgkmcnt(2)
ds_read_b128 v[16:19], v64 offset:27648
v_mfma_f32_32x32x16_bf16 v[32:47], v[24:27], v[192:195], v[32:47]
s_waitcnt lgkmcnt(2)
ds_read_b128 v[20:23], v64 offset:28672
v_mfma_f32_32x32x16_bf16 v[32:47], v[8:11], v[196:199], v[32:47]
s_waitcnt lgkmcnt(2)
ds_read_b128 v[24:27], v64 offset:29696
v_mfma_f32_32x32x16_bf16 v[32:47], v[12:15], v[200:203], v[32:47]
s_waitcnt lgkmcnt(2)
ds_read_b128 v[8:11], v64 offset:30720
v_mfma_f32_32x32x16_bf16 v[32:47], v[16:19], v[204:207], v[32:47]
s_waitcnt lgkmcnt(2)
ds_read_b128 v[12:15], v64 offset:31744
v_mfma_f32_32x32x16_bf16 v[32:47], v[20:23], v[208:211], v[32:47]
s_waitcnt lgkmcnt(2)
ds_read_b128 v[16:19], v64 offset:32768
v_mfma_f32_32x32x16_bf16 v[32:47], v[24:27], v[212:215], v[32:47]
s_waitcnt lgkmcnt(2)
ds_read_b128 v[20:23], v64 offset:33792
v_mfma_f32_32x32x16_bf16 v[32:47], v[8:11], v[216:219], v[32:47]
s_waitcnt lgkmcnt(2)
ds_read_b128 v[24:27], v64 offset:34816
v_mfma_f32_32x32x16_bf16 v[32:47], v[12:15], v[220:223], v[32:47]
s_waitcnt lgkmcnt(2)
ds_read_b128 v[8:11], v64 offset:35840
v_mfma_f32_32x32x16_bf16 v[32:47], v[16:19], v[224:227], v[32:47]
s_waitcnt lgkmcnt(2)
ds_read_b128 v[12:15], v64 offset:36864
v_mfma_f32_32x32x16_bf16 v[32:47], v[20:23], v[228:231], v[32:47]
s_waitcnt lgkmcnt(2)
ds_read_b128 v[16:19], v64 offset:37888
v_mfma_f32_32x32x16_bf16 v[32:47], v[24:27], v[232:235], v[32:47]
s_waitcnt lgkmcnt(2)
ds_read_b128 v[20:23], v64 offset:38912
v_mfma_f32_32x32x16_bf16 v[32:47], v[8:11], v[236:239], v[32:47]
s_waitcnt lgkmcnt(2)
ds_read_b128 v[24:27], v64 offset:39936
v_mfma_f32_32x32x16_bf16 v[32:47], v[12:15], v[240:243], v[32:47]
s_add_u32 s44, s44, 1
s_cmp_eq_u32 s44, 3
s_mov_b32 s56, 40960
s_cmov_b32 s56, -81920
s_cselect_b32 s44, 0, s44
v_add_u32 v64, s56, v64
s_waitcnt vmcnt(10) lgkmcnt(2)
s_barrier
ds_read_b128 v[8:11], v64 offset:0
v_mfma_f32_32x32x16_bf16 v[32:47], v[16:19], v[244:247], v[32:47]
s_waitcnt lgkmcnt(2)
ds_read_b128 v[12:15], v64 offset:1024
v_mfma_f32_32x32x16_bf16 v[32:47], v[20:23], v[248:251], v[32:47]
s_waitcnt lgkmcnt(2)
ds_read_b128 v[16:19], v64 offset:2048
v_mfma_f32_32x32x16_bf16 v[32:47], v[24:27], v[252:255], v[32:47]
s_waitcnt lgkmcnt(2)
ds_read_b128 v[20:23], v64 offset:3072
v_mfma_f32_32x32x16_bf16 v[48:63], v[8:11], v[96:99], 0
s_waitcnt lgkmcnt(2)
ds_read_b128 v[24:27], v64 offset:4096
v_mfma_f32_32x32x16_bf16 v[48:63], v[12:15], v[100:103], v[48:63]
s_waitcnt lgkmcnt(2)
ds_read_b128 v[8:11], v64 offset:5120
v_cvt_pk_bf16_f32 v32, v32, v33
v_cvt_pk_bf16_f32 v33, v34, v35
v_mfma_f32_32x32x16_bf16 v[48:63], v[16:19], v[104:107], v[48:63]
s_waitcnt lgkmcnt(2)
ds_read_b128 v[12:15], v64 offset:6144
v_cvt_pk_bf16_f32 v34, v36, v37
v_cvt_pk_bf16_f32 v35, v38, v39
v_mfma_f32_32x32x16_bf16 v[48:63], v[20:23], v[108:111], v[48:63]
s_waitcnt lgkmcnt(2)
ds_read_b128 v[16:19], v64 offset:7168
v_cvt_pk_bf16_f32 v36, v40, v41
v_cvt_pk_bf16_f32 v37, v42, v43
v_mfma_f32_32x32x16_bf16 v[48:63], v[24:27], v[112:115], v[48:63]
s_waitcnt lgkmcnt(2)
ds_read_b128 v[20:23], v64 offset:8192
v_cvt_pk_bf16_f32 v38, v44, v45
v_cvt_pk_bf16_f32 v39, v46, v47
v_mfma_f32_32x32x16_bf16 v[48:63], v[8:11], v[116:119], v[48:63]
s_waitcnt lgkmcnt(2)
ds_read_b128 v[24:27], v64 offset:9216
v_accvgpr_write_b32 a96, v32
v_accvgpr_write_b32 a97, v33
v_mfma_f32_32x32x16_bf16 v[48:63], v[12:15], v[120:123], v[48:63]
s_waitcnt lgkmcnt(2)
ds_read_b128 v[8:11], v64 offset:10240
v_accvgpr_write_b32 a98, v34
v_accvgpr_write_b32 a99, v35
v_mfma_f32_32x32x16_bf16 v[48:63], v[16:19], v[124:127], v[48:63]
s_waitcnt lgkmcnt(2)
ds_read_b128 v[12:15], v64 offset:11264
v_accvgpr_write_b32 a100, v36
v_accvgpr_write_b32 a101, v37
v_mfma_f32_32x32x16_bf16 v[48:63], v[20:23], v[128:131], v[48:63]
s_waitcnt lgkmcnt(2)
ds_read_b128 v[16:19], v64 offset:12288
v_accvgpr_write_b32 a102, v38
v_accvgpr_write_b32 a103, v39
v_mfma_f32_32x32x16_bf16 v[48:63], v[24:27], v[132:135], v[48:63]
s_waitcnt lgkmcnt(2)
ds_read_b128 v[20:23], v64 offset:13312
s_add_u32 m0, s45, 0
s_add_u32 s55, s46, 0
buffer_load_dwordx4 v0, s[4:7], s55 offen offset:0 sc1 lds
buffer_load_dwordx4 v0, s[4:7], s55 offen offset:1024 sc1 lds
v_mfma_f32_32x32x16_bf16 v[48:63], v[8:11], v[136:139], v[48:63]
s_waitcnt lgkmcnt(2)
ds_read_b128 v[24:27], v64 offset:14336
buffer_load_dwordx4 v0, s[4:7], s55 offen offset:2048 sc1 lds
buffer_load_dwordx4 v0, s[4:7], s55 offen offset:3072 sc1 lds
v_mfma_f32_32x32x16_bf16 v[48:63], v[12:15], v[140:143], v[48:63]
s_waitcnt lgkmcnt(2)
ds_read_b128 v[8:11], v64 offset:15360
s_add_u32 m0, s45, 4096
s_add_u32 s55, s46, 4096
buffer_load_dwordx4 v0, s[4:7], s55 offen offset:0 sc1 lds
buffer_load_dwordx4 v0, s[4:7], s55 offen offset:1024 sc1 lds
v_mfma_f32_32x32x16_bf16 v[48:63], v[16:19], v[144:147], v[48:63]
s_waitcnt lgkmcnt(2)
ds_read_b128 v[12:15], v64 offset:16384
buffer_load_dwordx4 v0, s[4:7], s55 offen offset:2048 sc1 lds
buffer_load_dwordx4 v0, s[4:7], s55 offen offset:3072 sc1 lds
v_mfma_f32_32x32x16_bf16 v[48:63], v[20:23], v[148:151], v[48:63]
s_waitcnt lgkmcnt(2)
ds_read_b128 v[16:19], v64 offset:17408
s_add_u32 m0, s45, 8192
s_add_u32 s55, s46, 8192
buffer_load_dwordx4 v0, s[4:7], s55 offen offset:0 sc1 lds
buffer_load_dwordx4 v0, s[4:7], s55 offen offset:1024 sc1 lds
v_mfma_f32_32x32x16_bf16 v[48:63], v[24:27], v[152:155], v[48:63]
s_waitcnt lgkmcnt(2)
ds_read_b128 v[20:23], v64 offset:18432
s_add_u32 s45, s45, 40960
s_cmp_ge_u32 s45, 122880
s_cselect_b32 s55, 122880, 0
s_sub_u32 s45, s45, s55
s_add_u32 s46, s46, 40960
v_mfma_f32_32x32x16_bf16 v[48:63], v[8:11], v[156:159], v[48:63]
s_waitcnt lgkmcnt(2)
ds_read_b128 v[24:27], v64 offset:19456
v_mfma_f32_32x32x16_bf16 v[48:63], v[12:15], v[160:163], v[48:63]
s_waitcnt lgkmcnt(2)
ds_read_b128 v[8:11], v64 offset:20480
v_mfma_f32_32x32x16_bf16 v[48:63], v[16:19], v[164:167], v[48:63]
s_waitcnt lgkmcnt(2)
ds_read_b128 v[12:15], v64 offset:21504
v_mfma_f32_32x32x16_bf16 v[48:63], v[20:23], v[168:171], v[48:63]
s_waitcnt lgkmcnt(2)
ds_read_b128 v[16:19], v64 offset:22528
v_mfma_f32_32x32x16_bf16 v[48:63], v[24:27], v[172:175], v[48:63]
s_waitcnt lgkmcnt(2)
ds_read_b128 v[20:23], v64 offset:23552
v_mfma_f32_32x32x16_bf16 v[48:63], v[8:11], v[176:179], v[48:63]
s_waitcnt lgkmcnt(2)
ds_read_b128 v[24:27], v64 offset:24576
v_mfma_f32_32x32x16_bf16 v[48:63], v[12:15], v[180:183], v[48:63]
s_waitcnt lgkmcnt(2)
ds_read_b128 v[8:11], v64 offset:25600
v_mfma_f32_32x32x16_bf16 v[48:63], v[16:19], v[184:187], v[48:63]
s_waitcnt lgkmcnt(2)
ds_read_b128 v[12:15], v64 offset:26624
v_mfma_f32_32x32x16_bf16 v[48:63], v[20:23], v[188:191], v[48:63]
s_waitcnt lgkmcnt(2)
ds_read_b128 v[16:19], v64 offset:27648
v_mfma_f32_32x32x16_bf16 v[48:63], v[24:27], v[192:195], v[48:63]
s_waitcnt lgkmcnt(2)
ds_read_b128 v[20:23], v64 offset:28672
v_mfma_f32_32x32x16_bf16 v[48:63], v[8:11], v[196:199], v[48:63]
s_waitcnt lgkmcnt(2)
ds_read_b128 v[24:27], v64 offset:29696
v_mfma_f32_32x32x16_bf16 v[48:63], v[12:15], v[200:203], v[48:63]
s_waitcnt lgkmcnt(2)
ds_read_b128 v[8:11], v64 offset:30720
v_mfma_f32_32x32x16_bf16 v[48:63], v[16:19], v[204:207], v[48:63]
s_waitcnt lgkmcnt(2)
ds_read_b128 v[12:15], v64 offset:31744
v_mfma_f32_32x32x16_bf16 v[48:63], v[20:23], v[208:211], v[48:63]
s_waitcnt lgkmcnt(2)
ds_read_b128 v[16:19], v64 offset:32768
v_mfma_f32_32x32x16_bf16 v[48:63], v[24:27], v[212:215], v[48:63]
s_waitcnt lgkmcnt(2)
ds_read_b128 v[20:23], v64 offset:33792
v_mfma_f32_32x32x16_bf16 v[48:63], v[8:11], v[216:219], v[48:63]
s_waitcnt lgkmcnt(2)
ds_read_b128 v[24:27], v64 offset:34816
v_mfma_f32_32x32x16_bf16 v[48:63], v[12:15], v[220:223], v[48:63]
s_waitcnt lgkmcnt(2)
ds_read_b128 v[8:11], v64 offset:35840
v_mfma_f32_32x32x16_bf16 v[48:63], v[16:19], v[224:227], v[48:63]
s_waitcnt lgkmcnt(2)
ds_read_b128 v[12:15], v64 offset:36864
v_mfma_f32_32x32x16_bf16 v[48:63], v[20:23], v[228:231], v[48:63]
s_waitcnt lgkmcnt(2)
ds_read_b128 v[16:19], v64 offset:37888
v_mfma_f32_32x32x16_bf16 v[48:63], v[24:27], v[232:235], v[48:63]
s_waitcnt lgkmcnt(2)
ds_read_b128 v[20:23], v64 offset:38912
v_mfma_f32_32x32x16_bf16 v[48:63], v[8:11], v[236:239], v[48:63]
s_waitcnt lgkmcnt(2)
ds_read_b128 v[24:27], v64 offset:39936
v_mfma_f32_32x32x16_bf16 v[48:63], v[12:15], v[240:243], v[48:63]
s_add_u32 s44, s44, 1
s_cmp_eq_u32 s44, 3
s_mov_b32 s56, 40960
s_cmov_b32 s56, -81920
s_cselect_b32 s44, 0, s44
v_add_u32 v64, s56, v64
s_waitcnt vmcnt(10) lgkmcnt(2)
s_barrier
ds_read_b128 v[8:11], v64 offset:0
v_mfma_f32_32x32x16_bf16 v[48:63], v[16:19], v[244:247], v[48:63]
s_waitcnt lgkmcnt(2)
ds_read_b128 v[12:15], v64 offset:1024
v_mfma_f32_32x32x16_bf16 v[48:63], v[20:23], v[248:251], v[48:63]
s_waitcnt lgkmcnt(2)
ds_read_b128 v[16:19], v64 offset:2048
v_mfma_f32_32x32x16_bf16 v[48:63], v[24:27], v[252:255], v[48:63]
s_waitcnt lgkmcnt(2)
ds_read_b128 v[20:23], v64 offset:3072
v_mfma_f32_32x32x16_bf16 v[32:47], v[8:11], v[96:99], 0
s_waitcnt lgkmcnt(2)
ds_read_b128 v[24:27], v64 offset:4096
v_mfma_f32_32x32x16_bf16 v[32:47], v[12:15], v[100:103], v[32:47]
s_waitcnt lgkmcnt(2)
ds_read_b128 v[8:11], v64 offset:5120
v_cvt_pk_bf16_f32 v48, v48, v49
v_cvt_pk_bf16_f32 v49, v50, v51
v_mfma_f32_32x32x16_bf16 v[32:47], v[16:19], v[104:107], v[32:47]
s_waitcnt lgkmcnt(2)
ds_read_b128 v[12:15], v64 offset:6144
v_cvt_pk_bf16_f32 v50, v52, v53
v_cvt_pk_bf16_f32 v51, v54, v55
v_mfma_f32_32x32x16_bf16 v[32:47], v[20:23], v[108:111], v[32:47]
s_waitcnt lgkmcnt(2)
ds_read_b128 v[16:19], v64 offset:7168
v_cvt_pk_bf16_f32 v52, v56, v57
v_cvt_pk_bf16_f32 v53, v58, v59
v_mfma_f32_32x32x16_bf16 v[32:47], v[24:27], v[112:115], v[32:47]
s_waitcnt lgkmcnt(2)
ds_read_b128 v[20:23], v64 offset:8192
v_cvt_pk_bf16_f32 v54, v60, v61
v_cvt_pk_bf16_f32 v55, v62, v63
v_mfma_f32_32x32x16_bf16 v[32:47], v[8:11], v[116:119], v[32:47]
s_waitcnt lgkmcnt(2)
ds_read_b128 v[24:27], v64 offset:9216
v_accvgpr_write_b32 a104, v48
v_accvgpr_write_b32 a105, v49
v_mfma_f32_32x32x16_bf16 v[32:47], v[12:15], v[120:123], v[32:47]
s_waitcnt lgkmcnt(2)
ds_read_b128 v[8:11], v64 offset:10240
v_accvgpr_write_b32 a106, v50
v_accvgpr_write_b32 a107, v51
v_mfma_f32_32x32x16_bf16 v[32:47], v[16:19], v[124:127], v[32:47]
s_waitcnt lgkmcnt(2)
ds_read_b128 v[12:15], v64 offset:11264
v_accvgpr_write_b32 a108, v52
v_accvgpr_write_b32 a109, v53
v_mfma_f32_32x32x16_bf16 v[32:47], v[20:23], v[128:131], v[32:47]
s_waitcnt lgkmcnt(2)
ds_read_b128 v[16:19], v64 offset:12288
v_accvgpr_write_b32 a110, v54
v_accvgpr_write_b32 a111, v55
v_mfma_f32_32x32x16_bf16 v[32:47], v[24:27], v[132:135], v[32:47]
s_waitcnt lgkmcnt(2)
ds_read_b128 v[20:23], v64 offset:13312
s_add_u32 m0, s45, 0
s_add_u32 s55, s46, 0
buffer_load_dwordx4 v0, s[4:7], s55 offen offset:0 sc1 lds
buffer_load_dwordx4 v0, s[4:7], s55 offen offset:1024 sc1 lds
v_mfma_f32_32x32x16_bf16 v[32:47], v[8:11], v[136:139], v[32:47]
s_waitcnt lgkmcnt(2)
ds_read_b128 v[24:27], v64 offset:14336
buffer_load_dwordx4 v0, s[4:7], s55 offen offset:2048 sc1 lds
buffer_load_dwordx4 v0, s[4:7], s55 offen offset:3072 sc1 lds
v_mfma_f32_32x32x16_bf16 v[32:47], v[12:15], v[140:143], v[32:47]
s_waitcnt lgkmcnt(2)
ds_read_b128 v[8:11], v64 offset:15360
s_add_u32 m0, s45, 4096
s_add_u32 s55, s46, 4096
buffer_load_dwordx4 v0, s[4:7], s55 offen offset:0 sc1 lds
buffer_load_dwordx4 v0, s[4:7], s55 offen offset:1024 sc1 lds
v_mfma_f32_32x32x16_bf16 v[32:47], v[16:19], v[144:147], v[32:47]
s_waitcnt lgkmcnt(2)
ds_read_b128 v[12:15], v64 offset:16384
buffer_load_dwordx4 v0, s[4:7], s55 offen offset:2048 sc1 lds
buffer_load_dwordx4 v0, s[4:7], s55 offen offset:3072 sc1 lds
v_mfma_f32_32x32x16_bf16 v[32:47], v[20:23], v[148:151], v[32:47]
s_waitcnt lgkmcnt(2)
ds_read_b128 v[16:19], v64 offset:17408
s_add_u32 m0, s45, 8192
s_add_u32 s55, s46, 8192
buffer_load_dwordx4 v0, s[4:7], s55 offen offset:0 sc1 lds
buffer_load_dwordx4 v0, s[4:7], s55 offen offset:1024 sc1 lds
v_mfma_f32_32x32x16_bf16 v[32:47], v[24:27], v[152:155], v[32:47]
s_waitcnt lgkmcnt(2)
ds_read_b128 v[20:23], v64 offset:18432
s_add_u32 s45, s45, 40960
s_cmp_ge_u32 s45, 122880
s_cselect_b32 s55, 122880, 0
s_sub_u32 s45, s45, s55
s_add_u32 s46, s46, 40960
v_mfma_f32_32x32x16_bf16 v[32:47], v[8:11], v[156:159], v[32:47]
s_waitcnt lgkmcnt(2)
ds_read_b128 v[24:27], v64 offset:19456
v_mfma_f32_32x32x16_bf16 v[32:47], v[12:15], v[160:163], v[32:47]
s_waitcnt lgkmcnt(2)
ds_read_b128 v[8:11], v64 offset:20480
v_mfma_f32_32x32x16_bf16 v[32:47], v[16:19], v[164:167], v[32:47]
s_waitcnt lgkmcnt(2)
ds_read_b128 v[12:15], v64 offset:21504
v_mfma_f32_32x32x16_bf16 v[32:47], v[20:23], v[168:171], v[32:47]
s_waitcnt lgkmcnt(2)
ds_read_b128 v[16:19], v64 offset:22528
v_mfma_f32_32x32x16_bf16 v[32:47], v[24:27], v[172:175], v[32:47]
s_waitcnt lgkmcnt(2)
ds_read_b128 v[20:23], v64 offset:23552
v_mfma_f32_32x32x16_bf16 v[32:47], v[8:11], v[176:179], v[32:47]
s_waitcnt lgkmcnt(2)
ds_read_b128 v[24:27], v64 offset:24576
v_mfma_f32_32x32x16_bf16 v[32:47], v[12:15], v[180:183], v[32:47]
s_waitcnt lgkmcnt(2)
ds_read_b128 v[8:11], v64 offset:25600
v_mfma_f32_32x32x16_bf16 v[32:47], v[16:19], v[184:187], v[32:47]
s_waitcnt lgkmcnt(2)
ds_read_b128 v[12:15], v64 offset:26624
v_mfma_f32_32x32x16_bf16 v[32:47], v[20:23], v[188:191], v[32:47]
s_waitcnt lgkmcnt(2)
ds_read_b128 v[16:19], v64 offset:27648
v_mfma_f32_32x32x16_bf16 v[32:47], v[24:27], v[192:195], v[32:47]
s_waitcnt lgkmcnt(2)
ds_read_b128 v[20:23], v64 offset:28672
v_mfma_f32_32x32x16_bf16 v[32:47], v[8:11], v[196:199], v[32:47]
s_waitcnt lgkmcnt(2)
ds_read_b128 v[24:27], v64 offset:29696
v_mfma_f32_32x32x16_bf16 v[32:47], v[12:15], v[200:203], v[32:47]
s_waitcnt lgkmcnt(2)
ds_read_b128 v[8:11], v64 offset:30720
v_mfma_f32_32x32x16_bf16 v[32:47], v[16:19], v[204:207], v[32:47]
s_waitcnt lgkmcnt(2)
ds_read_b128 v[12:15], v64 offset:31744
v_mfma_f32_32x32x16_bf16 v[32:47], v[20:23], v[208:211], v[32:47]
s_waitcnt lgkmcnt(2)
ds_read_b128 v[16:19], v64 offset:32768
v_mfma_f32_32x32x16_bf16 v[32:47], v[24:27], v[212:215], v[32:47]
s_waitcnt lgkmcnt(2)
ds_read_b128 v[20:23], v64 offset:33792
v_mfma_f32_32x32x16_bf16 v[32:47], v[8:11], v[216:219], v[32:47]
s_waitcnt lgkmcnt(2)
ds_read_b128 v[24:27], v64 offset:34816
v_mfma_f32_32x32x16_bf16 v[32:47], v[12:15], v[220:223], v[32:47]
s_waitcnt lgkmcnt(2)
ds_read_b128 v[8:11], v64 offset:35840
v_mfma_f32_32x32x16_bf16 v[32:47], v[16:19], v[224:227], v[32:47]
s_waitcnt lgkmcnt(2)
ds_read_b128 v[12:15], v64 offset:36864
v_mfma_f32_32x32x16_bf16 v[32:47], v[20:23], v[228:231], v[32:47]
s_waitcnt lgkmcnt(2)
ds_read_b128 v[16:19], v64 offset:37888
v_mfma_f32_32x32x16_bf16 v[32:47], v[24:27], v[232:235], v[32:47]
s_waitcnt lgkmcnt(2)
ds_read_b128 v[20:23], v64 offset:38912
v_mfma_f32_32x32x16_bf16 v[32:47], v[8:11], v[236:239], v[32:47]
s_waitcnt lgkmcnt(2)
ds_read_b128 v[24:27], v64 offset:39936
v_mfma_f32_32x32x16_bf16 v[32:47], v[12:15], v[240:243], v[32:47]
s_add_u32 s44, s44, 1
s_cmp_eq_u32 s44, 3
s_mov_b32 s56, 40960
s_cmov_b32 s56, -81920
s_cselect_b32 s44, 0, s44
v_add_u32 v64, s56, v64
s_waitcnt vmcnt(10) lgkmcnt(2)
s_barrier
ds_read_b128 v[8:11], v64 offset:0
v_mfma_f32_32x32x16_bf16 v[32:47], v[16:19], v[244:247], v[32:47]
s_waitcnt lgkmcnt(2)
ds_read_b128 v[12:15], v64 offset:1024
v_mfma_f32_32x32x16_bf16 v[32:47], v[20:23], v[248:251], v[32:47]
s_waitcnt lgkmcnt(2)
ds_read_b128 v[16:19], v64 offset:2048
v_mfma_f32_32x32x16_bf16 v[32:47], v[24:27], v[252:255], v[32:47]
s_waitcnt lgkmcnt(2)
ds_read_b128 v[20:23], v64 offset:3072
v_mfma_f32_32x32x16_bf16 v[48:63], v[8:11], v[96:99], 0
s_waitcnt lgkmcnt(2)
ds_read_b128 v[24:27], v64 offset:4096
v_mfma_f32_32x32x16_bf16 v[48:63], v[12:15], v[100:103], v[48:63]
s_waitcnt lgkmcnt(2)
ds_read_b128 v[8:11], v64 offset:5120
v_cvt_pk_bf16_f32 v32, v32, v33
v_cvt_pk_bf16_f32 v33, v34, v35
v_mfma_f32_32x32x16_bf16 v[48:63], v[16:19], v[104:107], v[48:63]
s_waitcnt lgkmcnt(2)
ds_read_b128 v[12:15], v64 offset:6144
v_cvt_pk_bf16_f32 v34, v36, v37
v_cvt_pk_bf16_f32 v35, v38, v39
v_mfma_f32_32x32x16_bf16 v[48:63], v[20:23], v[108:111], v[48:63]
s_waitcnt lgkmcnt(2)
ds_read_b128 v[16:19], v64 offset:7168
v_cvt_pk_bf16_f32 v36, v40, v41
v_cvt_pk_bf16_f32 v37, v42, v43
v_mfma_f32_32x32x16_bf16 v[48:63], v[24:27], v[112:115], v[48:63]
s_waitcnt lgkmcnt(2)
ds_read_b128 v[20:23], v64 offset:8192
v_cvt_pk_bf16_f32 v38, v44, v45
v_cvt_pk_bf16_f32 v39, v46, v47
v_mfma_f32_32x32x16_bf16 v[48:63], v[8:11], v[116:119], v[48:63]
s_waitcnt lgkmcnt(2)
ds_read_b128 v[24:27], v64 offset:9216
v_accvgpr_write_b32 a112, v32
v_accvgpr_write_b32 a113, v33
v_mfma_f32_32x32x16_bf16 v[48:63], v[12:15], v[120:123], v[48:63]
s_waitcnt lgkmcnt(2)
ds_read_b128 v[8:11], v64 offset:10240
v_accvgpr_write_b32 a114, v34
v_accvgpr_write_b32 a115, v35
v_mfma_f32_32x32x16_bf16 v[48:63], v[16:19], v[124:127], v[48:63]
s_waitcnt lgkmcnt(2)
ds_read_b128 v[12:15], v64 offset:11264
v_accvgpr_write_b32 a116, v36
v_accvgpr_write_b32 a117, v37
v_mfma_f32_32x32x16_bf16 v[48:63], v[20:23], v[128:131], v[48:63]
s_waitcnt lgkmcnt(2)
ds_read_b128 v[16:19], v64 offset:12288
v_accvgpr_write_b32 a118, v38
v_accvgpr_write_b32 a119, v39
v_mfma_f32_32x32x16_bf16 v[48:63], v[24:27], v[132:135], v[48:63]
s_waitcnt lgkmcnt(2)
ds_read_b128 v[20:23], v64 offset:13312
s_add_u32 m0, s45, 0
s_add_u32 s55, s46, 0
buffer_load_dwordx4 v0, s[4:7], s55 offen offset:0 sc1 lds
buffer_load_dwordx4 v0, s[4:7], s55 offen offset:1024 sc1 lds
v_mfma_f32_32x32x16_bf16 v[48:63], v[8:11], v[136:139], v[48:63]
s_waitcnt lgkmcnt(2)
ds_read_b128 v[24:27], v64 offset:14336
buffer_load_dwordx4 v0, s[4:7], s55 offen offset:2048 sc1 lds
buffer_load_dwordx4 v0, s[4:7], s55 offen offset:3072 sc1 lds
v_mfma_f32_32x32x16_bf16 v[48:63], v[12:15], v[140:143], v[48:63]
s_waitcnt lgkmcnt(2)
ds_read_b128 v[8:11], v64 offset:15360
s_add_u32 m0, s45, 4096
s_add_u32 s55, s46, 4096
buffer_load_dwordx4 v0, s[4:7], s55 offen offset:0 sc1 lds
buffer_load_dwordx4 v0, s[4:7], s55 offen offset:1024 sc1 lds
v_mfma_f32_32x32x16_bf16 v[48:63], v[16:19], v[144:147], v[48:63]
s_waitcnt lgkmcnt(2)
ds_read_b128 v[12:15], v64 offset:16384
buffer_load_dwordx4 v0, s[4:7], s55 offen offset:2048 sc1 lds
buffer_load_dwordx4 v0, s[4:7], s55 offen offset:3072 sc1 lds
v_mfma_f32_32x32x16_bf16 v[48:63], v[20:23], v[148:151], v[48:63]
s_waitcnt lgkmcnt(2)
ds_read_b128 v[16:19], v64 offset:17408
s_add_u32 m0, s45, 8192
s_add_u32 s55, s46, 8192
buffer_load_dwordx4 v0, s[4:7], s55 offen offset:0 sc1 lds
buffer_load_dwordx4 v0, s[4:7], s55 offen offset:1024 sc1 lds
v_mfma_f32_32x32x16_bf16 v[48:63], v[24:27], v[152:155], v[48:63]
s_waitcnt lgkmcnt(2)
ds_read_b128 v[20:23], v64 offset:18432
s_add_u32 s45, s45, 40960
s_cmp_ge_u32 s45, 122880
s_cselect_b32 s55, 122880, 0
s_sub_u32 s45, s45, s55
s_add_u32 s46, s46, 40960
v_mfma_f32_32x32x16_bf16 v[48:63], v[8:11], v[156:159], v[48:63]
s_waitcnt lgkmcnt(2)
ds_read_b128 v[24:27], v64 offset:19456
v_mfma_f32_32x32x16_bf16 v[48:63], v[12:15], v[160:163], v[48:63]
s_waitcnt lgkmcnt(2)
ds_read_b128 v[8:11], v64 offset:20480
v_mfma_f32_32x32x16_bf16 v[48:63], v[16:19], v[164:167], v[48:63]
s_waitcnt lgkmcnt(2)
ds_read_b128 v[12:15], v64 offset:21504
v_mfma_f32_32x32x16_bf16 v[48:63], v[20:23], v[168:171], v[48:63]
s_waitcnt lgkmcnt(2)
ds_read_b128 v[16:19], v64 offset:22528
v_mfma_f32_32x32x16_bf16 v[48:63], v[24:27], v[172:175], v[48:63]
s_waitcnt lgkmcnt(2)
ds_read_b128 v[20:23], v64 offset:23552
v_mfma_f32_32x32x16_bf16 v[48:63], v[8:11], v[176:179], v[48:63]
s_waitcnt lgkmcnt(2)
ds_read_b128 v[24:27], v64 offset:24576
v_mfma_f32_32x32x16_bf16 v[48:63], v[12:15], v[180:183], v[48:63]
s_waitcnt lgkmcnt(2)
ds_read_b128 v[8:11], v64 offset:25600
v_mfma_f32_32x32x16_bf16 v[48:63], v[16:19], v[184:187], v[48:63]
s_waitcnt lgkmcnt(2)
ds_read_b128 v[12:15], v64 offset:26624
v_mfma_f32_32x32x16_bf16 v[48:63], v[20:23], v[188:191], v[48:63]
s_waitcnt lgkmcnt(2)
ds_read_b128 v[16:19], v64 offset:27648
v_mfma_f32_32x32x16_bf16 v[48:63], v[24:27], v[192:195], v[48:63]
s_waitcnt lgkmcnt(2)
ds_read_b128 v[20:23], v64 offset:28672
v_mfma_f32_32x32x16_bf16 v[48:63], v[8:11], v[196:199], v[48:63]
s_waitcnt lgkmcnt(2)
ds_read_b128 v[24:27], v64 offset:29696
v_mfma_f32_32x32x16_bf16 v[48:63], v[12:15], v[200:203], v[48:63]
s_waitcnt lgkmcnt(2)
ds_read_b128 v[8:11], v64 offset:30720
v_mfma_f32_32x32x16_bf16 v[48:63], v[16:19], v[204:207], v[48:63]
s_waitcnt lgkmcnt(2)
ds_read_b128 v[12:15], v64 offset:31744
v_mfma_f32_32x32x16_bf16 v[48:63], v[20:23], v[208:211], v[48:63]
s_waitcnt lgkmcnt(2)
ds_read_b128 v[16:19], v64 offset:32768
v_mfma_f32_32x32x16_bf16 v[48:63], v[24:27], v[212:215], v[48:63]
s_waitcnt lgkmcnt(2)
ds_read_b128 v[20:23], v64 offset:33792
v_mfma_f32_32x32x16_bf16 v[48:63], v[8:11], v[216:219], v[48:63]
s_waitcnt lgkmcnt(2)
ds_read_b128 v[24:27], v64 offset:34816
v_mfma_f32_32x32x16_bf16 v[48:63], v[12:15], v[220:223], v[48:63]
s_waitcnt lgkmcnt(2)
ds_read_b128 v[8:11], v64 offset:35840
v_mfma_f32_32x32x16_bf16 v[48:63], v[16:19], v[224:227], v[48:63]
s_waitcnt lgkmcnt(2)
ds_read_b128 v[12:15], v64 offset:36864
v_mfma_f32_32x32x16_bf16 v[48:63], v[20:23], v[228:231], v[48:63]
s_waitcnt lgkmcnt(2)
ds_read_b128 v[16:19], v64 offset:37888
v_mfma_f32_32x32x16_bf16 v[48:63], v[24:27], v[232:235], v[48:63]
s_waitcnt lgkmcnt(2)
ds_read_b128 v[20:23], v64 offset:38912
v_mfma_f32_32x32x16_bf16 v[48:63], v[8:11], v[236:239], v[48:63]
s_waitcnt lgkmcnt(2)
ds_read_b128 v[24:27], v64 offset:39936
v_mfma_f32_32x32x16_bf16 v[48:63], v[12:15], v[240:243], v[48:63]
s_add_u32 s44, s44, 1
s_cmp_eq_u32 s44, 3
s_mov_b32 s56, 40960
s_cmov_b32 s56, -81920
s_cselect_b32 s44, 0, s44
v_add_u32 v64, s56, v64
s_waitcnt vmcnt(10) lgkmcnt(2)
s_barrier
ds_read_b128 v[8:11], v64 offset:0
v_mfma_f32_32x32x16_bf16 v[48:63], v[16:19], v[244:247], v[48:63]
s_waitcnt lgkmcnt(2)
ds_read_b128 v[12:15], v64 offset:1024
v_mfma_f32_32x32x16_bf16 v[48:63], v[20:23], v[248:251], v[48:63]
s_waitcnt lgkmcnt(2)
ds_read_b128 v[16:19], v64 offset:2048
v_mfma_f32_32x32x16_bf16 v[48:63], v[24:27], v[252:255], v[48:63]
s_waitcnt lgkmcnt(2)
ds_read_b128 v[20:23], v64 offset:3072
v_mfma_f32_32x32x16_bf16 v[32:47], v[8:11], v[96:99], 0
s_waitcnt lgkmcnt(2)
ds_read_b128 v[24:27], v64 offset:4096
v_mfma_f32_32x32x16_bf16 v[32:47], v[12:15], v[100:103], v[32:47]
s_waitcnt lgkmcnt(2)
ds_read_b128 v[8:11], v64 offset:5120
v_cvt_pk_bf16_f32 v48, v48, v49
v_cvt_pk_bf16_f32 v49, v50, v51
v_mfma_f32_32x32x16_bf16 v[32:47], v[16:19], v[104:107], v[32:47]
s_waitcnt lgkmcnt(2)
ds_read_b128 v[12:15], v64 offset:6144
v_cvt_pk_bf16_f32 v50, v52, v53
v_cvt_pk_bf16_f32 v51, v54, v55
v_mfma_f32_32x32x16_bf16 v[32:47], v[20:23], v[108:111], v[32:47]
s_waitcnt lgkmcnt(2)
ds_read_b128 v[16:19], v64 offset:7168
v_cvt_pk_bf16_f32 v52, v56, v57
v_cvt_pk_bf16_f32 v53, v58, v59
v_mfma_f32_32x32x16_bf16 v[32:47], v[24:27], v[112:115], v[32:47]
s_waitcnt lgkmcnt(2)
ds_read_b128 v[20:23], v64 offset:8192
v_cvt_pk_bf16_f32 v54, v60, v61
v_cvt_pk_bf16_f32 v55, v62, v63
v_mfma_f32_32x32x16_bf16 v[32:47], v[8:11], v[116:119], v[32:47]
s_waitcnt lgkmcnt(2)
ds_read_b128 v[24:27], v64 offset:9216
v_accvgpr_write_b32 a120, v48
v_accvgpr_write_b32 a121, v49
v_mfma_f32_32x32x16_bf16 v[32:47], v[12:15], v[120:123], v[32:47]
s_waitcnt lgkmcnt(2)
ds_read_b128 v[8:11], v64 offset:10240
v_accvgpr_write_b32 a122, v50
v_accvgpr_write_b32 a123, v51
v_mfma_f32_32x32x16_bf16 v[32:47], v[16:19], v[124:127], v[32:47]
s_waitcnt lgkmcnt(2)
ds_read_b128 v[12:15], v64 offset:11264
v_accvgpr_write_b32 a124, v52
v_accvgpr_write_b32 a125, v53
v_mfma_f32_32x32x16_bf16 v[32:47], v[20:23], v[128:131], v[32:47]
s_waitcnt lgkmcnt(2)
ds_read_b128 v[16:19], v64 offset:12288
v_accvgpr_write_b32 a126, v54
v_accvgpr_write_b32 a127, v55
v_mfma_f32_32x32x16_bf16 v[32:47], v[24:27], v[132:135], v[32:47]
s_waitcnt lgkmcnt(2)
ds_read_b128 v[20:23], v64 offset:13312
s_add_u32 m0, s45, 0
s_add_u32 s55, s46, 0
buffer_load_dwordx4 v0, s[4:7], s55 offen offset:0 sc1 lds
buffer_load_dwordx4 v0, s[4:7], s55 offen offset:1024 sc1 lds
v_mfma_f32_32x32x16_bf16 v[32:47], v[8:11], v[136:139], v[32:47]
s_waitcnt lgkmcnt(2)
ds_read_b128 v[24:27], v64 offset:14336
buffer_load_dwordx4 v0, s[4:7], s55 offen offset:2048 sc1 lds
buffer_load_dwordx4 v0, s[4:7], s55 offen offset:3072 sc1 lds
v_mfma_f32_32x32x16_bf16 v[32:47], v[12:15], v[140:143], v[32:47]
s_waitcnt lgkmcnt(2)
ds_read_b128 v[8:11], v64 offset:15360
s_add_u32 m0, s45, 4096
s_add_u32 s55, s46, 4096
buffer_load_dwordx4 v0, s[4:7], s55 offen offset:0 sc1 lds
buffer_load_dwordx4 v0, s[4:7], s55 offen offset:1024 sc1 lds
v_mfma_f32_32x32x16_bf16 v[32:47], v[16:19], v[144:147], v[32:47]
s_waitcnt lgkmcnt(2)
ds_read_b128 v[12:15], v64 offset:16384
buffer_load_dwordx4 v0, s[4:7], s55 offen offset:2048 sc1 lds
buffer_load_dwordx4 v0, s[4:7], s55 offen offset:3072 sc1 lds
v_mfma_f32_32x32x16_bf16 v[32:47], v[20:23], v[148:151], v[32:47]
s_waitcnt lgkmcnt(2)
ds_read_b128 v[16:19], v64 offset:17408
s_add_u32 m0, s45, 8192
s_add_u32 s55, s46, 8192
buffer_load_dwordx4 v0, s[4:7], s55 offen offset:0 sc1 lds
buffer_load_dwordx4 v0, s[4:7], s55 offen offset:1024 sc1 lds
v_mfma_f32_32x32x16_bf16 v[32:47], v[24:27], v[152:155], v[32:47]
s_waitcnt lgkmcnt(2)
ds_read_b128 v[20:23], v64 offset:18432
s_add_u32 s45, s45, 40960
s_cmp_ge_u32 s45, 122880
s_cselect_b32 s55, 122880, 0
s_sub_u32 s45, s45, s55
s_add_u32 s46, s46, 40960
v_mfma_f32_32x32x16_bf16 v[32:47], v[8:11], v[156:159], v[32:47]
s_waitcnt lgkmcnt(2)
ds_read_b128 v[24:27], v64 offset:19456
v_mfma_f32_32x32x16_bf16 v[32:47], v[12:15], v[160:163], v[32:47]
s_waitcnt lgkmcnt(2)
ds_read_b128 v[8:11], v64 offset:20480
v_mfma_f32_32x32x16_bf16 v[32:47], v[16:19], v[164:167], v[32:47]
s_waitcnt lgkmcnt(2)
ds_read_b128 v[12:15], v64 offset:21504
v_mfma_f32_32x32x16_bf16 v[32:47], v[20:23], v[168:171], v[32:47]
s_waitcnt lgkmcnt(2)
ds_read_b128 v[16:19], v64 offset:22528
v_mfma_f32_32x32x16_bf16 v[32:47], v[24:27], v[172:175], v[32:47]
s_waitcnt lgkmcnt(2)
ds_read_b128 v[20:23], v64 offset:23552
v_mfma_f32_32x32x16_bf16 v[32:47], v[8:11], v[176:179], v[32:47]
s_waitcnt lgkmcnt(2)
ds_read_b128 v[24:27], v64 offset:24576
v_mfma_f32_32x32x16_bf16 v[32:47], v[12:15], v[180:183], v[32:47]
s_waitcnt lgkmcnt(2)
ds_read_b128 v[8:11], v64 offset:25600
v_mfma_f32_32x32x16_bf16 v[32:47], v[16:19], v[184:187], v[32:47]
s_waitcnt lgkmcnt(2)
ds_read_b128 v[12:15], v64 offset:26624
v_mfma_f32_32x32x16_bf16 v[32:47], v[20:23], v[188:191], v[32:47]
s_waitcnt lgkmcnt(2)
ds_read_b128 v[16:19], v64 offset:27648
v_mfma_f32_32x32x16_bf16 v[32:47], v[24:27], v[192:195], v[32:47]
s_waitcnt lgkmcnt(2)
ds_read_b128 v[20:23], v64 offset:28672
v_mfma_f32_32x32x16_bf16 v[32:47], v[8:11], v[196:199], v[32:47]
s_waitcnt lgkmcnt(2)
ds_read_b128 v[24:27], v64 offset:29696
v_mfma_f32_32x32x16_bf16 v[32:47], v[12:15], v[200:203], v[32:47]
s_waitcnt lgkmcnt(2)
ds_read_b128 v[8:11], v64 offset:30720
v_mfma_f32_32x32x16_bf16 v[32:47], v[16:19], v[204:207], v[32:47]
s_waitcnt lgkmcnt(2)
ds_read_b128 v[12:15], v64 offset:31744
v_mfma_f32_32x32x16_bf16 v[32:47], v[20:23], v[208:211], v[32:47]
s_waitcnt lgkmcnt(2)
ds_read_b128 v[16:19], v64 offset:32768
v_mfma_f32_32x32x16_bf16 v[32:47], v[24:27], v[212:215], v[32:47]
s_waitcnt lgkmcnt(2)
ds_read_b128 v[20:23], v64 offset:33792
v_mfma_f32_32x32x16_bf16 v[32:47], v[8:11], v[216:219], v[32:47]
s_waitcnt lgkmcnt(2)
ds_read_b128 v[24:27], v64 offset:34816
v_mfma_f32_32x32x16_bf16 v[32:47], v[12:15], v[220:223], v[32:47]
s_waitcnt lgkmcnt(2)
ds_read_b128 v[8:11], v64 offset:35840
v_mfma_f32_32x32x16_bf16 v[32:47], v[16:19], v[224:227], v[32:47]
s_waitcnt lgkmcnt(2)
ds_read_b128 v[12:15], v64 offset:36864
v_mfma_f32_32x32x16_bf16 v[32:47], v[20:23], v[228:231], v[32:47]
s_waitcnt lgkmcnt(2)
ds_read_b128 v[16:19], v64 offset:37888
v_mfma_f32_32x32x16_bf16 v[32:47], v[24:27], v[232:235], v[32:47]
s_waitcnt lgkmcnt(2)
ds_read_b128 v[20:23], v64 offset:38912
v_mfma_f32_32x32x16_bf16 v[32:47], v[8:11], v[236:239], v[32:47]
s_waitcnt lgkmcnt(2)
ds_read_b128 v[24:27], v64 offset:39936
v_mfma_f32_32x32x16_bf16 v[32:47], v[12:15], v[240:243], v[32:47]
s_add_u32 s44, s44, 1
s_cmp_eq_u32 s44, 3
s_mov_b32 s56, 40960
s_cmov_b32 s56, -81920
s_cselect_b32 s44, 0, s44
v_add_u32 v64, s56, v64
s_waitcnt vmcnt(10) lgkmcnt(2)
s_barrier
ds_read_b128 v[8:11], v64 offset:0
v_mfma_f32_32x32x16_bf16 v[32:47], v[16:19], v[244:247], v[32:47]
s_waitcnt lgkmcnt(2)
ds_read_b128 v[12:15], v64 offset:1024
v_mfma_f32_32x32x16_bf16 v[32:47], v[20:23], v[248:251], v[32:47]
s_waitcnt lgkmcnt(2)
ds_read_b128 v[16:19], v64 offset:2048
v_mfma_f32_32x32x16_bf16 v[32:47], v[24:27], v[252:255], v[32:47]
s_waitcnt lgkmcnt(2)
ds_read_b128 v[20:23], v64 offset:3072
v_mfma_f32_32x32x16_bf16 v[48:63], v[8:11], v[96:99], 0
s_waitcnt lgkmcnt(2)
ds_read_b128 v[24:27], v64 offset:4096
v_mfma_f32_32x32x16_bf16 v[48:63], v[12:15], v[100:103], v[48:63]
s_waitcnt lgkmcnt(2)
ds_read_b128 v[8:11], v64 offset:5120
v_cvt_pk_bf16_f32 v32, v32, v33
v_cvt_pk_bf16_f32 v33, v34, v35
v_mfma_f32_32x32x16_bf16 v[48:63], v[16:19], v[104:107], v[48:63]
s_waitcnt lgkmcnt(2)
ds_read_b128 v[12:15], v64 offset:6144
v_cvt_pk_bf16_f32 v34, v36, v37
v_cvt_pk_bf16_f32 v35, v38, v39
v_mfma_f32_32x32x16_bf16 v[48:63], v[20:23], v[108:111], v[48:63]
s_waitcnt lgkmcnt(2)
ds_read_b128 v[16:19], v64 offset:7168
v_cvt_pk_bf16_f32 v36, v40, v41
v_cvt_pk_bf16_f32 v37, v42, v43
v_mfma_f32_32x32x16_bf16 v[48:63], v[24:27], v[112:115], v[48:63]
s_waitcnt lgkmcnt(2)
ds_read_b128 v[20:23], v64 offset:8192
v_cvt_pk_bf16_f32 v38, v44, v45
v_cvt_pk_bf16_f32 v39, v46, v47
v_mfma_f32_32x32x16_bf16 v[48:63], v[8:11], v[116:119], v[48:63]
s_waitcnt lgkmcnt(2)
ds_read_b128 v[24:27], v64 offset:9216
v_accvgpr_write_b32 a128, v32
v_accvgpr_write_b32 a129, v33
v_mfma_f32_32x32x16_bf16 v[48:63], v[12:15], v[120:123], v[48:63]
s_waitcnt lgkmcnt(2)
ds_read_b128 v[8:11], v64 offset:10240
v_accvgpr_write_b32 a130, v34
v_accvgpr_write_b32 a131, v35
v_mfma_f32_32x32x16_bf16 v[48:63], v[16:19], v[124:127], v[48:63]
s_waitcnt lgkmcnt(2)
ds_read_b128 v[12:15], v64 offset:11264
v_accvgpr_write_b32 a132, v36
v_accvgpr_write_b32 a133, v37
v_mfma_f32_32x32x16_bf16 v[48:63], v[20:23], v[128:131], v[48:63]
s_waitcnt lgkmcnt(2)
ds_read_b128 v[16:19], v64 offset:12288
v_accvgpr_write_b32 a134, v38
v_accvgpr_write_b32 a135, v39
v_mfma_f32_32x32x16_bf16 v[48:63], v[24:27], v[132:135], v[48:63]
s_waitcnt lgkmcnt(2)
ds_read_b128 v[20:23], v64 offset:13312
s_add_u32 m0, s45, 0
s_add_u32 s55, s46, 0
buffer_load_dwordx4 v0, s[4:7], s55 offen offset:0 sc1 lds
buffer_load_dwordx4 v0, s[4:7], s55 offen offset:1024 sc1 lds
v_mfma_f32_32x32x16_bf16 v[48:63], v[8:11], v[136:139], v[48:63]
s_waitcnt lgkmcnt(2)
ds_read_b128 v[24:27], v64 offset:14336
buffer_load_dwordx4 v0, s[4:7], s55 offen offset:2048 sc1 lds
buffer_load_dwordx4 v0, s[4:7], s55 offen offset:3072 sc1 lds
v_mfma_f32_32x32x16_bf16 v[48:63], v[12:15], v[140:143], v[48:63]
s_waitcnt lgkmcnt(2)
ds_read_b128 v[8:11], v64 offset:15360
s_add_u32 m0, s45, 4096
s_add_u32 s55, s46, 4096
buffer_load_dwordx4 v0, s[4:7], s55 offen offset:0 sc1 lds
buffer_load_dwordx4 v0, s[4:7], s55 offen offset:1024 sc1 lds
v_mfma_f32_32x32x16_bf16 v[48:63], v[16:19], v[144:147], v[48:63]
s_waitcnt lgkmcnt(2)
ds_read_b128 v[12:15], v64 offset:16384
buffer_load_dwordx4 v0, s[4:7], s55 offen offset:2048 sc1 lds
buffer_load_dwordx4 v0, s[4:7], s55 offen offset:3072 sc1 lds
v_mfma_f32_32x32x16_bf16 v[48:63], v[20:23], v[148:151], v[48:63]
s_waitcnt lgkmcnt(2)
ds_read_b128 v[16:19], v64 offset:17408
s_add_u32 m0, s45, 8192
s_add_u32 s55, s46, 8192
buffer_load_dwordx4 v0, s[4:7], s55 offen offset:0 sc1 lds
buffer_load_dwordx4 v0, s[4:7], s55 offen offset:1024 sc1 lds
v_mfma_f32_32x32x16_bf16 v[48:63], v[24:27], v[152:155], v[48:63]
s_waitcnt lgkmcnt(2)
ds_read_b128 v[20:23], v64 offset:18432
s_add_u32 s45, s45, 40960
s_cmp_ge_u32 s45, 122880
s_cselect_b32 s55, 122880, 0
s_sub_u32 s45, s45, s55
s_add_u32 s46, s46, 40960
v_mfma_f32_32x32x16_bf16 v[48:63], v[8:11], v[156:159], v[48:63]
s_waitcnt lgkmcnt(2)
ds_read_b128 v[24:27], v64 offset:19456
v_mfma_f32_32x32x16_bf16 v[48:63], v[12:15], v[160:163], v[48:63]
s_waitcnt lgkmcnt(2)
ds_read_b128 v[8:11], v64 offset:20480
v_mfma_f32_32x32x16_bf16 v[48:63], v[16:19], v[164:167], v[48:63]
s_waitcnt lgkmcnt(2)
ds_read_b128 v[12:15], v64 offset:21504
v_mfma_f32_32x32x16_bf16 v[48:63], v[20:23], v[168:171], v[48:63]
s_waitcnt lgkmcnt(2)
ds_read_b128 v[16:19], v64 offset:22528
v_mfma_f32_32x32x16_bf16 v[48:63], v[24:27], v[172:175], v[48:63]
s_waitcnt lgkmcnt(2)
ds_read_b128 v[20:23], v64 offset:23552
v_mfma_f32_32x32x16_bf16 v[48:63], v[8:11], v[176:179], v[48:63]
s_waitcnt lgkmcnt(2)
ds_read_b128 v[24:27], v64 offset:24576
v_mfma_f32_32x32x16_bf16 v[48:63], v[12:15], v[180:183], v[48:63]
s_waitcnt lgkmcnt(2)
ds_read_b128 v[8:11], v64 offset:25600
v_mfma_f32_32x32x16_bf16 v[48:63], v[16:19], v[184:187], v[48:63]
s_waitcnt lgkmcnt(2)
ds_read_b128 v[12:15], v64 offset:26624
v_mfma_f32_32x32x16_bf16 v[48:63], v[20:23], v[188:191], v[48:63]
s_waitcnt lgkmcnt(2)
ds_read_b128 v[16:19], v64 offset:27648
v_mfma_f32_32x32x16_bf16 v[48:63], v[24:27], v[192:195], v[48:63]
s_waitcnt lgkmcnt(2)
ds_read_b128 v[20:23], v64 offset:28672
v_mfma_f32_32x32x16_bf16 v[48:63], v[8:11], v[196:199], v[48:63]
s_waitcnt lgkmcnt(2)
ds_read_b128 v[24:27], v64 offset:29696
v_mfma_f32_32x32x16_bf16 v[48:63], v[12:15], v[200:203], v[48:63]
s_waitcnt lgkmcnt(2)
ds_read_b128 v[8:11], v64 offset:30720
v_mfma_f32_32x32x16_bf16 v[48:63], v[16:19], v[204:207], v[48:63]
s_waitcnt lgkmcnt(2)
ds_read_b128 v[12:15], v64 offset:31744
v_mfma_f32_32x32x16_bf16 v[48:63], v[20:23], v[208:211], v[48:63]
s_waitcnt lgkmcnt(2)
ds_read_b128 v[16:19], v64 offset:32768
v_mfma_f32_32x32x16_bf16 v[48:63], v[24:27], v[212:215], v[48:63]
s_waitcnt lgkmcnt(2)
ds_read_b128 v[20:23], v64 offset:33792
v_mfma_f32_32x32x16_bf16 v[48:63], v[8:11], v[216:219], v[48:63]
s_waitcnt lgkmcnt(2)
ds_read_b128 v[24:27], v64 offset:34816
v_mfma_f32_32x32x16_bf16 v[48:63], v[12:15], v[220:223], v[48:63]
s_waitcnt lgkmcnt(2)
ds_read_b128 v[8:11], v64 offset:35840
v_mfma_f32_32x32x16_bf16 v[48:63], v[16:19], v[224:227], v[48:63]
s_waitcnt lgkmcnt(2)
ds_read_b128 v[12:15], v64 offset:36864
v_mfma_f32_32x32x16_bf16 v[48:63], v[20:23], v[228:231], v[48:63]
s_waitcnt lgkmcnt(2)
ds_read_b128 v[16:19], v64 offset:37888
v_mfma_f32_32x32x16_bf16 v[48:63], v[24:27], v[232:235], v[48:63]
s_waitcnt lgkmcnt(2)
ds_read_b128 v[20:23], v64 offset:38912
v_mfma_f32_32x32x16_bf16 v[48:63], v[8:11], v[236:239], v[48:63]
s_waitcnt lgkmcnt(2)
ds_read_b128 v[24:27], v64 offset:39936
v_mfma_f32_32x32x16_bf16 v[48:63], v[12:15], v[240:243], v[48:63]
s_add_u32 s44, s44, 1
s_cmp_eq_u32 s44, 3
s_mov_b32 s56, 40960
s_cmov_b32 s56, -81920
s_cselect_b32 s44, 0, s44
v_add_u32 v64, s56, v64
s_waitcnt vmcnt(10) lgkmcnt(2)
s_barrier
ds_read_b128 v[8:11], v64 offset:0
v_mfma_f32_32x32x16_bf16 v[48:63], v[16:19], v[244:247], v[48:63]
s_waitcnt lgkmcnt(2)
ds_read_b128 v[12:15], v64 offset:1024
v_mfma_f32_32x32x16_bf16 v[48:63], v[20:23], v[248:251], v[48:63]
s_waitcnt lgkmcnt(2)
ds_read_b128 v[16:19], v64 offset:2048
v_mfma_f32_32x32x16_bf16 v[48:63], v[24:27], v[252:255], v[48:63]
s_waitcnt lgkmcnt(2)
ds_read_b128 v[20:23], v64 offset:3072
v_mfma_f32_32x32x16_bf16 v[32:47], v[8:11], v[96:99], 0
s_waitcnt lgkmcnt(2)
ds_read_b128 v[24:27], v64 offset:4096
v_mfma_f32_32x32x16_bf16 v[32:47], v[12:15], v[100:103], v[32:47]
s_waitcnt lgkmcnt(2)
ds_read_b128 v[8:11], v64 offset:5120
v_cvt_pk_bf16_f32 v48, v48, v49
v_cvt_pk_bf16_f32 v49, v50, v51
v_mfma_f32_32x32x16_bf16 v[32:47], v[16:19], v[104:107], v[32:47]
s_waitcnt lgkmcnt(2)
ds_read_b128 v[12:15], v64 offset:6144
v_cvt_pk_bf16_f32 v50, v52, v53
v_cvt_pk_bf16_f32 v51, v54, v55
v_mfma_f32_32x32x16_bf16 v[32:47], v[20:23], v[108:111], v[32:47]
s_waitcnt lgkmcnt(2)
ds_read_b128 v[16:19], v64 offset:7168
v_cvt_pk_bf16_f32 v52, v56, v57
v_cvt_pk_bf16_f32 v53, v58, v59
v_mfma_f32_32x32x16_bf16 v[32:47], v[24:27], v[112:115], v[32:47]
s_waitcnt lgkmcnt(2)
ds_read_b128 v[20:23], v64 offset:8192
v_cvt_pk_bf16_f32 v54, v60, v61
v_cvt_pk_bf16_f32 v55, v62, v63
v_mfma_f32_32x32x16_bf16 v[32:47], v[8:11], v[116:119], v[32:47]
s_waitcnt lgkmcnt(2)
ds_read_b128 v[24:27], v64 offset:9216
v_accvgpr_write_b32 a136, v48
v_accvgpr_write_b32 a137, v49
v_mfma_f32_32x32x16_bf16 v[32:47], v[12:15], v[120:123], v[32:47]
s_waitcnt lgkmcnt(2)
ds_read_b128 v[8:11], v64 offset:10240
v_accvgpr_write_b32 a138, v50
v_accvgpr_write_b32 a139, v51
v_mfma_f32_32x32x16_bf16 v[32:47], v[16:19], v[124:127], v[32:47]
s_waitcnt lgkmcnt(2)
ds_read_b128 v[12:15], v64 offset:11264
v_accvgpr_write_b32 a140, v52
v_accvgpr_write_b32 a141, v53
v_mfma_f32_32x32x16_bf16 v[32:47], v[20:23], v[128:131], v[32:47]
s_waitcnt lgkmcnt(2)
ds_read_b128 v[16:19], v64 offset:12288
v_accvgpr_write_b32 a142, v54
v_accvgpr_write_b32 a143, v55
v_mfma_f32_32x32x16_bf16 v[32:47], v[24:27], v[132:135], v[32:47]
s_waitcnt lgkmcnt(2)
ds_read_b128 v[20:23], v64 offset:13312
s_add_u32 m0, s45, 0
s_add_u32 s55, s46, 0
buffer_load_dwordx4 v0, s[4:7], s55 offen offset:0 sc1 lds
buffer_load_dwordx4 v0, s[4:7], s55 offen offset:1024 sc1 lds
v_mfma_f32_32x32x16_bf16 v[32:47], v[8:11], v[136:139], v[32:47]
s_waitcnt lgkmcnt(2)
ds_read_b128 v[24:27], v64 offset:14336
buffer_load_dwordx4 v0, s[4:7], s55 offen offset:2048 sc1 lds
buffer_load_dwordx4 v0, s[4:7], s55 offen offset:3072 sc1 lds
v_mfma_f32_32x32x16_bf16 v[32:47], v[12:15], v[140:143], v[32:47]
s_waitcnt lgkmcnt(2)
ds_read_b128 v[8:11], v64 offset:15360
s_add_u32 m0, s45, 4096
s_add_u32 s55, s46, 4096
buffer_load_dwordx4 v0, s[4:7], s55 offen offset:0 sc1 lds
buffer_load_dwordx4 v0, s[4:7], s55 offen offset:1024 sc1 lds
v_mfma_f32_32x32x16_bf16 v[32:47], v[16:19], v[144:147], v[32:47]
s_waitcnt lgkmcnt(2)
ds_read_b128 v[12:15], v64 offset:16384
buffer_load_dwordx4 v0, s[4:7], s55 offen offset:2048 sc1 lds
buffer_load_dwordx4 v0, s[4:7], s55 offen offset:3072 sc1 lds
v_mfma_f32_32x32x16_bf16 v[32:47], v[20:23], v[148:151], v[32:47]
s_waitcnt lgkmcnt(2)
ds_read_b128 v[16:19], v64 offset:17408
s_add_u32 m0, s45, 8192
s_add_u32 s55, s46, 8192
buffer_load_dwordx4 v0, s[4:7], s55 offen offset:0 sc1 lds
buffer_load_dwordx4 v0, s[4:7], s55 offen offset:1024 sc1 lds
v_mfma_f32_32x32x16_bf16 v[32:47], v[24:27], v[152:155], v[32:47]
s_waitcnt lgkmcnt(2)
ds_read_b128 v[20:23], v64 offset:18432
s_add_u32 s45, s45, 40960
s_cmp_ge_u32 s45, 122880
s_cselect_b32 s55, 122880, 0
s_sub_u32 s45, s45, s55
s_add_u32 s46, s46, 40960
v_mfma_f32_32x32x16_bf16 v[32:47], v[8:11], v[156:159], v[32:47]
s_waitcnt lgkmcnt(2)
ds_read_b128 v[24:27], v64 offset:19456
v_mfma_f32_32x32x16_bf16 v[32:47], v[12:15], v[160:163], v[32:47]
s_waitcnt lgkmcnt(2)
ds_read_b128 v[8:11], v64 offset:20480
v_mfma_f32_32x32x16_bf16 v[32:47], v[16:19], v[164:167], v[32:47]
s_waitcnt lgkmcnt(2)
ds_read_b128 v[12:15], v64 offset:21504
v_mfma_f32_32x32x16_bf16 v[32:47], v[20:23], v[168:171], v[32:47]
s_waitcnt lgkmcnt(2)
ds_read_b128 v[16:19], v64 offset:22528
v_mfma_f32_32x32x16_bf16 v[32:47], v[24:27], v[172:175], v[32:47]
s_waitcnt lgkmcnt(2)
ds_read_b128 v[20:23], v64 offset:23552
v_mfma_f32_32x32x16_bf16 v[32:47], v[8:11], v[176:179], v[32:47]
s_waitcnt lgkmcnt(2)
ds_read_b128 v[24:27], v64 offset:24576
v_mfma_f32_32x32x16_bf16 v[32:47], v[12:15], v[180:183], v[32:47]
s_waitcnt lgkmcnt(2)
ds_read_b128 v[8:11], v64 offset:25600
v_mfma_f32_32x32x16_bf16 v[32:47], v[16:19], v[184:187], v[32:47]
s_waitcnt lgkmcnt(2)
ds_read_b128 v[12:15], v64 offset:26624
v_mfma_f32_32x32x16_bf16 v[32:47], v[20:23], v[188:191], v[32:47]
s_waitcnt lgkmcnt(2)
ds_read_b128 v[16:19], v64 offset:27648
v_mfma_f32_32x32x16_bf16 v[32:47], v[24:27], v[192:195], v[32:47]
s_waitcnt lgkmcnt(2)
ds_read_b128 v[20:23], v64 offset:28672
v_mfma_f32_32x32x16_bf16 v[32:47], v[8:11], v[196:199], v[32:47]
s_waitcnt lgkmcnt(2)
ds_read_b128 v[24:27], v64 offset:29696
v_mfma_f32_32x32x16_bf16 v[32:47], v[12:15], v[200:203], v[32:47]
s_waitcnt lgkmcnt(2)
ds_read_b128 v[8:11], v64 offset:30720
v_mfma_f32_32x32x16_bf16 v[32:47], v[16:19], v[204:207], v[32:47]
s_waitcnt lgkmcnt(2)
ds_read_b128 v[12:15], v64 offset:31744
v_mfma_f32_32x32x16_bf16 v[32:47], v[20:23], v[208:211], v[32:47]
s_waitcnt lgkmcnt(2)
ds_read_b128 v[16:19], v64 offset:32768
v_mfma_f32_32x32x16_bf16 v[32:47], v[24:27], v[212:215], v[32:47]
s_waitcnt lgkmcnt(2)
ds_read_b128 v[20:23], v64 offset:33792
v_mfma_f32_32x32x16_bf16 v[32:47], v[8:11], v[216:219], v[32:47]
s_waitcnt lgkmcnt(2)
ds_read_b128 v[24:27], v64 offset:34816
v_mfma_f32_32x32x16_bf16 v[32:47], v[12:15], v[220:223], v[32:47]
s_waitcnt lgkmcnt(2)
ds_read_b128 v[8:11], v64 offset:35840
v_mfma_f32_32x32x16_bf16 v[32:47], v[16:19], v[224:227], v[32:47]
s_waitcnt lgkmcnt(2)
ds_read_b128 v[12:15], v64 offset:36864
v_mfma_f32_32x32x16_bf16 v[32:47], v[20:23], v[228:231], v[32:47]
s_waitcnt lgkmcnt(2)
ds_read_b128 v[16:19], v64 offset:37888
v_mfma_f32_32x32x16_bf16 v[32:47], v[24:27], v[232:235], v[32:47]
s_waitcnt lgkmcnt(2)
ds_read_b128 v[20:23], v64 offset:38912
v_mfma_f32_32x32x16_bf16 v[32:47], v[8:11], v[236:239], v[32:47]
s_waitcnt lgkmcnt(2)
ds_read_b128 v[24:27], v64 offset:39936
v_mfma_f32_32x32x16_bf16 v[32:47], v[12:15], v[240:243], v[32:47]
s_add_u32 s44, s44, 1
s_cmp_eq_u32 s44, 3
s_mov_b32 s56, 40960
s_cmov_b32 s56, -81920
s_cselect_b32 s44, 0, s44
v_add_u32 v64, s56, v64
s_waitcnt vmcnt(10) lgkmcnt(2)
s_barrier
ds_read_b128 v[8:11], v64 offset:0
v_mfma_f32_32x32x16_bf16 v[32:47], v[16:19], v[244:247], v[32:47]
s_waitcnt lgkmcnt(2)
ds_read_b128 v[12:15], v64 offset:1024
v_mfma_f32_32x32x16_bf16 v[32:47], v[20:23], v[248:251], v[32:47]
s_waitcnt lgkmcnt(2)
ds_read_b128 v[16:19], v64 offset:2048
v_mfma_f32_32x32x16_bf16 v[32:47], v[24:27], v[252:255], v[32:47]
s_waitcnt lgkmcnt(2)
ds_read_b128 v[20:23], v64 offset:3072
v_mfma_f32_32x32x16_bf16 v[48:63], v[8:11], v[96:99], 0
s_waitcnt lgkmcnt(2)
ds_read_b128 v[24:27], v64 offset:4096
v_mfma_f32_32x32x16_bf16 v[48:63], v[12:15], v[100:103], v[48:63]
s_waitcnt lgkmcnt(2)
ds_read_b128 v[8:11], v64 offset:5120
v_cvt_pk_bf16_f32 v32, v32, v33
v_cvt_pk_bf16_f32 v33, v34, v35
v_mfma_f32_32x32x16_bf16 v[48:63], v[16:19], v[104:107], v[48:63]
s_waitcnt lgkmcnt(2)
ds_read_b128 v[12:15], v64 offset:6144
v_cvt_pk_bf16_f32 v34, v36, v37
v_cvt_pk_bf16_f32 v35, v38, v39
v_mfma_f32_32x32x16_bf16 v[48:63], v[20:23], v[108:111], v[48:63]
s_waitcnt lgkmcnt(2)
ds_read_b128 v[16:19], v64 offset:7168
v_cvt_pk_bf16_f32 v36, v40, v41
v_cvt_pk_bf16_f32 v37, v42, v43
v_mfma_f32_32x32x16_bf16 v[48:63], v[24:27], v[112:115], v[48:63]
s_waitcnt lgkmcnt(2)
ds_read_b128 v[20:23], v64 offset:8192
v_cvt_pk_bf16_f32 v38, v44, v45
v_cvt_pk_bf16_f32 v39, v46, v47
v_mfma_f32_32x32x16_bf16 v[48:63], v[8:11], v[116:119], v[48:63]
s_waitcnt lgkmcnt(2)
ds_read_b128 v[24:27], v64 offset:9216
v_accvgpr_write_b32 a144, v32
v_accvgpr_write_b32 a145, v33
v_mfma_f32_32x32x16_bf16 v[48:63], v[12:15], v[120:123], v[48:63]
s_waitcnt lgkmcnt(2)
ds_read_b128 v[8:11], v64 offset:10240
v_accvgpr_write_b32 a146, v34
v_accvgpr_write_b32 a147, v35
v_mfma_f32_32x32x16_bf16 v[48:63], v[16:19], v[124:127], v[48:63]
s_waitcnt lgkmcnt(2)
ds_read_b128 v[12:15], v64 offset:11264
v_accvgpr_write_b32 a148, v36
v_accvgpr_write_b32 a149, v37
v_mfma_f32_32x32x16_bf16 v[48:63], v[20:23], v[128:131], v[48:63]
s_waitcnt lgkmcnt(2)
ds_read_b128 v[16:19], v64 offset:12288
v_accvgpr_write_b32 a150, v38
v_accvgpr_write_b32 a151, v39
v_mfma_f32_32x32x16_bf16 v[48:63], v[24:27], v[132:135], v[48:63]
s_waitcnt lgkmcnt(2)
ds_read_b128 v[20:23], v64 offset:13312
s_add_u32 m0, s45, 0
s_add_u32 s55, s46, 0
buffer_load_dwordx4 v0, s[4:7], s55 offen offset:0 sc1 lds
buffer_load_dwordx4 v0, s[4:7], s55 offen offset:1024 sc1 lds
v_mfma_f32_32x32x16_bf16 v[48:63], v[8:11], v[136:139], v[48:63]
s_waitcnt lgkmcnt(2)
ds_read_b128 v[24:27], v64 offset:14336
buffer_load_dwordx4 v0, s[4:7], s55 offen offset:2048 sc1 lds
buffer_load_dwordx4 v0, s[4:7], s55 offen offset:3072 sc1 lds
v_mfma_f32_32x32x16_bf16 v[48:63], v[12:15], v[140:143], v[48:63]
s_waitcnt lgkmcnt(2)
ds_read_b128 v[8:11], v64 offset:15360
s_add_u32 m0, s45, 4096
s_add_u32 s55, s46, 4096
buffer_load_dwordx4 v0, s[4:7], s55 offen offset:0 sc1 lds
buffer_load_dwordx4 v0, s[4:7], s55 offen offset:1024 sc1 lds
v_mfma_f32_32x32x16_bf16 v[48:63], v[16:19], v[144:147], v[48:63]
s_waitcnt lgkmcnt(2)
ds_read_b128 v[12:15], v64 offset:16384
buffer_load_dwordx4 v0, s[4:7], s55 offen offset:2048 sc1 lds
buffer_load_dwordx4 v0, s[4:7], s55 offen offset:3072 sc1 lds
v_mfma_f32_32x32x16_bf16 v[48:63], v[20:23], v[148:151], v[48:63]
s_waitcnt lgkmcnt(2)
ds_read_b128 v[16:19], v64 offset:17408
s_add_u32 m0, s45, 8192
s_add_u32 s55, s46, 8192
buffer_load_dwordx4 v0, s[4:7], s55 offen offset:0 sc1 lds
buffer_load_dwordx4 v0, s[4:7], s55 offen offset:1024 sc1 lds
v_mfma_f32_32x32x16_bf16 v[48:63], v[24:27], v[152:155], v[48:63]
s_waitcnt lgkmcnt(2)
ds_read_b128 v[20:23], v64 offset:18432
s_add_u32 s45, s45, 40960
s_cmp_ge_u32 s45, 122880
s_cselect_b32 s55, 122880, 0
s_sub_u32 s45, s45, s55
s_add_u32 s46, s46, 40960
v_mfma_f32_32x32x16_bf16 v[48:63], v[8:11], v[156:159], v[48:63]
s_waitcnt lgkmcnt(2)
ds_read_b128 v[24:27], v64 offset:19456
v_mfma_f32_32x32x16_bf16 v[48:63], v[12:15], v[160:163], v[48:63]
s_waitcnt lgkmcnt(2)
ds_read_b128 v[8:11], v64 offset:20480
v_mfma_f32_32x32x16_bf16 v[48:63], v[16:19], v[164:167], v[48:63]
s_waitcnt lgkmcnt(2)
ds_read_b128 v[12:15], v64 offset:21504
v_mfma_f32_32x32x16_bf16 v[48:63], v[20:23], v[168:171], v[48:63]
s_waitcnt lgkmcnt(2)
ds_read_b128 v[16:19], v64 offset:22528
v_mfma_f32_32x32x16_bf16 v[48:63], v[24:27], v[172:175], v[48:63]
s_waitcnt lgkmcnt(2)
ds_read_b128 v[20:23], v64 offset:23552
v_mfma_f32_32x32x16_bf16 v[48:63], v[8:11], v[176:179], v[48:63]
s_waitcnt lgkmcnt(2)
ds_read_b128 v[24:27], v64 offset:24576
v_mfma_f32_32x32x16_bf16 v[48:63], v[12:15], v[180:183], v[48:63]
s_waitcnt lgkmcnt(2)
ds_read_b128 v[8:11], v64 offset:25600
v_mfma_f32_32x32x16_bf16 v[48:63], v[16:19], v[184:187], v[48:63]
s_waitcnt lgkmcnt(2)
ds_read_b128 v[12:15], v64 offset:26624
v_mfma_f32_32x32x16_bf16 v[48:63], v[20:23], v[188:191], v[48:63]
s_waitcnt lgkmcnt(2)
ds_read_b128 v[16:19], v64 offset:27648
v_mfma_f32_32x32x16_bf16 v[48:63], v[24:27], v[192:195], v[48:63]
s_waitcnt lgkmcnt(2)
ds_read_b128 v[20:23], v64 offset:28672
v_mfma_f32_32x32x16_bf16 v[48:63], v[8:11], v[196:199], v[48:63]
s_waitcnt lgkmcnt(2)
ds_read_b128 v[24:27], v64 offset:29696
v_mfma_f32_32x32x16_bf16 v[48:63], v[12:15], v[200:203], v[48:63]
s_waitcnt lgkmcnt(2)
ds_read_b128 v[8:11], v64 offset:30720
v_mfma_f32_32x32x16_bf16 v[48:63], v[16:19], v[204:207], v[48:63]
s_waitcnt lgkmcnt(2)
ds_read_b128 v[12:15], v64 offset:31744
v_mfma_f32_32x32x16_bf16 v[48:63], v[20:23], v[208:211], v[48:63]
s_waitcnt lgkmcnt(2)
ds_read_b128 v[16:19], v64 offset:32768
v_mfma_f32_32x32x16_bf16 v[48:63], v[24:27], v[212:215], v[48:63]
s_waitcnt lgkmcnt(2)
ds_read_b128 v[20:23], v64 offset:33792
v_mfma_f32_32x32x16_bf16 v[48:63], v[8:11], v[216:219], v[48:63]
s_waitcnt lgkmcnt(2)
ds_read_b128 v[24:27], v64 offset:34816
v_mfma_f32_32x32x16_bf16 v[48:63], v[12:15], v[220:223], v[48:63]
s_waitcnt lgkmcnt(2)
ds_read_b128 v[8:11], v64 offset:35840
v_mfma_f32_32x32x16_bf16 v[48:63], v[16:19], v[224:227], v[48:63]
s_waitcnt lgkmcnt(2)
ds_read_b128 v[12:15], v64 offset:36864
v_mfma_f32_32x32x16_bf16 v[48:63], v[20:23], v[228:231], v[48:63]
s_waitcnt lgkmcnt(2)
ds_read_b128 v[16:19], v64 offset:37888
v_mfma_f32_32x32x16_bf16 v[48:63], v[24:27], v[232:235], v[48:63]
s_waitcnt lgkmcnt(2)
ds_read_b128 v[20:23], v64 offset:38912
v_mfma_f32_32x32x16_bf16 v[48:63], v[8:11], v[236:239], v[48:63]
s_waitcnt lgkmcnt(2)
ds_read_b128 v[24:27], v64 offset:39936
v_mfma_f32_32x32x16_bf16 v[48:63], v[12:15], v[240:243], v[48:63]
s_add_u32 s44, s44, 1
s_cmp_eq_u32 s44, 3
s_mov_b32 s56, 40960
s_cmov_b32 s56, -81920
s_cselect_b32 s44, 0, s44
v_add_u32 v64, s56, v64
s_waitcnt vmcnt(10) lgkmcnt(2)
s_barrier
ds_read_b128 v[8:11], v64 offset:0
v_mfma_f32_32x32x16_bf16 v[48:63], v[16:19], v[244:247], v[48:63]
s_waitcnt lgkmcnt(2)
ds_read_b128 v[12:15], v64 offset:1024
v_mfma_f32_32x32x16_bf16 v[48:63], v[20:23], v[248:251], v[48:63]
s_waitcnt lgkmcnt(2)
ds_read_b128 v[16:19], v64 offset:2048
v_mfma_f32_32x32x16_bf16 v[48:63], v[24:27], v[252:255], v[48:63]
s_waitcnt lgkmcnt(2)
ds_read_b128 v[20:23], v64 offset:3072
s_nop 9
v_cvt_pk_bf16_f32 v48, v48, v49
v_cvt_pk_bf16_f32 v49, v50, v51
v_cvt_pk_bf16_f32 v50, v52, v53
v_cvt_pk_bf16_f32 v51, v54, v55
v_cvt_pk_bf16_f32 v52, v56, v57
v_cvt_pk_bf16_f32 v53, v58, v59
v_cvt_pk_bf16_f32 v54, v60, v61
v_cvt_pk_bf16_f32 v55, v62, v63
v_accvgpr_write_b32 a152, v48
v_accvgpr_write_b32 a153, v49
v_accvgpr_write_b32 a154, v50
v_accvgpr_write_b32 a155, v51
v_accvgpr_write_b32 a156, v52
v_accvgpr_write_b32 a157, v53
v_accvgpr_write_b32 a158, v54
v_accvgpr_write_b32 a159, v55
s_cmp_eq_u32 s3, 0
s_cselect_b32 s52, 0, -1
v_or_b32 v3, s52, v30
s_waitcnt vmcnt(0) lgkmcnt(0)
s_barrier
k_nxt_44:
s_cmp_ge_u32 s30, 80
s_cbranch_scc1 k_fend_45
v_bfe_u32 v8, v0, 4, 5
v_lshrrev_b32 v9, 9, v0
s_lshl_b32 s52, s30, 2
s_add_u32 s52, s52, s3
s_cmp_eq_u32 s52, 0
s_cselect_b32 s47, 0xffff, -1
s_cselect_b32 s53, 0x30000, 0
s_cmov_b32 s52, 320
v_add_u32 v26, s53, v0
s_cmp_lg_u32 s51, 0
s_cbranch_scc1 k_fnog_46
s_load_dwordx2 s[36:37], s[0:1], 64
s_mov_b32 s38, 1314816
s_mov_b32 s39, 0x20000
s_load_dwordx2 s[40:41], s[0:1], 72
s_mov_b32 s42, 1314816
s_mov_b32 s43, 0x20000
v_lshl_add_u32 v20, v9, 8, v8
v_mul_u32_u24 v20, 642, v20
s_lshl_b32 s52, s52, 1
v_add_u32 v22, s52, v20
s_waitcnt lgkmcnt(0)
s_mov_b32 s53, 0
buffer_load_ushort v192, v22, s[36:39], s53 offen
buffer_load_ushort v208, v22, s[40:43], s53 offen
s_mov_b32 s53, 41088
buffer_load_ushort v193, v22, s[36:39], s53 offen
buffer_load_ushort v209, v22, s[40:43], s53 offen
s_mov_b32 s53, 82176
buffer_load_ushort v194, v22, s[36:39], s53 offen
buffer_load_ushort v210, v22, s[40:43], s53 offen
s_mov_b32 s53, 123264
buffer_load_ushort v195, v22, s[36:39], s53 offen
buffer_load_ushort v211, v22, s[40:43], s53 offen
s_mov_b32 s53, 328704
buffer_load_ushort v196, v22, s[36:39], s53 offen
buffer_load_ushort v212, v22, s[40:43], s53 offen
s_mov_b32 s53, 369792
buffer_load_ushort v197, v22, s[36:39], s53 offen
buffer_load_ushort v213, v22, s[40:43], s53 offen
s_mov_b32 s53, 410880
buffer_load_ushort v198, v22, s[36:39], s53 offen
buffer_load_ushort v214, v22, s[40:43], s53 offen
s_mov_b32 s53, 451968
buffer_load_ushort v199, v22, s[36:39], s53 offen
buffer_load_ushort v215, v22, s[40:43], s53 offen
s_mov_b32 s53, 657408
buffer_load_ushort v200, v22, s[36:39], s53 offen
buffer_load_ushort v216, v22, s[40:43], s53 offen
s_mov_b32 s53, 698496
buffer_load_ushort v201, v22, s[36:39], s53 offen
buffer_load_ushort v217, v22, s[40:43], s53 offen
s_mov_b32 s53, 739584
buffer_load_ushort v202, v22, s[36:39], s53 offen
buffer_load_ushort v218, v22, s[40:43], s53 offen
s_mov_b32 s53, 780672
buffer_load_ushort v203, v22, s[36:39], s53 offen
buffer_load_ushort v219, v22, s[40:43], s53 offen
s_mov_b32 s53, 986112
buffer_load_ushort v204, v22, s[36:39], s53 offen
buffer_load_ushort v220, v22, s[40:43], s53 offen
s_mov_b32 s53, 1027200
buffer_load_ushort v205, v22, s[36:39], s53 offen
buffer_load_ushort v221, v22, s[40:43], s53 offen
s_mov_b32 s53, 1068288
buffer_load_ushort v206, v22, s[36:39], s53 offen
buffer_load_ushort v222, v22, s[40:43], s53 offen
s_mov_b32 s53, 1109376
buffer_load_ushort v207, v22, s[36:39], s53 offen
buffer_load_ushort v223, v22, s[40:43], s53 offen
s_mov_b32 s53, 20544
buffer_load_ushort v224, v22, s[36:39], s53 offen
buffer_load_ushort v240, v22, s[40:43], s53 offen
s_mov_b32 s53, 61632
buffer_load_ushort v225, v22, s[36:39], s53 offen
buffer_load_ushort v241, v22, s[40:43], s53 offen
s_mov_b32 s53, 102720
buffer_load_ushort v226, v22, s[36:39], s53 offen
buffer_load_ushort v242, v22, s[40:43], s53 offen
s_mov_b32 s53, 143808
buffer_load_ushort v227, v22, s[36:39], s53 offen
buffer_load_ushort v243, v22, s[40:43], s53 offen
s_mov_b32 s53, 349248
buffer_load_ushort v228, v22, s[36:39], s53 offen
buffer_load_ushort v244, v22, s[40:43], s53 offen
s_mov_b32 s53, 390336
buffer_load_ushort v229, v22, s[36:39], s53 offen
buffer_load_ushort v245, v22, s[40:43], s53 offen
s_mov_b32 s53, 431424
buffer_load_ushort v230, v22, s[36:39], s53 offen
buffer_load_ushort v246, v22, s[40:43], s53 offen
s_mov_b32 s53, 472512
buffer_load_ushort v231, v22, s[36:39], s53 offen
buffer_load_ushort v247, v22, s[40:43], s53 offen
s_mov_b32 s53, 677952
buffer_load_ushort v232, v22, s[36:39], s53 offen
buffer_load_ushort v248, v22, s[40:43], s53 offen
s_mov_b32 s53, 719040
buffer_load_ushort v233, v22, s[36:39], s53 offen
buffer_load_ushort v249, v22, s[40:43], s53 offen
s_mov_b32 s53, 760128
buffer_load_ushort v234, v22, s[36:39], s53 offen
buffer_load_ushort v250, v22, s[40:43], s53 offen
s_mov_b32 s53, 801216
buffer_load_ushort v235, v22, s[36:39], s53 offen
buffer_load_ushort v251, v22, s[40:43], s53 offen
s_mov_b32 s53, 1006656
buffer_load_ushort v236, v22, s[36:39], s53 offen
buffer_load_ushort v252, v22, s[40:43], s53 offen
s_mov_b32 s53, 1047744
buffer_load_ushort v237, v22, s[36:39], s53 offen
buffer_load_ushort v253, v22, s[40:43], s53 offen
s_mov_b32 s53, 1088832
buffer_load_ushort v238, v22, s[36:39], s53 offen
buffer_load_ushort v254, v22, s[40:43], s53 offen
s_mov_b32 s53, 1129920
buffer_load_ushort v239, v22, s[36:39], s53 offen
buffer_load_ushort v255, v22, s[40:43], s53 offen
v_lshl_add_u32 v10, v9, 2, 0
v_mul_u32_u24 v10, v10, v8
v_and_b32 v20, 31, v10
v_cvt_f32_u32 v20, v20
v_mul_f32 v20, 0x3d000000, v20
v_sin_f32 v21, v20
v_cos_f32 v20, v20
v_add_u32 v10, v8, v10
v_cvt_pk_bf16_f32 v32, v20, v21
v_cvt_pk_bf16_f32 v36, -v21, v20
v_and_b32 v20, 31, v10
v_cvt_f32_u32 v20, v20
v_mul_f32 v20, 0x3d000000, v20
v_sin_f32 v21, v20
v_cos_f32 v20, v20
v_add_u32 v10, v8, v10
v_cvt_pk_bf16_f32 v33, v20, v21
v_cvt_pk_bf16_f32 v37, -v21, v20
v_and_b32 v20, 31, v10
v_cvt_f32_u32 v20, v20
v_mul_f32 v20, 0x3d000000, v20
v_sin_f32 v21, v20
v_cos_f32 v20, v20
v_add_u32 v10, v8, v10
v_cvt_pk_bf16_f32 v34, v20, v21
v_cvt_pk_bf16_f32 v38, -v21, v20
v_and_b32 v20, 31, v10
v_cvt_f32_u32 v20, v20
v_mul_f32 v20, 0x3d000000, v20
v_sin_f32 v21, v20
v_cos_f32 v20, v20
v_add_u32 v10, v8, v10
v_cvt_pk_bf16_f32 v35, v20, v21
v_cvt_pk_bf16_f32 v39, -v21, v20
v_accvgpr_write_b32 a160, v32
v_accvgpr_write_b32 a161, v33
v_accvgpr_write_b32 a162, v34
v_accvgpr_write_b32 a163, v35
v_accvgpr_write_b32 a164, v36
v_accvgpr_write_b32 a165, v37
v_accvgpr_write_b32 a166, v38
v_accvgpr_write_b32 a167, v39
v_lshl_add_u32 v10, v9, 2, 8
v_mul_u32_u24 v10, v10, v8
v_and_b32 v20, 31, v10
v_cvt_f32_u32 v20, v20
v_mul_f32 v20, 0x3d000000, v20
v_sin_f32 v21, v20
v_cos_f32 v20, v20
v_add_u32 v10, v8, v10
v_cvt_pk_bf16_f32 v32, v20, v21
v_cvt_pk_bf16_f32 v36, -v21, v20
v_and_b32 v20, 31, v10
v_cvt_f32_u32 v20, v20
v_mul_f32 v20, 0x3d000000, v20
v_sin_f32 v21, v20
v_cos_f32 v20, v20
v_add_u32 v10, v8, v10
v_cvt_pk_bf16_f32 v33, v20, v21
v_cvt_pk_bf16_f32 v37, -v21, v20
v_and_b32 v20, 31, v10
v_cvt_f32_u32 v20, v20
v_mul_f32 v20, 0x3d000000, v20
v_sin_f32 v21, v20
v_cos_f32 v20, v20
v_add_u32 v10, v8, v10
v_cvt_pk_bf16_f32 v34, v20, v21
v_cvt_pk_bf16_f32 v38, -v21, v20
v_and_b32 v20, 31, v10
v_cvt_f32_u32 v20, v20
v_mul_f32 v20, 0x3d000000, v20
v_sin_f32 v21, v20
v_cos_f32 v20, v20
v_add_u32 v10, v8, v10
v_cvt_pk_bf16_f32 v35, v20, v21
v_cvt_pk_bf16_f32 v39, -v21, v20
v_accvgpr_write_b32 a168, v32
v_accvgpr_write_b32 a169, v33
v_accvgpr_write_b32 a170, v34
v_accvgpr_write_b32 a171, v35
v_accvgpr_write_b32 a172, v36
v_accvgpr_write_b32 a173, v37
v_accvgpr_write_b32 a174, v38
v_accvgpr_write_b32 a175, v39
v_lshl_add_u32 v10, v9, 2, 16
v_mul_u32_u24 v10, v10, v8
v_and_b32 v20, 31, v10
v_cvt_f32_u32 v20, v20
v_mul_f32 v20, 0x3d000000, v20
v_sin_f32 v21, v20
v_cos_f32 v20, v20
v_add_u32 v10, v8, v10
v_cvt_pk_bf16_f32 v32, v20, v21
v_cvt_pk_bf16_f32 v36, -v21, v20
v_and_b32 v20, 31, v10
v_cvt_f32_u32 v20, v20
v_mul_f32 v20, 0x3d000000, v20
v_sin_f32 v21, v20
v_cos_f32 v20, v20
v_add_u32 v10, v8, v10
v_cvt_pk_bf16_f32 v33, v20, v21
v_cvt_pk_bf16_f32 v37, -v21, v20
v_and_b32 v20, 31, v10
v_cvt_f32_u32 v20, v20
v_mul_f32 v20, 0x3d000000, v20
v_sin_f32 v21, v20
v_cos_f32 v20, v20
v_add_u32 v10, v8, v10
v_cvt_pk_bf16_f32 v34, v20, v21
v_cvt_pk_bf16_f32 v38, -v21, v20
v_and_b32 v20, 31, v10
v_cvt_f32_u32 v20, v20
v_mul_f32 v20, 0x3d000000, v20
v_sin_f32 v21, v20
v_cos_f32 v20, v20
v_add_u32 v10, v8, v10
v_cvt_pk_bf16_f32 v35, v20, v21
v_cvt_pk_bf16_f32 v39, -v21, v20
v_accvgpr_write_b32 a176, v32
v_accvgpr_write_b32 a177, v33
v_accvgpr_write_b32 a178, v34
v_accvgpr_write_b32 a179, v35
v_accvgpr_write_b32 a180, v36
v_accvgpr_write_b32 a181, v37
v_accvgpr_write_b32 a182, v38
v_accvgpr_write_b32 a183, v39
v_lshl_add_u32 v10, v9, 2, 24
v_mul_u32_u24 v10, v10, v8
v_and_b32 v20, 31, v10
v_cvt_f32_u32 v20, v20
v_mul_f32 v20, 0x3d000000, v20
v_sin_f32 v21, v20
v_cos_f32 v20, v20
v_add_u32 v10, v8, v10
v_cvt_pk_bf16_f32 v32, v20, v21
v_cvt_pk_bf16_f32 v36, -v21, v20
v_and_b32 v20, 31, v10
v_cvt_f32_u32 v20, v20
v_mul_f32 v20, 0x3d000000, v20
v_sin_f32 v21, v20
v_cos_f32 v20, v20
v_add_u32 v10, v8, v10
v_cvt_pk_bf16_f32 v33, v20, v21
v_cvt_pk_bf16_f32 v37, -v21, v20
v_and_b32 v20, 31, v10
v_cvt_f32_u32 v20, v20
v_mul_f32 v20, 0x3d000000, v20
v_sin_f32 v21, v20
v_cos_f32 v20, v20
v_add_u32 v10, v8, v10
v_cvt_pk_bf16_f32 v34, v20, v21
v_cvt_pk_bf16_f32 v38, -v21, v20
v_and_b32 v20, 31, v10
v_cvt_f32_u32 v20, v20
v_mul_f32 v20, 0x3d000000, v20
v_sin_f32 v21, v20
v_cos_f32 v20, v20
v_add_u32 v10, v8, v10
v_cvt_pk_bf16_f32 v35, v20, v21
v_cvt_pk_bf16_f32 v39, -v21, v20
v_accvgpr_write_b32 a184, v32
v_accvgpr_write_b32 a185, v33
v_accvgpr_write_b32 a186, v34
v_accvgpr_write_b32 a187, v35
v_accvgpr_write_b32 a188, v36
v_accvgpr_write_b32 a189, v37
v_accvgpr_write_b32 a190, v38
v_accvgpr_write_b32 a191, v39
s_waitcnt vmcnt(63)
v_lshlrev_b32 v192, 16, v192
v_mul_f32 v192, 0x3a000000, v192
s_waitcnt vmcnt(61)
v_lshlrev_b32 v193, 16, v193
v_mul_f32 v193, 0x3a000000, v193
s_waitcnt vmcnt(59)
v_lshlrev_b32 v194, 16, v194
v_mul_f32 v194, 0x3a000000, v194
s_waitcnt vmcnt(57)
v_lshlrev_b32 v195, 16, v195
v_mul_f32 v195, 0x3a000000, v195
s_waitcnt vmcnt(55)
v_lshlrev_b32 v196, 16, v196
v_mul_f32 v196, 0x3a000000, v196
s_waitcnt vmcnt(53)
v_lshlrev_b32 v197, 16, v197
v_mul_f32 v197, 0x3a000000, v197
s_waitcnt vmcnt(51)
v_lshlrev_b32 v198, 16, v198
v_mul_f32 v198, 0x3a000000, v198
s_waitcnt vmcnt(49)
v_lshlrev_b32 v199, 16, v199
v_mul_f32 v199, 0x3a000000, v199
s_waitcnt vmcnt(47)
v_lshlrev_b32 v200, 16, v200
v_mul_f32 v200, 0x3a000000, v200
s_waitcnt vmcnt(45)
v_lshlrev_b32 v201, 16, v201
v_mul_f32 v201, 0x3a000000, v201
s_waitcnt vmcnt(43)
v_lshlrev_b32 v202, 16, v202
v_mul_f32 v202, 0x3a000000, v202
s_waitcnt vmcnt(41)
v_lshlrev_b32 v203, 16, v203
v_mul_f32 v203, 0x3a000000, v203
s_waitcnt vmcnt(39)
v_lshlrev_b32 v204, 16, v204
v_mul_f32 v204, 0x3a000000, v204
s_waitcnt vmcnt(37)
v_lshlrev_b32 v205, 16, v205
v_mul_f32 v205, 0x3a000000, v205
s_waitcnt vmcnt(35)
v_lshlrev_b32 v206, 16, v206
v_mul_f32 v206, 0x3a000000, v206
s_waitcnt vmcnt(33)
v_lshlrev_b32 v207, 16, v207
v_mul_f32 v207, 0x3a000000, v207
v_lshlrev_b32 v208, 16, v208
v_mul_f32 v208, 0x3a000000, v208
v_lshlrev_b32 v209, 16, v209
v_mul_f32 v209, 0x3a000000, v209
v_lshlrev_b32 v210, 16, v210
v_mul_f32 v210, 0x3a000000, v210
v_lshlrev_b32 v211, 16, v211
v_mul_f32 v211, 0x3a000000, v211
v_lshlrev_b32 v212, 16, v212
v_mul_f32 v212, 0x3a000000, v212
v_lshlrev_b32 v213, 16, v213
v_mul_f32 v213, 0x3a000000, v213
v_lshlrev_b32 v214, 16, v214
v_mul_f32 v214, 0x3a000000, v214
v_lshlrev_b32 v215, 16, v215
v_mul_f32 v215, 0x3a000000, v215
v_lshlrev_b32 v216, 16, v216
v_mul_f32 v216, 0x3a000000, v216
v_lshlrev_b32 v217, 16, v217
v_mul_f32 v217, 0x3a000000, v217
v_lshlrev_b32 v218, 16, v218
v_mul_f32 v218, 0x3a000000, v218
v_lshlrev_b32 v219, 16, v219
v_mul_f32 v219, 0x3a000000, v219
v_lshlrev_b32 v220, 16, v220
v_mul_f32 v220, 0x3a000000, v220
v_lshlrev_b32 v221, 16, v221
v_mul_f32 v221, 0x3a000000, v221
v_lshlrev_b32 v222, 16, v222
v_mul_f32 v222, 0x3a000000, v222
s_waitcnt vmcnt(32)
v_lshlrev_b32 v223, 16, v223
v_mul_f32 v223, 0x3a000000, v223
s_waitcnt vmcnt(31)
v_lshlrev_b32 v224, 16, v224
v_mul_f32 v224, 0x3a000000, v224
s_waitcnt vmcnt(29)
v_lshlrev_b32 v225, 16, v225
v_mul_f32 v225, 0x3a000000, v225
s_waitcnt vmcnt(27)
v_lshlrev_b32 v226, 16, v226
v_mul_f32 v226, 0x3a000000, v226
s_waitcnt vmcnt(25)
v_lshlrev_b32 v227, 16, v227
v_mul_f32 v227, 0x3a000000, v227
s_waitcnt vmcnt(23)
v_lshlrev_b32 v228, 16, v228
v_mul_f32 v228, 0x3a000000, v228
s_waitcnt vmcnt(21)
v_lshlrev_b32 v229, 16, v229
v_mul_f32 v229, 0x3a000000, v229
s_waitcnt vmcnt(19)
v_lshlrev_b32 v230, 16, v230
v_mul_f32 v230, 0x3a000000, v230
s_waitcnt vmcnt(17)
v_lshlrev_b32 v231, 16, v231
v_mul_f32 v231, 0x3a000000, v231
s_waitcnt vmcnt(15)
v_lshlrev_b32 v232, 16, v232
v_mul_f32 v232, 0x3a000000, v232
s_waitcnt vmcnt(13)
v_lshlrev_b32 v233, 16, v233
v_mul_f32 v233, 0x3a000000, v233
s_waitcnt vmcnt(11)
v_lshlrev_b32 v234, 16, v234
v_mul_f32 v234, 0x3a000000, v234
s_waitcnt vmcnt(9)
v_lshlrev_b32 v235, 16, v235
v_mul_f32 v235, 0x3a000000, v235
s_waitcnt vmcnt(7)
v_lshlrev_b32 v236, 16, v236
v_mul_f32 v236, 0x3a000000, v236
s_waitcnt vmcnt(5)
v_lshlrev_b32 v237, 16, v237
v_mul_f32 v237, 0x3a000000, v237
s_waitcnt vmcnt(3)
v_lshlrev_b32 v238, 16, v238
v_mul_f32 v238, 0x3a000000, v238
s_waitcnt vmcnt(1)
v_lshlrev_b32 v239, 16, v239
v_mul_f32 v239, 0x3a000000, v239
v_lshlrev_b32 v240, 16, v240
v_mul_f32 v240, 0x3a000000, v240
v_lshlrev_b32 v241, 16, v241
v_mul_f32 v241, 0x3a000000, v241
v_lshlrev_b32 v242, 16, v242
v_mul_f32 v242, 0x3a000000, v242
v_lshlrev_b32 v243, 16, v243
v_mul_f32 v243, 0x3a000000, v243
v_lshlrev_b32 v244, 16, v244
v_mul_f32 v244, 0x3a000000, v244
v_lshlrev_b32 v245, 16, v245
v_mul_f32 v245, 0x3a000000, v245
v_lshlrev_b32 v246, 16, v246
v_mul_f32 v246, 0x3a000000, v246
v_lshlrev_b32 v247, 16, v247
v_mul_f32 v247, 0x3a000000, v247
v_lshlrev_b32 v248, 16, v248
v_mul_f32 v248, 0x3a000000, v248
v_lshlrev_b32 v249, 16, v249
v_mul_f32 v249, 0x3a000000, v249
v_lshlrev_b32 v250, 16, v250
v_mul_f32 v250, 0x3a000000, v250
v_lshlrev_b32 v251, 16, v251
v_mul_f32 v251, 0x3a000000, v251
v_lshlrev_b32 v252, 16, v252
v_mul_f32 v252, 0x3a000000, v252
v_lshlrev_b32 v253, 16, v253
v_mul_f32 v253, 0x3a000000, v253
v_lshlrev_b32 v254, 16, v254
v_mul_f32 v254, 0x3a000000, v254
s_waitcnt vmcnt(0)
v_lshlrev_b32 v255, 16, v255
v_mul_f32 v255, 0x3a000000, v255
k_fnog_46:
s_lshl_b32 s52, s3, 13
v_add_u32 v12, s52, v0
s_lshl_b32 s52, s3, 4
v_lshl_add_u32 v10, v9, 2, s52
v_add_u32 v10, 0, v10
v_add_u32 v11, 0, v8
v_mul_u32_u24 v10, v10, v11
v_and_b32 v20, 63, v10
v_cvt_f32_u32 v20, v20
v_mul_f32 v20, 0x3c800000, v20
v_sin_f32 v21, v20
v_cos_f32 v20, v20
v_add_u32 v10, v11, v10
v_cvt_pk_bf16_f32 v32, v20, v21
v_cvt_pk_bf16_f32 v36, -v21, v20
v_and_b32 v20, 63, v10
v_cvt_f32_u32 v20, v20
v_mul_f32 v20, 0x3c800000, v20
v_sin_f32 v21, v20
v_cos_f32 v20, v20
v_add_u32 v10, v11, v10
v_cvt_pk_bf16_f32 v33, v20, v21
v_cvt_pk_bf16_f32 v37, -v21, v20
v_and_b32 v20, 63, v10
v_cvt_f32_u32 v20, v20
v_mul_f32 v20, 0x3c800000, v20
v_sin_f32 v21, v20
v_cos_f32 v20, v20
v_add_u32 v10, v11, v10
v_cvt_pk_bf16_f32 v34, v20, v21
v_cvt_pk_bf16_f32 v38, -v21, v20
v_and_b32 v20, 63, v10
v_cvt_f32_u32 v20, v20
v_mul_f32 v20, 0x3c800000, v20
v_sin_f32 v21, v20
v_cos_f32 v20, v20
v_add_u32 v10, v11, v10
v_cvt_pk_bf16_f32 v35, v20, v21
v_cvt_pk_bf16_f32 v39, -v21, v20
ds_write_b128 v12, v[32:35] offset:0
ds_write_b128 v12, v[36:39] offset:1024
v_lshl_add_u32 v10, v9, 2, s52
v_add_u32 v10, 0, v10
v_add_u32 v11, 32, v8
v_mul_u32_u24 v10, v10, v11
v_and_b32 v20, 63, v10
v_cvt_f32_u32 v20, v20
v_mul_f32 v20, 0x3c800000, v20
v_sin_f32 v21, v20
v_cos_f32 v20, v20
v_add_u32 v10, v11, v10
v_cvt_pk_bf16_f32 v40, v20, v21
v_cvt_pk_bf16_f32 v44, -v21, v20
v_and_b32 v20, 63, v10
v_cvt_f32_u32 v20, v20
v_mul_f32 v20, 0x3c800000, v20
v_sin_f32 v21, v20
v_cos_f32 v20, v20
v_add_u32 v10, v11, v10
v_cvt_pk_bf16_f32 v41, v20, v21
v_cvt_pk_bf16_f32 v45, -v21, v20
v_and_b32 v20, 63, v10
v_cvt_f32_u32 v20, v20
v_mul_f32 v20, 0x3c800000, v20
v_sin_f32 v21, v20
v_cos_f32 v20, v20
v_add_u32 v10, v11, v10
v_cvt_pk_bf16_f32 v42, v20, v21
v_cvt_pk_bf16_f32 v46, -v21, v20
v_and_b32 v20, 63, v10
v_cvt_f32_u32 v20, v20
v_mul_f32 v20, 0x3c800000, v20
v_sin_f32 v21, v20
v_cos_f32 v20, v20
v_add_u32 v10, v11, v10
v_cvt_pk_bf16_f32 v43, v20, v21
v_cvt_pk_bf16_f32 v47, -v21, v20
ds_write_b128 v12, v[40:43] offset:2048
ds_write_b128 v12, v[44:47] offset:3072
v_lshl_add_u32 v10, v9, 2, s52
v_add_u32 v10, 8, v10
v_add_u32 v11, 0, v8
v_mul_u32_u24 v10, v10, v11
v_and_b32 v20, 63, v10
v_cvt_f32_u32 v20, v20
v_mul_f32 v20, 0x3c800000, v20
v_sin_f32 v21, v20
v_cos_f32 v20, v20
v_add_u32 v10, v11, v10
v_cvt_pk_bf16_f32 v48, v20, v21
v_cvt_pk_bf16_f32 v52, -v21, v20
v_and_b32 v20, 63, v10
v_cvt_f32_u32 v20, v20
v_mul_f32 v20, 0x3c800000, v20
v_sin_f32 v21, v20
v_cos_f32 v20, v20
v_add_u32 v10, v11, v10
v_cvt_pk_bf16_f32 v49, v20, v21
v_cvt_pk_bf16_f32 v53, -v21, v20
v_and_b32 v20, 63, v10
v_cvt_f32_u32 v20, v20
v_mul_f32 v20, 0x3c800000, v20
v_sin_f32 v21, v20
v_cos_f32 v20, v20
v_add_u32 v10, v11, v10
v_cvt_pk_bf16_f32 v50, v20, v21
v_cvt_pk_bf16_f32 v54, -v21, v20
v_and_b32 v20, 63, v10
v_cvt_f32_u32 v20, v20
v_mul_f32 v20, 0x3c800000, v20
v_sin_f32 v21, v20
v_cos_f32 v20, v20
v_add_u32 v10, v11, v10
v_cvt_pk_bf16_f32 v51, v20, v21
v_cvt_pk_bf16_f32 v55, -v21, v20
ds_write_b128 v12, v[48:51] offset:4096
ds_write_b128 v12, v[52:55] offset:5120
v_lshl_add_u32 v10, v9, 2, s52
v_add_u32 v10, 8, v10
v_add_u32 v11, 32, v8
v_mul_u32_u24 v10, v10, v11
v_and_b32 v20, 63, v10
v_cvt_f32_u32 v20, v20
v_mul_f32 v20, 0x3c800000, v20
v_sin_f32 v21, v20
v_cos_f32 v20, v20
v_add_u32 v10, v11, v10
v_cvt_pk_bf16_f32 v56, v20, v21
v_cvt_pk_bf16_f32 v60, -v21, v20
v_and_b32 v20, 63, v10
v_cvt_f32_u32 v20, v20
v_mul_f32 v20, 0x3c800000, v20
v_sin_f32 v21, v20
v_cos_f32 v20, v20
v_add_u32 v10, v11, v10
v_cvt_pk_bf16_f32 v57, v20, v21
v_cvt_pk_bf16_f32 v61, -v21, v20
v_and_b32 v20, 63, v10
v_cvt_f32_u32 v20, v20
v_mul_f32 v20, 0x3c800000, v20
v_sin_f32 v21, v20
v_cos_f32 v20, v20
v_add_u32 v10, v11, v10
v_cvt_pk_bf16_f32 v58, v20, v21
v_cvt_pk_bf16_f32 v62, -v21, v20
v_and_b32 v20, 63, v10
v_cvt_f32_u32 v20, v20
v_mul_f32 v20, 0x3c800000, v20
v_sin_f32 v21, v20
v_cos_f32 v20, v20
v_add_u32 v10, v11, v10
v_cvt_pk_bf16_f32 v59, v20, v21
v_cvt_pk_bf16_f32 v63, -v21, v20
ds_write_b128 v12, v[56:59] offset:6144
ds_write_b128 v12, v[60:63] offset:7168
s_lshl_b32 s52, s3, 11
v_add_u32 v12, s52, v0
s_lshl_b32 s52, s3, 3
v_lshl_add_u32 v10, v9, 2, s52
v_add_u32 v10, 0, v10
v_add_u32 v11, 0, v8
v_mul_u32_u24 v10, v10, v11
v_cvt_f32_u32 v20, v10
v_mul_f32 v20, 0x3a000000, v20
v_add_u32 v10, v11, v10
v_cos_f32 v64, v20
v_sin_f32 v68, v20
v_cvt_f32_u32 v20, v10
v_mul_f32 v20, 0x3a000000, v20
v_add_u32 v10, v11, v10
v_cos_f32 v65, v20
v_sin_f32 v69, v20
v_cvt_f32_u32 v20, v10
v_mul_f32 v20, 0x3a000000, v20
v_add_u32 v10, v11, v10
v_cos_f32 v66, v20
v_sin_f32 v70, v20
v_cvt_f32_u32 v20, v10
v_mul_f32 v20, 0x3a000000, v20
v_add_u32 v10, v11, v10
v_cos_f32 v67, v20
v_sin_f32 v71, v20
ds_write_b128 v12, v[64:67] offset:32768
ds_write_b128 v12, v[68:71] offset:33792
v_lshl_add_u32 v10, v9, 2, s52
v_add_u32 v10, 0, v10
v_add_u32 v11, 32, v8
v_mul_u32_u24 v10, v10, v11
v_cvt_f32_u32 v20, v10
v_mul_f32 v20, 0x3a000000, v20
v_add_u32 v10, v11, v10
v_cos_f32 v72, v20
v_sin_f32 v76, v20
v_cvt_f32_u32 v20, v10
v_mul_f32 v20, 0x3a000000, v20
v_add_u32 v10, v11, v10
v_cos_f32 v73, v20
v_sin_f32 v77, v20
v_cvt_f32_u32 v20, v10
v_mul_f32 v20, 0x3a000000, v20
v_add_u32 v10, v11, v10
v_cos_f32 v74, v20
v_sin_f32 v78, v20
v_cvt_f32_u32 v20, v10
v_mul_f32 v20, 0x3a000000, v20
v_add_u32 v10, v11, v10
v_cos_f32 v75, v20
v_sin_f32 v79, v20
ds_write_b128 v12, v[72:75] offset:40960
ds_write_b128 v12, v[76:79] offset:41984
v_lshl_add_u32 v10, v9, 2, s52
v_add_u32 v10, 32, v10
v_add_u32 v11, 0, v8
v_mul_u32_u24 v10, v10, v11
v_cvt_f32_u32 v20, v10
v_mul_f32 v20, 0x3a000000, v20
v_add_u32 v10, v11, v10
v_cos_f32 v80, v20
v_sin_f32 v84, v20
v_cvt_f32_u32 v20, v10
v_mul_f32 v20, 0x3a000000, v20
v_add_u32 v10, v11, v10
v_cos_f32 v81, v20
v_sin_f32 v85, v20
v_cvt_f32_u32 v20, v10
v_mul_f32 v20, 0x3a000000, v20
v_add_u32 v10, v11, v10
v_cos_f32 v82, v20
v_sin_f32 v86, v20
v_cvt_f32_u32 v20, v10
v_mul_f32 v20, 0x3a000000, v20
v_add_u32 v10, v11, v10
v_cos_f32 v83, v20
v_sin_f32 v87, v20
ds_write_b128 v12, v[80:83] offset:49152
ds_write_b128 v12, v[84:87] offset:50176
s_lshl_b32 s52, s3, 2
v_lshl_add_u32 v30, v8, 4, s52
v_lshl_add_u32 v30, v9, 11, v30
v_mul_u32_u24 v31, 2560, v9
v_lshl_add_u32 v31, v8, 2, v31
s_lshr_b32 s52, s3, 1
s_lshl_b32 s52, s52, 9
s_and_b32 s53, s3, 1
s_lshl_b32 s53, s53, 3
s_add_u32 s52, s52, s53
v_lshl_add_u32 v24, v8, 4, s52
v_lshl_add_u32 v24, v9, 2, v24
s_mov_b32 s52, 163840
v_mul_lo_u32 v25, v9, s52
v_lshl_add_u32 v25, v8, 4, v25
s_mul_i32 s44, s51, 3145728
s_lshl_b32 s52, s30, 15
s_add_u32 s44, s44, s52
s_add_u32 s44, s44, 205520896
s_mul_i32 s45, s51, 1048576
s_mul_i32 s52, s3, 5120
s_add_u32 s45, s45, s52
s_add_u32 s45, s45, 211812352
s_mul_i32 s48, s51, 3145728
s_lshl_b32 s52, s30, 9
s_add_u32 s48, s48, s52
s_mul_i32 s52, s3, 327680
s_add_u32 s48, s48, s52
s_add_u32 s48, s48, 198180864
s_mov_b32 s49, 0x3acccccd
v_mov_b32 v27, 0x3727c5ac
s_waitcnt vmcnt(0) lgkmcnt(0)
s_barrier
s_mov_b32 s59, 0
ds_read_b128 v[112:115], v0 offset:0
ds_read_b128 v[116:119], v0 offset:1024
ds_read_b128 v[120:123], v0 offset:2048
ds_read_b128 v[124:127], v0 offset:3072
k_pr_49:
buffer_load_dword v18, v30, s[4:7], s44 offen offset:1024 sc1
s_waitcnt vmcnt(0)
v_cmp_eq_u32 vcc, -1, v18
s_cbranch_vccz k_prd_50
s_sleep 8
s_sub_u32 s32, s32, 1
s_cmp_gt_i32 s32, 0
s_cbranch_scc1 k_pr_49
k_prd_50:
k_ps_51:
buffer_load_dword v96, v31, s[4:7], s45 offen offset:0 sc1
buffer_load_dword v97, v31, s[4:7], s45 offen offset:128 sc1
buffer_load_dword v98, v31, s[4:7], s45 offen offset:256 sc1
buffer_load_dword v99, v31, s[4:7], s45 offen offset:384 sc1
buffer_load_dword v100, v31, s[4:7], s45 offen offset:512 sc1
buffer_load_dword v101, v31, s[4:7], s45 offen offset:640 sc1
buffer_load_dword v102, v31, s[4:7], s45 offen offset:768 sc1
buffer_load_dword v103, v31, s[4:7], s45 offen offset:896 sc1
buffer_load_dword v104, v31, s[4:7], s45 offen offset:1024 sc1
buffer_load_dword v105, v31, s[4:7], s45 offen offset:1152 sc1
buffer_load_dword v106, v31, s[4:7], s45 offen offset:1280 sc1
buffer_load_dword v107, v31, s[4:7], s45 offen offset:1408 sc1
buffer_load_dword v108, v31, s[4:7], s45 offen offset:1536 sc1
buffer_load_dword v109, v31, s[4:7], s45 offen offset:1664 sc1
buffer_load_dword v110, v31, s[4:7], s45 offen offset:1792 sc1
buffer_load_dword v111, v31, s[4:7], s45 offen offset:1920 sc1
buffer_load_dword v20, v31, s[4:7], s45 offen offset:2048 sc1
buffer_load_dword v21, v31, s[4:7], s45 offen offset:2176 sc1
buffer_load_dword v22, v31, s[4:7], s45 offen offset:2304 sc1
buffer_load_dword v23, v31, s[4:7], s45 offen offset:2432 sc1
buffer_load_dword v16, v30, s[4:7], s44 offen offset:0 sc1
buffer_load_dword v17, v30, s[4:7], s44 offen offset:512 sc1
buffer_load_dword v19, v30, s[4:7], s44 offen offset:1536 sc1
s_waitcnt vmcnt(21)
v_add_f32 v96, v96, v97
s_waitcnt vmcnt(20)
v_add_f32 v96, v96, v98
s_waitcnt vmcnt(19)
v_add_f32 v96, v96, v99
s_waitcnt vmcnt(18)
v_add_f32 v96, v96, v100
s_waitcnt vmcnt(17)
v_add_f32 v96, v96, v101
s_waitcnt vmcnt(16)
v_add_f32 v96, v96, v102
s_waitcnt vmcnt(15)
v_add_f32 v96, v96, v103
s_waitcnt vmcnt(14)
v_add_f32 v96, v96, v104
s_waitcnt vmcnt(13)
v_add_f32 v96, v96, v105
s_waitcnt vmcnt(12)
v_add_f32 v96, v96, v106
s_waitcnt vmcnt(11)
v_add_f32 v96, v96, v107
s_waitcnt vmcnt(10)
v_add_f32 v96, v96, v108
s_waitcnt vmcnt(9)
v_add_f32 v96, v96, v109
s_waitcnt vmcnt(8)
v_add_f32 v96, v96, v110
s_waitcnt vmcnt(7)
v_add_f32 v96, v96, v111
s_waitcnt vmcnt(6)
v_add_f32 v96, v96, v20
s_waitcnt vmcnt(5)
v_add_f32 v96, v96, v21
s_waitcnt vmcnt(4)
v_add_f32 v96, v96, v22
s_waitcnt vmcnt(3)
v_add_f32 v96, v96, v23
v_cmp_u_f32 vcc, v96, v96
v_fma_f32 v96, v96, s49, v27
s_cbranch_vccz k_psd_52
s_sub_u32 s32, s32, 1
s_cmp_gt_i32 s32, 0
s_cbranch_scc1 k_ps_51
k_psd_52:
v_rsq_f32 v96, v96
s_add_u32 s45, s45, 20480
ds_write_b32 v24, v96 offset:57344
s_branch k_pyd_54
k_py_53:
buffer_load_dword v16, v30, s[4:7], s44 offen offset:0 sc1
buffer_load_dword v17, v30, s[4:7], s44 offen offset:512 sc1
buffer_load_dword v19, v30, s[4:7], s44 offen offset:1536 sc1
s_sub_u32 s32, s32, 1
k_pyd_54:
s_waitcnt vmcnt(0)
v_max3_u32 v20, v16, v17, v19
v_cmp_eq_u32 vcc, -1, v20
s_cmp_gt_i32 s32, 0
s_cselect_b64 vcc, vcc, 0
s_cbranch_vccnz k_py_53
s_add_u32 s44, s44, 4096
s_waitcnt lgkmcnt(0)
s_barrier
ds_read_b128 v[12:15], v0 offset:57344
v_lshlrev_b32 v144, 16, v16
v_and_b32 v128, 0xffff0000, v16
v_lshlrev_b32 v145, 16, v17
v_and_b32 v129, 0xffff0000, v17
v_lshlrev_b32 v146, 16, v18
v_and_b32 v130, 0xffff0000, v18
v_lshlrev_b32 v147, 16, v19
v_and_b32 v131, 0xffff0000, v19
s_waitcnt lgkmcnt(0)
v_mul_f32 v8, v12, v144
v_mul_f32 v12, v12, v128
v_cvt_pk_bf16_f32 v8, v8, v12
v_and_b32 v8, s47, v8
v_mul_f32 v9, v13, v145
v_mul_f32 v13, v13, v129
v_cvt_pk_bf16_f32 v9, v9, v13
v_and_b32 v9, s47, v9
v_mul_f32 v10, v14, v146
v_mul_f32 v14, v14, v130
v_cvt_pk_bf16_f32 v10, v10, v14
v_and_b32 v10, s47, v10
v_mul_f32 v11, v15, v147
v_mul_f32 v15, v15, v131
v_cvt_pk_bf16_f32 v11, v11, v15
v_and_b32 v11, s47, v11
s_nop 1
v_mfma_f32_32x32x16_bf16 v[32:47], v[8:11], v[112:115], 0
v_mfma_f32_32x32x16_bf16 v[48:63], v[8:11], v[116:119], 0
v_mfma_f32_32x32x16_bf16 v[64:79], v[8:11], v[120:123], 0
v_mfma_f32_32x32x16_bf16 v[80:95], v[8:11], v[124:127], 0
ds_read_b128 v[112:115], v0 offset:4096
ds_read_b128 v[116:119], v0 offset:5120
ds_read_b128 v[120:123], v0 offset:6144
ds_read_b128 v[124:127], v0 offset:7168
k_pr_55:
buffer_load_dword v18, v30, s[4:7], s44 offen offset:1024 sc1
s_waitcnt vmcnt(0)
v_cmp_eq_u32 vcc, -1, v18
s_cbranch_vccz k_prd_56
s_sleep 8
s_sub_u32 s32, s32, 1
s_cmp_gt_i32 s32, 0
s_cbranch_scc1 k_pr_55
k_prd_56:
k_ps_57:
buffer_load_dword v96, v31, s[4:7], s45 offen offset:0 sc1
buffer_load_dword v97, v31, s[4:7], s45 offen offset:128 sc1
buffer_load_dword v98, v31, s[4:7], s45 offen offset:256 sc1
buffer_load_dword v99, v31, s[4:7], s45 offen offset:384 sc1
buffer_load_dword v100, v31, s[4:7], s45 offen offset:512 sc1
buffer_load_dword v101, v31, s[4:7], s45 offen offset:640 sc1
buffer_load_dword v102, v31, s[4:7], s45 offen offset:768 sc1
buffer_load_dword v103, v31, s[4:7], s45 offen offset:896 sc1
buffer_load_dword v104, v31, s[4:7], s45 offen offset:1024 sc1
buffer_load_dword v105, v31, s[4:7], s45 offen offset:1152 sc1
buffer_load_dword v106, v31, s[4:7], s45 offen offset:1280 sc1
buffer_load_dword v107, v31, s[4:7], s45 offen offset:1408 sc1
buffer_load_dword v108, v31, s[4:7], s45 offen offset:1536 sc1
buffer_load_dword v109, v31, s[4:7], s45 offen offset:1664 sc1
buffer_load_dword v110, v31, s[4:7], s45 offen offset:1792 sc1
buffer_load_dword v111, v31, s[4:7], s45 offen offset:1920 sc1
buffer_load_dword v20, v31, s[4:7], s45 offen offset:2048 sc1
buffer_load_dword v21, v31, s[4:7], s45 offen offset:2176 sc1
buffer_load_dword v22, v31, s[4:7], s45 offen offset:2304 sc1
buffer_load_dword v23, v31, s[4:7], s45 offen offset:2432 sc1
buffer_load_dword v16, v30, s[4:7], s44 offen offset:0 sc1
buffer_load_dword v17, v30, s[4:7], s44 offen offset:512 sc1
buffer_load_dword v19, v30, s[4:7], s44 offen offset:1536 sc1
s_waitcnt vmcnt(21)
v_add_f32 v96, v96, v97
s_waitcnt vmcnt(20)
v_add_f32 v96, v96, v98
s_waitcnt vmcnt(19)
v_add_f32 v96, v96, v99
s_waitcnt vmcnt(18)
v_add_f32 v96, v96, v100
s_waitcnt vmcnt(17)
v_add_f32 v96, v96, v101
s_waitcnt vmcnt(16)
v_add_f32 v96, v96, v102
s_waitcnt vmcnt(15)
v_add_f32 v96, v96, v103
s_waitcnt vmcnt(14)
v_add_f32 v96, v96, v104
s_waitcnt vmcnt(13)
v_add_f32 v96, v96, v105
s_waitcnt vmcnt(12)
v_add_f32 v96, v96, v106
s_waitcnt vmcnt(11)
v_add_f32 v96, v96, v107
s_waitcnt vmcnt(10)
v_add_f32 v96, v96, v108
s_waitcnt vmcnt(9)
v_add_f32 v96, v96, v109
s_waitcnt vmcnt(8)
v_add_f32 v96, v96, v110
s_waitcnt vmcnt(7)
v_add_f32 v96, v96, v111
s_waitcnt vmcnt(6)
v_add_f32 v96, v96, v20
s_waitcnt vmcnt(5)
v_add_f32 v96, v96, v21
s_waitcnt vmcnt(4)
v_add_f32 v96, v96, v22
s_waitcnt vmcnt(3)
v_add_f32 v96, v96, v23
v_cmp_u_f32 vcc, v96, v96
v_fma_f32 v96, v96, s49, v27
s_cbranch_vccz k_psd_58
s_sub_u32 s32, s32, 1
s_cmp_gt_i32 s32, 0
s_cbranch_scc1 k_ps_57
k_psd_58:
v_rsq_f32 v96, v96
s_add_u32 s45, s45, 20480
ds_write_b32 v24, v96 offset:58368
s_branch k_pyd_60
k_py_59:
buffer_load_dword v16, v30, s[4:7], s44 offen offset:0 sc1
buffer_load_dword v17, v30, s[4:7], s44 offen offset:512 sc1
buffer_load_dword v19, v30, s[4:7], s44 offen offset:1536 sc1
s_sub_u32 s32, s32, 1
k_pyd_60:
s_waitcnt vmcnt(0)
v_max3_u32 v20, v16, v17, v19
v_cmp_eq_u32 vcc, -1, v20
s_cmp_gt_i32 s32, 0
s_cselect_b64 vcc, vcc, 0
s_cbranch_vccnz k_py_59
s_add_u32 s44, s44, 4096
s_waitcnt lgkmcnt(0)
s_barrier
ds_read_b128 v[12:15], v0 offset:58368
v_lshlrev_b32 v148, 16, v16
v_and_b32 v132, 0xffff0000, v16
v_lshlrev_b32 v149, 16, v17
v_and_b32 v133, 0xffff0000, v17
v_lshlrev_b32 v150, 16, v18
v_and_b32 v134, 0xffff0000, v18
v_lshlrev_b32 v151, 16, v19
v_and_b32 v135, 0xffff0000, v19
s_waitcnt lgkmcnt(0)
v_mul_f32 v8, v12, v148
v_mul_f32 v12, v12, v132
v_cvt_pk_bf16_f32 v8, v8, v12
v_and_b32 v8, s47, v8
v_mul_f32 v9, v13, v149
v_mul_f32 v13, v13, v133
v_cvt_pk_bf16_f32 v9, v9, v13
v_and_b32 v9, s47, v9
v_mul_f32 v10, v14, v150
v_mul_f32 v14, v14, v134
v_cvt_pk_bf16_f32 v10, v10, v14
v_and_b32 v10, s47, v10
v_mul_f32 v11, v15, v151
v_mul_f32 v15, v15, v135
v_cvt_pk_bf16_f32 v11, v11, v15
v_and_b32 v11, s47, v11
s_nop 1
v_mfma_f32_32x32x16_bf16 v[32:47], v[8:11], v[112:115], v[32:47]
v_mfma_f32_32x32x16_bf16 v[48:63], v[8:11], v[116:119], v[48:63]
v_mfma_f32_32x32x16_bf16 v[64:79], v[8:11], v[120:123], v[64:79]
v_mfma_f32_32x32x16_bf16 v[80:95], v[8:11], v[124:127], v[80:95]
ds_read_b128 v[112:115], v0 offset:8192
ds_read_b128 v[116:119], v0 offset:9216
ds_read_b128 v[120:123], v0 offset:10240
ds_read_b128 v[124:127], v0 offset:11264
k_pr_61:
buffer_load_dword v18, v30, s[4:7], s44 offen offset:1024 sc1
s_waitcnt vmcnt(0)
v_cmp_eq_u32 vcc, -1, v18
s_cbranch_vccz k_prd_62
s_sleep 8
s_sub_u32 s32, s32, 1
s_cmp_gt_i32 s32, 0
s_cbranch_scc1 k_pr_61
k_prd_62:
k_ps_63:
buffer_load_dword v96, v31, s[4:7], s45 offen offset:0 sc1
buffer_load_dword v97, v31, s[4:7], s45 offen offset:128 sc1
buffer_load_dword v98, v31, s[4:7], s45 offen offset:256 sc1
buffer_load_dword v99, v31, s[4:7], s45 offen offset:384 sc1
buffer_load_dword v100, v31, s[4:7], s45 offen offset:512 sc1
buffer_load_dword v101, v31, s[4:7], s45 offen offset:640 sc1
buffer_load_dword v102, v31, s[4:7], s45 offen offset:768 sc1
buffer_load_dword v103, v31, s[4:7], s45 offen offset:896 sc1
buffer_load_dword v104, v31, s[4:7], s45 offen offset:1024 sc1
buffer_load_dword v105, v31, s[4:7], s45 offen offset:1152 sc1
buffer_load_dword v106, v31, s[4:7], s45 offen offset:1280 sc1
buffer_load_dword v107, v31, s[4:7], s45 offen offset:1408 sc1
buffer_load_dword v108, v31, s[4:7], s45 offen offset:1536 sc1
buffer_load_dword v109, v31, s[4:7], s45 offen offset:1664 sc1
buffer_load_dword v110, v31, s[4:7], s45 offen offset:1792 sc1
buffer_load_dword v111, v31, s[4:7], s45 offen offset:1920 sc1
buffer_load_dword v20, v31, s[4:7], s45 offen offset:2048 sc1
buffer_load_dword v21, v31, s[4:7], s45 offen offset:2176 sc1
buffer_load_dword v22, v31, s[4:7], s45 offen offset:2304 sc1
buffer_load_dword v23, v31, s[4:7], s45 offen offset:2432 sc1
buffer_load_dword v16, v30, s[4:7], s44 offen offset:0 sc1
buffer_load_dword v17, v30, s[4:7], s44 offen offset:512 sc1
buffer_load_dword v19, v30, s[4:7], s44 offen offset:1536 sc1
s_waitcnt vmcnt(21)
v_add_f32 v96, v96, v97
s_waitcnt vmcnt(20)
v_add_f32 v96, v96, v98
s_waitcnt vmcnt(19)
v_add_f32 v96, v96, v99
s_waitcnt vmcnt(18)
v_add_f32 v96, v96, v100
s_waitcnt vmcnt(17)
v_add_f32 v96, v96, v101
s_waitcnt vmcnt(16)
v_add_f32 v96, v96, v102
s_waitcnt vmcnt(15)
v_add_f32 v96, v96, v103
s_waitcnt vmcnt(14)
v_add_f32 v96, v96, v104
s_waitcnt vmcnt(13)
v_add_f32 v96, v96, v105
s_waitcnt vmcnt(12)
v_add_f32 v96, v96, v106
s_waitcnt vmcnt(11)
v_add_f32 v96, v96, v107
s_waitcnt vmcnt(10)
v_add_f32 v96, v96, v108
s_waitcnt vmcnt(9)
v_add_f32 v96, v96, v109
s_waitcnt vmcnt(8)
v_add_f32 v96, v96, v110
s_waitcnt vmcnt(7)
v_add_f32 v96, v96, v111
s_waitcnt vmcnt(6)
v_add_f32 v96, v96, v20
s_waitcnt vmcnt(5)
v_add_f32 v96, v96, v21
s_waitcnt vmcnt(4)
v_add_f32 v96, v96, v22
s_waitcnt vmcnt(3)
v_add_f32 v96, v96, v23
v_cmp_u_f32 vcc, v96, v96
v_fma_f32 v96, v96, s49, v27
s_cbranch_vccz k_psd_64
s_sub_u32 s32, s32, 1
s_cmp_gt_i32 s32, 0
s_cbranch_scc1 k_ps_63
k_psd_64:
v_rsq_f32 v96, v96
s_add_u32 s45, s45, 20480
ds_write_b32 v24, v96 offset:57344
s_branch k_pyd_66
k_py_65:
buffer_load_dword v16, v30, s[4:7], s44 offen offset:0 sc1
buffer_load_dword v17, v30, s[4:7], s44 offen offset:512 sc1
buffer_load_dword v19, v30, s[4:7], s44 offen offset:1536 sc1
s_sub_u32 s32, s32, 1
k_pyd_66:
s_waitcnt vmcnt(0)
v_max3_u32 v20, v16, v17, v19
v_cmp_eq_u32 vcc, -1, v20
s_cmp_gt_i32 s32, 0
s_cselect_b64 vcc, vcc, 0
s_cbranch_vccnz k_py_65
s_add_u32 s44, s44, 4096
s_waitcnt lgkmcnt(0)
s_barrier
ds_read_b128 v[12:15], v0 offset:57344
v_lshlrev_b32 v152, 16, v16
v_and_b32 v136, 0xffff0000, v16
v_lshlrev_b32 v153, 16, v17
v_and_b32 v137, 0xffff0000, v17
v_lshlrev_b32 v154, 16, v18
v_and_b32 v138, 0xffff0000, v18
v_lshlrev_b32 v155, 16, v19
v_and_b32 v139, 0xffff0000, v19
s_waitcnt lgkmcnt(0)
v_mul_f32 v8, v12, v152
v_mul_f32 v12, v12, v136
v_cvt_pk_bf16_f32 v8, v8, v12
v_and_b32 v8, s47, v8
v_mul_f32 v9, v13, v153
v_mul_f32 v13, v13, v137
v_cvt_pk_bf16_f32 v9, v9, v13
v_and_b32 v9, s47, v9
v_mul_f32 v10, v14, v154
v_mul_f32 v14, v14, v138
v_cvt_pk_bf16_f32 v10, v10, v14
v_and_b32 v10, s47, v10
v_mul_f32 v11, v15, v155
v_mul_f32 v15, v15, v139
v_cvt_pk_bf16_f32 v11, v11, v15
v_and_b32 v11, s47, v11
s_nop 1
v_mfma_f32_32x32x16_bf16 v[32:47], v[8:11], v[112:115], v[32:47]
v_mfma_f32_32x32x16_bf16 v[48:63], v[8:11], v[116:119], v[48:63]
v_mfma_f32_32x32x16_bf16 v[64:79], v[8:11], v[120:123], v[64:79]
v_mfma_f32_32x32x16_bf16 v[80:95], v[8:11], v[124:127], v[80:95]
ds_read_b128 v[112:115], v0 offset:12288
ds_read_b128 v[116:119], v0 offset:13312
ds_read_b128 v[120:123], v0 offset:14336
ds_read_b128 v[124:127], v0 offset:15360
k_pr_67:
buffer_load_dword v18, v30, s[4:7], s44 offen offset:1024 sc1
s_waitcnt vmcnt(0)
v_cmp_eq_u32 vcc, -1, v18
s_cbranch_vccz k_prd_68
s_sleep 8
s_sub_u32 s32, s32, 1
s_cmp_gt_i32 s32, 0
s_cbranch_scc1 k_pr_67
k_prd_68:
k_ps_69:
buffer_load_dword v96, v31, s[4:7], s45 offen offset:0 sc1
buffer_load_dword v97, v31, s[4:7], s45 offen offset:128 sc1
buffer_load_dword v98, v31, s[4:7], s45 offen offset:256 sc1
buffer_load_dword v99, v31, s[4:7], s45 offen offset:384 sc1
buffer_load_dword v100, v31, s[4:7], s45 offen offset:512 sc1
buffer_load_dword v101, v31, s[4:7], s45 offen offset:640 sc1
buffer_load_dword v102, v31, s[4:7], s45 offen offset:768 sc1
buffer_load_dword v103, v31, s[4:7], s45 offen offset:896 sc1
buffer_load_dword v104, v31, s[4:7], s45 offen offset:1024 sc1
buffer_load_dword v105, v31, s[4:7], s45 offen offset:1152 sc1
buffer_load_dword v106, v31, s[4:7], s45 offen offset:1280 sc1
buffer_load_dword v107, v31, s[4:7], s45 offen offset:1408 sc1
buffer_load_dword v108, v31, s[4:7], s45 offen offset:1536 sc1
buffer_load_dword v109, v31, s[4:7], s45 offen offset:1664 sc1
buffer_load_dword v110, v31, s[4:7], s45 offen offset:1792 sc1
buffer_load_dword v111, v31, s[4:7], s45 offen offset:1920 sc1
buffer_load_dword v20, v31, s[4:7], s45 offen offset:2048 sc1
buffer_load_dword v21, v31, s[4:7], s45 offen offset:2176 sc1
buffer_load_dword v22, v31, s[4:7], s45 offen offset:2304 sc1
buffer_load_dword v23, v31, s[4:7], s45 offen offset:2432 sc1
buffer_load_dword v16, v30, s[4:7], s44 offen offset:0 sc1
buffer_load_dword v17, v30, s[4:7], s44 offen offset:512 sc1
buffer_load_dword v19, v30, s[4:7], s44 offen offset:1536 sc1
s_waitcnt vmcnt(21)
v_add_f32 v96, v96, v97
s_waitcnt vmcnt(20)
v_add_f32 v96, v96, v98
s_waitcnt vmcnt(19)
v_add_f32 v96, v96, v99
s_waitcnt vmcnt(18)
v_add_f32 v96, v96, v100
s_waitcnt vmcnt(17)
v_add_f32 v96, v96, v101
s_waitcnt vmcnt(16)
v_add_f32 v96, v96, v102
s_waitcnt vmcnt(15)
v_add_f32 v96, v96, v103
s_waitcnt vmcnt(14)
v_add_f32 v96, v96, v104
s_waitcnt vmcnt(13)
v_add_f32 v96, v96, v105
s_waitcnt vmcnt(12)
v_add_f32 v96, v96, v106
s_waitcnt vmcnt(11)
v_add_f32 v96, v96, v107
s_waitcnt vmcnt(10)
v_add_f32 v96, v96, v108
s_waitcnt vmcnt(9)
v_add_f32 v96, v96, v109
s_waitcnt vmcnt(8)
v_add_f32 v96, v96, v110
s_waitcnt vmcnt(7)
v_add_f32 v96, v96, v111
s_waitcnt vmcnt(6)
v_add_f32 v96, v96, v20
s_waitcnt vmcnt(5)
v_add_f32 v96, v96, v21
s_waitcnt vmcnt(4)
v_add_f32 v96, v96, v22
s_waitcnt vmcnt(3)
v_add_f32 v96, v96, v23
v_cmp_u_f32 vcc, v96, v96
v_fma_f32 v96, v96, s49, v27
s_cbranch_vccz k_psd_70
s_sub_u32 s32, s32, 1
s_cmp_gt_i32 s32, 0
s_cbranch_scc1 k_ps_69
k_psd_70:
v_rsq_f32 v96, v96
s_add_u32 s45, s45, 20480
ds_write_b32 v24, v96 offset:58368
s_branch k_pyd_72
k_py_71:
buffer_load_dword v16, v30, s[4:7], s44 offen offset:0 sc1
buffer_load_dword v17, v30, s[4:7], s44 offen offset:512 sc1
buffer_load_dword v19, v30, s[4:7], s44 offen offset:1536 sc1
s_sub_u32 s32, s32, 1
k_pyd_72:
s_waitcnt vmcnt(0)
v_max3_u32 v20, v16, v17, v19
v_cmp_eq_u32 vcc, -1, v20
s_cmp_gt_i32 s32, 0
s_cselect_b64 vcc, vcc, 0
s_cbranch_vccnz k_py_71
s_add_u32 s44, s44, 4096
s_waitcnt lgkmcnt(0)
s_barrier
ds_read_b128 v[12:15], v0 offset:58368
v_lshlrev_b32 v156, 16, v16
v_and_b32 v140, 0xffff0000, v16
v_lshlrev_b32 v157, 16, v17
v_and_b32 v141, 0xffff0000, v17
v_lshlrev_b32 v158, 16, v18
v_and_b32 v142, 0xffff0000, v18
v_lshlrev_b32 v159, 16, v19
v_and_b32 v143, 0xffff0000, v19
s_waitcnt lgkmcnt(0)
v_mul_f32 v8, v12, v156
v_mul_f32 v12, v12, v140
v_cvt_pk_bf16_f32 v8, v8, v12
v_and_b32 v8, s47, v8
v_mul_f32 v9, v13, v157
v_mul_f32 v13, v13, v141
v_cvt_pk_bf16_f32 v9, v9, v13
v_and_b32 v9, s47, v9
v_mul_f32 v10, v14, v158
v_mul_f32 v14, v14, v142
v_cvt_pk_bf16_f32 v10, v10, v14
v_and_b32 v10, s47, v10
v_mul_f32 v11, v15, v159
v_mul_f32 v15, v15, v143
v_cvt_pk_bf16_f32 v11, v11, v15
v_and_b32 v11, s47, v11
s_nop 1
v_mfma_f32_32x32x16_bf16 v[32:47], v[8:11], v[112:115], v[32:47]
v_mfma_f32_32x32x16_bf16 v[48:63], v[8:11], v[116:119], v[48:63]
v_mfma_f32_32x32x16_bf16 v[64:79], v[8:11], v[120:123], v[64:79]
v_mfma_f32_32x32x16_bf16 v[80:95], v[8:11], v[124:127], v[80:95]
ds_read_b128 v[112:115], v0 offset:16384
ds_read_b128 v[116:119], v0 offset:17408
ds_read_b128 v[120:123], v0 offset:18432
ds_read_b128 v[124:127], v0 offset:19456
k_pr_73:
buffer_load_dword v18, v30, s[4:7], s44 offen offset:1024 sc1
s_waitcnt vmcnt(0)
v_cmp_eq_u32 vcc, -1, v18
s_cbranch_vccz k_prd_74
s_sleep 8
s_sub_u32 s32, s32, 1
s_cmp_gt_i32 s32, 0
s_cbranch_scc1 k_pr_73
k_prd_74:
k_ps_75:
buffer_load_dword v96, v31, s[4:7], s45 offen offset:0 sc1
buffer_load_dword v97, v31, s[4:7], s45 offen offset:128 sc1
buffer_load_dword v98, v31, s[4:7], s45 offen offset:256 sc1
buffer_load_dword v99, v31, s[4:7], s45 offen offset:384 sc1
buffer_load_dword v100, v31, s[4:7], s45 offen offset:512 sc1
buffer_load_dword v101, v31, s[4:7], s45 offen offset:640 sc1
buffer_load_dword v102, v31, s[4:7], s45 offen offset:768 sc1
buffer_load_dword v103, v31, s[4:7], s45 offen offset:896 sc1
buffer_load_dword v104, v31, s[4:7], s45 offen offset:1024 sc1
buffer_load_dword v105, v31, s[4:7], s45 offen offset:1152 sc1
buffer_load_dword v106, v31, s[4:7], s45 offen offset:1280 sc1
buffer_load_dword v107, v31, s[4:7], s45 offen offset:1408 sc1
buffer_load_dword v108, v31, s[4:7], s45 offen offset:1536 sc1
buffer_load_dword v109, v31, s[4:7], s45 offen offset:1664 sc1
buffer_load_dword v110, v31, s[4:7], s45 offen offset:1792 sc1
buffer_load_dword v111, v31, s[4:7], s45 offen offset:1920 sc1
buffer_load_dword v20, v31, s[4:7], s45 offen offset:2048 sc1
buffer_load_dword v21, v31, s[4:7], s45 offen offset:2176 sc1
buffer_load_dword v22, v31, s[4:7], s45 offen offset:2304 sc1
buffer_load_dword v23, v31, s[4:7], s45 offen offset:2432 sc1
buffer_load_dword v16, v30, s[4:7], s44 offen offset:0 sc1
buffer_load_dword v17, v30, s[4:7], s44 offen offset:512 sc1
buffer_load_dword v19, v30, s[4:7], s44 offen offset:1536 sc1
s_waitcnt vmcnt(21)
v_add_f32 v96, v96, v97
s_waitcnt vmcnt(20)
v_add_f32 v96, v96, v98
s_waitcnt vmcnt(19)
v_add_f32 v96, v96, v99
s_waitcnt vmcnt(18)
v_add_f32 v96, v96, v100
s_waitcnt vmcnt(17)
v_add_f32 v96, v96, v101
s_waitcnt vmcnt(16)
v_add_f32 v96, v96, v102
s_waitcnt vmcnt(15)
v_add_f32 v96, v96, v103
s_waitcnt vmcnt(14)
v_add_f32 v96, v96, v104
s_waitcnt vmcnt(13)
v_add_f32 v96, v96, v105
s_waitcnt vmcnt(12)
v_add_f32 v96, v96, v106
s_waitcnt vmcnt(11)
v_add_f32 v96, v96, v107
s_waitcnt vmcnt(10)
v_add_f32 v96, v96, v108
s_waitcnt vmcnt(9)
v_add_f32 v96, v96, v109
s_waitcnt vmcnt(8)
v_add_f32 v96, v96, v110
s_waitcnt vmcnt(7)
v_add_f32 v96, v96, v111
s_waitcnt vmcnt(6)
v_add_f32 v96, v96, v20
s_waitcnt vmcnt(5)
v_add_f32 v96, v96, v21
s_waitcnt vmcnt(4)
v_add_f32 v96, v96, v22
s_waitcnt vmcnt(3)
v_add_f32 v96, v96, v23
v_cmp_u_f32 vcc, v96, v96
v_fma_f32 v96, v96, s49, v27
s_cbranch_vccz k_psd_76
s_sub_u32 s32, s32, 1
s_cmp_gt_i32 s32, 0
s_cbranch_scc1 k_ps_75
k_psd_76:
v_rsq_f32 v96, v96
s_add_u32 s45, s45, 20480
ds_write_b32 v24, v96 offset:57344
s_branch k_pyd_78
k_py_77:
buffer_load_dword v16, v30, s[4:7], s44 offen offset:0 sc1
buffer_load_dword v17, v30, s[4:7], s44 offen offset:512 sc1
buffer_load_dword v19, v30, s[4:7], s44 offen offset:1536 sc1
s_sub_u32 s32, s32, 1
k_pyd_78:
s_waitcnt vmcnt(0)
v_max3_u32 v20, v16, v17, v19
v_cmp_eq_u32 vcc, -1, v20
s_cmp_gt_i32 s32, 0
s_cselect_b64 vcc, vcc, 0
s_cbranch_vccnz k_py_77
s_add_u32 s44, s44, 4096
s_waitcnt lgkmcnt(0)
s_barrier
ds_read_b128 v[12:15], v0 offset:57344
v_lshlrev_b32 v176, 16, v16
v_and_b32 v160, 0xffff0000, v16
v_lshlrev_b32 v177, 16, v17
v_and_b32 v161, 0xffff0000, v17
v_lshlrev_b32 v178, 16, v18
v_and_b32 v162, 0xffff0000, v18
v_lshlrev_b32 v179, 16, v19
v_and_b32 v163, 0xffff0000, v19
s_waitcnt lgkmcnt(0)
v_mul_f32 v8, v12, v176
v_mul_f32 v12, v12, v160
v_cvt_pk_bf16_f32 v8, v8, v12
v_and_b32 v8, s47, v8
v_mul_f32 v9, v13, v177
v_mul_f32 v13, v13, v161
v_cvt_pk_bf16_f32 v9, v9, v13
v_and_b32 v9, s47, v9
v_mul_f32 v10, v14, v178
v_mul_f32 v14, v14, v162
v_cvt_pk_bf16_f32 v10, v10, v14
v_and_b32 v10, s47, v10
v_mul_f32 v11, v15, v179
v_mul_f32 v15, v15, v163
v_cvt_pk_bf16_f32 v11, v11, v15
v_and_b32 v11, s47, v11
s_nop 1
v_mfma_f32_32x32x16_bf16 v[32:47], v[8:11], v[112:115], v[32:47]
v_mfma_f32_32x32x16_bf16 v[48:63], v[8:11], v[116:119], v[48:63]
v_mfma_f32_32x32x16_bf16 v[64:79], v[8:11], v[120:123], v[64:79]
v_mfma_f32_32x32x16_bf16 v[80:95], v[8:11], v[124:127], v[80:95]
ds_read_b128 v[112:115], v0 offset:20480
ds_read_b128 v[116:119], v0 offset:21504
ds_read_b128 v[120:123], v0 offset:22528
ds_read_b128 v[124:127], v0 offset:23552
k_pr_79:
buffer_load_dword v18, v30, s[4:7], s44 offen offset:1024 sc1
s_waitcnt vmcnt(0)
v_cmp_eq_u32 vcc, -1, v18
s_cbranch_vccz k_prd_80
s_sleep 8
s_sub_u32 s32, s32, 1
s_cmp_gt_i32 s32, 0
s_cbranch_scc1 k_pr_79
k_prd_80:
k_ps_81:
buffer_load_dword v96, v31, s[4:7], s45 offen offset:0 sc1
buffer_load_dword v97, v31, s[4:7], s45 offen offset:128 sc1
buffer_load_dword v98, v31, s[4:7], s45 offen offset:256 sc1
buffer_load_dword v99, v31, s[4:7], s45 offen offset:384 sc1
buffer_load_dword v100, v31, s[4:7], s45 offen offset:512 sc1
buffer_load_dword v101, v31, s[4:7], s45 offen offset:640 sc1
buffer_load_dword v102, v31, s[4:7], s45 offen offset:768 sc1
buffer_load_dword v103, v31, s[4:7], s45 offen offset:896 sc1
buffer_load_dword v104, v31, s[4:7], s45 offen offset:1024 sc1
buffer_load_dword v105, v31, s[4:7], s45 offen offset:1152 sc1
buffer_load_dword v106, v31, s[4:7], s45 offen offset:1280 sc1
buffer_load_dword v107, v31, s[4:7], s45 offen offset:1408 sc1
buffer_load_dword v108, v31, s[4:7], s45 offen offset:1536 sc1
buffer_load_dword v109, v31, s[4:7], s45 offen offset:1664 sc1
buffer_load_dword v110, v31, s[4:7], s45 offen offset:1792 sc1
buffer_load_dword v111, v31, s[4:7], s45 offen offset:1920 sc1
buffer_load_dword v20, v31, s[4:7], s45 offen offset:2048 sc1
buffer_load_dword v21, v31, s[4:7], s45 offen offset:2176 sc1
buffer_load_dword v22, v31, s[4:7], s45 offen offset:2304 sc1
buffer_load_dword v23, v31, s[4:7], s45 offen offset:2432 sc1
buffer_load_dword v16, v30, s[4:7], s44 offen offset:0 sc1
buffer_load_dword v17, v30, s[4:7], s44 offen offset:512 sc1
buffer_load_dword v19, v30, s[4:7], s44 offen offset:1536 sc1
s_waitcnt vmcnt(21)
v_add_f32 v96, v96, v97
s_waitcnt vmcnt(20)
v_add_f32 v96, v96, v98
s_waitcnt vmcnt(19)
v_add_f32 v96, v96, v99
s_waitcnt vmcnt(18)
v_add_f32 v96, v96, v100
s_waitcnt vmcnt(17)
v_add_f32 v96, v96, v101
s_waitcnt vmcnt(16)
v_add_f32 v96, v96, v102
s_waitcnt vmcnt(15)
v_add_f32 v96, v96, v103
s_waitcnt vmcnt(14)
v_add_f32 v96, v96, v104
s_waitcnt vmcnt(13)
v_add_f32 v96, v96, v105
s_waitcnt vmcnt(12)
v_add_f32 v96, v96, v106
s_waitcnt vmcnt(11)
v_add_f32 v96, v96, v107
s_waitcnt vmcnt(10)
v_add_f32 v96, v96, v108
s_waitcnt vmcnt(9)
v_add_f32 v96, v96, v109
s_waitcnt vmcnt(8)
v_add_f32 v96, v96, v110
s_waitcnt vmcnt(7)
v_add_f32 v96, v96, v111
s_waitcnt vmcnt(6)
v_add_f32 v96, v96, v20
s_waitcnt vmcnt(5)
v_add_f32 v96, v96, v21
s_waitcnt vmcnt(4)
v_add_f32 v96, v96, v22
s_waitcnt vmcnt(3)
v_add_f32 v96, v96, v23
v_cmp_u_f32 vcc, v96, v96
v_fma_f32 v96, v96, s49, v27
s_cbranch_vccz k_psd_82
s_sub_u32 s32, s32, 1
s_cmp_gt_i32 s32, 0
s_cbranch_scc1 k_ps_81
k_psd_82:
v_rsq_f32 v96, v96
s_add_u32 s45, s45, 20480
ds_write_b32 v24, v96 offset:58368
s_branch k_pyd_84
k_py_83:
buffer_load_dword v16, v30, s[4:7], s44 offen offset:0 sc1
buffer_load_dword v17, v30, s[4:7], s44 offen offset:512 sc1
buffer_load_dword v19, v30, s[4:7], s44 offen offset:1536 sc1
s_sub_u32 s32, s32, 1
k_pyd_84:
s_waitcnt vmcnt(0)
v_max3_u32 v20, v16, v17, v19
v_cmp_eq_u32 vcc, -1, v20
s_cmp_gt_i32 s32, 0
s_cselect_b64 vcc, vcc, 0
s_cbranch_vccnz k_py_83
s_add_u32 s44, s44, 4096
s_waitcnt lgkmcnt(0)
s_barrier
ds_read_b128 v[12:15], v0 offset:58368
v_lshlrev_b32 v180, 16, v16
v_and_b32 v164, 0xffff0000, v16
v_lshlrev_b32 v181, 16, v17
v_and_b32 v165, 0xffff0000, v17
v_lshlrev_b32 v182, 16, v18
v_and_b32 v166, 0xffff0000, v18
v_lshlrev_b32 v183, 16, v19
v_and_b32 v167, 0xffff0000, v19
s_waitcnt lgkmcnt(0)
v_mul_f32 v8, v12, v180
v_mul_f32 v12, v12, v164
v_cvt_pk_bf16_f32 v8, v8, v12
v_and_b32 v8, s47, v8
v_mul_f32 v9, v13, v181
v_mul_f32 v13, v13, v165
v_cvt_pk_bf16_f32 v9, v9, v13
v_and_b32 v9, s47, v9
v_mul_f32 v10, v14, v182
v_mul_f32 v14, v14, v166
v_cvt_pk_bf16_f32 v10, v10, v14
v_and_b32 v10, s47, v10
v_mul_f32 v11, v15, v183
v_mul_f32 v15, v15, v167
v_cvt_pk_bf16_f32 v11, v11, v15
v_and_b32 v11, s47, v11
s_nop 1
v_mfma_f32_32x32x16_bf16 v[32:47], v[8:11], v[112:115], v[32:47]
v_mfma_f32_32x32x16_bf16 v[48:63], v[8:11], v[116:119], v[48:63]
v_mfma_f32_32x32x16_bf16 v[64:79], v[8:11], v[120:123], v[64:79]
v_mfma_f32_32x32x16_bf16 v[80:95], v[8:11], v[124:127], v[80:95]
ds_read_b128 v[112:115], v0 offset:24576
ds_read_b128 v[116:119], v0 offset:25600
ds_read_b128 v[120:123], v0 offset:26624
ds_read_b128 v[124:127], v0 offset:27648
k_pr_85:
buffer_load_dword v18, v30, s[4:7], s44 offen offset:1024 sc1
s_waitcnt vmcnt(0)
v_cmp_eq_u32 vcc, -1, v18
s_cbranch_vccz k_prd_86
s_sleep 8
s_sub_u32 s32, s32, 1
s_cmp_gt_i32 s32, 0
s_cbranch_scc1 k_pr_85
k_prd_86:
k_ps_87:
buffer_load_dword v96, v31, s[4:7], s45 offen offset:0 sc1
buffer_load_dword v97, v31, s[4:7], s45 offen offset:128 sc1
buffer_load_dword v98, v31, s[4:7], s45 offen offset:256 sc1
buffer_load_dword v99, v31, s[4:7], s45 offen offset:384 sc1
buffer_load_dword v100, v31, s[4:7], s45 offen offset:512 sc1
buffer_load_dword v101, v31, s[4:7], s45 offen offset:640 sc1
buffer_load_dword v102, v31, s[4:7], s45 offen offset:768 sc1
buffer_load_dword v103, v31, s[4:7], s45 offen offset:896 sc1
buffer_load_dword v104, v31, s[4:7], s45 offen offset:1024 sc1
buffer_load_dword v105, v31, s[4:7], s45 offen offset:1152 sc1
buffer_load_dword v106, v31, s[4:7], s45 offen offset:1280 sc1
buffer_load_dword v107, v31, s[4:7], s45 offen offset:1408 sc1
buffer_load_dword v108, v31, s[4:7], s45 offen offset:1536 sc1
buffer_load_dword v109, v31, s[4:7], s45 offen offset:1664 sc1
buffer_load_dword v110, v31, s[4:7], s45 offen offset:1792 sc1
buffer_load_dword v111, v31, s[4:7], s45 offen offset:1920 sc1
buffer_load_dword v20, v31, s[4:7], s45 offen offset:2048 sc1
buffer_load_dword v21, v31, s[4:7], s45 offen offset:2176 sc1
buffer_load_dword v22, v31, s[4:7], s45 offen offset:2304 sc1
buffer_load_dword v23, v31, s[4:7], s45 offen offset:2432 sc1
buffer_load_dword v16, v30, s[4:7], s44 offen offset:0 sc1
buffer_load_dword v17, v30, s[4:7], s44 offen offset:512 sc1
buffer_load_dword v19, v30, s[4:7], s44 offen offset:1536 sc1
s_waitcnt vmcnt(21)
v_add_f32 v96, v96, v97
s_waitcnt vmcnt(20)
v_add_f32 v96, v96, v98
s_waitcnt vmcnt(19)
v_add_f32 v96, v96, v99
s_waitcnt vmcnt(18)
v_add_f32 v96, v96, v100
s_waitcnt vmcnt(17)
v_add_f32 v96, v96, v101
s_waitcnt vmcnt(16)
v_add_f32 v96, v96, v102
s_waitcnt vmcnt(15)
v_add_f32 v96, v96, v103
s_waitcnt vmcnt(14)
v_add_f32 v96, v96, v104
s_waitcnt vmcnt(13)
v_add_f32 v96, v96, v105
s_waitcnt vmcnt(12)
v_add_f32 v96, v96, v106
s_waitcnt vmcnt(11)
v_add_f32 v96, v96, v107
s_waitcnt vmcnt(10)
v_add_f32 v96, v96, v108
s_waitcnt vmcnt(9)
v_add_f32 v96, v96, v109
s_waitcnt vmcnt(8)
v_add_f32 v96, v96, v110
s_waitcnt vmcnt(7)
v_add_f32 v96, v96, v111
s_waitcnt vmcnt(6)
v_add_f32 v96, v96, v20
s_waitcnt vmcnt(5)
v_add_f32 v96, v96, v21
s_waitcnt vmcnt(4)
v_add_f32 v96, v96, v22
s_waitcnt vmcnt(3)
v_add_f32 v96, v96, v23
v_cmp_u_f32 vcc, v96, v96
v_fma_f32 v96, v96, s49, v27
s_cbranch_vccz k_psd_88
s_sub_u32 s32, s32, 1
s_cmp_gt_i32 s32, 0
s_cbranch_scc1 k_ps_87
k_psd_88:
v_rsq_f32 v96, v96
s_add_u32 s45, s45, 20480
ds_write_b32 v24, v96 offset:57344
s_branch k_pyd_90
k_py_89:
buffer_load_dword v16, v30, s[4:7], s44 offen offset:0 sc1
buffer_load_dword v17, v30, s[4:7], s44 offen offset:512 sc1
buffer_load_dword v19, v30, s[4:7], s44 offen offset:1536 sc1
s_sub_u32 s32, s32, 1
k_pyd_90:
s_waitcnt vmcnt(0)
v_max3_u32 v20, v16, v17, v19
v_cmp_eq_u32 vcc, -1, v20
s_cmp_gt_i32 s32, 0
s_cselect_b64 vcc, vcc, 0
s_cbranch_vccnz k_py_89
s_add_u32 s44, s44, 4096
s_waitcnt lgkmcnt(0)
s_barrier
ds_read_b128 v[12:15], v0 offset:57344
v_lshlrev_b32 v184, 16, v16
v_and_b32 v168, 0xffff0000, v16
v_lshlrev_b32 v185, 16, v17
v_and_b32 v169, 0xffff0000, v17
v_lshlrev_b32 v186, 16, v18
v_and_b32 v170, 0xffff0000, v18
v_lshlrev_b32 v187, 16, v19
v_and_b32 v171, 0xffff0000, v19
s_waitcnt lgkmcnt(0)
v_mul_f32 v8, v12, v184
v_mul_f32 v12, v12, v168
v_cvt_pk_bf16_f32 v8, v8, v12
v_and_b32 v8, s47, v8
v_mul_f32 v9, v13, v185
v_mul_f32 v13, v13, v169
v_cvt_pk_bf16_f32 v9, v9, v13
v_and_b32 v9, s47, v9
v_mul_f32 v10, v14, v186
v_mul_f32 v14, v14, v170
v_cvt_pk_bf16_f32 v10, v10, v14
v_and_b32 v10, s47, v10
v_mul_f32 v11, v15, v187
v_mul_f32 v15, v15, v171
v_cvt_pk_bf16_f32 v11, v11, v15
v_and_b32 v11, s47, v11
s_nop 1
v_mfma_f32_32x32x16_bf16 v[32:47], v[8:11], v[112:115], v[32:47]
v_mfma_f32_32x32x16_bf16 v[48:63], v[8:11], v[116:119], v[48:63]
v_mfma_f32_32x32x16_bf16 v[64:79], v[8:11], v[120:123], v[64:79]
v_mfma_f32_32x32x16_bf16 v[80:95], v[8:11], v[124:127], v[80:95]
ds_read_b128 v[112:115], v0 offset:28672
ds_read_b128 v[116:119], v0 offset:29696
ds_read_b128 v[120:123], v0 offset:30720
ds_read_b128 v[124:127], v0 offset:31744
k_pr_91:
buffer_load_dword v18, v30, s[4:7], s44 offen offset:1024 sc1
s_waitcnt vmcnt(0)
v_cmp_eq_u32 vcc, -1, v18
s_cbranch_vccz k_prd_92
s_sleep 8
s_sub_u32 s32, s32, 1
s_cmp_gt_i32 s32, 0
s_cbranch_scc1 k_pr_91
k_prd_92:
k_ps_93:
buffer_load_dword v96, v31, s[4:7], s45 offen offset:0 sc1
buffer_load_dword v97, v31, s[4:7], s45 offen offset:128 sc1
buffer_load_dword v98, v31, s[4:7], s45 offen offset:256 sc1
buffer_load_dword v99, v31, s[4:7], s45 offen offset:384 sc1
buffer_load_dword v100, v31, s[4:7], s45 offen offset:512 sc1
buffer_load_dword v101, v31, s[4:7], s45 offen offset:640 sc1
buffer_load_dword v102, v31, s[4:7], s45 offen offset:768 sc1
buffer_load_dword v103, v31, s[4:7], s45 offen offset:896 sc1
buffer_load_dword v104, v31, s[4:7], s45 offen offset:1024 sc1
buffer_load_dword v105, v31, s[4:7], s45 offen offset:1152 sc1
buffer_load_dword v106, v31, s[4:7], s45 offen offset:1280 sc1
buffer_load_dword v107, v31, s[4:7], s45 offen offset:1408 sc1
buffer_load_dword v108, v31, s[4:7], s45 offen offset:1536 sc1
buffer_load_dword v109, v31, s[4:7], s45 offen offset:1664 sc1
buffer_load_dword v110, v31, s[4:7], s45 offen offset:1792 sc1
buffer_load_dword v111, v31, s[4:7], s45 offen offset:1920 sc1
buffer_load_dword v20, v31, s[4:7], s45 offen offset:2048 sc1
buffer_load_dword v21, v31, s[4:7], s45 offen offset:2176 sc1
buffer_load_dword v22, v31, s[4:7], s45 offen offset:2304 sc1
buffer_load_dword v23, v31, s[4:7], s45 offen offset:2432 sc1
buffer_load_dword v16, v30, s[4:7], s44 offen offset:0 sc1
buffer_load_dword v17, v30, s[4:7], s44 offen offset:512 sc1
buffer_load_dword v19, v30, s[4:7], s44 offen offset:1536 sc1
s_waitcnt vmcnt(21)
v_add_f32 v96, v96, v97
s_waitcnt vmcnt(20)
v_add_f32 v96, v96, v98
s_waitcnt vmcnt(19)
v_add_f32 v96, v96, v99
s_waitcnt vmcnt(18)
v_add_f32 v96, v96, v100
s_waitcnt vmcnt(17)
v_add_f32 v96, v96, v101
s_waitcnt vmcnt(16)
v_add_f32 v96, v96, v102
s_waitcnt vmcnt(15)
v_add_f32 v96, v96, v103
s_waitcnt vmcnt(14)
v_add_f32 v96, v96, v104
s_waitcnt vmcnt(13)
v_add_f32 v96, v96, v105
s_waitcnt vmcnt(12)
v_add_f32 v96, v96, v106
s_waitcnt vmcnt(11)
v_add_f32 v96, v96, v107
s_waitcnt vmcnt(10)
v_add_f32 v96, v96, v108
s_waitcnt vmcnt(9)
v_add_f32 v96, v96, v109
s_waitcnt vmcnt(8)
v_add_f32 v96, v96, v110
s_waitcnt vmcnt(7)
v_add_f32 v96, v96, v111
s_waitcnt vmcnt(6)
v_add_f32 v96, v96, v20
s_waitcnt vmcnt(5)
v_add_f32 v96, v96, v21
s_waitcnt vmcnt(4)
v_add_f32 v96, v96, v22
s_waitcnt vmcnt(3)
v_add_f32 v96, v96, v23
v_cmp_u_f32 vcc, v96, v96
v_fma_f32 v96, v96, s49, v27
s_cbranch_vccz k_psd_94
s_sub_u32 s32, s32, 1
s_cmp_gt_i32 s32, 0
s_cbranch_scc1 k_ps_93
k_psd_94:
v_rsq_f32 v96, v96
s_add_u32 s45, s45, 20480
ds_write_b32 v24, v96 offset:58368
s_branch k_pyd_96
k_py_95:
buffer_load_dword v16, v30, s[4:7], s44 offen offset:0 sc1
buffer_load_dword v17, v30, s[4:7], s44 offen offset:512 sc1
buffer_load_dword v19, v30, s[4:7], s44 offen offset:1536 sc1
s_sub_u32 s32, s32, 1
k_pyd_96:
s_waitcnt vmcnt(0)
v_max3_u32 v20, v16, v17, v19
v_cmp_eq_u32 vcc, -1, v20
s_cmp_gt_i32 s32, 0
s_cselect_b64 vcc, vcc, 0
s_cbranch_vccnz k_py_95
s_add_u32 s44, s44, 4096
k_k7_48:
s_waitcnt lgkmcnt(0)
s_barrier
ds_read_b128 v[12:15], v0 offset:58368
v_lshlrev_b32 v188, 16, v16
v_and_b32 v172, 0xffff0000, v16
v_lshlrev_b32 v189, 16, v17
v_and_b32 v173, 0xffff0000, v17
v_lshlrev_b32 v190, 16, v18
v_and_b32 v174, 0xffff0000, v18
v_lshlrev_b32 v191, 16, v19
v_and_b32 v175, 0xffff0000, v19
s_waitcnt lgkmcnt(0)
v_mul_f32 v8, v12, v188
v_mul_f32 v12, v12, v172
v_cvt_pk_bf16_f32 v8, v8, v12
v_and_b32 v8, s47, v8
v_mul_f32 v9, v13, v189
v_mul_f32 v13, v13, v173
v_cvt_pk_bf16_f32 v9, v9, v13
v_and_b32 v9, s47, v9
v_mul_f32 v10, v14, v190
v_mul_f32 v14, v14, v174
v_cvt_pk_bf16_f32 v10, v10, v14
v_and_b32 v10, s47, v10
v_mul_f32 v11, v15, v191
v_mul_f32 v15, v15, v175
v_cvt_pk_bf16_f32 v11, v11, v15
v_and_b32 v11, s47, v11
s_nop 1
v_mfma_f32_32x32x16_bf16 v[32:47], v[8:11], v[112:115], v[32:47]
v_mfma_f32_32x32x16_bf16 v[48:63], v[8:11], v[116:119], v[48:63]
v_mfma_f32_32x32x16_bf16 v[64:79], v[8:11], v[120:123], v[64:79]
v_mfma_f32_32x32x16_bf16 v[80:95], v[8:11], v[124:127], v[80:95]
ds_read_b128 v[112:115], v0 offset:32768
ds_read_b128 v[116:119], v0 offset:33792
ds_read_b128 v[120:123], v0 offset:34816
ds_read_b128 v[124:127], v0 offset:35840
s_waitcnt lgkmcnt(3)
v_pk_mul_f32 v[8:9], v[32:33], v[112:113]
v_pk_mul_f32 v[10:11], v[48:49], v[112:113]
s_waitcnt lgkmcnt(2)
v_pk_fma_f32 v[8:9], v[48:49], v[116:117], v[8:9]
v_pk_fma_f32 v[10:11], v[32:33], v[116:117], v[10:11] neg_lo:[1,0,0] neg_hi:[1,0,0]
v_cvt_pk_bf16_f32 v32, v8, v10
v_cvt_pk_bf16_f32 v33, v9, v11
v_pk_mul_f32 v[8:9], v[34:35], v[114:115]
v_pk_mul_f32 v[10:11], v[50:51], v[114:115]
v_pk_fma_f32 v[8:9], v[50:51], v[118:119], v[8:9]
v_pk_fma_f32 v[10:11], v[34:35], v[118:119], v[10:11] neg_lo:[1,0,0] neg_hi:[1,0,0]
v_cvt_pk_bf16_f32 v34, v8, v10
v_cvt_pk_bf16_f32 v35, v9, v11
ds_read_b128 v[112:115], v0 offset:36864
ds_read_b128 v[116:119], v0 offset:37888
s_waitcnt lgkmcnt(3)
v_pk_mul_f32 v[8:9], v[36:37], v[120:121]
v_pk_mul_f32 v[10:11], v[52:53], v[120:121]
s_waitcnt lgkmcnt(2)
v_pk_fma_f32 v[8:9], v[52:53], v[124:125], v[8:9]
v_pk_fma_f32 v[10:11], v[36:37], v[124:125], v[10:11] neg_lo:[1,0,0] neg_hi:[1,0,0]
v_cvt_pk_bf16_f32 v36, v8, v10
v_cvt_pk_bf16_f32 v37, v9, v11
v_pk_mul_f32 v[8:9], v[38:39], v[122:123]
v_pk_mul_f32 v[10:11], v[54:55], v[122:123]
v_pk_fma_f32 v[8:9], v[54:55], v[126:127], v[8:9]
v_pk_fma_f32 v[10:11], v[38:39], v[126:127], v[10:11] neg_lo:[1,0,0] neg_hi:[1,0,0]
v_cvt_pk_bf16_f32 v38, v8, v10
v_cvt_pk_bf16_f32 v39, v9, v11
ds_read_b128 v[120:123], v0 offset:38912
ds_read_b128 v[124:127], v0 offset:39936
s_waitcnt lgkmcnt(3)
v_pk_mul_f32 v[8:9], v[40:41], v[112:113]
v_pk_mul_f32 v[10:11], v[56:57], v[112:113]
s_waitcnt lgkmcnt(2)
v_pk_fma_f32 v[8:9], v[56:57], v[116:117], v[8:9]
v_pk_fma_f32 v[10:11], v[40:41], v[116:117], v[10:11] neg_lo:[1,0,0] neg_hi:[1,0,0]
v_cvt_pk_bf16_f32 v40, v8, v10
v_cvt_pk_bf16_f32 v41, v9, v11
v_pk_mul_f32 v[8:9], v[42:43], v[114:115]
v_pk_mul_f32 v[10:11], v[58:59], v[114:115]
v_pk_fma_f32 v[8:9], v[58:59], v[118:119], v[8:9]
v_pk_fma_f32 v[10:11], v[42:43], v[118:119], v[10:11] neg_lo:[1,0,0] neg_hi:[1,0,0]
v_cvt_pk_bf16_f32 v42, v8, v10
v_cvt_pk_bf16_f32 v43, v9, v11
ds_read_b128 v[112:115], v0 offset:40960
ds_read_b128 v[116:119], v0 offset:41984
s_waitcnt lgkmcnt(3)
v_pk_mul_f32 v[8:9], v[44:45], v[120:121]
v_pk_mul_f32 v[10:11], v[60:61], v[120:121]
s_waitcnt lgkmcnt(2)
v_pk_fma_f32 v[8:9], v[60:61], v[124:125], v[8:9]
v_pk_fma_f32 v[10:11], v[44:45], v[124:125], v[10:11] neg_lo:[1,0,0] neg_hi:[1,0,0]
v_cvt_pk_bf16_f32 v44, v8, v10
v_cvt_pk_bf16_f32 v45, v9, v11
v_pk_mul_f32 v[8:9], v[46:47], v[122:123]
v_pk_mul_f32 v[10:11], v[62:63], v[122:123]
v_pk_fma_f32 v[8:9], v[62:63], v[126:127], v[8:9]
v_pk_fma_f32 v[10:11], v[46:47], v[126:127], v[10:11] neg_lo:[1,0,0] neg_hi:[1,0,0]
v_cvt_pk_bf16_f32 v46, v8, v10
v_cvt_pk_bf16_f32 v47, v9, v11
ds_read_b128 v[120:123], v0 offset:43008
ds_read_b128 v[124:127], v0 offset:44032
v_mfma_f32_32x32x16_bf16 v[48:63], a[160:163], v[32:35], 0
s_waitcnt lgkmcnt(3)
v_pk_mul_f32 v[8:9], v[64:65], v[112:113]
v_pk_mul_f32 v[10:11], v[80:81], v[112:113]
s_waitcnt lgkmcnt(2)
v_pk_fma_f32 v[8:9], v[80:81], v[116:117], v[8:9]
v_pk_fma_f32 v[10:11], v[64:65], v[116:117], v[10:11] neg_lo:[1,0,0] neg_hi:[1,0,0]
v_cvt_pk_bf16_f32 v64, v8, v10
v_cvt_pk_bf16_f32 v65, v9, v11
v_mfma_f32_32x32x16_bf16 v[96:111], a[164:167], v[32:35], 0
v_pk_mul_f32 v[8:9], v[66:67], v[114:115]
v_pk_mul_f32 v[10:11], v[82:83], v[114:115]
v_pk_fma_f32 v[8:9], v[82:83], v[118:119], v[8:9]
v_pk_fma_f32 v[10:11], v[66:67], v[118:119], v[10:11] neg_lo:[1,0,0] neg_hi:[1,0,0]
v_cvt_pk_bf16_f32 v66, v8, v10
v_cvt_pk_bf16_f32 v67, v9, v11
v_mfma_f32_32x32x16_bf16 v[48:63], a[168:171], v[36:39], v[48:63]
ds_read_b128 v[112:115], v0 offset:45056
ds_read_b128 v[116:119], v0 offset:46080
s_waitcnt lgkmcnt(3)
v_pk_mul_f32 v[8:9], v[68:69], v[120:121]
v_pk_mul_f32 v[10:11], v[84:85], v[120:121]
s_waitcnt lgkmcnt(2)
v_pk_fma_f32 v[8:9], v[84:85], v[124:125], v[8:9]
v_pk_fma_f32 v[10:11], v[68:69], v[124:125], v[10:11] neg_lo:[1,0,0] neg_hi:[1,0,0]
v_mfma_f32_32x32x16_bf16 v[96:111], a[172:175], v[36:39], v[96:111]
v_cvt_pk_bf16_f32 v68, v8, v10
v_cvt_pk_bf16_f32 v69, v9, v11
v_pk_mul_f32 v[8:9], v[70:71], v[122:123]
v_pk_mul_f32 v[10:11], v[86:87], v[122:123]
v_pk_fma_f32 v[8:9], v[86:87], v[126:127], v[8:9]
v_pk_fma_f32 v[10:11], v[70:71], v[126:127], v[10:11] neg_lo:[1,0,0] neg_hi:[1,0,0]
v_mfma_f32_32x32x16_bf16 v[48:63], a[176:179], v[40:43], v[48:63]
v_cvt_pk_bf16_f32 v70, v8, v10
v_cvt_pk_bf16_f32 v71, v9, v11
ds_read_b128 v[120:123], v0 offset:47104
ds_read_b128 v[124:127], v0 offset:48128
s_waitcnt lgkmcnt(3)
v_pk_mul_f32 v[8:9], v[72:73], v[112:113]
v_pk_mul_f32 v[10:11], v[88:89], v[112:113]
v_mfma_f32_32x32x16_bf16 v[96:111], a[180:183], v[40:43], v[96:111]
s_waitcnt lgkmcnt(2)
v_pk_fma_f32 v[8:9], v[88:89], v[116:117], v[8:9]
v_pk_fma_f32 v[10:11], v[72:73], v[116:117], v[10:11] neg_lo:[1,0,0] neg_hi:[1,0,0]
v_cvt_pk_bf16_f32 v72, v8, v10
v_cvt_pk_bf16_f32 v73, v9, v11
v_pk_mul_f32 v[8:9], v[74:75], v[114:115]
v_pk_mul_f32 v[10:11], v[90:91], v[114:115]
v_mfma_f32_32x32x16_bf16 v[48:63], a[184:187], v[44:47], v[48:63]
v_pk_fma_f32 v[8:9], v[90:91], v[118:119], v[8:9]
v_pk_fma_f32 v[10:11], v[74:75], v[118:119], v[10:11] neg_lo:[1,0,0] neg_hi:[1,0,0]
v_cvt_pk_bf16_f32 v74, v8, v10
v_cvt_pk_bf16_f32 v75, v9, v11
ds_read_b128 v[112:115], v0 offset:32768
ds_read_b128 v[116:119], v0 offset:33792
v_mfma_f32_32x32x16_bf16 v[96:111], a[188:191], v[44:47], v[96:111]
s_waitcnt lgkmcnt(3)
v_pk_mul_f32 v[8:9], v[76:77], v[120:121]
v_pk_mul_f32 v[10:11], v[92:93], v[120:121]
s_waitcnt lgkmcnt(2)
v_pk_fma_f32 v[8:9], v[92:93], v[124:125], v[8:9]
v_pk_fma_f32 v[10:11], v[76:77], v[124:125], v[10:11] neg_lo:[1,0,0] neg_hi:[1,0,0]
v_cvt_pk_bf16_f32 v76, v8, v10
v_cvt_pk_bf16_f32 v77, v9, v11
v_pk_mul_f32 v[8:9], v[78:79], v[122:123]
v_pk_mul_f32 v[10:11], v[94:95], v[122:123]
v_pk_fma_f32 v[8:9], v[94:95], v[126:127], v[8:9]
v_pk_fma_f32 v[10:11], v[78:79], v[126:127], v[10:11] neg_lo:[1,0,0] neg_hi:[1,0,0]
v_cvt_pk_bf16_f32 v78, v8, v10
v_cvt_pk_bf16_f32 v79, v9, v11
ds_read_b128 v[120:123], v0 offset:34816
ds_read_b128 v[124:127], v0 offset:35840
v_mfma_f32_32x32x16_bf16 v[80:95], a[160:163], v[64:67], 0
v_pk_mul_f32 v[8:9], v[48:49], v[208:209]
v_pk_mul_f32 v[10:11], v[96:97], v[208:209]
v_pk_fma_f32 v[8:9], v[96:97], v[192:193], v[8:9]
v_pk_fma_f32 v[10:11], v[48:49], v[192:193], v[10:11] neg_lo:[0,0,1] neg_hi:[0,0,1]
v_cvt_pk_bf16_f32 v48, v8, v10
v_cvt_pk_bf16_f32 v49, v9, v11
v_mfma_f32_32x32x16_bf16 v[32:47], a[164:167], v[64:67], 0
v_pk_mul_f32 v[8:9], v[50:51], v[210:211]
v_pk_mul_f32 v[10:11], v[98:99], v[210:211]
v_pk_fma_f32 v[8:9], v[98:99], v[194:195], v[8:9]
v_pk_fma_f32 v[10:11], v[50:51], v[194:195], v[10:11] neg_lo:[0,0,1] neg_hi:[0,0,1]
v_cvt_pk_bf16_f32 v50, v8, v10
v_cvt_pk_bf16_f32 v51, v9, v11
v_mfma_f32_32x32x16_bf16 v[80:95], a[168:171], v[68:71], v[80:95]
v_pk_mul_f32 v[8:9], v[52:53], v[212:213]
v_pk_mul_f32 v[10:11], v[100:101], v[212:213]
v_pk_fma_f32 v[8:9], v[100:101], v[196:197], v[8:9]
v_pk_fma_f32 v[10:11], v[52:53], v[196:197], v[10:11] neg_lo:[0,0,1] neg_hi:[0,0,1]
v_cvt_pk_bf16_f32 v52, v8, v10
v_cvt_pk_bf16_f32 v53, v9, v11
v_mfma_f32_32x32x16_bf16 v[32:47], a[172:175], v[68:71], v[32:47]
v_pk_mul_f32 v[8:9], v[54:55], v[214:215]
v_pk_mul_f32 v[10:11], v[102:103], v[214:215]
v_pk_fma_f32 v[8:9], v[102:103], v[198:199], v[8:9]
v_pk_fma_f32 v[10:11], v[54:55], v[198:199], v[10:11] neg_lo:[0,0,1] neg_hi:[0,0,1]
v_cvt_pk_bf16_f32 v54, v8, v10
v_cvt_pk_bf16_f32 v55, v9, v11
v_mfma_f32_32x32x16_bf16 v[80:95], a[176:179], v[72:75], v[80:95]
v_pk_mul_f32 v[8:9], v[56:57], v[216:217]
v_pk_mul_f32 v[10:11], v[104:105], v[216:217]
v_pk_fma_f32 v[8:9], v[104:105], v[200:201], v[8:9]
v_pk_fma_f32 v[10:11], v[56:57], v[200:201], v[10:11] neg_lo:[0,0,1] neg_hi:[0,0,1]
v_cvt_pk_bf16_f32 v56, v8, v10
v_cvt_pk_bf16_f32 v57, v9, v11
v_mfma_f32_32x32x16_bf16 v[32:47], a[180:183], v[72:75], v[32:47]
v_pk_mul_f32 v[8:9], v[58:59], v[218:219]
v_pk_mul_f32 v[10:11], v[106:107], v[218:219]
v_pk_fma_f32 v[8:9], v[106:107], v[202:203], v[8:9]
v_pk_fma_f32 v[10:11], v[58:59], v[202:203], v[10:11] neg_lo:[0,0,1] neg_hi:[0,0,1]
v_cvt_pk_bf16_f32 v58, v8, v10
v_cvt_pk_bf16_f32 v59, v9, v11
v_mfma_f32_32x32x16_bf16 v[80:95], a[184:187], v[76:79], v[80:95]
v_pk_mul_f32 v[8:9], v[60:61], v[220:221]
v_pk_mul_f32 v[10:11], v[108:109], v[220:221]
v_pk_fma_f32 v[8:9], v[108:109], v[204:205], v[8:9]
v_pk_fma_f32 v[10:11], v[60:61], v[204:205], v[10:11] neg_lo:[0,0,1] neg_hi:[0,0,1]
v_cvt_pk_bf16_f32 v60, v8, v10
v_cvt_pk_bf16_f32 v61, v9, v11
v_mfma_f32_32x32x16_bf16 v[32:47], a[188:191], v[76:79], v[32:47]
v_pk_mul_f32 v[8:9], v[62:63], v[222:223]
v_pk_mul_f32 v[10:11], v[110:111], v[222:223]
v_pk_fma_f32 v[8:9], v[110:111], v[206:207], v[8:9]
v_pk_fma_f32 v[10:11], v[62:63], v[206:207], v[10:11] neg_lo:[0,0,1] neg_hi:[0,0,1]
v_cvt_pk_bf16_f32 v62, v8, v10
v_cvt_pk_bf16_f32 v63, v9, v11
v_mfma_f32_32x32x16_bf16 v[96:111], v[48:51], a[160:163], 0
v_pk_mul_f32 v[8:9], v[80:81], v[240:241]
s_nop 2
v_pk_mul_f32 v[10:11], v[32:33], v[240:241]
v_pk_fma_f32 v[8:9], v[32:33], v[224:225], v[8:9]
v_pk_fma_f32 v[10:11], v[80:81], v[224:225], v[10:11] neg_lo:[0,0,1] neg_hi:[0,0,1]
v_cvt_pk_bf16_f32 v80, v8, v10
v_cvt_pk_bf16_f32 v81, v9, v11
v_mfma_f32_32x32x16_bf16 v[64:79], v[48:51], a[164:167], 0
v_pk_mul_f32 v[8:9], v[82:83], v[242:243]
v_pk_mul_f32 v[10:11], v[34:35], v[242:243]
v_pk_fma_f32 v[8:9], v[34:35], v[226:227], v[8:9]
v_pk_fma_f32 v[10:11], v[82:83], v[226:227], v[10:11] neg_lo:[0,0,1] neg_hi:[0,0,1]
v_cvt_pk_bf16_f32 v82, v8, v10
v_cvt_pk_bf16_f32 v83, v9, v11
v_mfma_f32_32x32x16_bf16 v[96:111], v[52:55], a[168:171], v[96:111]
v_pk_mul_f32 v[8:9], v[84:85], v[244:245]
v_pk_mul_f32 v[10:11], v[36:37], v[244:245]
v_pk_fma_f32 v[8:9], v[36:37], v[228:229], v[8:9]
v_pk_fma_f32 v[10:11], v[84:85], v[228:229], v[10:11] neg_lo:[0,0,1] neg_hi:[0,0,1]
v_cvt_pk_bf16_f32 v84, v8, v10
v_cvt_pk_bf16_f32 v85, v9, v11
v_mfma_f32_32x32x16_bf16 v[64:79], v[52:55], a[172:175], v[64:79]
v_pk_mul_f32 v[8:9], v[86:87], v[246:247]
v_pk_mul_f32 v[10:11], v[38:39], v[246:247]
v_pk_fma_f32 v[8:9], v[38:39], v[230:231], v[8:9]
v_pk_fma_f32 v[10:11], v[86:87], v[230:231], v[10:11] neg_lo:[0,0,1] neg_hi:[0,0,1]
v_cvt_pk_bf16_f32 v86, v8, v10
v_cvt_pk_bf16_f32 v87, v9, v11
v_mfma_f32_32x32x16_bf16 v[96:111], v[56:59], a[176:179], v[96:111]
v_pk_mul_f32 v[8:9], v[88:89], v[248:249]
v_pk_mul_f32 v[10:11], v[40:41], v[248:249]
v_pk_fma_f32 v[8:9], v[40:41], v[232:233], v[8:9]
v_pk_fma_f32 v[10:11], v[88:89], v[232:233], v[10:11] neg_lo:[0,0,1] neg_hi:[0,0,1]
v_cvt_pk_bf16_f32 v88, v8, v10
v_cvt_pk_bf16_f32 v89, v9, v11
v_mfma_f32_32x32x16_bf16 v[64:79], v[56:59], a[180:183], v[64:79]
v_pk_mul_f32 v[8:9], v[90:91], v[250:251]
v_pk_mul_f32 v[10:11], v[42:43], v[250:251]
v_pk_fma_f32 v[8:9], v[42:43], v[234:235], v[8:9]
v_pk_fma_f32 v[10:11], v[90:91], v[234:235], v[10:11] neg_lo:[0,0,1] neg_hi:[0,0,1]
v_cvt_pk_bf16_f32 v90, v8, v10
v_cvt_pk_bf16_f32 v91, v9, v11
v_mfma_f32_32x32x16_bf16 v[96:111], v[60:63], a[184:187], v[96:111]
v_pk_mul_f32 v[8:9], v[92:93], v[252:253]
v_pk_mul_f32 v[10:11], v[44:45], v[252:253]
v_pk_fma_f32 v[8:9], v[44:45], v[236:237], v[8:9]
v_pk_fma_f32 v[10:11], v[92:93], v[236:237], v[10:11] neg_lo:[0,0,1] neg_hi:[0,0,1]
v_cvt_pk_bf16_f32 v92, v8, v10
v_cvt_pk_bf16_f32 v93, v9, v11
v_mfma_f32_32x32x16_bf16 v[64:79], v[60:63], a[188:191], v[64:79]
v_pk_mul_f32 v[8:9], v[94:95], v[254:255]
v_pk_mul_f32 v[10:11], v[46:47], v[254:255]
v_pk_fma_f32 v[8:9], v[46:47], v[238:239], v[8:9]
v_pk_fma_f32 v[10:11], v[94:95], v[238:239], v[10:11] neg_lo:[0,0,1] neg_hi:[0,0,1]
v_cvt_pk_bf16_f32 v94, v8, v10
v_cvt_pk_bf16_f32 v95, v9, v11
v_mfma_f32_32x32x16_bf16 v[32:47], v[80:83], a[160:163], 0
s_waitcnt lgkmcnt(3)
v_pk_mul_f32 v[8:9], v[96:97], v[112:113]
s_nop 1
v_pk_mul_f32 v[10:11], v[64:65], v[112:113]
s_waitcnt lgkmcnt(2)
v_pk_fma_f32 v[8:9], v[64:65], v[116:117], v[8:9]
v_pk_fma_f32 v[10:11], v[96:97], v[116:117], v[10:11] neg_lo:[1,0,0] neg_hi:[1,0,0]
v_cvt_pk_bf16_f32 v96, v8, v10
v_cvt_pk_bf16_f32 v97, v9, v11
v_mfma_f32_32x32x16_bf16 v[48:63], v[80:83], a[164:167], 0
v_pk_mul_f32 v[8:9], v[98:99], v[114:115]
v_pk_mul_f32 v[10:11], v[66:67], v[114:115]
v_pk_fma_f32 v[8:9], v[66:67], v[118:119], v[8:9]
v_pk_fma_f32 v[10:11], v[98:99], v[118:119], v[10:11] neg_lo:[1,0,0] neg_hi:[1,0,0]
v_cvt_pk_bf16_f32 v98, v8, v10
v_cvt_pk_bf16_f32 v99, v9, v11
v_mfma_f32_32x32x16_bf16 v[32:47], v[84:87], a[168:171], v[32:47]
ds_read_b128 v[112:115], v0 offset:36864
ds_read_b128 v[116:119], v0 offset:37888
s_waitcnt lgkmcnt(3)
v_pk_mul_f32 v[8:9], v[100:101], v[120:121]
v_pk_mul_f32 v[10:11], v[68:69], v[120:121]
s_waitcnt lgkmcnt(2)
v_pk_fma_f32 v[8:9], v[68:69], v[124:125], v[8:9]
v_pk_fma_f32 v[10:11], v[100:101], v[124:125], v[10:11] neg_lo:[1,0,0] neg_hi:[1,0,0]
v_mfma_f32_32x32x16_bf16 v[48:63], v[84:87], a[172:175], v[48:63]
v_cvt_pk_bf16_f32 v100, v8, v10
v_cvt_pk_bf16_f32 v101, v9, v11
v_pk_mul_f32 v[8:9], v[102:103], v[122:123]
v_pk_mul_f32 v[10:11], v[70:71], v[122:123]
v_pk_fma_f32 v[8:9], v[70:71], v[126:127], v[8:9]
v_pk_fma_f32 v[10:11], v[102:103], v[126:127], v[10:11] neg_lo:[1,0,0] neg_hi:[1,0,0]
v_mfma_f32_32x32x16_bf16 v[32:47], v[88:91], a[176:179], v[32:47]
v_cvt_pk_bf16_f32 v102, v8, v10
v_cvt_pk_bf16_f32 v103, v9, v11
ds_read_b128 v[120:123], v0 offset:38912
ds_read_b128 v[124:127], v0 offset:39936
s_waitcnt lgkmcnt(3)
v_pk_mul_f32 v[8:9], v[104:105], v[112:113]
v_pk_mul_f32 v[10:11], v[72:73], v[112:113]
v_mfma_f32_32x32x16_bf16 v[48:63], v[88:91], a[180:183], v[48:63]
s_waitcnt lgkmcnt(2)
v_pk_fma_f32 v[8:9], v[72:73], v[116:117], v[8:9]
v_pk_fma_f32 v[10:11], v[104:105], v[116:117], v[10:11] neg_lo:[1,0,0] neg_hi:[1,0,0]
v_cvt_pk_bf16_f32 v104, v8, v10
v_cvt_pk_bf16_f32 v105, v9, v11
v_pk_mul_f32 v[8:9], v[106:107], v[114:115]
v_pk_mul_f32 v[10:11], v[74:75], v[114:115]
v_mfma_f32_32x32x16_bf16 v[32:47], v[92:95], a[184:187], v[32:47]
v_pk_fma_f32 v[8:9], v[74:75], v[118:119], v[8:9]
v_pk_fma_f32 v[10:11], v[106:107], v[118:119], v[10:11] neg_lo:[1,0,0] neg_hi:[1,0,0]
v_cvt_pk_bf16_f32 v106, v8, v10
v_cvt_pk_bf16_f32 v107, v9, v11
ds_read_b128 v[112:115], v0 offset:49152
ds_read_b128 v[116:119], v0 offset:50176
v_mfma_f32_32x32x16_bf16 v[48:63], v[92:95], a[188:191], v[48:63]
s_waitcnt lgkmcnt(3)
v_pk_mul_f32 v[8:9], v[108:109], v[120:121]
v_pk_mul_f32 v[10:11], v[76:77], v[120:121]
s_waitcnt lgkmcnt(2)
v_pk_fma_f32 v[8:9], v[76:77], v[124:125], v[8:9]
v_pk_fma_f32 v[10:11], v[108:109], v[124:125], v[10:11] neg_lo:[1,0,0] neg_hi:[1,0,0]
v_cvt_pk_bf16_f32 v108, v8, v10
v_cvt_pk_bf16_f32 v109, v9, v11
v_pk_mul_f32 v[8:9], v[110:111], v[122:123]
v_pk_mul_f32 v[10:11], v[78:79], v[122:123]
v_pk_fma_f32 v[8:9], v[78:79], v[126:127], v[8:9]
v_pk_fma_f32 v[10:11], v[110:111], v[126:127], v[10:11] neg_lo:[1,0,0] neg_hi:[1,0,0]
v_cvt_pk_bf16_f32 v110, v8, v10
v_cvt_pk_bf16_f32 v111, v9, v11
ds_read_b128 v[120:123], v0 offset:51200
ds_read_b128 v[124:127], v0 offset:52224
ds_read_b128 v[80:83], v26 offset:0
ds_read_b128 v[84:87], v0 offset:1024
ds_read_b128 v[88:91], v26 offset:2048
ds_read_b128 v[92:95], v0 offset:3072
ds_read_b128 v[64:67], v26 offset:4096
ds_read_b128 v[68:71], v0 offset:5120
s_lshl_b32 s52, s3, 10
v_add_u32 v20, s52, v0
v_add_u32 v20, 65536, v20
s_waitcnt lgkmcnt(5)
v_mfma_f32_32x32x16_bf16 v[128:143], v[80:83], v[96:99], v[128:143]
ds_read_b128 v[72:75], v26 offset:6144
v_pk_mul_f32 v[8:9], v[32:33], v[112:113]
v_pk_mul_f32 v[10:11], v[48:49], v[112:113]
v_pk_fma_f32 v[8:9], v[48:49], v[116:117], v[8:9]
v_pk_fma_f32 v[10:11], v[32:33], v[116:117], v[10:11] neg_lo:[1,0,0] neg_hi:[1,0,0]
v_cvt_pk_bf16_f32 v32, v8, v10
v_cvt_pk_bf16_f32 v33, v9, v11
s_waitcnt lgkmcnt(5)
v_mfma_f32_32x32x16_bf16 v[144:159], v[84:87], v[96:99], v[144:159]
ds_read_b128 v[76:79], v0 offset:7168
v_pk_mul_f32 v[8:9], v[34:35], v[114:115]
v_pk_mul_f32 v[10:11], v[50:51], v[114:115]
v_pk_fma_f32 v[8:9], v[50:51], v[118:119], v[8:9]
v_pk_fma_f32 v[10:11], v[34:35], v[118:119], v[10:11] neg_lo:[1,0,0] neg_hi:[1,0,0]
v_cvt_pk_bf16_f32 v34, v8, v10
v_cvt_pk_bf16_f32 v35, v9, v11
s_waitcnt lgkmcnt(5)
v_mfma_f32_32x32x16_bf16 v[160:175], v[88:91], v[96:99], v[160:175]
ds_read_b128 v[80:83], v26 offset:8192
ds_read_b128 v[112:115], v0 offset:53248
ds_read_b128 v[116:119], v0 offset:54272
v_pk_mul_f32 v[8:9], v[36:37], v[120:121]
v_pk_mul_f32 v[10:11], v[52:53], v[120:121]
v_pk_fma_f32 v[8:9], v[52:53], v[124:125], v[8:9]
v_pk_fma_f32 v[10:11], v[36:37], v[124:125], v[10:11] neg_lo:[1,0,0] neg_hi:[1,0,0]
s_waitcnt lgkmcnt(7)
v_mfma_f32_32x32x16_bf16 v[176:191], v[92:95], v[96:99], v[176:191]
ds_read_b128 v[84:87], v0 offset:9216
v_cvt_pk_bf16_f32 v36, v8, v10
v_cvt_pk_bf16_f32 v37, v9, v11
v_pk_mul_f32 v[8:9], v[38:39], v[122:123]
v_pk_mul_f32 v[10:11], v[54:55], v[122:123]
v_pk_fma_f32 v[8:9], v[54:55], v[126:127], v[8:9]
v_pk_fma_f32 v[10:11], v[38:39], v[126:127], v[10:11] neg_lo:[1,0,0] neg_hi:[1,0,0]
s_waitcnt lgkmcnt(7)
v_mfma_f32_32x32x16_bf16 v[128:143], v[64:67], v[100:103], v[128:143]
ds_read_b128 v[88:91], v26 offset:10240
v_cvt_pk_bf16_f32 v38, v8, v10
v_cvt_pk_bf16_f32 v39, v9, v11
ds_read_b128 v[120:123], v0 offset:55296
ds_read_b128 v[124:127], v0 offset:56320
s_waitcnt lgkmcnt(5)
v_pk_mul_f32 v[8:9], v[40:41], v[112:113]
v_pk_mul_f32 v[10:11], v[56:57], v[112:113]
v_mfma_f32_32x32x16_bf16 v[144:159], v[68:71], v[100:103], v[144:159]
ds_read_b128 v[92:95], v0 offset:11264
s_waitcnt lgkmcnt(5)
v_pk_fma_f32 v[8:9], v[56:57], v[116:117], v[8:9]
v_pk_fma_f32 v[10:11], v[40:41], v[116:117], v[10:11] neg_lo:[1,0,0] neg_hi:[1,0,0]
v_cvt_pk_bf16_f32 v40, v8, v10
v_cvt_pk_bf16_f32 v41, v9, v11
v_pk_mul_f32 v[8:9], v[42:43], v[114:115]
v_pk_mul_f32 v[10:11], v[58:59], v[114:115]
v_mfma_f32_32x32x16_bf16 v[160:175], v[72:75], v[100:103], v[160:175]
ds_read_b128 v[64:67], v26 offset:12288
v_pk_fma_f32 v[8:9], v[58:59], v[118:119], v[8:9]
v_pk_fma_f32 v[10:11], v[42:43], v[118:119], v[10:11] neg_lo:[1,0,0] neg_hi:[1,0,0]
v_cvt_pk_bf16_f32 v42, v8, v10
v_cvt_pk_bf16_f32 v43, v9, v11
s_waitcnt lgkmcnt(3)
v_pk_mul_f32 v[8:9], v[44:45], v[120:121]
v_pk_mul_f32 v[10:11], v[60:61], v[120:121]
v_mfma_f32_32x32x16_bf16 v[176:191], v[76:79], v[100:103], v[176:191]
ds_read_b128 v[68:71], v0 offset:13312
s_waitcnt lgkmcnt(3)
v_pk_fma_f32 v[8:9], v[60:61], v[124:125], v[8:9]
v_pk_fma_f32 v[10:11], v[44:45], v[124:125], v[10:11] neg_lo:[1,0,0] neg_hi:[1,0,0]
v_cvt_pk_bf16_f32 v44, v8, v10
v_cvt_pk_bf16_f32 v45, v9, v11
v_pk_mul_f32 v[8:9], v[46:47], v[122:123]
v_pk_mul_f32 v[10:11], v[62:63], v[122:123]
v_mfma_f32_32x32x16_bf16 v[128:143], v[80:83], v[104:107], v[128:143]
ds_read_b128 v[72:75], v26 offset:14336
v_pk_fma_f32 v[8:9], v[62:63], v[126:127], v[8:9]
v_pk_fma_f32 v[10:11], v[46:47], v[126:127], v[10:11] neg_lo:[1,0,0] neg_hi:[1,0,0]
v_cvt_pk_bf16_f32 v46, v8, v10
v_cvt_pk_bf16_f32 v47, v9, v11
v_mfma_f32_32x32x16_bf16 v[144:159], v[84:87], v[104:107], v[144:159]
ds_read_b128 v[76:79], v0 offset:15360
v_mfma_f32_32x32x16_bf16 v[160:175], v[88:91], v[104:107], v[160:175]
ds_read_b128 v[80:83], v26 offset:16384
s_waitcnt lgkmcnt(5)
v_mfma_f32_32x32x16_bf16 v[176:191], v[92:95], v[104:107], v[176:191]
ds_read_b128 v[84:87], v0 offset:17408
s_waitcnt lgkmcnt(5)
v_mfma_f32_32x32x16_bf16 v[128:143], v[64:67], v[108:111], v[128:143]
ds_read_b128 v[88:91], v26 offset:20480
s_waitcnt lgkmcnt(5)
v_mfma_f32_32x32x16_bf16 v[144:159], v[68:71], v[108:111], v[144:159]
ds_read_b128 v[92:95], v0 offset:21504
s_waitcnt lgkmcnt(5)
v_mfma_f32_32x32x16_bf16 v[160:175], v[72:75], v[108:111], v[160:175]
ds_read_b128 v[64:67], v26 offset:24576
s_waitcnt lgkmcnt(5)
v_mfma_f32_32x32x16_bf16 v[176:191], v[76:79], v[108:111], v[176:191]
ds_read_b128 v[68:71], v0 offset:25600
s_waitcnt lgkmcnt(5)
v_mfma_f32_32x32x16_bf16 v[128:143], v[80:83], v[32:35], v[128:143]
ds_read_b128 v[72:75], v26 offset:28672
s_waitcnt lgkmcnt(5)
v_mfma_f32_32x32x16_bf16 v[144:159], v[84:87], v[32:35], v[144:159]
ds_read_b128 v[76:79], v0 offset:29696
s_waitcnt lgkmcnt(5)
v_mfma_f32_32x32x16_bf16 v[128:143], v[88:91], v[36:39], v[128:143]
ds_read_b128 v[80:83], v26 offset:18432
s_waitcnt lgkmcnt(5)
v_mfma_f32_32x32x16_bf16 v[144:159], v[92:95], v[36:39], v[144:159]
ds_read_b128 v[84:87], v0 offset:19456
s_waitcnt lgkmcnt(5)
v_mfma_f32_32x32x16_bf16 v[128:143], v[64:67], v[40:43], v[128:143]
ds_read_b128 v[88:91], v26 offset:22528
s_waitcnt lgkmcnt(5)
v_mfma_f32_32x32x16_bf16 v[144:159], v[68:71], v[40:43], v[144:159]
ds_read_b128 v[92:95], v0 offset:23552
s_waitcnt lgkmcnt(5)
v_mfma_f32_32x32x16_bf16 v[128:143], v[72:75], v[44:47], v[128:143]
ds_read_b128 v[64:67], v26 offset:26624
s_waitcnt lgkmcnt(5)
v_mfma_f32_32x32x16_bf16 v[144:159], v[76:79], v[44:47], v[144:159]
ds_read_b128 v[68:71], v0 offset:27648
s_waitcnt lgkmcnt(5)
v_mfma_f32_32x32x16_bf16 v[160:175], v[80:83], v[32:35], v[160:175]
ds_read_b128 v[72:75], v26 offset:30720
s_waitcnt lgkmcnt(5)
v_mfma_f32_32x32x16_bf16 v[176:191], v[84:87], v[32:35], v[176:191]
ds_read_b128 v[76:79], v0 offset:31744
v_cvt_pk_bf16_f32 v128, v144, v128
v_cvt_pk_bf16_f32 v129, v145, v129
v_cvt_pk_bf16_f32 v130, v146, v130
v_cvt_pk_bf16_f32 v131, v147, v131
ds_write_b128 v20, v[128:131] offset:0
v_cvt_pk_bf16_f32 v132, v148, v132
s_waitcnt lgkmcnt(6)
v_mfma_f32_32x32x16_bf16 v[160:175], v[88:91], v[36:39], v[160:175]
v_cvt_pk_bf16_f32 v133, v149, v133
v_cvt_pk_bf16_f32 v134, v150, v134
v_cvt_pk_bf16_f32 v135, v151, v135
ds_write_b128 v20, v[132:135] offset:4096
v_cvt_pk_bf16_f32 v136, v152, v136
v_cvt_pk_bf16_f32 v137, v153, v137
s_waitcnt lgkmcnt(6)
v_mfma_f32_32x32x16_bf16 v[176:191], v[92:95], v[36:39], v[176:191]
v_cvt_pk_bf16_f32 v138, v154, v138
v_cvt_pk_bf16_f32 v139, v155, v139
ds_write_b128 v20, v[136:139] offset:8192
v_cvt_pk_bf16_f32 v140, v156, v140
v_cvt_pk_bf16_f32 v141, v157, v141
v_cvt_pk_bf16_f32 v142, v158, v142
s_waitcnt lgkmcnt(6)
v_mfma_f32_32x32x16_bf16 v[160:175], v[64:67], v[40:43], v[160:175]
v_cvt_pk_bf16_f32 v143, v159, v143
ds_write_b128 v20, v[140:143] offset:12288
s_waitcnt lgkmcnt(6)
v_mfma_f32_32x32x16_bf16 v[176:191], v[68:71], v[40:43], v[176:191]
s_waitcnt lgkmcnt(5)
v_mfma_f32_32x32x16_bf16 v[160:175], v[72:75], v[44:47], v[160:175]
s_waitcnt lgkmcnt(4)
v_mfma_f32_32x32x16_bf16 v[176:191], v[76:79], v[44:47], v[176:191]
s_nop 11
v_cvt_pk_bf16_f32 v160, v176, v160
v_cvt_pk_bf16_f32 v161, v177, v161
v_cvt_pk_bf16_f32 v162, v178, v162
v_cvt_pk_bf16_f32 v163, v179, v163
ds_write_b128 v20, v[160:163] offset:16384
v_cvt_pk_bf16_f32 v164, v180, v164
v_cvt_pk_bf16_f32 v165, v181, v165
v_cvt_pk_bf16_f32 v166, v182, v166
v_cvt_pk_bf16_f32 v167, v183, v167
ds_write_b128 v20, v[164:167] offset:20480
v_cvt_pk_bf16_f32 v168, v184, v168
v_cvt_pk_bf16_f32 v169, v185, v169
v_cvt_pk_bf16_f32 v170, v186, v170
v_cvt_pk_bf16_f32 v171, v187, v171
ds_write_b128 v20, v[168:171] offset:24576
v_cvt_pk_bf16_f32 v172, v188, v172
v_cvt_pk_bf16_f32 v173, v189, v173
v_cvt_pk_bf16_f32 v174, v190, v174
v_cvt_pk_bf16_f32 v175, v191, v175
ds_write_b128 v20, v[172:175] offset:28672
s_lshl_b32 s52, s3, 12
s_add_u32 s52, s52, 65536
v_add_u32 v20, s52, v0
s_waitcnt lgkmcnt(0)
s_barrier
ds_read_b128 v[32:35], v20 offset:0
ds_read_b128 v[36:39], v20 offset:1024
ds_read_b128 v[40:43], v20 offset:2048
ds_read_b128 v[44:47], v20 offset:3072
ds_read_b128 v[48:51], v20 offset:16384
ds_read_b128 v[52:55], v20 offset:17408
ds_read_b128 v[56:59], v20 offset:18432
ds_read_b128 v[60:63], v20 offset:19456
s_waitcnt lgkmcnt(6)
v_swap_b32 v33, v36
s_waitcnt lgkmcnt(5)
v_swap_b32 v34, v40
s_waitcnt lgkmcnt(4)
v_swap_b32 v35, v44
buffer_store_dwordx4 v[32:35], v25, s[4:7], s48 offen sc1
s_add_u32 s48, s48, 40960
v_swap_b32 v38, v41
v_swap_b32 v39, v45
buffer_store_dwordx4 v[36:39], v25, s[4:7], s48 offen sc1
s_add_u32 s48, s48, 40960
v_swap_b32 v43, v46
buffer_store_dwordx4 v[40:43], v25, s[4:7], s48 offen sc1
s_add_u32 s48, s48, 40960
buffer_store_dwordx4 v[44:47], v25, s[4:7], s48 offen sc1
s_add_u32 s48, s48, 1187840
s_waitcnt lgkmcnt(2)
v_swap_b32 v49, v52
s_waitcnt lgkmcnt(1)
v_swap_b32 v50, v56
s_waitcnt lgkmcnt(0)
v_swap_b32 v51, v60
buffer_store_dwordx4 v[48:51], v25, s[4:7], s48 offen sc1
s_add_u32 s48, s48, 40960
v_swap_b32 v54, v57
v_swap_b32 v55, v61
buffer_store_dwordx4 v[52:55], v25, s[4:7], s48 offen sc1
s_add_u32 s48, s48, 40960
v_swap_b32 v59, v62
buffer_store_dwordx4 v[56:59], v25, s[4:7], s48 offen sc1
s_add_u32 s48, s48, 40960
buffer_store_dwordx4 v[60:63], v25, s[4:7], s48 offen sc1
s_add_u32 s48, s48, 1187840
s_lshl_b32 s54, s51, 13
s_lshl_b32 s52, s30, 6
s_add_u32 s54, s54, s52
s_add_u32 s54, s54, 222306304
s_waitcnt vmcnt(0)
s_barrier
s_cmp_lg_u32 s3, 0
s_cbranch_scc1 k_s8_97
s_mov_b64 exec, 1
v_mov_b32 v8, 1
buffer_store_dword v8, off, s[4:7], s54 sc1
s_mov_b64 exec, -1
k_s8_97:
k_fend_45:
s_add_u32 s51, s51, 1
s_cmp_lt_u32 s51, 2
s_cbranch_scc1 k_lay_32
s_add_u32 s30, s30, 64
s_cmp_ge_u32 s30, 144
s_cbranch_scc1 k_fin_7
s_endpgm
k_o_4:
s_load_dwordx2 s[36:37], s[0:1], 0
s_mov_b32 s38, 2621440
s_mov_b32 s39, 0x20000
s_mul_i32 s57, s30, 52429
s_lshr_b32 s57, s57, 18
s_mul_i32 s52, s57, 5
s_sub_u32 s58, s30, s52
s_lshl_b32 s58, s58, 2
s_add_u32 s58, s58, s3
s_mul_i32 s52, s30, 40960
s_mul_i32 s53, s3, 320
s_add_u32 s53, s53, s52
v_bfe_u32 v8, v0, 4, 5
v_mul_u32_u24 v9, 1280, v8
v_lshrrev_b32 v10, 9, v0
v_lshl_add_u32 v9, v10, 4, v9
v_add_u32 v9, s53, v9
s_mul_i32 s56, s3, 10240
s_add_u32 s56, s56, s52
s_add_u32 s56, s56, 83886080
s_waitcnt lgkmcnt(0)
buffer_load_dwordx4 v[100:103], v9, s[36:39], 0 offen offset:0
buffer_load_dwordx4 v[104:107], v9, s[36:39], 0 offen offset:32
buffer_load_dwordx4 v[108:111], v9, s[36:39], 0 offen offset:64
buffer_load_dwordx4 v[112:115], v9, s[36:39], 0 offen offset:96
buffer_load_dwordx4 v[116:119], v9, s[36:39], 0 offen offset:128
buffer_load_dwordx4 v[120:123], v9, s[36:39], 0 offen offset:160
buffer_load_dwordx4 v[124:127], v9, s[36:39], 0 offen offset:192
buffer_load_dwordx4 v[128:131], v9, s[36:39], 0 offen offset:224
buffer_load_dwordx4 v[132:135], v9, s[36:39], 0 offen offset:256
buffer_load_dwordx4 v[136:139], v9, s[36:39], 0 offen offset:288
v_mov_b64 v[4:5], -1
v_mov_b64 v[6:7], -1
s_lshl_b32 s52, s30, 2
s_add_u32 s52, s52, s3
s_lshl_b32 s53, s52, 13
s_lshl_b32 s52, s52, 9
v_lshrrev_b32 v2, 1, v0
s_add_u32 s54, s52, 211812352
buffer_store_dwordx2 v[4:5], v2, s[4:7], s54 offen sc1
s_add_u32 s54, s53, 205520896
buffer_store_dwordx4 v[4:7], v0, s[4:7], s54 offen offset:0 sc1
buffer_store_dwordx4 v[4:7], v0, s[4:7], s54 offen offset:1024 sc1
buffer_store_dwordx4 v[4:7], v0, s[4:7], s54 offen offset:2048 sc1
buffer_store_dwordx4 v[4:7], v0, s[4:7], s54 offen offset:3072 sc1
s_add_u32 s54, s53, 205524992
buffer_store_dwordx4 v[4:7], v0, s[4:7], s54 offen offset:0 sc1
buffer_store_dwordx4 v[4:7], v0, s[4:7], s54 offen offset:1024 sc1
buffer_store_dwordx4 v[4:7], v0, s[4:7], s54 offen offset:2048 sc1
buffer_store_dwordx4 v[4:7], v0, s[4:7], s54 offen offset:3072 sc1
s_add_u32 s54, s52, 212860928
buffer_store_dwordx2 v[4:5], v2, s[4:7], s54 offen sc1
s_add_u32 s54, s53, 208666624
buffer_store_dwordx4 v[4:7], v0, s[4:7], s54 offen offset:0 sc1
buffer_store_dwordx4 v[4:7], v0, s[4:7], s54 offen offset:1024 sc1
buffer_store_dwordx4 v[4:7], v0, s[4:7], s54 offen offset:2048 sc1
buffer_store_dwordx4 v[4:7], v0, s[4:7], s54 offen offset:3072 sc1
s_add_u32 s54, s53, 208670720
buffer_store_dwordx4 v[4:7], v0, s[4:7], s54 offen offset:0 sc1
buffer_store_dwordx4 v[4:7], v0, s[4:7], s54 offen offset:1024 sc1
buffer_store_dwordx4 v[4:7], v0, s[4:7], s54 offen offset:2048 sc1
buffer_store_dwordx4 v[4:7], v0, s[4:7], s54 offen offset:3072 sc1
v_mov_b32 v11, 0x3f803f80
v_mov_b32 v12, 0
v_lshlrev_b32 v8, 5, v8
s_lshl_b32 s52, s3, 3
v_lshl_add_u32 v10, v10, 2, v8
v_add_u32 v10, s52, v10
s_waitcnt vmcnt(27)
v_dot2c_f32_bf16 v12, v100, v11
v_dot2c_f32_bf16 v12, v101, v11
v_dot2c_f32_bf16 v12, v102, v11
v_dot2c_f32_bf16 v12, v103, v11
s_waitcnt vmcnt(26)
v_dot2c_f32_bf16 v12, v104, v11
v_dot2c_f32_bf16 v12, v105, v11
v_dot2c_f32_bf16 v12, v106, v11
v_dot2c_f32_bf16 v12, v107, v11
s_waitcnt vmcnt(25)
v_dot2c_f32_bf16 v12, v108, v11
v_dot2c_f32_bf16 v12, v109, v11
v_dot2c_f32_bf16 v12, v110, v11
v_dot2c_f32_bf16 v12, v111, v11
s_waitcnt vmcnt(24)
v_dot2c_f32_bf16 v12, v112, v11
v_dot2c_f32_bf16 v12, v113, v11
v_dot2c_f32_bf16 v12, v114, v11
v_dot2c_f32_bf16 v12, v115, v11
s_waitcnt vmcnt(23)
v_dot2c_f32_bf16 v12, v116, v11
v_dot2c_f32_bf16 v12, v117, v11
v_dot2c_f32_bf16 v12, v118, v11
v_dot2c_f32_bf16 v12, v119, v11
s_waitcnt vmcnt(22)
v_dot2c_f32_bf16 v12, v120, v11
v_dot2c_f32_bf16 v12, v121, v11
v_dot2c_f32_bf16 v12, v122, v11
v_dot2c_f32_bf16 v12, v123, v11
s_waitcnt vmcnt(21)
v_dot2c_f32_bf16 v12, v124, v11
v_dot2c_f32_bf16 v12, v125, v11
v_dot2c_f32_bf16 v12, v126, v11
v_dot2c_f32_bf16 v12, v127, v11
s_waitcnt vmcnt(20)
v_dot2c_f32_bf16 v12, v128, v11
v_dot2c_f32_bf16 v12, v129, v11
v_dot2c_f32_bf16 v12, v130, v11
v_dot2c_f32_bf16 v12, v131, v11
s_waitcnt vmcnt(19)
v_dot2c_f32_bf16 v12, v132, v11
v_dot2c_f32_bf16 v12, v133, v11
v_dot2c_f32_bf16 v12, v134, v11
v_dot2c_f32_bf16 v12, v135, v11
s_waitcnt vmcnt(18)
v_dot2c_f32_bf16 v12, v136, v11
v_dot2c_f32_bf16 v12, v137, v11
v_dot2c_f32_bf16 v12, v138, v11
v_dot2c_f32_bf16 v12, v139, v11
s_nop 2
ds_write_b32 v10, v12
s_waitcnt lgkmcnt(0)
s_barrier
ds_read_b128 v[12:15], v8
ds_read_b128 v[16:19], v8 offset:16
s_waitcnt lgkmcnt(1)
v_add_f32 v12, v12, v13
v_add_f32 v12, v12, v14
v_add_f32 v12, v12, v15
s_waitcnt lgkmcnt(0)
v_add_f32 v12, v12, v16
v_add_f32 v12, v12, v17
v_add_f32 v12, v12, v18
v_add_f32 v12, v12, v19
v_mul_f32 v12, 0x3acccccd, v12
v_lshlrev_b32 v14, 16, v100
v_and_b32 v15, 0xffff0000, v100
v_sub_f32 v14, v14, v12
v_sub_f32 v15, v15, v12
v_cvt_pk_bf16_f32 v100, v14, v15
v_lshlrev_b32 v14, 16, v101
v_and_b32 v15, 0xffff0000, v101
v_sub_f32 v14, v14, v12
v_sub_f32 v15, v15, v12
v_cvt_pk_bf16_f32 v101, v14, v15
v_lshlrev_b32 v14, 16, v102
v_and_b32 v15, 0xffff0000, v102
v_sub_f32 v14, v14, v12
v_sub_f32 v15, v15, v12
v_cvt_pk_bf16_f32 v102, v14, v15
v_lshlrev_b32 v14, 16, v103
v_and_b32 v15, 0xffff0000, v103
v_sub_f32 v14, v14, v12
v_sub_f32 v15, v15, v12
v_cvt_pk_bf16_f32 v103, v14, v15
buffer_store_dwordx4 v[100:103], v0, s[4:7], s56 offen offset:0 sc1
v_lshlrev_b32 v14, 16, v104
v_and_b32 v15, 0xffff0000, v104
v_sub_f32 v14, v14, v12
v_sub_f32 v15, v15, v12
v_cvt_pk_bf16_f32 v104, v14, v15
v_lshlrev_b32 v14, 16, v105
v_and_b32 v15, 0xffff0000, v105
v_sub_f32 v14, v14, v12
v_sub_f32 v15, v15, v12
v_cvt_pk_bf16_f32 v105, v14, v15
v_lshlrev_b32 v14, 16, v106
v_and_b32 v15, 0xffff0000, v106
v_sub_f32 v14, v14, v12
v_sub_f32 v15, v15, v12
v_cvt_pk_bf16_f32 v106, v14, v15
v_lshlrev_b32 v14, 16, v107
v_and_b32 v15, 0xffff0000, v107
v_sub_f32 v14, v14, v12
v_sub_f32 v15, v15, v12
v_cvt_pk_bf16_f32 v107, v14, v15
buffer_store_dwordx4 v[104:107], v0, s[4:7], s56 offen offset:1024 sc1
v_lshlrev_b32 v14, 16, v108
v_and_b32 v15, 0xffff0000, v108
v_sub_f32 v14, v14, v12
v_sub_f32 v15, v15, v12
v_cvt_pk_bf16_f32 v108, v14, v15
v_lshlrev_b32 v14, 16, v109
v_and_b32 v15, 0xffff0000, v109
v_sub_f32 v14, v14, v12
v_sub_f32 v15, v15, v12
v_cvt_pk_bf16_f32 v109, v14, v15
v_lshlrev_b32 v14, 16, v110
v_and_b32 v15, 0xffff0000, v110
v_sub_f32 v14, v14, v12
v_sub_f32 v15, v15, v12
v_cvt_pk_bf16_f32 v110, v14, v15
v_lshlrev_b32 v14, 16, v111
v_and_b32 v15, 0xffff0000, v111
v_sub_f32 v14, v14, v12
v_sub_f32 v15, v15, v12
v_cvt_pk_bf16_f32 v111, v14, v15
buffer_store_dwordx4 v[108:111], v0, s[4:7], s56 offen offset:2048 sc1
v_lshlrev_b32 v14, 16, v112
v_and_b32 v15, 0xffff0000, v112
v_sub_f32 v14, v14, v12
v_sub_f32 v15, v15, v12
v_cvt_pk_bf16_f32 v112, v14, v15
v_lshlrev_b32 v14, 16, v113
v_and_b32 v15, 0xffff0000, v113
v_sub_f32 v14, v14, v12
v_sub_f32 v15, v15, v12
v_cvt_pk_bf16_f32 v113, v14, v15
v_lshlrev_b32 v14, 16, v114
v_and_b32 v15, 0xffff0000, v114
v_sub_f32 v14, v14, v12
v_sub_f32 v15, v15, v12
v_cvt_pk_bf16_f32 v114, v14, v15
v_lshlrev_b32 v14, 16, v115
v_and_b32 v15, 0xffff0000, v115
v_sub_f32 v14, v14, v12
v_sub_f32 v15, v15, v12
v_cvt_pk_bf16_f32 v115, v14, v15
buffer_store_dwordx4 v[112:115], v0, s[4:7], s56 offen offset:3072 sc1
s_add_u32 s56, s56, 4096
v_lshlrev_b32 v14, 16, v116
v_and_b32 v15, 0xffff0000, v116
v_sub_f32 v14, v14, v12
v_sub_f32 v15, v15, v12
v_cvt_pk_bf16_f32 v116, v14, v15
v_lshlrev_b32 v14, 16, v117
v_and_b32 v15, 0xffff0000, v117
v_sub_f32 v14, v14, v12
v_sub_f32 v15, v15, v12
v_cvt_pk_bf16_f32 v117, v14, v15
v_lshlrev_b32 v14, 16, v118
v_and_b32 v15, 0xffff0000, v118
v_sub_f32 v14, v14, v12
v_sub_f32 v15, v15, v12
v_cvt_pk_bf16_f32 v118, v14, v15
v_lshlrev_b32 v14, 16, v119
v_and_b32 v15, 0xffff0000, v119
v_sub_f32 v14, v14, v12
v_sub_f32 v15, v15, v12
v_cvt_pk_bf16_f32 v119, v14, v15
buffer_store_dwordx4 v[116:119], v0, s[4:7], s56 offen offset:0 sc1
v_lshlrev_b32 v14, 16, v120
v_and_b32 v15, 0xffff0000, v120
v_sub_f32 v14, v14, v12
v_sub_f32 v15, v15, v12
v_cvt_pk_bf16_f32 v120, v14, v15
v_lshlrev_b32 v14, 16, v121
v_and_b32 v15, 0xffff0000, v121
v_sub_f32 v14, v14, v12
v_sub_f32 v15, v15, v12
v_cvt_pk_bf16_f32 v121, v14, v15
v_lshlrev_b32 v14, 16, v122
v_and_b32 v15, 0xffff0000, v122
v_sub_f32 v14, v14, v12
v_sub_f32 v15, v15, v12
v_cvt_pk_bf16_f32 v122, v14, v15
v_lshlrev_b32 v14, 16, v123
v_and_b32 v15, 0xffff0000, v123
v_sub_f32 v14, v14, v12
v_sub_f32 v15, v15, v12
v_cvt_pk_bf16_f32 v123, v14, v15
buffer_store_dwordx4 v[120:123], v0, s[4:7], s56 offen offset:1024 sc1
v_lshlrev_b32 v14, 16, v124
v_and_b32 v15, 0xffff0000, v124
v_sub_f32 v14, v14, v12
v_sub_f32 v15, v15, v12
v_cvt_pk_bf16_f32 v124, v14, v15
v_lshlrev_b32 v14, 16, v125
v_and_b32 v15, 0xffff0000, v125
v_sub_f32 v14, v14, v12
v_sub_f32 v15, v15, v12
v_cvt_pk_bf16_f32 v125, v14, v15
v_lshlrev_b32 v14, 16, v126
v_and_b32 v15, 0xffff0000, v126
v_sub_f32 v14, v14, v12
v_sub_f32 v15, v15, v12
v_cvt_pk_bf16_f32 v126, v14, v15
v_lshlrev_b32 v14, 16, v127
v_and_b32 v15, 0xffff0000, v127
v_sub_f32 v14, v14, v12
v_sub_f32 v15, v15, v12
v_cvt_pk_bf16_f32 v127, v14, v15
buffer_store_dwordx4 v[124:127], v0, s[4:7], s56 offen offset:2048 sc1
v_lshlrev_b32 v14, 16, v128
v_and_b32 v15, 0xffff0000, v128
v_sub_f32 v14, v14, v12
v_sub_f32 v15, v15, v12
v_cvt_pk_bf16_f32 v128, v14, v15
v_lshlrev_b32 v14, 16, v129
v_and_b32 v15, 0xffff0000, v129
v_sub_f32 v14, v14, v12
v_sub_f32 v15, v15, v12
v_cvt_pk_bf16_f32 v129, v14, v15
v_lshlrev_b32 v14, 16, v130
v_and_b32 v15, 0xffff0000, v130
v_sub_f32 v14, v14, v12
v_sub_f32 v15, v15, v12
v_cvt_pk_bf16_f32 v130, v14, v15
v_lshlrev_b32 v14, 16, v131
v_and_b32 v15, 0xffff0000, v131
v_sub_f32 v14, v14, v12
v_sub_f32 v15, v15, v12
v_cvt_pk_bf16_f32 v131, v14, v15
buffer_store_dwordx4 v[128:131], v0, s[4:7], s56 offen offset:3072 sc1
s_add_u32 s56, s56, 4096
v_lshlrev_b32 v14, 16, v132
v_and_b32 v15, 0xffff0000, v132
v_sub_f32 v14, v14, v12
v_sub_f32 v15, v15, v12
v_cvt_pk_bf16_f32 v132, v14, v15
v_lshlrev_b32 v14, 16, v133
v_and_b32 v15, 0xffff0000, v133
v_sub_f32 v14, v14, v12
v_sub_f32 v15, v15, v12
v_cvt_pk_bf16_f32 v133, v14, v15
v_lshlrev_b32 v14, 16, v134
v_and_b32 v15, 0xffff0000, v134
v_sub_f32 v14, v14, v12
v_sub_f32 v15, v15, v12
v_cvt_pk_bf16_f32 v134, v14, v15
v_lshlrev_b32 v14, 16, v135
v_and_b32 v15, 0xffff0000, v135
v_sub_f32 v14, v14, v12
v_sub_f32 v15, v15, v12
v_cvt_pk_bf16_f32 v135, v14, v15
buffer_store_dwordx4 v[132:135], v0, s[4:7], s56 offen offset:0 sc1
v_lshlrev_b32 v14, 16, v136
v_and_b32 v15, 0xffff0000, v136
v_sub_f32 v14, v14, v12
v_sub_f32 v15, v15, v12
v_cvt_pk_bf16_f32 v136, v14, v15
v_lshlrev_b32 v14, 16, v137
v_and_b32 v15, 0xffff0000, v137
v_sub_f32 v14, v14, v12
v_sub_f32 v15, v15, v12
v_cvt_pk_bf16_f32 v137, v14, v15
v_lshlrev_b32 v14, 16, v138
v_and_b32 v15, 0xffff0000, v138
v_sub_f32 v14, v14, v12
v_sub_f32 v15, v15, v12
v_cvt_pk_bf16_f32 v138, v14, v15
v_lshlrev_b32 v14, 16, v139
v_and_b32 v15, 0xffff0000, v139
v_sub_f32 v14, v14, v12
v_sub_f32 v15, v15, v12
v_cvt_pk_bf16_f32 v139, v14, v15
buffer_store_dwordx4 v[136:139], v0, s[4:7], s56 offen offset:1024 sc1
s_waitcnt vmcnt(0)
s_barrier
s_cmp_lg_u32 s3, 0
s_cbranch_scc1 k_sd_98
s_mov_b64 exec, 1
v_mov_b32 v2, 64
v_mov_b32 v3, 1
global_atomic_add v2, v3, s[28:29] sc1
s_mov_b64 exec, -1
k_sd_98:
s_mul_i32 s52, s3, 640
v_lshrrev_b32 v8, 4, v0
v_add_u32 v8, s52, v8
s_mov_b32 s53, 52429
v_add_u32 v9, 0, v8
v_mul_u32_u24 v10, s53, v9
v_lshrrev_b32 v10, 22, v10
v_mul_u32_u24 v11, 80, v10
v_sub_u32 v9, v9, v11
v_and_b32 v11, 15, v10
v_xor_b32 v9, v9, v11
v_mul_u32_u24 v10, 1280, v10
v_lshl_add_u32 v72, v9, 4, v10
v_add_u32 v9, 64, v8
v_mul_u32_u24 v10, s53, v9
v_lshrrev_b32 v10, 22, v10
v_mul_u32_u24 v11, 80, v10
v_sub_u32 v9, v9, v11
v_and_b32 v11, 15, v10
v_xor_b32 v9, v9, v11
v_mul_u32_u24 v10, 1280, v10
v_lshl_add_u32 v73, v9, 4, v10
v_add_u32 v9, 128, v8
v_mul_u32_u24 v10, s53, v9
v_lshrrev_b32 v10, 22, v10
v_mul_u32_u24 v11, 80, v10
v_sub_u32 v9, v9, v11
v_and_b32 v11, 15, v10
v_xor_b32 v9, v9, v11
v_mul_u32_u24 v10, 1280, v10
v_lshl_add_u32 v74, v9, 4, v10
v_add_u32 v9, 192, v8
v_mul_u32_u24 v10, s53, v9
v_lshrrev_b32 v10, 22, v10
v_mul_u32_u24 v11, 80, v10
v_sub_u32 v9, v9, v11
v_and_b32 v11, 15, v10
v_xor_b32 v9, v9, v11
v_mul_u32_u24 v10, 1280, v10
v_lshl_add_u32 v75, v9, 4, v10
v_add_u32 v9, 256, v8
v_mul_u32_u24 v10, s53, v9
v_lshrrev_b32 v10, 22, v10
v_mul_u32_u24 v11, 80, v10
v_sub_u32 v9, v9, v11
v_and_b32 v11, 15, v10
v_xor_b32 v9, v9, v11
v_mul_u32_u24 v10, 1280, v10
v_lshl_add_u32 v76, v9, 4, v10
v_add_u32 v9, 320, v8
v_mul_u32_u24 v10, s53, v9
v_lshrrev_b32 v10, 22, v10
v_mul_u32_u24 v11, 80, v10
v_sub_u32 v9, v9, v11
v_and_b32 v11, 15, v10
v_xor_b32 v9, v9, v11
v_mul_u32_u24 v10, 1280, v10
v_lshl_add_u32 v77, v9, 4, v10
v_add_u32 v9, 384, v8
v_mul_u32_u24 v10, s53, v9
v_lshrrev_b32 v10, 22, v10
v_mul_u32_u24 v11, 80, v10
v_sub_u32 v9, v9, v11
v_and_b32 v11, 15, v10
v_xor_b32 v9, v9, v11
v_mul_u32_u24 v10, 1280, v10
v_lshl_add_u32 v78, v9, 4, v10
v_add_u32 v9, 448, v8
v_mul_u32_u24 v10, s53, v9
v_lshrrev_b32 v10, 22, v10
v_mul_u32_u24 v11, 80, v10
v_sub_u32 v9, v9, v11
v_and_b32 v11, 15, v10
v_xor_b32 v9, v9, v11
v_mul_u32_u24 v10, 1280, v10
v_lshl_add_u32 v79, v9, 4, v10
v_add_u32 v9, 512, v8
v_mul_u32_u24 v10, s53, v9
v_lshrrev_b32 v10, 22, v10
v_mul_u32_u24 v11, 80, v10
v_sub_u32 v9, v9, v11
v_and_b32 v11, 15, v10
v_xor_b32 v9, v9, v11
v_mul_u32_u24 v10, 1280, v10
v_lshl_add_u32 v80, v9, 4, v10
v_add_u32 v9, 576, v8
v_mul_u32_u24 v10, s53, v9
v_lshrrev_b32 v10, 22, v10
v_mul_u32_u24 v11, 80, v10
v_sub_u32 v9, v9, v11
v_and_b32 v11, 15, v10
v_xor_b32 v9, v9, v11
v_mul_u32_u24 v10, 1280, v10
v_lshl_add_u32 v81, v9, 4, v10
s_cmp_lg_u32 s3, 0
s_cbranch_scc1 k_wdd_100
v_mov_b32 v2, 128
k_wd_99:
global_load_dword v3, v2, s[28:29] sc1
s_waitcnt vmcnt(0)
v_readfirstlane_b32 s52, v3
s_cmp_ge_u32 s52, 32
s_cbranch_scc1 k_wdd_100
s_sleep 2
s_sub_u32 s32, s32, 1
s_cmp_gt_i32 s32, 0
s_cbranch_scc1 k_wd_99
k_wdd_100:
s_barrier
s_mul_i32 s53, s58, 40960
s_add_u32 s53, s53, 213909504
buffer_load_dwordx4 v[96:99], v0, s[4:7], s53 offen offset:0 sc1
buffer_load_dwordx4 v[100:103], v0, s[4:7], s53 offen offset:1024 sc1
buffer_load_dwordx4 v[104:107], v0, s[4:7], s53 offen offset:2048 sc1
buffer_load_dwordx4 v[108:111], v0, s[4:7], s53 offen offset:3072 sc1
s_add_u32 s53, s53, 4096
buffer_load_dwordx4 v[112:115], v0, s[4:7], s53 offen offset:0 sc1
buffer_load_dwordx4 v[116:119], v0, s[4:7], s53 offen offset:1024 sc1
buffer_load_dwordx4 v[120:123], v0, s[4:7], s53 offen offset:2048 sc1
buffer_load_dwordx4 v[124:127], v0, s[4:7], s53 offen offset:3072 sc1
s_add_u32 s53, s53, 4096
buffer_load_dwordx4 v[128:131], v0, s[4:7], s53 offen offset:0 sc1
buffer_load_dwordx4 v[132:135], v0, s[4:7], s53 offen offset:1024 sc1
buffer_load_dwordx4 v[136:139], v0, s[4:7], s53 offen offset:2048 sc1
buffer_load_dwordx4 v[140:143], v0, s[4:7], s53 offen offset:3072 sc1
s_add_u32 s53, s53, 4096
buffer_load_dwordx4 v[144:147], v0, s[4:7], s53 offen offset:0 sc1
buffer_load_dwordx4 v[148:151], v0, s[4:7], s53 offen offset:1024 sc1
buffer_load_dwordx4 v[152:155], v0, s[4:7], s53 offen offset:2048 sc1
buffer_load_dwordx4 v[156:159], v0, s[4:7], s53 offen offset:3072 sc1
s_add_u32 s53, s53, 4096
buffer_load_dwordx4 v[160:163], v0, s[4:7], s53 offen offset:0 sc1
buffer_load_dwordx4 v[164:167], v0, s[4:7], s53 offen offset:1024 sc1
buffer_load_dwordx4 v[168:171], v0, s[4:7], s53 offen offset:2048 sc1
buffer_load_dwordx4 v[172:175], v0, s[4:7], s53 offen offset:3072 sc1
s_add_u32 s53, s53, 4096
buffer_load_dwordx4 v[176:179], v0, s[4:7], s53 offen offset:0 sc1
buffer_load_dwordx4 v[180:183], v0, s[4:7], s53 offen offset:1024 sc1
buffer_load_dwordx4 v[184:187], v0, s[4:7], s53 offen offset:2048 sc1
buffer_load_dwordx4 v[188:191], v0, s[4:7], s53 offen offset:3072 sc1
s_add_u32 s53, s53, 4096
buffer_load_dwordx4 v[192:195], v0, s[4:7], s53 offen offset:0 sc1
buffer_load_dwordx4 v[196:199], v0, s[4:7], s53 offen offset:1024 sc1
buffer_load_dwordx4 v[200:203], v0, s[4:7], s53 offen offset:2048 sc1
buffer_load_dwordx4 v[204:207], v0, s[4:7], s53 offen offset:3072 sc1
s_add_u32 s53, s53, 4096
buffer_load_dwordx4 v[208:211], v0, s[4:7], s53 offen offset:0 sc1
buffer_load_dwordx4 v[212:215], v0, s[4:7], s53 offen offset:1024 sc1
buffer_load_dwordx4 v[216:219], v0, s[4:7], s53 offen offset:2048 sc1
buffer_load_dwordx4 v[220:223], v0, s[4:7], s53 offen offset:3072 sc1
s_add_u32 s53, s53, 4096
buffer_load_dwordx4 v[224:227], v0, s[4:7], s53 offen offset:0 sc1
buffer_load_dwordx4 v[228:231], v0, s[4:7], s53 offen offset:1024 sc1
buffer_load_dwordx4 v[232:235], v0, s[4:7], s53 offen offset:2048 sc1
buffer_load_dwordx4 v[236:239], v0, s[4:7], s53 offen offset:3072 sc1
s_add_u32 s53, s53, 4096
buffer_load_dwordx4 v[240:243], v0, s[4:7], s53 offen offset:0 sc1
buffer_load_dwordx4 v[244:247], v0, s[4:7], s53 offen offset:1024 sc1
buffer_load_dwordx4 v[248:251], v0, s[4:7], s53 offen offset:2048 sc1
buffer_load_dwordx4 v[252:255], v0, s[4:7], s53 offen offset:3072 sc1
s_mul_i32 s46, s57, 163840
s_lshl_b32 s48, s58, 11
s_add_u32 s48, s48, s46
s_add_u32 s48, s48, 195035136
s_mov_b32 s47, 0
s_waitcnt lgkmcnt(0)
s_mul_i32 s45, s3, 10240
s_mov_b32 s44, 0
v_bfe_u32 v8, v0, 4, 5
v_mul_u32_u24 v9, 1280, v8
v_and_b32 v8, 15, v8
v_lshrrev_b32 v10, 9, v0
v_xor_b32 v8, v8, v10
v_xor_b32 v10, 0, v8
v_lshl_add_u32 v64, v10, 4, v9
v_xor_b32 v10, 2, v8
v_lshl_add_u32 v65, v10, 4, v9
v_xor_b32 v10, 4, v8
v_lshl_add_u32 v66, v10, 4, v9
v_xor_b32 v10, 6, v8
v_lshl_add_u32 v67, v10, 4, v9
v_xor_b32 v10, 8, v8
v_lshl_add_u32 v68, v10, 4, v9
v_xor_b32 v10, 10, v8
v_lshl_add_u32 v69, v10, 4, v9
v_xor_b32 v10, 12, v8
v_lshl_add_u32 v70, v10, 4, v9
v_xor_b32 v10, 14, v8
v_lshl_add_u32 v71, v10, 4, v9
s_add_u32 m0, s45, 0
s_nop 0
buffer_load_dwordx4 v72, s[36:39], s46 offen lds
s_add_u32 m0, s45, 1024
s_nop 0
buffer_load_dwordx4 v73, s[36:39], s46 offen lds
s_add_u32 m0, s45, 2048
s_nop 0
buffer_load_dwordx4 v74, s[36:39], s46 offen lds
s_add_u32 m0, s45, 3072
s_nop 0
buffer_load_dwordx4 v75, s[36:39], s46 offen lds
s_add_u32 m0, s45, 4096
s_nop 0
buffer_load_dwordx4 v76, s[36:39], s46 offen lds
s_add_u32 m0, s45, 5120
s_nop 0
buffer_load_dwordx4 v77, s[36:39], s46 offen lds
s_add_u32 m0, s45, 6144
s_nop 0
buffer_load_dwordx4 v78, s[36:39], s46 offen lds
s_add_u32 m0, s45, 7168
s_nop 0
buffer_load_dwordx4 v79, s[36:39], s46 offen lds
s_add_u32 m0, s45, 8192
s_nop 0
buffer_load_dwordx4 v80, s[36:39], s46 offen lds
s_add_u32 m0, s45, 9216
s_nop 0
buffer_load_dwordx4 v81, s[36:39], s46 offen lds
s_add_u32 s45, s45, 40960
s_cmp_ge_u32 s45, 122880
s_cselect_b32 s55, 122880, 0
s_sub_u32 s45, s45, s55
s_add_u32 s47, s47, 1
s_cmp_lt_u32 s47, 4
s_cselect_b32 s55, 40960, 0
s_add_u32 s46, s46, s55
s_add_u32 m0, s45, 0
s_nop 0
buffer_load_dwordx4 v72, s[36:39], s46 offen lds
s_add_u32 m0, s45, 1024
s_nop 0
buffer_load_dwordx4 v73, s[36:39], s46 offen lds
s_add_u32 m0, s45, 2048
s_nop 0
buffer_load_dwordx4 v74, s[36:39], s46 offen lds
s_add_u32 m0, s45, 3072
s_nop 0
buffer_load_dwordx4 v75, s[36:39], s46 offen lds
s_add_u32 m0, s45, 4096
s_nop 0
buffer_load_dwordx4 v76, s[36:39], s46 offen lds
s_add_u32 m0, s45, 5120
s_nop 0
buffer_load_dwordx4 v77, s[36:39], s46 offen lds
s_add_u32 m0, s45, 6144
s_nop 0
buffer_load_dwordx4 v78, s[36:39], s46 offen lds
s_add_u32 m0, s45, 7168
s_nop 0
buffer_load_dwordx4 v79, s[36:39], s46 offen lds
s_add_u32 m0, s45, 8192
s_nop 0
buffer_load_dwordx4 v80, s[36:39], s46 offen lds
s_add_u32 m0, s45, 9216
s_nop 0
buffer_load_dwordx4 v81, s[36:39], s46 offen lds
s_add_u32 s45, s45, 40960
s_cmp_ge_u32 s45, 122880
s_cselect_b32 s55, 122880, 0
s_sub_u32 s45, s45, s55
s_add_u32 s47, s47, 1
s_cmp_lt_u32 s47, 4
s_cselect_b32 s55, 40960, 0
s_add_u32 s46, s46, s55
s_waitcnt vmcnt(10)
s_barrier
ds_read_b128 v[8:11], v64 offset:0
ds_read_b128 v[12:15], v65 offset:0
ds_read_b128 v[16:19], v66 offset:0
ds_read_b128 v[20:23], v67 offset:0
s_mov_b32 s59, 2
s_waitcnt lgkmcnt(3)
v_mfma_f32_32x32x16_bf16 v[32:47], v[96:99], v[8:11], 0
s_waitcnt lgkmcnt(2)
ds_read_b128 v[24:27], v68 offset:0
v_mfma_f32_32x32x16_bf16 v[32:47], v[100:103], v[12:15], v[32:47]
s_waitcnt lgkmcnt(2)
ds_read_b128 v[8:11], v69 offset:0
s_add_u32 m0, s45, 0
s_nop 0
buffer_load_dwordx4 v72, s[36:39], s46 offen lds
s_add_u32 m0, s45, 1024
s_nop 0
buffer_load_dwordx4 v73, s[36:39], s46 offen lds
v_mfma_f32_32x32x16_bf16 v[32:47], v[104:107], v[16:19], v[32:47]
s_waitcnt lgkmcnt(2)
ds_read_b128 v[12:15], v70 offset:0
s_add_u32 m0, s45, 2048
s_nop 0
buffer_load_dwordx4 v74, s[36:39], s46 offen lds
s_add_u32 m0, s45, 3072
s_nop 0
buffer_load_dwordx4 v75, s[36:39], s46 offen lds
v_mfma_f32_32x32x16_bf16 v[32:47], v[108:111], v[20:23], v[32:47]
s_waitcnt lgkmcnt(2)
ds_read_b128 v[16:19], v71 offset:0
s_add_u32 m0, s45, 4096
s_nop 0
buffer_load_dwordx4 v76, s[36:39], s46 offen lds
s_add_u32 m0, s45, 5120
s_nop 0
buffer_load_dwordx4 v77, s[36:39], s46 offen lds
v_mfma_f32_32x32x16_bf16 v[32:47], v[112:115], v[24:27], v[32:47]
s_waitcnt lgkmcnt(2)
ds_read_b128 v[20:23], v64 offset:256
s_add_u32 m0, s45, 6144
s_nop 0
buffer_load_dwordx4 v78, s[36:39], s46 offen lds
s_add_u32 m0, s45, 7168
s_nop 0
buffer_load_dwordx4 v79, s[36:39], s46 offen lds
v_mfma_f32_32x32x16_bf16 v[32:47], v[116:119], v[8:11], v[32:47]
s_waitcnt lgkmcnt(2)
ds_read_b128 v[24:27], v65 offset:256
s_add_u32 m0, s45, 8192
s_nop 0
buffer_load_dwordx4 v80, s[36:39], s46 offen lds
s_add_u32 m0, s45, 9216
s_nop 0
buffer_load_dwordx4 v81, s[36:39], s46 offen lds
v_mfma_f32_32x32x16_bf16 v[32:47], v[120:123], v[12:15], v[32:47]
s_waitcnt lgkmcnt(2)
ds_read_b128 v[8:11], v66 offset:256
s_add_u32 s45, s45, 40960
s_cmp_ge_u32 s45, 122880
s_cselect_b32 s55, 122880, 0
s_sub_u32 s45, s45, s55
s_add_u32 s47, s47, 1
s_cmp_lt_u32 s47, 4
s_cselect_b32 s55, 40960, 0
s_add_u32 s46, s46, s55
v_mfma_f32_32x32x16_bf16 v[32:47], v[124:127], v[16:19], v[32:47]
s_waitcnt lgkmcnt(2)
ds_read_b128 v[12:15], v67 offset:256
v_mfma_f32_32x32x16_bf16 v[32:47], v[128:131], v[20:23], v[32:47]
s_waitcnt lgkmcnt(2)
ds_read_b128 v[16:19], v68 offset:256
v_mfma_f32_32x32x16_bf16 v[32:47], v[132:135], v[24:27], v[32:47]
s_waitcnt lgkmcnt(2)
ds_read_b128 v[20:23], v69 offset:256
v_mfma_f32_32x32x16_bf16 v[32:47], v[136:139], v[8:11], v[32:47]
s_waitcnt lgkmcnt(2)
ds_read_b128 v[24:27], v70 offset:256
v_mfma_f32_32x32x16_bf16 v[32:47], v[140:143], v[12:15], v[32:47]
s_waitcnt lgkmcnt(2)
ds_read_b128 v[8:11], v71 offset:256
v_mfma_f32_32x32x16_bf16 v[32:47], v[144:147], v[16:19], v[32:47]
s_waitcnt lgkmcnt(2)
ds_read_b128 v[12:15], v64 offset:512
v_mfma_f32_32x32x16_bf16 v[32:47], v[148:151], v[20:23], v[32:47]
s_waitcnt lgkmcnt(2)
ds_read_b128 v[16:19], v65 offset:512
v_mfma_f32_32x32x16_bf16 v[32:47], v[152:155], v[24:27], v[32:47]
s_waitcnt lgkmcnt(2)
ds_read_b128 v[20:23], v66 offset:512
v_mfma_f32_32x32x16_bf16 v[32:47], v[156:159], v[8:11], v[32:47]
s_waitcnt lgkmcnt(2)
ds_read_b128 v[24:27], v67 offset:512
v_mfma_f32_32x32x16_bf16 v[32:47], v[160:163], v[12:15], v[32:47]
s_waitcnt lgkmcnt(2)
ds_read_b128 v[8:11], v68 offset:512
v_mfma_f32_32x32x16_bf16 v[32:47], v[164:167], v[16:19], v[32:47]
s_waitcnt lgkmcnt(2)
ds_read_b128 v[12:15], v69 offset:512
v_mfma_f32_32x32x16_bf16 v[32:47], v[168:171], v[20:23], v[32:47]
s_waitcnt lgkmcnt(2)
ds_read_b128 v[16:19], v70 offset:512
v_mfma_f32_32x32x16_bf16 v[32:47], v[172:175], v[24:27], v[32:47]
s_waitcnt lgkmcnt(2)
ds_read_b128 v[20:23], v71 offset:512
v_mfma_f32_32x32x16_bf16 v[32:47], v[176:179], v[8:11], v[32:47]
s_waitcnt lgkmcnt(2)
ds_read_b128 v[24:27], v64 offset:768
v_mfma_f32_32x32x16_bf16 v[32:47], v[180:183], v[12:15], v[32:47]
s_waitcnt lgkmcnt(2)
ds_read_b128 v[8:11], v65 offset:768
v_mfma_f32_32x32x16_bf16 v[32:47], v[184:187], v[16:19], v[32:47]
s_waitcnt lgkmcnt(2)
ds_read_b128 v[12:15], v66 offset:768
v_mfma_f32_32x32x16_bf16 v[32:47], v[188:191], v[20:23], v[32:47]
s_waitcnt lgkmcnt(2)
ds_read_b128 v[16:19], v67 offset:768
v_mfma_f32_32x32x16_bf16 v[32:47], v[192:195], v[24:27], v[32:47]
s_waitcnt lgkmcnt(2)
ds_read_b128 v[20:23], v68 offset:768
v_mfma_f32_32x32x16_bf16 v[32:47], v[196:199], v[8:11], v[32:47]
s_waitcnt lgkmcnt(2)
ds_read_b128 v[24:27], v69 offset:768
v_mfma_f32_32x32x16_bf16 v[32:47], v[200:203], v[12:15], v[32:47]
s_waitcnt lgkmcnt(2)
ds_read_b128 v[8:11], v70 offset:768
v_mfma_f32_32x32x16_bf16 v[32:47], v[204:207], v[16:19], v[32:47]
s_waitcnt lgkmcnt(2)
ds_read_b128 v[12:15], v71 offset:768
v_mfma_f32_32x32x16_bf16 v[32:47], v[208:211], v[20:23], v[32:47]
s_waitcnt lgkmcnt(2)
ds_read_b128 v[16:19], v64 offset:1024
v_mfma_f32_32x32x16_bf16 v[32:47], v[212:215], v[24:27], v[32:47]
s_waitcnt lgkmcnt(2)
ds_read_b128 v[20:23], v65 offset:1024
v_mfma_f32_32x32x16_bf16 v[32:47], v[216:219], v[8:11], v[32:47]
s_waitcnt lgkmcnt(2)
ds_read_b128 v[24:27], v66 offset:1024
v_mfma_f32_32x32x16_bf16 v[32:47], v[220:223], v[12:15], v[32:47]
s_waitcnt lgkmcnt(2)
ds_read_b128 v[8:11], v67 offset:1024
v_mfma_f32_32x32x16_bf16 v[32:47], v[224:227], v[16:19], v[32:47]
s_waitcnt lgkmcnt(2)
ds_read_b128 v[12:15], v68 offset:1024
v_mfma_f32_32x32x16_bf16 v[32:47], v[228:231], v[20:23], v[32:47]
s_waitcnt lgkmcnt(2)
ds_read_b128 v[16:19], v69 offset:1024
v_mfma_f32_32x32x16_bf16 v[32:47], v[232:235], v[24:27], v[32:47]
s_waitcnt lgkmcnt(2)
ds_read_b128 v[20:23], v70 offset:1024
v_mfma_f32_32x32x16_bf16 v[32:47], v[236:239], v[8:11], v[32:47]
s_waitcnt lgkmcnt(2)
ds_read_b128 v[24:27], v71 offset:1024
v_mfma_f32_32x32x16_bf16 v[32:47], v[240:243], v[12:15], v[32:47]
s_add_u32 s44, s44, 1
s_cmp_eq_u32 s44, 3
s_mov_b32 s56, 40960
s_cmov_b32 s56, -81920
s_cselect_b32 s44, 0, s44
v_add_u32 v64, s56, v64
v_add_u32 v65, s56, v65
v_add_u32 v66, s56, v66
v_add_u32 v67, s56, v67
v_add_u32 v68, s56, v68
v_add_u32 v69, s56, v69
v_add_u32 v70, s56, v70
v_add_u32 v71, s56, v71
s_waitcnt vmcnt(10) lgkmcnt(2)
s_barrier
ds_read_b128 v[8:11], v64 offset:0
v_mfma_f32_32x32x16_bf16 v[32:47], v[244:247], v[16:19], v[32:47]
s_waitcnt lgkmcnt(2)
ds_read_b128 v[12:15], v65 offset:0
v_mfma_f32_32x32x16_bf16 v[32:47], v[248:251], v[20:23], v[32:47]
s_waitcnt lgkmcnt(2)
ds_read_b128 v[16:19], v66 offset:0
v_mfma_f32_32x32x16_bf16 v[32:47], v[252:255], v[24:27], v[32:47]
s_waitcnt lgkmcnt(2)
ds_read_b128 v[20:23], v67 offset:0
k_st_101:
v_mfma_f32_32x32x16_bf16 v[48:63], v[96:99], v[8:11], 0
s_waitcnt lgkmcnt(2)
ds_read_b128 v[24:27], v68 offset:0
v_mfma_f32_32x32x16_bf16 v[48:63], v[100:103], v[12:15], v[48:63]
s_waitcnt lgkmcnt(2)
ds_read_b128 v[8:11], v69 offset:0
v_cvt_pk_bf16_f32 v32, v32, v33
v_cvt_pk_bf16_f32 v33, v34, v35
v_mfma_f32_32x32x16_bf16 v[48:63], v[104:107], v[16:19], v[48:63]
s_waitcnt lgkmcnt(2)
ds_read_b128 v[12:15], v70 offset:0
v_cvt_pk_bf16_f32 v34, v36, v37
v_cvt_pk_bf16_f32 v35, v38, v39
v_mfma_f32_32x32x16_bf16 v[48:63], v[108:111], v[20:23], v[48:63]
s_waitcnt lgkmcnt(2)
ds_read_b128 v[16:19], v71 offset:0
v_cvt_pk_bf16_f32 v36, v40, v41
v_cvt_pk_bf16_f32 v37, v42, v43
v_mfma_f32_32x32x16_bf16 v[48:63], v[112:115], v[24:27], v[48:63]
s_waitcnt lgkmcnt(2)
ds_read_b128 v[20:23], v64 offset:256
v_cvt_pk_bf16_f32 v38, v44, v45
v_cvt_pk_bf16_f32 v39, v46, v47
v_mfma_f32_32x32x16_bf16 v[48:63], v[116:119], v[8:11], v[48:63]
s_waitcnt lgkmcnt(2)
ds_read_b128 v[24:27], v65 offset:256
buffer_store_dwordx4 v[32:35], v0, s[4:7], s48 offen offset:0 sc1
buffer_store_dwordx4 v[36:39], v0, s[4:7], s48 offen offset:1024 sc1
v_mfma_f32_32x32x16_bf16 v[48:63], v[120:123], v[12:15], v[48:63]
s_waitcnt lgkmcnt(2)
ds_read_b128 v[8:11], v66 offset:256
s_add_u32 s48, s48, 40960
s_add_u32 m0, s45, 0
s_nop 0
buffer_load_dwordx4 v72, s[36:39], s46 offen lds
v_mfma_f32_32x32x16_bf16 v[48:63], v[124:127], v[16:19], v[48:63]
s_waitcnt lgkmcnt(2)
ds_read_b128 v[12:15], v67 offset:256
s_add_u32 m0, s45, 1024
s_nop 0
buffer_load_dwordx4 v73, s[36:39], s46 offen lds
s_add_u32 m0, s45, 2048
s_nop 0
buffer_load_dwordx4 v74, s[36:39], s46 offen lds
v_mfma_f32_32x32x16_bf16 v[48:63], v[128:131], v[20:23], v[48:63]
s_waitcnt lgkmcnt(2)
ds_read_b128 v[16:19], v68 offset:256
s_add_u32 m0, s45, 3072
s_nop 0
buffer_load_dwordx4 v75, s[36:39], s46 offen lds
s_add_u32 m0, s45, 4096
s_nop 0
buffer_load_dwordx4 v76, s[36:39], s46 offen lds
v_mfma_f32_32x32x16_bf16 v[48:63], v[132:135], v[24:27], v[48:63]
s_waitcnt lgkmcnt(2)
ds_read_b128 v[20:23], v69 offset:256
s_add_u32 m0, s45, 5120
s_nop 0
buffer_load_dwordx4 v77, s[36:39], s46 offen lds
s_add_u32 m0, s45, 6144
s_nop 0
buffer_load_dwordx4 v78, s[36:39], s46 offen lds
v_mfma_f32_32x32x16_bf16 v[48:63], v[136:139], v[8:11], v[48:63]
s_waitcnt lgkmcnt(2)
ds_read_b128 v[24:27], v70 offset:256
s_add_u32 m0, s45, 7168
s_nop 0
buffer_load_dwordx4 v79, s[36:39], s46 offen lds
s_add_u32 m0, s45, 8192
s_nop 0
buffer_load_dwordx4 v80, s[36:39], s46 offen lds
v_mfma_f32_32x32x16_bf16 v[48:63], v[140:143], v[12:15], v[48:63]
s_waitcnt lgkmcnt(2)
ds_read_b128 v[8:11], v71 offset:256
s_add_u32 m0, s45, 9216
s_nop 0
buffer_load_dwordx4 v81, s[36:39], s46 offen lds
s_add_u32 s45, s45, 40960
s_cmp_ge_u32 s45, 122880
s_cselect_b32 s55, 122880, 0
s_sub_u32 s45, s45, s55
v_mfma_f32_32x32x16_bf16 v[48:63], v[144:147], v[16:19], v[48:63]
s_waitcnt lgkmcnt(2)
ds_read_b128 v[12:15], v64 offset:512
s_add_u32 s47, s47, 1
s_cmp_lt_u32 s47, 4
s_cselect_b32 s55, 40960, 0
s_add_u32 s46, s46, s55
v_mfma_f32_32x32x16_bf16 v[48:63], v[148:151], v[20:23], v[48:63]
s_waitcnt lgkmcnt(2)
ds_read_b128 v[16:19], v65 offset:512
v_mfma_f32_32x32x16_bf16 v[48:63], v[152:155], v[24:27], v[48:63]
s_waitcnt lgkmcnt(2)
ds_read_b128 v[20:23], v66 offset:512
v_mfma_f32_32x32x16_bf16 v[48:63], v[156:159], v[8:11], v[48:63]
s_waitcnt lgkmcnt(2)
ds_read_b128 v[24:27], v67 offset:512
v_mfma_f32_32x32x16_bf16 v[48:63], v[160:163], v[12:15], v[48:63]
s_waitcnt lgkmcnt(2)
ds_read_b128 v[8:11], v68 offset:512
v_mfma_f32_32x32x16_bf16 v[48:63], v[164:167], v[16:19], v[48:63]
s_waitcnt lgkmcnt(2)
ds_read_b128 v[12:15], v69 offset:512
v_mfma_f32_32x32x16_bf16 v[48:63], v[168:171], v[20:23], v[48:63]
s_waitcnt lgkmcnt(2)
ds_read_b128 v[16:19], v70 offset:512
v_mfma_f32_32x32x16_bf16 v[48:63], v[172:175], v[24:27], v[48:63]
s_waitcnt lgkmcnt(2)
ds_read_b128 v[20:23], v71 offset:512
v_mfma_f32_32x32x16_bf16 v[48:63], v[176:179], v[8:11], v[48:63]
s_waitcnt lgkmcnt(2)
ds_read_b128 v[24:27], v64 offset:768
v_mfma_f32_32x32x16_bf16 v[48:63], v[180:183], v[12:15], v[48:63]
s_waitcnt lgkmcnt(2)
ds_read_b128 v[8:11], v65 offset:768
v_mfma_f32_32x32x16_bf16 v[48:63], v[184:187], v[16:19], v[48:63]
s_waitcnt lgkmcnt(2)
ds_read_b128 v[12:15], v66 offset:768
v_mfma_f32_32x32x16_bf16 v[48:63], v[188:191], v[20:23], v[48:63]
s_waitcnt lgkmcnt(2)
ds_read_b128 v[16:19], v67 offset:768
v_mfma_f32_32x32x16_bf16 v[48:63], v[192:195], v[24:27], v[48:63]
s_waitcnt lgkmcnt(2)
ds_read_b128 v[20:23], v68 offset:768
v_mfma_f32_32x32x16_bf16 v[48:63], v[196:199], v[8:11], v[48:63]
s_waitcnt lgkmcnt(2)
ds_read_b128 v[24:27], v69 offset:768
v_mfma_f32_32x32x16_bf16 v[48:63], v[200:203], v[12:15], v[48:63]
s_waitcnt lgkmcnt(2)
ds_read_b128 v[8:11], v70 offset:768
v_mfma_f32_32x32x16_bf16 v[48:63], v[204:207], v[16:19], v[48:63]
s_waitcnt lgkmcnt(2)
ds_read_b128 v[12:15], v71 offset:768
v_mfma_f32_32x32x16_bf16 v[48:63], v[208:211], v[20:23], v[48:63]
s_waitcnt lgkmcnt(2)
ds_read_b128 v[16:19], v64 offset:1024
v_mfma_f32_32x32x16_bf16 v[48:63], v[212:215], v[24:27], v[48:63]
s_waitcnt lgkmcnt(2)
ds_read_b128 v[20:23], v65 offset:1024
v_mfma_f32_32x32x16_bf16 v[48:63], v[216:219], v[8:11], v[48:63]
s_waitcnt lgkmcnt(2)
ds_read_b128 v[24:27], v66 offset:1024
v_mfma_f32_32x32x16_bf16 v[48:63], v[220:223], v[12:15], v[48:63]
s_waitcnt lgkmcnt(2)
ds_read_b128 v[8:11], v67 offset:1024
v_mfma_f32_32x32x16_bf16 v[48:63], v[224:227], v[16:19], v[48:63]
s_waitcnt lgkmcnt(2)
ds_read_b128 v[12:15], v68 offset:1024
v_mfma_f32_32x32x16_bf16 v[48:63], v[228:231], v[20:23], v[48:63]
s_waitcnt lgkmcnt(2)
ds_read_b128 v[16:19], v69 offset:1024
v_mfma_f32_32x32x16_bf16 v[48:63], v[232:235], v[24:27], v[48:63]
s_waitcnt lgkmcnt(2)
ds_read_b128 v[20:23], v70 offset:1024
v_mfma_f32_32x32x16_bf16 v[48:63], v[236:239], v[8:11], v[48:63]
s_waitcnt lgkmcnt(2)
ds_read_b128 v[24:27], v71 offset:1024
v_mfma_f32_32x32x16_bf16 v[48:63], v[240:243], v[12:15], v[48:63]
s_add_u32 s44, s44, 1
s_cmp_eq_u32 s44, 3
s_mov_b32 s56, 40960
s_cmov_b32 s56, -81920
s_cselect_b32 s44, 0, s44
v_add_u32 v64, s56, v64
v_add_u32 v65, s56, v65
v_add_u32 v66, s56, v66
v_add_u32 v67, s56, v67
v_add_u32 v68, s56, v68
v_add_u32 v69, s56, v69
v_add_u32 v70, s56, v70
v_add_u32 v71, s56, v71
s_waitcnt vmcnt(10) lgkmcnt(2)
s_barrier
ds_read_b128 v[8:11], v64 offset:0
v_mfma_f32_32x32x16_bf16 v[48:63], v[244:247], v[16:19], v[48:63]
s_waitcnt lgkmcnt(2)
ds_read_b128 v[12:15], v65 offset:0
v_mfma_f32_32x32x16_bf16 v[48:63], v[248:251], v[20:23], v[48:63]
s_waitcnt lgkmcnt(2)
ds_read_b128 v[16:19], v66 offset:0
v_mfma_f32_32x32x16_bf16 v[48:63], v[252:255], v[24:27], v[48:63]
s_waitcnt lgkmcnt(2)
ds_read_b128 v[20:23], v67 offset:0
k_sm_103:
s_sub_u32 s59, s59, 1
s_cmp_eq_u32 s59, 0
s_cbranch_scc1 k_so_102
v_mfma_f32_32x32x16_bf16 v[32:47], v[96:99], v[8:11], 0
s_waitcnt lgkmcnt(2)
ds_read_b128 v[24:27], v68 offset:0
v_mfma_f32_32x32x16_bf16 v[32:47], v[100:103], v[12:15], v[32:47]
s_waitcnt lgkmcnt(2)
ds_read_b128 v[8:11], v69 offset:0
v_cvt_pk_bf16_f32 v48, v48, v49
v_cvt_pk_bf16_f32 v49, v50, v51
v_mfma_f32_32x32x16_bf16 v[32:47], v[104:107], v[16:19], v[32:47]
s_waitcnt lgkmcnt(2)
ds_read_b128 v[12:15], v70 offset:0
v_cvt_pk_bf16_f32 v50, v52, v53
v_cvt_pk_bf16_f32 v51, v54, v55
v_mfma_f32_32x32x16_bf16 v[32:47], v[108:111], v[20:23], v[32:47]
s_waitcnt lgkmcnt(2)
ds_read_b128 v[16:19], v71 offset:0
v_cvt_pk_bf16_f32 v52, v56, v57
v_cvt_pk_bf16_f32 v53, v58, v59
v_mfma_f32_32x32x16_bf16 v[32:47], v[112:115], v[24:27], v[32:47]
s_waitcnt lgkmcnt(2)
ds_read_b128 v[20:23], v64 offset:256
v_cvt_pk_bf16_f32 v54, v60, v61
v_cvt_pk_bf16_f32 v55, v62, v63
v_mfma_f32_32x32x16_bf16 v[32:47], v[116:119], v[8:11], v[32:47]
s_waitcnt lgkmcnt(2)
ds_read_b128 v[24:27], v65 offset:256
buffer_store_dwordx4 v[48:51], v0, s[4:7], s48 offen offset:0 sc1
buffer_store_dwordx4 v[52:55], v0, s[4:7], s48 offen offset:1024 sc1
v_mfma_f32_32x32x16_bf16 v[32:47], v[120:123], v[12:15], v[32:47]
s_waitcnt lgkmcnt(2)
ds_read_b128 v[8:11], v66 offset:256
s_add_u32 s48, s48, 40960
s_add_u32 m0, s45, 0
s_nop 0
buffer_load_dwordx4 v72, s[36:39], s46 offen lds
v_mfma_f32_32x32x16_bf16 v[32:47], v[124:127], v[16:19], v[32:47]
s_waitcnt lgkmcnt(2)
ds_read_b128 v[12:15], v67 offset:256
s_add_u32 m0, s45, 1024
s_nop 0
buffer_load_dwordx4 v73, s[36:39], s46 offen lds
s_add_u32 m0, s45, 2048
s_nop 0
buffer_load_dwordx4 v74, s[36:39], s46 offen lds
v_mfma_f32_32x32x16_bf16 v[32:47], v[128:131], v[20:23], v[32:47]
s_waitcnt lgkmcnt(2)
ds_read_b128 v[16:19], v68 offset:256
s_add_u32 m0, s45, 3072
s_nop 0
buffer_load_dwordx4 v75, s[36:39], s46 offen lds
s_add_u32 m0, s45, 4096
s_nop 0
buffer_load_dwordx4 v76, s[36:39], s46 offen lds
v_mfma_f32_32x32x16_bf16 v[32:47], v[132:135], v[24:27], v[32:47]
s_waitcnt lgkmcnt(2)
ds_read_b128 v[20:23], v69 offset:256
s_add_u32 m0, s45, 5120
s_nop 0
buffer_load_dwordx4 v77, s[36:39], s46 offen lds
s_add_u32 m0, s45, 6144
s_nop 0
buffer_load_dwordx4 v78, s[36:39], s46 offen lds
v_mfma_f32_32x32x16_bf16 v[32:47], v[136:139], v[8:11], v[32:47]
s_waitcnt lgkmcnt(2)
ds_read_b128 v[24:27], v70 offset:256
s_add_u32 m0, s45, 7168
s_nop 0
buffer_load_dwordx4 v79, s[36:39], s46 offen lds
s_add_u32 m0, s45, 8192
s_nop 0
buffer_load_dwordx4 v80, s[36:39], s46 offen lds
v_mfma_f32_32x32x16_bf16 v[32:47], v[140:143], v[12:15], v[32:47]
s_waitcnt lgkmcnt(2)
ds_read_b128 v[8:11], v71 offset:256
s_add_u32 m0, s45, 9216
s_nop 0
buffer_load_dwordx4 v81, s[36:39], s46 offen lds
s_add_u32 s45, s45, 40960
s_cmp_ge_u32 s45, 122880
s_cselect_b32 s55, 122880, 0
s_sub_u32 s45, s45, s55
v_mfma_f32_32x32x16_bf16 v[32:47], v[144:147], v[16:19], v[32:47]
s_waitcnt lgkmcnt(2)
ds_read_b128 v[12:15], v64 offset:512
s_add_u32 s47, s47, 1
s_cmp_lt_u32 s47, 4
s_cselect_b32 s55, 40960, 0
s_add_u32 s46, s46, s55
v_mfma_f32_32x32x16_bf16 v[32:47], v[148:151], v[20:23], v[32:47]
s_waitcnt lgkmcnt(2)
ds_read_b128 v[16:19], v65 offset:512
v_mfma_f32_32x32x16_bf16 v[32:47], v[152:155], v[24:27], v[32:47]
s_waitcnt lgkmcnt(2)
ds_read_b128 v[20:23], v66 offset:512
v_mfma_f32_32x32x16_bf16 v[32:47], v[156:159], v[8:11], v[32:47]
s_waitcnt lgkmcnt(2)
ds_read_b128 v[24:27], v67 offset:512
v_mfma_f32_32x32x16_bf16 v[32:47], v[160:163], v[12:15], v[32:47]
s_waitcnt lgkmcnt(2)
ds_read_b128 v[8:11], v68 offset:512
v_mfma_f32_32x32x16_bf16 v[32:47], v[164:167], v[16:19], v[32:47]
s_waitcnt lgkmcnt(2)
ds_read_b128 v[12:15], v69 offset:512
v_mfma_f32_32x32x16_bf16 v[32:47], v[168:171], v[20:23], v[32:47]
s_waitcnt lgkmcnt(2)
ds_read_b128 v[16:19], v70 offset:512
v_mfma_f32_32x32x16_bf16 v[32:47], v[172:175], v[24:27], v[32:47]
s_waitcnt lgkmcnt(2)
ds_read_b128 v[20:23], v71 offset:512
v_mfma_f32_32x32x16_bf16 v[32:47], v[176:179], v[8:11], v[32:47]
s_waitcnt lgkmcnt(2)
ds_read_b128 v[24:27], v64 offset:768
v_mfma_f32_32x32x16_bf16 v[32:47], v[180:183], v[12:15], v[32:47]
s_waitcnt lgkmcnt(2)
ds_read_b128 v[8:11], v65 offset:768
v_mfma_f32_32x32x16_bf16 v[32:47], v[184:187], v[16:19], v[32:47]
s_waitcnt lgkmcnt(2)
ds_read_b128 v[12:15], v66 offset:768
v_mfma_f32_32x32x16_bf16 v[32:47], v[188:191], v[20:23], v[32:47]
s_waitcnt lgkmcnt(2)
ds_read_b128 v[16:19], v67 offset:768
v_mfma_f32_32x32x16_bf16 v[32:47], v[192:195], v[24:27], v[32:47]
s_waitcnt lgkmcnt(2)
ds_read_b128 v[20:23], v68 offset:768
v_mfma_f32_32x32x16_bf16 v[32:47], v[196:199], v[8:11], v[32:47]
s_waitcnt lgkmcnt(2)
ds_read_b128 v[24:27], v69 offset:768
v_mfma_f32_32x32x16_bf16 v[32:47], v[200:203], v[12:15], v[32:47]
s_waitcnt lgkmcnt(2)
ds_read_b128 v[8:11], v70 offset:768
v_mfma_f32_32x32x16_bf16 v[32:47], v[204:207], v[16:19], v[32:47]
s_waitcnt lgkmcnt(2)
ds_read_b128 v[12:15], v71 offset:768
v_mfma_f32_32x32x16_bf16 v[32:47], v[208:211], v[20:23], v[32:47]
s_waitcnt lgkmcnt(2)
ds_read_b128 v[16:19], v64 offset:1024
v_mfma_f32_32x32x16_bf16 v[32:47], v[212:215], v[24:27], v[32:47]
s_waitcnt lgkmcnt(2)
ds_read_b128 v[20:23], v65 offset:1024
v_mfma_f32_32x32x16_bf16 v[32:47], v[216:219], v[8:11], v[32:47]
s_waitcnt lgkmcnt(2)
ds_read_b128 v[24:27], v66 offset:1024
v_mfma_f32_32x32x16_bf16 v[32:47], v[220:223], v[12:15], v[32:47]
s_waitcnt lgkmcnt(2)
ds_read_b128 v[8:11], v67 offset:1024
v_mfma_f32_32x32x16_bf16 v[32:47], v[224:227], v[16:19], v[32:47]
s_waitcnt lgkmcnt(2)
ds_read_b128 v[12:15], v68 offset:1024
v_mfma_f32_32x32x16_bf16 v[32:47], v[228:231], v[20:23], v[32:47]
s_waitcnt lgkmcnt(2)
ds_read_b128 v[16:19], v69 offset:1024
v_mfma_f32_32x32x16_bf16 v[32:47], v[232:235], v[24:27], v[32:47]
s_waitcnt lgkmcnt(2)
ds_read_b128 v[20:23], v70 offset:1024
v_mfma_f32_32x32x16_bf16 v[32:47], v[236:239], v[8:11], v[32:47]
s_waitcnt lgkmcnt(2)
ds_read_b128 v[24:27], v71 offset:1024
v_mfma_f32_32x32x16_bf16 v[32:47], v[240:243], v[12:15], v[32:47]
s_add_u32 s44, s44, 1
s_cmp_eq_u32 s44, 3
s_mov_b32 s56, 40960
s_cmov_b32 s56, -81920
s_cselect_b32 s44, 0, s44
v_add_u32 v64, s56, v64
v_add_u32 v65, s56, v65
v_add_u32 v66, s56, v66
v_add_u32 v67, s56, v67
v_add_u32 v68, s56, v68
v_add_u32 v69, s56, v69
v_add_u32 v70, s56, v70
v_add_u32 v71, s56, v71
s_waitcnt vmcnt(10) lgkmcnt(2)
s_barrier
ds_read_b128 v[8:11], v64 offset:0
v_mfma_f32_32x32x16_bf16 v[32:47], v[244:247], v[16:19], v[32:47]
s_waitcnt lgkmcnt(2)
ds_read_b128 v[12:15], v65 offset:0
v_mfma_f32_32x32x16_bf16 v[32:47], v[248:251], v[20:23], v[32:47]
s_waitcnt lgkmcnt(2)
ds_read_b128 v[16:19], v66 offset:0
v_mfma_f32_32x32x16_bf16 v[32:47], v[252:255], v[24:27], v[32:47]
s_waitcnt lgkmcnt(2)
ds_read_b128 v[20:23], v67 offset:0
s_branch k_st_101
k_so_102:
s_nop 6
v_cvt_pk_bf16_f32 v48, v48, v49
v_cvt_pk_bf16_f32 v49, v50, v51
v_cvt_pk_bf16_f32 v50, v52, v53
v_cvt_pk_bf16_f32 v51, v54, v55
v_cvt_pk_bf16_f32 v52, v56, v57
v_cvt_pk_bf16_f32 v53, v58, v59
v_cvt_pk_bf16_f32 v54, v60, v61
v_cvt_pk_bf16_f32 v55, v62, v63
buffer_store_dwordx4 v[48:51], v0, s[4:7], s48 offen offset:0 sc1
buffer_store_dwordx4 v[52:55], v0, s[4:7], s48 offen offset:1024 sc1
s_add_u32 s48, s48, 40960
s_lshl_b32 s54, s30, 6
s_add_u32 s54, s54, 222298112
s_waitcnt lgkmcnt(0)
s_waitcnt vmcnt(0)
s_barrier
s_cmp_lg_u32 s3, 0
s_cbranch_scc1 k_s8_104
s_mov_b64 exec, 1
v_mov_b32 v2, 1
buffer_store_dword v2, off, s[4:7], s54 sc1
s_mov_b64 exec, -1
k_s8_104:
s_mul_i32 s52, s3, 640
v_lshrrev_b32 v8, 4, v0
v_add_u32 v8, s52, v8
s_mov_b32 s53, 52429
v_add_u32 v9, 0, v8
v_mul_u32_u24 v10, s53, v9
v_lshrrev_b32 v10, 22, v10
v_mul_u32_u24 v11, 80, v10
v_sub_u32 v9, v9, v11
v_and_b32 v11, 15, v10
v_xor_b32 v9, v9, v11
v_and_b32 v11, 1, v10
v_bfe_u32 v12, v10, 1, 1
v_lshl_add_u32 v11, v12, 4, v11
v_bfe_u32 v12, v10, 2, 1
v_lshl_add_u32 v11, v12, 6, v11
v_bfe_u32 v12, v10, 3, 1
v_lshl_add_u32 v11, v12, 1, v11
v_bfe_u32 v12, v10, 4, 1
v_lshl_add_u32 v10, v12, 3, v11
v_mul_u32_u24 v10, 1280, v10
v_lshl_add_u32 v72, v9, 4, v10
v_add_u32 v9, 64, v8
v_mul_u32_u24 v10, s53, v9
v_lshrrev_b32 v10, 22, v10
v_mul_u32_u24 v11, 80, v10
v_sub_u32 v9, v9, v11
v_and_b32 v11, 15, v10
v_xor_b32 v9, v9, v11
v_and_b32 v11, 1, v10
v_bfe_u32 v12, v10, 1, 1
v_lshl_add_u32 v11, v12, 4, v11
v_bfe_u32 v12, v10, 2, 1
v_lshl_add_u32 v11, v12, 6, v11
v_bfe_u32 v12, v10, 3, 1
v_lshl_add_u32 v11, v12, 1, v11
v_bfe_u32 v12, v10, 4, 1
v_lshl_add_u32 v10, v12, 3, v11
v_mul_u32_u24 v10, 1280, v10
v_lshl_add_u32 v73, v9, 4, v10
v_add_u32 v9, 128, v8
v_mul_u32_u24 v10, s53, v9
v_lshrrev_b32 v10, 22, v10
v_mul_u32_u24 v11, 80, v10
v_sub_u32 v9, v9, v11
v_and_b32 v11, 15, v10
v_xor_b32 v9, v9, v11
v_and_b32 v11, 1, v10
v_bfe_u32 v12, v10, 1, 1
v_lshl_add_u32 v11, v12, 4, v11
v_bfe_u32 v12, v10, 2, 1
v_lshl_add_u32 v11, v12, 6, v11
v_bfe_u32 v12, v10, 3, 1
v_lshl_add_u32 v11, v12, 1, v11
v_bfe_u32 v12, v10, 4, 1
v_lshl_add_u32 v10, v12, 3, v11
v_mul_u32_u24 v10, 1280, v10
v_lshl_add_u32 v74, v9, 4, v10
v_add_u32 v9, 192, v8
v_mul_u32_u24 v10, s53, v9
v_lshrrev_b32 v10, 22, v10
v_mul_u32_u24 v11, 80, v10
v_sub_u32 v9, v9, v11
v_and_b32 v11, 15, v10
v_xor_b32 v9, v9, v11
v_and_b32 v11, 1, v10
v_bfe_u32 v12, v10, 1, 1
v_lshl_add_u32 v11, v12, 4, v11
v_bfe_u32 v12, v10, 2, 1
v_lshl_add_u32 v11, v12, 6, v11
v_bfe_u32 v12, v10, 3, 1
v_lshl_add_u32 v11, v12, 1, v11
v_bfe_u32 v12, v10, 4, 1
v_lshl_add_u32 v10, v12, 3, v11
v_mul_u32_u24 v10, 1280, v10
v_lshl_add_u32 v75, v9, 4, v10
v_add_u32 v9, 256, v8
v_mul_u32_u24 v10, s53, v9
v_lshrrev_b32 v10, 22, v10
v_mul_u32_u24 v11, 80, v10
v_sub_u32 v9, v9, v11
v_and_b32 v11, 15, v10
v_xor_b32 v9, v9, v11
v_and_b32 v11, 1, v10
v_bfe_u32 v12, v10, 1, 1
v_lshl_add_u32 v11, v12, 4, v11
v_bfe_u32 v12, v10, 2, 1
v_lshl_add_u32 v11, v12, 6, v11
v_bfe_u32 v12, v10, 3, 1
v_lshl_add_u32 v11, v12, 1, v11
v_bfe_u32 v12, v10, 4, 1
v_lshl_add_u32 v10, v12, 3, v11
v_mul_u32_u24 v10, 1280, v10
v_lshl_add_u32 v76, v9, 4, v10
v_add_u32 v9, 320, v8
v_mul_u32_u24 v10, s53, v9
v_lshrrev_b32 v10, 22, v10
v_mul_u32_u24 v11, 80, v10
v_sub_u32 v9, v9, v11
v_and_b32 v11, 15, v10
v_xor_b32 v9, v9, v11
v_and_b32 v11, 1, v10
v_bfe_u32 v12, v10, 1, 1
v_lshl_add_u32 v11, v12, 4, v11
v_bfe_u32 v12, v10, 2, 1
v_lshl_add_u32 v11, v12, 6, v11
v_bfe_u32 v12, v10, 3, 1
v_lshl_add_u32 v11, v12, 1, v11
v_bfe_u32 v12, v10, 4, 1
v_lshl_add_u32 v10, v12, 3, v11
v_mul_u32_u24 v10, 1280, v10
v_lshl_add_u32 v77, v9, 4, v10
v_add_u32 v9, 384, v8
v_mul_u32_u24 v10, s53, v9
v_lshrrev_b32 v10, 22, v10
v_mul_u32_u24 v11, 80, v10
v_sub_u32 v9, v9, v11
v_and_b32 v11, 15, v10
v_xor_b32 v9, v9, v11
v_and_b32 v11, 1, v10
v_bfe_u32 v12, v10, 1, 1
v_lshl_add_u32 v11, v12, 4, v11
v_bfe_u32 v12, v10, 2, 1
v_lshl_add_u32 v11, v12, 6, v11
v_bfe_u32 v12, v10, 3, 1
v_lshl_add_u32 v11, v12, 1, v11
v_bfe_u32 v12, v10, 4, 1
v_lshl_add_u32 v10, v12, 3, v11
v_mul_u32_u24 v10, 1280, v10
v_lshl_add_u32 v78, v9, 4, v10
v_add_u32 v9, 448, v8
v_mul_u32_u24 v10, s53, v9
v_lshrrev_b32 v10, 22, v10
v_mul_u32_u24 v11, 80, v10
v_sub_u32 v9, v9, v11
v_and_b32 v11, 15, v10
v_xor_b32 v9, v9, v11
v_and_b32 v11, 1, v10
v_bfe_u32 v12, v10, 1, 1
v_lshl_add_u32 v11, v12, 4, v11
v_bfe_u32 v12, v10, 2, 1
v_lshl_add_u32 v11, v12, 6, v11
v_bfe_u32 v12, v10, 3, 1
v_lshl_add_u32 v11, v12, 1, v11
v_bfe_u32 v12, v10, 4, 1
v_lshl_add_u32 v10, v12, 3, v11
v_mul_u32_u24 v10, 1280, v10
v_lshl_add_u32 v79, v9, 4, v10
v_add_u32 v9, 512, v8
v_mul_u32_u24 v10, s53, v9
v_lshrrev_b32 v10, 22, v10
v_mul_u32_u24 v11, 80, v10
v_sub_u32 v9, v9, v11
v_and_b32 v11, 15, v10
v_xor_b32 v9, v9, v11
v_and_b32 v11, 1, v10
v_bfe_u32 v12, v10, 1, 1
v_lshl_add_u32 v11, v12, 4, v11
v_bfe_u32 v12, v10, 2, 1
v_lshl_add_u32 v11, v12, 6, v11
v_bfe_u32 v12, v10, 3, 1
v_lshl_add_u32 v11, v12, 1, v11
v_bfe_u32 v12, v10, 4, 1
v_lshl_add_u32 v10, v12, 3, v11
v_mul_u32_u24 v10, 1280, v10
v_lshl_add_u32 v80, v9, 4, v10
v_add_u32 v9, 576, v8
v_mul_u32_u24 v10, s53, v9
v_lshrrev_b32 v10, 22, v10
v_mul_u32_u24 v11, 80, v10
v_sub_u32 v9, v9, v11
v_and_b32 v11, 15, v10
v_xor_b32 v9, v9, v11
v_and_b32 v11, 1, v10
v_bfe_u32 v12, v10, 1, 1
v_lshl_add_u32 v11, v12, 4, v11
v_bfe_u32 v12, v10, 2, 1
v_lshl_add_u32 v11, v12, 6, v11
v_bfe_u32 v12, v10, 3, 1
v_lshl_add_u32 v11, v12, 1, v11
v_bfe_u32 v12, v10, 4, 1
v_lshl_add_u32 v10, v12, 3, v11
v_mul_u32_u24 v10, 1280, v10
v_lshl_add_u32 v81, v9, 4, v10
s_mul_i32 s49, s57, 327680
s_mov_b32 s46, s49
s_mov_b32 s47, 0
s_lshl_b32 s48, s58, 18
s_lshl_b32 s52, s57, 14
s_add_u32 s48, s48, s52
s_add_u32 s48, s48, 216006656
s_mov_b32 s50, 512
v_bfe_u32 v2, v0, 6, 1
v_bfe_u32 v3, v0, 7, 1
v_and_b32 v1, 0x30, v0
v_lshl_add_u32 v1, v2, 7, v1
v_lshl_add_u32 v1, v3, 6, v1
v_bfe_u32 v2, v0, 8, 1
v_lshl_add_u32 v1, v2, 11, v1
v_bfe_u32 v2, v0, 9, 1
v_lshl_add_u32 v1, v2, 8, v1
s_mul_i32 s45, s3, 10240
s_mov_b32 s44, 0
v_bfe_u32 v8, v0, 4, 5
v_mul_u32_u24 v9, 1280, v8
v_and_b32 v8, 15, v8
v_lshrrev_b32 v10, 9, v0
v_xor_b32 v8, v8, v10
v_xor_b32 v10, 0, v8
v_lshl_add_u32 v64, v10, 4, v9
v_xor_b32 v10, 2, v8
v_lshl_add_u32 v65, v10, 4, v9
v_xor_b32 v10, 4, v8
v_lshl_add_u32 v66, v10, 4, v9
v_xor_b32 v10, 6, v8
v_lshl_add_u32 v67, v10, 4, v9
v_xor_b32 v10, 8, v8
v_lshl_add_u32 v68, v10, 4, v9
v_xor_b32 v10, 10, v8
v_lshl_add_u32 v69, v10, 4, v9
v_xor_b32 v10, 12, v8
v_lshl_add_u32 v70, v10, 4, v9
v_xor_b32 v10, 14, v8
v_lshl_add_u32 v71, v10, 4, v9
s_add_u32 m0, s45, 0
s_nop 0
buffer_load_dwordx4 v72, s[20:23], s46 offen lds
s_add_u32 m0, s45, 1024
s_nop 0
buffer_load_dwordx4 v73, s[20:23], s46 offen lds
s_add_u32 m0, s45, 2048
s_nop 0
buffer_load_dwordx4 v74, s[20:23], s46 offen lds
s_add_u32 m0, s45, 3072
s_nop 0
buffer_load_dwordx4 v75, s[20:23], s46 offen lds
s_add_u32 m0, s45, 4096
s_nop 0
buffer_load_dwordx4 v76, s[20:23], s46 offen lds
s_add_u32 m0, s45, 5120
s_nop 0
buffer_load_dwordx4 v77, s[20:23], s46 offen lds
s_add_u32 m0, s45, 6144
s_nop 0
buffer_load_dwordx4 v78, s[20:23], s46 offen lds
s_add_u32 m0, s45, 7168
s_nop 0
buffer_load_dwordx4 v79, s[20:23], s46 offen lds
s_add_u32 m0, s45, 8192
s_nop 0
buffer_load_dwordx4 v80, s[20:23], s46 offen lds
s_add_u32 m0, s45, 9216
s_nop 0
buffer_load_dwordx4 v81, s[20:23], s46 offen lds
s_add_u32 s45, s45, 40960
s_cmp_ge_u32 s45, 122880
s_cselect_b32 s55, 122880, 0
s_sub_u32 s45, s45, s55
s_add_u32 s47, s47, 1
s_and_b32 s55, s47, 1
s_mul_i32 s46, s55, 5120
s_and_b32 s55, s47, 2
s_mul_i32 s55, s55, 20480
s_add_u32 s46, s46, s55
s_and_b32 s55, s47, 4
s_mul_i32 s55, s55, 40960
s_add_u32 s46, s46, s55
s_add_u32 s46, s46, s49
s_add_u32 m0, s45, 0
s_nop 0
buffer_load_dwordx4 v72, s[20:23], s46 offen lds
s_add_u32 m0, s45, 1024
s_nop 0
buffer_load_dwordx4 v73, s[20:23], s46 offen lds
s_add_u32 m0, s45, 2048
s_nop 0
buffer_load_dwordx4 v74, s[20:23], s46 offen lds
s_add_u32 m0, s45, 3072
s_nop 0
buffer_load_dwordx4 v75, s[20:23], s46 offen lds
s_add_u32 m0, s45, 4096
s_nop 0
buffer_load_dwordx4 v76, s[20:23], s46 offen lds
s_add_u32 m0, s45, 5120
s_nop 0
buffer_load_dwordx4 v77, s[20:23], s46 offen lds
s_add_u32 m0, s45, 6144
s_nop 0
buffer_load_dwordx4 v78, s[20:23], s46 offen lds
s_add_u32 m0, s45, 7168
s_nop 0
buffer_load_dwordx4 v79, s[20:23], s46 offen lds
s_add_u32 m0, s45, 8192
s_nop 0
buffer_load_dwordx4 v80, s[20:23], s46 offen lds
s_add_u32 m0, s45, 9216
s_nop 0
buffer_load_dwordx4 v81, s[20:23], s46 offen lds
s_add_u32 s45, s45, 40960
s_cmp_ge_u32 s45, 122880
s_cselect_b32 s55, 122880, 0
s_sub_u32 s45, s45, s55
s_add_u32 s47, s47, 1
s_and_b32 s55, s47, 1
s_mul_i32 s46, s55, 5120
s_and_b32 s55, s47, 2
s_mul_i32 s55, s55, 20480
s_add_u32 s46, s46, s55
s_and_b32 s55, s47, 4
s_mul_i32 s55, s55, 40960
s_add_u32 s46, s46, s55
s_add_u32 s46, s46, s49
s_waitcnt vmcnt(10)
s_barrier
ds_read_b128 v[8:11], v64 offset:0
ds_read_b128 v[12:15], v65 offset:0
ds_read_b128 v[16:19], v66 offset:0
ds_read_b128 v[20:23], v67 offset:0
s_mov_b32 s59, 4
s_waitcnt lgkmcnt(3)
v_mfma_f32_32x32x16_bf16 v[32:47], v[8:11], v[96:99], 0
s_waitcnt lgkmcnt(2)
ds_read_b128 v[24:27], v68 offset:0
v_mfma_f32_32x32x16_bf16 v[32:47], v[12:15], v[100:103], v[32:47]
s_waitcnt lgkmcnt(2)
ds_read_b128 v[8:11], v69 offset:0
s_add_u32 m0, s45, 0
s_nop 0
buffer_load_dwordx4 v72, s[20:23], s46 offen lds
s_add_u32 m0, s45, 1024
s_nop 0
buffer_load_dwordx4 v73, s[20:23], s46 offen lds
v_mfma_f32_32x32x16_bf16 v[32:47], v[16:19], v[104:107], v[32:47]
s_waitcnt lgkmcnt(2)
ds_read_b128 v[12:15], v70 offset:0
s_add_u32 m0, s45, 2048
s_nop 0
buffer_load_dwordx4 v74, s[20:23], s46 offen lds
s_add_u32 m0, s45, 3072
s_nop 0
buffer_load_dwordx4 v75, s[20:23], s46 offen lds
v_mfma_f32_32x32x16_bf16 v[32:47], v[20:23], v[108:111], v[32:47]
s_waitcnt lgkmcnt(2)
ds_read_b128 v[16:19], v71 offset:0
s_add_u32 m0, s45, 4096
s_nop 0
buffer_load_dwordx4 v76, s[20:23], s46 offen lds
s_add_u32 m0, s45, 5120
s_nop 0
buffer_load_dwordx4 v77, s[20:23], s46 offen lds
v_mfma_f32_32x32x16_bf16 v[32:47], v[24:27], v[112:115], v[32:47]
s_waitcnt lgkmcnt(2)
ds_read_b128 v[20:23], v64 offset:256
s_add_u32 m0, s45, 6144
s_nop 0
buffer_load_dwordx4 v78, s[20:23], s46 offen lds
s_add_u32 m0, s45, 7168
s_nop 0
buffer_load_dwordx4 v79, s[20:23], s46 offen lds
v_mfma_f32_32x32x16_bf16 v[32:47], v[8:11], v[116:119], v[32:47]
s_waitcnt lgkmcnt(2)
ds_read_b128 v[24:27], v65 offset:256
s_add_u32 m0, s45, 8192
s_nop 0
buffer_load_dwordx4 v80, s[20:23], s46 offen lds
s_add_u32 m0, s45, 9216
s_nop 0
buffer_load_dwordx4 v81, s[20:23], s46 offen lds
v_mfma_f32_32x32x16_bf16 v[32:47], v[12:15], v[120:123], v[32:47]
s_waitcnt lgkmcnt(2)
ds_read_b128 v[8:11], v66 offset:256
s_add_u32 s45, s45, 40960
s_cmp_ge_u32 s45, 122880
s_cselect_b32 s55, 122880, 0
s_sub_u32 s45, s45, s55
s_add_u32 s47, s47, 1
s_and_b32 s55, s47, 1
s_mul_i32 s46, s55, 5120
s_and_b32 s55, s47, 2
s_mul_i32 s55, s55, 20480
s_add_u32 s46, s46, s55
s_and_b32 s55, s47, 4
s_mul_i32 s55, s55, 40960
s_add_u32 s46, s46, s55
s_add_u32 s46, s46, s49
v_mfma_f32_32x32x16_bf16 v[32:47], v[16:19], v[124:127], v[32:47]
s_waitcnt lgkmcnt(2)
ds_read_b128 v[12:15], v67 offset:256
v_mfma_f32_32x32x16_bf16 v[32:47], v[20:23], v[128:131], v[32:47]
s_waitcnt lgkmcnt(2)
ds_read_b128 v[16:19], v68 offset:256
v_mfma_f32_32x32x16_bf16 v[32:47], v[24:27], v[132:135], v[32:47]
s_waitcnt lgkmcnt(2)
ds_read_b128 v[20:23], v69 offset:256
v_mfma_f32_32x32x16_bf16 v[32:47], v[8:11], v[136:139], v[32:47]
s_waitcnt lgkmcnt(2)
ds_read_b128 v[24:27], v70 offset:256
v_mfma_f32_32x32x16_bf16 v[32:47], v[12:15], v[140:143], v[32:47]
s_waitcnt lgkmcnt(2)
ds_read_b128 v[8:11], v71 offset:256
v_mfma_f32_32x32x16_bf16 v[32:47], v[16:19], v[144:147], v[32:47]
s_waitcnt lgkmcnt(2)
ds_read_b128 v[12:15], v64 offset:512
v_mfma_f32_32x32x16_bf16 v[32:47], v[20:23], v[148:151], v[32:47]
s_waitcnt lgkmcnt(2)
ds_read_b128 v[16:19], v65 offset:512
v_mfma_f32_32x32x16_bf16 v[32:47], v[24:27], v[152:155], v[32:47]
s_waitcnt lgkmcnt(2)
ds_read_b128 v[20:23], v66 offset:512
v_mfma_f32_32x32x16_bf16 v[32:47], v[8:11], v[156:159], v[32:47]
s_waitcnt lgkmcnt(2)
ds_read_b128 v[24:27], v67 offset:512
v_mfma_f32_32x32x16_bf16 v[32:47], v[12:15], v[160:163], v[32:47]
s_waitcnt lgkmcnt(2)
ds_read_b128 v[8:11], v68 offset:512
v_mfma_f32_32x32x16_bf16 v[32:47], v[16:19], v[164:167], v[32:47]
s_waitcnt lgkmcnt(2)
ds_read_b128 v[12:15], v69 offset:512
v_mfma_f32_32x32x16_bf16 v[32:47], v[20:23], v[168:171], v[32:47]
s_waitcnt lgkmcnt(2)
ds_read_b128 v[16:19], v70 offset:512
v_mfma_f32_32x32x16_bf16 v[32:47], v[24:27], v[172:175], v[32:47]
s_waitcnt lgkmcnt(2)
ds_read_b128 v[20:23], v71 offset:512
v_mfma_f32_32x32x16_bf16 v[32:47], v[8:11], v[176:179], v[32:47]
s_waitcnt lgkmcnt(2)
ds_read_b128 v[24:27], v64 offset:768
v_mfma_f32_32x32x16_bf16 v[32:47], v[12:15], v[180:183], v[32:47]
s_waitcnt lgkmcnt(2)
ds_read_b128 v[8:11], v65 offset:768
v_mfma_f32_32x32x16_bf16 v[32:47], v[16:19], v[184:187], v[32:47]
s_waitcnt lgkmcnt(2)
ds_read_b128 v[12:15], v66 offset:768
v_mfma_f32_32x32x16_bf16 v[32:47], v[20:23], v[188:191], v[32:47]
s_waitcnt lgkmcnt(2)
ds_read_b128 v[16:19], v67 offset:768
v_mfma_f32_32x32x16_bf16 v[32:47], v[24:27], v[192:195], v[32:47]
s_waitcnt lgkmcnt(2)
ds_read_b128 v[20:23], v68 offset:768
v_mfma_f32_32x32x16_bf16 v[32:47], v[8:11], v[196:199], v[32:47]
s_waitcnt lgkmcnt(2)
ds_read_b128 v[24:27], v69 offset:768
v_mfma_f32_32x32x16_bf16 v[32:47], v[12:15], v[200:203], v[32:47]
s_waitcnt lgkmcnt(2)
ds_read_b128 v[8:11], v70 offset:768
v_mfma_f32_32x32x16_bf16 v[32:47], v[16:19], v[204:207], v[32:47]
s_waitcnt lgkmcnt(2)
ds_read_b128 v[12:15], v71 offset:768
v_mfma_f32_32x32x16_bf16 v[32:47], v[20:23], v[208:211], v[32:47]
s_waitcnt lgkmcnt(2)
ds_read_b128 v[16:19], v64 offset:1024
v_mfma_f32_32x32x16_bf16 v[32:47], v[24:27], v[212:215], v[32:47]
s_waitcnt lgkmcnt(2)
ds_read_b128 v[20:23], v65 offset:1024
v_mfma_f32_32x32x16_bf16 v[32:47], v[8:11], v[216:219], v[32:47]
s_waitcnt lgkmcnt(2)
ds_read_b128 v[24:27], v66 offset:1024
v_mfma_f32_32x32x16_bf16 v[32:47], v[12:15], v[220:223], v[32:47]
s_waitcnt lgkmcnt(2)
ds_read_b128 v[8:11], v67 offset:1024
v_mfma_f32_32x32x16_bf16 v[32:47], v[16:19], v[224:227], v[32:47]
s_waitcnt lgkmcnt(2)
ds_read_b128 v[12:15], v68 offset:1024
v_mfma_f32_32x32x16_bf16 v[32:47], v[20:23], v[228:231], v[32:47]
s_waitcnt lgkmcnt(2)
ds_read_b128 v[16:19], v69 offset:1024
v_mfma_f32_32x32x16_bf16 v[32:47], v[24:27], v[232:235], v[32:47]
s_waitcnt lgkmcnt(2)
ds_read_b128 v[20:23], v70 offset:1024
v_mfma_f32_32x32x16_bf16 v[32:47], v[8:11], v[236:239], v[32:47]
s_waitcnt lgkmcnt(2)
ds_read_b128 v[24:27], v71 offset:1024
v_mfma_f32_32x32x16_bf16 v[32:47], v[12:15], v[240:243], v[32:47]
s_add_u32 s44, s44, 1
s_cmp_eq_u32 s44, 3
s_mov_b32 s56, 40960
s_cmov_b32 s56, -81920
s_cselect_b32 s44, 0, s44
v_add_u32 v64, s56, v64
v_add_u32 v65, s56, v65
v_add_u32 v66, s56, v66
v_add_u32 v67, s56, v67
v_add_u32 v68, s56, v68
v_add_u32 v69, s56, v69
v_add_u32 v70, s56, v70
v_add_u32 v71, s56, v71
s_waitcnt vmcnt(10) lgkmcnt(2)
s_barrier
ds_read_b128 v[8:11], v64 offset:0
v_mfma_f32_32x32x16_bf16 v[32:47], v[16:19], v[244:247], v[32:47]
s_waitcnt lgkmcnt(2)
ds_read_b128 v[12:15], v65 offset:0
v_mfma_f32_32x32x16_bf16 v[32:47], v[20:23], v[248:251], v[32:47]
s_waitcnt lgkmcnt(2)
ds_read_b128 v[16:19], v66 offset:0
v_mfma_f32_32x32x16_bf16 v[32:47], v[24:27], v[252:255], v[32:47]
s_waitcnt lgkmcnt(2)
ds_read_b128 v[20:23], v67 offset:0
k_st_105:
v_mfma_f32_32x32x16_bf16 v[48:63], v[8:11], v[96:99], 0
s_waitcnt lgkmcnt(2)
ds_read_b128 v[24:27], v68 offset:0
v_mfma_f32_32x32x16_bf16 v[48:63], v[12:15], v[100:103], v[48:63]
s_waitcnt lgkmcnt(2)
ds_read_b128 v[8:11], v69 offset:0
v_cvt_pk_bf16_f32 v32, v32, v33
v_cvt_pk_bf16_f32 v33, v34, v35
v_mfma_f32_32x32x16_bf16 v[48:63], v[16:19], v[104:107], v[48:63]
s_waitcnt lgkmcnt(2)
ds_read_b128 v[12:15], v70 offset:0
v_cvt_pk_bf16_f32 v34, v36, v37
v_cvt_pk_bf16_f32 v35, v38, v39
v_mfma_f32_32x32x16_bf16 v[48:63], v[20:23], v[108:111], v[48:63]
s_waitcnt lgkmcnt(2)
ds_read_b128 v[16:19], v71 offset:0
v_cvt_pk_bf16_f32 v36, v40, v41
v_cvt_pk_bf16_f32 v37, v42, v43
v_mfma_f32_32x32x16_bf16 v[48:63], v[24:27], v[112:115], v[48:63]
s_waitcnt lgkmcnt(2)
ds_read_b128 v[20:23], v64 offset:256
v_cvt_pk_bf16_f32 v38, v44, v45
v_cvt_pk_bf16_f32 v39, v46, v47
v_mfma_f32_32x32x16_bf16 v[48:63], v[8:11], v[116:119], v[48:63]
s_waitcnt lgkmcnt(2)
ds_read_b128 v[24:27], v65 offset:256
buffer_store_dwordx4 v[32:35], v1, s[4:7], s48 offen offset:0 sc1
buffer_store_dwordx4 v[36:39], v1, s[4:7], s48 offen offset:1024 sc1
v_mfma_f32_32x32x16_bf16 v[48:63], v[12:15], v[120:123], v[48:63]
s_waitcnt lgkmcnt(2)
ds_read_b128 v[8:11], v66 offset:256
s_add_u32 s48, s48, s50
s_sub_u32 s50, 4096, s50
s_add_u32 m0, s45, 0
s_nop 0
buffer_load_dwordx4 v72, s[20:23], s46 offen lds
v_mfma_f32_32x32x16_bf16 v[48:63], v[16:19], v[124:127], v[48:63]
s_waitcnt lgkmcnt(2)
ds_read_b128 v[12:15], v67 offset:256
s_add_u32 m0, s45, 1024
s_nop 0
buffer_load_dwordx4 v73, s[20:23], s46 offen lds
s_add_u32 m0, s45, 2048
s_nop 0
buffer_load_dwordx4 v74, s[20:23], s46 offen lds
v_mfma_f32_32x32x16_bf16 v[48:63], v[20:23], v[128:131], v[48:63]
s_waitcnt lgkmcnt(2)
ds_read_b128 v[16:19], v68 offset:256
s_add_u32 m0, s45, 3072
s_nop 0
buffer_load_dwordx4 v75, s[20:23], s46 offen lds
s_add_u32 m0, s45, 4096
s_nop 0
buffer_load_dwordx4 v76, s[20:23], s46 offen lds
v_mfma_f32_32x32x16_bf16 v[48:63], v[24:27], v[132:135], v[48:63]
s_waitcnt lgkmcnt(2)
ds_read_b128 v[20:23], v69 offset:256
s_add_u32 m0, s45, 5120
s_nop 0
buffer_load_dwordx4 v77, s[20:23], s46 offen lds
s_add_u32 m0, s45, 6144
s_nop 0
buffer_load_dwordx4 v78, s[20:23], s46 offen lds
v_mfma_f32_32x32x16_bf16 v[48:63], v[8:11], v[136:139], v[48:63]
s_waitcnt lgkmcnt(2)
ds_read_b128 v[24:27], v70 offset:256
s_add_u32 m0, s45, 7168
s_nop 0
buffer_load_dwordx4 v79, s[20:23], s46 offen lds
s_add_u32 m0, s45, 8192
s_nop 0
buffer_load_dwordx4 v80, s[20:23], s46 offen lds
v_mfma_f32_32x32x16_bf16 v[48:63], v[12:15], v[140:143], v[48:63]
s_waitcnt lgkmcnt(2)
ds_read_b128 v[8:11], v71 offset:256
s_add_u32 m0, s45, 9216
s_nop 0
buffer_load_dwordx4 v81, s[20:23], s46 offen lds
s_add_u32 s45, s45, 40960
s_cmp_ge_u32 s45, 122880
s_cselect_b32 s55, 122880, 0
s_sub_u32 s45, s45, s55
v_mfma_f32_32x32x16_bf16 v[48:63], v[16:19], v[144:147], v[48:63]
s_waitcnt lgkmcnt(2)
ds_read_b128 v[12:15], v64 offset:512
s_add_u32 s47, s47, 1
s_and_b32 s55, s47, 1
s_mul_i32 s46, s55, 5120
s_and_b32 s55, s47, 2
s_mul_i32 s55, s55, 20480
s_add_u32 s46, s46, s55
s_and_b32 s55, s47, 4
s_mul_i32 s55, s55, 40960
s_add_u32 s46, s46, s55
s_add_u32 s46, s46, s49
v_mfma_f32_32x32x16_bf16 v[48:63], v[20:23], v[148:151], v[48:63]
s_waitcnt lgkmcnt(2)
ds_read_b128 v[16:19], v65 offset:512
v_mfma_f32_32x32x16_bf16 v[48:63], v[24:27], v[152:155], v[48:63]
s_waitcnt lgkmcnt(2)
ds_read_b128 v[20:23], v66 offset:512
v_mfma_f32_32x32x16_bf16 v[48:63], v[8:11], v[156:159], v[48:63]
s_waitcnt lgkmcnt(2)
ds_read_b128 v[24:27], v67 offset:512
v_mfma_f32_32x32x16_bf16 v[48:63], v[12:15], v[160:163], v[48:63]
s_waitcnt lgkmcnt(2)
ds_read_b128 v[8:11], v68 offset:512
v_mfma_f32_32x32x16_bf16 v[48:63], v[16:19], v[164:167], v[48:63]
s_waitcnt lgkmcnt(2)
ds_read_b128 v[12:15], v69 offset:512
v_mfma_f32_32x32x16_bf16 v[48:63], v[20:23], v[168:171], v[48:63]
s_waitcnt lgkmcnt(2)
ds_read_b128 v[16:19], v70 offset:512
v_mfma_f32_32x32x16_bf16 v[48:63], v[24:27], v[172:175], v[48:63]
s_waitcnt lgkmcnt(2)
ds_read_b128 v[20:23], v71 offset:512
v_mfma_f32_32x32x16_bf16 v[48:63], v[8:11], v[176:179], v[48:63]
s_waitcnt lgkmcnt(2)
ds_read_b128 v[24:27], v64 offset:768
v_mfma_f32_32x32x16_bf16 v[48:63], v[12:15], v[180:183], v[48:63]
s_waitcnt lgkmcnt(2)
ds_read_b128 v[8:11], v65 offset:768
v_mfma_f32_32x32x16_bf16 v[48:63], v[16:19], v[184:187], v[48:63]
s_waitcnt lgkmcnt(2)
ds_read_b128 v[12:15], v66 offset:768
v_mfma_f32_32x32x16_bf16 v[48:63], v[20:23], v[188:191], v[48:63]
s_waitcnt lgkmcnt(2)
ds_read_b128 v[16:19], v67 offset:768
v_mfma_f32_32x32x16_bf16 v[48:63], v[24:27], v[192:195], v[48:63]
s_waitcnt lgkmcnt(2)
ds_read_b128 v[20:23], v68 offset:768
v_mfma_f32_32x32x16_bf16 v[48:63], v[8:11], v[196:199], v[48:63]
s_waitcnt lgkmcnt(2)
ds_read_b128 v[24:27], v69 offset:768
v_mfma_f32_32x32x16_bf16 v[48:63], v[12:15], v[200:203], v[48:63]
s_waitcnt lgkmcnt(2)
ds_read_b128 v[8:11], v70 offset:768
v_mfma_f32_32x32x16_bf16 v[48:63], v[16:19], v[204:207], v[48:63]
s_waitcnt lgkmcnt(2)
ds_read_b128 v[12:15], v71 offset:768
v_mfma_f32_32x32x16_bf16 v[48:63], v[20:23], v[208:211], v[48:63]
s_waitcnt lgkmcnt(2)
ds_read_b128 v[16:19], v64 offset:1024
v_mfma_f32_32x32x16_bf16 v[48:63], v[24:27], v[212:215], v[48:63]
s_waitcnt lgkmcnt(2)
ds_read_b128 v[20:23], v65 offset:1024
v_mfma_f32_32x32x16_bf16 v[48:63], v[8:11], v[216:219], v[48:63]
s_waitcnt lgkmcnt(2)
ds_read_b128 v[24:27], v66 offset:1024
v_mfma_f32_32x32x16_bf16 v[48:63], v[12:15], v[220:223], v[48:63]
s_waitcnt lgkmcnt(2)
ds_read_b128 v[8:11], v67 offset:1024
v_mfma_f32_32x32x16_bf16 v[48:63], v[16:19], v[224:227], v[48:63]
s_waitcnt lgkmcnt(2)
ds_read_b128 v[12:15], v68 offset:1024
v_mfma_f32_32x32x16_bf16 v[48:63], v[20:23], v[228:231], v[48:63]
s_waitcnt lgkmcnt(2)
ds_read_b128 v[16:19], v69 offset:1024
v_mfma_f32_32x32x16_bf16 v[48:63], v[24:27], v[232:235], v[48:63]
s_waitcnt lgkmcnt(2)
ds_read_b128 v[20:23], v70 offset:1024
v_mfma_f32_32x32x16_bf16 v[48:63], v[8:11], v[236:239], v[48:63]
s_waitcnt lgkmcnt(2)
ds_read_b128 v[24:27], v71 offset:1024
v_mfma_f32_32x32x16_bf16 v[48:63], v[12:15], v[240:243], v[48:63]
s_add_u32 s44, s44, 1
s_cmp_eq_u32 s44, 3
s_mov_b32 s56, 40960
s_cmov_b32 s56, -81920
s_cselect_b32 s44, 0, s44
v_add_u32 v64, s56, v64
v_add_u32 v65, s56, v65
v_add_u32 v66, s56, v66
v_add_u32 v67, s56, v67
v_add_u32 v68, s56, v68
v_add_u32 v69, s56, v69
v_add_u32 v70, s56, v70
v_add_u32 v71, s56, v71
s_waitcnt vmcnt(10) lgkmcnt(2)
s_barrier
ds_read_b128 v[8:11], v64 offset:0
v_mfma_f32_32x32x16_bf16 v[48:63], v[16:19], v[244:247], v[48:63]
s_waitcnt lgkmcnt(2)
ds_read_b128 v[12:15], v65 offset:0
v_mfma_f32_32x32x16_bf16 v[48:63], v[20:23], v[248:251], v[48:63]
s_waitcnt lgkmcnt(2)
ds_read_b128 v[16:19], v66 offset:0
v_mfma_f32_32x32x16_bf16 v[48:63], v[24:27], v[252:255], v[48:63]
s_waitcnt lgkmcnt(2)
ds_read_b128 v[20:23], v67 offset:0
k_sm_107:
s_sub_u32 s59, s59, 1
s_cmp_eq_u32 s59, 0
s_cbranch_scc1 k_so_106
v_mfma_f32_32x32x16_bf16 v[32:47], v[8:11], v[96:99], 0
s_waitcnt lgkmcnt(2)
ds_read_b128 v[24:27], v68 offset:0
v_mfma_f32_32x32x16_bf16 v[32:47], v[12:15], v[100:103], v[32:47]
s_waitcnt lgkmcnt(2)
ds_read_b128 v[8:11], v69 offset:0
v_cvt_pk_bf16_f32 v48, v48, v49
v_cvt_pk_bf16_f32 v49, v50, v51
v_mfma_f32_32x32x16_bf16 v[32:47], v[16:19], v[104:107], v[32:47]
s_waitcnt lgkmcnt(2)
ds_read_b128 v[12:15], v70 offset:0
v_cvt_pk_bf16_f32 v50, v52, v53
v_cvt_pk_bf16_f32 v51, v54, v55
v_mfma_f32_32x32x16_bf16 v[32:47], v[20:23], v[108:111], v[32:47]
s_waitcnt lgkmcnt(2)
ds_read_b128 v[16:19], v71 offset:0
v_cvt_pk_bf16_f32 v52, v56, v57
v_cvt_pk_bf16_f32 v53, v58, v59
v_mfma_f32_32x32x16_bf16 v[32:47], v[24:27], v[112:115], v[32:47]
s_waitcnt lgkmcnt(2)
ds_read_b128 v[20:23], v64 offset:256
v_cvt_pk_bf16_f32 v54, v60, v61
v_cvt_pk_bf16_f32 v55, v62, v63
v_mfma_f32_32x32x16_bf16 v[32:47], v[8:11], v[116:119], v[32:47]
s_waitcnt lgkmcnt(2)
ds_read_b128 v[24:27], v65 offset:256
buffer_store_dwordx4 v[48:51], v1, s[4:7], s48 offen offset:0 sc1
buffer_store_dwordx4 v[52:55], v1, s[4:7], s48 offen offset:1024 sc1
v_mfma_f32_32x32x16_bf16 v[32:47], v[12:15], v[120:123], v[32:47]
s_waitcnt lgkmcnt(2)
ds_read_b128 v[8:11], v66 offset:256
s_add_u32 s48, s48, s50
s_sub_u32 s50, 4096, s50
s_add_u32 m0, s45, 0
s_nop 0
buffer_load_dwordx4 v72, s[20:23], s46 offen lds
v_mfma_f32_32x32x16_bf16 v[32:47], v[16:19], v[124:127], v[32:47]
s_waitcnt lgkmcnt(2)
ds_read_b128 v[12:15], v67 offset:256
s_add_u32 m0, s45, 1024
s_nop 0
buffer_load_dwordx4 v73, s[20:23], s46 offen lds
s_add_u32 m0, s45, 2048
s_nop 0
buffer_load_dwordx4 v74, s[20:23], s46 offen lds
v_mfma_f32_32x32x16_bf16 v[32:47], v[20:23], v[128:131], v[32:47]
s_waitcnt lgkmcnt(2)
ds_read_b128 v[16:19], v68 offset:256
s_add_u32 m0, s45, 3072
s_nop 0
buffer_load_dwordx4 v75, s[20:23], s46 offen lds
s_add_u32 m0, s45, 4096
s_nop 0
buffer_load_dwordx4 v76, s[20:23], s46 offen lds
v_mfma_f32_32x32x16_bf16 v[32:47], v[24:27], v[132:135], v[32:47]
s_waitcnt lgkmcnt(2)
ds_read_b128 v[20:23], v69 offset:256
s_add_u32 m0, s45, 5120
s_nop 0
buffer_load_dwordx4 v77, s[20:23], s46 offen lds
s_add_u32 m0, s45, 6144
s_nop 0
buffer_load_dwordx4 v78, s[20:23], s46 offen lds
v_mfma_f32_32x32x16_bf16 v[32:47], v[8:11], v[136:139], v[32:47]
s_waitcnt lgkmcnt(2)
ds_read_b128 v[24:27], v70 offset:256
s_add_u32 m0, s45, 7168
s_nop 0
buffer_load_dwordx4 v79, s[20:23], s46 offen lds
s_add_u32 m0, s45, 8192
s_nop 0
buffer_load_dwordx4 v80, s[20:23], s46 offen lds
v_mfma_f32_32x32x16_bf16 v[32:47], v[12:15], v[140:143], v[32:47]
s_waitcnt lgkmcnt(2)
ds_read_b128 v[8:11], v71 offset:256
s_add_u32 m0, s45, 9216
s_nop 0
buffer_load_dwordx4 v81, s[20:23], s46 offen lds
s_add_u32 s45, s45, 40960
s_cmp_ge_u32 s45, 122880
s_cselect_b32 s55, 122880, 0
s_sub_u32 s45, s45, s55
v_mfma_f32_32x32x16_bf16 v[32:47], v[16:19], v[144:147], v[32:47]
s_waitcnt lgkmcnt(2)
ds_read_b128 v[12:15], v64 offset:512
s_add_u32 s47, s47, 1
s_and_b32 s55, s47, 1
s_mul_i32 s46, s55, 5120
s_and_b32 s55, s47, 2
s_mul_i32 s55, s55, 20480
s_add_u32 s46, s46, s55
s_and_b32 s55, s47, 4
s_mul_i32 s55, s55, 40960
s_add_u32 s46, s46, s55
s_add_u32 s46, s46, s49
v_mfma_f32_32x32x16_bf16 v[32:47], v[20:23], v[148:151], v[32:47]
s_waitcnt lgkmcnt(2)
ds_read_b128 v[16:19], v65 offset:512
v_mfma_f32_32x32x16_bf16 v[32:47], v[24:27], v[152:155], v[32:47]
s_waitcnt lgkmcnt(2)
ds_read_b128 v[20:23], v66 offset:512
v_mfma_f32_32x32x16_bf16 v[32:47], v[8:11], v[156:159], v[32:47]
s_waitcnt lgkmcnt(2)
ds_read_b128 v[24:27], v67 offset:512
v_mfma_f32_32x32x16_bf16 v[32:47], v[12:15], v[160:163], v[32:47]
s_waitcnt lgkmcnt(2)
ds_read_b128 v[8:11], v68 offset:512
v_mfma_f32_32x32x16_bf16 v[32:47], v[16:19], v[164:167], v[32:47]
s_waitcnt lgkmcnt(2)
ds_read_b128 v[12:15], v69 offset:512
v_mfma_f32_32x32x16_bf16 v[32:47], v[20:23], v[168:171], v[32:47]
s_waitcnt lgkmcnt(2)
ds_read_b128 v[16:19], v70 offset:512
v_mfma_f32_32x32x16_bf16 v[32:47], v[24:27], v[172:175], v[32:47]
s_waitcnt lgkmcnt(2)
ds_read_b128 v[20:23], v71 offset:512
v_mfma_f32_32x32x16_bf16 v[32:47], v[8:11], v[176:179], v[32:47]
s_waitcnt lgkmcnt(2)
ds_read_b128 v[24:27], v64 offset:768
v_mfma_f32_32x32x16_bf16 v[32:47], v[12:15], v[180:183], v[32:47]
s_waitcnt lgkmcnt(2)
ds_read_b128 v[8:11], v65 offset:768
v_mfma_f32_32x32x16_bf16 v[32:47], v[16:19], v[184:187], v[32:47]
s_waitcnt lgkmcnt(2)
ds_read_b128 v[12:15], v66 offset:768
v_mfma_f32_32x32x16_bf16 v[32:47], v[20:23], v[188:191], v[32:47]
s_waitcnt lgkmcnt(2)
ds_read_b128 v[16:19], v67 offset:768
v_mfma_f32_32x32x16_bf16 v[32:47], v[24:27], v[192:195], v[32:47]
s_waitcnt lgkmcnt(2)
ds_read_b128 v[20:23], v68 offset:768
v_mfma_f32_32x32x16_bf16 v[32:47], v[8:11], v[196:199], v[32:47]
s_waitcnt lgkmcnt(2)
ds_read_b128 v[24:27], v69 offset:768
v_mfma_f32_32x32x16_bf16 v[32:47], v[12:15], v[200:203], v[32:47]
s_waitcnt lgkmcnt(2)
ds_read_b128 v[8:11], v70 offset:768
v_mfma_f32_32x32x16_bf16 v[32:47], v[16:19], v[204:207], v[32:47]
s_waitcnt lgkmcnt(2)
ds_read_b128 v[12:15], v71 offset:768
v_mfma_f32_32x32x16_bf16 v[32:47], v[20:23], v[208:211], v[32:47]
s_waitcnt lgkmcnt(2)
ds_read_b128 v[16:19], v64 offset:1024
v_mfma_f32_32x32x16_bf16 v[32:47], v[24:27], v[212:215], v[32:47]
s_waitcnt lgkmcnt(2)
ds_read_b128 v[20:23], v65 offset:1024
v_mfma_f32_32x32x16_bf16 v[32:47], v[8:11], v[216:219], v[32:47]
s_waitcnt lgkmcnt(2)
ds_read_b128 v[24:27], v66 offset:1024
v_mfma_f32_32x32x16_bf16 v[32:47], v[12:15], v[220:223], v[32:47]
s_waitcnt lgkmcnt(2)
ds_read_b128 v[8:11], v67 offset:1024
v_mfma_f32_32x32x16_bf16 v[32:47], v[16:19], v[224:227], v[32:47]
s_waitcnt lgkmcnt(2)
ds_read_b128 v[12:15], v68 offset:1024
v_mfma_f32_32x32x16_bf16 v[32:47], v[20:23], v[228:231], v[32:47]
s_waitcnt lgkmcnt(2)
ds_read_b128 v[16:19], v69 offset:1024
v_mfma_f32_32x32x16_bf16 v[32:47], v[24:27], v[232:235], v[32:47]
s_waitcnt lgkmcnt(2)
ds_read_b128 v[20:23], v70 offset:1024
v_mfma_f32_32x32x16_bf16 v[32:47], v[8:11], v[236:239], v[32:47]
s_waitcnt lgkmcnt(2)
ds_read_b128 v[24:27], v71 offset:1024
v_mfma_f32_32x32x16_bf16 v[32:47], v[12:15], v[240:243], v[32:47]
s_add_u32 s44, s44, 1
s_cmp_eq_u32 s44, 3
s_mov_b32 s56, 40960
s_cmov_b32 s56, -81920
s_cselect_b32 s44, 0, s44
v_add_u32 v64, s56, v64
v_add_u32 v65, s56, v65
v_add_u32 v66, s56, v66
v_add_u32 v67, s56, v67
v_add_u32 v68, s56, v68
v_add_u32 v69, s56, v69
v_add_u32 v70, s56, v70
v_add_u32 v71, s56, v71
s_waitcnt vmcnt(10) lgkmcnt(2)
s_barrier
ds_read_b128 v[8:11], v64 offset:0
v_mfma_f32_32x32x16_bf16 v[32:47], v[16:19], v[244:247], v[32:47]
s_waitcnt lgkmcnt(2)
ds_read_b128 v[12:15], v65 offset:0
v_mfma_f32_32x32x16_bf16 v[32:47], v[20:23], v[248:251], v[32:47]
s_waitcnt lgkmcnt(2)
ds_read_b128 v[16:19], v66 offset:0
v_mfma_f32_32x32x16_bf16 v[32:47], v[24:27], v[252:255], v[32:47]
s_waitcnt lgkmcnt(2)
ds_read_b128 v[20:23], v67 offset:0
s_branch k_st_105
k_so_106:
s_nop 6
v_cvt_pk_bf16_f32 v48, v48, v49
v_cvt_pk_bf16_f32 v49, v50, v51
v_cvt_pk_bf16_f32 v50, v52, v53
v_cvt_pk_bf16_f32 v51, v54, v55
v_cvt_pk_bf16_f32 v52, v56, v57
v_cvt_pk_bf16_f32 v53, v58, v59
v_cvt_pk_bf16_f32 v54, v60, v61
v_cvt_pk_bf16_f32 v55, v62, v63
buffer_store_dwordx4 v[48:51], v1, s[4:7], s48 offen offset:0 sc1
buffer_store_dwordx4 v[52:55], v1, s[4:7], s48 offen offset:1024 sc1
s_add_u32 s48, s48, s50
s_sub_u32 s50, 4096, s50
s_lshl_b32 s54, s30, 6
s_add_u32 s54, s54, 222322688
s_waitcnt lgkmcnt(0)
s_waitcnt vmcnt(0)
s_barrier
s_cmp_lg_u32 s3, 0
s_cbranch_scc1 k_s8_108
s_mov_b64 exec, 1
v_mov_b32 v2, 1
buffer_store_dword v2, off, s[4:7], s54 sc1
s_mov_b64 exec, -1
k_s8_108:
s_mul_i32 s57, s30, 3277
s_lshr_b32 s57, s57, 16
s_mul_i32 s52, s57, 20
s_sub_u32 s58, s30, s52
s_mov_b32 s54, 222322688
v_add_u32 v10, 4096, v0
v_add_u32 v11, 8192, v0
v_add_u32 v12, 12288, v0
s_cmp_lg_u32 s3, 0
s_cbranch_scc1 k_w8d_110
v_lshlrev_b32 v96, 2, v0
k_w8_109:
buffer_load_dword v97, v96, s[4:7], s54 offen sc1
buffer_load_dword v98, v96, s[4:7], s54 offen offset:1024 sc1
s_waitcnt vmcnt(0)
v_and_b32 v97, v97, v98
v_cmp_eq_u32 vcc, 0, v97
s_cbranch_vccz k_w8d_110
s_sleep 1
s_sub_u32 s32, s32, 1
s_cmp_gt_i32 s32, 0
s_cbranch_scc1 k_w8_109
k_w8d_110:
s_barrier
s_lshl_b32 s52, s58, 2
s_add_u32 s52, s52, s3
s_lshl_b32 s52, s52, 16
s_add_u32 s52, s52, 216006656
buffer_load_dwordx4 a[0:3], v0, s[4:7], s52 offen offset:0 sc1
buffer_load_dwordx4 a[4:7], v0, s[4:7], s52 offen offset:1024 sc1
buffer_load_dwordx4 a[8:11], v0, s[4:7], s52 offen offset:2048 sc1
buffer_load_dwordx4 a[12:15], v0, s[4:7], s52 offen offset:3072 sc1
buffer_load_dwordx4 a[16:19], v10, s[4:7], s52 offen offset:0 sc1
buffer_load_dwordx4 a[20:23], v10, s[4:7], s52 offen offset:1024 sc1
buffer_load_dwordx4 a[24:27], v10, s[4:7], s52 offen offset:2048 sc1
buffer_load_dwordx4 a[28:31], v10, s[4:7], s52 offen offset:3072 sc1
buffer_load_dwordx4 a[32:35], v11, s[4:7], s52 offen offset:0 sc1
buffer_load_dwordx4 a[36:39], v11, s[4:7], s52 offen offset:1024 sc1
buffer_load_dwordx4 a[40:43], v11, s[4:7], s52 offen offset:2048 sc1
buffer_load_dwordx4 a[44:47], v11, s[4:7], s52 offen offset:3072 sc1
buffer_load_dwordx4 a[48:51], v12, s[4:7], s52 offen offset:0 sc1
buffer_load_dwordx4 a[52:55], v12, s[4:7], s52 offen offset:1024 sc1
buffer_load_dwordx4 a[56:59], v12, s[4:7], s52 offen offset:2048 sc1
buffer_load_dwordx4 a[60:63], v12, s[4:7], s52 offen offset:3072 sc1
s_add_u32 s52, s52, 16384
buffer_load_dwordx4 a[64:67], v0, s[4:7], s52 offen offset:0 sc1
buffer_load_dwordx4 a[68:71], v0, s[4:7], s52 offen offset:1024 sc1
buffer_load_dwordx4 a[72:75], v0, s[4:7], s52 offen offset:2048 sc1
buffer_load_dwordx4 a[76:79], v0, s[4:7], s52 offen offset:3072 sc1
buffer_load_dwordx4 a[80:83], v10, s[4:7], s52 offen offset:0 sc1
buffer_load_dwordx4 a[84:87], v10, s[4:7], s52 offen offset:1024 sc1
buffer_load_dwordx4 a[88:91], v10, s[4:7], s52 offen offset:2048 sc1
buffer_load_dwordx4 a[92:95], v10, s[4:7], s52 offen offset:3072 sc1
buffer_load_dwordx4 a[96:99], v11, s[4:7], s52 offen offset:0 sc1
buffer_load_dwordx4 a[100:103], v11, s[4:7], s52 offen offset:1024 sc1
buffer_load_dwordx4 a[104:107], v11, s[4:7], s52 offen offset:2048 sc1
buffer_load_dwordx4 a[108:111], v11, s[4:7], s52 offen offset:3072 sc1
buffer_load_dwordx4 a[112:115], v12, s[4:7], s52 offen offset:0 sc1
buffer_load_dwordx4 a[116:119], v12, s[4:7], s52 offen offset:1024 sc1
buffer_load_dwordx4 a[120:123], v12, s[4:7], s52 offen offset:2048 sc1
buffer_load_dwordx4 a[124:127], v12, s[4:7], s52 offen offset:3072 sc1
s_waitcnt vmcnt(0)
s_add_u32 s52, s52, 16384
buffer_load_dwordx4 a[128:131], v0, s[4:7], s52 offen offset:0 sc1
buffer_load_dwordx4 a[132:135], v0, s[4:7], s52 offen offset:1024 sc1
buffer_load_dwordx4 a[136:139], v0, s[4:7], s52 offen offset:2048 sc1
buffer_load_dwordx4 a[140:143], v0, s[4:7], s52 offen offset:3072 sc1
buffer_load_dwordx4 a[144:147], v10, s[4:7], s52 offen offset:0 sc1
buffer_load_dwordx4 a[148:151], v10, s[4:7], s52 offen offset:1024 sc1
buffer_load_dwordx4 a[152:155], v10, s[4:7], s52 offen offset:2048 sc1
buffer_load_dwordx4 a[156:159], v10, s[4:7], s52 offen offset:3072 sc1
buffer_load_dwordx4 a[160:163], v11, s[4:7], s52 offen offset:0 sc1
buffer_load_dwordx4 a[164:167], v11, s[4:7], s52 offen offset:1024 sc1
buffer_load_dwordx4 a[168:171], v11, s[4:7], s52 offen offset:2048 sc1
buffer_load_dwordx4 a[172:175], v11, s[4:7], s52 offen offset:3072 sc1
buffer_load_dwordx4 a[176:179], v12, s[4:7], s52 offen offset:0 sc1
buffer_load_dwordx4 a[180:183], v12, s[4:7], s52 offen offset:1024 sc1
buffer_load_dwordx4 a[184:187], v12, s[4:7], s52 offen offset:2048 sc1
buffer_load_dwordx4 a[188:191], v12, s[4:7], s52 offen offset:3072 sc1
s_add_u32 s52, s52, 16384
buffer_load_dwordx4 a[192:195], v0, s[4:7], s52 offen offset:0 sc1
buffer_load_dwordx4 a[196:199], v0, s[4:7], s52 offen offset:1024 sc1
buffer_load_dwordx4 a[200:203], v0, s[4:7], s52 offen offset:2048 sc1
buffer_load_dwordx4 a[204:207], v0, s[4:7], s52 offen offset:3072 sc1
buffer_load_dwordx4 a[208:211], v10, s[4:7], s52 offen offset:0 sc1
buffer_load_dwordx4 a[212:215], v10, s[4:7], s52 offen offset:1024 sc1
buffer_load_dwordx4 a[216:219], v10, s[4:7], s52 offen offset:2048 sc1
buffer_load_dwordx4 a[220:223], v10, s[4:7], s52 offen offset:3072 sc1
buffer_load_dwordx4 a[224:227], v11, s[4:7], s52 offen offset:0 sc1
buffer_load_dwordx4 a[228:231], v11, s[4:7], s52 offen offset:1024 sc1
buffer_load_dwordx4 a[232:235], v11, s[4:7], s52 offen offset:2048 sc1
buffer_load_dwordx4 a[236:239], v11, s[4:7], s52 offen offset:3072 sc1
buffer_load_dwordx4 a[240:243], v12, s[4:7], s52 offen offset:0 sc1
buffer_load_dwordx4 a[244:247], v12, s[4:7], s52 offen offset:1024 sc1
buffer_load_dwordx4 a[248:251], v12, s[4:7], s52 offen offset:2048 sc1
buffer_load_dwordx4 a[252:255], v12, s[4:7], s52 offen offset:3072 sc1
s_waitcnt vmcnt(0)
s_lshl_b32 s46, s57, 16
s_lshl_b32 s52, s3, 14
s_add_u32 s46, s46, s52
s_add_u32 s46, s46, 159383552
s_lshl_b32 s53, s57, 7
s_lshl_b32 s44, s58, 11
s_add_u32 s44, s44, s53
s_add_u32 s44, s44, 195035136
s_lshl_b32 s45, s58, 17
s_add_u32 s45, s45, s53
s_add_u32 s45, s45, 205520896
s_lshl_b32 s48, s58, 7
s_lshl_b32 s53, s57, 5
s_add_u32 s48, s48, s53
s_add_u32 s48, s48, 211812352
s_lshr_b32 s49, s57, 1
s_lshl_b32 s49, s49, 8
s_lshl_b32 s53, s3, 5
s_add_u32 s49, s49, s53
s_add_u32 s49, s49, 222339072
s_mov_b32 s50, 1
v_lshrrev_b32 v96, 4, v0
v_and_b32 v97, 8, v96
v_cmp_ne_u32 vcc, 0, v97
v_mov_b32 v1, 0x4444
v_mov_b32 v97, 0xeeee
v_cndmask_b32 v1, v1, v97, vcc
v_and_b32 v97, 7, v96
v_lshrrev_b32 v98, 3, v96
v_lshlrev_b32 v2, 2, v97
v_mul_u32_u24 v4, 144, v98
v_lshl_add_u32 v4, v97, 4, v4
v_and_b32 v99, 1, v96
v_lshlrev_b32 v99, 3, v99
v_lshl_add_u32 v99, v98, 4, v99
v_bfe_u32 v100, v96, 1, 2
v_lshl_add_u32 v5, v100, 9, v99
v_lshl_add_u32 v6, v100, 15, v99
v_lshlrev_b32 v7, 2, v98
v_mov_b32 v99, 2146435072
v_cmp_eq_u32 vcc, 0, v97
s_nop 1
v_cndmask_b32 v7, v99, v7, vcc
v_add_u32 v97, s58, v97
v_cmp_eq_u32 vcc, 0, v97
s_nop 1
v_cndmask_b32 v9, 1.0, 0, vcc
v_and_b32 v3, 15, v96
v_bfe_u32 v97, v96, 4, 1
v_mul_u32_u24 v97, 144, v97
v_add_u32 v3, v3, v97
v_lshrrev_b32 v97, 5, v96
v_lshl_add_u32 v3, v97, 4, v3
v_lshlrev_b32 v3, 2, v3
s_mul_i32 s52, s3, 1152
v_add_u32 v3, s52, v3
s_mov_b32 s56, 8192
k_poll_112:
buffer_load_dword v8, v2, s[4:7], s49 offen sc1
s_waitcnt vmcnt(0)
v_cmp_gt_u32 vcc, s50, v8
s_cbranch_vccz k_pd_113
s_sleep 1
s_sub_u32 s32, s32, 1
s_cmp_gt_i32 s32, 0
s_cbranch_scc1 k_poll_112
k_pd_113:
buffer_load_dwordx2 v[14:15], v5, s[4:7], s44 offen sc1
buffer_load_dwordx4 v[32:35], v0, s[4:7], s46 offen offset:0 sc1
buffer_load_dwordx4 v[36:39], v0, s[4:7], s46 offen offset:1024 sc1
buffer_load_dwordx4 v[40:43], v0, s[4:7], s46 offen offset:2048 sc1
buffer_load_dwordx4 v[44:47], v0, s[4:7], s46 offen offset:3072 sc1
buffer_load_dwordx4 v[48:51], v10, s[4:7], s46 offen offset:0 sc1
buffer_load_dwordx4 v[52:55], v10, s[4:7], s46 offen offset:1024 sc1
buffer_load_dwordx4 v[56:59], v10, s[4:7], s46 offen offset:2048 sc1
buffer_load_dwordx4 v[60:63], v10, s[4:7], s46 offen offset:3072 sc1
buffer_load_dwordx4 v[64:67], v11, s[4:7], s46 offen offset:0 sc1
buffer_load_dwordx4 v[68:71], v11, s[4:7], s46 offen offset:1024 sc1
buffer_load_dwordx4 v[72:75], v11, s[4:7], s46 offen offset:2048 sc1
buffer_load_dwordx4 v[76:79], v11, s[4:7], s46 offen offset:3072 sc1
buffer_load_dwordx4 v[80:83], v12, s[4:7], s46 offen offset:0 sc1
buffer_load_dwordx4 v[84:87], v12, s[4:7], s46 offen offset:1024 sc1
buffer_load_dwordx4 v[88:91], v12, s[4:7], s46 offen offset:2048 sc1
buffer_load_dwordx4 v[92:95], v12, s[4:7], s46 offen offset:3072 sc1
s_xor_b32 s49, s49, 512
buffer_load_dword v8, v2, s[4:7], s49 offen sc1
k_top_111:
v_mov_b64 v[24:25], 0
v_mov_b64 v[26:27], 0
v_mov_b64 v[28:29], 0
v_mov_b64 v[30:31], 0
s_add_u32 s50, s50, 1
s_add_u32 s46, s46, 262144
s_add_u32 s44, s44, 40960
s_cmp_eq_u32 s50, 65
s_cselect_b32 s52, 1048576, 0
s_cselect_b32 s53, 524288, 0
s_add_u32 s46, s46, s52
s_add_u32 s44, s44, s53
s_waitcnt vmcnt(17)
v_lshlrev_b32 v16, 16, v14
v_and_b32 v17, 0xffff0000, v14
v_lshlrev_b32 v18, 16, v15
v_and_b32 v19, 0xffff0000, v15
s_waitcnt vmcnt(16)
v_smfmac_f32_16x16x64_bf16 v[24:27], v[32:35], a[0:7], v1
v_smfmac_f32_16x16x64_bf16 v[28:31], v[32:35], a[8:15], v1
s_waitcnt vmcnt(15)
v_smfmac_f32_16x16x64_bf16 v[24:27], v[36:39], a[16:23], v1
v_smfmac_f32_16x16x64_bf16 v[28:31], v[36:39], a[24:31], v1
s_waitcnt vmcnt(14)
v_smfmac_f32_16x16x64_bf16 v[24:27], v[40:43], a[32:39], v1
v_smfmac_f32_16x16x64_bf16 v[28:31], v[40:43], a[40:47], v1
s_waitcnt vmcnt(13)
v_smfmac_f32_16x16x64_bf16 v[24:27], v[44:47], a[48:55], v1
v_smfmac_f32_16x16x64_bf16 v[28:31], v[44:47], a[56:63], v1
s_waitcnt vmcnt(12)
v_smfmac_f32_16x16x64_bf16 v[24:27], v[48:51], a[64:71], v1
v_smfmac_f32_16x16x64_bf16 v[28:31], v[48:51], a[72:79], v1
s_waitcnt vmcnt(11)
v_smfmac_f32_16x16x64_bf16 v[24:27], v[52:55], a[80:87], v1
v_smfmac_f32_16x16x64_bf16 v[28:31], v[52:55], a[88:95], v1
s_waitcnt vmcnt(10)
v_smfmac_f32_16x16x64_bf16 v[24:27], v[56:59], a[96:103], v1
v_smfmac_f32_16x16x64_bf16 v[28:31], v[56:59], a[104:111], v1
s_waitcnt vmcnt(9)
v_smfmac_f32_16x16x64_bf16 v[24:27], v[60:63], a[112:119], v1
v_smfmac_f32_16x16x64_bf16 v[28:31], v[60:63], a[120:127], v1
s_waitcnt vmcnt(8)
v_smfmac_f32_16x16x64_bf16 v[24:27], v[64:67], a[128:135], v1
v_smfmac_f32_16x16x64_bf16 v[28:31], v[64:67], a[136:143], v1
s_waitcnt vmcnt(7)
v_smfmac_f32_16x16x64_bf16 v[24:27], v[68:71], a[144:151], v1
v_smfmac_f32_16x16x64_bf16 v[28:31], v[68:71], a[152:159], v1
s_waitcnt vmcnt(6)
v_smfmac_f32_16x16x64_bf16 v[24:27], v[72:75], a[160:167], v1
v_smfmac_f32_16x16x64_bf16 v[28:31], v[72:75], a[168:175], v1
s_waitcnt vmcnt(5)
v_smfmac_f32_16x16x64_bf16 v[24:27], v[76:79], a[176:183], v1
v_smfmac_f32_16x16x64_bf16 v[28:31], v[76:79], a[184:191], v1
s_waitcnt vmcnt(4)
v_smfmac_f32_16x16x64_bf16 v[24:27], v[80:83], a[192:199], v1
v_smfmac_f32_16x16x64_bf16 v[28:31], v[80:83], a[200:207], v1
s_waitcnt vmcnt(3)
v_smfmac_f32_16x16x64_bf16 v[24:27], v[84:87], a[208:215], v1
v_smfmac_f32_16x16x64_bf16 v[28:31], v[84:87], a[216:223], v1
s_waitcnt vmcnt(2)
v_smfmac_f32_16x16x64_bf16 v[24:27], v[88:91], a[224:231], v1
v_smfmac_f32_16x16x64_bf16 v[28:31], v[88:91], a[232:239], v1
s_waitcnt vmcnt(1)
v_smfmac_f32_16x16x64_bf16 v[24:27], v[92:95], a[240:247], v1
v_smfmac_f32_16x16x64_bf16 v[28:31], v[92:95], a[248:255], v1
s_waitcnt vmcnt(0)
v_cmp_gt_u32 vcc, s50, v8
s_mov_b32 s47, 0
s_cbranch_vccnz k_nr_114
s_mov_b32 s47, 1
buffer_load_dwordx2 v[14:15], v5, s[4:7], s44 offen sc1
buffer_load_dwordx4 v[32:35], v0, s[4:7], s46 offen offset:0 sc1
buffer_load_dwordx4 v[36:39], v0, s[4:7], s46 offen offset:1024 sc1
buffer_load_dwordx4 v[40:43], v0, s[4:7], s46 offen offset:2048 sc1
buffer_load_dwordx4 v[44:47], v0, s[4:7], s46 offen offset:3072 sc1
buffer_load_dwordx4 v[48:51], v10, s[4:7], s46 offen offset:0 sc1
buffer_load_dwordx4 v[52:55], v10, s[4:7], s46 offen offset:1024 sc1
buffer_load_dwordx4 v[56:59], v10, s[4:7], s46 offen offset:2048 sc1
buffer_load_dwordx4 v[60:63], v10, s[4:7], s46 offen offset:3072 sc1
buffer_load_dwordx4 v[64:67], v11, s[4:7], s46 offen offset:0 sc1
buffer_load_dwordx4 v[68:71], v11, s[4:7], s46 offen offset:1024 sc1
buffer_load_dwordx4 v[72:75], v11, s[4:7], s46 offen offset:2048 sc1
buffer_load_dwordx4 v[76:79], v11, s[4:7], s46 offen offset:3072 sc1
buffer_load_dwordx4 v[80:83], v12, s[4:7], s46 offen offset:0 sc1
buffer_load_dwordx4 v[84:87], v12, s[4:7], s46 offen offset:1024 sc1
buffer_load_dwordx4 v[88:91], v12, s[4:7], s46 offen offset:2048 sc1
buffer_load_dwordx4 v[92:95], v12, s[4:7], s46 offen offset:3072 sc1
s_xor_b32 s49, s49, 512
buffer_load_dword v8, v2, s[4:7], s49 offen sc1
k_nr_114:
s_nop 2
v_permlane32_swap_b32 v24, v28
v_permlane32_swap_b32 v25, v29
v_permlane32_swap_b32 v26, v30
v_permlane32_swap_b32 v27, v31
v_add_f32 v24, v24, v28
ds_write_b32 v3, v24 offset:0
v_add_f32 v25, v25, v29
ds_write_b32 v3, v25 offset:144
v_add_f32 v26, v26, v30
ds_write_b32 v3, v26 offset:288
v_add_f32 v27, v27, v31
ds_write_b32 v3, v27 offset:432
v_add_u32 v3, s56, v3
s_waitcnt lgkmcnt(0)
s_barrier
s_cmp_lg_u32 s3, 0
s_cbranch_scc1 k_ne_115
ds_read_b128 v[96:99], v4 offset:0
ds_read_b128 v[100:103], v4 offset:1152
ds_read_b128 v[104:107], v4 offset:2304
ds_read_b128 v[108:111], v4 offset:3456
v_add_u32 v4, s56, v4
s_waitcnt lgkmcnt(3)
v_add_f32 v16, v16, v96
v_add_f32 v17, v17, v97
v_add_f32 v18, v18, v98
v_add_f32 v19, v19, v99
s_waitcnt lgkmcnt(2)
v_add_f32 v16, v16, v100
v_add_f32 v17, v17, v101
v_add_f32 v18, v18, v102
v_add_f32 v19, v19, v103
s_waitcnt lgkmcnt(1)
v_add_f32 v16, v16, v104
v_add_f32 v17, v17, v105
v_add_f32 v18, v18, v106
v_add_f32 v19, v19, v107
s_waitcnt lgkmcnt(0)
v_add_f32 v16, v16, v108
v_add_f32 v17, v17, v109
v_add_f32 v18, v18, v110
v_add_f32 v19, v19, v111
v_cvt_pk_bf16_f32 v96, v16, v17
v_cvt_pk_bf16_f32 v97, v18, v19
buffer_store_dwordx2 v[96:97], v6, s[4:7], s45 offen sc1
v_mul_f32 v17, v9, v17
v_mul_f32 v16, v16, v16
v_fmac_f32 v16, v17, v17
v_fmac_f32 v16, v18, v18
v_fmac_f32 v16, v19, v19
s_nop 1
v_add_f32_dpp v16, v16, v16 quad_perm:[1,0,3,2] row_mask:0xf bank_mask:0xf
s_nop 1
v_add_f32_dpp v16, v16, v16 quad_perm:[2,3,0,1] row_mask:0xf bank_mask:0xf
s_nop 1
v_add_f32_dpp v16, v16, v16 row_half_mirror row_mask:0xf bank_mask:0xf
buffer_store_dword v16, v7, s[4:7], s48 offen sc1
s_add_u32 s45, s45, 512
s_add_u32 s48, s48, 2560
s_cmp_eq_u32 s50, 65
s_cbranch_scc0 k_ne_115
s_add_u32 s45, s45, 3112960
s_add_u32 s48, s48, 884736
k_ne_115:
s_sub_u32 s56, 0, s56
s_cmp_eq_u32 s47, 1
s_cbranch_scc1 k_top_111
s_cmp_le_u32 s50, 128
s_cbranch_scc1 k_poll_112
s_waitcnt vmcnt(0) lgkmcnt(0)
s_barrier
k_fin_7:
s_mul_i32 s57, s30, 52429
s_lshr_b32 s57, s57, 18
s_mul_i32 s52, s57, 5
s_sub_u32 s58, s30, s52
s_lshl_b32 s58, s58, 2
s_add_u32 s58, s58, s3
s_mul_i32 s53, s58, 40960
s_add_u32 s53, s53, 214958080
s_load_dwordx2 s[36:37], s[0:1], 80
s_mov_b32 s38, 2621440
s_mov_b32 s39, 0x20000
buffer_load_dwordx4 v[96:99], v0, s[4:7], s53 offen offset:0 sc1
buffer_load_dwordx4 v[100:103], v0, s[4:7], s53 offen offset:1024 sc1
buffer_load_dwordx4 v[104:107], v0, s[4:7], s53 offen offset:2048 sc1
buffer_load_dwordx4 v[108:111], v0, s[4:7], s53 offen offset:3072 sc1
s_add_u32 s53, s53, 4096
buffer_load_dwordx4 v[112:115], v0, s[4:7], s53 offen offset:0 sc1
buffer_load_dwordx4 v[116:119], v0, s[4:7], s53 offen offset:1024 sc1
buffer_load_dwordx4 v[120:123], v0, s[4:7], s53 offen offset:2048 sc1
buffer_load_dwordx4 v[124:127], v0, s[4:7], s53 offen offset:3072 sc1
s_add_u32 s53, s53, 4096
buffer_load_dwordx4 v[128:131], v0, s[4:7], s53 offen offset:0 sc1
buffer_load_dwordx4 v[132:135], v0, s[4:7], s53 offen offset:1024 sc1
buffer_load_dwordx4 v[136:139], v0, s[4:7], s53 offen offset:2048 sc1
buffer_load_dwordx4 v[140:143], v0, s[4:7], s53 offen offset:3072 sc1
s_add_u32 s53, s53, 4096
buffer_load_dwordx4 v[144:147], v0, s[4:7], s53 offen offset:0 sc1
buffer_load_dwordx4 v[148:151], v0, s[4:7], s53 offen offset:1024 sc1
buffer_load_dwordx4 v[152:155], v0, s[4:7], s53 offen offset:2048 sc1
buffer_load_dwordx4 v[156:159], v0, s[4:7], s53 offen offset:3072 sc1
s_add_u32 s53, s53, 4096
buffer_load_dwordx4 v[160:163], v0, s[4:7], s53 offen offset:0 sc1
buffer_load_dwordx4 v[164:167], v0, s[4:7], s53 offen offset:1024 sc1
buffer_load_dwordx4 v[168:171], v0, s[4:7], s53 offen offset:2048 sc1
buffer_load_dwordx4 v[172:175], v0, s[4:7], s53 offen offset:3072 sc1
s_add_u32 s53, s53, 4096
buffer_load_dwordx4 v[176:179], v0, s[4:7], s53 offen offset:0 sc1
buffer_load_dwordx4 v[180:183], v0, s[4:7], s53 offen offset:1024 sc1
buffer_load_dwordx4 v[184:187], v0, s[4:7], s53 offen offset:2048 sc1
buffer_load_dwordx4 v[188:191], v0, s[4:7], s53 offen offset:3072 sc1
s_add_u32 s53, s53, 4096
buffer_load_dwordx4 v[192:195], v0, s[4:7], s53 offen offset:0 sc1
buffer_load_dwordx4 v[196:199], v0, s[4:7], s53 offen offset:1024 sc1
buffer_load_dwordx4 v[200:203], v0, s[4:7], s53 offen offset:2048 sc1
buffer_load_dwordx4 v[204:207], v0, s[4:7], s53 offen offset:3072 sc1
s_add_u32 s53, s53, 4096
buffer_load_dwordx4 v[208:211], v0, s[4:7], s53 offen offset:0 sc1
buffer_load_dwordx4 v[212:215], v0, s[4:7], s53 offen offset:1024 sc1
buffer_load_dwordx4 v[216:219], v0, s[4:7], s53 offen offset:2048 sc1
buffer_load_dwordx4 v[220:223], v0, s[4:7], s53 offen offset:3072 sc1
s_add_u32 s53, s53, 4096
buffer_load_dwordx4 v[224:227], v0, s[4:7], s53 offen offset:0 sc1
buffer_load_dwordx4 v[228:231], v0, s[4:7], s53 offen offset:1024 sc1
buffer_load_dwordx4 v[232:235], v0, s[4:7], s53 offen offset:2048 sc1
buffer_load_dwordx4 v[236:239], v0, s[4:7], s53 offen offset:3072 sc1
s_add_u32 s53, s53, 4096
buffer_load_dwordx4 v[240:243], v0, s[4:7], s53 offen offset:0 sc1
buffer_load_dwordx4 v[244:247], v0, s[4:7], s53 offen offset:1024 sc1
buffer_load_dwordx4 v[248:251], v0, s[4:7], s53 offen offset:2048 sc1
buffer_load_dwordx4 v[252:255], v0, s[4:7], s53 offen offset:3072 sc1
s_lshl_b32 s58, s58, 6
s_mov_b32 s38, 2621440
s_mov_b32 s47, 201326592
k_ft_118:
s_mul_i32 s48, s57, 40960
s_mul_i32 s52, s3, 10240
s_add_u32 s46, s48, s52
s_add_u32 s46, s46, s47
s_add_u32 s48, s48, s58
v_bfe_u32 v1, v0, 4, 5
v_mul_u32_u24 v1, 1280, v1
v_lshrrev_b32 v2, 9, v0
v_lshl_add_u32 v1, v2, 5, v1
s_mov_b32 s49, 1310720
s_mov_b32 s54, 222314496
s_cmp_eq_u32 s38, 0
s_cbranch_scc1 k_fg_119
s_waitcnt vmcnt(0) lgkmcnt(0)
s_cmp_lg_u32 s3, 0
s_cbranch_scc1 k_w8d_121
v_lshlrev_b32 v2, 2, v0
k_w8_120:
buffer_load_dword v3, v2, s[4:7], s54 offen sc1
buffer_load_dword v4, v2, s[4:7], s54 offen offset:1024 sc1
s_waitcnt vmcnt(0)
v_and_b32 v3, v3, v4
v_cmp_eq_u32 vcc, 0, v3
s_cbranch_vccz k_w8d_121
s_sleep 1
s_sub_u32 s32, s32, 1
s_cmp_gt_i32 s32, 0
s_cbranch_scc1 k_w8_120
k_w8d_121:
s_barrier
k_fg_119:
s_mul_i32 s45, s3, 10240
s_mov_b32 s44, 0
v_mov_b32 v64, v0
s_add_u32 m0, s45, 0
s_add_u32 s55, s46, 0
buffer_load_dwordx4 v0, s[4:7], s55 offen offset:0 sc1 lds
buffer_load_dwordx4 v0, s[4:7], s55 offen offset:1024 sc1 lds
buffer_load_dwordx4 v0, s[4:7], s55 offen offset:2048 sc1 lds
buffer_load_dwordx4 v0, s[4:7], s55 offen offset:3072 sc1 lds
s_add_u32 m0, s45, 4096
s_add_u32 s55, s46, 4096
buffer_load_dwordx4 v0, s[4:7], s55 offen offset:0 sc1 lds
buffer_load_dwordx4 v0, s[4:7], s55 offen offset:1024 sc1 lds
buffer_load_dwordx4 v0, s[4:7], s55 offen offset:2048 sc1 lds
buffer_load_dwordx4 v0, s[4:7], s55 offen offset:3072 sc1 lds
s_add_u32 m0, s45, 8192
s_add_u32 s55, s46, 8192
buffer_load_dwordx4 v0, s[4:7], s55 offen offset:0 sc1 lds
buffer_load_dwordx4 v0, s[4:7], s55 offen offset:1024 sc1 lds
s_add_u32 s45, s45, 40960
s_cmp_ge_u32 s45, 122880
s_cselect_b32 s55, 122880, 0
s_sub_u32 s45, s45, s55
s_add_u32 s46, s46, s49
s_mov_b32 s49, 0
s_add_u32 m0, s45, 0
s_add_u32 s55, s46, 0
buffer_load_dwordx4 v0, s[4:7], s55 offen offset:0 sc1 lds
buffer_load_dwordx4 v0, s[4:7], s55 offen offset:1024 sc1 lds
buffer_load_dwordx4 v0, s[4:7], s55 offen offset:2048 sc1 lds
buffer_load_dwordx4 v0, s[4:7], s55 offen offset:3072 sc1 lds
s_add_u32 m0, s45, 4096
s_add_u32 s55, s46, 4096
buffer_load_dwordx4 v0, s[4:7], s55 offen offset:0 sc1 lds
buffer_load_dwordx4 v0, s[4:7], s55 offen offset:1024 sc1 lds
buffer_load_dwordx4 v0, s[4:7], s55 offen offset:2048 sc1 lds
buffer_load_dwordx4 v0, s[4:7], s55 offen offset:3072 sc1 lds
s_add_u32 m0, s45, 8192
s_add_u32 s55, s46, 8192
buffer_load_dwordx4 v0, s[4:7], s55 offen offset:0 sc1 lds
buffer_load_dwordx4 v0, s[4:7], s55 offen offset:1024 sc1 lds
s_add_u32 s45, s45, 40960
s_cmp_ge_u32 s45, 122880
s_cselect_b32 s55, 122880, 0
s_sub_u32 s45, s45, s55
s_add_u32 s46, s46, s49
s_mov_b32 s49, 0
s_waitcnt vmcnt(10)
s_barrier
ds_read_b128 v[8:11], v64 offset:0
ds_read_b128 v[12:15], v64 offset:1024
ds_read_b128 v[16:19], v64 offset:2048
ds_read_b128 v[20:23], v64 offset:3072
s_mov_b32 s59, 1
s_waitcnt lgkmcnt(0)
v_mfma_f32_32x32x16_bf16 v[32:47], v[96:99], v[8:11], 0
ds_read_b128 v[24:27], v64 offset:4096
v_mfma_f32_32x32x16_bf16 v[32:47], v[100:103], v[12:15], v[32:47]
ds_read_b128 v[8:11], v64 offset:5120
v_mfma_f32_32x32x16_bf16 v[32:47], v[104:107], v[16:19], v[32:47]
ds_read_b128 v[12:15], v64 offset:6144
v_mfma_f32_32x32x16_bf16 v[32:47], v[108:111], v[20:23], v[32:47]
s_waitcnt lgkmcnt(2)
ds_read_b128 v[16:19], v64 offset:7168
v_mfma_f32_32x32x16_bf16 v[32:47], v[112:115], v[24:27], v[32:47]
s_waitcnt lgkmcnt(2)
ds_read_b128 v[20:23], v64 offset:8192
v_mfma_f32_32x32x16_bf16 v[32:47], v[116:119], v[8:11], v[32:47]
s_waitcnt lgkmcnt(2)
ds_read_b128 v[24:27], v64 offset:9216
v_mfma_f32_32x32x16_bf16 v[32:47], v[120:123], v[12:15], v[32:47]
s_waitcnt lgkmcnt(2)
ds_read_b128 v[8:11], v64 offset:10240
v_mfma_f32_32x32x16_bf16 v[32:47], v[124:127], v[16:19], v[32:47]
s_waitcnt lgkmcnt(2)
ds_read_b128 v[12:15], v64 offset:11264
v_mfma_f32_32x32x16_bf16 v[32:47], v[128:131], v[20:23], v[32:47]
s_waitcnt lgkmcnt(2)
ds_read_b128 v[16:19], v64 offset:12288
v_mfma_f32_32x32x16_bf16 v[32:47], v[132:135], v[24:27], v[32:47]
s_waitcnt lgkmcnt(2)
ds_read_b128 v[20:23], v64 offset:13312
v_mfma_f32_32x32x16_bf16 v[32:47], v[136:139], v[8:11], v[32:47]
s_waitcnt lgkmcnt(2)
ds_read_b128 v[24:27], v64 offset:14336
v_mfma_f32_32x32x16_bf16 v[32:47], v[140:143], v[12:15], v[32:47]
s_waitcnt lgkmcnt(2)
ds_read_b128 v[8:11], v64 offset:15360
v_mfma_f32_32x32x16_bf16 v[32:47], v[144:147], v[16:19], v[32:47]
s_waitcnt lgkmcnt(2)
ds_read_b128 v[12:15], v64 offset:16384
v_mfma_f32_32x32x16_bf16 v[32:47], v[148:151], v[20:23], v[32:47]
s_waitcnt lgkmcnt(2)
ds_read_b128 v[16:19], v64 offset:17408
v_mfma_f32_32x32x16_bf16 v[32:47], v[152:155], v[24:27], v[32:47]
s_waitcnt lgkmcnt(2)
ds_read_b128 v[20:23], v64 offset:18432
v_mfma_f32_32x32x16_bf16 v[32:47], v[156:159], v[8:11], v[32:47]
s_waitcnt lgkmcnt(2)
ds_read_b128 v[24:27], v64 offset:19456
v_mfma_f32_32x32x16_bf16 v[32:47], v[160:163], v[12:15], v[32:47]
s_waitcnt lgkmcnt(2)
ds_read_b128 v[8:11], v64 offset:20480
v_mfma_f32_32x32x16_bf16 v[32:47], v[164:167], v[16:19], v[32:47]
s_waitcnt lgkmcnt(2)
ds_read_b128 v[12:15], v64 offset:21504
v_mfma_f32_32x32x16_bf16 v[32:47], v[168:171], v[20:23], v[32:47]
s_waitcnt lgkmcnt(2)
ds_read_b128 v[16:19], v64 offset:22528
v_mfma_f32_32x32x16_bf16 v[32:47], v[172:175], v[24:27], v[32:47]
s_waitcnt lgkmcnt(2)
ds_read_b128 v[20:23], v64 offset:23552
v_mfma_f32_32x32x16_bf16 v[32:47], v[176:179], v[8:11], v[32:47]
s_waitcnt lgkmcnt(2)
ds_read_b128 v[24:27], v64 offset:24576
v_mfma_f32_32x32x16_bf16 v[32:47], v[180:183], v[12:15], v[32:47]
s_waitcnt lgkmcnt(2)
ds_read_b128 v[8:11], v64 offset:25600
v_mfma_f32_32x32x16_bf16 v[32:47], v[184:187], v[16:19], v[32:47]
s_waitcnt lgkmcnt(2)
ds_read_b128 v[12:15], v64 offset:26624
v_mfma_f32_32x32x16_bf16 v[32:47], v[188:191], v[20:23], v[32:47]
s_waitcnt lgkmcnt(2)
ds_read_b128 v[16:19], v64 offset:27648
v_mfma_f32_32x32x16_bf16 v[32:47], v[192:195], v[24:27], v[32:47]
s_waitcnt lgkmcnt(2)
ds_read_b128 v[20:23], v64 offset:28672
v_mfma_f32_32x32x16_bf16 v[32:47], v[196:199], v[8:11], v[32:47]
s_waitcnt lgkmcnt(2)
ds_read_b128 v[24:27], v64 offset:29696
v_mfma_f32_32x32x16_bf16 v[32:47], v[200:203], v[12:15], v[32:47]
s_waitcnt lgkmcnt(2)
ds_read_b128 v[8:11], v64 offset:30720
v_mfma_f32_32x32x16_bf16 v[32:47], v[204:207], v[16:19], v[32:47]
s_waitcnt lgkmcnt(2)
ds_read_b128 v[12:15], v64 offset:31744
v_mfma_f32_32x32x16_bf16 v[32:47], v[208:211], v[20:23], v[32:47]
s_waitcnt lgkmcnt(2)
ds_read_b128 v[16:19], v64 offset:32768
v_mfma_f32_32x32x16_bf16 v[32:47], v[212:215], v[24:27], v[32:47]
s_waitcnt lgkmcnt(2)
ds_read_b128 v[20:23], v64 offset:33792
v_mfma_f32_32x32x16_bf16 v[32:47], v[216:219], v[8:11], v[32:47]
s_waitcnt lgkmcnt(2)
ds_read_b128 v[24:27], v64 offset:34816
v_mfma_f32_32x32x16_bf16 v[32:47], v[220:223], v[12:15], v[32:47]
s_waitcnt lgkmcnt(2)
ds_read_b128 v[8:11], v64 offset:35840
v_mfma_f32_32x32x16_bf16 v[32:47], v[224:227], v[16:19], v[32:47]
s_waitcnt lgkmcnt(2)
ds_read_b128 v[12:15], v64 offset:36864
v_mfma_f32_32x32x16_bf16 v[32:47], v[228:231], v[20:23], v[32:47]
s_waitcnt lgkmcnt(2)
ds_read_b128 v[16:19], v64 offset:37888
v_mfma_f32_32x32x16_bf16 v[32:47], v[232:235], v[24:27], v[32:47]
s_waitcnt lgkmcnt(2)
ds_read_b128 v[20:23], v64 offset:38912
v_mfma_f32_32x32x16_bf16 v[32:47], v[236:239], v[8:11], v[32:47]
s_waitcnt lgkmcnt(2)
ds_read_b128 v[24:27], v64 offset:39936
v_mfma_f32_32x32x16_bf16 v[32:47], v[240:243], v[12:15], v[32:47]
s_add_u32 s44, s44, 1
s_cmp_eq_u32 s44, 3
s_mov_b32 s56, 40960
s_cmov_b32 s56, -81920
s_cselect_b32 s44, 0, s44
v_add_u32 v64, s56, v64
s_waitcnt vmcnt(0) lgkmcnt(2)
s_barrier
ds_read_b128 v[8:11], v64 offset:0
v_mfma_f32_32x32x16_bf16 v[32:47], v[244:247], v[16:19], v[32:47]
s_waitcnt lgkmcnt(2)
ds_read_b128 v[12:15], v64 offset:1024
v_mfma_f32_32x32x16_bf16 v[32:47], v[248:251], v[20:23], v[32:47]
s_waitcnt lgkmcnt(2)
ds_read_b128 v[16:19], v64 offset:2048
v_mfma_f32_32x32x16_bf16 v[32:47], v[252:255], v[24:27], v[32:47]
s_waitcnt lgkmcnt(2)
ds_read_b128 v[20:23], v64 offset:3072
k_st_122:
v_mfma_f32_32x32x16_bf16 v[48:63], v[96:99], v[8:11], 0
s_waitcnt lgkmcnt(2)
ds_read_b128 v[24:27], v64 offset:4096
v_mfma_f32_32x32x16_bf16 v[48:63], v[100:103], v[12:15], v[48:63]
s_waitcnt lgkmcnt(2)
ds_read_b128 v[8:11], v64 offset:5120
v_cvt_pk_bf16_f32 v32, v32, v33
v_cvt_pk_bf16_f32 v33, v34, v35
v_mfma_f32_32x32x16_bf16 v[48:63], v[104:107], v[16:19], v[48:63]
s_waitcnt lgkmcnt(2)
ds_read_b128 v[12:15], v64 offset:6144
v_cvt_pk_bf16_f32 v34, v36, v37
v_cvt_pk_bf16_f32 v35, v38, v39
v_mfma_f32_32x32x16_bf16 v[48:63], v[108:111], v[20:23], v[48:63]
s_waitcnt lgkmcnt(2)
ds_read_b128 v[16:19], v64 offset:7168
v_cvt_pk_bf16_f32 v36, v40, v41
v_cvt_pk_bf16_f32 v37, v42, v43
v_mfma_f32_32x32x16_bf16 v[48:63], v[112:115], v[24:27], v[48:63]
s_waitcnt lgkmcnt(2)
ds_read_b128 v[20:23], v64 offset:8192
v_cvt_pk_bf16_f32 v38, v44, v45
v_cvt_pk_bf16_f32 v39, v46, v47
v_mfma_f32_32x32x16_bf16 v[48:63], v[116:119], v[8:11], v[48:63]
s_waitcnt lgkmcnt(2)
ds_read_b128 v[24:27], v64 offset:9216
buffer_store_dwordx4 v[32:35], v1, s[36:39], s48 offen offset:0
buffer_store_dwordx4 v[36:39], v1, s[36:39], s48 offen offset:16
v_mfma_f32_32x32x16_bf16 v[48:63], v[120:123], v[12:15], v[48:63]
s_waitcnt lgkmcnt(2)
ds_read_b128 v[8:11], v64 offset:10240
s_add_u32 s48, s48, 1310720
v_mfma_f32_32x32x16_bf16 v[48:63], v[124:127], v[16:19], v[48:63]
s_waitcnt lgkmcnt(2)
ds_read_b128 v[12:15], v64 offset:11264
v_mfma_f32_32x32x16_bf16 v[48:63], v[128:131], v[20:23], v[48:63]
s_waitcnt lgkmcnt(2)
ds_read_b128 v[16:19], v64 offset:12288
v_mfma_f32_32x32x16_bf16 v[48:63], v[132:135], v[24:27], v[48:63]
s_waitcnt lgkmcnt(2)
ds_read_b128 v[20:23], v64 offset:13312
v_mfma_f32_32x32x16_bf16 v[48:63], v[136:139], v[8:11], v[48:63]
s_waitcnt lgkmcnt(2)
ds_read_b128 v[24:27], v64 offset:14336
v_mfma_f32_32x32x16_bf16 v[48:63], v[140:143], v[12:15], v[48:63]
s_waitcnt lgkmcnt(2)
ds_read_b128 v[8:11], v64 offset:15360
v_mfma_f32_32x32x16_bf16 v[48:63], v[144:147], v[16:19], v[48:63]
s_waitcnt lgkmcnt(2)
ds_read_b128 v[12:15], v64 offset:16384
v_mfma_f32_32x32x16_bf16 v[48:63], v[148:151], v[20:23], v[48:63]
s_waitcnt lgkmcnt(2)
ds_read_b128 v[16:19], v64 offset:17408
v_mfma_f32_32x32x16_bf16 v[48:63], v[152:155], v[24:27], v[48:63]
s_waitcnt lgkmcnt(2)
ds_read_b128 v[20:23], v64 offset:18432
v_mfma_f32_32x32x16_bf16 v[48:63], v[156:159], v[8:11], v[48:63]
s_waitcnt lgkmcnt(2)
ds_read_b128 v[24:27], v64 offset:19456
v_mfma_f32_32x32x16_bf16 v[48:63], v[160:163], v[12:15], v[48:63]
s_waitcnt lgkmcnt(2)
ds_read_b128 v[8:11], v64 offset:20480
v_mfma_f32_32x32x16_bf16 v[48:63], v[164:167], v[16:19], v[48:63]
s_waitcnt lgkmcnt(2)
ds_read_b128 v[12:15], v64 offset:21504
v_mfma_f32_32x32x16_bf16 v[48:63], v[168:171], v[20:23], v[48:63]
s_waitcnt lgkmcnt(2)
ds_read_b128 v[16:19], v64 offset:22528
v_mfma_f32_32x32x16_bf16 v[48:63], v[172:175], v[24:27], v[48:63]
s_waitcnt lgkmcnt(2)
ds_read_b128 v[20:23], v64 offset:23552
v_mfma_f32_32x32x16_bf16 v[48:63], v[176:179], v[8:11], v[48:63]
s_waitcnt lgkmcnt(2)
ds_read_b128 v[24:27], v64 offset:24576
v_mfma_f32_32x32x16_bf16 v[48:63], v[180:183], v[12:15], v[48:63]
s_waitcnt lgkmcnt(2)
ds_read_b128 v[8:11], v64 offset:25600
v_mfma_f32_32x32x16_bf16 v[48:63], v[184:187], v[16:19], v[48:63]
s_waitcnt lgkmcnt(2)
ds_read_b128 v[12:15], v64 offset:26624
v_mfma_f32_32x32x16_bf16 v[48:63], v[188:191], v[20:23], v[48:63]
s_waitcnt lgkmcnt(2)
ds_read_b128 v[16:19], v64 offset:27648
v_mfma_f32_32x32x16_bf16 v[48:63], v[192:195], v[24:27], v[48:63]
s_waitcnt lgkmcnt(2)
ds_read_b128 v[20:23], v64 offset:28672
v_mfma_f32_32x32x16_bf16 v[48:63], v[196:199], v[8:11], v[48:63]
s_waitcnt lgkmcnt(2)
ds_read_b128 v[24:27], v64 offset:29696
v_mfma_f32_32x32x16_bf16 v[48:63], v[200:203], v[12:15], v[48:63]
s_waitcnt lgkmcnt(2)
ds_read_b128 v[8:11], v64 offset:30720
v_mfma_f32_32x32x16_bf16 v[48:63], v[204:207], v[16:19], v[48:63]
s_waitcnt lgkmcnt(2)
ds_read_b128 v[12:15], v64 offset:31744
v_mfma_f32_32x32x16_bf16 v[48:63], v[208:211], v[20:23], v[48:63]
s_waitcnt lgkmcnt(2)
ds_read_b128 v[16:19], v64 offset:32768
v_mfma_f32_32x32x16_bf16 v[48:63], v[212:215], v[24:27], v[48:63]
s_waitcnt lgkmcnt(2)
ds_read_b128 v[20:23], v64 offset:33792
v_mfma_f32_32x32x16_bf16 v[48:63], v[216:219], v[8:11], v[48:63]
s_waitcnt lgkmcnt(2)
ds_read_b128 v[24:27], v64 offset:34816
v_mfma_f32_32x32x16_bf16 v[48:63], v[220:223], v[12:15], v[48:63]
s_waitcnt lgkmcnt(2)
ds_read_b128 v[8:11], v64 offset:35840
v_mfma_f32_32x32x16_bf16 v[48:63], v[224:227], v[16:19], v[48:63]
s_waitcnt lgkmcnt(2)
ds_read_b128 v[12:15], v64 offset:36864
v_mfma_f32_32x32x16_bf16 v[48:63], v[228:231], v[20:23], v[48:63]
s_waitcnt lgkmcnt(2)
ds_read_b128 v[16:19], v64 offset:37888
v_mfma_f32_32x32x16_bf16 v[48:63], v[232:235], v[24:27], v[48:63]
s_waitcnt lgkmcnt(2)
ds_read_b128 v[20:23], v64 offset:38912
v_mfma_f32_32x32x16_bf16 v[48:63], v[236:239], v[8:11], v[48:63]
s_waitcnt lgkmcnt(2)
ds_read_b128 v[24:27], v64 offset:39936
v_mfma_f32_32x32x16_bf16 v[48:63], v[240:243], v[12:15], v[48:63]
s_add_u32 s44, s44, 1
s_cmp_eq_u32 s44, 3
s_mov_b32 s56, 40960
s_cmov_b32 s56, -81920
s_cselect_b32 s44, 0, s44
v_add_u32 v64, s56, v64
s_waitcnt vmcnt(10) lgkmcnt(2)
s_barrier
ds_read_b128 v[8:11], v64 offset:0
v_mfma_f32_32x32x16_bf16 v[48:63], v[244:247], v[16:19], v[48:63]
s_waitcnt lgkmcnt(2)
ds_read_b128 v[12:15], v64 offset:1024
v_mfma_f32_32x32x16_bf16 v[48:63], v[248:251], v[20:23], v[48:63]
s_waitcnt lgkmcnt(2)
ds_read_b128 v[16:19], v64 offset:2048
v_mfma_f32_32x32x16_bf16 v[48:63], v[252:255], v[24:27], v[48:63]
s_waitcnt lgkmcnt(2)
ds_read_b128 v[20:23], v64 offset:3072
k_sm_124:
s_nop 9
v_cvt_pk_bf16_f32 v48, v48, v49
v_cvt_pk_bf16_f32 v49, v50, v51
v_cvt_pk_bf16_f32 v50, v52, v53
v_cvt_pk_bf16_f32 v51, v54, v55
v_cvt_pk_bf16_f32 v52, v56, v57
v_cvt_pk_bf16_f32 v53, v58, v59
v_cvt_pk_bf16_f32 v54, v60, v61
v_cvt_pk_bf16_f32 v55, v62, v63
buffer_store_dwordx4 v[48:51], v1, s[36:39], s48 offen offset:0
buffer_store_dwordx4 v[52:55], v1, s[36:39], s48 offen offset:16
s_add_u32 s48, s48, 1310720
s_cmp_eq_u32 s38, 0
s_mov_b32 s38, 2621440
s_mov_b32 s47, 201326592
s_cbranch_scc1 k_ft_118
s_waitcnt vmcnt(0)
s_endpgm
k_team_3:
s_cmp_eq_u32 s3, 1
s_cbranch_scc1 k_w1_126
s_cmp_eq_u32 s3, 2
s_cbranch_scc1 k_w2_127
s_cmp_eq_u32 s3, 3
s_cbranch_scc1 k_w3_128
k_w0_125:
v_lshlrev_b32 v0, 4, v0
s_mov_b32 s90, 0x300003
s_mov_b32 s91, 0x300003
s_mov_b32 s92, 0xc0000c
s_mov_b32 s93, 0xc0000c
s_mov_b32 s94, 0x30000300
s_mov_b32 s95, 0x30000300
s_mov_b32 s96, 0xc0000c00
s_mov_b32 s97, 0xc0000c00
s_mov_b32 s98, 0xff00ff00
s_mov_b32 s99, 0xff00ff00
v_mov_b32 v1, 0x4444
v_mov_b32 v4, 0xeeee
v_cndmask_b32 v1, v1, v4, s[98:99]
v_lshrrev_b32 v4, 8, v0
v_lshl_or_b32 v1, v4, 28, v1
v_bfe_u32 v4, v0, 4, 4
v_lshl_or_b32 v1, v4, 19, v1
s_mov_b32 s51, 0x3e0293ee
s_mov_b32 s52, 0x3f803f80
s_mov_b32 s53, 0x3f803f80
s_mov_b32 s54, 0x3f003f00
s_mov_b32 s55, 0x3f003f00
s_mov_b32 s56, 0xff800000
s_mov_b32 s57, 0xff800000
s_mov_b32 s58, 0x3f80
s_mov_b32 s31, 0
s_mov_b32 s45, -2
s_lshl_b32 s46, s30, 6
s_add_u32 s46, s46, 222330880
s_lshl_b32 s48, s30, 7
s_and_b32 s49, s30, 15
s_lshl_b32 s49, s49, 12
s_add_u32 s43, s49, 119537664
v_mov_b64 v[12:13], -1
s_add_u32 s38, s48, 119537664
s_add_u32 s39, s48, 119603200
s_add_u32 s40, s48, 119668736
s_add_u32 s41, s48, 119734272
s_add_u32 s42, s48, 119799808
v_lshrrev_b32 v4, 16, v1
buffer_store_dwordx2 v[12:13], v4, s[4:7], s38 offen sc1
buffer_store_dwordx2 v[12:13], v4, s[4:7], s39 offen sc1
buffer_store_dwordx2 v[12:13], v4, s[4:7], s40 offen sc1
buffer_store_dwordx2 v[12:13], v4, s[4:7], s41 offen sc1
buffer_store_dwordx2 v[12:13], v4, s[4:7], s42 offen sc1
s_add_u32 s47, s31, 63
s_mul_i32 s33, s31, 0
s_add_u32 s33, s33, 120324096
s_add_u32 s34, s33, 2048
s_add_u32 s35, s33, 6144
s_mul_i32 s48, s31, 655360
s_lshl_b32 s36, s30, 14
s_add_u32 s36, s36, s48
s_add_u32 s36, s36, 0
v_mov_b32 v36, -1
s_and_b32 s48, s30, 15
s_add_u32 s48, s48, 0
s_lshr_b32 s49, s48, 1
s_and_b32 s48, s48, 1
s_lshl_b32 s44, s49, 8
s_lshl_b32 s50, s48, 6
s_add_u32 s44, s44, s50
s_add_u32 s44, s44, s33
s_mul_i32 s48, s48, 5120
s_lshl_b32 s49, s49, 5
s_add_u32 s48, s48, s49
v_lshrrev_b32 v32, 4, v0
v_and_b32 v33, 3, v32
v_mul_u32_u24 v33, 1280, v33
v_bfe_u32 v34, v32, 2, 1
v_lshl_add_u32 v33, v34, 1, v33
v_bfe_u32 v34, v32, 4, 1
v_lshl_add_u32 v33, v34, 4, v33
v_bfe_u32 v34, v32, 5, 1
v_lshl_add_u32 v33, v34, 2, v33
buffer_load_ushort v34, v33, s[24:27], s48 offen
buffer_load_ushort v35, v33, s[24:27], s48 offen offset:8
v_and_b32 v45, 0x30, v0
v_lshrrev_b32 v46, 8, v0
v_lshl_or_b32 v45, v46, 2, v45
v_bfe_u32 v46, v0, 6, 1
v_lshl_or_b32 v45, v46, 7, v45
v_cndmask_b32 v45, v45, 2.0, s[98:99]
s_lshl_b32 s63, s30, 10
s_add_u32 s63, s63, 0x8000
s_add_u32 s63, s63, s33
s_lshl_b32 s37, s31, 14
s_add_u32 s37, s37, 117440512
s_add_u32 s59, s37, 4096
v_lshrrev_b32 v0, 4, v0
v_lshrrev_b32 v12, 3, v0
v_lshlrev_b32 v10, 13, v12
v_bfe_u32 v12, v0, 1, 2
v_lshrrev_b32 v13, 4, v0
v_xor_b32 v12, v12, v13
v_lshl_add_u32 v10, v12, 5, v10
v_and_b32 v14, 1, v0
v_lshl_add_u32 v10, v14, 4, v10
v_mul_u32_u24 v11, 1280, v13
v_bfe_u32 v12, v0, 1, 3
v_and_b32 v13, 1, v13
v_lshlrev_b32 v13, 1, v13
v_xor_b32 v12, v12, v13
v_xor_b32 v12, 0, v12
v_lshl_add_u32 v11, v12, 5, v11
v_lshl_add_u32 v11, v14, 4, v11
v_bfe_u32 v12, v0, 5, 1
v_lshlrev_b32 v12, 4, v12
v_bfe_u32 v13, v0, 4, 1
v_lshl_add_u32 v12, v13, 1, v12
v_bfe_u32 v13, v0, 2, 1
v_lshl_add_u32 v12, v13, 2, v12
v_bfe_u32 v13, v0, 3, 1
v_mul_u32_u24 v15, 4224, v13
v_add_u32 v12, v13, v12
v_bfe_u32 v13, v12, 1, 2
v_xor_b32 v13, 0, v13
v_lshlrev_b32 v13, 5, v13
v_lshl_add_u32 v4, v12, 7, v13
v_and_b32 v14, 3, v0
v_lshl_add_u32 v4, v14, 3, v4
v_add_u32 v5, 0x10000, v4
v_add_u32 v6, 0x20000, v4
v_bfe_u32 v12, v0, 4, 1
v_lshlrev_b32 v13, 4, v12
v_lshlrev_b32 v12, 2, v12
v_bfe_u32 v8, v0, 5, 1
v_lshl_add_u32 v13, v8, 2, v13
v_bfe_u32 v8, v0, 2, 1
v_add_u32 v13, v8, v13
v_lshl_add_u32 v12, v8, 1, v12
v_bfe_u32 v8, v0, 3, 1
v_add_u32 v8, 0, v8
v_xor_b32 v12, v12, v8
v_lshlrev_b32 v12, 5, v12
v_lshl_add_u32 v7, v13, 8, v12
v_lshl_add_u32 v7, v14, 3, v7
v_add_u32 v8, 0x10000, v7
v_add_u32 v9, 0x20000, v7
v_lshlrev_b32 v0, 4, v0
v_add_u32 v2, 98304, v0
s_lshl_b32 s49, s30, 8
s_mul_i32 s50, s30, 163840
s_mul_i32 s60, s30, 131072
s_add_u32 s60, s60, 120586240
s_add_u32 s61, s60, 4096
s_add_u32 s62, s60, 8192
s_mov_b32 m0, 0
s_add_u32 s48, s49, 0
buffer_load_dwordx4 v10, s[8:11], s48 offen lds
s_mov_b32 m0, 1024
s_add_u32 s48, s49, 65536
buffer_load_dwordx4 v10, s[8:11], s48 offen lds
s_mov_b32 m0, 8192
s_add_u32 s48, s49, 128
buffer_load_dwordx4 v10, s[8:11], s48 offen lds
s_mov_b32 m0, 9216
s_add_u32 s48, s49, 65664
buffer_load_dwordx4 v10, s[8:11], s48 offen lds
s_mov_b32 m0, 16384
s_add_u32 s48, s49, 128
buffer_load_dwordx4 v10, s[12:15], s48 offen lds
s_mov_b32 m0, 17408
s_add_u32 s48, s49, 65664
buffer_load_dwordx4 v10, s[12:15], s48 offen lds
s_mov_b32 m0, 24576
s_add_u32 s48, s49, 0
buffer_load_dwordx4 v10, s[16:19], s48 offen lds
s_mov_b32 m0, 25600
s_add_u32 s48, s49, 65536
buffer_load_dwordx4 v10, s[16:19], s48 offen lds
s_mov_b32 m0, 32768
s_add_u32 s48, s49, 128
buffer_load_dwordx4 v10, s[16:19], s48 offen lds
s_mov_b32 m0, 33792
s_add_u32 s48, s49, 65664
buffer_load_dwordx4 v10, s[16:19], s48 offen lds
s_mov_b32 m0, 40960
s_add_u32 s48, s49, 524288
buffer_load_dwordx4 v10, s[8:11], s48 offen lds
s_mov_b32 m0, 41984
s_add_u32 s48, s49, 589824
buffer_load_dwordx4 v10, s[8:11], s48 offen lds
s_mov_b32 m0, 49152
s_add_u32 s48, s49, 524416
buffer_load_dwordx4 v10, s[8:11], s48 offen lds
s_mov_b32 m0, 50176
s_add_u32 s48, s49, 589952
buffer_load_dwordx4 v10, s[8:11], s48 offen lds
s_mov_b32 m0, 57344
s_add_u32 s48, s49, 524416
buffer_load_dwordx4 v10, s[12:15], s48 offen lds
s_mov_b32 m0, 58368
s_add_u32 s48, s49, 589952
buffer_load_dwordx4 v10, s[12:15], s48 offen lds
s_mov_b32 m0, 65536
s_add_u32 s48, s49, 524288
buffer_load_dwordx4 v10, s[16:19], s48 offen lds
s_mov_b32 m0, 66560
s_add_u32 s48, s49, 589824
buffer_load_dwordx4 v10, s[16:19], s48 offen lds
s_mov_b32 m0, 73728
s_add_u32 s48, s49, 524416
buffer_load_dwordx4 v10, s[16:19], s48 offen lds
s_mov_b32 m0, 74752
s_add_u32 s48, s49, 589952
buffer_load_dwordx4 v10, s[16:19], s48 offen lds
s_mov_b32 m0, 81920
s_add_u32 s48, s49, 1048576
buffer_load_dwordx4 v10, s[8:11], s48 offen lds
s_mov_b32 m0, 82944
s_add_u32 s48, s49, 1114112
buffer_load_dwordx4 v10, s[8:11], s48 offen lds
s_mov_b32 m0, 90112
s_add_u32 s48, s49, 1048704
buffer_load_dwordx4 v10, s[8:11], s48 offen lds
s_mov_b32 m0, 91136
s_add_u32 s48, s49, 1114240
buffer_load_dwordx4 v10, s[8:11], s48 offen lds
s_mov_b32 m0, 98304
s_add_u32 s48, s49, 1048704
buffer_load_dwordx4 v10, s[12:15], s48 offen lds
s_mov_b32 m0, 99328
s_add_u32 s48, s49, 1114240
buffer_load_dwordx4 v10, s[12:15], s48 offen lds
s_mov_b32 m0, 106496
s_add_u32 s48, s49, 1048576
buffer_load_dwordx4 v10, s[16:19], s48 offen lds
s_mov_b32 m0, 107520
s_add_u32 s48, s49, 1114112
buffer_load_dwordx4 v10, s[16:19], s48 offen lds
s_mov_b32 m0, 114688
s_add_u32 s48, s49, 1572864
buffer_load_dwordx4 v10, s[8:11], s48 offen lds
s_mov_b32 m0, 115712
s_add_u32 s48, s49, 1638400
buffer_load_dwordx4 v10, s[8:11], s48 offen lds
s_mov_b32 m0, 122880
s_add_u32 s48, s49, 1572992
buffer_load_dwordx4 v10, s[8:11], s48 offen lds
s_mov_b32 m0, 123904
s_add_u32 s48, s49, 1638528
buffer_load_dwordx4 v10, s[8:11], s48 offen lds
s_waitcnt vmcnt(32)
v_lshl_or_b32 v34, v35, 16, v34
buffer_store_dword v34, v45, s[4:7], s44 offen sc1
s_add_u32 s44, s44, 16384
buffer_store_dword v36, v45, s[4:7], s44 offen sc1
s_waitcnt vmcnt(26)
s_barrier
s_mov_b32 m0, 131072
s_add_u32 s48, s49, 1572992
buffer_load_dwordx4 v10, s[12:15], s48 offen lds
s_mov_b32 m0, 132096
s_add_u32 s48, s49, 1638528
buffer_load_dwordx4 v10, s[12:15], s48 offen lds
s_mov_b32 m0, 139264
s_add_u32 s48, s49, 1572864
buffer_load_dwordx4 v10, s[16:19], s48 offen lds
s_mov_b32 m0, 140288
s_add_u32 s48, s49, 1638400
buffer_load_dwordx4 v10, s[16:19], s48 offen lds
s_mov_b32 m0, 147456
s_add_u32 s48, s49, 2097152
buffer_load_dwordx4 v10, s[8:11], s48 offen lds
s_mov_b32 m0, 148480
s_add_u32 s48, s49, 2162688
buffer_load_dwordx4 v10, s[8:11], s48 offen lds
s_mov_b32 m0, 155648
s_add_u32 s48, s49, 2097280
buffer_load_dwordx4 v10, s[8:11], s48 offen lds
s_mov_b32 m0, 156672
s_add_u32 s48, s49, 2162816
buffer_load_dwordx4 v10, s[8:11], s48 offen lds
ds_read_b64_tr_b16 a[0:1], v4 offset:0
ds_read_b64_tr_b16 a[2:3], v4 offset:1024
ds_read_b64_tr_b16 a[4:5], v4 offset:4096
ds_read_b64_tr_b16 a[6:7], v4 offset:5120
ds_read_b64_tr_b16 a[8:9], v4 offset:8192
ds_read_b64_tr_b16 a[10:11], v4 offset:9216
ds_read_b64_tr_b16 a[12:13], v4 offset:12288
ds_read_b64_tr_b16 a[14:15], v4 offset:13312
ds_read_b64_tr_b16 a[16:17], v4 offset:16384
ds_read_b64_tr_b16 a[18:19], v4 offset:17408
ds_read_b64_tr_b16 a[20:21], v4 offset:20480
ds_read_b64_tr_b16 a[22:23], v4 offset:21504
ds_read_b64_tr_b16 v[40:41], v4 offset:24576
ds_read_b64_tr_b16 v[42:43], v4 offset:25600
ds_read_b64_tr_b16 v[44:45], v4 offset:28672
ds_read_b64_tr_b16 v[46:47], v4 offset:29696
s_waitcnt lgkmcnt(0)
buffer_store_dwordx4 v[40:43], v0, s[4:7], s60 offen offset:0
buffer_store_dwordx4 v[44:47], v0, s[4:7], s60 offen offset:1024
s_waitcnt vmcnt(28)
s_barrier
s_mov_b32 m0, 0
s_add_u32 s48, s49, 2097280
buffer_load_dwordx4 v10, s[12:15], s48 offen lds
s_mov_b32 m0, 1024
s_add_u32 s48, s49, 2162816
buffer_load_dwordx4 v10, s[12:15], s48 offen lds
s_mov_b32 m0, 8192
s_add_u32 s48, s49, 2097152
buffer_load_dwordx4 v10, s[16:19], s48 offen lds
s_mov_b32 m0, 9216
s_add_u32 s48, s49, 2162688
buffer_load_dwordx4 v10, s[16:19], s48 offen lds
s_mov_b32 m0, 16384
s_add_u32 s48, s49, 2621440
buffer_load_dwordx4 v10, s[8:11], s48 offen lds
s_mov_b32 m0, 17408
s_add_u32 s48, s49, 2686976
buffer_load_dwordx4 v10, s[8:11], s48 offen lds
s_mov_b32 m0, 24576
s_add_u32 s48, s49, 2621568
buffer_load_dwordx4 v10, s[8:11], s48 offen lds
s_mov_b32 m0, 25600
s_add_u32 s48, s49, 2687104
buffer_load_dwordx4 v10, s[8:11], s48 offen lds
ds_read_b64_tr_b16 v[16:17], v4 offset:32768
ds_read_b64_tr_b16 v[18:19], v4 offset:33792
ds_read_b64_tr_b16 v[20:21], v4 offset:36864
ds_read_b64_tr_b16 v[22:23], v4 offset:37888
ds_read_b64_tr_b16 a[24:25], v4 offset:40960
ds_read_b64_tr_b16 a[26:27], v4 offset:41984
ds_read_b64_tr_b16 a[28:29], v4 offset:45056
ds_read_b64_tr_b16 a[30:31], v4 offset:46080
ds_read_b64_tr_b16 a[32:33], v4 offset:49152
ds_read_b64_tr_b16 a[34:35], v4 offset:50176
ds_read_b64_tr_b16 a[36:37], v4 offset:53248
ds_read_b64_tr_b16 a[38:39], v4 offset:54272
ds_read_b64_tr_b16 a[40:41], v4 offset:57344
ds_read_b64_tr_b16 a[42:43], v4 offset:58368
ds_read_b64_tr_b16 a[44:45], v4 offset:61440
ds_read_b64_tr_b16 a[46:47], v4 offset:62464
s_waitcnt lgkmcnt(0)
buffer_store_dwordx4 v[16:19], v0, s[4:7], s60 offen offset:2048
buffer_store_dwordx4 v[20:23], v0, s[4:7], s60 offen offset:3072
s_waitcnt vmcnt(30)
s_barrier
s_mov_b32 m0, 32768
s_add_u32 s48, s49, 2621568
buffer_load_dwordx4 v10, s[12:15], s48 offen lds
s_mov_b32 m0, 33792
s_add_u32 s48, s49, 2687104
buffer_load_dwordx4 v10, s[12:15], s48 offen lds
s_mov_b32 m0, 40960
s_add_u32 s48, s49, 2621440
buffer_load_dwordx4 v10, s[16:19], s48 offen lds
s_mov_b32 m0, 41984
s_add_u32 s48, s49, 2686976
buffer_load_dwordx4 v10, s[16:19], s48 offen lds
s_mov_b32 m0, 49152
s_add_u32 s48, s49, 3145856
buffer_load_dwordx4 v10, s[8:11], s48 offen lds
s_mov_b32 m0, 50176
s_add_u32 s48, s49, 3211392
buffer_load_dwordx4 v10, s[8:11], s48 offen lds
s_mov_b32 m0, 57344
s_add_u32 s48, s49, 3670016
buffer_load_dwordx4 v10, s[8:11], s48 offen lds
s_mov_b32 m0, 58368
s_add_u32 s48, s49, 3735552
buffer_load_dwordx4 v10, s[8:11], s48 offen lds
ds_read_b64_tr_b16 a[176:177], v5 offset:0
ds_read_b64_tr_b16 a[178:179], v5 offset:1024
ds_read_b64_tr_b16 a[180:181], v5 offset:4096
ds_read_b64_tr_b16 a[182:183], v5 offset:5120
ds_read_b64_tr_b16 v[232:233], v5 offset:8192
ds_read_b64_tr_b16 v[234:235], v5 offset:9216
ds_read_b64_tr_b16 v[236:237], v5 offset:12288
ds_read_b64_tr_b16 v[238:239], v5 offset:13312
ds_read_b64_tr_b16 a[48:49], v5 offset:16384
ds_read_b64_tr_b16 a[50:51], v5 offset:17408
ds_read_b64_tr_b16 a[52:53], v5 offset:20480
ds_read_b64_tr_b16 a[54:55], v5 offset:21504
ds_read_b64_tr_b16 a[56:57], v5 offset:24576
ds_read_b64_tr_b16 a[58:59], v5 offset:25600
ds_read_b64_tr_b16 a[60:61], v5 offset:28672
ds_read_b64_tr_b16 a[62:63], v5 offset:29696
s_waitcnt lgkmcnt(0)
s_waitcnt vmcnt(30)
s_barrier
s_mov_b32 m0, 65536
s_add_u32 s48, s49, 3670144
buffer_load_dwordx4 v10, s[8:11], s48 offen lds
s_mov_b32 m0, 66560
s_add_u32 s48, s49, 3735680
buffer_load_dwordx4 v10, s[8:11], s48 offen lds
s_mov_b32 m0, 73728
s_add_u32 s48, s49, 4194304
buffer_load_dwordx4 v10, s[8:11], s48 offen lds
s_mov_b32 m0, 74752
s_add_u32 s48, s49, 4259840
buffer_load_dwordx4 v10, s[8:11], s48 offen lds
s_mov_b32 m0, 81920
s_add_u32 s48, s49, 4194432
buffer_load_dwordx4 v10, s[8:11], s48 offen lds
s_mov_b32 m0, 82944
s_add_u32 s48, s49, 4259968
buffer_load_dwordx4 v10, s[8:11], s48 offen lds
s_mov_b32 m0, 90112
s_add_u32 s48, s49, 4718592
buffer_load_dwordx4 v10, s[8:11], s48 offen lds
s_mov_b32 m0, 91136
s_add_u32 s48, s49, 4784128
buffer_load_dwordx4 v10, s[8:11], s48 offen lds
ds_read_b64_tr_b16 a[64:65], v5 offset:32768
ds_read_b64_tr_b16 a[66:67], v5 offset:33792
ds_read_b64_tr_b16 a[68:69], v5 offset:36864
ds_read_b64_tr_b16 a[70:71], v5 offset:37888
ds_read_b64_tr_b16 a[72:73], v5 offset:40960
ds_read_b64_tr_b16 a[74:75], v5 offset:41984
ds_read_b64_tr_b16 a[76:77], v5 offset:45056
ds_read_b64_tr_b16 a[78:79], v5 offset:46080
ds_read_b64_tr_b16 a[80:81], v5 offset:49152
ds_read_b64_tr_b16 a[82:83], v5 offset:50176
ds_read_b64_tr_b16 a[84:85], v5 offset:53248
ds_read_b64_tr_b16 a[86:87], v5 offset:54272
ds_read_b64_tr_b16 a[88:89], v5 offset:57344
ds_read_b64_tr_b16 a[90:91], v5 offset:58368
ds_read_b64_tr_b16 a[92:93], v5 offset:61440
ds_read_b64_tr_b16 a[94:95], v5 offset:62464
s_waitcnt lgkmcnt(0)
s_waitcnt vmcnt(28)
s_barrier
s_mov_b64 exec, 1
v_mov_b32 v12, 160
v_or_b32 v13, s64, 1
global_atomic_add v12, v13, s[28:29] sc1
s_mov_b64 exec, -1
s_mov_b32 m0, 98304
s_add_u32 s48, s49, 4718720
buffer_load_dwordx4 v10, s[8:11], s48 offen lds
s_mov_b32 m0, 99328
s_add_u32 s48, s49, 4784256
buffer_load_dwordx4 v10, s[8:11], s48 offen lds
s_mov_b32 m0, 106496
s_add_u32 s48, s49, 3145728
buffer_load_dwordx4 v10, s[12:15], s48 offen lds
s_mov_b32 m0, 107520
s_add_u32 s48, s49, 3211264
buffer_load_dwordx4 v10, s[12:15], s48 offen lds
s_mov_b32 m0, 114688
s_add_u32 s48, s49, 3145856
buffer_load_dwordx4 v10, s[12:15], s48 offen lds
s_mov_b32 m0, 115712
s_add_u32 s48, s49, 3211392
buffer_load_dwordx4 v10, s[12:15], s48 offen lds
s_mov_b32 m0, 122880
s_add_u32 s48, s49, 3670016
buffer_load_dwordx4 v10, s[12:15], s48 offen lds
s_mov_b32 m0, 123904
s_add_u32 s48, s49, 3735552
buffer_load_dwordx4 v10, s[12:15], s48 offen lds
ds_read_b64_tr_b16 a[96:97], v6 offset:0
ds_read_b64_tr_b16 a[98:99], v6 offset:1024
ds_read_b64_tr_b16 a[100:101], v6 offset:4096
ds_read_b64_tr_b16 a[102:103], v6 offset:5120
ds_read_b64_tr_b16 a[104:105], v6 offset:8192
ds_read_b64_tr_b16 a[106:107], v6 offset:9216
ds_read_b64_tr_b16 a[108:109], v6 offset:12288
ds_read_b64_tr_b16 a[110:111], v6 offset:13312
ds_read_b64_tr_b16 a[112:113], v6 offset:16384
ds_read_b64_tr_b16 a[114:115], v6 offset:17408
ds_read_b64_tr_b16 a[116:117], v6 offset:20480
ds_read_b64_tr_b16 a[118:119], v6 offset:21504
ds_read_b64_tr_b16 a[120:121], v6 offset:24576
ds_read_b64_tr_b16 a[122:123], v6 offset:25600
ds_read_b64_tr_b16 a[124:125], v6 offset:28672
ds_read_b64_tr_b16 a[126:127], v6 offset:29696
s_waitcnt lgkmcnt(0)
s_waitcnt vmcnt(27)
s_barrier
s_mov_b32 m0, 131072
s_add_u32 s48, s49, 3670144
buffer_load_dwordx4 v10, s[12:15], s48 offen lds
s_mov_b32 m0, 132096
s_add_u32 s48, s49, 3735680
buffer_load_dwordx4 v10, s[12:15], s48 offen lds
s_mov_b32 m0, 139264
s_add_u32 s48, s49, 4194304
buffer_load_dwordx4 v10, s[12:15], s48 offen lds
s_mov_b32 m0, 140288
s_add_u32 s48, s49, 4259840
buffer_load_dwordx4 v10, s[12:15], s48 offen lds
s_mov_b32 m0, 147456
s_add_u32 s48, s49, 4194432
buffer_load_dwordx4 v10, s[12:15], s48 offen lds
s_mov_b32 m0, 148480
s_add_u32 s48, s49, 4259968
buffer_load_dwordx4 v10, s[12:15], s48 offen lds
s_mov_b32 m0, 155648
s_add_u32 s48, s49, 4718592
buffer_load_dwordx4 v10, s[12:15], s48 offen lds
s_mov_b32 m0, 156672
s_add_u32 s48, s49, 4784128
buffer_load_dwordx4 v10, s[12:15], s48 offen lds
ds_read_b64_tr_b16 a[128:129], v4 offset:0
ds_read_b64_tr_b16 a[130:131], v4 offset:1024
ds_read_b64_tr_b16 a[132:133], v4 offset:4096
ds_read_b64_tr_b16 a[134:135], v4 offset:5120
ds_read_b64_tr_b16 a[136:137], v4 offset:8192
ds_read_b64_tr_b16 a[138:139], v4 offset:9216
ds_read_b64_tr_b16 a[140:141], v4 offset:12288
ds_read_b64_tr_b16 a[142:143], v4 offset:13312
ds_read_b64_tr_b16 a[144:145], v4 offset:16384
ds_read_b64_tr_b16 a[146:147], v4 offset:17408
ds_read_b64_tr_b16 a[148:149], v4 offset:20480
ds_read_b64_tr_b16 a[150:151], v4 offset:21504
ds_read_b64_tr_b16 a[152:153], v4 offset:24576
ds_read_b64_tr_b16 a[154:155], v4 offset:25600
ds_read_b64_tr_b16 a[156:157], v4 offset:28672
ds_read_b64_tr_b16 a[158:159], v4 offset:29696
s_waitcnt lgkmcnt(0)
s_waitcnt vmcnt(25)
s_barrier
s_mov_b32 m0, 0
s_add_u32 s48, s49, 4718720
buffer_load_dwordx4 v10, s[12:15], s48 offen lds
s_mov_b32 m0, 1024
s_add_u32 s48, s49, 4784256
buffer_load_dwordx4 v10, s[12:15], s48 offen lds
s_mov_b32 m0, 8192
s_add_u32 s48, s49, 3145728
buffer_load_dwordx4 v10, s[16:19], s48 offen lds
s_mov_b32 m0, 9216
s_add_u32 s48, s49, 3211264
buffer_load_dwordx4 v10, s[16:19], s48 offen lds
s_mov_b32 m0, 16384
s_add_u32 s48, s49, 3145856
buffer_load_dwordx4 v10, s[16:19], s48 offen lds
s_mov_b32 m0, 17408
s_add_u32 s48, s49, 3211392
buffer_load_dwordx4 v10, s[16:19], s48 offen lds
s_mov_b32 m0, 24576
s_add_u32 s48, s49, 3670016
buffer_load_dwordx4 v10, s[16:19], s48 offen lds
s_mov_b32 m0, 25600
s_add_u32 s48, s49, 3735552
buffer_load_dwordx4 v10, s[16:19], s48 offen lds
ds_read_b64_tr_b16 a[160:161], v4 offset:32768
ds_read_b64_tr_b16 a[162:163], v4 offset:33792
ds_read_b64_tr_b16 a[164:165], v4 offset:36864
ds_read_b64_tr_b16 a[166:167], v4 offset:37888
ds_read_b64_tr_b16 a[168:169], v4 offset:40960
ds_read_b64_tr_b16 a[170:171], v4 offset:41984
ds_read_b64_tr_b16 a[172:173], v4 offset:45056
ds_read_b64_tr_b16 a[174:175], v4 offset:46080
ds_read_b64_tr_b16 a[192:193], v4 offset:49152
ds_read_b64_tr_b16 a[194:195], v4 offset:50176
ds_read_b64_tr_b16 a[196:197], v4 offset:53248
ds_read_b64_tr_b16 a[198:199], v4 offset:54272
ds_read_b64_tr_b16 v[240:241], v4 offset:57344
ds_read_b64_tr_b16 v[242:243], v4 offset:58368
ds_read_b64_tr_b16 v[244:245], v4 offset:61440
ds_read_b64_tr_b16 v[246:247], v4 offset:62464
s_waitcnt lgkmcnt(0)
s_waitcnt vmcnt(25)
s_barrier
s_mov_b32 m0, 32768
s_add_u32 s48, s49, 3670144
buffer_load_dwordx4 v10, s[16:19], s48 offen lds
s_mov_b32 m0, 33792
s_add_u32 s48, s49, 3735680
buffer_load_dwordx4 v10, s[16:19], s48 offen lds
s_mov_b32 m0, 40960
s_add_u32 s48, s49, 4194304
buffer_load_dwordx4 v10, s[16:19], s48 offen lds
s_mov_b32 m0, 41984
s_add_u32 s48, s49, 4259840
buffer_load_dwordx4 v10, s[16:19], s48 offen lds
s_mov_b32 m0, 49152
s_add_u32 s48, s49, 4194432
buffer_load_dwordx4 v10, s[16:19], s48 offen lds
s_mov_b32 m0, 50176
s_add_u32 s48, s49, 4259968
buffer_load_dwordx4 v10, s[16:19], s48 offen lds
s_mov_b32 m0, 57344
s_add_u32 s48, s49, 4718592
buffer_load_dwordx4 v10, s[16:19], s48 offen lds
s_mov_b32 m0, 58368
s_add_u32 s48, s49, 4784128
buffer_load_dwordx4 v10, s[16:19], s48 offen lds
ds_read_b64_tr_b16 a[200:201], v5 offset:0
ds_read_b64_tr_b16 a[202:203], v5 offset:1024
ds_read_b64_tr_b16 a[204:205], v5 offset:4096
ds_read_b64_tr_b16 a[206:207], v5 offset:5120
ds_read_b64_tr_b16 a[208:209], v5 offset:8192
ds_read_b64_tr_b16 a[210:211], v5 offset:9216
ds_read_b64_tr_b16 a[212:213], v5 offset:12288
ds_read_b64_tr_b16 a[214:215], v5 offset:13312
ds_read_b64_tr_b16 a[216:217], v5 offset:16384
ds_read_b64_tr_b16 a[218:219], v5 offset:17408
ds_read_b64_tr_b16 a[220:221], v5 offset:20480
ds_read_b64_tr_b16 a[222:223], v5 offset:21504
ds_read_b64_tr_b16 a[224:225], v5 offset:24576
ds_read_b64_tr_b16 a[226:227], v5 offset:25600
ds_read_b64_tr_b16 a[228:229], v5 offset:28672
ds_read_b64_tr_b16 a[230:231], v5 offset:29696
s_waitcnt lgkmcnt(0)
s_waitcnt vmcnt(24)
s_barrier
s_mov_b32 m0, 65536
s_add_u32 s48, s49, 4718720
buffer_load_dwordx4 v10, s[16:19], s48 offen lds
s_mov_b32 m0, 66560
s_add_u32 s48, s49, 4784256
buffer_load_dwordx4 v10, s[16:19], s48 offen lds
s_mov_b32 m0, 73728
s_add_u32 s48, s50, 0
buffer_load_dwordx4 v11, s[20:23], s48 offen lds
s_mov_b32 m0, 74752
s_add_u32 s48, s50, 5120
buffer_load_dwordx4 v11, s[20:23], s48 offen lds
s_mov_b32 m0, 81920
s_add_u32 s48, s50, 20480
buffer_load_dwordx4 v11, s[20:23], s48 offen lds
s_mov_b32 m0, 82944
s_add_u32 s48, s50, 25600
buffer_load_dwordx4 v11, s[20:23], s48 offen lds
s_mov_b32 m0, 90112
s_add_u32 s48, s50, 40960
buffer_load_dwordx4 v11, s[20:23], s48 offen lds
s_mov_b32 m0, 91136
s_add_u32 s48, s50, 46080
buffer_load_dwordx4 v11, s[20:23], s48 offen lds
ds_read_b64_tr_b16 a[232:233], v5 offset:32768
ds_read_b64_tr_b16 a[234:235], v5 offset:33792
ds_read_b64_tr_b16 a[236:237], v5 offset:36864
ds_read_b64_tr_b16 a[238:239], v5 offset:37888
ds_read_b64_tr_b16 v[248:249], v5 offset:40960
ds_read_b64_tr_b16 v[250:251], v5 offset:41984
ds_read_b64_tr_b16 v[252:253], v5 offset:45056
ds_read_b64_tr_b16 v[254:255], v5 offset:46080
ds_read_b64_tr_b16 a[240:241], v5 offset:49152
ds_read_b64_tr_b16 a[242:243], v5 offset:50176
ds_read_b64_tr_b16 a[244:245], v5 offset:53248
ds_read_b64_tr_b16 a[246:247], v5 offset:54272
ds_read_b64_tr_b16 a[248:249], v5 offset:57344
ds_read_b64_tr_b16 a[250:251], v5 offset:58368
ds_read_b64_tr_b16 a[252:253], v5 offset:61440
ds_read_b64_tr_b16 a[254:255], v5 offset:62464
s_waitcnt lgkmcnt(0)
s_waitcnt vmcnt(24)
s_barrier
s_mov_b32 m0, 98304
s_add_u32 s48, s50, 61440
buffer_load_dwordx4 v11, s[20:23], s48 offen lds
s_mov_b32 m0, 99328
s_add_u32 s48, s50, 66560
buffer_load_dwordx4 v11, s[20:23], s48 offen lds
s_mov_b32 m0, 106496
s_add_u32 s48, s50, 256
buffer_load_dwordx4 v11, s[20:23], s48 offen lds
s_mov_b32 m0, 107520
s_add_u32 s48, s50, 5376
buffer_load_dwordx4 v11, s[20:23], s48 offen lds
s_mov_b32 m0, 114688
s_add_u32 s48, s50, 20736
buffer_load_dwordx4 v11, s[20:23], s48 offen lds
s_mov_b32 m0, 115712
s_add_u32 s48, s50, 25856
buffer_load_dwordx4 v11, s[20:23], s48 offen lds
s_mov_b32 m0, 122880
s_add_u32 s48, s50, 41216
buffer_load_dwordx4 v11, s[20:23], s48 offen lds
s_mov_b32 m0, 123904
s_add_u32 s48, s50, 46336
buffer_load_dwordx4 v11, s[20:23], s48 offen lds
ds_read_b64_tr_b16 v[72:73], v6 offset:0
ds_read_b64_tr_b16 v[74:75], v6 offset:1024
ds_read_b64_tr_b16 v[76:77], v6 offset:4096
ds_read_b64_tr_b16 v[78:79], v6 offset:5120
ds_read_b64_tr_b16 v[80:81], v6 offset:8192
ds_read_b64_tr_b16 v[82:83], v6 offset:9216
ds_read_b64_tr_b16 v[84:85], v6 offset:12288
ds_read_b64_tr_b16 v[86:87], v6 offset:13312
ds_read_b64_tr_b16 v[88:89], v6 offset:16384
ds_read_b64_tr_b16 v[90:91], v6 offset:17408
ds_read_b64_tr_b16 v[92:93], v6 offset:20480
ds_read_b64_tr_b16 v[94:95], v6 offset:21504
ds_read_b64_tr_b16 v[96:97], v6 offset:24576
ds_read_b64_tr_b16 v[98:99], v6 offset:25600
ds_read_b64_tr_b16 v[100:101], v6 offset:28672
ds_read_b64_tr_b16 v[102:103], v6 offset:29696
s_waitcnt lgkmcnt(0)
s_waitcnt vmcnt(24)
s_barrier
s_mov_b32 m0, 131072
s_add_u32 s48, s50, 61696
buffer_load_dwordx4 v11, s[20:23], s48 offen lds
s_mov_b32 m0, 132096
s_add_u32 s48, s50, 66816
buffer_load_dwordx4 v11, s[20:23], s48 offen lds
s_mov_b32 m0, 139264
s_add_u32 s48, s50, 512
buffer_load_dwordx4 v11, s[20:23], s48 offen lds
s_mov_b32 m0, 140288
s_add_u32 s48, s50, 5632
buffer_load_dwordx4 v11, s[20:23], s48 offen lds
s_mov_b32 m0, 147456
s_add_u32 s48, s50, 20992
buffer_load_dwordx4 v11, s[20:23], s48 offen lds
s_mov_b32 m0, 148480
s_add_u32 s48, s50, 26112
buffer_load_dwordx4 v11, s[20:23], s48 offen lds
s_mov_b32 m0, 155648
s_add_u32 s48, s50, 41472
buffer_load_dwordx4 v11, s[20:23], s48 offen lds
s_mov_b32 m0, 156672
s_add_u32 s48, s50, 46592
buffer_load_dwordx4 v11, s[20:23], s48 offen lds
ds_read_b64_tr_b16 v[104:105], v4 offset:0
ds_read_b64_tr_b16 v[106:107], v4 offset:1024
ds_read_b64_tr_b16 v[108:109], v4 offset:4096
ds_read_b64_tr_b16 v[110:111], v4 offset:5120
ds_read_b64_tr_b16 v[112:113], v4 offset:8192
ds_read_b64_tr_b16 v[114:115], v4 offset:9216
ds_read_b64_tr_b16 v[116:117], v4 offset:12288
ds_read_b64_tr_b16 v[118:119], v4 offset:13312
ds_read_b64_tr_b16 v[120:121], v4 offset:16384
ds_read_b64_tr_b16 v[122:123], v4 offset:17408
ds_read_b64_tr_b16 v[124:125], v4 offset:20480
ds_read_b64_tr_b16 v[126:127], v4 offset:21504
ds_read_b64_tr_b16 v[128:129], v4 offset:24576
ds_read_b64_tr_b16 v[130:131], v4 offset:25600
ds_read_b64_tr_b16 v[132:133], v4 offset:28672
ds_read_b64_tr_b16 v[134:135], v4 offset:29696
s_waitcnt lgkmcnt(0)
s_waitcnt vmcnt(24)
s_barrier
s_mov_b32 m0, 0
s_add_u32 s48, s50, 61952
buffer_load_dwordx4 v11, s[20:23], s48 offen lds
s_mov_b32 m0, 1024
s_add_u32 s48, s50, 67072
buffer_load_dwordx4 v11, s[20:23], s48 offen lds
s_mov_b32 m0, 8192
s_add_u32 s48, s49, 0
buffer_load_dwordx4 v10, s[12:15], s48 offen lds
s_mov_b32 m0, 9216
s_add_u32 s48, s49, 65536
buffer_load_dwordx4 v10, s[12:15], s48 offen lds
s_mov_b32 m0, 16384
s_add_u32 s48, s49, 524288
buffer_load_dwordx4 v10, s[12:15], s48 offen lds
s_mov_b32 m0, 17408
s_add_u32 s48, s49, 589824
buffer_load_dwordx4 v10, s[12:15], s48 offen lds
s_mov_b32 m0, 24576
s_add_u32 s48, s49, 1048576
buffer_load_dwordx4 v10, s[12:15], s48 offen lds
s_mov_b32 m0, 25600
s_add_u32 s48, s49, 1114112
buffer_load_dwordx4 v10, s[12:15], s48 offen lds
ds_read_b64_tr_b16 v[136:137], v4 offset:32768
ds_read_b64_tr_b16 v[138:139], v4 offset:33792
ds_read_b64_tr_b16 v[140:141], v4 offset:36864
ds_read_b64_tr_b16 v[142:143], v4 offset:37888
ds_read_b64_tr_b16 v[144:145], v4 offset:40960
ds_read_b64_tr_b16 v[146:147], v4 offset:41984
ds_read_b64_tr_b16 v[148:149], v4 offset:45056
ds_read_b64_tr_b16 v[150:151], v4 offset:46080
ds_read_b64_tr_b16 v[152:153], v4 offset:49152
ds_read_b64_tr_b16 v[154:155], v4 offset:50176
ds_read_b64_tr_b16 v[156:157], v4 offset:53248
ds_read_b64_tr_b16 v[158:159], v4 offset:54272
ds_read_b64_tr_b16 v[160:161], v4 offset:57344
ds_read_b64_tr_b16 v[162:163], v4 offset:58368
ds_read_b64_tr_b16 v[164:165], v4 offset:61440
ds_read_b64_tr_b16 v[166:167], v4 offset:62464
s_waitcnt lgkmcnt(0)
s_waitcnt vmcnt(24)
s_barrier
s_mov_b32 m0, 32768
s_add_u32 s48, s49, 1572864
buffer_load_dwordx4 v10, s[12:15], s48 offen lds
s_mov_b32 m0, 33792
s_add_u32 s48, s49, 1638400
buffer_load_dwordx4 v10, s[12:15], s48 offen lds
s_mov_b32 m0, 40960
s_add_u32 s48, s49, 2097152
buffer_load_dwordx4 v10, s[12:15], s48 offen lds
s_mov_b32 m0, 41984
s_add_u32 s48, s49, 2162688
buffer_load_dwordx4 v10, s[12:15], s48 offen lds
s_mov_b32 m0, 49152
s_add_u32 s48, s49, 2621440
buffer_load_dwordx4 v10, s[12:15], s48 offen lds
s_mov_b32 m0, 50176
s_add_u32 s48, s49, 2686976
buffer_load_dwordx4 v10, s[12:15], s48 offen lds
s_mov_b32 m0, 57344
s_add_u32 s48, s49, 1048704
buffer_load_dwordx4 v10, s[16:19], s48 offen lds
s_mov_b32 m0, 58368
s_add_u32 s48, s49, 1114240
buffer_load_dwordx4 v10, s[16:19], s48 offen lds
ds_read_b64_tr_b16 v[168:169], v5 offset:0
ds_read_b64_tr_b16 v[170:171], v5 offset:1024
ds_read_b64_tr_b16 v[172:173], v5 offset:4096
ds_read_b64_tr_b16 v[174:175], v5 offset:5120
v_xor_b32 v12, v15, v8
ds_read_b64_tr_b16 v[24:25], v12 offset:8192
ds_read_b64_tr_b16 v[26:27], v12 offset:8704
ds_read_b64_tr_b16 v[28:29], v12 offset:10240
ds_read_b64_tr_b16 v[30:31], v12 offset:10752
ds_read_b64_tr_b16 v[176:177], v8 offset:16384
ds_read_b64_tr_b16 v[178:179], v8 offset:16896
ds_read_b64_tr_b16 v[180:181], v8 offset:18432
ds_read_b64_tr_b16 v[182:183], v8 offset:18944
ds_read_b64_tr_b16 v[184:185], v8 offset:24576
ds_read_b64_tr_b16 v[186:187], v8 offset:25088
ds_read_b64_tr_b16 v[188:189], v8 offset:26624
ds_read_b64_tr_b16 v[190:191], v8 offset:27136
s_waitcnt lgkmcnt(0)
buffer_store_dwordx4 v[24:27], v0, s[4:7], s61 offen offset:0
buffer_store_dwordx4 v[28:31], v0, s[4:7], s61 offen offset:1024
s_waitcnt vmcnt(26)
s_barrier
s_mov_b32 m0, 65536
s_add_u32 s48, s49, 1572992
buffer_load_dwordx4 v10, s[16:19], s48 offen lds
s_mov_b32 m0, 66560
s_add_u32 s48, s49, 1638528
buffer_load_dwordx4 v10, s[16:19], s48 offen lds
s_mov_b32 m0, 73728
s_add_u32 s48, s49, 2097280
buffer_load_dwordx4 v10, s[16:19], s48 offen lds
s_mov_b32 m0, 74752
s_add_u32 s48, s49, 2162816
buffer_load_dwordx4 v10, s[16:19], s48 offen lds
s_mov_b32 m0, 81920
s_add_u32 s48, s49, 2621568
buffer_load_dwordx4 v10, s[16:19], s48 offen lds
s_mov_b32 m0, 82944
s_add_u32 s48, s49, 2687104
buffer_load_dwordx4 v10, s[16:19], s48 offen lds
s_mov_b32 m0, 90112
s_add_u32 s48, s50, 768
buffer_load_dwordx4 v11, s[20:23], s48 offen lds
s_mov_b32 m0, 91136
s_add_u32 s48, s50, 5888
buffer_load_dwordx4 v11, s[20:23], s48 offen lds
ds_read_b64_tr_b16 v[192:193], v8 offset:32768
ds_read_b64_tr_b16 v[194:195], v8 offset:33280
ds_read_b64_tr_b16 v[196:197], v8 offset:34816
ds_read_b64_tr_b16 v[198:199], v8 offset:35328
v_xor_b32 v12, v15, v8
ds_read_b64_tr_b16 v[24:25], v12 offset:40960
ds_read_b64_tr_b16 v[26:27], v12 offset:41472
ds_read_b64_tr_b16 v[28:29], v12 offset:43008
ds_read_b64_tr_b16 v[30:31], v12 offset:43520
ds_read_b64_tr_b16 a[184:185], v8 offset:49152
ds_read_b64_tr_b16 a[186:187], v8 offset:49664
ds_read_b64_tr_b16 a[188:189], v8 offset:51200
ds_read_b64_tr_b16 a[190:191], v8 offset:51712
ds_read_b64_tr_b16 v[224:225], v8 offset:57344
ds_read_b64_tr_b16 v[226:227], v8 offset:57856
ds_read_b64_tr_b16 v[228:229], v8 offset:59392
ds_read_b64_tr_b16 v[230:231], v8 offset:59904
s_waitcnt lgkmcnt(0)
buffer_store_dwordx4 v[24:27], v0, s[4:7], s61 offen offset:2048
buffer_store_dwordx4 v[28:31], v0, s[4:7], s61 offen offset:3072
s_waitcnt vmcnt(28)
s_barrier
s_mov_b32 m0, 98304
s_add_u32 s48, s50, 21248
buffer_load_dwordx4 v11, s[20:23], s48 offen lds
s_mov_b32 m0, 99328
s_add_u32 s48, s50, 26368
buffer_load_dwordx4 v11, s[20:23], s48 offen lds
s_mov_b32 m0, 106496
s_add_u32 s48, s50, 41728
buffer_load_dwordx4 v11, s[20:23], s48 offen lds
s_mov_b32 m0, 107520
s_add_u32 s48, s50, 46848
buffer_load_dwordx4 v11, s[20:23], s48 offen lds
s_mov_b32 m0, 114688
s_add_u32 s48, s50, 62208
buffer_load_dwordx4 v11, s[20:23], s48 offen lds
s_mov_b32 m0, 115712
s_add_u32 s48, s50, 67328
buffer_load_dwordx4 v11, s[20:23], s48 offen lds
s_mov_b32 m0, 122880
s_add_u32 s48, s50, 1024
buffer_load_dwordx4 v11, s[20:23], s48 offen lds
s_mov_b32 m0, 123904
s_add_u32 s48, s50, 6144
buffer_load_dwordx4 v11, s[20:23], s48 offen lds
ds_read_b64_tr_b16 v[16:17], v9 offset:0
ds_read_b64_tr_b16 v[18:19], v9 offset:512
ds_read_b64_tr_b16 v[20:21], v9 offset:2048
ds_read_b64_tr_b16 v[22:23], v9 offset:2560
v_xor_b32 v12, v15, v9
ds_read_b64_tr_b16 v[200:201], v12 offset:8192
ds_read_b64_tr_b16 v[202:203], v12 offset:8704
ds_read_b64_tr_b16 v[204:205], v12 offset:10240
ds_read_b64_tr_b16 v[206:207], v12 offset:10752
ds_read_b64_tr_b16 v[32:33], v9 offset:16384
ds_read_b64_tr_b16 v[34:35], v9 offset:16896
ds_read_b64_tr_b16 v[36:37], v9 offset:18432
ds_read_b64_tr_b16 v[38:39], v9 offset:18944
ds_read_b64_tr_b16 v[208:209], v9 offset:24576
ds_read_b64_tr_b16 v[210:211], v9 offset:25088
ds_read_b64_tr_b16 v[212:213], v9 offset:26624
ds_read_b64_tr_b16 v[214:215], v9 offset:27136
s_waitcnt lgkmcnt(0)
buffer_store_dwordx4 v[16:19], v0, s[4:7], s62 offen offset:0
buffer_store_dwordx4 v[20:23], v0, s[4:7], s62 offen offset:1024
buffer_store_dwordx4 v[32:35], v0, s[4:7], s62 offen offset:2048
buffer_store_dwordx4 v[36:39], v0, s[4:7], s62 offen offset:3072
s_waitcnt vmcnt(38)
s_barrier
s_mov_b32 m0, 131072
s_add_u32 s48, s50, 21504
buffer_load_dwordx4 v11, s[20:23], s48 offen lds
s_mov_b32 m0, 132096
s_add_u32 s48, s50, 26624
buffer_load_dwordx4 v11, s[20:23], s48 offen lds
s_mov_b32 m0, 139264
s_add_u32 s48, s50, 41984
buffer_load_dwordx4 v11, s[20:23], s48 offen lds
s_mov_b32 m0, 140288
s_add_u32 s48, s50, 47104
buffer_load_dwordx4 v11, s[20:23], s48 offen lds
s_mov_b32 m0, 147456
s_add_u32 s48, s50, 62464
buffer_load_dwordx4 v11, s[20:23], s48 offen lds
s_mov_b32 m0, 148480
s_add_u32 s48, s50, 67584
buffer_load_dwordx4 v11, s[20:23], s48 offen lds
s_mov_b32 m0, 155648
s_add_u32 s48, s49, 3145728
buffer_load_dwordx4 v10, s[8:11], s48 offen lds
s_mov_b32 m0, 156672
s_add_u32 s48, s49, 3211264
buffer_load_dwordx4 v10, s[8:11], s48 offen lds
ds_read_b64_tr_b16 v[216:217], v7 offset:0
ds_read_b64_tr_b16 v[218:219], v7 offset:512
ds_read_b64_tr_b16 v[220:221], v7 offset:2048
ds_read_b64_tr_b16 v[222:223], v7 offset:2560
s_waitcnt lgkmcnt(0)
s_waitcnt vmcnt(32)
s_barrier
ds_read_b64_tr_b16 v[16:17], v4 offset:8192
ds_read_b64_tr_b16 v[18:19], v4 offset:9216
ds_read_b64_tr_b16 v[20:21], v4 offset:12288
ds_read_b64_tr_b16 v[22:23], v4 offset:13312
ds_read_b64_tr_b16 v[24:25], v4 offset:16384
ds_read_b64_tr_b16 v[26:27], v4 offset:17408
ds_read_b64_tr_b16 v[28:29], v4 offset:20480
ds_read_b64_tr_b16 v[30:31], v4 offset:21504
ds_read_b64_tr_b16 v[32:33], v4 offset:24576
ds_read_b64_tr_b16 v[34:35], v4 offset:25600
ds_read_b64_tr_b16 v[36:37], v4 offset:28672
ds_read_b64_tr_b16 v[38:39], v4 offset:29696
ds_read_b64_tr_b16 v[40:41], v4 offset:32768
ds_read_b64_tr_b16 v[42:43], v4 offset:33792
ds_read_b64_tr_b16 v[44:45], v4 offset:36864
ds_read_b64_tr_b16 v[46:47], v4 offset:37888
ds_read_b64_tr_b16 v[48:49], v4 offset:40960
ds_read_b64_tr_b16 v[50:51], v4 offset:41984
ds_read_b64_tr_b16 v[52:53], v4 offset:45056
ds_read_b64_tr_b16 v[54:55], v4 offset:46080
ds_read_b64_tr_b16 v[56:57], v4 offset:49152
ds_read_b64_tr_b16 v[58:59], v4 offset:50176
ds_read_b64_tr_b16 v[60:61], v4 offset:53248
ds_read_b64_tr_b16 v[62:63], v4 offset:54272
ds_read_b64_tr_b16 v[64:65], v4 offset:57344
ds_read_b64_tr_b16 v[66:67], v4 offset:58368
ds_read_b64_tr_b16 v[68:69], v4 offset:61440
ds_read_b64_tr_b16 v[70:71], v4 offset:62464
s_waitcnt lgkmcnt(0)
s_barrier
ds_write_b128 v0, v[16:19] offset:8192
ds_write_b128 v0, v[20:23] offset:9216
ds_write_b128 v0, v[24:27] offset:10240
ds_write_b128 v0, v[28:31] offset:11264
ds_write_b128 v0, v[32:35] offset:12288
ds_write_b128 v0, v[36:39] offset:13312
ds_write_b128 v0, v[40:43] offset:14336
ds_write_b128 v0, v[44:47] offset:15360
ds_write_b128 v0, v[48:51] offset:16384
ds_write_b128 v0, v[52:55] offset:17408
ds_write_b128 v0, v[56:59] offset:18432
ds_write_b128 v0, v[60:63] offset:19456
ds_write_b128 v0, v[64:67] offset:20480
ds_write_b128 v0, v[68:71] offset:21504
s_waitcnt lgkmcnt(0)
s_waitcnt vmcnt(6)
s_barrier
v_xor_b32 v12, v15, v8
ds_read_b64_tr_b16 v[16:17], v12 offset:24576
ds_read_b64_tr_b16 v[18:19], v12 offset:25088
ds_read_b64_tr_b16 v[20:21], v12 offset:26624
ds_read_b64_tr_b16 v[22:23], v12 offset:27136
ds_read_b64_tr_b16 v[24:25], v8 offset:32768
ds_read_b64_tr_b16 v[26:27], v8 offset:33280
ds_read_b64_tr_b16 v[28:29], v8 offset:34816
ds_read_b64_tr_b16 v[30:31], v8 offset:35328
ds_read_b64_tr_b16 v[32:33], v8 offset:40960
ds_read_b64_tr_b16 v[34:35], v8 offset:41472
ds_read_b64_tr_b16 v[36:37], v8 offset:43008
ds_read_b64_tr_b16 v[38:39], v8 offset:43520
ds_read_b64_tr_b16 v[40:41], v8 offset:49152
ds_read_b64_tr_b16 v[42:43], v8 offset:49664
ds_read_b64_tr_b16 v[44:45], v8 offset:51200
ds_read_b64_tr_b16 v[46:47], v8 offset:51712
v_xor_b32 v12, v15, v8
ds_read_b64_tr_b16 v[48:49], v12 offset:57344
ds_read_b64_tr_b16 v[50:51], v12 offset:57856
ds_read_b64_tr_b16 v[52:53], v12 offset:59392
ds_read_b64_tr_b16 v[54:55], v12 offset:59904
ds_read_b64_tr_b16 v[56:57], v9 offset:0
ds_read_b64_tr_b16 v[58:59], v9 offset:512
ds_read_b64_tr_b16 v[60:61], v9 offset:2048
ds_read_b64_tr_b16 v[62:63], v9 offset:2560
s_waitcnt lgkmcnt(0)
s_barrier
ds_write_b128 v2, v[224:227] offset:16384
ds_write_b128 v2, v[228:231] offset:17408
ds_write_b128 v2, v[24:27] offset:18432
ds_write_b128 v2, v[28:31] offset:19456
ds_write_b128 v2, v[32:35] offset:20480
ds_write_b128 v2, v[36:39] offset:21504
ds_write_b128 v2, v[232:235] offset:22528
ds_write_b128 v2, v[236:239] offset:23552
ds_write_b128 v2, v[240:243] offset:24576
ds_write_b128 v2, v[244:247] offset:25600
ds_write_b128 v2, v[56:59] offset:26624
ds_write_b128 v2, v[60:63] offset:27648
s_waitcnt lgkmcnt(0)
v_mov_b32 v224, v16
v_mov_b32 v225, v17
v_mov_b32 v226, v18
v_mov_b32 v227, v19
v_mov_b32 v228, v20
v_mov_b32 v229, v21
v_mov_b32 v230, v22
v_mov_b32 v231, v23
v_mov_b32 v232, v40
v_mov_b32 v233, v41
v_mov_b32 v234, v42
v_mov_b32 v235, v43
v_mov_b32 v236, v44
v_mov_b32 v237, v45
v_mov_b32 v238, v46
v_mov_b32 v239, v47
v_mov_b32 v240, v48
v_mov_b32 v241, v49
v_mov_b32 v242, v50
v_mov_b32 v243, v51
v_mov_b32 v244, v52
v_mov_b32 v245, v53
v_mov_b32 v246, v54
v_mov_b32 v247, v55
s_waitcnt vmcnt(0)
s_barrier
ds_read_b64_tr_b16 v[16:17], v5 offset:0
ds_read_b64_tr_b16 v[18:19], v5 offset:1024
ds_read_b64_tr_b16 v[20:21], v5 offset:4096
ds_read_b64_tr_b16 v[22:23], v5 offset:5120
ds_read_b64_tr_b16 v[24:25], v5 offset:8192
ds_read_b64_tr_b16 v[26:27], v5 offset:9216
ds_read_b64_tr_b16 v[28:29], v5 offset:12288
ds_read_b64_tr_b16 v[30:31], v5 offset:13312
ds_read_b64_tr_b16 v[32:33], v5 offset:16384
ds_read_b64_tr_b16 v[34:35], v5 offset:17408
ds_read_b64_tr_b16 v[36:37], v5 offset:20480
ds_read_b64_tr_b16 v[38:39], v5 offset:21504
ds_read_b64_tr_b16 v[40:41], v9 offset:8192
ds_read_b64_tr_b16 v[42:43], v9 offset:8704
ds_read_b64_tr_b16 v[44:45], v9 offset:10240
ds_read_b64_tr_b16 v[46:47], v9 offset:10752
ds_read_b64_tr_b16 v[48:49], v9 offset:16384
ds_read_b64_tr_b16 v[50:51], v9 offset:16896
ds_read_b64_tr_b16 v[52:53], v9 offset:18432
ds_read_b64_tr_b16 v[54:55], v9 offset:18944
ds_read_b64_tr_b16 v[56:57], v6 offset:24576
ds_read_b64_tr_b16 v[58:59], v6 offset:25600
ds_read_b64_tr_b16 v[60:61], v6 offset:28672
ds_read_b64_tr_b16 v[62:63], v6 offset:29696
s_waitcnt lgkmcnt(0)
s_barrier
ds_write_b128 v2, v[16:19] offset:40960
ds_write_b128 v2, v[20:23] offset:41984
ds_write_b128 v2, v[24:27] offset:43008
ds_write_b128 v2, v[28:31] offset:44032
ds_write_b128 v2, a[176:179] offset:45056
ds_write_b128 v2, a[180:183] offset:46080
ds_write_b128 v2, v[40:43] offset:47104
ds_write_b128 v2, v[44:47] offset:48128
ds_write_b128 v2, v[248:251] offset:49152
ds_write_b128 v2, v[252:255] offset:50176
ds_write_b128 v2, a[184:187] offset:51200
ds_write_b128 v2, a[188:191] offset:52224
s_waitcnt lgkmcnt(0)
v_accvgpr_write_b32 a176, v32
v_accvgpr_write_b32 a177, v33
v_accvgpr_write_b32 a178, v34
v_accvgpr_write_b32 a179, v35
v_accvgpr_write_b32 a180, v36
v_accvgpr_write_b32 a181, v37
v_accvgpr_write_b32 a182, v38
v_accvgpr_write_b32 a183, v39
v_mov_b32 v248, v48
v_mov_b32 v249, v49
v_mov_b32 v250, v50
v_mov_b32 v251, v51
v_mov_b32 v252, v52
v_mov_b32 v253, v53
v_mov_b32 v254, v54
v_mov_b32 v255, v55
v_accvgpr_write_b32 a184, v56
v_accvgpr_write_b32 a185, v57
v_accvgpr_write_b32 a186, v58
v_accvgpr_write_b32 a187, v59
v_accvgpr_write_b32 a188, v60
v_accvgpr_write_b32 a189, v61
v_accvgpr_write_b32 a190, v62
v_accvgpr_write_b32 a191, v63
s_mov_b32 s12, 0x3030303
s_mov_b32 s13, 0x3030303
s_mov_b32 s14, 0xc0c0c0c
s_mov_b32 s15, 0xc0c0c0c
s_mov_b32 s16, 0x30303030
s_mov_b32 s17, 0x30303030
s_mov_b32 s18, 0xc0c0c0c0
s_mov_b32 s19, 0xc0c0c0c0
s_mov_b32 s8, s4
s_mov_b32 s9, s5
s_cmp_eq_u32 s30, 28
s_cselect_b32 s10, s6, 0
s_waitcnt vmcnt(0)
s_barrier
v_mov_b32 v8, 160
s_mov_b64 exec, 1
s_add_u32 s49, s31, 32
k_tb_131:
global_load_dword v9, v8, s[28:29] sc1
global_load_dword v11, v8, s[28:29] offset:32 sc1
s_waitcnt vmcnt(1)
v_readfirstlane_b32 s48, v9
s_waitcnt vmcnt(0)
v_readfirstlane_b32 s50, v11
s_cmp_gt_u32 s48, 0xffff
s_cmov_b32 s64, 0x10000
s_cmp_ge_u32 s50, 32
s_cselect_b32 s50, 0xffff, 0
s_and_b32 s48, s48, s50
s_cmp_ge_u32 s48, s49
s_cbranch_scc1 k_tbd_132
s_sub_u32 s32, s32, 1
s_cmp_gt_i32 s32, 0
s_cbranch_scc1 k_tb_131
k_tbd_132:
v_mov_b32 v9, s64
ds_write_b32 v8, v9
s_mov_b64 exec, -1
s_waitcnt lgkmcnt(0)
s_barrier
ds_read_b32 v9, v8
s_waitcnt lgkmcnt(0)
v_readfirstlane_b32 s64, v9
v_lshlrev_b32 v23, v0, s58
v_cndmask_b32 v20, 0, v23, s[90:91]
v_cndmask_b32 v21, 0, v23, s[92:93]
v_cndmask_b32 v22, 0, v23, s[94:95]
v_cndmask_b32 v23, 0, v23, s[96:97]
s_branch k_go_130
k_lay_129:
s_add_u32 s47, s31, 63
s_mul_i32 s33, s31, 0
s_add_u32 s33, s33, 120324096
s_add_u32 s34, s33, 2048
s_add_u32 s35, s33, 6144
s_mul_i32 s48, s31, 655360
s_lshl_b32 s36, s30, 14
s_add_u32 s36, s36, s48
s_add_u32 s36, s36, 0
v_mov_b32 v36, -1
s_and_b32 s48, s30, 15
s_add_u32 s48, s48, 0
s_lshr_b32 s49, s48, 1
s_and_b32 s48, s48, 1
s_lshl_b32 s44, s49, 8
s_lshl_b32 s50, s48, 6
s_add_u32 s44, s44, s50
s_add_u32 s44, s44, s33
s_mul_i32 s48, s48, 5120
s_lshl_b32 s49, s49, 5
s_add_u32 s48, s48, s49
v_lshrrev_b32 v32, 4, v0
v_and_b32 v33, 3, v32
v_mul_u32_u24 v33, 1280, v33
v_bfe_u32 v34, v32, 2, 1
v_lshl_add_u32 v33, v34, 1, v33
v_bfe_u32 v34, v32, 4, 1
v_lshl_add_u32 v33, v34, 4, v33
v_bfe_u32 v34, v32, 5, 1
v_lshl_add_u32 v33, v34, 2, v33
buffer_load_ushort v34, v33, s[24:27], s48 offen
buffer_load_ushort v35, v33, s[24:27], s48 offen offset:8
v_and_b32 v45, 0x30, v0
v_lshrrev_b32 v46, 8, v0
v_lshl_or_b32 v45, v46, 2, v45
v_bfe_u32 v46, v0, 6, 1
v_lshl_or_b32 v45, v46, 7, v45
v_cndmask_b32 v45, v45, 2.0, s[98:99]
s_lshl_b32 s63, s30, 10
s_add_u32 s63, s63, 0x8000
s_add_u32 s63, s63, s33
s_lshl_b32 s37, s31, 14
s_add_u32 s37, s37, 117440512
s_add_u32 s59, s37, 4096
s_waitcnt vmcnt(0)
s_barrier
v_mov_b32 v8, 160
s_mov_b64 exec, 1
v_mov_b32 v8, 160
v_or_b32 v9, s64, 1
global_atomic_add v8, v9, s[28:29] sc1
s_mov_b64 exec, -1
s_mov_b64 exec, 1
s_add_u32 s49, s31, 0
k_tb_133:
global_load_dword v9, v8, s[28:29] sc1
global_load_dword v11, v8, s[28:29] offset:32 sc1
s_waitcnt vmcnt(1)
v_readfirstlane_b32 s48, v9
s_waitcnt vmcnt(0)
v_readfirstlane_b32 s50, v11
s_cmp_gt_u32 s48, 0xffff
s_cmov_b32 s64, 0x10000
s_cmp_ge_u32 s50, 32
s_cselect_b32 s50, 0xffff, 0
s_and_b32 s48, s48, s50
s_cmp_ge_u32 s48, s49
s_cbranch_scc1 k_tbd_134
s_sub_u32 s32, s32, 1
s_cmp_gt_i32 s32, 0
s_cbranch_scc1 k_tb_133
k_tbd_134:
v_mov_b32 v9, s64
ds_write_b32 v8, v9
s_mov_b64 exec, -1
s_waitcnt lgkmcnt(0)
s_barrier
ds_read_b32 v9, v8
s_waitcnt lgkmcnt(0)
v_readfirstlane_b32 s64, v9
v_lshl_or_b32 v34, v35, 16, v34
buffer_store_dword v34, v45, s[4:7], s44 offen sc1
s_add_u32 s44, s44, 16384
buffer_store_dword v36, v45, s[4:7], s44 offen sc1
s_waitcnt vmcnt(0)
s_barrier
v_mov_b32 v8, 160
s_mov_b64 exec, 1
v_mov_b32 v8, 160
v_or_b32 v9, s64, 1
global_atomic_add v8, v9, s[28:29] sc1
s_mov_b64 exec, -1
s_mov_b64 exec, 1
s_add_u32 s49, s31, 32
k_tb_135:
global_load_dword v9, v8, s[28:29] sc1
global_load_dword v11, v8, s[28:29] offset:32 sc1
s_waitcnt vmcnt(1)
v_readfirstlane_b32 s48, v9
s_waitcnt vmcnt(0)
v_readfirstlane_b32 s50, v11
s_cmp_gt_u32 s48, 0xffff
s_cmov_b32 s64, 0x10000
s_cmp_ge_u32 s50, 32
s_cselect_b32 s50, 0xffff, 0
s_and_b32 s48, s48, s50
s_cmp_ge_u32 s48, s49
s_cbranch_scc1 k_tbd_136
s_sub_u32 s32, s32, 1
s_cmp_gt_i32 s32, 0
s_cbranch_scc1 k_tb_135
k_tbd_136:
v_mov_b32 v9, s64
ds_write_b32 v8, v9
s_mov_b64 exec, -1
s_waitcnt lgkmcnt(0)
s_barrier
ds_read_b32 v9, v8
s_waitcnt lgkmcnt(0)
v_readfirstlane_b32 s64, v9
v_lshlrev_b32 v23, v0, s58
v_cndmask_b32 v20, 0, v23, s[90:91]
v_cndmask_b32 v21, 0, v23, s[92:93]
v_cndmask_b32 v22, 0, v23, s[94:95]
v_cndmask_b32 v23, 0, v23, s[96:97]
k_go_130:
s_cmp_lg_u32 s64, 0
s_cbranch_scc1 k_far_137
s_branch k_cold2_141
k_T0_139:
s_waitcnt vmcnt(2)
v_smfmac_f32_16x16x64_bf16 v[40:43], v[4:7], v[48:55], v1
s_waitcnt vmcnt(1)
v_cmp_u_f32 vcc, v4, v8
v_smfmac_f32_16x16x64_bf16 v[24:27], v[8:11], a[24:31], v1
v_smfmac_f32_16x16x64_bf16 v[28:31], v[8:11], a[32:39], v1
s_cbranch_vccnz k_cold_140
k_okC_142:
s_waitcnt vmcnt(1)
v_smfmac_f32_16x16x64_bf16 v[36:39], v[8:11], a[40:47], v1
s_waitcnt lgkmcnt(0)
ds_read_b128 v[48:51], v2 offset:45056
v_smfmac_f32_16x16x64_bf16 v[32:35], v[4:7], v[64:71], v1
ds_read_b128 v[52:55], v2 offset:46080
ds_read_b128 v[64:67], v0 offset:10240
v_smfmac_f32_16x16x64_bf16 v[44:47], v[4:7], v[56:63], v1
ds_read_b128 v[68:71], v0 offset:11264
v_smfmac_f32_16x16x64_bf16 v[28:31], v[4:7], a[8:15], v1
v_smfmac_f32_16x16x64_bf16 v[24:27], v[4:7], a[0:7], v1
ds_read_b128 v[56:59], v2 offset:22528
v_smfmac_f32_16x16x64_bf16 v[36:39], v[4:7], a[16:23], v1
ds_read_b128 v[60:63], v2 offset:23552
s_waitcnt lgkmcnt(4)
v_smfmac_f32_16x16x64_bf16 v[40:43], v[8:11], v[48:55], v1
s_waitcnt vmcnt(0)
ds_write_b128 v0, v[12:15] offset:0
s_waitcnt lgkmcnt(3)
v_smfmac_f32_16x16x64_bf16 v[32:35], v[8:11], v[64:71], v1
buffer_load_dwordx4 v[16:19], v0, s[4:7], s35 offen offset:0 sc1
v_cmp_u_f32 vcc, v12, v12
s_waitcnt lgkmcnt(1)
v_smfmac_f32_16x16x64_bf16 v[44:47], v[8:11], v[56:63], v1
ds_read_b128 v[56:59], v0 offset:20480
ds_read_b128 v[60:63], v0 offset:21504
ds_read_b128 v[64:67], v0 offset:12288
s_cbranch_vccnz k_coldA_143
k_okA_144:
v_smfmac_f32_16x16x64_bf16 v[36:39], v[12:15], a[64:71], v1
ds_read_b128 v[68:71], v0 offset:13312
s_waitcnt lgkmcnt(4)
v_smfmac_f32_16x16x64_bf16 v[40:43], v[12:15], a[72:79], v1
s_barrier
v_smfmac_f32_16x16x64_bf16 v[28:31], v[12:15], a[56:63], v1
ds_read_b128 v[8:11], v0 offset:1024
buffer_load_dwordx4 v[48:51], v0, s[4:7], s36 offen offset:0 sc1
s_waitcnt lgkmcnt(3)
v_smfmac_f32_16x16x64_bf16 v[44:47], v[12:15], v[56:63], v1
ds_read_b128 v[56:59], v2 offset:40960
v_smfmac_f32_16x16x64_bf16 v[24:27], v[12:15], a[48:55], v1
ds_read_b128 v[60:63], v2 offset:41984
s_waitcnt lgkmcnt(3)
v_smfmac_f32_16x16x64_bf16 v[32:35], v[12:15], v[64:71], v1
buffer_load_dwordx4 v[52:55], v0, s[4:7], s36 offen offset:1024 sc1
s_waitcnt lgkmcnt(2)
v_smfmac_f32_16x16x64_bf16 v[24:27], v[8:11], a[80:87], v1
ds_read_b128 v[64:67], v0 offset:14336
ds_read_b128 v[68:71], v0 offset:15360
v_smfmac_f32_16x16x64_bf16 v[36:39], v[8:11], a[96:103], v1
buffer_store_dwordx4 v[4:7], v0, s[8:11], s37 offen offset:0 sc1
s_waitcnt lgkmcnt(2)
s_nop 0
ds_read_b128 v[4:7], v0 offset:2048
v_smfmac_f32_16x16x64_bf16 v[44:47], v[8:11], v[56:63], v1
ds_read_b128 v[56:59], v2 offset:43008
ds_read_b128 v[60:63], v2 offset:44032
v_smfmac_f32_16x16x64_bf16 v[28:31], v[8:11], a[88:95], v1
buffer_store_dwordx4 v[12:15], v0, s[8:11], s37 offen offset:2048 sc1
v_smfmac_f32_16x16x64_bf16 v[40:43], v[8:11], a[104:111], v1
s_waitcnt lgkmcnt(3)
s_waitcnt lgkmcnt(2)
v_smfmac_f32_16x16x64_bf16 v[32:35], v[8:11], v[64:71], v1
ds_read_b128 v[64:67], v0 offset:16384
ds_read_b128 v[12:15], v0 offset:3072
v_smfmac_f32_16x16x64_bf16 v[36:39], v[4:7], a[128:135], v1
s_waitcnt lgkmcnt(2)
v_smfmac_f32_16x16x64_bf16 v[44:47], v[4:7], v[56:63], v1
ds_read_b128 v[68:71], v0 offset:17408
buffer_load_dwordx4 v[56:59], v0, s[4:7], s36 offen offset:2048 sc1
v_smfmac_f32_16x16x64_bf16 v[28:31], v[4:7], a[120:127], v1
v_smfmac_f32_16x16x64_bf16 v[24:27], v[4:7], a[112:119], v1
s_waitcnt vmcnt(5)
ds_write_b128 v0, v[16:19] offset:4096
v_smfmac_f32_16x16x64_bf16 v[40:43], v[4:7], a[136:143], v1
s_waitcnt lgkmcnt(1)
buffer_load_dwordx4 v[60:63], v0, s[4:7], s36 offen offset:3072 sc1
v_cmp_u_f32 vcc, v16, v16
v_smfmac_f32_16x16x64_bf16 v[32:35], v[4:7], v[64:71], v1
ds_read_b128 v[64:67], v0 offset:18432
ds_read_b128 v[68:71], v0 offset:19456
v_smfmac_f32_16x16x64_bf16 v[28:31], v[12:15], a[152:159], v1
v_smfmac_f32_16x16x64_bf16 v[24:27], v[12:15], a[144:151], v1
s_cbranch_vccnz k_coldB_145
k_okB_146:
v_smfmac_f32_16x16x64_bf16 v[36:39], v[12:15], a[160:167], v1
s_waitcnt lgkmcnt(2)
buffer_store_dwordx4 v[16:19], v0, s[8:11], s59 offen offset:2048 sc1
s_barrier
ds_read_b128 v[4:7], v0 offset:6144
v_smfmac_f32_16x16x64_bf16 v[44:47], v[12:15], a[176:183], v1
ds_read_b128 v[8:11], v0 offset:5120
s_waitcnt lgkmcnt(2)
v_smfmac_f32_16x16x64_bf16 v[32:35], v[12:15], v[64:71], v1
ds_read_b128 v[64:67], v2 offset:24576
ds_read_b128 v[68:71], v2 offset:25600
v_smfmac_f32_16x16x64_bf16 v[24:27], v[16:19], a[184:191], v1
v_smfmac_f32_16x16x64_bf16 v[40:43], v[12:15], a[168:175], v1
s_waitcnt lgkmcnt(3)
ds_read_b128 v[12:15], v0 offset:7168
v_smfmac_f32_16x16x64_bf16 v[24:27], v[4:7], a[208:215], v1
s_waitcnt lgkmcnt(3)
v_smfmac_f32_16x16x64_bf16 v[28:31], v[4:7], a[216:223], v1
v_smfmac_f32_16x16x64_bf16 v[28:31], v[8:11], a[200:207], v1
s_waitcnt lgkmcnt(1)
v_smfmac_f32_16x16x64_bf16 v[24:27], v[8:11], v[64:71], v1
ds_read_b128 v[64:67], v2 offset:49152
s_waitcnt lgkmcnt(1)
v_smfmac_f32_16x16x64_bf16 v[24:27], v[12:15], a[224:231], v1
ds_read_b128 v[68:71], v2 offset:50176
v_smfmac_f32_16x16x64_bf16 v[28:31], v[12:15], a[232:239], v1
v_smfmac_f32_16x16x64_bf16 v[28:31], v[16:19], a[192:199], v1
v_cvt_pk_bf16_f32 v24, v24, v25
v_cvt_pk_bf16_f32 v25, v26, v27
v_smfmac_f32_16x16x64_bf16 v[32:35], v[4:7], v[80:87], v1
v_cvt_pk_bf16_f32 v26, v28, v29
v_cvt_pk_bf16_f32 v27, v30, v31
v_smfmac_f32_16x16x64_bf16 v[32:35], v[8:11], a[248:255], v1
s_waitcnt lgkmcnt(0)
v_mfma_f32_16x16x32_bf16 v[28:31], v[24:27], v[20:23], 0
v_and_b32 v26, 0xffffff7f, v0
v_smfmac_f32_16x16x64_bf16 v[32:35], v[16:19], v[64:71], v1
v_and_or_b32 v26, v1, 8, v26
v_mul_f32 v28, s51, v28
v_mul_f32 v29, s51, v29
v_mul_f32 v31, s51, v31
v_cvt_pk_bf16_f32 v24, v28, v29
v_mul_f32 v30, s51, v30
v_cvt_pk_bf16_f32 v25, v30, v31
v_smfmac_f32_16x16x64_bf16 v[32:35], v[12:15], v[96:103], v1
ds_write_b64 v26, v[24:25] offset:0
v_smfmac_f32_16x16x64_bf16 v[36:39], v[8:11], v[72:79], v1
v_cvt_pk_bf16_f32 v32, v32, v33
v_smfmac_f32_16x16x64_bf16 v[36:39], v[16:19], a[240:247], v1
buffer_load_dwordx4 v[64:67], v0, s[4:7], s61 offen offset:0
v_cvt_pk_bf16_f32 v33, v34, v35
v_smfmac_f32_16x16x64_bf16 v[36:39], v[12:15], v[104:111], v1
s_waitcnt lgkmcnt(0)
v_smfmac_f32_16x16x64_bf16 v[36:39], v[4:7], v[88:95], v1
s_barrier
ds_read_b128 v[24:27], v0 offset:0
v_smfmac_f32_16x16x64_bf16 v[40:43], v[4:7], v[144:151], v1
ds_read_b128 v[28:31], v0 offset:1024
s_nop 0
v_cvt_pk_bf16_f32 v34, v36, v37
v_cvt_pk_bf16_f32 v35, v38, v39
s_nop 1
v_mfma_f32_16x16x32_bf16 v[36:39], v[32:35], v[20:23], 0
s_waitcnt vmcnt(6)
buffer_load_dwordx4 v[68:71], v0, s[4:7], s61 offen offset:1024
v_and_b32 v34, 0xffffff7f, v0
v_and_or_b32 v34, v1, 8, v34
s_waitcnt lgkmcnt(1)
v_mfma_f32_16x16x32_bf16 v[48:51], v[48:51], v[24:27], 0
v_cvt_pk_bf16_f32 v32, v36, v37
s_waitcnt lgkmcnt(0)
v_mfma_f32_16x16x32_bf16 v[48:51], v[52:55], v[28:31], v[48:51]
v_mov_b64 v[52:53], s[56:57]
v_cvt_pk_bf16_f32 v33, v38, v39
v_smfmac_f32_16x16x64_bf16 v[44:47], v[4:7], v[152:159], v1
ds_write_b64 v34, v[32:33] offset:2048
v_permlane32_swap_b32 v48, v50
v_permlane32_swap_b32 v49, v51
v_add_f32_dpp v52, v50, v48 row_ror:8 row_mask:0xf bank_mask:0x3
v_exp_f32 v52, v52
v_add_f32_dpp v53, v51, v49 row_ror:8 row_mask:0xf bank_mask:0x3
v_exp_f32 v53, v53
s_nop 0
v_cvt_pk_bf16_f32 v48, v52, v53
v_smfmac_f32_16x16x64_bf16 v[44:47], v[16:19], v[120:127], v1
ds_write_b32 v0, v48 offset:4096
v_smfmac_f32_16x16x64_bf16 v[44:47], v[12:15], v[168:175], v1
buffer_load_dwordx4 v[48:51], v0, s[4:7], s61 offen offset:2048
v_smfmac_f32_16x16x64_bf16 v[40:43], v[12:15], v[160:167], v1
s_waitcnt lgkmcnt(1)
v_xor_b32 v12, 0x80, v0
v_smfmac_f32_16x16x64_bf16 v[40:43], v[8:11], v[128:135], v1
s_waitcnt lgkmcnt(0)
s_barrier
ds_read_b128 v[32:35], v0 offset:2048
v_mov_b64 v[22:23], s[52:53]
v_smfmac_f32_16x16x64_bf16 v[40:43], v[16:19], v[112:119], v1
ds_read_b128 v[36:39], v0 offset:3072
ds_read_b128 v[16:19], v0 offset:4096
buffer_load_dwordx4 v[52:55], v0, s[4:7], s61 offen offset:3072
v_smfmac_f32_16x16x64_bf16 v[44:47], v[8:11], v[136:143], v1
ds_read_b128 v[12:15], v12 offset:4096
v_cvt_pk_bf16_f32 v40, v40, v41
v_mov_b64 v[20:21], s[52:53]
s_waitcnt lgkmcnt(3)
v_mfma_f32_16x16x32_bf16 v[24:27], v[32:35], v[24:27], 0
v_cvt_pk_bf16_f32 v41, v42, v43
s_waitcnt lgkmcnt(2)
v_mfma_f32_16x16x32_bf16 v[24:27], v[36:39], v[28:31], v[24:27]
s_waitcnt vmcnt(5)
s_waitcnt lgkmcnt(1)
v_mfma_f32_16x16x32_bf16 v[8:11], v[56:59], v[16:19], 0
buffer_load_dwordx4 v[56:59], v0, s[4:7], s62 offen offset:0
v_mov_b64 v[28:29], s[56:57]
v_cvt_pk_bf16_f32 v43, v46, v47
v_cvt_pk_bf16_f32 v42, v44, v45
v_permlane32_swap_b32 v25, v27
v_permlane32_swap_b32 v24, v26
v_mfma_f32_16x16x32_bf16 v[4:7], v[20:23], v[16:19], 0
s_waitcnt lgkmcnt(0)
v_add_f32_dpp v28, v26, v24 row_ror:8 row_mask:0xf bank_mask:0x3
v_add_f32_dpp v29, v27, v25 row_ror:8 row_mask:0xf bank_mask:0x3
v_exp_f32 v28, v28
v_mfma_f32_16x16x32_bf16 v[8:11], v[60:63], v[12:15], v[8:11]
buffer_load_dwordx4 v[60:63], v0, s[4:7], s62 offen offset:1024
v_exp_f32 v29, v29
v_permlane32_swap_b32 v42, v43
v_cvt_pk_bf16_f32 v24, v28, v29
v_mov_b64 v[44:45], s[54:55]
v_cvt_pk_bf16_f32 v25, v28, v29
v_mov_b32_dpp v26, v24 row_ror:8 row_mask:0xf bank_mask:0xf
v_mov_b32_dpp v27, v24 row_ror:8 row_mask:0xf bank_mask:0xf
v_mfma_f32_16x16x16_bf16 v[4:7], v[44:45], v[24:25], v[4:7]
v_permlane32_swap_b32 v40, v41
v_mov_b64 v[36:37], 0
v_mov_b64 v[38:39], 0
v_mov_b64 v[30:31], 0
v_mfma_f32_16x16x32_bf16 v[8:11], v[40:43], v[24:27], v[8:11]
buffer_load_dwordx4 v[16:19], v0, s[4:7], s62 offen offset:2048
v_rcp_f32 v6, v4
v_and_b32 v12, 0xffffff7f, v0
v_and_or_b32 v13, v1, 8, v12
v_rcp_f32_dpp v6, v4 row_ror:8 row_mask:0xf bank_mask:0xc
v_mov_b64 v[26:27], 0
v_pk_mul_f32 v[8:9], v[8:9], v[6:7] op_sel_hi:[1,0]
v_cvt_pk_bf16_f32 v44, v8, v9
v_pk_mul_f32 v[10:11], v[10:11], v[6:7] op_sel_hi:[1,0]
v_cvt_pk_bf16_f32 v45, v10, v11
s_waitcnt vmcnt(5)
ds_write_b64 v13, v[44:45] offset:6144
buffer_load_dwordx4 v[20:23], v0, s[4:7], s62 offen offset:3072
v_add_u32 v6, 0xd4800000, v6
v_cmp_lt_u32 vcc, 0x28000000, v6
v_mov_b64 v[34:35], 0
v_mov_b32_dpp v46, v44 row_ror:8 row_mask:0xf bank_mask:0xf
v_mov_b32_dpp v47, v45 row_ror:8 row_mask:0xf bank_mask:0xf
v_mov_b64 v[28:29], 0
v_mov_b64 v[32:33], 0
s_cbranch_vccnz k_slow_147
k_okS_148:
v_smfmac_f32_16x16x64_bf16 v[36:39], v[44:47], v[224:231], v1
s_waitcnt lgkmcnt(0)
s_barrier
ds_read_b128 v[8:11], v12 offset:7168
v_smfmac_f32_16x16x64_bf16 v[32:35], v[44:47], v[200:207], v1
s_waitcnt vmcnt(4)
ds_read_b128 v[4:7], v12 offset:6272
v_mov_b64 v[24:25], 0
v_smfmac_f32_16x16x64_bf16 v[28:31], v[44:47], v[48:55], v1
ds_read_b128 v[12:15], v12 offset:7296
ds_read_b128 v[48:51], v2 offset:16384
v_smfmac_f32_16x16x64_bf16 v[24:27], v[44:47], v[64:71], v1
ds_read_b128 v[52:55], v2 offset:17408
v_mov_b64 v[42:43], 0
s_waitcnt lgkmcnt(4)
v_smfmac_f32_16x16x64_bf16 v[24:27], v[8:11], v[184:191], v1
s_waitcnt lgkmcnt(3)
v_mov_b64 v[40:41], 0
v_smfmac_f32_16x16x64_bf16 v[24:27], v[4:7], v[176:183], v1
s_waitcnt lgkmcnt(2)
ds_read_b128 v[64:67], v2 offset:51200
v_smfmac_f32_16x16x64_bf16 v[24:27], v[12:15], v[192:199], v1
ds_read_b128 v[68:71], v2 offset:52224
v_smfmac_f32_16x16x64_bf16 v[40:43], v[44:47], v[240:247], v1
s_waitcnt vmcnt(2)
s_waitcnt lgkmcnt(2)
v_lshrrev_b32 v44, 16, v1
v_cvt_pk_bf16_f32 v24, v24, v25
v_bfi_b32 v24, 1, s45, v24
v_cvt_pk_bf16_f32 v25, v26, v27
v_smfmac_f32_16x16x64_bf16 v[28:31], v[8:11], v[48:55], v1
buffer_store_dwordx2 v[24:25], v44, s[4:7], s38 offen
ds_read_b128 v[48:51], v2 offset:20480
ds_read_b128 v[52:55], v2 offset:21504
v_smfmac_f32_16x16x64_bf16 v[28:31], v[12:15], v[56:63], v1
s_waitcnt lgkmcnt(2)
ds_read_b128 v[56:59], v2 offset:26624
v_smfmac_f32_16x16x64_bf16 v[28:31], v[4:7], v[64:71], v1
ds_read_b128 v[60:63], v2 offset:27648
v_smfmac_f32_16x16x64_bf16 v[32:35], v[8:11], v[208:215], v1
ds_read_b128 v[64:67], v2 offset:18432
s_nop 0
v_cvt_pk_bf16_f32 v28, v28, v29
v_bfi_b32 v28, 1, s45, v28
v_cvt_pk_bf16_f32 v29, v30, v31
v_smfmac_f32_16x16x64_bf16 v[32:35], v[12:15], v[216:223], v1
buffer_store_dwordx2 v[28:29], v44, s[4:7], s39 offen
v_smfmac_f32_16x16x64_bf16 v[40:43], v[12:15], v[248:255], v1
ds_read_b128 v[68:71], v2 offset:19456
s_waitcnt vmcnt(2)
v_smfmac_f32_16x16x64_bf16 v[32:35], v[4:7], v[16:23], v1
s_waitcnt lgkmcnt(2)
v_smfmac_f32_16x16x64_bf16 v[36:39], v[12:15], v[232:239], v1
ds_read_b128 v[16:19], v2 offset:47104
ds_read_b128 v[20:23], v2 offset:48128
v_cvt_pk_bf16_f32 v32, v32, v33
v_bfi_b32 v32, 1, s45, v32
v_cvt_pk_bf16_f32 v33, v34, v35
v_smfmac_f32_16x16x64_bf16 v[36:39], v[8:11], v[48:55], v1
buffer_store_dwordx2 v[32:33], v44, s[4:7], s40 offen
s_waitcnt lgkmcnt(2)
v_smfmac_f32_16x16x64_bf16 v[36:39], v[4:7], v[64:71], v1
s_nop 6
v_cvt_pk_bf16_f32 v36, v36, v37
v_cvt_pk_bf16_f32 v37, v38, v39
s_waitcnt lgkmcnt(0)
v_bfi_b32 v36, 1, s45, v36
v_smfmac_f32_16x16x64_bf16 v[40:43], v[8:11], v[16:23], v1
buffer_store_dwordx2 v[36:37], v44, s[4:7], s41 offen
v_smfmac_f32_16x16x64_bf16 v[40:43], v[4:7], v[56:63], v1
s_nop 6
v_cvt_pk_bf16_f32 v40, v40, v41
v_bfi_b32 v40, 1, s45, v40
v_cvt_pk_bf16_f32 v41, v42, v43
buffer_store_dwordx2 v[40:41], v44, s[4:7], s42 offen
s_barrier
buffer_load_dwordx4 v[24:27], v0, s[4:7], s43 offen offset:0 sc1
buffer_load_dwordx4 v[28:31], v0, s[4:7], s43 offen offset:1024 sc1
buffer_load_dwordx4 v[32:35], v0, s[4:7], s43 offen offset:2048 sc1
buffer_load_dwordx4 v[36:39], v0, s[4:7], s43 offen offset:3072 sc1
v_lshlrev_b32 v23, v0, s58
v_cndmask_b32 v16, 0, v23, s[12:13]
v_cndmask_b32 v17, 0, v23, s[14:15]
v_cndmask_b32 v18, 0, v23, s[16:17]
v_cndmask_b32 v19, 0, v23, s[18:19]
v_and_b32 v45, 0x30, v0
v_lshrrev_b32 v46, 8, v0
v_lshl_or_b32 v45, v46, 2, v45
v_bfe_u32 v46, v0, 6, 1
v_lshl_or_b32 v45, v46, 7, v45
v_cndmask_b32 v45, v45, 2.0, s[98:99]
v_cndmask_b32 v20, 0, v23, s[90:91]
v_cndmask_b32 v21, 0, v23, s[92:93]
v_cndmask_b32 v22, 0, v23, s[94:95]
v_cndmask_b32 v23, 0, v23, s[96:97]
s_add_u32 s33, s33, 16384
s_bitset0_b32 s33, 16
s_waitcnt vmcnt(3)
v_mfma_f32_16x16x32_bf16 v[40:43], v[24:27], v[16:19], 0
s_waitcnt vmcnt(2)
v_mfma_f32_16x16x32_bf16 v[40:43], v[28:31], v[16:19], v[40:43]
v_bitop3_b32 v46, v24, v28, s45 bitop3:0x7e
s_waitcnt vmcnt(1)
v_mfma_f32_16x16x32_bf16 v[40:43], v[32:35], v[16:19], v[40:43]
s_waitcnt vmcnt(0)
v_mfma_f32_16x16x32_bf16 v[40:43], v[36:39], v[16:19], v[40:43]
v_bitop3_b32 v47, v32, v36, s45 bitop3:0x7e
v_bitop3_b32 v46, v46, v47, 1 bitop3:0xa8
v_cmp_ne_u32 vcc, 0, v46
v_mov_b64 v[24:25], 0
v_mov_b64 v[26:27], 0
v_mov_b64 v[28:29], 0
v_mov_b64 v[30:31], 0
v_permlane32_swap_b32 v40, v41
v_permlane32_swap_b32 v42, v43
v_add_f32 v40, v40, v41
v_add_f32 v41, v42, v43
v_cvt_pk_bf16_f32 v42, v40, v41
s_cbranch_vccnz k_r1_150
k_ok1_151:
buffer_store_dword v42, v45, s[4:7], s44 offen
buffer_load_dwordx4 v[48:51], v0, s[4:7], s60 offen offset:0
buffer_load_dwordx4 v[52:55], v0, s[4:7], s60 offen offset:1024
buffer_load_dwordx4 v[56:59], v0, s[4:7], s60 offen offset:2048
buffer_load_dwordx4 v[60:63], v0, s[4:7], s60 offen offset:3072
s_barrier
buffer_load_dwordx4 v[4:7], v0, s[4:7], s33 offen offset:0 sc1
buffer_load_dwordx4 v[8:11], v0, s[4:7], s33 offen offset:1024 sc1
s_add_u32 s34, s33, 2048
s_add_u32 s35, s33, 6144
s_add_u32 s36, s36, 524288
s_add_u32 s37, s37, 10240
s_add_u32 s59, s59, 10240
v_mov_b64 v[32:33], 0
v_mov_b64 v[34:35], 0
v_mov_b64 v[36:37], 0
v_mov_b64 v[38:39], 0
v_mov_b64 v[40:41], 0
v_mov_b64 v[42:43], 0
v_mov_b64 v[44:45], 0
v_mov_b64 v[46:47], 0
s_add_u32 s44, s44, 16384
s_bitset0_b32 s44, 16
s_sub_u32 s45, s45, 1
s_add_u32 s31, s31, 1
ds_read_b128 v[64:67], v0 offset:8192
ds_read_b128 v[68:71], v0 offset:9216
buffer_load_dwordx4 v[12:15], v0, s[4:7], s34 offen offset:0 sc1
s_cmp_lg_u32 s31, s47
s_cbranch_scc1 k_T0_139
s_branch k_done_149
k_cold2_141:
s_barrier
buffer_load_dwordx4 v[48:51], v0, s[4:7], s60 offen offset:0
buffer_load_dwordx4 v[52:55], v0, s[4:7], s60 offen offset:1024
buffer_load_dwordx4 v[56:59], v0, s[4:7], s60 offen offset:2048
buffer_load_dwordx4 v[60:63], v0, s[4:7], s60 offen offset:3072
ds_read_b128 v[64:67], v0 offset:8192
ds_read_b128 v[68:71], v0 offset:9216
k_cold_140:
buffer_load_dwordx4 v[4:7], v0, s[4:7], s33 offen offset:0 sc1
buffer_load_dwordx4 v[8:11], v0, s[4:7], s33 offen offset:1024 sc1
buffer_load_dwordx4 v[12:15], v0, s[4:7], s34 offen offset:0 sc1
s_sub_u32 s32, s32, 1
s_cmp_gt_i32 s32, 0
s_cbranch_scc0 k_okC_142
v_mov_b64 v[24:25], 0
v_mov_b64 v[26:27], 0
v_mov_b64 v[28:29], 0
v_mov_b64 v[30:31], 0
v_mov_b64 v[32:33], 0
v_mov_b64 v[34:35], 0
v_mov_b64 v[36:37], 0
v_mov_b64 v[38:39], 0
v_mov_b64 v[40:41], 0
v_mov_b64 v[42:43], 0
v_mov_b64 v[44:45], 0
v_mov_b64 v[46:47], 0
s_branch k_T0_139
k_coldA_143:
buffer_load_dwordx4 v[12:15], v0, s[4:7], s34 offen offset:0 sc1
s_sub_u32 s32, s32, 1
s_cmp_gt_i32 s32, 0
s_waitcnt vmcnt(0)
v_cmp_u_f32 vcc, v12, v12
ds_write_b128 v0, v[12:15] offset:0
s_waitcnt lgkmcnt(0)
s_cbranch_vccz k_okA_144
s_cbranch_scc1 k_coldA_143
s_branch k_okA_144
k_coldB_145:
buffer_load_dwordx4 v[16:19], v0, s[4:7], s35 offen offset:0 sc1
s_sub_u32 s32, s32, 1
s_cmp_gt_i32 s32, 0
s_waitcnt vmcnt(0)
v_cmp_u_f32 vcc, v16, v16
ds_write_b128 v0, v[16:19] offset:4096
s_waitcnt lgkmcnt(0)
s_cbranch_vccz k_okB_146
s_cbranch_scc1 k_coldB_145
s_branch k_okB_146
k_r1_150:
buffer_load_dwordx4 v[24:27], v0, s[4:7], s43 offen offset:0 sc1
buffer_load_dwordx4 v[28:31], v0, s[4:7], s43 offen offset:1024 sc1
buffer_load_dwordx4 v[32:35], v0, s[4:7], s43 offen offset:2048 sc1
buffer_load_dwordx4 v[36:39], v0, s[4:7], s43 offen offset:3072 sc1
s_sub_u32 s32, s32, 1
s_cmp_gt_i32 s32, 0
s_waitcnt vmcnt(3)
v_mfma_f32_16x16x32_bf16 v[40:43], v[24:27], v[16:19], 0
s_waitcnt vmcnt(2)
v_mfma_f32_16x16x32_bf16 v[40:43], v[28:31], v[16:19], v[40:43]
v_bitop3_b32 v46, v24, v28, s45 bitop3:0x7e
s_waitcnt vmcnt(1)
v_mfma_f32_16x16x32_bf16 v[40:43], v[32:35], v[16:19], v[40:43]
s_waitcnt vmcnt(0)
v_mfma_f32_16x16x32_bf16 v[40:43], v[36:39], v[16:19], v[40:43]
v_bitop3_b32 v47, v32, v36, s45 bitop3:0x7e
v_bitop3_b32 v46, v46, v47, 1 bitop3:0xa8
v_cmp_ne_u32 vcc, 0, v46
v_mov_b64 v[24:25], 0
v_mov_b64 v[26:27], 0
v_mov_b64 v[28:29], 0
v_mov_b64 v[30:31], 0
v_permlane32_swap_b32 v40, v41
v_permlane32_swap_b32 v42, v43
v_add_f32 v40, v40, v41
v_add_f32 v41, v42, v43
v_cvt_pk_bf16_f32 v42, v40, v41
s_cbranch_vccz k_ok1_151
s_cbranch_scc1 k_r1_150
s_branch k_ok1_151
k_slow_147:
ds_read_b128 v[24:27], v0 offset:0
ds_read_b128 v[28:31], v0 offset:1024
v_mov_b32 v46, 0xff7fffff
s_add_u32 s48, s36, 0x0
buffer_load_dwordx4 v[32:35], v0, s[4:7], s48 offen offset:0 sc1
buffer_load_dwordx4 v[36:39], v0, s[4:7], s48 offen offset:1024 sc1
s_waitcnt vmcnt(1) lgkmcnt(1)
v_mfma_f32_16x16x32_bf16 v[4:7], v[32:35], v[24:27], 0
s_waitcnt vmcnt(0) lgkmcnt(0)
v_mfma_f32_16x16x32_bf16 v[4:7], v[36:39], v[28:31], v[4:7]
v_mov_b64 v[8:9], s[56:57]
s_nop 5
v_permlane32_swap_b32 v4, v6
v_permlane32_swap_b32 v5, v7
v_add_f32_dpp v8, v6, v4 row_ror:8 row_mask:0xf bank_mask:0x3
s_nop 0
v_add_f32_dpp v9, v7, v5 row_ror:8 row_mask:0xf bank_mask:0x3
v_max3_f32 v46, v46, v8, v9
s_add_u32 s48, s36, 0x1000
buffer_load_dwordx4 v[32:35], v0, s[4:7], s48 offen offset:0 sc1
buffer_load_dwordx4 v[36:39], v0, s[4:7], s48 offen offset:1024 sc1
s_waitcnt vmcnt(1)
v_mfma_f32_16x16x32_bf16 v[4:7], v[32:35], v[24:27], 0
s_waitcnt vmcnt(0)
v_mfma_f32_16x16x32_bf16 v[4:7], v[36:39], v[28:31], v[4:7]
v_mov_b64 v[10:11], s[56:57]
s_nop 5
v_permlane32_swap_b32 v4, v6
v_permlane32_swap_b32 v5, v7
v_add_f32_dpp v10, v6, v4 row_ror:8 row_mask:0xf bank_mask:0x3
s_nop 0
v_add_f32_dpp v11, v7, v5 row_ror:8 row_mask:0xf bank_mask:0x3
v_max3_f32 v46, v46, v10, v11
s_add_u32 s48, s36, 0x2000
buffer_load_dwordx4 v[32:35], v0, s[4:7], s48 offen offset:0 sc1
buffer_load_dwordx4 v[36:39], v0, s[4:7], s48 offen offset:1024 sc1
s_waitcnt vmcnt(1)
v_mfma_f32_16x16x32_bf16 v[4:7], v[32:35], v[24:27], 0
s_waitcnt vmcnt(0)
v_mfma_f32_16x16x32_bf16 v[4:7], v[36:39], v[28:31], v[4:7]
v_mov_b64 v[12:13], s[56:57]
s_nop 5
v_permlane32_swap_b32 v4, v6
v_permlane32_swap_b32 v5, v7
v_add_f32_dpp v12, v6, v4 row_ror:8 row_mask:0xf bank_mask:0x3
s_nop 0
v_add_f32_dpp v13, v7, v5 row_ror:8 row_mask:0xf bank_mask:0x3
v_max3_f32 v46, v46, v12, v13
s_add_u32 s48, s36, 0x3000
buffer_load_dwordx4 v[32:35], v0, s[4:7], s48 offen offset:0 sc1
buffer_load_dwordx4 v[36:39], v0, s[4:7], s48 offen offset:1024 sc1
s_waitcnt vmcnt(1)
v_mfma_f32_16x16x32_bf16 v[4:7], v[32:35], v[24:27], 0
s_waitcnt vmcnt(0)
v_mfma_f32_16x16x32_bf16 v[4:7], v[36:39], v[28:31], v[4:7]
v_mov_b64 v[14:15], s[56:57]
s_nop 5
v_permlane32_swap_b32 v4, v6
v_permlane32_swap_b32 v5, v7
v_add_f32_dpp v14, v6, v4 row_ror:8 row_mask:0xf bank_mask:0x3
s_nop 0
v_add_f32_dpp v15, v7, v5 row_ror:8 row_mask:0xf bank_mask:0x3
v_max3_f32 v46, v46, v14, v15
ds_read_b128 v[32:35], v0 offset:2048
ds_read_b128 v[36:39], v0 offset:3072
s_waitcnt lgkmcnt(1)
v_mfma_f32_16x16x32_bf16 v[4:7], v[32:35], v[24:27], 0
s_waitcnt lgkmcnt(0)
v_mfma_f32_16x16x32_bf16 v[4:7], v[36:39], v[28:31], v[4:7]
v_mov_b64 v[44:45], s[56:57]
s_nop 5
v_permlane32_swap_b32 v4, v6
v_permlane32_swap_b32 v5, v7
v_add_f32_dpp v44, v6, v4 row_ror:8 row_mask:0xf bank_mask:0x3
s_nop 0
v_add_f32_dpp v45, v7, v5 row_ror:8 row_mask:0xf bank_mask:0x3
v_max3_f32 v46, v46, v44, v45
buffer_load_dwordx4 v[32:35], v0, s[4:7], s36 offen offset:2048 sc1
buffer_load_dwordx4 v[36:39], v0, s[4:7], s36 offen offset:3072 sc1
v_mov_b32 v47, v46
s_nop 1
v_permlane32_swap_b32 v46, v47
v_max_f32 v46, v46, v47
v_mov_b32 v47, v46
s_nop 1
v_permlane16_swap_b32 v46, v47
v_max_f32 v46, v46, v47
v_sub_f32 v8, v8, v46
v_exp_f32 v8, v8
v_sub_f32 v9, v9, v46
v_exp_f32 v9, v9
v_sub_f32 v10, v10, v46
v_exp_f32 v10, v10
v_sub_f32 v11, v11, v46
v_exp_f32 v11, v11
v_sub_f32 v12, v12, v46
v_exp_f32 v12, v12
v_sub_f32 v13, v13, v46
v_exp_f32 v13, v13
v_sub_f32 v14, v14, v46
v_exp_f32 v14, v14
v_sub_f32 v15, v15, v46
v_exp_f32 v15, v15
v_sub_f32 v44, v44, v46
v_exp_f32 v44, v44
v_sub_f32 v45, v45, v46
v_exp_f32 v45, v45
v_cvt_pk_bf16_f32 v4, v8, v9
v_cvt_pk_bf16_f32 v5, v10, v11
v_cvt_pk_bf16_f32 v6, v12, v13
v_cvt_pk_bf16_f32 v7, v14, v15
v_mov_b32_dpp v8, v4 row_ror:8 row_mask:0xf bank_mask:0xf
v_mov_b32_dpp v9, v5 row_ror:8 row_mask:0xf bank_mask:0xf
v_mov_b32_dpp v10, v6 row_ror:8 row_mask:0xf bank_mask:0xf
v_mov_b32_dpp v11, v7 row_ror:8 row_mask:0xf bank_mask:0xf
v_cvt_pk_bf16_f32 v24, v44, v45
v_cvt_pk_bf16_f32 v25, v44, v45
s_nop 0
v_mov_b32_dpp v26, v24 row_ror:8 row_mask:0xf bank_mask:0xf
v_mov_b32_dpp v27, v24 row_ror:8 row_mask:0xf bank_mask:0xf
v_mov_b64 v[28:29], s[52:53]
v_mov_b64 v[30:31], s[52:53]
s_nop 1
v_mfma_f32_16x16x32_bf16 v[44:47], v[28:31], v[4:7], 0
s_waitcnt vmcnt(1)
v_mfma_f32_16x16x32_bf16 v[12:15], v[32:35], v[4:7], 0
s_waitcnt vmcnt(0)
v_mfma_f32_16x16x32_bf16 v[12:15], v[36:39], v[8:11], v[12:15]
v_mfma_f32_16x16x32_bf16 v[12:15], v[40:43], v[24:27], v[12:15]
v_mov_b64 v[28:29], s[54:55]
s_nop 1
v_mfma_f32_16x16x16_bf16 v[44:47], v[28:29], v[24:25], v[44:47]
s_nop 6
v_rcp_f32 v4, v44
s_nop 1
v_rcp_f32_dpp v4, v44 row_ror:8 row_mask:0xf bank_mask:0xc
s_nop 0
v_mul_f32 v12, v4, v12
v_mul_f32 v13, v4, v13
v_mul_f32 v14, v4, v14
v_mul_f32 v15, v4, v15
v_cvt_pk_bf16_f32 v44, v12, v13
v_cvt_pk_bf16_f32 v45, v14, v15
v_and_b32 v12, 0xffffff7f, v0
v_and_or_b32 v8, v1, 8, v12
ds_write_b64 v8, v[44:45] offset:6144
v_mov_b32_dpp v46, v44 row_ror:8 row_mask:0xf bank_mask:0xf
v_mov_b32_dpp v47, v45 row_ror:8 row_mask:0xf bank_mask:0xf
v_mov_b64 v[24:25], 0
v_mov_b64 v[26:27], 0
v_mov_b64 v[28:29], 0
v_mov_b64 v[30:31], 0
v_mov_b64 v[32:33], 0
v_mov_b64 v[34:35], 0
v_mov_b64 v[36:37], 0
v_mov_b64 v[38:39], 0
s_waitcnt lgkmcnt(0)
s_branch k_okS_148
k_done_149:
buffer_load_dwordx4 v[16:19], v0, s[4:7], s35 offen offset:0 sc1
k_xs_155:
s_waitcnt vmcnt(1)
v_cmp_u_f32 vcc, v4, v12
s_waitcnt vmcnt(0)
v_cmp_u_f32 s[66:67], v16, v16
s_or_b64 vcc, vcc, s[66:67]
s_cbranch_vccz k_xd_156
buffer_load_dwordx4 v[4:7], v0, s[4:7], s33 offen offset:0 sc1
buffer_load_dwordx4 v[8:11], v0, s[4:7], s33 offen offset:1024 sc1
buffer_load_dwordx4 v[12:15], v0, s[4:7], s34 offen offset:0 sc1
buffer_load_dwordx4 v[16:19], v0, s[4:7], s35 offen offset:0 sc1
s_sub_u32 s32, s32, 1
s_cmp_gt_i32 s32, 0
s_cbranch_scc1 k_xs_155
k_xd_156:
s_waitcnt vmcnt(3)
buffer_store_dwordx4 v[4:7], v0, s[8:11], s37 offen offset:0 sc1
s_waitcnt vmcnt(2)
buffer_store_dwordx4 v[12:15], v0, s[8:11], s37 offen offset:2048 sc1
s_waitcnt vmcnt(2)
buffer_store_dwordx4 v[16:19], v0, s[8:11], s59 offen offset:2048 sc1
s_add_u32 s31, s31, 1
s_branch k_jn_138
k_far_137:
s_branch k_cold2_159
k_T0_157:
s_waitcnt vmcnt(2)
v_smfmac_f32_16x16x64_bf16 v[40:43], v[4:7], v[48:55], v1
s_waitcnt vmcnt(1)
v_cmp_u_f32 vcc, v4, v8
v_smfmac_f32_16x16x64_bf16 v[24:27], v[8:11], a[24:31], v1
v_smfmac_f32_16x16x64_bf16 v[28:31], v[8:11], a[32:39], v1
s_cbranch_vccnz k_cold_158
k_okC_160:
s_waitcnt vmcnt(1)
v_smfmac_f32_16x16x64_bf16 v[36:39], v[8:11], a[40:47], v1
s_waitcnt lgkmcnt(0)
ds_read_b128 v[48:51], v2 offset:45056
v_smfmac_f32_16x16x64_bf16 v[32:35], v[4:7], v[64:71], v1
ds_read_b128 v[52:55], v2 offset:46080
ds_read_b128 v[64:67], v0 offset:10240
v_smfmac_f32_16x16x64_bf16 v[44:47], v[4:7], v[56:63], v1
ds_read_b128 v[68:71], v0 offset:11264
v_smfmac_f32_16x16x64_bf16 v[28:31], v[4:7], a[8:15], v1
v_smfmac_f32_16x16x64_bf16 v[24:27], v[4:7], a[0:7], v1
ds_read_b128 v[56:59], v2 offset:22528
v_smfmac_f32_16x16x64_bf16 v[36:39], v[4:7], a[16:23], v1
ds_read_b128 v[60:63], v2 offset:23552
s_waitcnt lgkmcnt(4)
v_smfmac_f32_16x16x64_bf16 v[40:43], v[8:11], v[48:55], v1
s_waitcnt vmcnt(0)
ds_write_b128 v0, v[12:15] offset:0
s_waitcnt lgkmcnt(3)
v_smfmac_f32_16x16x64_bf16 v[32:35], v[8:11], v[64:71], v1
buffer_load_dwordx4 v[16:19], v0, s[4:7], s35 offen offset:0 sc1
v_cmp_u_f32 vcc, v12, v12
s_waitcnt lgkmcnt(1)
v_smfmac_f32_16x16x64_bf16 v[44:47], v[8:11], v[56:63], v1
ds_read_b128 v[56:59], v0 offset:20480
ds_read_b128 v[60:63], v0 offset:21504
ds_read_b128 v[64:67], v0 offset:12288
s_cbranch_vccnz k_coldA_161
k_okA_162:
v_smfmac_f32_16x16x64_bf16 v[36:39], v[12:15], a[64:71], v1
ds_read_b128 v[68:71], v0 offset:13312
s_waitcnt lgkmcnt(4)
v_smfmac_f32_16x16x64_bf16 v[40:43], v[12:15], a[72:79], v1
s_barrier
v_smfmac_f32_16x16x64_bf16 v[28:31], v[12:15], a[56:63], v1
ds_read_b128 v[8:11], v0 offset:1024
buffer_load_dwordx4 v[48:51], v0, s[4:7], s36 offen offset:0 sc1
s_waitcnt lgkmcnt(3)
v_smfmac_f32_16x16x64_bf16 v[44:47], v[12:15], v[56:63], v1
ds_read_b128 v[56:59], v2 offset:40960
v_smfmac_f32_16x16x64_bf16 v[24:27], v[12:15], a[48:55], v1
ds_read_b128 v[60:63], v2 offset:41984
s_waitcnt lgkmcnt(3)
v_smfmac_f32_16x16x64_bf16 v[32:35], v[12:15], v[64:71], v1
buffer_load_dwordx4 v[52:55], v0, s[4:7], s36 offen offset:1024 sc1
s_waitcnt lgkmcnt(2)
v_smfmac_f32_16x16x64_bf16 v[24:27], v[8:11], a[80:87], v1
ds_read_b128 v[64:67], v0 offset:14336
ds_read_b128 v[68:71], v0 offset:15360
v_smfmac_f32_16x16x64_bf16 v[36:39], v[8:11], a[96:103], v1
buffer_store_dwordx4 v[4:7], v0, s[8:11], s37 offen offset:0 sc1
s_waitcnt lgkmcnt(2)
s_nop 0
ds_read_b128 v[4:7], v0 offset:2048
v_smfmac_f32_16x16x64_bf16 v[44:47], v[8:11], v[56:63], v1
ds_read_b128 v[56:59], v2 offset:43008
ds_read_b128 v[60:63], v2 offset:44032
v_smfmac_f32_16x16x64_bf16 v[28:31], v[8:11], a[88:95], v1
buffer_store_dwordx4 v[12:15], v0, s[8:11], s37 offen offset:2048 sc1
v_smfmac_f32_16x16x64_bf16 v[40:43], v[8:11], a[104:111], v1
s_waitcnt lgkmcnt(3)
s_waitcnt lgkmcnt(2)
v_smfmac_f32_16x16x64_bf16 v[32:35], v[8:11], v[64:71], v1
ds_read_b128 v[64:67], v0 offset:16384
ds_read_b128 v[12:15], v0 offset:3072
v_smfmac_f32_16x16x64_bf16 v[36:39], v[4:7], a[128:135], v1
s_waitcnt lgkmcnt(2)
v_smfmac_f32_16x16x64_bf16 v[44:47], v[4:7], v[56:63], v1
ds_read_b128 v[68:71], v0 offset:17408
buffer_load_dwordx4 v[56:59], v0, s[4:7], s36 offen offset:2048 sc1
v_smfmac_f32_16x16x64_bf16 v[28:31], v[4:7], a[120:127], v1
v_smfmac_f32_16x16x64_bf16 v[24:27], v[4:7], a[112:119], v1
s_waitcnt vmcnt(5)
ds_write_b128 v0, v[16:19] offset:4096
v_smfmac_f32_16x16x64_bf16 v[40:43], v[4:7], a[136:143], v1
s_waitcnt lgkmcnt(1)
buffer_load_dwordx4 v[60:63], v0, s[4:7], s36 offen offset:3072 sc1
v_cmp_u_f32 vcc, v16, v16
v_smfmac_f32_16x16x64_bf16 v[32:35], v[4:7], v[64:71], v1
ds_read_b128 v[64:67], v0 offset:18432
ds_read_b128 v[68:71], v0 offset:19456
v_smfmac_f32_16x16x64_bf16 v[28:31], v[12:15], a[152:159], v1
v_smfmac_f32_16x16x64_bf16 v[24:27], v[12:15], a[144:151], v1
s_cbranch_vccnz k_coldB_163
k_okB_164:
v_smfmac_f32_16x16x64_bf16 v[36:39], v[12:15], a[160:167], v1
s_waitcnt lgkmcnt(2)
buffer_store_dwordx4 v[16:19], v0, s[8:11], s59 offen offset:2048 sc1
s_barrier
ds_read_b128 v[4:7], v0 offset:6144
v_smfmac_f32_16x16x64_bf16 v[44:47], v[12:15], a[176:183], v1
ds_read_b128 v[8:11], v0 offset:5120
s_waitcnt lgkmcnt(2)
v_smfmac_f32_16x16x64_bf16 v[32:35], v[12:15], v[64:71], v1
ds_read_b128 v[64:67], v2 offset:24576
ds_read_b128 v[68:71], v2 offset:25600
v_smfmac_f32_16x16x64_bf16 v[24:27], v[16:19], a[184:191], v1
v_smfmac_f32_16x16x64_bf16 v[40:43], v[12:15], a[168:175], v1
s_waitcnt lgkmcnt(3)
ds_read_b128 v[12:15], v0 offset:7168
v_smfmac_f32_16x16x64_bf16 v[24:27], v[4:7], a[208:215], v1
s_waitcnt lgkmcnt(3)
v_smfmac_f32_16x16x64_bf16 v[28:31], v[4:7], a[216:223], v1
v_smfmac_f32_16x16x64_bf16 v[28:31], v[8:11], a[200:207], v1
s_waitcnt lgkmcnt(1)
v_smfmac_f32_16x16x64_bf16 v[24:27], v[8:11], v[64:71], v1
ds_read_b128 v[64:67], v2 offset:49152
s_waitcnt lgkmcnt(1)
v_smfmac_f32_16x16x64_bf16 v[24:27], v[12:15], a[224:231], v1
ds_read_b128 v[68:71], v2 offset:50176
v_smfmac_f32_16x16x64_bf16 v[28:31], v[12:15], a[232:239], v1
v_smfmac_f32_16x16x64_bf16 v[28:31], v[16:19], a[192:199], v1
v_cvt_pk_bf16_f32 v24, v24, v25
v_cvt_pk_bf16_f32 v25, v26, v27
v_smfmac_f32_16x16x64_bf16 v[32:35], v[4:7], v[80:87], v1
v_cvt_pk_bf16_f32 v26, v28, v29
v_cvt_pk_bf16_f32 v27, v30, v31
v_smfmac_f32_16x16x64_bf16 v[32:35], v[8:11], a[248:255], v1
s_waitcnt lgkmcnt(0)
v_mfma_f32_16x16x32_bf16 v[28:31], v[24:27], v[20:23], 0
v_and_b32 v26, 0xffffff7f, v0
v_smfmac_f32_16x16x64_bf16 v[32:35], v[16:19], v[64:71], v1
v_and_or_b32 v26, v1, 8, v26
v_mul_f32 v28, s51, v28
v_mul_f32 v29, s51, v29
v_mul_f32 v31, s51, v31
v_cvt_pk_bf16_f32 v24, v28, v29
v_mul_f32 v30, s51, v30
v_cvt_pk_bf16_f32 v25, v30, v31
v_smfmac_f32_16x16x64_bf16 v[32:35], v[12:15], v[96:103], v1
ds_write_b64 v26, v[24:25] offset:0
v_smfmac_f32_16x16x64_bf16 v[36:39], v[8:11], v[72:79], v1
v_cvt_pk_bf16_f32 v32, v32, v33
v_smfmac_f32_16x16x64_bf16 v[36:39], v[16:19], a[240:247], v1
buffer_load_dwordx4 v[64:67], v0, s[4:7], s61 offen offset:0
v_cvt_pk_bf16_f32 v33, v34, v35
v_smfmac_f32_16x16x64_bf16 v[36:39], v[12:15], v[104:111], v1
s_waitcnt lgkmcnt(0)
v_smfmac_f32_16x16x64_bf16 v[36:39], v[4:7], v[88:95], v1
s_barrier
ds_read_b128 v[24:27], v0 offset:0
v_smfmac_f32_16x16x64_bf16 v[40:43], v[4:7], v[144:151], v1
ds_read_b128 v[28:31], v0 offset:1024
s_nop 0
v_cvt_pk_bf16_f32 v34, v36, v37
v_cvt_pk_bf16_f32 v35, v38, v39
s_nop 1
v_mfma_f32_16x16x32_bf16 v[36:39], v[32:35], v[20:23], 0
s_waitcnt vmcnt(6)
buffer_load_dwordx4 v[68:71], v0, s[4:7], s61 offen offset:1024
v_and_b32 v34, 0xffffff7f, v0
v_and_or_b32 v34, v1, 8, v34
s_waitcnt lgkmcnt(1)
v_mfma_f32_16x16x32_bf16 v[48:51], v[48:51], v[24:27], 0
v_cvt_pk_bf16_f32 v32, v36, v37
s_waitcnt lgkmcnt(0)
v_mfma_f32_16x16x32_bf16 v[48:51], v[52:55], v[28:31], v[48:51]
v_mov_b64 v[52:53], s[56:57]
v_cvt_pk_bf16_f32 v33, v38, v39
v_smfmac_f32_16x16x64_bf16 v[44:47], v[4:7], v[152:159], v1
ds_write_b64 v34, v[32:33] offset:2048
v_permlane32_swap_b32 v48, v50
v_permlane32_swap_b32 v49, v51
v_add_f32_dpp v52, v50, v48 row_ror:8 row_mask:0xf bank_mask:0x3
v_exp_f32 v52, v52
v_add_f32_dpp v53, v51, v49 row_ror:8 row_mask:0xf bank_mask:0x3
v_exp_f32 v53, v53
s_nop 0
v_cvt_pk_bf16_f32 v48, v52, v53
v_smfmac_f32_16x16x64_bf16 v[44:47], v[16:19], v[120:127], v1
ds_write_b32 v0, v48 offset:4096
v_smfmac_f32_16x16x64_bf16 v[44:47], v[12:15], v[168:175], v1
buffer_load_dwordx4 v[48:51], v0, s[4:7], s61 offen offset:2048
v_smfmac_f32_16x16x64_bf16 v[40:43], v[12:15], v[160:167], v1
s_waitcnt lgkmcnt(1)
v_xor_b32 v12, 0x80, v0
v_smfmac_f32_16x16x64_bf16 v[40:43], v[8:11], v[128:135], v1
s_waitcnt lgkmcnt(0)
s_barrier
ds_read_b128 v[32:35], v0 offset:2048
v_mov_b64 v[22:23], s[52:53]
v_smfmac_f32_16x16x64_bf16 v[40:43], v[16:19], v[112:119], v1
ds_read_b128 v[36:39], v0 offset:3072
ds_read_b128 v[16:19], v0 offset:4096
buffer_load_dwordx4 v[52:55], v0, s[4:7], s61 offen offset:3072
v_smfmac_f32_16x16x64_bf16 v[44:47], v[8:11], v[136:143], v1
ds_read_b128 v[12:15], v12 offset:4096
v_cvt_pk_bf16_f32 v40, v40, v41
v_mov_b64 v[20:21], s[52:53]
s_waitcnt lgkmcnt(3)
v_mfma_f32_16x16x32_bf16 v[24:27], v[32:35], v[24:27], 0
v_cvt_pk_bf16_f32 v41, v42, v43
s_waitcnt lgkmcnt(2)
v_mfma_f32_16x16x32_bf16 v[24:27], v[36:39], v[28:31], v[24:27]
s_waitcnt vmcnt(5)
s_waitcnt lgkmcnt(1)
v_mfma_f32_16x16x32_bf16 v[8:11], v[56:59], v[16:19], 0
buffer_load_dwordx4 v[56:59], v0, s[4:7], s62 offen offset:0
v_mov_b64 v[28:29], s[56:57]
v_cvt_pk_bf16_f32 v43, v46, v47
v_cvt_pk_bf16_f32 v42, v44, v45
v_permlane32_swap_b32 v25, v27
v_permlane32_swap_b32 v24, v26
v_mfma_f32_16x16x32_bf16 v[4:7], v[20:23], v[16:19], 0
s_waitcnt lgkmcnt(0)
v_add_f32_dpp v28, v26, v24 row_ror:8 row_mask:0xf bank_mask:0x3
v_add_f32_dpp v29, v27, v25 row_ror:8 row_mask:0xf bank_mask:0x3
v_exp_f32 v28, v28
v_mfma_f32_16x16x32_bf16 v[8:11], v[60:63], v[12:15], v[8:11]
buffer_load_dwordx4 v[60:63], v0, s[4:7], s62 offen offset:1024
v_exp_f32 v29, v29
v_permlane32_swap_b32 v42, v43
v_cvt_pk_bf16_f32 v24, v28, v29
v_mov_b64 v[44:45], s[54:55]
v_cvt_pk_bf16_f32 v25, v28, v29
v_mov_b32_dpp v26, v24 row_ror:8 row_mask:0xf bank_mask:0xf
v_mov_b32_dpp v27, v24 row_ror:8 row_mask:0xf bank_mask:0xf
v_mfma_f32_16x16x16_bf16 v[4:7], v[44:45], v[24:25], v[4:7]
v_permlane32_swap_b32 v40, v41
v_mov_b64 v[36:37], 0
v_mov_b64 v[38:39], 0
v_mov_b64 v[30:31], 0
v_mfma_f32_16x16x32_bf16 v[8:11], v[40:43], v[24:27], v[8:11]
buffer_load_dwordx4 v[16:19], v0, s[4:7], s62 offen offset:2048
v_rcp_f32 v6, v4
v_and_b32 v12, 0xffffff7f, v0
v_and_or_b32 v13, v1, 8, v12
v_rcp_f32_dpp v6, v4 row_ror:8 row_mask:0xf bank_mask:0xc
v_mov_b64 v[26:27], 0
v_pk_mul_f32 v[8:9], v[8:9], v[6:7] op_sel_hi:[1,0]
v_cvt_pk_bf16_f32 v44, v8, v9
v_pk_mul_f32 v[10:11], v[10:11], v[6:7] op_sel_hi:[1,0]
v_cvt_pk_bf16_f32 v45, v10, v11
s_waitcnt vmcnt(5)
ds_write_b64 v13, v[44:45] offset:6144
buffer_load_dwordx4 v[20:23], v0, s[4:7], s62 offen offset:3072
v_add_u32 v6, 0xd4800000, v6
v_cmp_lt_u32 vcc, 0x28000000, v6
v_mov_b64 v[34:35], 0
v_mov_b32_dpp v46, v44 row_ror:8 row_mask:0xf bank_mask:0xf
v_mov_b32_dpp v47, v45 row_ror:8 row_mask:0xf bank_mask:0xf
v_mov_b64 v[28:29], 0
v_mov_b64 v[32:33], 0
s_cbranch_vccnz k_slow_165
k_okS_166:
v_smfmac_f32_16x16x64_bf16 v[36:39], v[44:47], v[224:231], v1
s_waitcnt lgkmcnt(0)
s_barrier
ds_read_b128 v[8:11], v12 offset:7168
v_smfmac_f32_16x16x64_bf16 v[32:35], v[44:47], v[200:207], v1
s_waitcnt vmcnt(4)
ds_read_b128 v[4:7], v12 offset:6272
v_mov_b64 v[24:25], 0
v_smfmac_f32_16x16x64_bf16 v[28:31], v[44:47], v[48:55], v1
ds_read_b128 v[12:15], v12 offset:7296
ds_read_b128 v[48:51], v2 offset:16384
v_smfmac_f32_16x16x64_bf16 v[24:27], v[44:47], v[64:71], v1
ds_read_b128 v[52:55], v2 offset:17408
v_mov_b64 v[42:43], 0
s_waitcnt lgkmcnt(4)
v_smfmac_f32_16x16x64_bf16 v[24:27], v[8:11], v[184:191], v1
s_waitcnt lgkmcnt(3)
v_mov_b64 v[40:41], 0
v_smfmac_f32_16x16x64_bf16 v[24:27], v[4:7], v[176:183], v1
s_waitcnt lgkmcnt(2)
ds_read_b128 v[64:67], v2 offset:51200
v_smfmac_f32_16x16x64_bf16 v[24:27], v[12:15], v[192:199], v1
ds_read_b128 v[68:71], v2 offset:52224
v_smfmac_f32_16x16x64_bf16 v[40:43], v[44:47], v[240:247], v1
s_waitcnt vmcnt(2)
s_waitcnt lgkmcnt(2)
v_lshrrev_b32 v44, 16, v1
v_cvt_pk_bf16_f32 v24, v24, v25
v_bfi_b32 v24, 1, s45, v24
v_cvt_pk_bf16_f32 v25, v26, v27
v_smfmac_f32_16x16x64_bf16 v[28:31], v[8:11], v[48:55], v1
buffer_store_dwordx2 v[24:25], v44, s[4:7], s38 offen sc1
ds_read_b128 v[48:51], v2 offset:20480
ds_read_b128 v[52:55], v2 offset:21504
v_smfmac_f32_16x16x64_bf16 v[28:31], v[12:15], v[56:63], v1
s_waitcnt lgkmcnt(2)
ds_read_b128 v[56:59], v2 offset:26624
v_smfmac_f32_16x16x64_bf16 v[28:31], v[4:7], v[64:71], v1
ds_read_b128 v[60:63], v2 offset:27648
v_smfmac_f32_16x16x64_bf16 v[32:35], v[8:11], v[208:215], v1
ds_read_b128 v[64:67], v2 offset:18432
s_nop 0
v_cvt_pk_bf16_f32 v28, v28, v29
v_bfi_b32 v28, 1, s45, v28
v_cvt_pk_bf16_f32 v29, v30, v31
v_smfmac_f32_16x16x64_bf16 v[32:35], v[12:15], v[216:223], v1
buffer_store_dwordx2 v[28:29], v44, s[4:7], s39 offen sc1
v_smfmac_f32_16x16x64_bf16 v[40:43], v[12:15], v[248:255], v1
ds_read_b128 v[68:71], v2 offset:19456
s_waitcnt vmcnt(2)
v_smfmac_f32_16x16x64_bf16 v[32:35], v[4:7], v[16:23], v1
s_waitcnt lgkmcnt(2)
v_smfmac_f32_16x16x64_bf16 v[36:39], v[12:15], v[232:239], v1
ds_read_b128 v[16:19], v2 offset:47104
ds_read_b128 v[20:23], v2 offset:48128
v_cvt_pk_bf16_f32 v32, v32, v33
v_bfi_b32 v32, 1, s45, v32
v_cvt_pk_bf16_f32 v33, v34, v35
v_smfmac_f32_16x16x64_bf16 v[36:39], v[8:11], v[48:55], v1
buffer_store_dwordx2 v[32:33], v44, s[4:7], s40 offen sc1
s_waitcnt lgkmcnt(2)
v_smfmac_f32_16x16x64_bf16 v[36:39], v[4:7], v[64:71], v1
s_nop 6
v_cvt_pk_bf16_f32 v36, v36, v37
v_cvt_pk_bf16_f32 v37, v38, v39
s_waitcnt lgkmcnt(0)
v_bfi_b32 v36, 1, s45, v36
v_smfmac_f32_16x16x64_bf16 v[40:43], v[8:11], v[16:23], v1
buffer_store_dwordx2 v[36:37], v44, s[4:7], s41 offen sc1
v_smfmac_f32_16x16x64_bf16 v[40:43], v[4:7], v[56:63], v1
s_nop 6
v_cvt_pk_bf16_f32 v40, v40, v41
v_bfi_b32 v40, 1, s45, v40
v_cvt_pk_bf16_f32 v41, v42, v43
buffer_store_dwordx2 v[40:41], v44, s[4:7], s42 offen sc1
s_barrier
buffer_load_dwordx4 v[24:27], v0, s[4:7], s43 offen offset:0 sc1
buffer_load_dwordx4 v[28:31], v0, s[4:7], s43 offen offset:1024 sc1
buffer_load_dwordx4 v[32:35], v0, s[4:7], s43 offen offset:2048 sc1
buffer_load_dwordx4 v[36:39], v0, s[4:7], s43 offen offset:3072 sc1
v_lshlrev_b32 v23, v0, s58
v_cndmask_b32 v16, 0, v23, s[12:13]
v_cndmask_b32 v17, 0, v23, s[14:15]
v_cndmask_b32 v18, 0, v23, s[16:17]
v_cndmask_b32 v19, 0, v23, s[18:19]
v_and_b32 v45, 0x30, v0
v_lshrrev_b32 v46, 8, v0
v_lshl_or_b32 v45, v46, 2, v45
v_bfe_u32 v46, v0, 6, 1
v_lshl_or_b32 v45, v46, 7, v45
v_cndmask_b32 v45, v45, 2.0, s[98:99]
v_cndmask_b32 v20, 0, v23, s[90:91]
v_cndmask_b32 v21, 0, v23, s[92:93]
v_cndmask_b32 v22, 0, v23, s[94:95]
v_cndmask_b32 v23, 0, v23, s[96:97]
s_add_u32 s33, s33, 16384
s_bitset0_b32 s33, 16
s_waitcnt vmcnt(3)
v_mfma_f32_16x16x32_bf16 v[40:43], v[24:27], v[16:19], 0
s_waitcnt vmcnt(2)
v_mfma_f32_16x16x32_bf16 v[40:43], v[28:31], v[16:19], v[40:43]
v_bitop3_b32 v46, v24, v28, s45 bitop3:0x7e
s_waitcnt vmcnt(1)
v_mfma_f32_16x16x32_bf16 v[40:43], v[32:35], v[16:19], v[40:43]
s_waitcnt vmcnt(0)
v_mfma_f32_16x16x32_bf16 v[40:43], v[36:39], v[16:19], v[40:43]
v_bitop3_b32 v47, v32, v36, s45 bitop3:0x7e
v_bitop3_b32 v46, v46, v47, 1 bitop3:0xa8
v_cmp_ne_u32 vcc, 0, v46
v_mov_b64 v[24:25], 0
v_mov_b64 v[26:27], 0
v_mov_b64 v[28:29], 0
v_mov_b64 v[30:31], 0
v_permlane32_swap_b32 v40, v41
v_permlane32_swap_b32 v42, v43
v_add_f32 v40, v40, v41
v_add_f32 v41, v42, v43
v_cvt_pk_bf16_f32 v42, v40, v41
s_cbranch_vccnz k_r1_168
k_ok1_169:
buffer_store_dword v42, v45, s[4:7], s44 offen sc1
buffer_load_dwordx4 v[48:51], v0, s[4:7], s60 offen offset:0
buffer_load_dwordx4 v[52:55], v0, s[4:7], s60 offen offset:1024
buffer_load_dwordx4 v[56:59], v0, s[4:7], s60 offen offset:2048
buffer_load_dwordx4 v[60:63], v0, s[4:7], s60 offen offset:3072
s_barrier
buffer_load_dwordx4 v[4:7], v0, s[4:7], s33 offen offset:0 sc1
buffer_load_dwordx4 v[8:11], v0, s[4:7], s33 offen offset:1024 sc1
s_add_u32 s34, s33, 2048
s_add_u32 s35, s33, 6144
s_add_u32 s36, s36, 524288
s_add_u32 s37, s37, 10240
s_add_u32 s59, s59, 10240
v_mov_b64 v[32:33], 0
v_mov_b64 v[34:35], 0
v_mov_b64 v[36:37], 0
v_mov_b64 v[38:39], 0
v_mov_b64 v[40:41], 0
v_mov_b64 v[42:43], 0
v_mov_b64 v[44:45], 0
v_mov_b64 v[46:47], 0
s_add_u32 s44, s44, 16384
s_bitset0_b32 s44, 16
s_sub_u32 s45, s45, 1
s_add_u32 s31, s31, 1
ds_read_b128 v[64:67], v0 offset:8192
ds_read_b128 v[68:71], v0 offset:9216
buffer_load_dwordx4 v[12:15], v0, s[4:7], s34 offen offset:0 sc1
s_cmp_lg_u32 s31, s47
s_cbranch_scc1 k_T0_157
s_branch k_done_167
k_cold2_159:
s_barrier
buffer_load_dwordx4 v[48:51], v0, s[4:7], s60 offen offset:0
buffer_load_dwordx4 v[52:55], v0, s[4:7], s60 offen offset:1024
buffer_load_dwordx4 v[56:59], v0, s[4:7], s60 offen offset:2048
buffer_load_dwordx4 v[60:63], v0, s[4:7], s60 offen offset:3072
ds_read_b128 v[64:67], v0 offset:8192
ds_read_b128 v[68:71], v0 offset:9216
k_cold_158:
buffer_load_dwordx4 v[4:7], v0, s[4:7], s33 offen offset:0 sc1
buffer_load_dwordx4 v[8:11], v0, s[4:7], s33 offen offset:1024 sc1
buffer_load_dwordx4 v[12:15], v0, s[4:7], s34 offen offset:0 sc1
s_sub_u32 s32, s32, 1
s_cmp_gt_i32 s32, 0
s_cbranch_scc0 k_okC_160
v_mov_b64 v[24:25], 0
v_mov_b64 v[26:27], 0
v_mov_b64 v[28:29], 0
v_mov_b64 v[30:31], 0
v_mov_b64 v[32:33], 0
v_mov_b64 v[34:35], 0
v_mov_b64 v[36:37], 0
v_mov_b64 v[38:39], 0
v_mov_b64 v[40:41], 0
v_mov_b64 v[42:43], 0
v_mov_b64 v[44:45], 0
v_mov_b64 v[46:47], 0
s_branch k_T0_157
k_coldA_161:
buffer_load_dwordx4 v[12:15], v0, s[4:7], s34 offen offset:0 sc1
s_sub_u32 s32, s32, 1
s_cmp_gt_i32 s32, 0
s_waitcnt vmcnt(0)
v_cmp_u_f32 vcc, v12, v12
ds_write_b128 v0, v[12:15] offset:0
s_waitcnt lgkmcnt(0)
s_cbranch_vccz k_okA_162
s_cbranch_scc1 k_coldA_161
s_branch k_okA_162
k_coldB_163:
buffer_load_dwordx4 v[16:19], v0, s[4:7], s35 offen offset:0 sc1
s_sub_u32 s32, s32, 1
s_cmp_gt_i32 s32, 0
s_waitcnt vmcnt(0)
v_cmp_u_f32 vcc, v16, v16
ds_write_b128 v0, v[16:19] offset:4096
s_waitcnt lgkmcnt(0)
s_cbranch_vccz k_okB_164
s_cbranch_scc1 k_coldB_163
s_branch k_okB_164
k_r1_168:
buffer_load_dwordx4 v[24:27], v0, s[4:7], s43 offen offset:0 sc1
buffer_load_dwordx4 v[28:31], v0, s[4:7], s43 offen offset:1024 sc1
buffer_load_dwordx4 v[32:35], v0, s[4:7], s43 offen offset:2048 sc1
buffer_load_dwordx4 v[36:39], v0, s[4:7], s43 offen offset:3072 sc1
s_sub_u32 s32, s32, 1
s_cmp_gt_i32 s32, 0
s_waitcnt vmcnt(3)
v_mfma_f32_16x16x32_bf16 v[40:43], v[24:27], v[16:19], 0
s_waitcnt vmcnt(2)
v_mfma_f32_16x16x32_bf16 v[40:43], v[28:31], v[16:19], v[40:43]
v_bitop3_b32 v46, v24, v28, s45 bitop3:0x7e
s_waitcnt vmcnt(1)
v_mfma_f32_16x16x32_bf16 v[40:43], v[32:35], v[16:19], v[40:43]
s_waitcnt vmcnt(0)
v_mfma_f32_16x16x32_bf16 v[40:43], v[36:39], v[16:19], v[40:43]
v_bitop3_b32 v47, v32, v36, s45 bitop3:0x7e
v_bitop3_b32 v46, v46, v47, 1 bitop3:0xa8
v_cmp_ne_u32 vcc, 0, v46
v_mov_b64 v[24:25], 0
v_mov_b64 v[26:27], 0
v_mov_b64 v[28:29], 0
v_mov_b64 v[30:31], 0
v_permlane32_swap_b32 v40, v41
v_permlane32_swap_b32 v42, v43
v_add_f32 v40, v40, v41
v_add_f32 v41, v42, v43
v_cvt_pk_bf16_f32 v42, v40, v41
s_cbranch_vccz k_ok1_169
s_cbranch_scc1 k_r1_168
s_branch k_ok1_169
k_slow_165:
ds_read_b128 v[24:27], v0 offset:0
ds_read_b128 v[28:31], v0 offset:1024
v_mov_b32 v46, 0xff7fffff
s_add_u32 s48, s36, 0x0
buffer_load_dwordx4 v[32:35], v0, s[4:7], s48 offen offset:0 sc1
buffer_load_dwordx4 v[36:39], v0, s[4:7], s48 offen offset:1024 sc1
s_waitcnt vmcnt(1) lgkmcnt(1)
v_mfma_f32_16x16x32_bf16 v[4:7], v[32:35], v[24:27], 0
s_waitcnt vmcnt(0) lgkmcnt(0)
v_mfma_f32_16x16x32_bf16 v[4:7], v[36:39], v[28:31], v[4:7]
v_mov_b64 v[8:9], s[56:57]
s_nop 5
v_permlane32_swap_b32 v4, v6
v_permlane32_swap_b32 v5, v7
v_add_f32_dpp v8, v6, v4 row_ror:8 row_mask:0xf bank_mask:0x3
s_nop 0
v_add_f32_dpp v9, v7, v5 row_ror:8 row_mask:0xf bank_mask:0x3
v_max3_f32 v46, v46, v8, v9
s_add_u32 s48, s36, 0x1000
buffer_load_dwordx4 v[32:35], v0, s[4:7], s48 offen offset:0 sc1
buffer_load_dwordx4 v[36:39], v0, s[4:7], s48 offen offset:1024 sc1
s_waitcnt vmcnt(1)
v_mfma_f32_16x16x32_bf16 v[4:7], v[32:35], v[24:27], 0
s_waitcnt vmcnt(0)
v_mfma_f32_16x16x32_bf16 v[4:7], v[36:39], v[28:31], v[4:7]
v_mov_b64 v[10:11], s[56:57]
s_nop 5
v_permlane32_swap_b32 v4, v6
v_permlane32_swap_b32 v5, v7
v_add_f32_dpp v10, v6, v4 row_ror:8 row_mask:0xf bank_mask:0x3
s_nop 0
v_add_f32_dpp v11, v7, v5 row_ror:8 row_mask:0xf bank_mask:0x3
v_max3_f32 v46, v46, v10, v11
s_add_u32 s48, s36, 0x2000
buffer_load_dwordx4 v[32:35], v0, s[4:7], s48 offen offset:0 sc1
buffer_load_dwordx4 v[36:39], v0, s[4:7], s48 offen offset:1024 sc1
s_waitcnt vmcnt(1)
v_mfma_f32_16x16x32_bf16 v[4:7], v[32:35], v[24:27], 0
s_waitcnt vmcnt(0)
v_mfma_f32_16x16x32_bf16 v[4:7], v[36:39], v[28:31], v[4:7]
v_mov_b64 v[12:13], s[56:57]
s_nop 5
v_permlane32_swap_b32 v4, v6
v_permlane32_swap_b32 v5, v7
v_add_f32_dpp v12, v6, v4 row_ror:8 row_mask:0xf bank_mask:0x3
s_nop 0
v_add_f32_dpp v13, v7, v5 row_ror:8 row_mask:0xf bank_mask:0x3
v_max3_f32 v46, v46, v12, v13
s_add_u32 s48, s36, 0x3000
buffer_load_dwordx4 v[32:35], v0, s[4:7], s48 offen offset:0 sc1
buffer_load_dwordx4 v[36:39], v0, s[4:7], s48 offen offset:1024 sc1
s_waitcnt vmcnt(1)
v_mfma_f32_16x16x32_bf16 v[4:7], v[32:35], v[24:27], 0
s_waitcnt vmcnt(0)
v_mfma_f32_16x16x32_bf16 v[4:7], v[36:39], v[28:31], v[4:7]
v_mov_b64 v[14:15], s[56:57]
s_nop 5
v_permlane32_swap_b32 v4, v6
v_permlane32_swap_b32 v5, v7
v_add_f32_dpp v14, v6, v4 row_ror:8 row_mask:0xf bank_mask:0x3
s_nop 0
v_add_f32_dpp v15, v7, v5 row_ror:8 row_mask:0xf bank_mask:0x3
v_max3_f32 v46, v46, v14, v15
ds_read_b128 v[32:35], v0 offset:2048
ds_read_b128 v[36:39], v0 offset:3072
s_waitcnt lgkmcnt(1)
v_mfma_f32_16x16x32_bf16 v[4:7], v[32:35], v[24:27], 0
s_waitcnt lgkmcnt(0)
v_mfma_f32_16x16x32_bf16 v[4:7], v[36:39], v[28:31], v[4:7]
v_mov_b64 v[44:45], s[56:57]
s_nop 5
v_permlane32_swap_b32 v4, v6
v_permlane32_swap_b32 v5, v7
v_add_f32_dpp v44, v6, v4 row_ror:8 row_mask:0xf bank_mask:0x3
s_nop 0
v_add_f32_dpp v45, v7, v5 row_ror:8 row_mask:0xf bank_mask:0x3
v_max3_f32 v46, v46, v44, v45
buffer_load_dwordx4 v[32:35], v0, s[4:7], s36 offen offset:2048 sc1
buffer_load_dwordx4 v[36:39], v0, s[4:7], s36 offen offset:3072 sc1
v_mov_b32 v47, v46
s_nop 1
v_permlane32_swap_b32 v46, v47
v_max_f32 v46, v46, v47
v_mov_b32 v47, v46
s_nop 1
v_permlane16_swap_b32 v46, v47
v_max_f32 v46, v46, v47
v_sub_f32 v8, v8, v46
v_exp_f32 v8, v8
v_sub_f32 v9, v9, v46
v_exp_f32 v9, v9
v_sub_f32 v10, v10, v46
v_exp_f32 v10, v10
v_sub_f32 v11, v11, v46
v_exp_f32 v11, v11
v_sub_f32 v12, v12, v46
v_exp_f32 v12, v12
v_sub_f32 v13, v13, v46
v_exp_f32 v13, v13
v_sub_f32 v14, v14, v46
v_exp_f32 v14, v14
v_sub_f32 v15, v15, v46
v_exp_f32 v15, v15
v_sub_f32 v44, v44, v46
v_exp_f32 v44, v44
v_sub_f32 v45, v45, v46
v_exp_f32 v45, v45
v_cvt_pk_bf16_f32 v4, v8, v9
v_cvt_pk_bf16_f32 v5, v10, v11
v_cvt_pk_bf16_f32 v6, v12, v13
v_cvt_pk_bf16_f32 v7, v14, v15
v_mov_b32_dpp v8, v4 row_ror:8 row_mask:0xf bank_mask:0xf
v_mov_b32_dpp v9, v5 row_ror:8 row_mask:0xf bank_mask:0xf
v_mov_b32_dpp v10, v6 row_ror:8 row_mask:0xf bank_mask:0xf
v_mov_b32_dpp v11, v7 row_ror:8 row_mask:0xf bank_mask:0xf
v_cvt_pk_bf16_f32 v24, v44, v45
v_cvt_pk_bf16_f32 v25, v44, v45
s_nop 0
v_mov_b32_dpp v26, v24 row_ror:8 row_mask:0xf bank_mask:0xf
v_mov_b32_dpp v27, v24 row_ror:8 row_mask:0xf bank_mask:0xf
v_mov_b64 v[28:29], s[52:53]
v_mov_b64 v[30:31], s[52:53]
s_nop 1
v_mfma_f32_16x16x32_bf16 v[44:47], v[28:31], v[4:7], 0
s_waitcnt vmcnt(1)
v_mfma_f32_16x16x32_bf16 v[12:15], v[32:35], v[4:7], 0
s_waitcnt vmcnt(0)
v_mfma_f32_16x16x32_bf16 v[12:15], v[36:39], v[8:11], v[12:15]
v_mfma_f32_16x16x32_bf16 v[12:15], v[40:43], v[24:27], v[12:15]
v_mov_b64 v[28:29], s[54:55]
s_nop 1
v_mfma_f32_16x16x16_bf16 v[44:47], v[28:29], v[24:25], v[44:47]
s_nop 6
v_rcp_f32 v4, v44
s_nop 1
v_rcp_f32_dpp v4, v44 row_ror:8 row_mask:0xf bank_mask:0xc
s_nop 0
v_mul_f32 v12, v4, v12
v_mul_f32 v13, v4, v13
v_mul_f32 v14, v4, v14
v_mul_f32 v15, v4, v15
v_cvt_pk_bf16_f32 v44, v12, v13
v_cvt_pk_bf16_f32 v45, v14, v15
v_and_b32 v12, 0xffffff7f, v0
v_and_or_b32 v8, v1, 8, v12
ds_write_b64 v8, v[44:45] offset:6144
v_mov_b32_dpp v46, v44 row_ror:8 row_mask:0xf bank_mask:0xf
v_mov_b32_dpp v47, v45 row_ror:8 row_mask:0xf bank_mask:0xf
v_mov_b64 v[24:25], 0
v_mov_b64 v[26:27], 0
v_mov_b64 v[28:29], 0
v_mov_b64 v[30:31], 0
v_mov_b64 v[32:33], 0
v_mov_b64 v[34:35], 0
v_mov_b64 v[36:37], 0
v_mov_b64 v[38:39], 0
s_waitcnt lgkmcnt(0)
s_branch k_okS_166
k_done_167:
buffer_load_dwordx4 v[16:19], v0, s[4:7], s35 offen offset:0 sc1
k_xs_173:
s_waitcnt vmcnt(1)
v_cmp_u_f32 vcc, v4, v12
s_waitcnt vmcnt(0)
v_cmp_u_f32 s[66:67], v16, v16
s_or_b64 vcc, vcc, s[66:67]
s_cbranch_vccz k_xd_174
buffer_load_dwordx4 v[4:7], v0, s[4:7], s33 offen offset:0 sc1
buffer_load_dwordx4 v[8:11], v0, s[4:7], s33 offen offset:1024 sc1
buffer_load_dwordx4 v[12:15], v0, s[4:7], s34 offen offset:0 sc1
buffer_load_dwordx4 v[16:19], v0, s[4:7], s35 offen offset:0 sc1
s_sub_u32 s32, s32, 1
s_cmp_gt_i32 s32, 0
s_cbranch_scc1 k_xs_173
k_xd_174:
s_waitcnt vmcnt(3)
buffer_store_dwordx4 v[4:7], v0, s[8:11], s37 offen offset:0 sc1
s_waitcnt vmcnt(2)
buffer_store_dwordx4 v[12:15], v0, s[8:11], s37 offen offset:2048 sc1
s_waitcnt vmcnt(2)
buffer_store_dwordx4 v[16:19], v0, s[8:11], s59 offen offset:2048 sc1
s_add_u32 s31, s31, 1
k_jn_138:
s_cmp_lt_u32 s31, 128
s_cbranch_scc1 k_lay_129
s_add_u32 s30, s30, 112
s_waitcnt vmcnt(0) lgkmcnt(0)
s_barrier
s_branch k_fin_7
k_w1_126:
v_lshlrev_b32 v0, 4, v0
s_mov_b32 s90, 0x300003
s_mov_b32 s91, 0x300003
s_mov_b32 s92, 0xc0000c
s_mov_b32 s93, 0xc0000c
s_mov_b32 s94, 0x30000300
s_mov_b32 s95, 0x30000300
s_mov_b32 s96, 0xc0000c00
s_mov_b32 s97, 0xc0000c00
s_mov_b32 s98, 0xff00ff00
s_mov_b32 s99, 0xff00ff00
v_mov_b32 v1, 0x4444
v_mov_b32 v4, 0xeeee
v_cndmask_b32 v1, v1, v4, s[98:99]
v_lshrrev_b32 v4, 8, v0
v_lshl_or_b32 v1, v4, 28, v1
v_bfe_u32 v4, v0, 4, 4
v_lshl_or_b32 v1, v4, 19, v1
s_mov_b32 s51, 0x3e0293ee
s_mov_b32 s52, 0x3f803f80
s_mov_b32 s53, 0x3f803f80
s_mov_b32 s54, 0x3f003f00
s_mov_b32 s55, 0x3f003f00
s_mov_b32 s56, 0xff800000
s_mov_b32 s57, 0xff800000
s_mov_b32 s58, 0x3f80
s_mov_b32 s31, 0
s_mov_b32 s45, -2
s_lshl_b32 s46, s30, 6
s_add_u32 s46, s46, 222330880
s_lshl_b32 s48, s30, 7
s_and_b32 s49, s30, 31
s_lshl_b32 s49, s49, 12
s_add_u32 s43, s49, 119603200
v_mov_b64 v[12:13], -1
s_add_u32 s38, s48, 119554048
s_add_u32 s39, s48, 119619584
s_add_u32 s40, s48, 119685120
s_add_u32 s41, s48, 119750656
s_add_u32 s42, s48, 119816192
v_lshrrev_b32 v4, 16, v1
buffer_store_dwordx2 v[12:13], v4, s[4:7], s38 offen sc1
buffer_store_dwordx2 v[12:13], v4, s[4:7], s39 offen sc1
buffer_store_dwordx2 v[12:13], v4, s[4:7], s40 offen sc1
buffer_store_dwordx2 v[12:13], v4, s[4:7], s41 offen sc1
buffer_store_dwordx2 v[12:13], v4, s[4:7], s42 offen sc1
s_add_u32 s47, s31, 63
s_mul_i32 s33, s31, 0
s_add_u32 s33, s33, 120324096
s_add_u32 s34, s33, 3072
s_add_u32 s35, s33, 7168
s_mul_i32 s48, s31, 655360
s_lshl_b32 s36, s30, 14
s_add_u32 s36, s36, s48
s_add_u32 s36, s36, 4096
v_mov_b32 v36, -1
s_and_b32 s48, s30, 31
s_add_u32 s48, s48, 16
s_lshr_b32 s49, s48, 1
s_and_b32 s48, s48, 1
s_lshl_b32 s44, s49, 8
s_lshl_b32 s50, s48, 6
s_add_u32 s44, s44, s50
s_add_u32 s44, s44, s33
s_mul_i32 s48, s48, 5120
s_lshl_b32 s49, s49, 5
s_add_u32 s48, s48, s49
v_lshrrev_b32 v32, 4, v0
v_and_b32 v33, 3, v32
v_mul_u32_u24 v33, 1280, v33
v_bfe_u32 v34, v32, 2, 1
v_lshl_add_u32 v33, v34, 1, v33
v_bfe_u32 v34, v32, 4, 1
v_lshl_add_u32 v33, v34, 4, v33
v_bfe_u32 v34, v32, 5, 1
v_lshl_add_u32 v33, v34, 2, v33
buffer_load_ushort v34, v33, s[24:27], s48 offen
buffer_load_ushort v35, v33, s[24:27], s48 offen offset:8
v_and_b32 v45, 0x30, v0
v_lshrrev_b32 v46, 8, v0
v_lshl_or_b32 v45, v46, 2, v45
v_bfe_u32 v46, v0, 6, 1
v_lshl_or_b32 v45, v46, 7, v45
v_cndmask_b32 v45, v45, 2.0, s[98:99]
s_lshl_b32 s63, s30, 10
s_add_u32 s63, s63, 0x8000
s_add_u32 s63, s63, s33
s_lshl_b32 s37, s31, 14
s_add_u32 s37, s37, 117441536
s_add_u32 s59, s37, 4096
v_lshrrev_b32 v0, 4, v0
v_lshrrev_b32 v12, 3, v0
v_lshlrev_b32 v10, 13, v12
v_bfe_u32 v12, v0, 1, 2
v_lshrrev_b32 v13, 4, v0
v_xor_b32 v12, v12, v13
v_lshl_add_u32 v10, v12, 5, v10
v_and_b32 v14, 1, v0
v_lshl_add_u32 v10, v14, 4, v10
v_mul_u32_u24 v11, 1280, v13
v_bfe_u32 v12, v0, 1, 3
v_and_b32 v13, 1, v13
v_lshlrev_b32 v13, 1, v13
v_xor_b32 v12, v12, v13
v_xor_b32 v12, 0, v12
v_lshl_add_u32 v11, v12, 5, v11
v_lshl_add_u32 v11, v14, 4, v11
v_bfe_u32 v12, v0, 5, 1
v_lshlrev_b32 v12, 4, v12
v_bfe_u32 v13, v0, 4, 1
v_lshl_add_u32 v12, v13, 1, v12
v_bfe_u32 v13, v0, 2, 1
v_lshl_add_u32 v12, v13, 2, v12
v_bfe_u32 v13, v0, 3, 1
v_mul_u32_u24 v15, 4224, v13
v_add_u32 v12, v13, v12
v_bfe_u32 v13, v12, 1, 2
v_xor_b32 v13, 1, v13
v_lshlrev_b32 v13, 5, v13
v_lshl_add_u32 v4, v12, 7, v13
v_and_b32 v14, 3, v0
v_lshl_add_u32 v4, v14, 3, v4
v_add_u32 v5, 0x10000, v4
v_add_u32 v6, 0x20000, v4
v_bfe_u32 v12, v0, 4, 1
v_lshlrev_b32 v13, 4, v12
v_lshlrev_b32 v12, 2, v12
v_bfe_u32 v8, v0, 5, 1
v_lshl_add_u32 v13, v8, 2, v13
v_bfe_u32 v8, v0, 2, 1
v_add_u32 v13, v8, v13
v_lshl_add_u32 v12, v8, 1, v12
v_bfe_u32 v8, v0, 3, 1
v_add_u32 v8, 2, v8
v_xor_b32 v12, v12, v8
v_lshlrev_b32 v12, 5, v12
v_lshl_add_u32 v7, v13, 8, v12
v_lshl_add_u32 v7, v14, 3, v7
v_add_u32 v8, 0x10000, v7
v_add_u32 v9, 0x20000, v7
v_lshlrev_b32 v0, 4, v0
v_add_u32 v2, 98304, v0
s_lshl_b32 s49, s30, 8
s_mul_i32 s50, s30, 163840
s_mul_i32 s60, s30, 131072
s_add_u32 s60, s60, 120619008
s_add_u32 s61, s60, 4096
s_add_u32 s62, s60, 8192
s_mov_b32 m0, 2048
s_add_u32 s48, s49, 131072
buffer_load_dwordx4 v10, s[8:11], s48 offen lds
s_mov_b32 m0, 3072
s_add_u32 s48, s49, 196608
buffer_load_dwordx4 v10, s[8:11], s48 offen lds
s_mov_b32 m0, 10240
s_add_u32 s48, s49, 131200
buffer_load_dwordx4 v10, s[8:11], s48 offen lds
s_mov_b32 m0, 11264
s_add_u32 s48, s49, 196736
buffer_load_dwordx4 v10, s[8:11], s48 offen lds
s_mov_b32 m0, 18432
s_add_u32 s48, s49, 131200
buffer_load_dwordx4 v10, s[12:15], s48 offen lds
s_mov_b32 m0, 19456
s_add_u32 s48, s49, 196736
buffer_load_dwordx4 v10, s[12:15], s48 offen lds
s_mov_b32 m0, 26624
s_add_u32 s48, s49, 131072
buffer_load_dwordx4 v10, s[16:19], s48 offen lds
s_mov_b32 m0, 27648
s_add_u32 s48, s49, 196608
buffer_load_dwordx4 v10, s[16:19], s48 offen lds
s_mov_b32 m0, 34816
s_add_u32 s48, s49, 131200
buffer_load_dwordx4 v10, s[16:19], s48 offen lds
s_mov_b32 m0, 35840
s_add_u32 s48, s49, 196736
buffer_load_dwordx4 v10, s[16:19], s48 offen lds
s_mov_b32 m0, 43008
s_add_u32 s48, s49, 655360
buffer_load_dwordx4 v10, s[8:11], s48 offen lds
s_mov_b32 m0, 44032
s_add_u32 s48, s49, 720896
buffer_load_dwordx4 v10, s[8:11], s48 offen lds
s_mov_b32 m0, 51200
s_add_u32 s48, s49, 655488
buffer_load_dwordx4 v10, s[8:11], s48 offen lds
s_mov_b32 m0, 52224
s_add_u32 s48, s49, 721024
buffer_load_dwordx4 v10, s[8:11], s48 offen lds
s_mov_b32 m0, 59392
s_add_u32 s48, s49, 655488
buffer_load_dwordx4 v10, s[12:15], s48 offen lds
s_mov_b32 m0, 60416
s_add_u32 s48, s49, 721024
buffer_load_dwordx4 v10, s[12:15], s48 offen lds
s_mov_b32 m0, 67584
s_add_u32 s48, s49, 655360
buffer_load_dwordx4 v10, s[16:19], s48 offen lds
s_mov_b32 m0, 68608
s_add_u32 s48, s49, 720896
buffer_load_dwordx4 v10, s[16:19], s48 offen lds
s_mov_b32 m0, 75776
s_add_u32 s48, s49, 655488
buffer_load_dwordx4 v10, s[16:19], s48 offen lds
s_mov_b32 m0, 76800
s_add_u32 s48, s49, 721024
buffer_load_dwordx4 v10, s[16:19], s48 offen lds
s_mov_b32 m0, 83968
s_add_u32 s48, s49, 1179648
buffer_load_dwordx4 v10, s[8:11], s48 offen lds
s_mov_b32 m0, 84992
s_add_u32 s48, s49, 1245184
buffer_load_dwordx4 v10, s[8:11], s48 offen lds
s_mov_b32 m0, 92160
s_add_u32 s48, s49, 1179776
buffer_load_dwordx4 v10, s[8:11], s48 offen lds
s_mov_b32 m0, 93184
s_add_u32 s48, s49, 1245312
buffer_load_dwordx4 v10, s[8:11], s48 offen lds
s_mov_b32 m0, 100352
s_add_u32 s48, s49, 1179776
buffer_load_dwordx4 v10, s[12:15], s48 offen lds
s_mov_b32 m0, 101376
s_add_u32 s48, s49, 1245312
buffer_load_dwordx4 v10, s[12:15], s48 offen lds
s_mov_b32 m0, 108544
s_add_u32 s48, s49, 1179648
buffer_load_dwordx4 v10, s[16:19], s48 offen lds
s_mov_b32 m0, 109568
s_add_u32 s48, s49, 1245184
buffer_load_dwordx4 v10, s[16:19], s48 offen lds
s_mov_b32 m0, 116736
s_add_u32 s48, s49, 1703936
buffer_load_dwordx4 v10, s[8:11], s48 offen lds
s_mov_b32 m0, 117760
s_add_u32 s48, s49, 1769472
buffer_load_dwordx4 v10, s[8:11], s48 offen lds
s_mov_b32 m0, 124928
s_add_u32 s48, s49, 1704064
buffer_load_dwordx4 v10, s[8:11], s48 offen lds
s_mov_b32 m0, 125952
s_add_u32 s48, s49, 1769600
buffer_load_dwordx4 v10, s[8:11], s48 offen lds
s_waitcnt vmcnt(32)
v_lshl_or_b32 v34, v35, 16, v34
buffer_store_dword v34, v45, s[4:7], s44 offen sc1
s_add_u32 s44, s44, 16384
buffer_store_dword v36, v45, s[4:7], s44 offen sc1
s_waitcnt vmcnt(26)
s_barrier
s_mov_b32 m0, 133120
s_add_u32 s48, s49, 1704064
buffer_load_dwordx4 v10, s[12:15], s48 offen lds
s_mov_b32 m0, 134144
s_add_u32 s48, s49, 1769600
buffer_load_dwordx4 v10, s[12:15], s48 offen lds
s_mov_b32 m0, 141312
s_add_u32 s48, s49, 1703936
buffer_load_dwordx4 v10, s[16:19], s48 offen lds
s_mov_b32 m0, 142336
s_add_u32 s48, s49, 1769472
buffer_load_dwordx4 v10, s[16:19], s48 offen lds
s_mov_b32 m0, 149504
s_add_u32 s48, s49, 2228224
buffer_load_dwordx4 v10, s[8:11], s48 offen lds
s_mov_b32 m0, 150528
s_add_u32 s48, s49, 2293760
buffer_load_dwordx4 v10, s[8:11], s48 offen lds
s_mov_b32 m0, 157696
s_add_u32 s48, s49, 2228352
buffer_load_dwordx4 v10, s[8:11], s48 offen lds
s_mov_b32 m0, 158720
s_add_u32 s48, s49, 2293888
buffer_load_dwordx4 v10, s[8:11], s48 offen lds
ds_read_b64_tr_b16 a[24:25], v4 offset:0
ds_read_b64_tr_b16 a[26:27], v4 offset:1024
ds_read_b64_tr_b16 a[28:29], v4 offset:4096
ds_read_b64_tr_b16 a[30:31], v4 offset:5120
ds_read_b64_tr_b16 a[32:33], v4 offset:8192
ds_read_b64_tr_b16 a[34:35], v4 offset:9216
ds_read_b64_tr_b16 a[36:37], v4 offset:12288
ds_read_b64_tr_b16 a[38:39], v4 offset:13312
ds_read_b64_tr_b16 a[40:41], v4 offset:16384
ds_read_b64_tr_b16 a[42:43], v4 offset:17408
ds_read_b64_tr_b16 a[44:45], v4 offset:20480
ds_read_b64_tr_b16 a[46:47], v4 offset:21504
ds_read_b64_tr_b16 a[176:177], v4 offset:24576
ds_read_b64_tr_b16 a[178:179], v4 offset:25600
ds_read_b64_tr_b16 a[180:181], v4 offset:28672
ds_read_b64_tr_b16 a[182:183], v4 offset:29696
s_waitcnt lgkmcnt(0)
s_waitcnt vmcnt(26)
s_barrier
s_mov_b32 m0, 2048
s_add_u32 s48, s49, 2228352
buffer_load_dwordx4 v10, s[12:15], s48 offen lds
s_mov_b32 m0, 3072
s_add_u32 s48, s49, 2293888
buffer_load_dwordx4 v10, s[12:15], s48 offen lds
s_mov_b32 m0, 10240
s_add_u32 s48, s49, 2228224
buffer_load_dwordx4 v10, s[16:19], s48 offen lds
s_mov_b32 m0, 11264
s_add_u32 s48, s49, 2293760
buffer_load_dwordx4 v10, s[16:19], s48 offen lds
s_mov_b32 m0, 18432
s_add_u32 s48, s49, 2752512
buffer_load_dwordx4 v10, s[8:11], s48 offen lds
s_mov_b32 m0, 19456
s_add_u32 s48, s49, 2818048
buffer_load_dwordx4 v10, s[8:11], s48 offen lds
s_mov_b32 m0, 26624
s_add_u32 s48, s49, 2752640
buffer_load_dwordx4 v10, s[8:11], s48 offen lds
s_mov_b32 m0, 27648
s_add_u32 s48, s49, 2818176
buffer_load_dwordx4 v10, s[8:11], s48 offen lds
ds_read_b64_tr_b16 v[224:225], v4 offset:32768
ds_read_b64_tr_b16 v[226:227], v4 offset:33792
ds_read_b64_tr_b16 v[228:229], v4 offset:36864
ds_read_b64_tr_b16 v[230:231], v4 offset:37888
ds_read_b64_tr_b16 a[0:1], v4 offset:40960
ds_read_b64_tr_b16 a[2:3], v4 offset:41984
ds_read_b64_tr_b16 a[4:5], v4 offset:45056
ds_read_b64_tr_b16 a[6:7], v4 offset:46080
ds_read_b64_tr_b16 a[8:9], v4 offset:49152
ds_read_b64_tr_b16 a[10:11], v4 offset:50176
ds_read_b64_tr_b16 a[12:13], v4 offset:53248
ds_read_b64_tr_b16 a[14:15], v4 offset:54272
ds_read_b64_tr_b16 a[16:17], v4 offset:57344
ds_read_b64_tr_b16 a[18:19], v4 offset:58368
ds_read_b64_tr_b16 a[20:21], v4 offset:61440
ds_read_b64_tr_b16 a[22:23], v4 offset:62464
s_waitcnt lgkmcnt(0)
s_waitcnt vmcnt(26)
s_barrier
s_mov_b32 m0, 34816
s_add_u32 s48, s49, 2752640
buffer_load_dwordx4 v10, s[12:15], s48 offen lds
s_mov_b32 m0, 35840
s_add_u32 s48, s49, 2818176
buffer_load_dwordx4 v10, s[12:15], s48 offen lds
s_mov_b32 m0, 43008
s_add_u32 s48, s49, 2752512
buffer_load_dwordx4 v10, s[16:19], s48 offen lds
s_mov_b32 m0, 44032
s_add_u32 s48, s49, 2818048
buffer_load_dwordx4 v10, s[16:19], s48 offen lds
s_mov_b32 m0, 51200
s_add_u32 s48, s49, 3276928
buffer_load_dwordx4 v10, s[8:11], s48 offen lds
s_mov_b32 m0, 52224
s_add_u32 s48, s49, 3342464
buffer_load_dwordx4 v10, s[8:11], s48 offen lds
s_mov_b32 m0, 59392
s_add_u32 s48, s49, 3801088
buffer_load_dwordx4 v10, s[8:11], s48 offen lds
s_mov_b32 m0, 60416
s_add_u32 s48, s49, 3866624
buffer_load_dwordx4 v10, s[8:11], s48 offen lds
ds_read_b64_tr_b16 v[16:17], v5 offset:0
ds_read_b64_tr_b16 v[18:19], v5 offset:1024
ds_read_b64_tr_b16 v[20:21], v5 offset:4096
ds_read_b64_tr_b16 v[22:23], v5 offset:5120
ds_read_b64_tr_b16 v[24:25], v5 offset:8192
ds_read_b64_tr_b16 v[26:27], v5 offset:9216
ds_read_b64_tr_b16 v[28:29], v5 offset:12288
ds_read_b64_tr_b16 v[30:31], v5 offset:13312
ds_read_b64_tr_b16 a[144:145], v5 offset:16384
ds_read_b64_tr_b16 a[146:147], v5 offset:17408
ds_read_b64_tr_b16 a[148:149], v5 offset:20480
ds_read_b64_tr_b16 a[150:151], v5 offset:21504
ds_read_b64_tr_b16 a[152:153], v5 offset:24576
ds_read_b64_tr_b16 a[154:155], v5 offset:25600
ds_read_b64_tr_b16 a[156:157], v5 offset:28672
ds_read_b64_tr_b16 a[158:159], v5 offset:29696
s_waitcnt lgkmcnt(0)
buffer_store_dwordx4 v[16:19], v0, s[4:7], s60 offen offset:0
buffer_store_dwordx4 v[20:23], v0, s[4:7], s60 offen offset:1024
buffer_store_dwordx4 v[24:27], v0, s[4:7], s60 offen offset:2048
buffer_store_dwordx4 v[28:31], v0, s[4:7], s60 offen offset:3072
s_waitcnt vmcnt(30)
s_barrier
s_mov_b32 m0, 67584
s_add_u32 s48, s49, 3801216
buffer_load_dwordx4 v10, s[8:11], s48 offen lds
s_mov_b32 m0, 68608
s_add_u32 s48, s49, 3866752
buffer_load_dwordx4 v10, s[8:11], s48 offen lds
s_mov_b32 m0, 75776
s_add_u32 s48, s49, 4325376
buffer_load_dwordx4 v10, s[8:11], s48 offen lds
s_mov_b32 m0, 76800
s_add_u32 s48, s49, 4390912
buffer_load_dwordx4 v10, s[8:11], s48 offen lds
s_mov_b32 m0, 83968
s_add_u32 s48, s49, 4325504
buffer_load_dwordx4 v10, s[8:11], s48 offen lds
s_mov_b32 m0, 84992
s_add_u32 s48, s49, 4391040
buffer_load_dwordx4 v10, s[8:11], s48 offen lds
s_mov_b32 m0, 92160
s_add_u32 s48, s49, 4849664
buffer_load_dwordx4 v10, s[8:11], s48 offen lds
s_mov_b32 m0, 93184
s_add_u32 s48, s49, 4915200
buffer_load_dwordx4 v10, s[8:11], s48 offen lds
ds_read_b64_tr_b16 a[160:161], v5 offset:32768
ds_read_b64_tr_b16 a[162:163], v5 offset:33792
ds_read_b64_tr_b16 a[164:165], v5 offset:36864
ds_read_b64_tr_b16 a[166:167], v5 offset:37888
ds_read_b64_tr_b16 a[168:169], v5 offset:40960
ds_read_b64_tr_b16 a[170:171], v5 offset:41984
ds_read_b64_tr_b16 a[172:173], v5 offset:45056
ds_read_b64_tr_b16 a[174:175], v5 offset:46080
ds_read_b64_tr_b16 a[48:49], v5 offset:49152
ds_read_b64_tr_b16 a[50:51], v5 offset:50176
ds_read_b64_tr_b16 a[52:53], v5 offset:53248
ds_read_b64_tr_b16 a[54:55], v5 offset:54272
ds_read_b64_tr_b16 a[56:57], v5 offset:57344
ds_read_b64_tr_b16 a[58:59], v5 offset:58368
ds_read_b64_tr_b16 a[60:61], v5 offset:61440
ds_read_b64_tr_b16 a[62:63], v5 offset:62464
s_waitcnt lgkmcnt(0)
s_waitcnt vmcnt(28)
s_barrier
s_mov_b32 m0, 100352
s_add_u32 s48, s49, 4849792
buffer_load_dwordx4 v10, s[8:11], s48 offen lds
s_mov_b32 m0, 101376
s_add_u32 s48, s49, 4915328
buffer_load_dwordx4 v10, s[8:11], s48 offen lds
s_mov_b32 m0, 108544
s_add_u32 s48, s49, 3276800
buffer_load_dwordx4 v10, s[12:15], s48 offen lds
s_mov_b32 m0, 109568
s_add_u32 s48, s49, 3342336
buffer_load_dwordx4 v10, s[12:15], s48 offen lds
s_mov_b32 m0, 116736
s_add_u32 s48, s49, 3276928
buffer_load_dwordx4 v10, s[12:15], s48 offen lds
s_mov_b32 m0, 117760
s_add_u32 s48, s49, 3342464
buffer_load_dwordx4 v10, s[12:15], s48 offen lds
s_mov_b32 m0, 124928
s_add_u32 s48, s49, 3801088
buffer_load_dwordx4 v10, s[12:15], s48 offen lds
s_mov_b32 m0, 125952
s_add_u32 s48, s49, 3866624
buffer_load_dwordx4 v10, s[12:15], s48 offen lds
ds_read_b64_tr_b16 a[64:65], v6 offset:0
ds_read_b64_tr_b16 a[66:67], v6 offset:1024
ds_read_b64_tr_b16 a[68:69], v6 offset:4096
ds_read_b64_tr_b16 a[70:71], v6 offset:5120
ds_read_b64_tr_b16 a[72:73], v6 offset:8192
ds_read_b64_tr_b16 a[74:75], v6 offset:9216
ds_read_b64_tr_b16 a[76:77], v6 offset:12288
ds_read_b64_tr_b16 a[78:79], v6 offset:13312
ds_read_b64_tr_b16 a[80:81], v6 offset:16384
ds_read_b64_tr_b16 a[82:83], v6 offset:17408
ds_read_b64_tr_b16 a[84:85], v6 offset:20480
ds_read_b64_tr_b16 a[86:87], v6 offset:21504
ds_read_b64_tr_b16 a[88:89], v6 offset:24576
ds_read_b64_tr_b16 a[90:91], v6 offset:25600
ds_read_b64_tr_b16 a[92:93], v6 offset:28672
ds_read_b64_tr_b16 a[94:95], v6 offset:29696
s_waitcnt lgkmcnt(0)
s_waitcnt vmcnt(28)
s_barrier
s_mov_b32 m0, 133120
s_add_u32 s48, s49, 3801216
buffer_load_dwordx4 v10, s[12:15], s48 offen lds
s_mov_b32 m0, 134144
s_add_u32 s48, s49, 3866752
buffer_load_dwordx4 v10, s[12:15], s48 offen lds
s_mov_b32 m0, 141312
s_add_u32 s48, s49, 4325376
buffer_load_dwordx4 v10, s[12:15], s48 offen lds
s_mov_b32 m0, 142336
s_add_u32 s48, s49, 4390912
buffer_load_dwordx4 v10, s[12:15], s48 offen lds
s_mov_b32 m0, 149504
s_add_u32 s48, s49, 4325504
buffer_load_dwordx4 v10, s[12:15], s48 offen lds
s_mov_b32 m0, 150528
s_add_u32 s48, s49, 4391040
buffer_load_dwordx4 v10, s[12:15], s48 offen lds
s_mov_b32 m0, 157696
s_add_u32 s48, s49, 4849664
buffer_load_dwordx4 v10, s[12:15], s48 offen lds
s_mov_b32 m0, 158720
s_add_u32 s48, s49, 4915200
buffer_load_dwordx4 v10, s[12:15], s48 offen lds
ds_read_b64_tr_b16 a[96:97], v4 offset:0
ds_read_b64_tr_b16 a[98:99], v4 offset:1024
ds_read_b64_tr_b16 a[100:101], v4 offset:4096
ds_read_b64_tr_b16 a[102:103], v4 offset:5120
ds_read_b64_tr_b16 a[104:105], v4 offset:8192
ds_read_b64_tr_b16 a[106:107], v4 offset:9216
ds_read_b64_tr_b16 a[108:109], v4 offset:12288
ds_read_b64_tr_b16 a[110:111], v4 offset:13312
ds_read_b64_tr_b16 a[112:113], v4 offset:16384
ds_read_b64_tr_b16 a[114:115], v4 offset:17408
ds_read_b64_tr_b16 a[116:117], v4 offset:20480
ds_read_b64_tr_b16 a[118:119], v4 offset:21504
ds_read_b64_tr_b16 a[120:121], v4 offset:24576
ds_read_b64_tr_b16 a[122:123], v4 offset:25600
ds_read_b64_tr_b16 a[124:125], v4 offset:28672
ds_read_b64_tr_b16 a[126:127], v4 offset:29696
s_waitcnt lgkmcnt(0)
s_waitcnt vmcnt(28)
s_barrier
s_mov_b32 m0, 2048
s_add_u32 s48, s49, 4849792
buffer_load_dwordx4 v10, s[12:15], s48 offen lds
s_mov_b32 m0, 3072
s_add_u32 s48, s49, 4915328
buffer_load_dwordx4 v10, s[12:15], s48 offen lds
s_mov_b32 m0, 10240
s_add_u32 s48, s49, 3276800
buffer_load_dwordx4 v10, s[16:19], s48 offen lds
s_mov_b32 m0, 11264
s_add_u32 s48, s49, 3342336
buffer_load_dwordx4 v10, s[16:19], s48 offen lds
s_mov_b32 m0, 18432
s_add_u32 s48, s49, 3276928
buffer_load_dwordx4 v10, s[16:19], s48 offen lds
s_mov_b32 m0, 19456
s_add_u32 s48, s49, 3342464
buffer_load_dwordx4 v10, s[16:19], s48 offen lds
s_mov_b32 m0, 26624
s_add_u32 s48, s49, 3801088
buffer_load_dwordx4 v10, s[16:19], s48 offen lds
s_mov_b32 m0, 27648
s_add_u32 s48, s49, 3866624
buffer_load_dwordx4 v10, s[16:19], s48 offen lds
ds_read_b64_tr_b16 a[128:129], v4 offset:32768
ds_read_b64_tr_b16 a[130:131], v4 offset:33792
ds_read_b64_tr_b16 a[132:133], v4 offset:36864
ds_read_b64_tr_b16 a[134:135], v4 offset:37888
ds_read_b64_tr_b16 a[136:137], v4 offset:40960
ds_read_b64_tr_b16 a[138:139], v4 offset:41984
ds_read_b64_tr_b16 a[140:141], v4 offset:45056
ds_read_b64_tr_b16 a[142:143], v4 offset:46080
ds_read_b64_tr_b16 a[232:233], v4 offset:49152
ds_read_b64_tr_b16 a[234:235], v4 offset:50176
ds_read_b64_tr_b16 a[236:237], v4 offset:53248
ds_read_b64_tr_b16 a[238:239], v4 offset:54272
ds_read_b64_tr_b16 a[184:185], v4 offset:57344
ds_read_b64_tr_b16 a[186:187], v4 offset:58368
ds_read_b64_tr_b16 a[188:189], v4 offset:61440
ds_read_b64_tr_b16 a[190:191], v4 offset:62464
s_waitcnt lgkmcnt(0)
s_waitcnt vmcnt(24)
s_barrier
s_mov_b32 m0, 34816
s_add_u32 s48, s49, 3801216
buffer_load_dwordx4 v10, s[16:19], s48 offen lds
s_mov_b32 m0, 35840
s_add_u32 s48, s49, 3866752
buffer_load_dwordx4 v10, s[16:19], s48 offen lds
s_mov_b32 m0, 43008
s_add_u32 s48, s49, 4325376
buffer_load_dwordx4 v10, s[16:19], s48 offen lds
s_mov_b32 m0, 44032
s_add_u32 s48, s49, 4390912
buffer_load_dwordx4 v10, s[16:19], s48 offen lds
s_mov_b32 m0, 51200
s_add_u32 s48, s49, 4325504
buffer_load_dwordx4 v10, s[16:19], s48 offen lds
s_mov_b32 m0, 52224
s_add_u32 s48, s49, 4391040
buffer_load_dwordx4 v10, s[16:19], s48 offen lds
s_mov_b32 m0, 59392
s_add_u32 s48, s49, 4849664
buffer_load_dwordx4 v10, s[16:19], s48 offen lds
s_mov_b32 m0, 60416
s_add_u32 s48, s49, 4915200
buffer_load_dwordx4 v10, s[16:19], s48 offen lds
ds_read_b64_tr_b16 a[192:193], v5 offset:0
ds_read_b64_tr_b16 a[194:195], v5 offset:1024
ds_read_b64_tr_b16 a[196:197], v5 offset:4096
ds_read_b64_tr_b16 a[198:199], v5 offset:5120
ds_read_b64_tr_b16 v[248:249], v5 offset:8192
ds_read_b64_tr_b16 v[250:251], v5 offset:9216
ds_read_b64_tr_b16 v[252:253], v5 offset:12288
ds_read_b64_tr_b16 v[254:255], v5 offset:13312
ds_read_b64_tr_b16 a[200:201], v5 offset:16384
ds_read_b64_tr_b16 a[202:203], v5 offset:17408
ds_read_b64_tr_b16 a[204:205], v5 offset:20480
ds_read_b64_tr_b16 a[206:207], v5 offset:21504
ds_read_b64_tr_b16 a[208:209], v5 offset:24576
ds_read_b64_tr_b16 a[210:211], v5 offset:25600
ds_read_b64_tr_b16 a[212:213], v5 offset:28672
ds_read_b64_tr_b16 a[214:215], v5 offset:29696
s_waitcnt lgkmcnt(0)
s_waitcnt vmcnt(24)
s_barrier
s_mov_b32 m0, 67584
s_add_u32 s48, s49, 4849792
buffer_load_dwordx4 v10, s[16:19], s48 offen lds
s_mov_b32 m0, 68608
s_add_u32 s48, s49, 4915328
buffer_load_dwordx4 v10, s[16:19], s48 offen lds
s_mov_b32 m0, 75776
s_add_u32 s48, s50, 10240
buffer_load_dwordx4 v11, s[20:23], s48 offen lds
s_mov_b32 m0, 76800
s_add_u32 s48, s50, 15360
buffer_load_dwordx4 v11, s[20:23], s48 offen lds
s_mov_b32 m0, 83968
s_add_u32 s48, s50, 30720
buffer_load_dwordx4 v11, s[20:23], s48 offen lds
s_mov_b32 m0, 84992
s_add_u32 s48, s50, 35840
buffer_load_dwordx4 v11, s[20:23], s48 offen lds
s_mov_b32 m0, 92160
s_add_u32 s48, s50, 51200
buffer_load_dwordx4 v11, s[20:23], s48 offen lds
s_mov_b32 m0, 93184
s_add_u32 s48, s50, 56320
buffer_load_dwordx4 v11, s[20:23], s48 offen lds
ds_read_b64_tr_b16 a[216:217], v5 offset:32768
ds_read_b64_tr_b16 a[218:219], v5 offset:33792
ds_read_b64_tr_b16 a[220:221], v5 offset:36864
ds_read_b64_tr_b16 a[222:223], v5 offset:37888
ds_read_b64_tr_b16 v[96:97], v5 offset:40960
ds_read_b64_tr_b16 v[98:99], v5 offset:41984
ds_read_b64_tr_b16 v[100:101], v5 offset:45056
ds_read_b64_tr_b16 v[102:103], v5 offset:46080
ds_read_b64_tr_b16 v[104:105], v5 offset:49152
ds_read_b64_tr_b16 v[106:107], v5 offset:50176
ds_read_b64_tr_b16 v[108:109], v5 offset:53248
ds_read_b64_tr_b16 v[110:111], v5 offset:54272
ds_read_b64_tr_b16 v[240:241], v5 offset:57344
ds_read_b64_tr_b16 v[242:243], v5 offset:58368
ds_read_b64_tr_b16 v[244:245], v5 offset:61440
ds_read_b64_tr_b16 v[246:247], v5 offset:62464
s_waitcnt lgkmcnt(0)
s_waitcnt vmcnt(24)
s_barrier
s_mov_b32 m0, 100352
s_add_u32 s48, s50, 71680
buffer_load_dwordx4 v11, s[20:23], s48 offen lds
s_mov_b32 m0, 101376
s_add_u32 s48, s50, 76800
buffer_load_dwordx4 v11, s[20:23], s48 offen lds
s_mov_b32 m0, 108544
s_add_u32 s48, s50, 10496
buffer_load_dwordx4 v11, s[20:23], s48 offen lds
s_mov_b32 m0, 109568
s_add_u32 s48, s50, 15616
buffer_load_dwordx4 v11, s[20:23], s48 offen lds
s_mov_b32 m0, 116736
s_add_u32 s48, s50, 30976
buffer_load_dwordx4 v11, s[20:23], s48 offen lds
s_mov_b32 m0, 117760
s_add_u32 s48, s50, 36096
buffer_load_dwordx4 v11, s[20:23], s48 offen lds
s_mov_b32 m0, 124928
s_add_u32 s48, s50, 51456
buffer_load_dwordx4 v11, s[20:23], s48 offen lds
s_mov_b32 m0, 125952
s_add_u32 s48, s50, 56576
buffer_load_dwordx4 v11, s[20:23], s48 offen lds
ds_read_b64_tr_b16 a[240:241], v6 offset:0
ds_read_b64_tr_b16 a[242:243], v6 offset:1024
ds_read_b64_tr_b16 a[244:245], v6 offset:4096
ds_read_b64_tr_b16 a[246:247], v6 offset:5120
ds_read_b64_tr_b16 a[248:249], v6 offset:8192
ds_read_b64_tr_b16 a[250:251], v6 offset:9216
ds_read_b64_tr_b16 a[252:253], v6 offset:12288
ds_read_b64_tr_b16 a[254:255], v6 offset:13312
ds_read_b64_tr_b16 v[72:73], v6 offset:16384
ds_read_b64_tr_b16 v[74:75], v6 offset:17408
ds_read_b64_tr_b16 v[76:77], v6 offset:20480
ds_read_b64_tr_b16 v[78:79], v6 offset:21504
ds_read_b64_tr_b16 v[80:81], v6 offset:24576
ds_read_b64_tr_b16 v[82:83], v6 offset:25600
ds_read_b64_tr_b16 v[84:85], v6 offset:28672
ds_read_b64_tr_b16 v[86:87], v6 offset:29696
s_waitcnt lgkmcnt(0)
s_waitcnt vmcnt(24)
s_barrier
s_mov_b32 m0, 133120
s_add_u32 s48, s50, 71936
buffer_load_dwordx4 v11, s[20:23], s48 offen lds
s_mov_b32 m0, 134144
s_add_u32 s48, s50, 77056
buffer_load_dwordx4 v11, s[20:23], s48 offen lds
s_mov_b32 m0, 141312
s_add_u32 s48, s50, 10752
buffer_load_dwordx4 v11, s[20:23], s48 offen lds
s_mov_b32 m0, 142336
s_add_u32 s48, s50, 15872
buffer_load_dwordx4 v11, s[20:23], s48 offen lds
s_mov_b32 m0, 149504
s_add_u32 s48, s50, 31232
buffer_load_dwordx4 v11, s[20:23], s48 offen lds
s_mov_b32 m0, 150528
s_add_u32 s48, s50, 36352
buffer_load_dwordx4 v11, s[20:23], s48 offen lds
s_mov_b32 m0, 157696
s_add_u32 s48, s50, 51712
buffer_load_dwordx4 v11, s[20:23], s48 offen lds
s_mov_b32 m0, 158720
s_add_u32 s48, s50, 56832
buffer_load_dwordx4 v11, s[20:23], s48 offen lds
ds_read_b64_tr_b16 v[88:89], v4 offset:0
ds_read_b64_tr_b16 v[90:91], v4 offset:1024
ds_read_b64_tr_b16 v[92:93], v4 offset:4096
ds_read_b64_tr_b16 v[94:95], v4 offset:5120
ds_read_b64_tr_b16 v[160:161], v4 offset:8192
ds_read_b64_tr_b16 v[162:163], v4 offset:9216
ds_read_b64_tr_b16 v[164:165], v4 offset:12288
ds_read_b64_tr_b16 v[166:167], v4 offset:13312
ds_read_b64_tr_b16 v[168:169], v4 offset:16384
ds_read_b64_tr_b16 v[170:171], v4 offset:17408
ds_read_b64_tr_b16 v[172:173], v4 offset:20480
ds_read_b64_tr_b16 v[174:175], v4 offset:21504
ds_read_b64_tr_b16 v[112:113], v4 offset:24576
ds_read_b64_tr_b16 v[114:115], v4 offset:25600
ds_read_b64_tr_b16 v[116:117], v4 offset:28672
ds_read_b64_tr_b16 v[118:119], v4 offset:29696
s_waitcnt lgkmcnt(0)
s_waitcnt vmcnt(24)
s_barrier
s_mov_b32 m0, 2048
s_add_u32 s48, s50, 72192
buffer_load_dwordx4 v11, s[20:23], s48 offen lds
s_mov_b32 m0, 3072
s_add_u32 s48, s50, 77312
buffer_load_dwordx4 v11, s[20:23], s48 offen lds
s_mov_b32 m0, 10240
s_add_u32 s48, s49, 131072
buffer_load_dwordx4 v10, s[12:15], s48 offen lds
s_mov_b32 m0, 11264
s_add_u32 s48, s49, 196608
buffer_load_dwordx4 v10, s[12:15], s48 offen lds
s_mov_b32 m0, 18432
s_add_u32 s48, s49, 655360
buffer_load_dwordx4 v10, s[12:15], s48 offen lds
s_mov_b32 m0, 19456
s_add_u32 s48, s49, 720896
buffer_load_dwordx4 v10, s[12:15], s48 offen lds
s_mov_b32 m0, 26624
s_add_u32 s48, s49, 1179648
buffer_load_dwordx4 v10, s[12:15], s48 offen lds
s_mov_b32 m0, 27648
s_add_u32 s48, s49, 1245184
buffer_load_dwordx4 v10, s[12:15], s48 offen lds
ds_read_b64_tr_b16 v[120:121], v4 offset:32768
ds_read_b64_tr_b16 v[122:123], v4 offset:33792
ds_read_b64_tr_b16 v[124:125], v4 offset:36864
ds_read_b64_tr_b16 v[126:127], v4 offset:37888
ds_read_b64_tr_b16 v[128:129], v4 offset:40960
ds_read_b64_tr_b16 v[130:131], v4 offset:41984
ds_read_b64_tr_b16 v[132:133], v4 offset:45056
ds_read_b64_tr_b16 v[134:135], v4 offset:46080
ds_read_b64_tr_b16 v[136:137], v4 offset:49152
ds_read_b64_tr_b16 v[138:139], v4 offset:50176
ds_read_b64_tr_b16 v[140:141], v4 offset:53248
ds_read_b64_tr_b16 v[142:143], v4 offset:54272
ds_read_b64_tr_b16 v[144:145], v4 offset:57344
ds_read_b64_tr_b16 v[146:147], v4 offset:58368
ds_read_b64_tr_b16 v[148:149], v4 offset:61440
ds_read_b64_tr_b16 v[150:151], v4 offset:62464
s_waitcnt lgkmcnt(0)
s_waitcnt vmcnt(24)
s_barrier
s_mov_b32 m0, 34816
s_add_u32 s48, s49, 1703936
buffer_load_dwordx4 v10, s[12:15], s48 offen lds
s_mov_b32 m0, 35840
s_add_u32 s48, s49, 1769472
buffer_load_dwordx4 v10, s[12:15], s48 offen lds
s_mov_b32 m0, 43008
s_add_u32 s48, s49, 2228224
buffer_load_dwordx4 v10, s[12:15], s48 offen lds
s_mov_b32 m0, 44032
s_add_u32 s48, s49, 2293760
buffer_load_dwordx4 v10, s[12:15], s48 offen lds
s_mov_b32 m0, 51200
s_add_u32 s48, s49, 2752512
buffer_load_dwordx4 v10, s[12:15], s48 offen lds
s_mov_b32 m0, 52224
s_add_u32 s48, s49, 2818048
buffer_load_dwordx4 v10, s[12:15], s48 offen lds
s_mov_b32 m0, 59392
s_add_u32 s48, s49, 1179776
buffer_load_dwordx4 v10, s[16:19], s48 offen lds
s_mov_b32 m0, 60416
s_add_u32 s48, s49, 1245312
buffer_load_dwordx4 v10, s[16:19], s48 offen lds
ds_read_b64_tr_b16 v[152:153], v5 offset:0
ds_read_b64_tr_b16 v[154:155], v5 offset:1024
ds_read_b64_tr_b16 v[156:157], v5 offset:4096
ds_read_b64_tr_b16 v[158:159], v5 offset:5120
ds_read_b64_tr_b16 v[192:193], v8 offset:8192
ds_read_b64_tr_b16 v[194:195], v8 offset:8704
ds_read_b64_tr_b16 v[196:197], v8 offset:10240
ds_read_b64_tr_b16 v[198:199], v8 offset:10752
v_xor_b32 v12, v15, v8
ds_read_b64_tr_b16 v[32:33], v12 offset:16384
ds_read_b64_tr_b16 v[34:35], v12 offset:16896
ds_read_b64_tr_b16 v[36:37], v12 offset:18432
ds_read_b64_tr_b16 v[38:39], v12 offset:18944
ds_read_b64_tr_b16 v[176:177], v8 offset:24576
ds_read_b64_tr_b16 v[178:179], v8 offset:25088
ds_read_b64_tr_b16 v[180:181], v8 offset:26624
ds_read_b64_tr_b16 v[182:183], v8 offset:27136
s_waitcnt lgkmcnt(0)
buffer_store_dwordx4 v[32:35], v0, s[4:7], s61 offen offset:0
buffer_store_dwordx4 v[36:39], v0, s[4:7], s61 offen offset:1024
s_waitcnt vmcnt(26)
s_barrier
s_mov_b32 m0, 67584
s_add_u32 s48, s49, 1704064
buffer_load_dwordx4 v10, s[16:19], s48 offen lds
s_mov_b32 m0, 68608
s_add_u32 s48, s49, 1769600
buffer_load_dwordx4 v10, s[16:19], s48 offen lds
s_mov_b32 m0, 75776
s_add_u32 s48, s49, 2228352
buffer_load_dwordx4 v10, s[16:19], s48 offen lds
s_mov_b32 m0, 76800
s_add_u32 s48, s49, 2293888
buffer_load_dwordx4 v10, s[16:19], s48 offen lds
s_mov_b32 m0, 83968
s_add_u32 s48, s49, 2752640
buffer_load_dwordx4 v10, s[16:19], s48 offen lds
s_mov_b32 m0, 84992
s_add_u32 s48, s49, 2818176
buffer_load_dwordx4 v10, s[16:19], s48 offen lds
s_mov_b32 m0, 92160
s_add_u32 s48, s50, 11008
buffer_load_dwordx4 v11, s[20:23], s48 offen lds
s_mov_b32 m0, 93184
s_add_u32 s48, s50, 16128
buffer_load_dwordx4 v11, s[20:23], s48 offen lds
ds_read_b64_tr_b16 v[184:185], v8 offset:32768
ds_read_b64_tr_b16 v[186:187], v8 offset:33280
ds_read_b64_tr_b16 v[188:189], v8 offset:34816
ds_read_b64_tr_b16 v[190:191], v8 offset:35328
ds_read_b64_tr_b16 v[24:25], v8 offset:40960
ds_read_b64_tr_b16 v[26:27], v8 offset:41472
ds_read_b64_tr_b16 v[28:29], v8 offset:43008
ds_read_b64_tr_b16 v[30:31], v8 offset:43520
v_xor_b32 v12, v15, v8
ds_read_b64_tr_b16 v[32:33], v12 offset:49152
ds_read_b64_tr_b16 v[34:35], v12 offset:49664
ds_read_b64_tr_b16 v[36:37], v12 offset:51200
ds_read_b64_tr_b16 v[38:39], v12 offset:51712
ds_read_b64_tr_b16 a[224:225], v8 offset:57344
ds_read_b64_tr_b16 a[226:227], v8 offset:57856
ds_read_b64_tr_b16 a[228:229], v8 offset:59392
ds_read_b64_tr_b16 a[230:231], v8 offset:59904
s_waitcnt lgkmcnt(0)
buffer_store_dwordx4 v[24:27], v0, s[4:7], s62 offen offset:0
buffer_store_dwordx4 v[28:31], v0, s[4:7], s62 offen offset:1024
buffer_store_dwordx4 v[32:35], v0, s[4:7], s61 offen offset:2048
buffer_store_dwordx4 v[36:39], v0, s[4:7], s61 offen offset:3072
s_waitcnt vmcnt(30)
s_barrier
s_mov_b32 m0, 100352
s_add_u32 s48, s50, 31488
buffer_load_dwordx4 v11, s[20:23], s48 offen lds
s_mov_b32 m0, 101376
s_add_u32 s48, s50, 36608
buffer_load_dwordx4 v11, s[20:23], s48 offen lds
s_mov_b32 m0, 108544
s_add_u32 s48, s50, 51968
buffer_load_dwordx4 v11, s[20:23], s48 offen lds
s_mov_b32 m0, 109568
s_add_u32 s48, s50, 57088
buffer_load_dwordx4 v11, s[20:23], s48 offen lds
s_mov_b32 m0, 116736
s_add_u32 s48, s50, 72448
buffer_load_dwordx4 v11, s[20:23], s48 offen lds
s_mov_b32 m0, 117760
s_add_u32 s48, s50, 77568
buffer_load_dwordx4 v11, s[20:23], s48 offen lds
s_mov_b32 m0, 124928
s_add_u32 s48, s50, 11264
buffer_load_dwordx4 v11, s[20:23], s48 offen lds
s_mov_b32 m0, 125952
s_add_u32 s48, s50, 16384
buffer_load_dwordx4 v11, s[20:23], s48 offen lds
ds_read_b64_tr_b16 v[232:233], v9 offset:0
ds_read_b64_tr_b16 v[234:235], v9 offset:512
ds_read_b64_tr_b16 v[236:237], v9 offset:2048
ds_read_b64_tr_b16 v[238:239], v9 offset:2560
ds_read_b64_tr_b16 v[216:217], v9 offset:8192
ds_read_b64_tr_b16 v[218:219], v9 offset:8704
ds_read_b64_tr_b16 v[220:221], v9 offset:10240
ds_read_b64_tr_b16 v[222:223], v9 offset:10752
v_xor_b32 v12, v15, v9
ds_read_b64_tr_b16 v[200:201], v12 offset:16384
ds_read_b64_tr_b16 v[202:203], v12 offset:16896
ds_read_b64_tr_b16 v[204:205], v12 offset:18432
ds_read_b64_tr_b16 v[206:207], v12 offset:18944
ds_read_b64_tr_b16 v[40:41], v9 offset:24576
ds_read_b64_tr_b16 v[42:43], v9 offset:25088
ds_read_b64_tr_b16 v[44:45], v9 offset:26624
ds_read_b64_tr_b16 v[46:47], v9 offset:27136
s_waitcnt lgkmcnt(0)
buffer_store_dwordx4 v[40:43], v0, s[4:7], s62 offen offset:2048
buffer_store_dwordx4 v[44:47], v0, s[4:7], s62 offen offset:3072
s_waitcnt vmcnt(38)
s_barrier
s_mov_b32 m0, 133120
s_add_u32 s48, s50, 31744
buffer_load_dwordx4 v11, s[20:23], s48 offen lds
s_mov_b32 m0, 134144
s_add_u32 s48, s50, 36864
buffer_load_dwordx4 v11, s[20:23], s48 offen lds
s_mov_b32 m0, 141312
s_add_u32 s48, s50, 52224
buffer_load_dwordx4 v11, s[20:23], s48 offen lds
s_mov_b32 m0, 142336
s_add_u32 s48, s50, 57344
buffer_load_dwordx4 v11, s[20:23], s48 offen lds
s_mov_b32 m0, 149504
s_add_u32 s48, s50, 72704
buffer_load_dwordx4 v11, s[20:23], s48 offen lds
s_mov_b32 m0, 150528
s_add_u32 s48, s50, 77824
buffer_load_dwordx4 v11, s[20:23], s48 offen lds
s_mov_b32 m0, 157696
s_add_u32 s48, s49, 3276800
buffer_load_dwordx4 v10, s[8:11], s48 offen lds
s_mov_b32 m0, 158720
s_add_u32 s48, s49, 3342336
buffer_load_dwordx4 v10, s[8:11], s48 offen lds
ds_read_b64_tr_b16 v[208:209], v7 offset:0
ds_read_b64_tr_b16 v[210:211], v7 offset:512
ds_read_b64_tr_b16 v[212:213], v7 offset:2048
ds_read_b64_tr_b16 v[214:215], v7 offset:2560
s_waitcnt lgkmcnt(0)
s_waitcnt vmcnt(32)
s_barrier
ds_read_b64_tr_b16 v[16:17], v4 offset:8192
ds_read_b64_tr_b16 v[18:19], v4 offset:9216
ds_read_b64_tr_b16 v[20:21], v4 offset:12288
ds_read_b64_tr_b16 v[22:23], v4 offset:13312
ds_read_b64_tr_b16 v[24:25], v4 offset:16384
ds_read_b64_tr_b16 v[26:27], v4 offset:17408
ds_read_b64_tr_b16 v[28:29], v4 offset:20480
ds_read_b64_tr_b16 v[30:31], v4 offset:21504
ds_read_b64_tr_b16 v[32:33], v4 offset:24576
ds_read_b64_tr_b16 v[34:35], v4 offset:25600
ds_read_b64_tr_b16 v[36:37], v4 offset:28672
ds_read_b64_tr_b16 v[38:39], v4 offset:29696
ds_read_b64_tr_b16 v[40:41], v4 offset:32768
ds_read_b64_tr_b16 v[42:43], v4 offset:33792
ds_read_b64_tr_b16 v[44:45], v4 offset:36864
ds_read_b64_tr_b16 v[46:47], v4 offset:37888
ds_read_b64_tr_b16 v[48:49], v4 offset:40960
ds_read_b64_tr_b16 v[50:51], v4 offset:41984
ds_read_b64_tr_b16 v[52:53], v4 offset:45056
ds_read_b64_tr_b16 v[54:55], v4 offset:46080
ds_read_b64_tr_b16 v[56:57], v4 offset:49152
ds_read_b64_tr_b16 v[58:59], v4 offset:50176
ds_read_b64_tr_b16 v[60:61], v4 offset:53248
ds_read_b64_tr_b16 v[62:63], v4 offset:54272
ds_read_b64_tr_b16 v[64:65], v4 offset:57344
ds_read_b64_tr_b16 v[66:67], v4 offset:58368
ds_read_b64_tr_b16 v[68:69], v4 offset:61440
ds_read_b64_tr_b16 v[70:71], v4 offset:62464
s_waitcnt lgkmcnt(0)
s_barrier
ds_write_b128 v0, v[16:19] offset:22528
ds_write_b128 v0, v[20:23] offset:23552
ds_write_b128 v0, v[24:27] offset:24576
ds_write_b128 v0, v[28:31] offset:25600
ds_write_b128 v0, v[32:35] offset:26624
ds_write_b128 v0, v[36:39] offset:27648
ds_write_b128 v0, v[40:43] offset:28672
ds_write_b128 v0, v[44:47] offset:29696
ds_write_b128 v0, v[48:51] offset:30720
ds_write_b128 v0, v[52:55] offset:31744
ds_write_b128 v0, v[56:59] offset:32768
ds_write_b128 v0, v[60:63] offset:33792
ds_write_b128 v0, a[176:179] offset:34816
ds_write_b128 v0, a[180:183] offset:35840
s_waitcnt lgkmcnt(0)
v_accvgpr_write_b32 a176, v64
v_accvgpr_write_b32 a177, v65
v_accvgpr_write_b32 a178, v66
v_accvgpr_write_b32 a179, v67
v_accvgpr_write_b32 a180, v68
v_accvgpr_write_b32 a181, v69
v_accvgpr_write_b32 a182, v70
v_accvgpr_write_b32 a183, v71
s_waitcnt vmcnt(6)
s_barrier
ds_read_b64_tr_b16 v[16:17], v8 offset:24576
ds_read_b64_tr_b16 v[18:19], v8 offset:25088
ds_read_b64_tr_b16 v[20:21], v8 offset:26624
ds_read_b64_tr_b16 v[22:23], v8 offset:27136
v_xor_b32 v12, v15, v8
ds_read_b64_tr_b16 v[24:25], v12 offset:32768
ds_read_b64_tr_b16 v[26:27], v12 offset:33280
ds_read_b64_tr_b16 v[28:29], v12 offset:34816
ds_read_b64_tr_b16 v[30:31], v12 offset:35328
ds_read_b64_tr_b16 v[32:33], v8 offset:40960
ds_read_b64_tr_b16 v[34:35], v8 offset:41472
ds_read_b64_tr_b16 v[36:37], v8 offset:43008
ds_read_b64_tr_b16 v[38:39], v8 offset:43520
ds_read_b64_tr_b16 v[40:41], v8 offset:49152
ds_read_b64_tr_b16 v[42:43], v8 offset:49664
ds_read_b64_tr_b16 v[44:45], v8 offset:51200
ds_read_b64_tr_b16 v[46:47], v8 offset:51712
ds_read_b64_tr_b16 v[48:49], v8 offset:57344
ds_read_b64_tr_b16 v[50:51], v8 offset:57856
ds_read_b64_tr_b16 v[52:53], v8 offset:59392
ds_read_b64_tr_b16 v[54:55], v8 offset:59904
v_xor_b32 v12, v15, v9
ds_read_b64_tr_b16 v[56:57], v12 offset:0
ds_read_b64_tr_b16 v[58:59], v12 offset:512
ds_read_b64_tr_b16 v[60:61], v12 offset:2048
ds_read_b64_tr_b16 v[62:63], v12 offset:2560
s_waitcnt lgkmcnt(0)
s_barrier
ds_write_b128 v2, v[232:235] offset:28672
ds_write_b128 v2, v[236:239] offset:29696
ds_write_b128 v2, v[224:227] offset:30720
ds_write_b128 v2, v[228:231] offset:31744
ds_write_b128 v2, v[32:35] offset:32768
ds_write_b128 v2, v[36:39] offset:33792
ds_write_b128 v2, v[40:43] offset:34816
ds_write_b128 v2, v[44:47] offset:35840
ds_write_b128 v2, v[248:251] offset:36864
ds_write_b128 v2, v[252:255] offset:37888
ds_write_b128 v2, v[240:243] offset:38912
ds_write_b128 v2, v[244:247] offset:39936
s_waitcnt lgkmcnt(0)
v_mov_b32 v232, v16
v_mov_b32 v233, v17
v_mov_b32 v234, v18
v_mov_b32 v235, v19
v_mov_b32 v236, v20
v_mov_b32 v237, v21
v_mov_b32 v238, v22
v_mov_b32 v239, v23
v_mov_b32 v224, v24
v_mov_b32 v225, v25
v_mov_b32 v226, v26
v_mov_b32 v227, v27
v_mov_b32 v228, v28
v_mov_b32 v229, v29
v_mov_b32 v230, v30
v_mov_b32 v231, v31
v_mov_b32 v248, v48
v_mov_b32 v249, v49
v_mov_b32 v250, v50
v_mov_b32 v251, v51
v_mov_b32 v252, v52
v_mov_b32 v253, v53
v_mov_b32 v254, v54
v_mov_b32 v255, v55
v_mov_b32 v240, v56
v_mov_b32 v241, v57
v_mov_b32 v242, v58
v_mov_b32 v243, v59
v_mov_b32 v244, v60
v_mov_b32 v245, v61
v_mov_b32 v246, v62
v_mov_b32 v247, v63
s_waitcnt vmcnt(0)
s_barrier
ds_read_b64_tr_b16 v[16:17], v5 offset:0
ds_read_b64_tr_b16 v[18:19], v5 offset:1024
ds_read_b64_tr_b16 v[20:21], v5 offset:4096
ds_read_b64_tr_b16 v[22:23], v5 offset:5120
ds_read_b64_tr_b16 v[24:25], v5 offset:8192
ds_read_b64_tr_b16 v[26:27], v5 offset:9216
ds_read_b64_tr_b16 v[28:29], v5 offset:12288
ds_read_b64_tr_b16 v[30:31], v5 offset:13312
ds_read_b64_tr_b16 v[32:33], v5 offset:16384
ds_read_b64_tr_b16 v[34:35], v5 offset:17408
ds_read_b64_tr_b16 v[36:37], v5 offset:20480
ds_read_b64_tr_b16 v[38:39], v5 offset:21504
ds_read_b64_tr_b16 v[40:41], v9 offset:8192
ds_read_b64_tr_b16 v[42:43], v9 offset:8704
ds_read_b64_tr_b16 v[44:45], v9 offset:10240
ds_read_b64_tr_b16 v[46:47], v9 offset:10752
ds_read_b64_tr_b16 v[48:49], v9 offset:16384
ds_read_b64_tr_b16 v[50:51], v9 offset:16896
ds_read_b64_tr_b16 v[52:53], v9 offset:18432
ds_read_b64_tr_b16 v[54:55], v9 offset:18944
ds_read_b64_tr_b16 v[56:57], v6 offset:24576
ds_read_b64_tr_b16 v[58:59], v6 offset:25600
ds_read_b64_tr_b16 v[60:61], v6 offset:28672
ds_read_b64_tr_b16 v[62:63], v6 offset:29696
s_waitcnt lgkmcnt(0)
s_barrier
ds_write_b128 v2, v[16:19] offset:53248
ds_write_b128 v2, v[20:23] offset:54272
ds_write_b128 v2, v[24:27] offset:55296
ds_write_b128 v2, v[28:31] offset:56320
ds_write_b128 v2, v[32:35] offset:57344
ds_write_b128 v2, v[36:39] offset:58368
ds_write_b128 v2, v[40:43] offset:59392
ds_write_b128 v2, v[44:47] offset:60416
ds_write_b128 v2, v[48:51] offset:61440
ds_write_b128 v2, v[52:55] offset:62464
ds_write_b128 v2, a[224:227] offset:63488
ds_write_b128 v2, a[228:231] offset:64512
s_waitcnt lgkmcnt(0)
v_accvgpr_write_b32 a224, v56
v_accvgpr_write_b32 a225, v57
v_accvgpr_write_b32 a226, v58
v_accvgpr_write_b32 a227, v59
v_accvgpr_write_b32 a228, v60
v_accvgpr_write_b32 a229, v61
v_accvgpr_write_b32 a230, v62
v_accvgpr_write_b32 a231, v63
s_mov_b32 s12, 0x3030303
s_mov_b32 s13, 0x3030303
s_mov_b32 s14, 0xc0c0c0c
s_mov_b32 s15, 0xc0c0c0c
s_mov_b32 s16, 0x30303030
s_mov_b32 s17, 0x30303030
s_mov_b32 s18, 0xc0c0c0c0
s_mov_b32 s19, 0xc0c0c0c0
s_mov_b32 s8, s4
s_mov_b32 s9, s5
s_cmp_eq_u32 s30, 29
s_cselect_b32 s10, s6, 0
s_waitcnt vmcnt(0)
s_barrier
v_mov_b32 v8, 160
s_barrier
ds_read_b32 v9, v8
s_waitcnt lgkmcnt(0)
v_readfirstlane_b32 s64, v9
v_lshlrev_b32 v23, v0, s58
v_cndmask_b32 v20, 0, v23, s[90:91]
v_cndmask_b32 v21, 0, v23, s[92:93]
v_cndmask_b32 v22, 0, v23, s[94:95]
v_cndmask_b32 v23, 0, v23, s[96:97]
s_branch k_go_176
k_lay_175:
s_add_u32 s47, s31, 63
s_mul_i32 s33, s31, 0
s_add_u32 s33, s33, 120324096
s_add_u32 s34, s33, 3072
s_add_u32 s35, s33, 7168
s_mul_i32 s48, s31, 655360
s_lshl_b32 s36, s30, 14
s_add_u32 s36, s36, s48
s_add_u32 s36, s36, 4096
v_mov_b32 v36, -1
s_and_b32 s48, s30, 31
s_add_u32 s48, s48, 16
s_lshr_b32 s49, s48, 1
s_and_b32 s48, s48, 1
s_lshl_b32 s44, s49, 8
s_lshl_b32 s50, s48, 6
s_add_u32 s44, s44, s50
s_add_u32 s44, s44, s33
s_mul_i32 s48, s48, 5120
s_lshl_b32 s49, s49, 5
s_add_u32 s48, s48, s49
v_lshrrev_b32 v32, 4, v0
v_and_b32 v33, 3, v32
v_mul_u32_u24 v33, 1280, v33
v_bfe_u32 v34, v32, 2, 1
v_lshl_add_u32 v33, v34, 1, v33
v_bfe_u32 v34, v32, 4, 1
v_lshl_add_u32 v33, v34, 4, v33
v_bfe_u32 v34, v32, 5, 1
v_lshl_add_u32 v33, v34, 2, v33
buffer_load_ushort v34, v33, s[24:27], s48 offen
buffer_load_ushort v35, v33, s[24:27], s48 offen offset:8
v_and_b32 v45, 0x30, v0
v_lshrrev_b32 v46, 8, v0
v_lshl_or_b32 v45, v46, 2, v45
v_bfe_u32 v46, v0, 6, 1
v_lshl_or_b32 v45, v46, 7, v45
v_cndmask_b32 v45, v45, 2.0, s[98:99]
s_lshl_b32 s63, s30, 10
s_add_u32 s63, s63, 0x8000
s_add_u32 s63, s63, s33
s_lshl_b32 s37, s31, 14
s_add_u32 s37, s37, 117441536
s_add_u32 s59, s37, 4096
s_waitcnt vmcnt(0)
s_barrier
v_mov_b32 v8, 160
s_barrier
ds_read_b32 v9, v8
s_waitcnt lgkmcnt(0)
v_readfirstlane_b32 s64, v9
v_lshl_or_b32 v34, v35, 16, v34
buffer_store_dword v34, v45, s[4:7], s44 offen sc1
s_add_u32 s44, s44, 16384
buffer_store_dword v36, v45, s[4:7], s44 offen sc1
s_waitcnt vmcnt(0)
s_barrier
v_mov_b32 v8, 160
s_barrier
ds_read_b32 v9, v8
s_waitcnt lgkmcnt(0)
v_readfirstlane_b32 s64, v9
v_lshlrev_b32 v23, v0, s58
v_cndmask_b32 v20, 0, v23, s[90:91]
v_cndmask_b32 v21, 0, v23, s[92:93]
v_cndmask_b32 v22, 0, v23, s[94:95]
v_cndmask_b32 v23, 0, v23, s[96:97]
k_go_176:
s_cmp_lg_u32 s64, 0
s_cbranch_scc1 k_far_183
s_branch k_cold2_187
k_T0_185:
s_waitcnt vmcnt(2)
v_smfmac_f32_16x16x64_bf16 v[40:43], v[4:7], v[48:55], v1
s_waitcnt vmcnt(1)
v_cmp_u_f32 vcc, v4, v8
v_smfmac_f32_16x16x64_bf16 v[24:27], v[8:11], a[24:31], v1
v_smfmac_f32_16x16x64_bf16 v[28:31], v[8:11], a[32:39], v1
s_cbranch_vccnz k_cold_186
k_okC_188:
s_waitcnt vmcnt(1)
v_smfmac_f32_16x16x64_bf16 v[36:39], v[8:11], a[40:47], v1
s_waitcnt lgkmcnt(0)
ds_read_b128 v[48:51], v0 offset:34816
v_smfmac_f32_16x16x64_bf16 v[32:35], v[4:7], v[64:71], v1
ds_read_b128 v[52:55], v0 offset:35840
ds_read_b128 v[64:67], v0 offset:22528
v_smfmac_f32_16x16x64_bf16 v[44:47], v[4:7], v[56:63], v1
ds_read_b128 v[68:71], v0 offset:23552
v_smfmac_f32_16x16x64_bf16 v[28:31], v[4:7], a[8:15], v1
v_smfmac_f32_16x16x64_bf16 v[24:27], v[4:7], a[0:7], v1
ds_read_b128 v[56:59], v2 offset:30720
v_smfmac_f32_16x16x64_bf16 v[36:39], v[4:7], a[16:23], v1
ds_read_b128 v[60:63], v2 offset:31744
s_waitcnt lgkmcnt(4)
v_smfmac_f32_16x16x64_bf16 v[40:43], v[8:11], v[48:55], v1
s_waitcnt vmcnt(0)
ds_write_b128 v0, v[12:15] offset:1024
s_waitcnt lgkmcnt(3)
v_smfmac_f32_16x16x64_bf16 v[32:35], v[8:11], v[64:71], v1
buffer_load_dwordx4 v[16:19], v0, s[4:7], s35 offen offset:0 sc1
v_cmp_u_f32 vcc, v12, v12
s_waitcnt lgkmcnt(1)
v_smfmac_f32_16x16x64_bf16 v[44:47], v[8:11], v[56:63], v1
ds_read_b128 v[56:59], v2 offset:53248
ds_read_b128 v[60:63], v2 offset:54272
ds_read_b128 v[64:67], v0 offset:28672
s_cbranch_vccnz k_coldA_189
k_okA_190:
v_smfmac_f32_16x16x64_bf16 v[36:39], v[12:15], a[64:71], v1
ds_read_b128 v[68:71], v0 offset:29696
s_waitcnt lgkmcnt(4)
v_smfmac_f32_16x16x64_bf16 v[40:43], v[12:15], a[72:79], v1
s_barrier
v_smfmac_f32_16x16x64_bf16 v[28:31], v[12:15], a[56:63], v1
ds_read_b128 v[8:11], v0 offset:2048
buffer_load_dwordx4 v[48:51], v0, s[4:7], s36 offen offset:0 sc1
s_waitcnt lgkmcnt(3)
v_smfmac_f32_16x16x64_bf16 v[44:47], v[12:15], v[56:63], v1
ds_read_b128 v[56:59], v2 offset:55296
v_smfmac_f32_16x16x64_bf16 v[24:27], v[12:15], a[48:55], v1
ds_read_b128 v[60:63], v2 offset:56320
s_waitcnt lgkmcnt(3)
v_smfmac_f32_16x16x64_bf16 v[32:35], v[12:15], v[64:71], v1
buffer_load_dwordx4 v[52:55], v0, s[4:7], s36 offen offset:1024 sc1
s_waitcnt lgkmcnt(2)
v_smfmac_f32_16x16x64_bf16 v[24:27], v[8:11], a[80:87], v1
ds_read_b128 v[64:67], v0 offset:30720
ds_read_b128 v[68:71], v0 offset:31744
v_smfmac_f32_16x16x64_bf16 v[36:39], v[8:11], a[96:103], v1
buffer_store_dwordx4 v[4:7], v0, s[8:11], s37 offen offset:0 sc1
s_waitcnt lgkmcnt(2)
s_nop 0
ds_read_b128 v[4:7], v0 offset:3072
v_smfmac_f32_16x16x64_bf16 v[44:47], v[8:11], v[56:63], v1
ds_read_b128 v[56:59], v2 offset:57344
ds_read_b128 v[60:63], v2 offset:58368
v_smfmac_f32_16x16x64_bf16 v[28:31], v[8:11], a[88:95], v1
buffer_store_dwordx4 v[12:15], v0, s[8:11], s37 offen offset:2048 sc1
v_smfmac_f32_16x16x64_bf16 v[40:43], v[8:11], a[104:111], v1
s_waitcnt lgkmcnt(3)
s_waitcnt lgkmcnt(2)
v_smfmac_f32_16x16x64_bf16 v[32:35], v[8:11], v[64:71], v1
ds_read_b128 v[64:67], v0 offset:32768
ds_read_b128 v[12:15], v0 offset:0
v_smfmac_f32_16x16x64_bf16 v[36:39], v[4:7], a[128:135], v1
s_waitcnt lgkmcnt(2)
v_smfmac_f32_16x16x64_bf16 v[44:47], v[4:7], v[56:63], v1
ds_read_b128 v[68:71], v0 offset:33792
buffer_load_dwordx4 v[56:59], v0, s[4:7], s36 offen offset:2048 sc1
v_smfmac_f32_16x16x64_bf16 v[28:31], v[4:7], a[120:127], v1
v_smfmac_f32_16x16x64_bf16 v[24:27], v[4:7], a[112:119], v1
s_waitcnt vmcnt(5)
ds_write_b128 v0, v[16:19] offset:5120
v_smfmac_f32_16x16x64_bf16 v[40:43], v[4:7], a[136:143], v1
s_waitcnt lgkmcnt(1)
buffer_load_dwordx4 v[60:63], v0, s[4:7], s36 offen offset:3072 sc1
v_cmp_u_f32 vcc, v16, v16
v_smfmac_f32_16x16x64_bf16 v[32:35], v[4:7], v[64:71], v1
ds_read_b128 v[64:67], v0 offset:26624
ds_read_b128 v[68:71], v0 offset:27648
v_smfmac_f32_16x16x64_bf16 v[28:31], v[12:15], a[152:159], v1
v_smfmac_f32_16x16x64_bf16 v[24:27], v[12:15], a[144:151], v1
s_cbranch_vccnz k_coldB_191
k_okB_192:
v_smfmac_f32_16x16x64_bf16 v[36:39], v[12:15], a[160:167], v1
s_waitcnt lgkmcnt(2)
buffer_store_dwordx4 v[16:19], v0, s[8:11], s59 offen offset:2048 sc1
s_barrier
ds_read_b128 v[4:7], v0 offset:7168
v_smfmac_f32_16x16x64_bf16 v[44:47], v[12:15], a[176:183], v1
ds_read_b128 v[8:11], v0 offset:6144
s_waitcnt lgkmcnt(2)
v_smfmac_f32_16x16x64_bf16 v[32:35], v[12:15], v[64:71], v1
ds_read_b128 v[64:67], v2 offset:36864
ds_read_b128 v[68:71], v2 offset:37888
v_smfmac_f32_16x16x64_bf16 v[24:27], v[16:19], a[184:191], v1
v_smfmac_f32_16x16x64_bf16 v[40:43], v[12:15], a[168:175], v1
s_waitcnt lgkmcnt(3)
ds_read_b128 v[12:15], v0 offset:4096
v_smfmac_f32_16x16x64_bf16 v[24:27], v[4:7], a[208:215], v1
s_waitcnt lgkmcnt(3)
v_smfmac_f32_16x16x64_bf16 v[28:31], v[4:7], a[216:223], v1
v_smfmac_f32_16x16x64_bf16 v[28:31], v[8:11], a[200:207], v1
s_waitcnt lgkmcnt(1)
v_smfmac_f32_16x16x64_bf16 v[24:27], v[8:11], v[64:71], v1
ds_read_b128 v[64:67], v2 offset:38912
s_waitcnt lgkmcnt(1)
v_smfmac_f32_16x16x64_bf16 v[24:27], v[12:15], a[224:231], v1
ds_read_b128 v[68:71], v2 offset:39936
v_smfmac_f32_16x16x64_bf16 v[28:31], v[12:15], a[232:239], v1
v_smfmac_f32_16x16x64_bf16 v[28:31], v[16:19], a[192:199], v1
v_cvt_pk_bf16_f32 v24, v24, v25
v_cvt_pk_bf16_f32 v25, v26, v27
v_smfmac_f32_16x16x64_bf16 v[32:35], v[4:7], v[80:87], v1
v_cvt_pk_bf16_f32 v26, v28, v29
v_cvt_pk_bf16_f32 v27, v30, v31
v_smfmac_f32_16x16x64_bf16 v[32:35], v[8:11], a[248:255], v1
s_waitcnt lgkmcnt(0)
v_mfma_f32_16x16x32_bf16 v[28:31], v[24:27], v[20:23], 0
v_and_b32 v26, 0xffffff7f, v0
v_smfmac_f32_16x16x64_bf16 v[32:35], v[16:19], v[64:71], v1
v_and_or_b32 v26, v1, 8, v26
v_mul_f32 v28, s51, v28
v_mul_f32 v29, s51, v29
v_mul_f32 v31, s51, v31
v_cvt_pk_bf16_f32 v24, v28, v29
v_mul_f32 v30, s51, v30
v_cvt_pk_bf16_f32 v25, v30, v31
v_smfmac_f32_16x16x64_bf16 v[32:35], v[12:15], v[96:103], v1
ds_write_b64 v26, v[24:25] offset:128
v_smfmac_f32_16x16x64_bf16 v[36:39], v[8:11], v[72:79], v1
v_cvt_pk_bf16_f32 v32, v32, v33
v_smfmac_f32_16x16x64_bf16 v[36:39], v[16:19], a[240:247], v1
buffer_load_dwordx4 v[64:67], v0, s[4:7], s61 offen offset:0
v_cvt_pk_bf16_f32 v33, v34, v35
v_smfmac_f32_16x16x64_bf16 v[36:39], v[12:15], v[104:111], v1
s_waitcnt lgkmcnt(0)
v_smfmac_f32_16x16x64_bf16 v[36:39], v[4:7], v[88:95], v1
s_barrier
ds_read_b128 v[24:27], v0 offset:0
v_smfmac_f32_16x16x64_bf16 v[40:43], v[4:7], v[144:151], v1
ds_read_b128 v[28:31], v0 offset:1024
s_nop 0
v_cvt_pk_bf16_f32 v34, v36, v37
v_cvt_pk_bf16_f32 v35, v38, v39
s_nop 1
v_mfma_f32_16x16x32_bf16 v[36:39], v[32:35], v[20:23], 0
s_waitcnt vmcnt(6)
buffer_load_dwordx4 v[68:71], v0, s[4:7], s61 offen offset:1024
v_and_b32 v34, 0xffffff7f, v0
v_and_or_b32 v34, v1, 8, v34
s_waitcnt lgkmcnt(1)
v_mfma_f32_16x16x32_bf16 v[48:51], v[48:51], v[24:27], 0
v_cvt_pk_bf16_f32 v32, v36, v37
s_waitcnt lgkmcnt(0)
v_mfma_f32_16x16x32_bf16 v[48:51], v[52:55], v[28:31], v[48:51]
v_mov_b64 v[52:53], s[56:57]
v_cvt_pk_bf16_f32 v33, v38, v39
v_smfmac_f32_16x16x64_bf16 v[44:47], v[4:7], v[152:159], v1
ds_write_b64 v34, v[32:33] offset:2176
v_permlane32_swap_b32 v48, v50
v_permlane32_swap_b32 v49, v51
v_add_f32_dpp v52, v50, v48 row_ror:8 row_mask:0xf bank_mask:0x3
v_exp_f32 v52, v52
v_add_f32_dpp v53, v51, v49 row_ror:8 row_mask:0xf bank_mask:0x3
v_exp_f32 v53, v53
s_nop 0
v_cvt_pk_bf16_f32 v48, v52, v53
v_smfmac_f32_16x16x64_bf16 v[44:47], v[16:19], v[120:127], v1
ds_write_b32 v0, v48 offset:4100
v_smfmac_f32_16x16x64_bf16 v[44:47], v[12:15], v[168:175], v1
buffer_load_dwordx4 v[48:51], v0, s[4:7], s61 offen offset:2048
v_smfmac_f32_16x16x64_bf16 v[40:43], v[12:15], v[160:167], v1
s_waitcnt lgkmcnt(1)
v_xor_b32 v12, 0x80, v0
v_smfmac_f32_16x16x64_bf16 v[40:43], v[8:11], v[128:135], v1
s_waitcnt lgkmcnt(0)
s_barrier
ds_read_b128 v[32:35], v0 offset:2048
v_mov_b64 v[22:23], s[52:53]
v_smfmac_f32_16x16x64_bf16 v[40:43], v[16:19], v[112:119], v1
ds_read_b128 v[36:39], v0 offset:3072
ds_read_b128 v[16:19], v0 offset:4096
buffer_load_dwordx4 v[52:55], v0, s[4:7], s61 offen offset:3072
v_smfmac_f32_16x16x64_bf16 v[44:47], v[8:11], v[136:143], v1
ds_read_b128 v[12:15], v12 offset:4096
v_cvt_pk_bf16_f32 v40, v40, v41
v_mov_b64 v[20:21], s[52:53]
s_waitcnt lgkmcnt(3)
v_mfma_f32_16x16x32_bf16 v[24:27], v[32:35], v[24:27], 0
v_cvt_pk_bf16_f32 v41, v42, v43
s_waitcnt lgkmcnt(2)
v_mfma_f32_16x16x32_bf16 v[24:27], v[36:39], v[28:31], v[24:27]
s_waitcnt vmcnt(5)
s_waitcnt lgkmcnt(1)
v_mfma_f32_16x16x32_bf16 v[8:11], v[56:59], v[16:19], 0
buffer_load_dwordx4 v[56:59], v0, s[4:7], s62 offen offset:0
v_mov_b64 v[28:29], s[56:57]
v_cvt_pk_bf16_f32 v43, v46, v47
v_cvt_pk_bf16_f32 v42, v44, v45
v_permlane32_swap_b32 v25, v27
v_permlane32_swap_b32 v24, v26
v_mfma_f32_16x16x32_bf16 v[4:7], v[20:23], v[16:19], 0
s_waitcnt lgkmcnt(0)
v_add_f32_dpp v28, v26, v24 row_ror:8 row_mask:0xf bank_mask:0x3
v_add_f32_dpp v29, v27, v25 row_ror:8 row_mask:0xf bank_mask:0x3
v_exp_f32 v28, v28
v_mfma_f32_16x16x32_bf16 v[8:11], v[60:63], v[12:15], v[8:11]
buffer_load_dwordx4 v[60:63], v0, s[4:7], s62 offen offset:1024
v_exp_f32 v29, v29
v_permlane32_swap_b32 v42, v43
v_cvt_pk_bf16_f32 v24, v28, v29
v_mov_b64 v[44:45], s[54:55]
v_cvt_pk_bf16_f32 v25, v28, v29
v_mov_b32_dpp v26, v24 row_ror:8 row_mask:0xf bank_mask:0xf
v_mov_b32_dpp v27, v24 row_ror:8 row_mask:0xf bank_mask:0xf
v_mfma_f32_16x16x16_bf16 v[4:7], v[44:45], v[24:25], v[4:7]
v_permlane32_swap_b32 v40, v41
v_mov_b64 v[36:37], 0
v_mov_b64 v[38:39], 0
v_mov_b64 v[30:31], 0
v_mfma_f32_16x16x32_bf16 v[8:11], v[40:43], v[24:27], v[8:11]
buffer_load_dwordx4 v[16:19], v0, s[4:7], s62 offen offset:2048
v_rcp_f32 v6, v4
v_and_b32 v12, 0xffffff7f, v0
v_and_or_b32 v13, v1, 8, v12
v_rcp_f32_dpp v6, v4 row_ror:8 row_mask:0xf bank_mask:0xc
v_mov_b64 v[26:27], 0
v_pk_mul_f32 v[8:9], v[8:9], v[6:7] op_sel_hi:[1,0]
v_cvt_pk_bf16_f32 v44, v8, v9
v_pk_mul_f32 v[10:11], v[10:11], v[6:7] op_sel_hi:[1,0]
v_cvt_pk_bf16_f32 v45, v10, v11
s_waitcnt vmcnt(5)
ds_write_b64 v13, v[44:45] offset:6272
buffer_load_dwordx4 v[20:23], v0, s[4:7], s62 offen offset:3072
v_add_u32 v6, 0xd4800000, v6
v_cmp_lt_u32 vcc, 0x28000000, v6
v_mov_b64 v[34:35], 0
v_mov_b32_dpp v46, v44 row_ror:8 row_mask:0xf bank_mask:0xf
v_mov_b32_dpp v47, v45 row_ror:8 row_mask:0xf bank_mask:0xf
v_mov_b64 v[28:29], 0
v_mov_b64 v[32:33], 0
s_cbranch_vccnz k_slow_193
k_okS_194:
v_smfmac_f32_16x16x64_bf16 v[36:39], v[44:47], v[224:231], v1
s_waitcnt lgkmcnt(0)
s_barrier
ds_read_b128 v[8:11], v12 offset:7296
v_smfmac_f32_16x16x64_bf16 v[32:35], v[44:47], v[200:207], v1
s_waitcnt vmcnt(4)
ds_read_b128 v[4:7], v12 offset:7168
v_mov_b64 v[24:25], 0
v_smfmac_f32_16x16x64_bf16 v[28:31], v[44:47], v[48:55], v1
ds_read_b128 v[12:15], v12 offset:6144
ds_read_b128 v[48:51], v2 offset:28672
v_smfmac_f32_16x16x64_bf16 v[24:27], v[44:47], v[64:71], v1
ds_read_b128 v[52:55], v2 offset:29696
v_mov_b64 v[42:43], 0
s_waitcnt lgkmcnt(4)
v_smfmac_f32_16x16x64_bf16 v[24:27], v[8:11], v[184:191], v1
s_waitcnt lgkmcnt(3)
v_mov_b64 v[40:41], 0
v_smfmac_f32_16x16x64_bf16 v[24:27], v[4:7], v[176:183], v1
s_waitcnt lgkmcnt(2)
ds_read_b128 v[64:67], v2 offset:63488
v_smfmac_f32_16x16x64_bf16 v[24:27], v[12:15], v[192:199], v1
ds_read_b128 v[68:71], v2 offset:64512
v_smfmac_f32_16x16x64_bf16 v[40:43], v[44:47], v[240:247], v1
s_waitcnt vmcnt(2)
s_waitcnt lgkmcnt(2)
v_lshrrev_b32 v44, 16, v1
v_cvt_pk_bf16_f32 v24, v24, v25
v_bfi_b32 v24, 1, s45, v24
v_cvt_pk_bf16_f32 v25, v26, v27
v_smfmac_f32_16x16x64_bf16 v[28:31], v[8:11], v[48:55], v1
buffer_store_dwordx2 v[24:25], v44, s[4:7], s38 offen
ds_read_b128 v[48:51], v2 offset:34816
ds_read_b128 v[52:55], v2 offset:35840
v_smfmac_f32_16x16x64_bf16 v[28:31], v[12:15], v[56:63], v1
s_waitcnt lgkmcnt(2)
ds_read_b128 v[56:59], v2 offset:59392
v_smfmac_f32_16x16x64_bf16 v[28:31], v[4:7], v[64:71], v1
ds_read_b128 v[60:63], v2 offset:60416
v_smfmac_f32_16x16x64_bf16 v[32:35], v[8:11], v[208:215], v1
ds_read_b128 v[64:67], v2 offset:32768
s_nop 0
v_cvt_pk_bf16_f32 v28, v28, v29
v_bfi_b32 v28, 1, s45, v28
v_cvt_pk_bf16_f32 v29, v30, v31
v_smfmac_f32_16x16x64_bf16 v[32:35], v[12:15], v[216:223], v1
buffer_store_dwordx2 v[28:29], v44, s[4:7], s39 offen
v_smfmac_f32_16x16x64_bf16 v[40:43], v[12:15], v[248:255], v1
ds_read_b128 v[68:71], v2 offset:33792
s_waitcnt vmcnt(2)
v_smfmac_f32_16x16x64_bf16 v[32:35], v[4:7], v[16:23], v1
s_waitcnt lgkmcnt(2)
v_smfmac_f32_16x16x64_bf16 v[36:39], v[12:15], v[232:239], v1
ds_read_b128 v[16:19], v2 offset:61440
ds_read_b128 v[20:23], v2 offset:62464
v_cvt_pk_bf16_f32 v32, v32, v33
v_bfi_b32 v32, 1, s45, v32
v_cvt_pk_bf16_f32 v33, v34, v35
v_smfmac_f32_16x16x64_bf16 v[36:39], v[8:11], v[48:55], v1
buffer_store_dwordx2 v[32:33], v44, s[4:7], s40 offen
s_waitcnt lgkmcnt(2)
v_smfmac_f32_16x16x64_bf16 v[36:39], v[4:7], v[64:71], v1
s_nop 6
v_cvt_pk_bf16_f32 v36, v36, v37
v_cvt_pk_bf16_f32 v37, v38, v39
s_waitcnt lgkmcnt(0)
v_bfi_b32 v36, 1, s45, v36
v_smfmac_f32_16x16x64_bf16 v[40:43], v[8:11], v[16:23], v1
buffer_store_dwordx2 v[36:37], v44, s[4:7], s41 offen
v_smfmac_f32_16x16x64_bf16 v[40:43], v[4:7], v[56:63], v1
s_nop 6
v_cvt_pk_bf16_f32 v40, v40, v41
v_bfi_b32 v40, 1, s45, v40
v_cvt_pk_bf16_f32 v41, v42, v43
buffer_store_dwordx2 v[40:41], v44, s[4:7], s42 offen
s_barrier
buffer_load_dwordx4 v[24:27], v0, s[4:7], s43 offen offset:0 sc1
buffer_load_dwordx4 v[28:31], v0, s[4:7], s43 offen offset:1024 sc1
buffer_load_dwordx4 v[32:35], v0, s[4:7], s43 offen offset:2048 sc1
buffer_load_dwordx4 v[36:39], v0, s[4:7], s43 offen offset:3072 sc1
buffer_load_dwordx4 v[48:51], v0, s[4:7], s60 offen offset:0
buffer_load_dwordx4 v[52:55], v0, s[4:7], s60 offen offset:1024
buffer_load_dwordx4 v[56:59], v0, s[4:7], s60 offen offset:2048
buffer_load_dwordx4 v[60:63], v0, s[4:7], s60 offen offset:3072
v_lshlrev_b32 v23, v0, s58
v_cndmask_b32 v16, 0, v23, s[12:13]
v_cndmask_b32 v17, 0, v23, s[14:15]
v_cndmask_b32 v18, 0, v23, s[16:17]
v_cndmask_b32 v19, 0, v23, s[18:19]
v_and_b32 v45, 0x30, v0
v_lshrrev_b32 v46, 8, v0
v_lshl_or_b32 v45, v46, 2, v45
v_bfe_u32 v46, v0, 6, 1
v_lshl_or_b32 v45, v46, 7, v45
v_cndmask_b32 v45, v45, 2.0, s[98:99]
v_cndmask_b32 v20, 0, v23, s[90:91]
v_cndmask_b32 v21, 0, v23, s[92:93]
v_cndmask_b32 v22, 0, v23, s[94:95]
v_cndmask_b32 v23, 0, v23, s[96:97]
s_add_u32 s33, s33, 16384
s_bitset0_b32 s33, 16
s_waitcnt vmcnt(7)
v_mfma_f32_16x16x32_bf16 v[40:43], v[24:27], v[16:19], 0
s_waitcnt vmcnt(6)
v_mfma_f32_16x16x32_bf16 v[40:43], v[28:31], v[16:19], v[40:43]
v_bitop3_b32 v46, v24, v28, s45 bitop3:0x7e
s_waitcnt vmcnt(5)
v_mfma_f32_16x16x32_bf16 v[40:43], v[32:35], v[16:19], v[40:43]
s_waitcnt vmcnt(4)
v_mfma_f32_16x16x32_bf16 v[40:43], v[36:39], v[16:19], v[40:43]
v_bitop3_b32 v47, v32, v36, s45 bitop3:0x7e
v_bitop3_b32 v46, v46, v47, 1 bitop3:0xa8
v_cmp_ne_u32 vcc, 0, v46
v_mov_b64 v[24:25], 0
v_mov_b64 v[26:27], 0
v_mov_b64 v[28:29], 0
v_mov_b64 v[30:31], 0
v_permlane32_swap_b32 v40, v41
v_permlane32_swap_b32 v42, v43
v_add_f32 v40, v40, v41
v_add_f32 v41, v42, v43
v_cvt_pk_bf16_f32 v42, v40, v41
s_cbranch_vccnz k_r1_196
k_ok1_197:
buffer_store_dword v42, v45, s[4:7], s44 offen
s_barrier
buffer_load_dwordx4 v[4:7], v0, s[4:7], s33 offen offset:1024 sc1
buffer_load_dwordx4 v[8:11], v0, s[4:7], s33 offen offset:0 sc1
s_add_u32 s34, s33, 3072
s_add_u32 s35, s33, 7168
s_add_u32 s36, s36, 524288
s_add_u32 s37, s37, 10240
s_add_u32 s59, s59, 10240
v_mov_b64 v[32:33], 0
v_mov_b64 v[34:35], 0
v_mov_b64 v[36:37], 0
v_mov_b64 v[38:39], 0
v_mov_b64 v[40:41], 0
v_mov_b64 v[42:43], 0
v_mov_b64 v[44:45], 0
v_mov_b64 v[46:47], 0
s_add_u32 s44, s44, 16384
s_bitset0_b32 s44, 16
s_sub_u32 s45, s45, 1
s_add_u32 s31, s31, 1
ds_read_b128 v[64:67], v0 offset:24576
ds_read_b128 v[68:71], v0 offset:25600
buffer_load_dwordx4 v[12:15], v0, s[4:7], s34 offen offset:0 sc1
s_cmp_lg_u32 s31, s47
s_cbranch_scc1 k_T0_185
s_branch k_done_195
k_cold2_187:
s_barrier
buffer_load_dwordx4 v[48:51], v0, s[4:7], s60 offen offset:0
buffer_load_dwordx4 v[52:55], v0, s[4:7], s60 offen offset:1024
buffer_load_dwordx4 v[56:59], v0, s[4:7], s60 offen offset:2048
buffer_load_dwordx4 v[60:63], v0, s[4:7], s60 offen offset:3072
ds_read_b128 v[64:67], v0 offset:24576
ds_read_b128 v[68:71], v0 offset:25600
k_cold_186:
buffer_load_dwordx4 v[4:7], v0, s[4:7], s33 offen offset:1024 sc1
buffer_load_dwordx4 v[8:11], v0, s[4:7], s33 offen offset:0 sc1
buffer_load_dwordx4 v[12:15], v0, s[4:7], s34 offen offset:0 sc1
s_sub_u32 s32, s32, 1
s_cmp_gt_i32 s32, 0
s_cbranch_scc0 k_okC_188
v_mov_b64 v[24:25], 0
v_mov_b64 v[26:27], 0
v_mov_b64 v[28:29], 0
v_mov_b64 v[30:31], 0
v_mov_b64 v[32:33], 0
v_mov_b64 v[34:35], 0
v_mov_b64 v[36:37], 0
v_mov_b64 v[38:39], 0
v_mov_b64 v[40:41], 0
v_mov_b64 v[42:43], 0
v_mov_b64 v[44:45], 0
v_mov_b64 v[46:47], 0
s_branch k_T0_185
k_coldA_189:
buffer_load_dwordx4 v[12:15], v0, s[4:7], s34 offen offset:0 sc1
s_sub_u32 s32, s32, 1
s_cmp_gt_i32 s32, 0
s_waitcnt vmcnt(0)
v_cmp_u_f32 vcc, v12, v12
ds_write_b128 v0, v[12:15] offset:1024
s_waitcnt lgkmcnt(0)
s_cbranch_vccz k_okA_190
s_cbranch_scc1 k_coldA_189
s_branch k_okA_190
k_coldB_191:
buffer_load_dwordx4 v[16:19], v0, s[4:7], s35 offen offset:0 sc1
s_sub_u32 s32, s32, 1
s_cmp_gt_i32 s32, 0
s_waitcnt vmcnt(0)
v_cmp_u_f32 vcc, v16, v16
ds_write_b128 v0, v[16:19] offset:5120
s_waitcnt lgkmcnt(0)
s_cbranch_vccz k_okB_192
s_cbranch_scc1 k_coldB_191
s_branch k_okB_192
k_r1_196:
buffer_load_dwordx4 v[24:27], v0, s[4:7], s43 offen offset:0 sc1
buffer_load_dwordx4 v[28:31], v0, s[4:7], s43 offen offset:1024 sc1
buffer_load_dwordx4 v[32:35], v0, s[4:7], s43 offen offset:2048 sc1
buffer_load_dwordx4 v[36:39], v0, s[4:7], s43 offen offset:3072 sc1
s_sub_u32 s32, s32, 1
s_cmp_gt_i32 s32, 0
s_waitcnt vmcnt(3)
v_mfma_f32_16x16x32_bf16 v[40:43], v[24:27], v[16:19], 0
s_waitcnt vmcnt(2)
v_mfma_f32_16x16x32_bf16 v[40:43], v[28:31], v[16:19], v[40:43]
v_bitop3_b32 v46, v24, v28, s45 bitop3:0x7e
s_waitcnt vmcnt(1)
v_mfma_f32_16x16x32_bf16 v[40:43], v[32:35], v[16:19], v[40:43]
s_waitcnt vmcnt(0)
v_mfma_f32_16x16x32_bf16 v[40:43], v[36:39], v[16:19], v[40:43]
v_bitop3_b32 v47, v32, v36, s45 bitop3:0x7e
v_bitop3_b32 v46, v46, v47, 1 bitop3:0xa8
v_cmp_ne_u32 vcc, 0, v46
v_mov_b64 v[24:25], 0
v_mov_b64 v[26:27], 0
v_mov_b64 v[28:29], 0
v_mov_b64 v[30:31], 0
v_permlane32_swap_b32 v40, v41
v_permlane32_swap_b32 v42, v43
v_add_f32 v40, v40, v41
v_add_f32 v41, v42, v43
v_cvt_pk_bf16_f32 v42, v40, v41
s_cbranch_vccz k_ok1_197
s_cbranch_scc1 k_r1_196
s_branch k_ok1_197
k_slow_193:
ds_read_b128 v[24:27], v0 offset:0
ds_read_b128 v[28:31], v0 offset:1024
v_mov_b32 v46, 0xff7fffff
s_add_u32 s48, s36, 0xfffff000
buffer_load_dwordx4 v[32:35], v0, s[4:7], s48 offen offset:0 sc1
buffer_load_dwordx4 v[36:39], v0, s[4:7], s48 offen offset:1024 sc1
s_waitcnt vmcnt(1) lgkmcnt(1)
v_mfma_f32_16x16x32_bf16 v[4:7], v[32:35], v[24:27], 0
s_waitcnt vmcnt(0) lgkmcnt(0)
v_mfma_f32_16x16x32_bf16 v[4:7], v[36:39], v[28:31], v[4:7]
v_mov_b64 v[8:9], s[56:57]
s_nop 5
v_permlane32_swap_b32 v4, v6
v_permlane32_swap_b32 v5, v7
v_add_f32_dpp v8, v6, v4 row_ror:8 row_mask:0xf bank_mask:0x3
s_nop 0
v_add_f32_dpp v9, v7, v5 row_ror:8 row_mask:0xf bank_mask:0x3
v_max3_f32 v46, v46, v8, v9
s_add_u32 s48, s36, 0x0
buffer_load_dwordx4 v[32:35], v0, s[4:7], s48 offen offset:0 sc1
buffer_load_dwordx4 v[36:39], v0, s[4:7], s48 offen offset:1024 sc1
s_waitcnt vmcnt(1)
v_mfma_f32_16x16x32_bf16 v[4:7], v[32:35], v[24:27], 0
s_waitcnt vmcnt(0)
v_mfma_f32_16x16x32_bf16 v[4:7], v[36:39], v[28:31], v[4:7]
v_mov_b64 v[10:11], s[56:57]
s_nop 5
v_permlane32_swap_b32 v4, v6
v_permlane32_swap_b32 v5, v7
v_add_f32_dpp v10, v6, v4 row_ror:8 row_mask:0xf bank_mask:0x3
s_nop 0
v_add_f32_dpp v11, v7, v5 row_ror:8 row_mask:0xf bank_mask:0x3
v_max3_f32 v46, v46, v10, v11
s_add_u32 s48, s36, 0x1000
buffer_load_dwordx4 v[32:35], v0, s[4:7], s48 offen offset:0 sc1
buffer_load_dwordx4 v[36:39], v0, s[4:7], s48 offen offset:1024 sc1
s_waitcnt vmcnt(1)
v_mfma_f32_16x16x32_bf16 v[4:7], v[32:35], v[24:27], 0
s_waitcnt vmcnt(0)
v_mfma_f32_16x16x32_bf16 v[4:7], v[36:39], v[28:31], v[4:7]
v_mov_b64 v[12:13], s[56:57]
s_nop 5
v_permlane32_swap_b32 v4, v6
v_permlane32_swap_b32 v5, v7
v_add_f32_dpp v12, v6, v4 row_ror:8 row_mask:0xf bank_mask:0x3
s_nop 0
v_add_f32_dpp v13, v7, v5 row_ror:8 row_mask:0xf bank_mask:0x3
v_max3_f32 v46, v46, v12, v13
s_add_u32 s48, s36, 0x2000
buffer_load_dwordx4 v[32:35], v0, s[4:7], s48 offen offset:0 sc1
buffer_load_dwordx4 v[36:39], v0, s[4:7], s48 offen offset:1024 sc1
s_waitcnt vmcnt(1)
v_mfma_f32_16x16x32_bf16 v[4:7], v[32:35], v[24:27], 0
s_waitcnt vmcnt(0)
v_mfma_f32_16x16x32_bf16 v[4:7], v[36:39], v[28:31], v[4:7]
v_mov_b64 v[14:15], s[56:57]
s_nop 5
v_permlane32_swap_b32 v4, v6
v_permlane32_swap_b32 v5, v7
v_add_f32_dpp v14, v6, v4 row_ror:8 row_mask:0xf bank_mask:0x3
s_nop 0
v_add_f32_dpp v15, v7, v5 row_ror:8 row_mask:0xf bank_mask:0x3
v_max3_f32 v46, v46, v14, v15
ds_read_b128 v[32:35], v0 offset:2048
ds_read_b128 v[36:39], v0 offset:3072
s_waitcnt lgkmcnt(1)
v_mfma_f32_16x16x32_bf16 v[4:7], v[32:35], v[24:27], 0
s_waitcnt lgkmcnt(0)
v_mfma_f32_16x16x32_bf16 v[4:7], v[36:39], v[28:31], v[4:7]
v_mov_b64 v[44:45], s[56:57]
s_nop 5
v_permlane32_swap_b32 v4, v6
v_permlane32_swap_b32 v5, v7
v_add_f32_dpp v44, v6, v4 row_ror:8 row_mask:0xf bank_mask:0x3
s_nop 0
v_add_f32_dpp v45, v7, v5 row_ror:8 row_mask:0xf bank_mask:0x3
v_max3_f32 v46, v46, v44, v45
buffer_load_dwordx4 v[32:35], v0, s[4:7], s36 offen offset:2048 sc1
buffer_load_dwordx4 v[36:39], v0, s[4:7], s36 offen offset:3072 sc1
v_mov_b32 v47, v46
s_nop 1
v_permlane32_swap_b32 v46, v47
v_max_f32 v46, v46, v47
v_mov_b32 v47, v46
s_nop 1
v_permlane16_swap_b32 v46, v47
v_max_f32 v46, v46, v47
v_sub_f32 v8, v8, v46
v_exp_f32 v8, v8
v_sub_f32 v9, v9, v46
v_exp_f32 v9, v9
v_sub_f32 v10, v10, v46
v_exp_f32 v10, v10
v_sub_f32 v11, v11, v46
v_exp_f32 v11, v11
v_sub_f32 v12, v12, v46
v_exp_f32 v12, v12
v_sub_f32 v13, v13, v46
v_exp_f32 v13, v13
v_sub_f32 v14, v14, v46
v_exp_f32 v14, v14
v_sub_f32 v15, v15, v46
v_exp_f32 v15, v15
v_sub_f32 v44, v44, v46
v_exp_f32 v44, v44
v_sub_f32 v45, v45, v46
v_exp_f32 v45, v45
v_cvt_pk_bf16_f32 v4, v8, v9
v_cvt_pk_bf16_f32 v5, v10, v11
v_cvt_pk_bf16_f32 v6, v12, v13
v_cvt_pk_bf16_f32 v7, v14, v15
v_mov_b32_dpp v8, v4 row_ror:8 row_mask:0xf bank_mask:0xf
v_mov_b32_dpp v9, v5 row_ror:8 row_mask:0xf bank_mask:0xf
v_mov_b32_dpp v10, v6 row_ror:8 row_mask:0xf bank_mask:0xf
v_mov_b32_dpp v11, v7 row_ror:8 row_mask:0xf bank_mask:0xf
v_cvt_pk_bf16_f32 v24, v44, v45
v_cvt_pk_bf16_f32 v25, v44, v45
s_nop 0
v_mov_b32_dpp v26, v24 row_ror:8 row_mask:0xf bank_mask:0xf
v_mov_b32_dpp v27, v24 row_ror:8 row_mask:0xf bank_mask:0xf
v_mov_b64 v[28:29], s[52:53]
v_mov_b64 v[30:31], s[52:53]
s_nop 1
v_mfma_f32_16x16x32_bf16 v[44:47], v[28:31], v[4:7], 0
s_waitcnt vmcnt(1)
v_mfma_f32_16x16x32_bf16 v[12:15], v[32:35], v[4:7], 0
s_waitcnt vmcnt(0)
v_mfma_f32_16x16x32_bf16 v[12:15], v[36:39], v[8:11], v[12:15]
v_mfma_f32_16x16x32_bf16 v[12:15], v[40:43], v[24:27], v[12:15]
v_mov_b64 v[28:29], s[54:55]
s_nop 1
v_mfma_f32_16x16x16_bf16 v[44:47], v[28:29], v[24:25], v[44:47]
s_nop 6
v_rcp_f32 v4, v44
s_nop 1
v_rcp_f32_dpp v4, v44 row_ror:8 row_mask:0xf bank_mask:0xc
s_nop 0
v_mul_f32 v12, v4, v12
v_mul_f32 v13, v4, v13
v_mul_f32 v14, v4, v14
v_mul_f32 v15, v4, v15
v_cvt_pk_bf16_f32 v44, v12, v13
v_cvt_pk_bf16_f32 v45, v14, v15
v_and_b32 v12, 0xffffff7f, v0
v_and_or_b32 v8, v1, 8, v12
ds_write_b64 v8, v[44:45] offset:6272
v_mov_b32_dpp v46, v44 row_ror:8 row_mask:0xf bank_mask:0xf
v_mov_b32_dpp v47, v45 row_ror:8 row_mask:0xf bank_mask:0xf
v_mov_b64 v[24:25], 0
v_mov_b64 v[26:27], 0
v_mov_b64 v[28:29], 0
v_mov_b64 v[30:31], 0
v_mov_b64 v[32:33], 0
v_mov_b64 v[34:35], 0
v_mov_b64 v[36:37], 0
v_mov_b64 v[38:39], 0
s_waitcnt lgkmcnt(0)
s_branch k_okS_194
k_done_195:
buffer_load_dwordx4 v[16:19], v0, s[4:7], s35 offen offset:0 sc1
k_xs_201:
s_waitcnt vmcnt(1)
v_cmp_u_f32 vcc, v4, v12
s_waitcnt vmcnt(0)
v_cmp_u_f32 s[66:67], v16, v16
s_or_b64 vcc, vcc, s[66:67]
s_cbranch_vccz k_xd_202
buffer_load_dwordx4 v[4:7], v0, s[4:7], s33 offen offset:1024 sc1
buffer_load_dwordx4 v[8:11], v0, s[4:7], s33 offen offset:0 sc1
buffer_load_dwordx4 v[12:15], v0, s[4:7], s34 offen offset:0 sc1
buffer_load_dwordx4 v[16:19], v0, s[4:7], s35 offen offset:0 sc1
s_sub_u32 s32, s32, 1
s_cmp_gt_i32 s32, 0
s_cbranch_scc1 k_xs_201
k_xd_202:
s_waitcnt vmcnt(3)
buffer_store_dwordx4 v[4:7], v0, s[8:11], s37 offen offset:0 sc1
s_waitcnt vmcnt(2)
buffer_store_dwordx4 v[12:15], v0, s[8:11], s37 offen offset:2048 sc1
s_waitcnt vmcnt(2)
buffer_store_dwordx4 v[16:19], v0, s[8:11], s59 offen offset:2048 sc1
s_add_u32 s31, s31, 1
s_branch k_jn_184
k_far_183:
s_branch k_cold2_205
k_T0_203:
s_waitcnt vmcnt(2)
v_smfmac_f32_16x16x64_bf16 v[40:43], v[4:7], v[48:55], v1
s_waitcnt vmcnt(1)
v_cmp_u_f32 vcc, v4, v8
v_smfmac_f32_16x16x64_bf16 v[24:27], v[8:11], a[24:31], v1
v_smfmac_f32_16x16x64_bf16 v[28:31], v[8:11], a[32:39], v1
s_cbranch_vccnz k_cold_204
k_okC_206:
s_waitcnt vmcnt(1)
v_smfmac_f32_16x16x64_bf16 v[36:39], v[8:11], a[40:47], v1
s_waitcnt lgkmcnt(0)
ds_read_b128 v[48:51], v0 offset:34816
v_smfmac_f32_16x16x64_bf16 v[32:35], v[4:7], v[64:71], v1
ds_read_b128 v[52:55], v0 offset:35840
ds_read_b128 v[64:67], v0 offset:22528
v_smfmac_f32_16x16x64_bf16 v[44:47], v[4:7], v[56:63], v1
ds_read_b128 v[68:71], v0 offset:23552
v_smfmac_f32_16x16x64_bf16 v[28:31], v[4:7], a[8:15], v1
v_smfmac_f32_16x16x64_bf16 v[24:27], v[4:7], a[0:7], v1
ds_read_b128 v[56:59], v2 offset:30720
v_smfmac_f32_16x16x64_bf16 v[36:39], v[4:7], a[16:23], v1
ds_read_b128 v[60:63], v2 offset:31744
s_waitcnt lgkmcnt(4)
v_smfmac_f32_16x16x64_bf16 v[40:43], v[8:11], v[48:55], v1
s_waitcnt vmcnt(0)
ds_write_b128 v0, v[12:15] offset:1024
s_waitcnt lgkmcnt(3)
v_smfmac_f32_16x16x64_bf16 v[32:35], v[8:11], v[64:71], v1
buffer_load_dwordx4 v[16:19], v0, s[4:7], s35 offen offset:0 sc1
v_cmp_u_f32 vcc, v12, v12
s_waitcnt lgkmcnt(1)
v_smfmac_f32_16x16x64_bf16 v[44:47], v[8:11], v[56:63], v1
ds_read_b128 v[56:59], v2 offset:53248
ds_read_b128 v[60:63], v2 offset:54272
ds_read_b128 v[64:67], v0 offset:28672
s_cbranch_vccnz k_coldA_207
k_okA_208:
v_smfmac_f32_16x16x64_bf16 v[36:39], v[12:15], a[64:71], v1
ds_read_b128 v[68:71], v0 offset:29696
s_waitcnt lgkmcnt(4)
v_smfmac_f32_16x16x64_bf16 v[40:43], v[12:15], a[72:79], v1
s_barrier
v_smfmac_f32_16x16x64_bf16 v[28:31], v[12:15], a[56:63], v1
ds_read_b128 v[8:11], v0 offset:2048
buffer_load_dwordx4 v[48:51], v0, s[4:7], s36 offen offset:0 sc1
s_waitcnt lgkmcnt(3)
v_smfmac_f32_16x16x64_bf16 v[44:47], v[12:15], v[56:63], v1
ds_read_b128 v[56:59], v2 offset:55296
v_smfmac_f32_16x16x64_bf16 v[24:27], v[12:15], a[48:55], v1
ds_read_b128 v[60:63], v2 offset:56320
s_waitcnt lgkmcnt(3)
v_smfmac_f32_16x16x64_bf16 v[32:35], v[12:15], v[64:71], v1
buffer_load_dwordx4 v[52:55], v0, s[4:7], s36 offen offset:1024 sc1
s_waitcnt lgkmcnt(2)
v_smfmac_f32_16x16x64_bf16 v[24:27], v[8:11], a[80:87], v1
ds_read_b128 v[64:67], v0 offset:30720
ds_read_b128 v[68:71], v0 offset:31744
v_smfmac_f32_16x16x64_bf16 v[36:39], v[8:11], a[96:103], v1
buffer_store_dwordx4 v[4:7], v0, s[8:11], s37 offen offset:0 sc1
s_waitcnt lgkmcnt(2)
s_nop 0
ds_read_b128 v[4:7], v0 offset:3072
v_smfmac_f32_16x16x64_bf16 v[44:47], v[8:11], v[56:63], v1
ds_read_b128 v[56:59], v2 offset:57344
ds_read_b128 v[60:63], v2 offset:58368
v_smfmac_f32_16x16x64_bf16 v[28:31], v[8:11], a[88:95], v1
buffer_store_dwordx4 v[12:15], v0, s[8:11], s37 offen offset:2048 sc1
v_smfmac_f32_16x16x64_bf16 v[40:43], v[8:11], a[104:111], v1
s_waitcnt lgkmcnt(3)
s_waitcnt lgkmcnt(2)
v_smfmac_f32_16x16x64_bf16 v[32:35], v[8:11], v[64:71], v1
ds_read_b128 v[64:67], v0 offset:32768
ds_read_b128 v[12:15], v0 offset:0
v_smfmac_f32_16x16x64_bf16 v[36:39], v[4:7], a[128:135], v1
s_waitcnt lgkmcnt(2)
v_smfmac_f32_16x16x64_bf16 v[44:47], v[4:7], v[56:63], v1
ds_read_b128 v[68:71], v0 offset:33792
buffer_load_dwordx4 v[56:59], v0, s[4:7], s36 offen offset:2048 sc1
v_smfmac_f32_16x16x64_bf16 v[28:31], v[4:7], a[120:127], v1
v_smfmac_f32_16x16x64_bf16 v[24:27], v[4:7], a[112:119], v1
s_waitcnt vmcnt(5)
ds_write_b128 v0, v[16:19] offset:5120
v_smfmac_f32_16x16x64_bf16 v[40:43], v[4:7], a[136:143], v1
s_waitcnt lgkmcnt(1)
buffer_load_dwordx4 v[60:63], v0, s[4:7], s36 offen offset:3072 sc1
v_cmp_u_f32 vcc, v16, v16
v_smfmac_f32_16x16x64_bf16 v[32:35], v[4:7], v[64:71], v1
ds_read_b128 v[64:67], v0 offset:26624
ds_read_b128 v[68:71], v0 offset:27648
v_smfmac_f32_16x16x64_bf16 v[28:31], v[12:15], a[152:159], v1
v_smfmac_f32_16x16x64_bf16 v[24:27], v[12:15], a[144:151], v1
s_cbranch_vccnz k_coldB_209
k_okB_210:
v_smfmac_f32_16x16x64_bf16 v[36:39], v[12:15], a[160:167], v1
s_waitcnt lgkmcnt(2)
buffer_store_dwordx4 v[16:19], v0, s[8:11], s59 offen offset:2048 sc1
s_barrier
ds_read_b128 v[4:7], v0 offset:7168
v_smfmac_f32_16x16x64_bf16 v[44:47], v[12:15], a[176:183], v1
ds_read_b128 v[8:11], v0 offset:6144
s_waitcnt lgkmcnt(2)
v_smfmac_f32_16x16x64_bf16 v[32:35], v[12:15], v[64:71], v1
ds_read_b128 v[64:67], v2 offset:36864
ds_read_b128 v[68:71], v2 offset:37888
v_smfmac_f32_16x16x64_bf16 v[24:27], v[16:19], a[184:191], v1
v_smfmac_f32_16x16x64_bf16 v[40:43], v[12:15], a[168:175], v1
s_waitcnt lgkmcnt(3)
ds_read_b128 v[12:15], v0 offset:4096
v_smfmac_f32_16x16x64_bf16 v[24:27], v[4:7], a[208:215], v1
s_waitcnt lgkmcnt(3)
v_smfmac_f32_16x16x64_bf16 v[28:31], v[4:7], a[216:223], v1
v_smfmac_f32_16x16x64_bf16 v[28:31], v[8:11], a[200:207], v1
s_waitcnt lgkmcnt(1)
v_smfmac_f32_16x16x64_bf16 v[24:27], v[8:11], v[64:71], v1
ds_read_b128 v[64:67], v2 offset:38912
s_waitcnt lgkmcnt(1)
v_smfmac_f32_16x16x64_bf16 v[24:27], v[12:15], a[224:231], v1
ds_read_b128 v[68:71], v2 offset:39936
v_smfmac_f32_16x16x64_bf16 v[28:31], v[12:15], a[232:239], v1
v_smfmac_f32_16x16x64_bf16 v[28:31], v[16:19], a[192:199], v1
v_cvt_pk_bf16_f32 v24, v24, v25
v_cvt_pk_bf16_f32 v25, v26, v27
v_smfmac_f32_16x16x64_bf16 v[32:35], v[4:7], v[80:87], v1
v_cvt_pk_bf16_f32 v26, v28, v29
v_cvt_pk_bf16_f32 v27, v30, v31
v_smfmac_f32_16x16x64_bf16 v[32:35], v[8:11], a[248:255], v1
s_waitcnt lgkmcnt(0)
v_mfma_f32_16x16x32_bf16 v[28:31], v[24:27], v[20:23], 0
v_and_b32 v26, 0xffffff7f, v0
v_smfmac_f32_16x16x64_bf16 v[32:35], v[16:19], v[64:71], v1
v_and_or_b32 v26, v1, 8, v26
v_mul_f32 v28, s51, v28
v_mul_f32 v29, s51, v29
v_mul_f32 v31, s51, v31
v_cvt_pk_bf16_f32 v24, v28, v29
v_mul_f32 v30, s51, v30
v_cvt_pk_bf16_f32 v25, v30, v31
v_smfmac_f32_16x16x64_bf16 v[32:35], v[12:15], v[96:103], v1
ds_write_b64 v26, v[24:25] offset:128
v_smfmac_f32_16x16x64_bf16 v[36:39], v[8:11], v[72:79], v1
v_cvt_pk_bf16_f32 v32, v32, v33
v_smfmac_f32_16x16x64_bf16 v[36:39], v[16:19], a[240:247], v1
buffer_load_dwordx4 v[64:67], v0, s[4:7], s61 offen offset:0
v_cvt_pk_bf16_f32 v33, v34, v35
v_smfmac_f32_16x16x64_bf16 v[36:39], v[12:15], v[104:111], v1
s_waitcnt lgkmcnt(0)
v_smfmac_f32_16x16x64_bf16 v[36:39], v[4:7], v[88:95], v1
s_barrier
ds_read_b128 v[24:27], v0 offset:0
v_smfmac_f32_16x16x64_bf16 v[40:43], v[4:7], v[144:151], v1
ds_read_b128 v[28:31], v0 offset:1024
s_nop 0
v_cvt_pk_bf16_f32 v34, v36, v37
v_cvt_pk_bf16_f32 v35, v38, v39
s_nop 1
v_mfma_f32_16x16x32_bf16 v[36:39], v[32:35], v[20:23], 0
s_waitcnt vmcnt(6)
buffer_load_dwordx4 v[68:71], v0, s[4:7], s61 offen offset:1024
v_and_b32 v34, 0xffffff7f, v0
v_and_or_b32 v34, v1, 8, v34
s_waitcnt lgkmcnt(1)
v_mfma_f32_16x16x32_bf16 v[48:51], v[48:51], v[24:27], 0
v_cvt_pk_bf16_f32 v32, v36, v37
s_waitcnt lgkmcnt(0)
v_mfma_f32_16x16x32_bf16 v[48:51], v[52:55], v[28:31], v[48:51]
v_mov_b64 v[52:53], s[56:57]
v_cvt_pk_bf16_f32 v33, v38, v39
v_smfmac_f32_16x16x64_bf16 v[44:47], v[4:7], v[152:159], v1
ds_write_b64 v34, v[32:33] offset:2176
v_permlane32_swap_b32 v48, v50
v_permlane32_swap_b32 v49, v51
v_add_f32_dpp v52, v50, v48 row_ror:8 row_mask:0xf bank_mask:0x3
v_exp_f32 v52, v52
v_add_f32_dpp v53, v51, v49 row_ror:8 row_mask:0xf bank_mask:0x3
v_exp_f32 v53, v53
s_nop 0
v_cvt_pk_bf16_f32 v48, v52, v53
v_smfmac_f32_16x16x64_bf16 v[44:47], v[16:19], v[120:127], v1
ds_write_b32 v0, v48 offset:4100
v_smfmac_f32_16x16x64_bf16 v[44:47], v[12:15], v[168:175], v1
buffer_load_dwordx4 v[48:51], v0, s[4:7], s61 offen offset:2048
v_smfmac_f32_16x16x64_bf16 v[40:43], v[12:15], v[160:167], v1
s_waitcnt lgkmcnt(1)
v_xor_b32 v12, 0x80, v0
v_smfmac_f32_16x16x64_bf16 v[40:43], v[8:11], v[128:135], v1
s_waitcnt lgkmcnt(0)
s_barrier
ds_read_b128 v[32:35], v0 offset:2048
v_mov_b64 v[22:23], s[52:53]
v_smfmac_f32_16x16x64_bf16 v[40:43], v[16:19], v[112:119], v1
ds_read_b128 v[36:39], v0 offset:3072
ds_read_b128 v[16:19], v0 offset:4096
buffer_load_dwordx4 v[52:55], v0, s[4:7], s61 offen offset:3072
v_smfmac_f32_16x16x64_bf16 v[44:47], v[8:11], v[136:143], v1
ds_read_b128 v[12:15], v12 offset:4096
v_cvt_pk_bf16_f32 v40, v40, v41
v_mov_b64 v[20:21], s[52:53]
s_waitcnt lgkmcnt(3)
v_mfma_f32_16x16x32_bf16 v[24:27], v[32:35], v[24:27], 0
v_cvt_pk_bf16_f32 v41, v42, v43
s_waitcnt lgkmcnt(2)
v_mfma_f32_16x16x32_bf16 v[24:27], v[36:39], v[28:31], v[24:27]
s_waitcnt vmcnt(5)
s_waitcnt lgkmcnt(1)
v_mfma_f32_16x16x32_bf16 v[8:11], v[56:59], v[16:19], 0
buffer_load_dwordx4 v[56:59], v0, s[4:7], s62 offen offset:0
v_mov_b64 v[28:29], s[56:57]
v_cvt_pk_bf16_f32 v43, v46, v47
v_cvt_pk_bf16_f32 v42, v44, v45
v_permlane32_swap_b32 v25, v27
v_permlane32_swap_b32 v24, v26
v_mfma_f32_16x16x32_bf16 v[4:7], v[20:23], v[16:19], 0
s_waitcnt lgkmcnt(0)
v_add_f32_dpp v28, v26, v24 row_ror:8 row_mask:0xf bank_mask:0x3
v_add_f32_dpp v29, v27, v25 row_ror:8 row_mask:0xf bank_mask:0x3
v_exp_f32 v28, v28
v_mfma_f32_16x16x32_bf16 v[8:11], v[60:63], v[12:15], v[8:11]
buffer_load_dwordx4 v[60:63], v0, s[4:7], s62 offen offset:1024
v_exp_f32 v29, v29
v_permlane32_swap_b32 v42, v43
v_cvt_pk_bf16_f32 v24, v28, v29
v_mov_b64 v[44:45], s[54:55]
v_cvt_pk_bf16_f32 v25, v28, v29
v_mov_b32_dpp v26, v24 row_ror:8 row_mask:0xf bank_mask:0xf
v_mov_b32_dpp v27, v24 row_ror:8 row_mask:0xf bank_mask:0xf
v_mfma_f32_16x16x16_bf16 v[4:7], v[44:45], v[24:25], v[4:7]
v_permlane32_swap_b32 v40, v41
v_mov_b64 v[36:37], 0
v_mov_b64 v[38:39], 0
v_mov_b64 v[30:31], 0
v_mfma_f32_16x16x32_bf16 v[8:11], v[40:43], v[24:27], v[8:11]
buffer_load_dwordx4 v[16:19], v0, s[4:7], s62 offen offset:2048
v_rcp_f32 v6, v4
v_and_b32 v12, 0xffffff7f, v0
v_and_or_b32 v13, v1, 8, v12
v_rcp_f32_dpp v6, v4 row_ror:8 row_mask:0xf bank_mask:0xc
v_mov_b64 v[26:27], 0
v_pk_mul_f32 v[8:9], v[8:9], v[6:7] op_sel_hi:[1,0]
v_cvt_pk_bf16_f32 v44, v8, v9
v_pk_mul_f32 v[10:11], v[10:11], v[6:7] op_sel_hi:[1,0]
v_cvt_pk_bf16_f32 v45, v10, v11
s_waitcnt vmcnt(5)
ds_write_b64 v13, v[44:45] offset:6272
buffer_load_dwordx4 v[20:23], v0, s[4:7], s62 offen offset:3072
v_add_u32 v6, 0xd4800000, v6
v_cmp_lt_u32 vcc, 0x28000000, v6
v_mov_b64 v[34:35], 0
v_mov_b32_dpp v46, v44 row_ror:8 row_mask:0xf bank_mask:0xf
v_mov_b32_dpp v47, v45 row_ror:8 row_mask:0xf bank_mask:0xf
v_mov_b64 v[28:29], 0
v_mov_b64 v[32:33], 0
s_cbranch_vccnz k_slow_211
k_okS_212:
v_smfmac_f32_16x16x64_bf16 v[36:39], v[44:47], v[224:231], v1
s_waitcnt lgkmcnt(0)
s_barrier
ds_read_b128 v[8:11], v12 offset:7296
v_smfmac_f32_16x16x64_bf16 v[32:35], v[44:47], v[200:207], v1
s_waitcnt vmcnt(4)
ds_read_b128 v[4:7], v12 offset:7168
v_mov_b64 v[24:25], 0
v_smfmac_f32_16x16x64_bf16 v[28:31], v[44:47], v[48:55], v1
ds_read_b128 v[12:15], v12 offset:6144
ds_read_b128 v[48:51], v2 offset:28672
v_smfmac_f32_16x16x64_bf16 v[24:27], v[44:47], v[64:71], v1
ds_read_b128 v[52:55], v2 offset:29696
v_mov_b64 v[42:43], 0
s_waitcnt lgkmcnt(4)
v_smfmac_f32_16x16x64_bf16 v[24:27], v[8:11], v[184:191], v1
s_waitcnt lgkmcnt(3)
v_mov_b64 v[40:41], 0
v_smfmac_f32_16x16x64_bf16 v[24:27], v[4:7], v[176:183], v1
s_waitcnt lgkmcnt(2)
ds_read_b128 v[64:67], v2 offset:63488
v_smfmac_f32_16x16x64_bf16 v[24:27], v[12:15], v[192:199], v1
ds_read_b128 v[68:71], v2 offset:64512
v_smfmac_f32_16x16x64_bf16 v[40:43], v[44:47], v[240:247], v1
s_waitcnt vmcnt(2)
s_waitcnt lgkmcnt(2)
v_lshrrev_b32 v44, 16, v1
v_cvt_pk_bf16_f32 v24, v24, v25
v_bfi_b32 v24, 1, s45, v24
v_cvt_pk_bf16_f32 v25, v26, v27
v_smfmac_f32_16x16x64_bf16 v[28:31], v[8:11], v[48:55], v1
buffer_store_dwordx2 v[24:25], v44, s[4:7], s38 offen sc1
ds_read_b128 v[48:51], v2 offset:34816
ds_read_b128 v[52:55], v2 offset:35840
v_smfmac_f32_16x16x64_bf16 v[28:31], v[12:15], v[56:63], v1
s_waitcnt lgkmcnt(2)
ds_read_b128 v[56:59], v2 offset:59392
v_smfmac_f32_16x16x64_bf16 v[28:31], v[4:7], v[64:71], v1
ds_read_b128 v[60:63], v2 offset:60416
v_smfmac_f32_16x16x64_bf16 v[32:35], v[8:11], v[208:215], v1
ds_read_b128 v[64:67], v2 offset:32768
s_nop 0
v_cvt_pk_bf16_f32 v28, v28, v29
v_bfi_b32 v28, 1, s45, v28
v_cvt_pk_bf16_f32 v29, v30, v31
v_smfmac_f32_16x16x64_bf16 v[32:35], v[12:15], v[216:223], v1
buffer_store_dwordx2 v[28:29], v44, s[4:7], s39 offen sc1
v_smfmac_f32_16x16x64_bf16 v[40:43], v[12:15], v[248:255], v1
ds_read_b128 v[68:71], v2 offset:33792
s_waitcnt vmcnt(2)
v_smfmac_f32_16x16x64_bf16 v[32:35], v[4:7], v[16:23], v1
s_waitcnt lgkmcnt(2)
v_smfmac_f32_16x16x64_bf16 v[36:39], v[12:15], v[232:239], v1
ds_read_b128 v[16:19], v2 offset:61440
ds_read_b128 v[20:23], v2 offset:62464
v_cvt_pk_bf16_f32 v32, v32, v33
v_bfi_b32 v32, 1, s45, v32
v_cvt_pk_bf16_f32 v33, v34, v35
v_smfmac_f32_16x16x64_bf16 v[36:39], v[8:11], v[48:55], v1
buffer_store_dwordx2 v[32:33], v44, s[4:7], s40 offen sc1
s_waitcnt lgkmcnt(2)
v_smfmac_f32_16x16x64_bf16 v[36:39], v[4:7], v[64:71], v1
s_nop 6
v_cvt_pk_bf16_f32 v36, v36, v37
v_cvt_pk_bf16_f32 v37, v38, v39
s_waitcnt lgkmcnt(0)
v_bfi_b32 v36, 1, s45, v36
v_smfmac_f32_16x16x64_bf16 v[40:43], v[8:11], v[16:23], v1
buffer_store_dwordx2 v[36:37], v44, s[4:7], s41 offen sc1
v_smfmac_f32_16x16x64_bf16 v[40:43], v[4:7], v[56:63], v1
s_nop 6
v_cvt_pk_bf16_f32 v40, v40, v41
v_bfi_b32 v40, 1, s45, v40
v_cvt_pk_bf16_f32 v41, v42, v43
buffer_store_dwordx2 v[40:41], v44, s[4:7], s42 offen sc1
s_barrier
buffer_load_dwordx4 v[24:27], v0, s[4:7], s43 offen offset:0 sc1
buffer_load_dwordx4 v[28:31], v0, s[4:7], s43 offen offset:1024 sc1
buffer_load_dwordx4 v[32:35], v0, s[4:7], s43 offen offset:2048 sc1
buffer_load_dwordx4 v[36:39], v0, s[4:7], s43 offen offset:3072 sc1
buffer_load_dwordx4 v[48:51], v0, s[4:7], s60 offen offset:0
buffer_load_dwordx4 v[52:55], v0, s[4:7], s60 offen offset:1024
buffer_load_dwordx4 v[56:59], v0, s[4:7], s60 offen offset:2048
buffer_load_dwordx4 v[60:63], v0, s[4:7], s60 offen offset:3072
v_lshlrev_b32 v23, v0, s58
v_cndmask_b32 v16, 0, v23, s[12:13]
v_cndmask_b32 v17, 0, v23, s[14:15]
v_cndmask_b32 v18, 0, v23, s[16:17]
v_cndmask_b32 v19, 0, v23, s[18:19]
v_and_b32 v45, 0x30, v0
v_lshrrev_b32 v46, 8, v0
v_lshl_or_b32 v45, v46, 2, v45
v_bfe_u32 v46, v0, 6, 1
v_lshl_or_b32 v45, v46, 7, v45
v_cndmask_b32 v45, v45, 2.0, s[98:99]
v_cndmask_b32 v20, 0, v23, s[90:91]
v_cndmask_b32 v21, 0, v23, s[92:93]
v_cndmask_b32 v22, 0, v23, s[94:95]
v_cndmask_b32 v23, 0, v23, s[96:97]
s_add_u32 s33, s33, 16384
s_bitset0_b32 s33, 16
s_waitcnt vmcnt(7)
v_mfma_f32_16x16x32_bf16 v[40:43], v[24:27], v[16:19], 0
s_waitcnt vmcnt(6)
v_mfma_f32_16x16x32_bf16 v[40:43], v[28:31], v[16:19], v[40:43]
v_bitop3_b32 v46, v24, v28, s45 bitop3:0x7e
s_waitcnt vmcnt(5)
v_mfma_f32_16x16x32_bf16 v[40:43], v[32:35], v[16:19], v[40:43]
s_waitcnt vmcnt(4)
v_mfma_f32_16x16x32_bf16 v[40:43], v[36:39], v[16:19], v[40:43]
v_bitop3_b32 v47, v32, v36, s45 bitop3:0x7e
v_bitop3_b32 v46, v46, v47, 1 bitop3:0xa8
v_cmp_ne_u32 vcc, 0, v46
v_mov_b64 v[24:25], 0
v_mov_b64 v[26:27], 0
v_mov_b64 v[28:29], 0
v_mov_b64 v[30:31], 0
v_permlane32_swap_b32 v40, v41
v_permlane32_swap_b32 v42, v43
v_add_f32 v40, v40, v41
v_add_f32 v41, v42, v43
v_cvt_pk_bf16_f32 v42, v40, v41
s_cbranch_vccnz k_r1_214
k_ok1_215:
buffer_store_dword v42, v45, s[4:7], s44 offen sc1
s_barrier
buffer_load_dwordx4 v[4:7], v0, s[4:7], s33 offen offset:1024 sc1
buffer_load_dwordx4 v[8:11], v0, s[4:7], s33 offen offset:0 sc1
s_add_u32 s34, s33, 3072
s_add_u32 s35, s33, 7168
s_add_u32 s36, s36, 524288
s_add_u32 s37, s37, 10240
s_add_u32 s59, s59, 10240
v_mov_b64 v[32:33], 0
v_mov_b64 v[34:35], 0
v_mov_b64 v[36:37], 0
v_mov_b64 v[38:39], 0
v_mov_b64 v[40:41], 0
v_mov_b64 v[42:43], 0
v_mov_b64 v[44:45], 0
v_mov_b64 v[46:47], 0
s_add_u32 s44, s44, 16384
s_bitset0_b32 s44, 16
s_sub_u32 s45, s45, 1
s_add_u32 s31, s31, 1
ds_read_b128 v[64:67], v0 offset:24576
ds_read_b128 v[68:71], v0 offset:25600
buffer_load_dwordx4 v[12:15], v0, s[4:7], s34 offen offset:0 sc1
s_cmp_lg_u32 s31, s47
s_cbranch_scc1 k_T0_203
s_branch k_done_213
k_cold2_205:
s_barrier
buffer_load_dwordx4 v[48:51], v0, s[4:7], s60 offen offset:0
buffer_load_dwordx4 v[52:55], v0, s[4:7], s60 offen offset:1024
buffer_load_dwordx4 v[56:59], v0, s[4:7], s60 offen offset:2048
buffer_load_dwordx4 v[60:63], v0, s[4:7], s60 offen offset:3072
ds_read_b128 v[64:67], v0 offset:24576
ds_read_b128 v[68:71], v0 offset:25600
k_cold_204:
buffer_load_dwordx4 v[4:7], v0, s[4:7], s33 offen offset:1024 sc1
buffer_load_dwordx4 v[8:11], v0, s[4:7], s33 offen offset:0 sc1
buffer_load_dwordx4 v[12:15], v0, s[4:7], s34 offen offset:0 sc1
s_sub_u32 s32, s32, 1
s_cmp_gt_i32 s32, 0
s_cbranch_scc0 k_okC_206
v_mov_b64 v[24:25], 0
v_mov_b64 v[26:27], 0
v_mov_b64 v[28:29], 0
v_mov_b64 v[30:31], 0
v_mov_b64 v[32:33], 0
v_mov_b64 v[34:35], 0
v_mov_b64 v[36:37], 0
v_mov_b64 v[38:39], 0
v_mov_b64 v[40:41], 0
v_mov_b64 v[42:43], 0
v_mov_b64 v[44:45], 0
v_mov_b64 v[46:47], 0
s_branch k_T0_203
k_coldA_207:
buffer_load_dwordx4 v[12:15], v0, s[4:7], s34 offen offset:0 sc1
s_sub_u32 s32, s32, 1
s_cmp_gt_i32 s32, 0
s_waitcnt vmcnt(0)
v_cmp_u_f32 vcc, v12, v12
ds_write_b128 v0, v[12:15] offset:1024
s_waitcnt lgkmcnt(0)
s_cbranch_vccz k_okA_208
s_cbranch_scc1 k_coldA_207
s_branch k_okA_208
k_coldB_209:
buffer_load_dwordx4 v[16:19], v0, s[4:7], s35 offen offset:0 sc1
s_sub_u32 s32, s32, 1
s_cmp_gt_i32 s32, 0
s_waitcnt vmcnt(0)
v_cmp_u_f32 vcc, v16, v16
ds_write_b128 v0, v[16:19] offset:5120
s_waitcnt lgkmcnt(0)
s_cbranch_vccz k_okB_210
s_cbranch_scc1 k_coldB_209
s_branch k_okB_210
k_r1_214:
buffer_load_dwordx4 v[24:27], v0, s[4:7], s43 offen offset:0 sc1
buffer_load_dwordx4 v[28:31], v0, s[4:7], s43 offen offset:1024 sc1
buffer_load_dwordx4 v[32:35], v0, s[4:7], s43 offen offset:2048 sc1
buffer_load_dwordx4 v[36:39], v0, s[4:7], s43 offen offset:3072 sc1
s_sub_u32 s32, s32, 1
s_cmp_gt_i32 s32, 0
s_waitcnt vmcnt(3)
v_mfma_f32_16x16x32_bf16 v[40:43], v[24:27], v[16:19], 0
s_waitcnt vmcnt(2)
v_mfma_f32_16x16x32_bf16 v[40:43], v[28:31], v[16:19], v[40:43]
v_bitop3_b32 v46, v24, v28, s45 bitop3:0x7e
s_waitcnt vmcnt(1)
v_mfma_f32_16x16x32_bf16 v[40:43], v[32:35], v[16:19], v[40:43]
s_waitcnt vmcnt(0)
v_mfma_f32_16x16x32_bf16 v[40:43], v[36:39], v[16:19], v[40:43]
v_bitop3_b32 v47, v32, v36, s45 bitop3:0x7e
v_bitop3_b32 v46, v46, v47, 1 bitop3:0xa8
v_cmp_ne_u32 vcc, 0, v46
v_mov_b64 v[24:25], 0
v_mov_b64 v[26:27], 0
v_mov_b64 v[28:29], 0
v_mov_b64 v[30:31], 0
v_permlane32_swap_b32 v40, v41
v_permlane32_swap_b32 v42, v43
v_add_f32 v40, v40, v41
v_add_f32 v41, v42, v43
v_cvt_pk_bf16_f32 v42, v40, v41
s_cbranch_vccz k_ok1_215
s_cbranch_scc1 k_r1_214
s_branch k_ok1_215
k_slow_211:
ds_read_b128 v[24:27], v0 offset:0
ds_read_b128 v[28:31], v0 offset:1024
v_mov_b32 v46, 0xff7fffff
s_add_u32 s48, s36, 0xfffff000
buffer_load_dwordx4 v[32:35], v0, s[4:7], s48 offen offset:0 sc1
buffer_load_dwordx4 v[36:39], v0, s[4:7], s48 offen offset:1024 sc1
s_waitcnt vmcnt(1) lgkmcnt(1)
v_mfma_f32_16x16x32_bf16 v[4:7], v[32:35], v[24:27], 0
s_waitcnt vmcnt(0) lgkmcnt(0)
v_mfma_f32_16x16x32_bf16 v[4:7], v[36:39], v[28:31], v[4:7]
v_mov_b64 v[8:9], s[56:57]
s_nop 5
v_permlane32_swap_b32 v4, v6
v_permlane32_swap_b32 v5, v7
v_add_f32_dpp v8, v6, v4 row_ror:8 row_mask:0xf bank_mask:0x3
s_nop 0
v_add_f32_dpp v9, v7, v5 row_ror:8 row_mask:0xf bank_mask:0x3
v_max3_f32 v46, v46, v8, v9
s_add_u32 s48, s36, 0x0
buffer_load_dwordx4 v[32:35], v0, s[4:7], s48 offen offset:0 sc1
buffer_load_dwordx4 v[36:39], v0, s[4:7], s48 offen offset:1024 sc1
s_waitcnt vmcnt(1)
v_mfma_f32_16x16x32_bf16 v[4:7], v[32:35], v[24:27], 0
s_waitcnt vmcnt(0)
v_mfma_f32_16x16x32_bf16 v[4:7], v[36:39], v[28:31], v[4:7]
v_mov_b64 v[10:11], s[56:57]
s_nop 5
v_permlane32_swap_b32 v4, v6
v_permlane32_swap_b32 v5, v7
v_add_f32_dpp v10, v6, v4 row_ror:8 row_mask:0xf bank_mask:0x3
s_nop 0
v_add_f32_dpp v11, v7, v5 row_ror:8 row_mask:0xf bank_mask:0x3
v_max3_f32 v46, v46, v10, v11
s_add_u32 s48, s36, 0x1000
buffer_load_dwordx4 v[32:35], v0, s[4:7], s48 offen offset:0 sc1
buffer_load_dwordx4 v[36:39], v0, s[4:7], s48 offen offset:1024 sc1
s_waitcnt vmcnt(1)
v_mfma_f32_16x16x32_bf16 v[4:7], v[32:35], v[24:27], 0
s_waitcnt vmcnt(0)
v_mfma_f32_16x16x32_bf16 v[4:7], v[36:39], v[28:31], v[4:7]
v_mov_b64 v[12:13], s[56:57]
s_nop 5
v_permlane32_swap_b32 v4, v6
v_permlane32_swap_b32 v5, v7
v_add_f32_dpp v12, v6, v4 row_ror:8 row_mask:0xf bank_mask:0x3
s_nop 0
v_add_f32_dpp v13, v7, v5 row_ror:8 row_mask:0xf bank_mask:0x3
v_max3_f32 v46, v46, v12, v13
s_add_u32 s48, s36, 0x2000
buffer_load_dwordx4 v[32:35], v0, s[4:7], s48 offen offset:0 sc1
buffer_load_dwordx4 v[36:39], v0, s[4:7], s48 offen offset:1024 sc1
s_waitcnt vmcnt(1)
v_mfma_f32_16x16x32_bf16 v[4:7], v[32:35], v[24:27], 0
s_waitcnt vmcnt(0)
v_mfma_f32_16x16x32_bf16 v[4:7], v[36:39], v[28:31], v[4:7]
v_mov_b64 v[14:15], s[56:57]
s_nop 5
v_permlane32_swap_b32 v4, v6
v_permlane32_swap_b32 v5, v7
v_add_f32_dpp v14, v6, v4 row_ror:8 row_mask:0xf bank_mask:0x3
s_nop 0
v_add_f32_dpp v15, v7, v5 row_ror:8 row_mask:0xf bank_mask:0x3
v_max3_f32 v46, v46, v14, v15
ds_read_b128 v[32:35], v0 offset:2048
ds_read_b128 v[36:39], v0 offset:3072
s_waitcnt lgkmcnt(1)
v_mfma_f32_16x16x32_bf16 v[4:7], v[32:35], v[24:27], 0
s_waitcnt lgkmcnt(0)
v_mfma_f32_16x16x32_bf16 v[4:7], v[36:39], v[28:31], v[4:7]
v_mov_b64 v[44:45], s[56:57]
s_nop 5
v_permlane32_swap_b32 v4, v6
v_permlane32_swap_b32 v5, v7
v_add_f32_dpp v44, v6, v4 row_ror:8 row_mask:0xf bank_mask:0x3
s_nop 0
v_add_f32_dpp v45, v7, v5 row_ror:8 row_mask:0xf bank_mask:0x3
v_max3_f32 v46, v46, v44, v45
buffer_load_dwordx4 v[32:35], v0, s[4:7], s36 offen offset:2048 sc1
buffer_load_dwordx4 v[36:39], v0, s[4:7], s36 offen offset:3072 sc1
v_mov_b32 v47, v46
s_nop 1
v_permlane32_swap_b32 v46, v47
v_max_f32 v46, v46, v47
v_mov_b32 v47, v46
s_nop 1
v_permlane16_swap_b32 v46, v47
v_max_f32 v46, v46, v47
v_sub_f32 v8, v8, v46
v_exp_f32 v8, v8
v_sub_f32 v9, v9, v46
v_exp_f32 v9, v9
v_sub_f32 v10, v10, v46
v_exp_f32 v10, v10
v_sub_f32 v11, v11, v46
v_exp_f32 v11, v11
v_sub_f32 v12, v12, v46
v_exp_f32 v12, v12
v_sub_f32 v13, v13, v46
v_exp_f32 v13, v13
v_sub_f32 v14, v14, v46
v_exp_f32 v14, v14
v_sub_f32 v15, v15, v46
v_exp_f32 v15, v15
v_sub_f32 v44, v44, v46
v_exp_f32 v44, v44
v_sub_f32 v45, v45, v46
v_exp_f32 v45, v45
v_cvt_pk_bf16_f32 v4, v8, v9
v_cvt_pk_bf16_f32 v5, v10, v11
v_cvt_pk_bf16_f32 v6, v12, v13
v_cvt_pk_bf16_f32 v7, v14, v15
v_mov_b32_dpp v8, v4 row_ror:8 row_mask:0xf bank_mask:0xf
v_mov_b32_dpp v9, v5 row_ror:8 row_mask:0xf bank_mask:0xf
v_mov_b32_dpp v10, v6 row_ror:8 row_mask:0xf bank_mask:0xf
v_mov_b32_dpp v11, v7 row_ror:8 row_mask:0xf bank_mask:0xf
v_cvt_pk_bf16_f32 v24, v44, v45
v_cvt_pk_bf16_f32 v25, v44, v45
s_nop 0
v_mov_b32_dpp v26, v24 row_ror:8 row_mask:0xf bank_mask:0xf
v_mov_b32_dpp v27, v24 row_ror:8 row_mask:0xf bank_mask:0xf
v_mov_b64 v[28:29], s[52:53]
v_mov_b64 v[30:31], s[52:53]
s_nop 1
v_mfma_f32_16x16x32_bf16 v[44:47], v[28:31], v[4:7], 0
s_waitcnt vmcnt(1)
v_mfma_f32_16x16x32_bf16 v[12:15], v[32:35], v[4:7], 0
s_waitcnt vmcnt(0)
v_mfma_f32_16x16x32_bf16 v[12:15], v[36:39], v[8:11], v[12:15]
v_mfma_f32_16x16x32_bf16 v[12:15], v[40:43], v[24:27], v[12:15]
v_mov_b64 v[28:29], s[54:55]
s_nop 1
v_mfma_f32_16x16x16_bf16 v[44:47], v[28:29], v[24:25], v[44:47]
s_nop 6
v_rcp_f32 v4, v44
s_nop 1
v_rcp_f32_dpp v4, v44 row_ror:8 row_mask:0xf bank_mask:0xc
s_nop 0
v_mul_f32 v12, v4, v12
v_mul_f32 v13, v4, v13
v_mul_f32 v14, v4, v14
v_mul_f32 v15, v4, v15
v_cvt_pk_bf16_f32 v44, v12, v13
v_cvt_pk_bf16_f32 v45, v14, v15
v_and_b32 v12, 0xffffff7f, v0
v_and_or_b32 v8, v1, 8, v12
ds_write_b64 v8, v[44:45] offset:6272
v_mov_b32_dpp v46, v44 row_ror:8 row_mask:0xf bank_mask:0xf
v_mov_b32_dpp v47, v45 row_ror:8 row_mask:0xf bank_mask:0xf
v_mov_b64 v[24:25], 0
v_mov_b64 v[26:27], 0
v_mov_b64 v[28:29], 0
v_mov_b64 v[30:31], 0
v_mov_b64 v[32:33], 0
v_mov_b64 v[34:35], 0
v_mov_b64 v[36:37], 0
v_mov_b64 v[38:39], 0
s_waitcnt lgkmcnt(0)
s_branch k_okS_212
k_done_213:
buffer_load_dwordx4 v[16:19], v0, s[4:7], s35 offen offset:0 sc1
k_xs_219:
s_waitcnt vmcnt(1)
v_cmp_u_f32 vcc, v4, v12
s_waitcnt vmcnt(0)
v_cmp_u_f32 s[66:67], v16, v16
s_or_b64 vcc, vcc, s[66:67]
s_cbranch_vccz k_xd_220
buffer_load_dwordx4 v[4:7], v0, s[4:7], s33 offen offset:1024 sc1
buffer_load_dwordx4 v[8:11], v0, s[4:7], s33 offen offset:0 sc1
buffer_load_dwordx4 v[12:15], v0, s[4:7], s34 offen offset:0 sc1
buffer_load_dwordx4 v[16:19], v0, s[4:7], s35 offen offset:0 sc1
s_sub_u32 s32, s32, 1
s_cmp_gt_i32 s32, 0
s_cbranch_scc1 k_xs_219
k_xd_220:
s_waitcnt vmcnt(3)
buffer_store_dwordx4 v[4:7], v0, s[8:11], s37 offen offset:0 sc1
s_waitcnt vmcnt(2)
buffer_store_dwordx4 v[12:15], v0, s[8:11], s37 offen offset:2048 sc1
s_waitcnt vmcnt(2)
buffer_store_dwordx4 v[16:19], v0, s[8:11], s59 offen offset:2048 sc1
s_add_u32 s31, s31, 1
k_jn_184:
s_cmp_lt_u32 s31, 128
s_cbranch_scc1 k_lay_175
s_add_u32 s30, s30, 112
s_waitcnt vmcnt(0) lgkmcnt(0)
s_barrier
s_branch k_fin_7
k_w2_127:
v_lshlrev_b32 v0, 4, v0
s_mov_b32 s90, 0x300003
s_mov_b32 s91, 0x300003
s_mov_b32 s92, 0xc0000c
s_mov_b32 s93, 0xc0000c
s_mov_b32 s94, 0x30000300
s_mov_b32 s95, 0x30000300
s_mov_b32 s96, 0xc0000c00
s_mov_b32 s97, 0xc0000c00
s_mov_b32 s98, 0xff00ff00
s_mov_b32 s99, 0xff00ff00
v_mov_b32 v1, 0x4444
v_mov_b32 v4, 0xeeee
v_cndmask_b32 v1, v1, v4, s[98:99]
v_lshrrev_b32 v4, 8, v0
v_lshl_or_b32 v1, v4, 28, v1
v_bfe_u32 v4, v0, 4, 4
v_lshl_or_b32 v1, v4, 19, v1
s_mov_b32 s51, 0x3e0293ee
s_mov_b32 s52, 0x3f803f80
s_mov_b32 s53, 0x3f803f80
s_mov_b32 s54, 0x3f003f00
s_mov_b32 s55, 0x3f003f00
s_mov_b32 s56, 0xff800000
s_mov_b32 s57, 0xff800000
s_mov_b32 s58, 0x3f80
s_mov_b32 s31, 0
s_mov_b32 s45, -2
s_lshl_b32 s46, s30, 6
s_add_u32 s46, s46, 222330880
s_lshl_b32 s48, s30, 7
s_and_b32 s49, s30, 31
s_lshl_b32 s49, s49, 12
s_add_u32 s43, s49, 119734272
v_mov_b64 v[12:13], -1
s_add_u32 s38, s48, 119570432
s_add_u32 s39, s48, 119635968
s_add_u32 s40, s48, 119701504
s_add_u32 s41, s48, 119767040
s_add_u32 s42, s48, 119832576
v_lshrrev_b32 v4, 16, v1
buffer_store_dwordx2 v[12:13], v4, s[4:7], s38 offen sc1
buffer_store_dwordx2 v[12:13], v4, s[4:7], s39 offen sc1
buffer_store_dwordx2 v[12:13], v4, s[4:7], s40 offen sc1
buffer_store_dwordx2 v[12:13], v4, s[4:7], s41 offen sc1
buffer_store_dwordx2 v[12:13], v4, s[4:7], s42 offen sc1
s_add_u32 s47, s31, 63
s_mul_i32 s33, s31, 0
s_add_u32 s33, s33, 120324096
s_add_u32 s34, s33, 4096
s_add_u32 s35, s33, 8192
s_mul_i32 s48, s31, 655360
s_lshl_b32 s36, s30, 14
s_add_u32 s36, s36, s48
s_add_u32 s36, s36, 8192
v_mov_b32 v36, -1
s_and_b32 s48, s30, 31
s_add_u32 s48, s48, 48
s_lshr_b32 s49, s48, 1
s_and_b32 s48, s48, 1
s_lshl_b32 s44, s49, 8
s_lshl_b32 s50, s48, 6
s_add_u32 s44, s44, s50
s_add_u32 s44, s44, s33
s_mul_i32 s48, s48, 5120
s_lshl_b32 s49, s49, 5
s_add_u32 s48, s48, s49
v_lshrrev_b32 v32, 4, v0
v_and_b32 v33, 3, v32
v_mul_u32_u24 v33, 1280, v33
v_bfe_u32 v34, v32, 2, 1
v_lshl_add_u32 v33, v34, 1, v33
v_bfe_u32 v34, v32, 4, 1
v_lshl_add_u32 v33, v34, 4, v33
v_bfe_u32 v34, v32, 5, 1
v_lshl_add_u32 v33, v34, 2, v33
buffer_load_ushort v34, v33, s[24:27], s48 offen
buffer_load_ushort v35, v33, s[24:27], s48 offen offset:8
v_and_b32 v45, 0x30, v0
v_lshrrev_b32 v46, 8, v0
v_lshl_or_b32 v45, v46, 2, v45
v_bfe_u32 v46, v0, 6, 1
v_lshl_or_b32 v45, v46, 7, v45
v_cndmask_b32 v45, v45, 2.0, s[98:99]
s_lshl_b32 s63, s30, 10
s_add_u32 s63, s63, 0x8000
s_add_u32 s63, s63, s33
s_lshl_b32 s37, s31, 14
s_add_u32 s37, s37, 117442560
s_add_u32 s59, s37, 4096
v_lshrrev_b32 v0, 4, v0
v_lshrrev_b32 v12, 3, v0
v_lshlrev_b32 v10, 13, v12
v_bfe_u32 v12, v0, 1, 2
v_lshrrev_b32 v13, 4, v0
v_xor_b32 v12, v12, v13
v_lshl_add_u32 v10, v12, 5, v10
v_and_b32 v14, 1, v0
v_lshl_add_u32 v10, v14, 4, v10
v_mul_u32_u24 v11, 1280, v13
v_bfe_u32 v12, v0, 1, 3
v_and_b32 v13, 1, v13
v_lshlrev_b32 v13, 1, v13
v_xor_b32 v12, v12, v13
v_xor_b32 v12, 4, v12
v_lshl_add_u32 v11, v12, 5, v11
v_lshl_add_u32 v11, v14, 4, v11
v_bfe_u32 v12, v0, 5, 1
v_lshlrev_b32 v12, 4, v12
v_bfe_u32 v13, v0, 4, 1
v_lshl_add_u32 v12, v13, 1, v12
v_bfe_u32 v13, v0, 2, 1
v_lshl_add_u32 v12, v13, 2, v12
v_bfe_u32 v13, v0, 3, 1
v_mul_u32_u24 v15, 4224, v13
v_add_u32 v12, v13, v12
v_bfe_u32 v13, v12, 1, 2
v_xor_b32 v13, 2, v13
v_lshlrev_b32 v13, 5, v13
v_lshl_add_u32 v4, v12, 7, v13
v_and_b32 v14, 3, v0
v_lshl_add_u32 v4, v14, 3, v4
v_add_u32 v5, 0x10000, v4
v_add_u32 v6, 0x20000, v4
v_bfe_u32 v12, v0, 4, 1
v_lshlrev_b32 v13, 4, v12
v_lshlrev_b32 v12, 2, v12
v_bfe_u32 v8, v0, 5, 1
v_lshl_add_u32 v13, v8, 2, v13
v_bfe_u32 v8, v0, 2, 1
v_add_u32 v13, v8, v13
v_lshl_add_u32 v12, v8, 1, v12
v_bfe_u32 v8, v0, 3, 1
v_add_u32 v8, 4, v8
v_xor_b32 v12, v12, v8
v_lshlrev_b32 v12, 5, v12
v_lshl_add_u32 v7, v13, 8, v12
v_lshl_add_u32 v7, v14, 3, v7
v_add_u32 v8, 0x10000, v7
v_add_u32 v9, 0x20000, v7
v_lshlrev_b32 v0, 4, v0
v_add_u32 v2, 65536, v0
s_lshl_b32 s49, s30, 8
s_mul_i32 s50, s30, 163840
s_mul_i32 s60, s30, 131072
s_add_u32 s60, s60, 120651776
s_add_u32 s61, s60, 4096
s_add_u32 s62, s60, 8192
s_mov_b32 m0, 4096
s_add_u32 s48, s49, 262144
buffer_load_dwordx4 v10, s[8:11], s48 offen lds
s_mov_b32 m0, 5120
s_add_u32 s48, s49, 327680
buffer_load_dwordx4 v10, s[8:11], s48 offen lds
s_mov_b32 m0, 12288
s_add_u32 s48, s49, 262272
buffer_load_dwordx4 v10, s[8:11], s48 offen lds
s_mov_b32 m0, 13312
s_add_u32 s48, s49, 327808
buffer_load_dwordx4 v10, s[8:11], s48 offen lds
s_mov_b32 m0, 20480
s_add_u32 s48, s49, 262272
buffer_load_dwordx4 v10, s[12:15], s48 offen lds
s_mov_b32 m0, 21504
s_add_u32 s48, s49, 327808
buffer_load_dwordx4 v10, s[12:15], s48 offen lds
s_mov_b32 m0, 28672
s_add_u32 s48, s49, 262144
buffer_load_dwordx4 v10, s[16:19], s48 offen lds
s_mov_b32 m0, 29696
s_add_u32 s48, s49, 327680
buffer_load_dwordx4 v10, s[16:19], s48 offen lds
s_mov_b32 m0, 36864
s_add_u32 s48, s49, 262272
buffer_load_dwordx4 v10, s[16:19], s48 offen lds
s_mov_b32 m0, 37888
s_add_u32 s48, s49, 327808
buffer_load_dwordx4 v10, s[16:19], s48 offen lds
s_mov_b32 m0, 45056
s_add_u32 s48, s49, 786432
buffer_load_dwordx4 v10, s[8:11], s48 offen lds
s_mov_b32 m0, 46080
s_add_u32 s48, s49, 851968
buffer_load_dwordx4 v10, s[8:11], s48 offen lds
s_mov_b32 m0, 53248
s_add_u32 s48, s49, 786560
buffer_load_dwordx4 v10, s[8:11], s48 offen lds
s_mov_b32 m0, 54272
s_add_u32 s48, s49, 852096
buffer_load_dwordx4 v10, s[8:11], s48 offen lds
s_mov_b32 m0, 61440
s_add_u32 s48, s49, 786560
buffer_load_dwordx4 v10, s[12:15], s48 offen lds
s_mov_b32 m0, 62464
s_add_u32 s48, s49, 852096
buffer_load_dwordx4 v10, s[12:15], s48 offen lds
s_mov_b32 m0, 69632
s_add_u32 s48, s49, 786432
buffer_load_dwordx4 v10, s[16:19], s48 offen lds
s_mov_b32 m0, 70656
s_add_u32 s48, s49, 851968
buffer_load_dwordx4 v10, s[16:19], s48 offen lds
s_mov_b32 m0, 77824
s_add_u32 s48, s49, 786560
buffer_load_dwordx4 v10, s[16:19], s48 offen lds
s_mov_b32 m0, 78848
s_add_u32 s48, s49, 852096
buffer_load_dwordx4 v10, s[16:19], s48 offen lds
s_mov_b32 m0, 86016
s_add_u32 s48, s49, 1310720
buffer_load_dwordx4 v10, s[8:11], s48 offen lds
s_mov_b32 m0, 87040
s_add_u32 s48, s49, 1376256
buffer_load_dwordx4 v10, s[8:11], s48 offen lds
s_mov_b32 m0, 94208
s_add_u32 s48, s49, 1310848
buffer_load_dwordx4 v10, s[8:11], s48 offen lds
s_mov_b32 m0, 95232
s_add_u32 s48, s49, 1376384
buffer_load_dwordx4 v10, s[8:11], s48 offen lds
s_mov_b32 m0, 102400
s_add_u32 s48, s49, 1310848
buffer_load_dwordx4 v10, s[12:15], s48 offen lds
s_mov_b32 m0, 103424
s_add_u32 s48, s49, 1376384
buffer_load_dwordx4 v10, s[12:15], s48 offen lds
s_mov_b32 m0, 110592
s_add_u32 s48, s49, 1310720
buffer_load_dwordx4 v10, s[16:19], s48 offen lds
s_mov_b32 m0, 111616
s_add_u32 s48, s49, 1376256
buffer_load_dwordx4 v10, s[16:19], s48 offen lds
s_mov_b32 m0, 118784
s_add_u32 s48, s49, 1835008
buffer_load_dwordx4 v10, s[8:11], s48 offen lds
s_mov_b32 m0, 119808
s_add_u32 s48, s49, 1900544
buffer_load_dwordx4 v10, s[8:11], s48 offen lds
s_mov_b32 m0, 126976
s_add_u32 s48, s49, 1835136
buffer_load_dwordx4 v10, s[8:11], s48 offen lds
s_mov_b32 m0, 128000
s_add_u32 s48, s49, 1900672
buffer_load_dwordx4 v10, s[8:11], s48 offen lds
s_waitcnt vmcnt(32)
v_lshl_or_b32 v34, v35, 16, v34
buffer_store_dword v34, v45, s[4:7], s44 offen sc1
s_add_u32 s44, s44, 16384
buffer_store_dword v36, v45, s[4:7], s44 offen sc1
s_waitcnt vmcnt(26)
s_barrier
s_mov_b32 m0, 135168
s_add_u32 s48, s49, 1835136
buffer_load_dwordx4 v10, s[12:15], s48 offen lds
s_mov_b32 m0, 136192
s_add_u32 s48, s49, 1900672
buffer_load_dwordx4 v10, s[12:15], s48 offen lds
s_mov_b32 m0, 143360
s_add_u32 s48, s49, 1835008
buffer_load_dwordx4 v10, s[16:19], s48 offen lds
s_mov_b32 m0, 144384
s_add_u32 s48, s49, 1900544
buffer_load_dwordx4 v10, s[16:19], s48 offen lds
s_mov_b32 m0, 151552
s_add_u32 s48, s49, 2359296
buffer_load_dwordx4 v10, s[8:11], s48 offen lds
s_mov_b32 m0, 152576
s_add_u32 s48, s49, 2424832
buffer_load_dwordx4 v10, s[8:11], s48 offen lds
s_mov_b32 m0, 159744
s_add_u32 s48, s49, 2359424
buffer_load_dwordx4 v10, s[8:11], s48 offen lds
s_mov_b32 m0, 160768
s_add_u32 s48, s49, 2424960
buffer_load_dwordx4 v10, s[8:11], s48 offen lds
ds_read_b64_tr_b16 a[0:1], v4 offset:0
ds_read_b64_tr_b16 a[2:3], v4 offset:1024
ds_read_b64_tr_b16 a[4:5], v4 offset:4096
ds_read_b64_tr_b16 a[6:7], v4 offset:5120
ds_read_b64_tr_b16 a[8:9], v4 offset:8192
ds_read_b64_tr_b16 a[10:11], v4 offset:9216
ds_read_b64_tr_b16 a[12:13], v4 offset:12288
ds_read_b64_tr_b16 a[14:15], v4 offset:13312
ds_read_b64_tr_b16 a[16:17], v4 offset:16384
ds_read_b64_tr_b16 a[18:19], v4 offset:17408
ds_read_b64_tr_b16 a[20:21], v4 offset:20480
ds_read_b64_tr_b16 a[22:23], v4 offset:21504
ds_read_b64_tr_b16 v[40:41], v4 offset:24576
ds_read_b64_tr_b16 v[42:43], v4 offset:25600
ds_read_b64_tr_b16 v[44:45], v4 offset:28672
ds_read_b64_tr_b16 v[46:47], v4 offset:29696
s_waitcnt lgkmcnt(0)
buffer_store_dwordx4 v[40:43], v0, s[4:7], s60 offen offset:0
buffer_store_dwordx4 v[44:47], v0, s[4:7], s60 offen offset:1024
s_waitcnt vmcnt(28)
s_barrier
s_mov_b32 m0, 4096
s_add_u32 s48, s49, 2359424
buffer_load_dwordx4 v10, s[12:15], s48 offen lds
s_mov_b32 m0, 5120
s_add_u32 s48, s49, 2424960
buffer_load_dwordx4 v10, s[12:15], s48 offen lds
s_mov_b32 m0, 12288
s_add_u32 s48, s49, 2359296
buffer_load_dwordx4 v10, s[16:19], s48 offen lds
s_mov_b32 m0, 13312
s_add_u32 s48, s49, 2424832
buffer_load_dwordx4 v10, s[16:19], s48 offen lds
s_mov_b32 m0, 20480
s_add_u32 s48, s49, 2883584
buffer_load_dwordx4 v10, s[8:11], s48 offen lds
s_mov_b32 m0, 21504
s_add_u32 s48, s49, 2949120
buffer_load_dwordx4 v10, s[8:11], s48 offen lds
s_mov_b32 m0, 28672
s_add_u32 s48, s49, 2883712
buffer_load_dwordx4 v10, s[8:11], s48 offen lds
s_mov_b32 m0, 29696
s_add_u32 s48, s49, 2949248
buffer_load_dwordx4 v10, s[8:11], s48 offen lds
ds_read_b64_tr_b16 v[16:17], v4 offset:32768
ds_read_b64_tr_b16 v[18:19], v4 offset:33792
ds_read_b64_tr_b16 v[20:21], v4 offset:36864
ds_read_b64_tr_b16 v[22:23], v4 offset:37888
ds_read_b64_tr_b16 a[24:25], v4 offset:40960
ds_read_b64_tr_b16 a[26:27], v4 offset:41984
ds_read_b64_tr_b16 a[28:29], v4 offset:45056
ds_read_b64_tr_b16 a[30:31], v4 offset:46080
ds_read_b64_tr_b16 a[32:33], v4 offset:49152
ds_read_b64_tr_b16 a[34:35], v4 offset:50176
ds_read_b64_tr_b16 a[36:37], v4 offset:53248
ds_read_b64_tr_b16 a[38:39], v4 offset:54272
ds_read_b64_tr_b16 a[40:41], v4 offset:57344
ds_read_b64_tr_b16 a[42:43], v4 offset:58368
ds_read_b64_tr_b16 a[44:45], v4 offset:61440
ds_read_b64_tr_b16 a[46:47], v4 offset:62464
s_waitcnt lgkmcnt(0)
buffer_store_dwordx4 v[16:19], v0, s[4:7], s60 offen offset:2048
buffer_store_dwordx4 v[20:23], v0, s[4:7], s60 offen offset:3072
s_waitcnt vmcnt(30)
s_barrier
s_mov_b32 m0, 36864
s_add_u32 s48, s49, 2883712
buffer_load_dwordx4 v10, s[12:15], s48 offen lds
s_mov_b32 m0, 37888
s_add_u32 s48, s49, 2949248
buffer_load_dwordx4 v10, s[12:15], s48 offen lds
s_mov_b32 m0, 45056
s_add_u32 s48, s49, 2883584
buffer_load_dwordx4 v10, s[16:19], s48 offen lds
s_mov_b32 m0, 46080
s_add_u32 s48, s49, 2949120
buffer_load_dwordx4 v10, s[16:19], s48 offen lds
s_mov_b32 m0, 53248
s_add_u32 s48, s49, 3408000
buffer_load_dwordx4 v10, s[8:11], s48 offen lds
s_mov_b32 m0, 54272
s_add_u32 s48, s49, 3473536
buffer_load_dwordx4 v10, s[8:11], s48 offen lds
s_mov_b32 m0, 61440
s_add_u32 s48, s49, 3932160
buffer_load_dwordx4 v10, s[8:11], s48 offen lds
s_mov_b32 m0, 62464
s_add_u32 s48, s49, 3997696
buffer_load_dwordx4 v10, s[8:11], s48 offen lds
ds_read_b64_tr_b16 a[176:177], v5 offset:0
ds_read_b64_tr_b16 a[178:179], v5 offset:1024
ds_read_b64_tr_b16 a[180:181], v5 offset:4096
ds_read_b64_tr_b16 a[182:183], v5 offset:5120
ds_read_b64_tr_b16 v[224:225], v5 offset:8192
ds_read_b64_tr_b16 v[226:227], v5 offset:9216
ds_read_b64_tr_b16 v[228:229], v5 offset:12288
ds_read_b64_tr_b16 v[230:231], v5 offset:13312
ds_read_b64_tr_b16 a[112:113], v5 offset:16384
ds_read_b64_tr_b16 a[114:115], v5 offset:17408
ds_read_b64_tr_b16 a[116:117], v5 offset:20480
ds_read_b64_tr_b16 a[118:119], v5 offset:21504
ds_read_b64_tr_b16 a[120:121], v5 offset:24576
ds_read_b64_tr_b16 a[122:123], v5 offset:25600
ds_read_b64_tr_b16 a[124:125], v5 offset:28672
ds_read_b64_tr_b16 a[126:127], v5 offset:29696
s_waitcnt lgkmcnt(0)
s_waitcnt vmcnt(30)
s_barrier
s_mov_b32 m0, 69632
s_add_u32 s48, s49, 3932288
buffer_load_dwordx4 v10, s[8:11], s48 offen lds
s_mov_b32 m0, 70656
s_add_u32 s48, s49, 3997824
buffer_load_dwordx4 v10, s[8:11], s48 offen lds
s_mov_b32 m0, 77824
s_add_u32 s48, s49, 4456448
buffer_load_dwordx4 v10, s[8:11], s48 offen lds
s_mov_b32 m0, 78848
s_add_u32 s48, s49, 4521984
buffer_load_dwordx4 v10, s[8:11], s48 offen lds
s_mov_b32 m0, 86016
s_add_u32 s48, s49, 4456576
buffer_load_dwordx4 v10, s[8:11], s48 offen lds
s_mov_b32 m0, 87040
s_add_u32 s48, s49, 4522112
buffer_load_dwordx4 v10, s[8:11], s48 offen lds
s_mov_b32 m0, 94208
s_add_u32 s48, s49, 4980736
buffer_load_dwordx4 v10, s[8:11], s48 offen lds
s_mov_b32 m0, 95232
s_add_u32 s48, s49, 5046272
buffer_load_dwordx4 v10, s[8:11], s48 offen lds
ds_read_b64_tr_b16 a[128:129], v5 offset:32768
ds_read_b64_tr_b16 a[130:131], v5 offset:33792
ds_read_b64_tr_b16 a[132:133], v5 offset:36864
ds_read_b64_tr_b16 a[134:135], v5 offset:37888
ds_read_b64_tr_b16 a[136:137], v5 offset:40960
ds_read_b64_tr_b16 a[138:139], v5 offset:41984
ds_read_b64_tr_b16 a[140:141], v5 offset:45056
ds_read_b64_tr_b16 a[142:143], v5 offset:46080
ds_read_b64_tr_b16 a[144:145], v5 offset:49152
ds_read_b64_tr_b16 a[146:147], v5 offset:50176
ds_read_b64_tr_b16 a[148:149], v5 offset:53248
ds_read_b64_tr_b16 a[150:151], v5 offset:54272
ds_read_b64_tr_b16 a[152:153], v5 offset:57344
ds_read_b64_tr_b16 a[154:155], v5 offset:58368
ds_read_b64_tr_b16 a[156:157], v5 offset:61440
ds_read_b64_tr_b16 a[158:159], v5 offset:62464
s_waitcnt lgkmcnt(0)
s_waitcnt vmcnt(28)
s_barrier
s_mov_b32 m0, 102400
s_add_u32 s48, s49, 4980864
buffer_load_dwordx4 v10, s[8:11], s48 offen lds
s_mov_b32 m0, 103424
s_add_u32 s48, s49, 5046400
buffer_load_dwordx4 v10, s[8:11], s48 offen lds
s_mov_b32 m0, 110592
s_add_u32 s48, s49, 3407872
buffer_load_dwordx4 v10, s[12:15], s48 offen lds
s_mov_b32 m0, 111616
s_add_u32 s48, s49, 3473408
buffer_load_dwordx4 v10, s[12:15], s48 offen lds
s_mov_b32 m0, 118784
s_add_u32 s48, s49, 3408000
buffer_load_dwordx4 v10, s[12:15], s48 offen lds
s_mov_b32 m0, 119808
s_add_u32 s48, s49, 3473536
buffer_load_dwordx4 v10, s[12:15], s48 offen lds
s_mov_b32 m0, 126976
s_add_u32 s48, s49, 3932160
buffer_load_dwordx4 v10, s[12:15], s48 offen lds
s_mov_b32 m0, 128000
s_add_u32 s48, s49, 3997696
buffer_load_dwordx4 v10, s[12:15], s48 offen lds
ds_read_b64_tr_b16 a[160:161], v6 offset:0
ds_read_b64_tr_b16 a[162:163], v6 offset:1024
ds_read_b64_tr_b16 a[164:165], v6 offset:4096
ds_read_b64_tr_b16 a[166:167], v6 offset:5120
ds_read_b64_tr_b16 a[168:169], v6 offset:8192
ds_read_b64_tr_b16 a[170:171], v6 offset:9216
ds_read_b64_tr_b16 a[172:173], v6 offset:12288
ds_read_b64_tr_b16 a[174:175], v6 offset:13312
ds_read_b64_tr_b16 a[48:49], v6 offset:16384
ds_read_b64_tr_b16 a[50:51], v6 offset:17408
ds_read_b64_tr_b16 a[52:53], v6 offset:20480
ds_read_b64_tr_b16 a[54:55], v6 offset:21504
ds_read_b64_tr_b16 a[56:57], v6 offset:24576
ds_read_b64_tr_b16 a[58:59], v6 offset:25600
ds_read_b64_tr_b16 a[60:61], v6 offset:28672
ds_read_b64_tr_b16 a[62:63], v6 offset:29696
s_waitcnt lgkmcnt(0)
s_waitcnt vmcnt(26)
s_barrier
s_mov_b32 m0, 135168
s_add_u32 s48, s49, 3932288
buffer_load_dwordx4 v10, s[12:15], s48 offen lds
s_mov_b32 m0, 136192
s_add_u32 s48, s49, 3997824
buffer_load_dwordx4 v10, s[12:15], s48 offen lds
s_mov_b32 m0, 143360
s_add_u32 s48, s49, 4456448
buffer_load_dwordx4 v10, s[12:15], s48 offen lds
s_mov_b32 m0, 144384
s_add_u32 s48, s49, 4521984
buffer_load_dwordx4 v10, s[12:15], s48 offen lds
s_mov_b32 m0, 151552
s_add_u32 s48, s49, 4456576
buffer_load_dwordx4 v10, s[12:15], s48 offen lds
s_mov_b32 m0, 152576
s_add_u32 s48, s49, 4522112
buffer_load_dwordx4 v10, s[12:15], s48 offen lds
s_mov_b32 m0, 159744
s_add_u32 s48, s49, 4980736
buffer_load_dwordx4 v10, s[12:15], s48 offen lds
s_mov_b32 m0, 160768
s_add_u32 s48, s49, 5046272
buffer_load_dwordx4 v10, s[12:15], s48 offen lds
ds_read_b64_tr_b16 a[64:65], v4 offset:0
ds_read_b64_tr_b16 a[66:67], v4 offset:1024
ds_read_b64_tr_b16 a[68:69], v4 offset:4096
ds_read_b64_tr_b16 a[70:71], v4 offset:5120
ds_read_b64_tr_b16 a[72:73], v4 offset:8192
ds_read_b64_tr_b16 a[74:75], v4 offset:9216
ds_read_b64_tr_b16 a[76:77], v4 offset:12288
ds_read_b64_tr_b16 a[78:79], v4 offset:13312
ds_read_b64_tr_b16 a[80:81], v4 offset:16384
ds_read_b64_tr_b16 a[82:83], v4 offset:17408
ds_read_b64_tr_b16 a[84:85], v4 offset:20480
ds_read_b64_tr_b16 a[86:87], v4 offset:21504
ds_read_b64_tr_b16 a[88:89], v4 offset:24576
ds_read_b64_tr_b16 a[90:91], v4 offset:25600
ds_read_b64_tr_b16 a[92:93], v4 offset:28672
ds_read_b64_tr_b16 a[94:95], v4 offset:29696
s_waitcnt lgkmcnt(0)
s_waitcnt vmcnt(24)
s_barrier
s_mov_b32 m0, 4096
s_add_u32 s48, s49, 4980864
buffer_load_dwordx4 v10, s[12:15], s48 offen lds
s_mov_b32 m0, 5120
s_add_u32 s48, s49, 5046400
buffer_load_dwordx4 v10, s[12:15], s48 offen lds
s_mov_b32 m0, 12288
s_add_u32 s48, s49, 3407872
buffer_load_dwordx4 v10, s[16:19], s48 offen lds
s_mov_b32 m0, 13312
s_add_u32 s48, s49, 3473408
buffer_load_dwordx4 v10, s[16:19], s48 offen lds
s_mov_b32 m0, 20480
s_add_u32 s48, s49, 3408000
buffer_load_dwordx4 v10, s[16:19], s48 offen lds
s_mov_b32 m0, 21504
s_add_u32 s48, s49, 3473536
buffer_load_dwordx4 v10, s[16:19], s48 offen lds
s_mov_b32 m0, 28672
s_add_u32 s48, s49, 3932160
buffer_load_dwordx4 v10, s[16:19], s48 offen lds
s_mov_b32 m0, 29696
s_add_u32 s48, s49, 3997696
buffer_load_dwordx4 v10, s[16:19], s48 offen lds
ds_read_b64_tr_b16 a[96:97], v4 offset:32768
ds_read_b64_tr_b16 a[98:99], v4 offset:33792
ds_read_b64_tr_b16 a[100:101], v4 offset:36864
ds_read_b64_tr_b16 a[102:103], v4 offset:37888
ds_read_b64_tr_b16 a[104:105], v4 offset:40960
ds_read_b64_tr_b16 a[106:107], v4 offset:41984
ds_read_b64_tr_b16 a[108:109], v4 offset:45056
ds_read_b64_tr_b16 a[110:111], v4 offset:46080
ds_read_b64_tr_b16 a[216:217], v4 offset:49152
ds_read_b64_tr_b16 a[218:219], v4 offset:50176
ds_read_b64_tr_b16 a[220:221], v4 offset:53248
ds_read_b64_tr_b16 a[222:223], v4 offset:54272
ds_read_b64_tr_b16 a[224:225], v4 offset:57344
ds_read_b64_tr_b16 a[226:227], v4 offset:58368
ds_read_b64_tr_b16 a[228:229], v4 offset:61440
ds_read_b64_tr_b16 a[230:231], v4 offset:62464
s_waitcnt lgkmcnt(0)
s_waitcnt vmcnt(24)
s_barrier
s_mov_b32 m0, 36864
s_add_u32 s48, s49, 3932288
buffer_load_dwordx4 v10, s[16:19], s48 offen lds
s_mov_b32 m0, 37888
s_add_u32 s48, s49, 3997824
buffer_load_dwordx4 v10, s[16:19], s48 offen lds
s_mov_b32 m0, 45056
s_add_u32 s48, s49, 4456448
buffer_load_dwordx4 v10, s[16:19], s48 offen lds
s_mov_b32 m0, 46080
s_add_u32 s48, s49, 4521984
buffer_load_dwordx4 v10, s[16:19], s48 offen lds
s_mov_b32 m0, 53248
s_add_u32 s48, s49, 4456576
buffer_load_dwordx4 v10, s[16:19], s48 offen lds
s_mov_b32 m0, 54272
s_add_u32 s48, s49, 4522112
buffer_load_dwordx4 v10, s[16:19], s48 offen lds
s_mov_b32 m0, 61440
s_add_u32 s48, s49, 4980736
buffer_load_dwordx4 v10, s[16:19], s48 offen lds
s_mov_b32 m0, 62464
s_add_u32 s48, s49, 5046272
buffer_load_dwordx4 v10, s[16:19], s48 offen lds
ds_read_b64_tr_b16 a[232:233], v5 offset:0
ds_read_b64_tr_b16 a[234:235], v5 offset:1024
ds_read_b64_tr_b16 a[236:237], v5 offset:4096
ds_read_b64_tr_b16 a[238:239], v5 offset:5120
ds_read_b64_tr_b16 a[184:185], v5 offset:8192
ds_read_b64_tr_b16 a[186:187], v5 offset:9216
ds_read_b64_tr_b16 a[188:189], v5 offset:12288
ds_read_b64_tr_b16 a[190:191], v5 offset:13312
ds_read_b64_tr_b16 a[192:193], v5 offset:16384
ds_read_b64_tr_b16 a[194:195], v5 offset:17408
ds_read_b64_tr_b16 a[196:197], v5 offset:20480
ds_read_b64_tr_b16 a[198:199], v5 offset:21504
ds_read_b64_tr_b16 v[248:249], v5 offset:24576
ds_read_b64_tr_b16 v[250:251], v5 offset:25600
ds_read_b64_tr_b16 v[252:253], v5 offset:28672
ds_read_b64_tr_b16 v[254:255], v5 offset:29696
s_waitcnt lgkmcnt(0)
s_waitcnt vmcnt(24)
s_barrier
s_mov_b32 m0, 69632
s_add_u32 s48, s49, 4980864
buffer_load_dwordx4 v10, s[16:19], s48 offen lds
s_mov_b32 m0, 70656
s_add_u32 s48, s49, 5046400
buffer_load_dwordx4 v10, s[16:19], s48 offen lds
s_mov_b32 m0, 77824
s_add_u32 s48, s50, 81920
buffer_load_dwordx4 v11, s[20:23], s48 offen lds
s_mov_b32 m0, 78848
s_add_u32 s48, s50, 87040
buffer_load_dwordx4 v11, s[20:23], s48 offen lds
s_mov_b32 m0, 86016
s_add_u32 s48, s50, 102400
buffer_load_dwordx4 v11, s[20:23], s48 offen lds
s_mov_b32 m0, 87040
s_add_u32 s48, s50, 107520
buffer_load_dwordx4 v11, s[20:23], s48 offen lds
s_mov_b32 m0, 94208
s_add_u32 s48, s50, 122880
buffer_load_dwordx4 v11, s[20:23], s48 offen lds
s_mov_b32 m0, 95232
s_add_u32 s48, s50, 128000
buffer_load_dwordx4 v11, s[20:23], s48 offen lds
ds_read_b64_tr_b16 a[200:201], v5 offset:32768
ds_read_b64_tr_b16 a[202:203], v5 offset:33792
ds_read_b64_tr_b16 a[204:205], v5 offset:36864
ds_read_b64_tr_b16 a[206:207], v5 offset:37888
ds_read_b64_tr_b16 v[80:81], v5 offset:40960
ds_read_b64_tr_b16 v[82:83], v5 offset:41984
ds_read_b64_tr_b16 v[84:85], v5 offset:45056
ds_read_b64_tr_b16 v[86:87], v5 offset:46080
ds_read_b64_tr_b16 v[88:89], v5 offset:49152
ds_read_b64_tr_b16 v[90:91], v5 offset:50176
ds_read_b64_tr_b16 v[92:93], v5 offset:53248
ds_read_b64_tr_b16 v[94:95], v5 offset:54272
ds_read_b64_tr_b16 v[96:97], v5 offset:57344
ds_read_b64_tr_b16 v[98:99], v5 offset:58368
ds_read_b64_tr_b16 v[100:101], v5 offset:61440
ds_read_b64_tr_b16 v[102:103], v5 offset:62464
s_waitcnt lgkmcnt(0)
s_waitcnt vmcnt(24)
s_barrier
s_mov_b32 m0, 102400
s_add_u32 s48, s50, 143360
buffer_load_dwordx4 v11, s[20:23], s48 offen lds
s_mov_b32 m0, 103424
s_add_u32 s48, s50, 148480
buffer_load_dwordx4 v11, s[20:23], s48 offen lds
s_mov_b32 m0, 110592
s_add_u32 s48, s50, 82176
buffer_load_dwordx4 v11, s[20:23], s48 offen lds
s_mov_b32 m0, 111616
s_add_u32 s48, s50, 87296
buffer_load_dwordx4 v11, s[20:23], s48 offen lds
s_mov_b32 m0, 118784
s_add_u32 s48, s50, 102656
buffer_load_dwordx4 v11, s[20:23], s48 offen lds
s_mov_b32 m0, 119808
s_add_u32 s48, s50, 107776
buffer_load_dwordx4 v11, s[20:23], s48 offen lds
s_mov_b32 m0, 126976
s_add_u32 s48, s50, 123136
buffer_load_dwordx4 v11, s[20:23], s48 offen lds
s_mov_b32 m0, 128000
s_add_u32 s48, s50, 128256
buffer_load_dwordx4 v11, s[20:23], s48 offen lds
ds_read_b64_tr_b16 v[104:105], v6 offset:0
ds_read_b64_tr_b16 v[106:107], v6 offset:1024
ds_read_b64_tr_b16 v[108:109], v6 offset:4096
ds_read_b64_tr_b16 v[110:111], v6 offset:5120
ds_read_b64_tr_b16 v[240:241], v6 offset:8192
ds_read_b64_tr_b16 v[242:243], v6 offset:9216
ds_read_b64_tr_b16 v[244:245], v6 offset:12288
ds_read_b64_tr_b16 v[246:247], v6 offset:13312
ds_read_b64_tr_b16 a[240:241], v6 offset:16384
ds_read_b64_tr_b16 a[242:243], v6 offset:17408
ds_read_b64_tr_b16 a[244:245], v6 offset:20480
ds_read_b64_tr_b16 a[246:247], v6 offset:21504
ds_read_b64_tr_b16 a[248:249], v6 offset:24576
ds_read_b64_tr_b16 a[250:251], v6 offset:25600
ds_read_b64_tr_b16 a[252:253], v6 offset:28672
ds_read_b64_tr_b16 a[254:255], v6 offset:29696
s_waitcnt lgkmcnt(0)
s_waitcnt vmcnt(24)
s_barrier
s_mov_b32 m0, 135168
s_add_u32 s48, s50, 143616
buffer_load_dwordx4 v11, s[20:23], s48 offen lds
s_mov_b32 m0, 136192
s_add_u32 s48, s50, 148736
buffer_load_dwordx4 v11, s[20:23], s48 offen lds
s_mov_b32 m0, 143360
s_add_u32 s48, s50, 82432
buffer_load_dwordx4 v11, s[20:23], s48 offen lds
s_mov_b32 m0, 144384
s_add_u32 s48, s50, 87552
buffer_load_dwordx4 v11, s[20:23], s48 offen lds
s_mov_b32 m0, 151552
s_add_u32 s48, s50, 102912
buffer_load_dwordx4 v11, s[20:23], s48 offen lds
s_mov_b32 m0, 152576
s_add_u32 s48, s50, 108032
buffer_load_dwordx4 v11, s[20:23], s48 offen lds
s_mov_b32 m0, 159744
s_add_u32 s48, s50, 123392
buffer_load_dwordx4 v11, s[20:23], s48 offen lds
s_mov_b32 m0, 160768
s_add_u32 s48, s50, 128512
buffer_load_dwordx4 v11, s[20:23], s48 offen lds
ds_read_b64_tr_b16 v[72:73], v4 offset:0
ds_read_b64_tr_b16 v[74:75], v4 offset:1024
ds_read_b64_tr_b16 v[76:77], v4 offset:4096
ds_read_b64_tr_b16 v[78:79], v4 offset:5120
ds_read_b64_tr_b16 v[144:145], v4 offset:8192
ds_read_b64_tr_b16 v[146:147], v4 offset:9216
ds_read_b64_tr_b16 v[148:149], v4 offset:12288
ds_read_b64_tr_b16 v[150:151], v4 offset:13312
ds_read_b64_tr_b16 v[152:153], v4 offset:16384
ds_read_b64_tr_b16 v[154:155], v4 offset:17408
ds_read_b64_tr_b16 v[156:157], v4 offset:20480
ds_read_b64_tr_b16 v[158:159], v4 offset:21504
ds_read_b64_tr_b16 v[160:161], v4 offset:24576
ds_read_b64_tr_b16 v[162:163], v4 offset:25600
ds_read_b64_tr_b16 v[164:165], v4 offset:28672
ds_read_b64_tr_b16 v[166:167], v4 offset:29696
s_waitcnt lgkmcnt(0)
s_waitcnt vmcnt(24)
s_barrier
s_mov_b32 m0, 4096
s_add_u32 s48, s50, 143872
buffer_load_dwordx4 v11, s[20:23], s48 offen lds
s_mov_b32 m0, 5120
s_add_u32 s48, s50, 148992
buffer_load_dwordx4 v11, s[20:23], s48 offen lds
s_mov_b32 m0, 12288
s_add_u32 s48, s49, 262144
buffer_load_dwordx4 v10, s[12:15], s48 offen lds
s_mov_b32 m0, 13312
s_add_u32 s48, s49, 327680
buffer_load_dwordx4 v10, s[12:15], s48 offen lds
s_mov_b32 m0, 20480
s_add_u32 s48, s49, 786432
buffer_load_dwordx4 v10, s[12:15], s48 offen lds
s_mov_b32 m0, 21504
s_add_u32 s48, s49, 851968
buffer_load_dwordx4 v10, s[12:15], s48 offen lds
s_mov_b32 m0, 28672
s_add_u32 s48, s49, 1310720
buffer_load_dwordx4 v10, s[12:15], s48 offen lds
s_mov_b32 m0, 29696
s_add_u32 s48, s49, 1376256
buffer_load_dwordx4 v10, s[12:15], s48 offen lds
ds_read_b64_tr_b16 v[168:169], v4 offset:32768
ds_read_b64_tr_b16 v[170:171], v4 offset:33792
ds_read_b64_tr_b16 v[172:173], v4 offset:36864
ds_read_b64_tr_b16 v[174:175], v4 offset:37888
ds_read_b64_tr_b16 v[112:113], v4 offset:40960
ds_read_b64_tr_b16 v[114:115], v4 offset:41984
ds_read_b64_tr_b16 v[116:117], v4 offset:45056
ds_read_b64_tr_b16 v[118:119], v4 offset:46080
ds_read_b64_tr_b16 v[120:121], v4 offset:49152
ds_read_b64_tr_b16 v[122:123], v4 offset:50176
ds_read_b64_tr_b16 v[124:125], v4 offset:53248
ds_read_b64_tr_b16 v[126:127], v4 offset:54272
ds_read_b64_tr_b16 v[128:129], v4 offset:57344
ds_read_b64_tr_b16 v[130:131], v4 offset:58368
ds_read_b64_tr_b16 v[132:133], v4 offset:61440
ds_read_b64_tr_b16 v[134:135], v4 offset:62464
s_waitcnt lgkmcnt(0)
s_waitcnt vmcnt(24)
s_barrier
s_mov_b32 m0, 36864
s_add_u32 s48, s49, 1835008
buffer_load_dwordx4 v10, s[12:15], s48 offen lds
s_mov_b32 m0, 37888
s_add_u32 s48, s49, 1900544
buffer_load_dwordx4 v10, s[12:15], s48 offen lds
s_mov_b32 m0, 45056
s_add_u32 s48, s49, 2359296
buffer_load_dwordx4 v10, s[12:15], s48 offen lds
s_mov_b32 m0, 46080
s_add_u32 s48, s49, 2424832
buffer_load_dwordx4 v10, s[12:15], s48 offen lds
s_mov_b32 m0, 53248
s_add_u32 s48, s49, 2883584
buffer_load_dwordx4 v10, s[12:15], s48 offen lds
s_mov_b32 m0, 54272
s_add_u32 s48, s49, 2949120
buffer_load_dwordx4 v10, s[12:15], s48 offen lds
s_mov_b32 m0, 61440
s_add_u32 s48, s49, 1310848
buffer_load_dwordx4 v10, s[16:19], s48 offen lds
s_mov_b32 m0, 62464
s_add_u32 s48, s49, 1376384
buffer_load_dwordx4 v10, s[16:19], s48 offen lds
ds_read_b64_tr_b16 v[136:137], v5 offset:0
ds_read_b64_tr_b16 v[138:139], v5 offset:1024
ds_read_b64_tr_b16 v[140:141], v5 offset:4096
ds_read_b64_tr_b16 v[142:143], v5 offset:5120
ds_read_b64_tr_b16 v[184:185], v8 offset:8192
ds_read_b64_tr_b16 v[186:187], v8 offset:8704
ds_read_b64_tr_b16 v[188:189], v8 offset:10240
ds_read_b64_tr_b16 v[190:191], v8 offset:10752
ds_read_b64_tr_b16 v[192:193], v8 offset:16384
ds_read_b64_tr_b16 v[194:195], v8 offset:16896
ds_read_b64_tr_b16 v[196:197], v8 offset:18432
ds_read_b64_tr_b16 v[198:199], v8 offset:18944
v_xor_b32 v12, v15, v8
ds_read_b64_tr_b16 v[40:41], v12 offset:24576
ds_read_b64_tr_b16 v[42:43], v12 offset:25088
ds_read_b64_tr_b16 v[44:45], v12 offset:26624
ds_read_b64_tr_b16 v[46:47], v12 offset:27136
s_waitcnt lgkmcnt(0)
buffer_store_dwordx4 v[40:43], v0, s[4:7], s61 offen offset:0
buffer_store_dwordx4 v[44:47], v0, s[4:7], s61 offen offset:1024
s_waitcnt vmcnt(26)
s_barrier
s_mov_b32 m0, 69632
s_add_u32 s48, s49, 1835136
buffer_load_dwordx4 v10, s[16:19], s48 offen lds
s_mov_b32 m0, 70656
s_add_u32 s48, s49, 1900672
buffer_load_dwordx4 v10, s[16:19], s48 offen lds
s_mov_b32 m0, 77824
s_add_u32 s48, s49, 2359424
buffer_load_dwordx4 v10, s[16:19], s48 offen lds
s_mov_b32 m0, 78848
s_add_u32 s48, s49, 2424960
buffer_load_dwordx4 v10, s[16:19], s48 offen lds
s_mov_b32 m0, 86016
s_add_u32 s48, s49, 2883712
buffer_load_dwordx4 v10, s[16:19], s48 offen lds
s_mov_b32 m0, 87040
s_add_u32 s48, s49, 2949248
buffer_load_dwordx4 v10, s[16:19], s48 offen lds
s_mov_b32 m0, 94208
s_add_u32 s48, s50, 82688
buffer_load_dwordx4 v11, s[20:23], s48 offen lds
s_mov_b32 m0, 95232
s_add_u32 s48, s50, 87808
buffer_load_dwordx4 v11, s[20:23], s48 offen lds
ds_read_b64_tr_b16 v[176:177], v8 offset:32768
ds_read_b64_tr_b16 v[178:179], v8 offset:33280
ds_read_b64_tr_b16 v[180:181], v8 offset:34816
ds_read_b64_tr_b16 v[182:183], v8 offset:35328
ds_read_b64_tr_b16 v[232:233], v8 offset:40960
ds_read_b64_tr_b16 v[234:235], v8 offset:41472
ds_read_b64_tr_b16 v[236:237], v8 offset:43008
ds_read_b64_tr_b16 v[238:239], v8 offset:43520
ds_read_b64_tr_b16 v[32:33], v8 offset:49152
ds_read_b64_tr_b16 v[34:35], v8 offset:49664
ds_read_b64_tr_b16 v[36:37], v8 offset:51200
ds_read_b64_tr_b16 v[38:39], v8 offset:51712
v_xor_b32 v12, v15, v8
ds_read_b64_tr_b16 v[40:41], v12 offset:57344
ds_read_b64_tr_b16 v[42:43], v12 offset:57856
ds_read_b64_tr_b16 v[44:45], v12 offset:59392
ds_read_b64_tr_b16 v[46:47], v12 offset:59904
s_waitcnt lgkmcnt(0)
buffer_store_dwordx4 v[32:35], v0, s[4:7], s62 offen offset:0
buffer_store_dwordx4 v[36:39], v0, s[4:7], s62 offen offset:1024
buffer_store_dwordx4 v[40:43], v0, s[4:7], s61 offen offset:2048
buffer_store_dwordx4 v[44:47], v0, s[4:7], s61 offen offset:3072
s_waitcnt vmcnt(30)
s_barrier
s_mov_b32 m0, 102400
s_add_u32 s48, s50, 103168
buffer_load_dwordx4 v11, s[20:23], s48 offen lds
s_mov_b32 m0, 103424
s_add_u32 s48, s50, 108288
buffer_load_dwordx4 v11, s[20:23], s48 offen lds
s_mov_b32 m0, 110592
s_add_u32 s48, s50, 123648
buffer_load_dwordx4 v11, s[20:23], s48 offen lds
s_mov_b32 m0, 111616
s_add_u32 s48, s50, 128768
buffer_load_dwordx4 v11, s[20:23], s48 offen lds
s_mov_b32 m0, 118784
s_add_u32 s48, s50, 144128
buffer_load_dwordx4 v11, s[20:23], s48 offen lds
s_mov_b32 m0, 119808
s_add_u32 s48, s50, 149248
buffer_load_dwordx4 v11, s[20:23], s48 offen lds
s_mov_b32 m0, 126976
s_add_u32 s48, s50, 82944
buffer_load_dwordx4 v11, s[20:23], s48 offen lds
s_mov_b32 m0, 128000
s_add_u32 s48, s50, 88064
buffer_load_dwordx4 v11, s[20:23], s48 offen lds
ds_read_b64_tr_b16 a[208:209], v9 offset:0
ds_read_b64_tr_b16 a[210:211], v9 offset:512
ds_read_b64_tr_b16 a[212:213], v9 offset:2048
ds_read_b64_tr_b16 a[214:215], v9 offset:2560
ds_read_b64_tr_b16 v[208:209], v9 offset:8192
ds_read_b64_tr_b16 v[210:211], v9 offset:8704
ds_read_b64_tr_b16 v[212:213], v9 offset:10240
ds_read_b64_tr_b16 v[214:215], v9 offset:10752
ds_read_b64_tr_b16 v[216:217], v9 offset:16384
ds_read_b64_tr_b16 v[218:219], v9 offset:16896
ds_read_b64_tr_b16 v[220:221], v9 offset:18432
ds_read_b64_tr_b16 v[222:223], v9 offset:18944
v_xor_b32 v12, v15, v9
ds_read_b64_tr_b16 v[200:201], v12 offset:24576
ds_read_b64_tr_b16 v[202:203], v12 offset:25088
ds_read_b64_tr_b16 v[204:205], v12 offset:26624
ds_read_b64_tr_b16 v[206:207], v12 offset:27136
s_waitcnt lgkmcnt(0)
s_waitcnt vmcnt(36)
s_barrier
s_mov_b32 m0, 135168
s_add_u32 s48, s50, 103424
buffer_load_dwordx4 v11, s[20:23], s48 offen lds
s_mov_b32 m0, 136192
s_add_u32 s48, s50, 108544
buffer_load_dwordx4 v11, s[20:23], s48 offen lds
s_mov_b32 m0, 143360
s_add_u32 s48, s50, 123904
buffer_load_dwordx4 v11, s[20:23], s48 offen lds
s_mov_b32 m0, 144384
s_add_u32 s48, s50, 129024
buffer_load_dwordx4 v11, s[20:23], s48 offen lds
s_mov_b32 m0, 151552
s_add_u32 s48, s50, 144384
buffer_load_dwordx4 v11, s[20:23], s48 offen lds
s_mov_b32 m0, 152576
s_add_u32 s48, s50, 149504
buffer_load_dwordx4 v11, s[20:23], s48 offen lds
s_mov_b32 m0, 159744
s_add_u32 s48, s49, 3407872
buffer_load_dwordx4 v10, s[8:11], s48 offen lds
s_mov_b32 m0, 160768
s_add_u32 s48, s49, 3473408
buffer_load_dwordx4 v10, s[8:11], s48 offen lds
ds_read_b64_tr_b16 v[16:17], v7 offset:0
ds_read_b64_tr_b16 v[18:19], v7 offset:512
ds_read_b64_tr_b16 v[20:21], v7 offset:2048
ds_read_b64_tr_b16 v[22:23], v7 offset:2560
s_waitcnt lgkmcnt(0)
buffer_store_dwordx4 v[16:19], v0, s[4:7], s62 offen offset:2048
buffer_store_dwordx4 v[20:23], v0, s[4:7], s62 offen offset:3072
s_waitcnt vmcnt(32)
s_barrier
ds_read_b64_tr_b16 v[16:17], v4 offset:8192
ds_read_b64_tr_b16 v[18:19], v4 offset:9216
ds_read_b64_tr_b16 v[20:21], v4 offset:12288
ds_read_b64_tr_b16 v[22:23], v4 offset:13312
ds_read_b64_tr_b16 v[24:25], v4 offset:16384
ds_read_b64_tr_b16 v[26:27], v4 offset:17408
ds_read_b64_tr_b16 v[28:29], v4 offset:20480
ds_read_b64_tr_b16 v[30:31], v4 offset:21504
ds_read_b64_tr_b16 v[32:33], v4 offset:24576
ds_read_b64_tr_b16 v[34:35], v4 offset:25600
ds_read_b64_tr_b16 v[36:37], v4 offset:28672
ds_read_b64_tr_b16 v[38:39], v4 offset:29696
ds_read_b64_tr_b16 v[40:41], v4 offset:32768
ds_read_b64_tr_b16 v[42:43], v4 offset:33792
ds_read_b64_tr_b16 v[44:45], v4 offset:36864
ds_read_b64_tr_b16 v[46:47], v4 offset:37888
ds_read_b64_tr_b16 v[48:49], v4 offset:40960
ds_read_b64_tr_b16 v[50:51], v4 offset:41984
ds_read_b64_tr_b16 v[52:53], v4 offset:45056
ds_read_b64_tr_b16 v[54:55], v4 offset:46080
ds_read_b64_tr_b16 v[56:57], v4 offset:49152
ds_read_b64_tr_b16 v[58:59], v4 offset:50176
ds_read_b64_tr_b16 v[60:61], v4 offset:53248
ds_read_b64_tr_b16 v[62:63], v4 offset:54272
ds_read_b64_tr_b16 v[64:65], v4 offset:57344
ds_read_b64_tr_b16 v[66:67], v4 offset:58368
ds_read_b64_tr_b16 v[68:69], v4 offset:61440
ds_read_b64_tr_b16 v[70:71], v4 offset:62464
s_waitcnt lgkmcnt(0)
s_barrier
ds_write_b128 v0, v[16:19] offset:36864
ds_write_b128 v0, v[20:23] offset:37888
ds_write_b128 v0, v[24:27] offset:38912
ds_write_b128 v0, v[28:31] offset:39936
ds_write_b128 v0, v[32:35] offset:40960
ds_write_b128 v0, v[36:39] offset:41984
ds_write_b128 v0, v[40:43] offset:43008
ds_write_b128 v0, v[44:47] offset:44032
ds_write_b128 v0, v[48:51] offset:45056
ds_write_b128 v0, v[52:55] offset:46080
ds_write_b128 v0, v[56:59] offset:47104
ds_write_b128 v0, v[60:63] offset:48128
ds_write_b128 v0, v[64:67] offset:49152
ds_write_b128 v0, v[68:71] offset:50176
s_waitcnt lgkmcnt(0)
s_waitcnt vmcnt(8)
s_barrier
ds_read_b64_tr_b16 v[16:17], v8 offset:24576
ds_read_b64_tr_b16 v[18:19], v8 offset:25088
ds_read_b64_tr_b16 v[20:21], v8 offset:26624
ds_read_b64_tr_b16 v[22:23], v8 offset:27136
ds_read_b64_tr_b16 v[24:25], v8 offset:32768
ds_read_b64_tr_b16 v[26:27], v8 offset:33280
ds_read_b64_tr_b16 v[28:29], v8 offset:34816
ds_read_b64_tr_b16 v[30:31], v8 offset:35328
v_xor_b32 v12, v15, v8
ds_read_b64_tr_b16 v[32:33], v12 offset:40960
ds_read_b64_tr_b16 v[34:35], v12 offset:41472
ds_read_b64_tr_b16 v[36:37], v12 offset:43008
ds_read_b64_tr_b16 v[38:39], v12 offset:43520
ds_read_b64_tr_b16 v[40:41], v8 offset:49152
ds_read_b64_tr_b16 v[42:43], v8 offset:49664
ds_read_b64_tr_b16 v[44:45], v8 offset:51200
ds_read_b64_tr_b16 v[46:47], v8 offset:51712
ds_read_b64_tr_b16 v[48:49], v8 offset:57344
ds_read_b64_tr_b16 v[50:51], v8 offset:57856
ds_read_b64_tr_b16 v[52:53], v8 offset:59392
ds_read_b64_tr_b16 v[54:55], v8 offset:59904
ds_read_b64_tr_b16 v[56:57], v9 offset:0
ds_read_b64_tr_b16 v[58:59], v9 offset:512
ds_read_b64_tr_b16 v[60:61], v9 offset:2048
ds_read_b64_tr_b16 v[62:63], v9 offset:2560
s_waitcnt lgkmcnt(0)
s_barrier
ds_write_b128 v2, v[16:19] offset:24576
ds_write_b128 v2, v[20:23] offset:25600
ds_write_b128 v2, v[232:235] offset:26624
ds_write_b128 v2, v[236:239] offset:27648
ds_write_b128 v2, v[224:227] offset:28672
ds_write_b128 v2, v[228:231] offset:29696
ds_write_b128 v2, v[40:43] offset:30720
ds_write_b128 v2, v[44:47] offset:31744
ds_write_b128 v2, v[48:51] offset:32768
ds_write_b128 v2, v[52:55] offset:33792
ds_write_b128 v2, v[248:251] offset:34816
ds_write_b128 v2, v[252:255] offset:35840
s_waitcnt lgkmcnt(0)
v_mov_b32 v232, v24
v_mov_b32 v233, v25
v_mov_b32 v234, v26
v_mov_b32 v235, v27
v_mov_b32 v236, v28
v_mov_b32 v237, v29
v_mov_b32 v238, v30
v_mov_b32 v239, v31
v_mov_b32 v224, v32
v_mov_b32 v225, v33
v_mov_b32 v226, v34
v_mov_b32 v227, v35
v_mov_b32 v228, v36
v_mov_b32 v229, v37
v_mov_b32 v230, v38
v_mov_b32 v231, v39
v_mov_b32 v248, v56
v_mov_b32 v249, v57
v_mov_b32 v250, v58
v_mov_b32 v251, v59
v_mov_b32 v252, v60
v_mov_b32 v253, v61
v_mov_b32 v254, v62
v_mov_b32 v255, v63
s_waitcnt vmcnt(2)
s_barrier
ds_read_b64_tr_b16 v[16:17], v5 offset:0
ds_read_b64_tr_b16 v[18:19], v5 offset:1024
ds_read_b64_tr_b16 v[20:21], v5 offset:4096
ds_read_b64_tr_b16 v[22:23], v5 offset:5120
ds_read_b64_tr_b16 v[24:25], v5 offset:8192
ds_read_b64_tr_b16 v[26:27], v5 offset:9216
ds_read_b64_tr_b16 v[28:29], v5 offset:12288
ds_read_b64_tr_b16 v[30:31], v5 offset:13312
ds_read_b64_tr_b16 v[32:33], v5 offset:16384
ds_read_b64_tr_b16 v[34:35], v5 offset:17408
ds_read_b64_tr_b16 v[36:37], v5 offset:20480
ds_read_b64_tr_b16 v[38:39], v5 offset:21504
v_xor_b32 v12, v15, v9
ds_read_b64_tr_b16 v[40:41], v12 offset:8192
ds_read_b64_tr_b16 v[42:43], v12 offset:8704
ds_read_b64_tr_b16 v[44:45], v12 offset:10240
ds_read_b64_tr_b16 v[46:47], v12 offset:10752
ds_read_b64_tr_b16 v[48:49], v9 offset:16384
ds_read_b64_tr_b16 v[50:51], v9 offset:16896
ds_read_b64_tr_b16 v[52:53], v9 offset:18432
ds_read_b64_tr_b16 v[54:55], v9 offset:18944
ds_read_b64_tr_b16 v[56:57], v6 offset:24576
ds_read_b64_tr_b16 v[58:59], v6 offset:25600
ds_read_b64_tr_b16 v[60:61], v6 offset:28672
ds_read_b64_tr_b16 v[62:63], v6 offset:29696
s_waitcnt lgkmcnt(0)
s_barrier
ds_write_b128 v2, a[176:179] offset:0
ds_write_b128 v2, a[180:183] offset:1024
ds_write_b128 v2, v[24:27] offset:2048
ds_write_b128 v2, v[28:31] offset:3072
ds_write_b128 v2, v[32:35] offset:4096
ds_write_b128 v2, v[36:39] offset:5120
ds_write_b128 v2, v[240:243] offset:6144
ds_write_b128 v2, v[244:247] offset:7168
ds_write_b128 v2, v[48:51] offset:8192
ds_write_b128 v2, v[52:55] offset:9216
ds_write_b128 v2, a[208:211] offset:10240
ds_write_b128 v2, a[212:215] offset:11264
s_waitcnt lgkmcnt(0)
v_accvgpr_write_b32 a176, v16
v_accvgpr_write_b32 a177, v17
v_accvgpr_write_b32 a178, v18
v_accvgpr_write_b32 a179, v19
v_accvgpr_write_b32 a180, v20
v_accvgpr_write_b32 a181, v21
v_accvgpr_write_b32 a182, v22
v_accvgpr_write_b32 a183, v23
v_mov_b32 v240, v40
v_mov_b32 v241, v41
v_mov_b32 v242, v42
v_mov_b32 v243, v43
v_mov_b32 v244, v44
v_mov_b32 v245, v45
v_mov_b32 v246, v46
v_mov_b32 v247, v47
v_accvgpr_write_b32 a208, v56
v_accvgpr_write_b32 a209, v57
v_accvgpr_write_b32 a210, v58
v_accvgpr_write_b32 a211, v59
v_accvgpr_write_b32 a212, v60
v_accvgpr_write_b32 a213, v61
v_accvgpr_write_b32 a214, v62
v_accvgpr_write_b32 a215, v63
s_mov_b32 s12, 0x3030303
s_mov_b32 s13, 0x3030303
s_mov_b32 s14, 0xc0c0c0c
s_mov_b32 s15, 0xc0c0c0c
s_mov_b32 s16, 0x30303030
s_mov_b32 s17, 0x30303030
s_mov_b32 s18, 0xc0c0c0c0
s_mov_b32 s19, 0xc0c0c0c0
s_mov_b32 s8, s4
s_mov_b32 s9, s5
s_cmp_eq_u32 s30, 30
s_cselect_b32 s10, s6, 0
s_mov_b32 s20, s4
s_mov_b32 s21, s5
s_cmp_lt_u32 s30, 10
s_cselect_b32 s22, s6, 0
v_mov_b32 v3, -1
s_waitcnt vmcnt(0)
s_barrier
v_mov_b32 v8, 160
s_barrier
ds_read_b32 v9, v8
s_waitcnt lgkmcnt(0)
v_readfirstlane_b32 s64, v9
v_lshlrev_b32 v23, v0, s58
v_cndmask_b32 v20, 0, v23, s[90:91]
v_cndmask_b32 v21, 0, v23, s[92:93]
v_cndmask_b32 v22, 0, v23, s[94:95]
v_cndmask_b32 v23, 0, v23, s[96:97]
s_branch k_go_222
k_lay_221:
s_add_u32 s47, s31, 63
s_mul_i32 s33, s31, 0
s_add_u32 s33, s33, 120324096
s_add_u32 s34, s33, 4096
s_add_u32 s35, s33, 8192
s_mul_i32 s48, s31, 655360
s_lshl_b32 s36, s30, 14
s_add_u32 s36, s36, s48
s_add_u32 s36, s36, 8192
v_mov_b32 v36, -1
s_and_b32 s48, s30, 31
s_add_u32 s48, s48, 48
s_lshr_b32 s49, s48, 1
s_and_b32 s48, s48, 1
s_lshl_b32 s44, s49, 8
s_lshl_b32 s50, s48, 6
s_add_u32 s44, s44, s50
s_add_u32 s44, s44, s33
s_mul_i32 s48, s48, 5120
s_lshl_b32 s49, s49, 5
s_add_u32 s48, s48, s49
v_lshrrev_b32 v32, 4, v0
v_and_b32 v33, 3, v32
v_mul_u32_u24 v33, 1280, v33
v_bfe_u32 v34, v32, 2, 1
v_lshl_add_u32 v33, v34, 1, v33
v_bfe_u32 v34, v32, 4, 1
v_lshl_add_u32 v33, v34, 4, v33
v_bfe_u32 v34, v32, 5, 1
v_lshl_add_u32 v33, v34, 2, v33
buffer_load_ushort v34, v33, s[24:27], s48 offen
buffer_load_ushort v35, v33, s[24:27], s48 offen offset:8
v_and_b32 v45, 0x30, v0
v_lshrrev_b32 v46, 8, v0
v_lshl_or_b32 v45, v46, 2, v45
v_bfe_u32 v46, v0, 6, 1
v_lshl_or_b32 v45, v46, 7, v45
v_cndmask_b32 v45, v45, 2.0, s[98:99]
s_lshl_b32 s63, s30, 10
s_add_u32 s63, s63, 0x8000
s_add_u32 s63, s63, s33
s_lshl_b32 s37, s31, 14
s_add_u32 s37, s37, 117442560
s_add_u32 s59, s37, 4096
s_waitcnt vmcnt(0)
s_barrier
v_mov_b32 v8, 160
s_barrier
ds_read_b32 v9, v8
s_waitcnt lgkmcnt(0)
v_readfirstlane_b32 s64, v9
v_lshl_or_b32 v34, v35, 16, v34
buffer_store_dword v34, v45, s[4:7], s44 offen sc1
s_add_u32 s44, s44, 16384
buffer_store_dword v36, v45, s[4:7], s44 offen sc1
s_waitcnt vmcnt(0)
s_barrier
v_mov_b32 v8, 160
s_barrier
ds_read_b32 v9, v8
s_waitcnt lgkmcnt(0)
v_readfirstlane_b32 s64, v9
v_lshlrev_b32 v23, v0, s58
v_cndmask_b32 v20, 0, v23, s[90:91]
v_cndmask_b32 v21, 0, v23, s[92:93]
v_cndmask_b32 v22, 0, v23, s[94:95]
v_cndmask_b32 v23, 0, v23, s[96:97]
k_go_222:
s_cmp_lg_u32 s64, 0
s_cbranch_scc1 k_far_229
s_branch k_cold2_233
k_T0_231:
s_waitcnt vmcnt(2)
v_smfmac_f32_16x16x64_bf16 v[40:43], v[4:7], v[48:55], v1
s_waitcnt vmcnt(1)
v_cmp_u_f32 vcc, v4, v8
v_smfmac_f32_16x16x64_bf16 v[24:27], v[8:11], a[24:31], v1
v_smfmac_f32_16x16x64_bf16 v[28:31], v[8:11], a[32:39], v1
s_cbranch_vccnz k_cold_232
k_okC_234:
s_waitcnt vmcnt(1)
v_smfmac_f32_16x16x64_bf16 v[36:39], v[8:11], a[40:47], v1
s_waitcnt lgkmcnt(0)
ds_read_b128 v[48:51], v2 offset:0
v_smfmac_f32_16x16x64_bf16 v[32:35], v[4:7], v[64:71], v1
ds_read_b128 v[52:55], v2 offset:1024
ds_read_b128 v[64:67], v0 offset:38912
v_smfmac_f32_16x16x64_bf16 v[44:47], v[4:7], v[56:63], v1
ds_read_b128 v[68:71], v0 offset:39936
v_smfmac_f32_16x16x64_bf16 v[28:31], v[4:7], a[8:15], v1
v_smfmac_f32_16x16x64_bf16 v[24:27], v[4:7], a[0:7], v1
ds_read_b128 v[56:59], v2 offset:28672
v_smfmac_f32_16x16x64_bf16 v[36:39], v[4:7], a[16:23], v1
ds_read_b128 v[60:63], v2 offset:29696
s_waitcnt lgkmcnt(4)
v_smfmac_f32_16x16x64_bf16 v[40:43], v[8:11], v[48:55], v1
s_waitcnt vmcnt(0)
ds_write_b128 v0, v[12:15] offset:2048
s_waitcnt lgkmcnt(3)
v_smfmac_f32_16x16x64_bf16 v[32:35], v[8:11], v[64:71], v1
buffer_load_dwordx4 v[16:19], v0, s[4:7], s35 offen offset:0 sc1
v_cmp_u_f32 vcc, v12, v12
s_waitcnt lgkmcnt(1)
v_smfmac_f32_16x16x64_bf16 v[44:47], v[8:11], v[56:63], v1
ds_read_b128 v[56:59], v2 offset:2048
ds_read_b128 v[60:63], v2 offset:3072
ds_read_b128 v[64:67], v0 offset:45056
s_cbranch_vccnz k_coldA_235
k_okA_236:
v_smfmac_f32_16x16x64_bf16 v[36:39], v[12:15], a[64:71], v1
ds_read_b128 v[68:71], v0 offset:46080
s_waitcnt lgkmcnt(4)
v_smfmac_f32_16x16x64_bf16 v[40:43], v[12:15], a[72:79], v1
s_barrier
v_smfmac_f32_16x16x64_bf16 v[28:31], v[12:15], a[56:63], v1
ds_read_b128 v[8:11], v0 offset:3072
buffer_load_dwordx4 v[48:51], v0, s[4:7], s36 offen offset:0 sc1
s_waitcnt lgkmcnt(3)
v_smfmac_f32_16x16x64_bf16 v[44:47], v[12:15], v[56:63], v1
ds_read_b128 v[56:59], v2 offset:4096
v_smfmac_f32_16x16x64_bf16 v[24:27], v[12:15], a[48:55], v1
ds_read_b128 v[60:63], v2 offset:5120
s_waitcnt lgkmcnt(3)
v_smfmac_f32_16x16x64_bf16 v[32:35], v[12:15], v[64:71], v1
buffer_load_dwordx4 v[52:55], v0, s[4:7], s36 offen offset:1024 sc1
s_waitcnt lgkmcnt(2)
v_smfmac_f32_16x16x64_bf16 v[24:27], v[8:11], a[80:87], v1
ds_read_b128 v[64:67], v0 offset:47104
ds_read_b128 v[68:71], v0 offset:48128
v_smfmac_f32_16x16x64_bf16 v[36:39], v[8:11], a[96:103], v1
buffer_store_dword v3, v0, s[20:23], s63 offen
s_waitcnt lgkmcnt(2)
ds_read_b128 v[4:7], v0 offset:0
v_smfmac_f32_16x16x64_bf16 v[44:47], v[8:11], v[56:63], v1
ds_read_b128 v[56:59], v0 offset:49152
ds_read_b128 v[60:63], v0 offset:50176
v_smfmac_f32_16x16x64_bf16 v[28:31], v[8:11], a[88:95], v1
buffer_store_dwordx4 v[12:15], v0, s[8:11], s37 offen offset:2048 sc1
v_smfmac_f32_16x16x64_bf16 v[40:43], v[8:11], a[104:111], v1
s_waitcnt lgkmcnt(3)
s_waitcnt lgkmcnt(2)
v_smfmac_f32_16x16x64_bf16 v[32:35], v[8:11], v[64:71], v1
ds_read_b128 v[64:67], v0 offset:40960
ds_read_b128 v[12:15], v0 offset:1024
v_smfmac_f32_16x16x64_bf16 v[36:39], v[4:7], a[128:135], v1
s_waitcnt lgkmcnt(2)
v_smfmac_f32_16x16x64_bf16 v[44:47], v[4:7], v[56:63], v1
ds_read_b128 v[68:71], v0 offset:41984
buffer_load_dwordx4 v[56:59], v0, s[4:7], s36 offen offset:2048 sc1
v_smfmac_f32_16x16x64_bf16 v[28:31], v[4:7], a[120:127], v1
v_smfmac_f32_16x16x64_bf16 v[24:27], v[4:7], a[112:119], v1
s_waitcnt vmcnt(5)
ds_write_b128 v0, v[16:19] offset:6144
v_smfmac_f32_16x16x64_bf16 v[40:43], v[4:7], a[136:143], v1
s_waitcnt lgkmcnt(1)
buffer_load_dwordx4 v[60:63], v0, s[4:7], s36 offen offset:3072 sc1
v_cmp_u_f32 vcc, v16, v16
v_smfmac_f32_16x16x64_bf16 v[32:35], v[4:7], v[64:71], v1
ds_read_b128 v[64:67], v0 offset:43008
ds_read_b128 v[68:71], v0 offset:44032
v_smfmac_f32_16x16x64_bf16 v[28:31], v[12:15], a[152:159], v1
v_smfmac_f32_16x16x64_bf16 v[24:27], v[12:15], a[144:151], v1
s_cbranch_vccnz k_coldB_237
k_okB_238:
v_smfmac_f32_16x16x64_bf16 v[36:39], v[12:15], a[160:167], v1
s_waitcnt lgkmcnt(2)
buffer_store_dwordx4 v[16:19], v0, s[8:11], s59 offen offset:2048 sc1
s_barrier
ds_read_b128 v[4:7], v0 offset:4096
v_smfmac_f32_16x16x64_bf16 v[44:47], v[12:15], a[176:183], v1
ds_read_b128 v[8:11], v0 offset:7168
s_waitcnt lgkmcnt(2)
v_smfmac_f32_16x16x64_bf16 v[32:35], v[12:15], v[64:71], v1
ds_read_b128 v[64:67], v2 offset:34816
ds_read_b128 v[68:71], v2 offset:35840
v_smfmac_f32_16x16x64_bf16 v[24:27], v[16:19], a[184:191], v1
v_smfmac_f32_16x16x64_bf16 v[40:43], v[12:15], a[168:175], v1
s_waitcnt lgkmcnt(3)
ds_read_b128 v[12:15], v0 offset:5120
v_smfmac_f32_16x16x64_bf16 v[24:27], v[4:7], a[208:215], v1
s_waitcnt lgkmcnt(3)
v_smfmac_f32_16x16x64_bf16 v[28:31], v[4:7], a[216:223], v1
v_smfmac_f32_16x16x64_bf16 v[28:31], v[8:11], a[200:207], v1
s_waitcnt lgkmcnt(1)
v_smfmac_f32_16x16x64_bf16 v[24:27], v[8:11], v[64:71], v1
ds_read_b128 v[64:67], v2 offset:6144
s_waitcnt lgkmcnt(1)
v_smfmac_f32_16x16x64_bf16 v[24:27], v[12:15], a[224:231], v1
ds_read_b128 v[68:71], v2 offset:7168
v_smfmac_f32_16x16x64_bf16 v[28:31], v[12:15], a[232:239], v1
v_smfmac_f32_16x16x64_bf16 v[28:31], v[16:19], a[192:199], v1
v_cvt_pk_bf16_f32 v24, v24, v25
v_cvt_pk_bf16_f32 v25, v26, v27
v_smfmac_f32_16x16x64_bf16 v[32:35], v[4:7], v[80:87], v1
v_cvt_pk_bf16_f32 v26, v28, v29
v_cvt_pk_bf16_f32 v27, v30, v31
v_smfmac_f32_16x16x64_bf16 v[32:35], v[8:11], a[248:255], v1
s_waitcnt lgkmcnt(0)
v_mfma_f32_16x16x32_bf16 v[28:31], v[24:27], v[20:23], 0
v_and_b32 v26, 0xffffff7f, v0
v_smfmac_f32_16x16x64_bf16 v[32:35], v[16:19], v[64:71], v1
v_and_or_b32 v26, v1, 8, v26
v_mul_f32 v28, s51, v28
v_mul_f32 v29, s51, v29
v_mul_f32 v31, s51, v31
v_cvt_pk_bf16_f32 v24, v28, v29
v_mul_f32 v30, s51, v30
v_cvt_pk_bf16_f32 v25, v30, v31
v_smfmac_f32_16x16x64_bf16 v[32:35], v[12:15], v[96:103], v1
ds_write_b64 v26, v[24:25] offset:1024
v_smfmac_f32_16x16x64_bf16 v[36:39], v[8:11], v[72:79], v1
v_cvt_pk_bf16_f32 v32, v32, v33
v_smfmac_f32_16x16x64_bf16 v[36:39], v[16:19], a[240:247], v1
buffer_load_dwordx4 v[64:67], v0, s[4:7], s61 offen offset:0
v_cvt_pk_bf16_f32 v33, v34, v35
v_smfmac_f32_16x16x64_bf16 v[36:39], v[12:15], v[104:111], v1
s_waitcnt lgkmcnt(0)
v_smfmac_f32_16x16x64_bf16 v[36:39], v[4:7], v[88:95], v1
s_barrier
ds_read_b128 v[24:27], v0 offset:0
v_smfmac_f32_16x16x64_bf16 v[40:43], v[4:7], v[144:151], v1
ds_read_b128 v[28:31], v0 offset:1024
s_nop 0
v_cvt_pk_bf16_f32 v34, v36, v37
v_cvt_pk_bf16_f32 v35, v38, v39
s_nop 1
v_mfma_f32_16x16x32_bf16 v[36:39], v[32:35], v[20:23], 0
s_waitcnt vmcnt(6)
buffer_load_dwordx4 v[68:71], v0, s[4:7], s61 offen offset:1024
v_and_b32 v34, 0xffffff7f, v0
v_and_or_b32 v34, v1, 8, v34
s_waitcnt lgkmcnt(1)
v_mfma_f32_16x16x32_bf16 v[48:51], v[48:51], v[24:27], 0
v_cvt_pk_bf16_f32 v32, v36, v37
s_waitcnt lgkmcnt(0)
v_mfma_f32_16x16x32_bf16 v[48:51], v[52:55], v[28:31], v[48:51]
v_mov_b64 v[52:53], s[56:57]
v_cvt_pk_bf16_f32 v33, v38, v39
v_smfmac_f32_16x16x64_bf16 v[44:47], v[4:7], v[152:159], v1
ds_write_b64 v34, v[32:33] offset:3072
v_permlane32_swap_b32 v48, v50
v_permlane32_swap_b32 v49, v51
v_add_f32_dpp v52, v50, v48 row_ror:8 row_mask:0xf bank_mask:0x3
v_exp_f32 v52, v52
v_add_f32_dpp v53, v51, v49 row_ror:8 row_mask:0xf bank_mask:0x3
v_exp_f32 v53, v53
s_nop 0
v_cvt_pk_bf16_f32 v48, v52, v53
v_smfmac_f32_16x16x64_bf16 v[44:47], v[16:19], v[120:127], v1
ds_write_b32 v0, v48 offset:4104
v_smfmac_f32_16x16x64_bf16 v[44:47], v[12:15], v[168:175], v1
buffer_load_dwordx4 v[48:51], v0, s[4:7], s61 offen offset:2048
v_smfmac_f32_16x16x64_bf16 v[40:43], v[12:15], v[160:167], v1
s_waitcnt lgkmcnt(1)
v_xor_b32 v12, 0x80, v0
v_smfmac_f32_16x16x64_bf16 v[40:43], v[8:11], v[128:135], v1
s_waitcnt lgkmcnt(0)
s_barrier
ds_read_b128 v[32:35], v0 offset:2048
v_mov_b64 v[22:23], s[52:53]
v_smfmac_f32_16x16x64_bf16 v[40:43], v[16:19], v[112:119], v1
ds_read_b128 v[36:39], v0 offset:3072
ds_read_b128 v[16:19], v0 offset:4096
buffer_load_dwordx4 v[52:55], v0, s[4:7], s61 offen offset:3072
v_smfmac_f32_16x16x64_bf16 v[44:47], v[8:11], v[136:143], v1
ds_read_b128 v[12:15], v12 offset:4096
v_cvt_pk_bf16_f32 v40, v40, v41
v_mov_b64 v[20:21], s[52:53]
s_waitcnt lgkmcnt(3)
v_mfma_f32_16x16x32_bf16 v[24:27], v[32:35], v[24:27], 0
v_cvt_pk_bf16_f32 v41, v42, v43
s_waitcnt lgkmcnt(2)
v_mfma_f32_16x16x32_bf16 v[24:27], v[36:39], v[28:31], v[24:27]
s_waitcnt vmcnt(5)
s_waitcnt lgkmcnt(1)
v_mfma_f32_16x16x32_bf16 v[8:11], v[56:59], v[16:19], 0
buffer_load_dwordx4 v[56:59], v0, s[4:7], s62 offen offset:0
v_mov_b64 v[28:29], s[56:57]
v_cvt_pk_bf16_f32 v43, v46, v47
v_cvt_pk_bf16_f32 v42, v44, v45
v_permlane32_swap_b32 v25, v27
v_permlane32_swap_b32 v24, v26
v_mfma_f32_16x16x32_bf16 v[4:7], v[20:23], v[16:19], 0
s_waitcnt lgkmcnt(0)
v_add_f32_dpp v28, v26, v24 row_ror:8 row_mask:0xf bank_mask:0x3
v_add_f32_dpp v29, v27, v25 row_ror:8 row_mask:0xf bank_mask:0x3
v_exp_f32 v28, v28
v_mfma_f32_16x16x32_bf16 v[8:11], v[60:63], v[12:15], v[8:11]
buffer_load_dwordx4 v[60:63], v0, s[4:7], s62 offen offset:1024
v_exp_f32 v29, v29
v_permlane32_swap_b32 v42, v43
v_cvt_pk_bf16_f32 v24, v28, v29
v_mov_b64 v[44:45], s[54:55]
v_cvt_pk_bf16_f32 v25, v28, v29
v_mov_b32_dpp v26, v24 row_ror:8 row_mask:0xf bank_mask:0xf
v_mov_b32_dpp v27, v24 row_ror:8 row_mask:0xf bank_mask:0xf
v_mfma_f32_16x16x16_bf16 v[4:7], v[44:45], v[24:25], v[4:7]
v_permlane32_swap_b32 v40, v41
v_mov_b64 v[36:37], 0
v_mov_b64 v[38:39], 0
v_mov_b64 v[30:31], 0
v_mfma_f32_16x16x32_bf16 v[8:11], v[40:43], v[24:27], v[8:11]
buffer_load_dwordx4 v[16:19], v0, s[4:7], s62 offen offset:2048
v_rcp_f32 v6, v4
v_and_b32 v12, 0xffffff7f, v0
v_and_or_b32 v13, v1, 8, v12
v_rcp_f32_dpp v6, v4 row_ror:8 row_mask:0xf bank_mask:0xc
v_mov_b64 v[26:27], 0
v_pk_mul_f32 v[8:9], v[8:9], v[6:7] op_sel_hi:[1,0]
v_cvt_pk_bf16_f32 v44, v8, v9
v_pk_mul_f32 v[10:11], v[10:11], v[6:7] op_sel_hi:[1,0]
v_cvt_pk_bf16_f32 v45, v10, v11
s_waitcnt vmcnt(5)
ds_write_b64 v13, v[44:45] offset:7168
buffer_load_dwordx4 v[20:23], v0, s[4:7], s62 offen offset:3072
v_add_u32 v6, 0xd4800000, v6
v_cmp_lt_u32 vcc, 0x28000000, v6
v_mov_b64 v[34:35], 0
v_mov_b32_dpp v46, v44 row_ror:8 row_mask:0xf bank_mask:0xf
v_mov_b32_dpp v47, v45 row_ror:8 row_mask:0xf bank_mask:0xf
v_mov_b64 v[28:29], 0
v_mov_b64 v[32:33], 0
s_cbranch_vccnz k_slow_239
k_okS_240:
v_smfmac_f32_16x16x64_bf16 v[36:39], v[44:47], v[224:231], v1
s_waitcnt lgkmcnt(0)
s_barrier
ds_read_b128 v[8:11], v12 offset:6144
v_smfmac_f32_16x16x64_bf16 v[32:35], v[44:47], v[200:207], v1
s_waitcnt vmcnt(4)
ds_read_b128 v[4:7], v12 offset:7296
v_mov_b64 v[24:25], 0
v_smfmac_f32_16x16x64_bf16 v[28:31], v[44:47], v[48:55], v1
ds_read_b128 v[12:15], v12 offset:6272
ds_read_b128 v[48:51], v2 offset:26624
v_smfmac_f32_16x16x64_bf16 v[24:27], v[44:47], v[64:71], v1
ds_read_b128 v[52:55], v2 offset:27648
v_mov_b64 v[42:43], 0
s_waitcnt lgkmcnt(4)
v_smfmac_f32_16x16x64_bf16 v[24:27], v[8:11], v[184:191], v1
s_waitcnt lgkmcnt(3)
v_mov_b64 v[40:41], 0
v_smfmac_f32_16x16x64_bf16 v[24:27], v[4:7], v[176:183], v1
s_waitcnt lgkmcnt(2)
ds_read_b128 v[64:67], v2 offset:10240
v_smfmac_f32_16x16x64_bf16 v[24:27], v[12:15], v[192:199], v1
ds_read_b128 v[68:71], v2 offset:11264
v_smfmac_f32_16x16x64_bf16 v[40:43], v[44:47], v[240:247], v1
s_waitcnt vmcnt(2)
s_waitcnt lgkmcnt(2)
v_lshrrev_b32 v44, 16, v1
v_cvt_pk_bf16_f32 v24, v24, v25
v_bfi_b32 v24, 1, s45, v24
v_cvt_pk_bf16_f32 v25, v26, v27
v_smfmac_f32_16x16x64_bf16 v[28:31], v[8:11], v[48:55], v1
buffer_store_dwordx2 v[24:25], v44, s[4:7], s38 offen
ds_read_b128 v[48:51], v2 offset:24576
ds_read_b128 v[52:55], v2 offset:25600
v_smfmac_f32_16x16x64_bf16 v[28:31], v[12:15], v[56:63], v1
s_waitcnt lgkmcnt(2)
ds_read_b128 v[56:59], v2 offset:8192
v_smfmac_f32_16x16x64_bf16 v[28:31], v[4:7], v[64:71], v1
ds_read_b128 v[60:63], v2 offset:9216
v_smfmac_f32_16x16x64_bf16 v[32:35], v[8:11], v[208:215], v1
ds_read_b128 v[64:67], v2 offset:30720
s_nop 0
v_cvt_pk_bf16_f32 v28, v28, v29
v_bfi_b32 v28, 1, s45, v28
v_cvt_pk_bf16_f32 v29, v30, v31
v_smfmac_f32_16x16x64_bf16 v[32:35], v[12:15], v[216:223], v1
buffer_store_dwordx2 v[28:29], v44, s[4:7], s39 offen
v_smfmac_f32_16x16x64_bf16 v[40:43], v[12:15], v[248:255], v1
ds_read_b128 v[68:71], v2 offset:31744
s_waitcnt vmcnt(2)
v_smfmac_f32_16x16x64_bf16 v[32:35], v[4:7], v[16:23], v1
s_waitcnt lgkmcnt(2)
v_smfmac_f32_16x16x64_bf16 v[36:39], v[12:15], v[232:239], v1
ds_read_b128 v[16:19], v2 offset:32768
ds_read_b128 v[20:23], v2 offset:33792
v_cvt_pk_bf16_f32 v32, v32, v33
v_bfi_b32 v32, 1, s45, v32
v_cvt_pk_bf16_f32 v33, v34, v35
v_smfmac_f32_16x16x64_bf16 v[36:39], v[8:11], v[48:55], v1
buffer_store_dwordx2 v[32:33], v44, s[4:7], s40 offen
s_waitcnt lgkmcnt(2)
v_smfmac_f32_16x16x64_bf16 v[36:39], v[4:7], v[64:71], v1
s_nop 6
v_cvt_pk_bf16_f32 v36, v36, v37
v_cvt_pk_bf16_f32 v37, v38, v39
s_waitcnt lgkmcnt(0)
v_bfi_b32 v36, 1, s45, v36
v_smfmac_f32_16x16x64_bf16 v[40:43], v[8:11], v[16:23], v1
buffer_store_dwordx2 v[36:37], v44, s[4:7], s41 offen
v_smfmac_f32_16x16x64_bf16 v[40:43], v[4:7], v[56:63], v1
s_nop 6
v_cvt_pk_bf16_f32 v40, v40, v41
v_bfi_b32 v40, 1, s45, v40
v_cvt_pk_bf16_f32 v41, v42, v43
buffer_store_dwordx2 v[40:41], v44, s[4:7], s42 offen
s_barrier
v_lshlrev_b32 v23, v0, s58
v_cndmask_b32 v16, 0, v23, s[12:13]
v_cndmask_b32 v17, 0, v23, s[14:15]
v_cndmask_b32 v18, 0, v23, s[16:17]
v_cndmask_b32 v19, 0, v23, s[18:19]
v_and_b32 v45, 0x30, v0
v_lshrrev_b32 v46, 8, v0
v_lshl_or_b32 v45, v46, 2, v45
v_bfe_u32 v46, v0, 6, 1
v_lshl_or_b32 v45, v46, 7, v45
v_cndmask_b32 v45, v45, 2.0, s[98:99]
buffer_load_dwordx4 v[48:51], v0, s[4:7], s60 offen offset:0
buffer_load_dwordx4 v[52:55], v0, s[4:7], s60 offen offset:1024
buffer_load_dwordx4 v[56:59], v0, s[4:7], s60 offen offset:2048
buffer_load_dwordx4 v[60:63], v0, s[4:7], s60 offen offset:3072
v_cndmask_b32 v20, 0, v23, s[90:91]
v_cndmask_b32 v21, 0, v23, s[92:93]
v_cndmask_b32 v22, 0, v23, s[94:95]
v_cndmask_b32 v23, 0, v23, s[96:97]
s_waitcnt vmcnt(4)
buffer_load_dwordx4 v[24:27], v0, s[4:7], s43 offen offset:0 sc1
buffer_load_dwordx4 v[28:31], v0, s[4:7], s43 offen offset:1024 sc1
buffer_load_dwordx4 v[32:35], v0, s[4:7], s43 offen offset:2048 sc1
buffer_load_dwordx4 v[36:39], v0, s[4:7], s43 offen offset:3072 sc1
s_add_u32 s33, s33, 16384
s_bitset0_b32 s33, 16
s_waitcnt vmcnt(3)
v_mfma_f32_16x16x32_bf16 v[40:43], v[24:27], v[16:19], 0
s_waitcnt vmcnt(2)
v_mfma_f32_16x16x32_bf16 v[40:43], v[28:31], v[16:19], v[40:43]
v_bitop3_b32 v46, v24, v28, s45 bitop3:0x7e
s_waitcnt vmcnt(1)
v_mfma_f32_16x16x32_bf16 v[40:43], v[32:35], v[16:19], v[40:43]
s_waitcnt vmcnt(0)
v_mfma_f32_16x16x32_bf16 v[40:43], v[36:39], v[16:19], v[40:43]
v_bitop3_b32 v47, v32, v36, s45 bitop3:0x7e
v_bitop3_b32 v46, v46, v47, 1 bitop3:0xa8
v_cmp_ne_u32 vcc, 0, v46
v_mov_b64 v[24:25], 0
v_mov_b64 v[26:27], 0
v_mov_b64 v[28:29], 0
v_mov_b64 v[30:31], 0
v_permlane32_swap_b32 v40, v41
v_permlane32_swap_b32 v42, v43
v_add_f32 v40, v40, v41
v_add_f32 v41, v42, v43
v_cvt_pk_bf16_f32 v42, v40, v41
s_cbranch_vccnz k_r1_242
k_ok1_243:
buffer_store_dword v42, v45, s[4:7], s44 offen
s_barrier
buffer_load_dwordx4 v[4:7], v0, s[4:7], s33 offen offset:0 sc1
buffer_load_dwordx4 v[8:11], v0, s[4:7], s33 offen offset:1024 sc1
s_add_u32 s34, s33, 4096
s_add_u32 s35, s33, 8192
s_add_u32 s36, s36, 524288
s_add_u32 s37, s37, 10240
s_add_u32 s59, s59, 10240
s_add_u32 s63, s63, 16384
s_bitset0_b32 s63, 16
v_mov_b64 v[32:33], 0
v_mov_b64 v[34:35], 0
v_mov_b64 v[36:37], 0
v_mov_b64 v[38:39], 0
v_mov_b64 v[40:41], 0
v_mov_b64 v[42:43], 0
v_mov_b64 v[44:45], 0
v_mov_b64 v[46:47], 0
s_add_u32 s44, s44, 16384
s_bitset0_b32 s44, 16
s_sub_u32 s45, s45, 1
s_add_u32 s31, s31, 1
ds_read_b128 v[64:67], v0 offset:36864
ds_read_b128 v[68:71], v0 offset:37888
s_waitcnt lgkmcnt(0)
buffer_load_dwordx4 v[12:15], v0, s[4:7], s34 offen offset:0 sc1
s_cmp_lg_u32 s31, s47
s_cbranch_scc1 k_T0_231
s_branch k_done_241
k_cold2_233:
s_barrier
buffer_load_dwordx4 v[48:51], v0, s[4:7], s60 offen offset:0
buffer_load_dwordx4 v[52:55], v0, s[4:7], s60 offen offset:1024
buffer_load_dwordx4 v[56:59], v0, s[4:7], s60 offen offset:2048
buffer_load_dwordx4 v[60:63], v0, s[4:7], s60 offen offset:3072
ds_read_b128 v[64:67], v0 offset:36864
ds_read_b128 v[68:71], v0 offset:37888
k_cold_232:
buffer_load_dwordx4 v[4:7], v0, s[4:7], s33 offen offset:0 sc1
buffer_load_dwordx4 v[8:11], v0, s[4:7], s33 offen offset:1024 sc1
buffer_load_dwordx4 v[12:15], v0, s[4:7], s34 offen offset:0 sc1
s_sub_u32 s32, s32, 1
s_cmp_gt_i32 s32, 0
s_cbranch_scc0 k_okC_234
v_mov_b64 v[24:25], 0
v_mov_b64 v[26:27], 0
v_mov_b64 v[28:29], 0
v_mov_b64 v[30:31], 0
v_mov_b64 v[32:33], 0
v_mov_b64 v[34:35], 0
v_mov_b64 v[36:37], 0
v_mov_b64 v[38:39], 0
v_mov_b64 v[40:41], 0
v_mov_b64 v[42:43], 0
v_mov_b64 v[44:45], 0
v_mov_b64 v[46:47], 0
s_branch k_T0_231
k_coldA_235:
buffer_load_dwordx4 v[12:15], v0, s[4:7], s34 offen offset:0 sc1
s_sub_u32 s32, s32, 1
s_cmp_gt_i32 s32, 0
s_waitcnt vmcnt(0)
v_cmp_u_f32 vcc, v12, v12
ds_write_b128 v0, v[12:15] offset:2048
s_waitcnt lgkmcnt(0)
s_cbranch_vccz k_okA_236
s_cbranch_scc1 k_coldA_235
s_branch k_okA_236
k_coldB_237:
buffer_load_dwordx4 v[16:19], v0, s[4:7], s35 offen offset:0 sc1
s_sub_u32 s32, s32, 1
s_cmp_gt_i32 s32, 0
s_waitcnt vmcnt(0)
v_cmp_u_f32 vcc, v16, v16
ds_write_b128 v0, v[16:19] offset:6144
s_waitcnt lgkmcnt(0)
s_cbranch_vccz k_okB_238
s_cbranch_scc1 k_coldB_237
s_branch k_okB_238
k_r1_242:
buffer_load_dwordx4 v[24:27], v0, s[4:7], s43 offen offset:0 sc1
buffer_load_dwordx4 v[28:31], v0, s[4:7], s43 offen offset:1024 sc1
buffer_load_dwordx4 v[32:35], v0, s[4:7], s43 offen offset:2048 sc1
buffer_load_dwordx4 v[36:39], v0, s[4:7], s43 offen offset:3072 sc1
s_sub_u32 s32, s32, 1
s_cmp_gt_i32 s32, 0
s_waitcnt vmcnt(3)
v_mfma_f32_16x16x32_bf16 v[40:43], v[24:27], v[16:19], 0
s_waitcnt vmcnt(2)
v_mfma_f32_16x16x32_bf16 v[40:43], v[28:31], v[16:19], v[40:43]
v_bitop3_b32 v46, v24, v28, s45 bitop3:0x7e
s_waitcnt vmcnt(1)
v_mfma_f32_16x16x32_bf16 v[40:43], v[32:35], v[16:19], v[40:43]
s_waitcnt vmcnt(0)
v_mfma_f32_16x16x32_bf16 v[40:43], v[36:39], v[16:19], v[40:43]
v_bitop3_b32 v47, v32, v36, s45 bitop3:0x7e
v_bitop3_b32 v46, v46, v47, 1 bitop3:0xa8
v_cmp_ne_u32 vcc, 0, v46
v_mov_b64 v[24:25], 0
v_mov_b64 v[26:27], 0
v_mov_b64 v[28:29], 0
v_mov_b64 v[30:31], 0
v_permlane32_swap_b32 v40, v41
v_permlane32_swap_b32 v42, v43
v_add_f32 v40, v40, v41
v_add_f32 v41, v42, v43
v_cvt_pk_bf16_f32 v42, v40, v41
s_cbranch_vccz k_ok1_243
s_cbranch_scc1 k_r1_242
s_branch k_ok1_243
k_slow_239:
ds_read_b128 v[24:27], v0 offset:0
ds_read_b128 v[28:31], v0 offset:1024
v_mov_b32 v46, 0xff7fffff
s_add_u32 s48, s36, 0xffffe000
buffer_load_dwordx4 v[32:35], v0, s[4:7], s48 offen offset:0 sc1
buffer_load_dwordx4 v[36:39], v0, s[4:7], s48 offen offset:1024 sc1
s_waitcnt vmcnt(1) lgkmcnt(1)
v_mfma_f32_16x16x32_bf16 v[4:7], v[32:35], v[24:27], 0
s_waitcnt vmcnt(0) lgkmcnt(0)
v_mfma_f32_16x16x32_bf16 v[4:7], v[36:39], v[28:31], v[4:7]
v_mov_b64 v[8:9], s[56:57]
s_nop 5
v_permlane32_swap_b32 v4, v6
v_permlane32_swap_b32 v5, v7
v_add_f32_dpp v8, v6, v4 row_ror:8 row_mask:0xf bank_mask:0x3
s_nop 0
v_add_f32_dpp v9, v7, v5 row_ror:8 row_mask:0xf bank_mask:0x3
v_max3_f32 v46, v46, v8, v9
s_add_u32 s48, s36, 0xfffff000
buffer_load_dwordx4 v[32:35], v0, s[4:7], s48 offen offset:0 sc1
buffer_load_dwordx4 v[36:39], v0, s[4:7], s48 offen offset:1024 sc1
s_waitcnt vmcnt(1)
v_mfma_f32_16x16x32_bf16 v[4:7], v[32:35], v[24:27], 0
s_waitcnt vmcnt(0)
v_mfma_f32_16x16x32_bf16 v[4:7], v[36:39], v[28:31], v[4:7]
v_mov_b64 v[10:11], s[56:57]
s_nop 5
v_permlane32_swap_b32 v4, v6
v_permlane32_swap_b32 v5, v7
v_add_f32_dpp v10, v6, v4 row_ror:8 row_mask:0xf bank_mask:0x3
s_nop 0
v_add_f32_dpp v11, v7, v5 row_ror:8 row_mask:0xf bank_mask:0x3
v_max3_f32 v46, v46, v10, v11
s_add_u32 s48, s36, 0x0
buffer_load_dwordx4 v[32:35], v0, s[4:7], s48 offen offset:0 sc1
buffer_load_dwordx4 v[36:39], v0, s[4:7], s48 offen offset:1024 sc1
s_waitcnt vmcnt(1)
v_mfma_f32_16x16x32_bf16 v[4:7], v[32:35], v[24:27], 0
s_waitcnt vmcnt(0)
v_mfma_f32_16x16x32_bf16 v[4:7], v[36:39], v[28:31], v[4:7]
v_mov_b64 v[12:13], s[56:57]
s_nop 5
v_permlane32_swap_b32 v4, v6
v_permlane32_swap_b32 v5, v7
v_add_f32_dpp v12, v6, v4 row_ror:8 row_mask:0xf bank_mask:0x3
s_nop 0
v_add_f32_dpp v13, v7, v5 row_ror:8 row_mask:0xf bank_mask:0x3
v_max3_f32 v46, v46, v12, v13
s_add_u32 s48, s36, 0x1000
buffer_load_dwordx4 v[32:35], v0, s[4:7], s48 offen offset:0 sc1
buffer_load_dwordx4 v[36:39], v0, s[4:7], s48 offen offset:1024 sc1
s_waitcnt vmcnt(1)
v_mfma_f32_16x16x32_bf16 v[4:7], v[32:35], v[24:27], 0
s_waitcnt vmcnt(0)
v_mfma_f32_16x16x32_bf16 v[4:7], v[36:39], v[28:31], v[4:7]
v_mov_b64 v[14:15], s[56:57]
s_nop 5
v_permlane32_swap_b32 v4, v6
v_permlane32_swap_b32 v5, v7
v_add_f32_dpp v14, v6, v4 row_ror:8 row_mask:0xf bank_mask:0x3
s_nop 0
v_add_f32_dpp v15, v7, v5 row_ror:8 row_mask:0xf bank_mask:0x3
v_max3_f32 v46, v46, v14, v15
ds_read_b128 v[32:35], v0 offset:2048
ds_read_b128 v[36:39], v0 offset:3072
s_waitcnt lgkmcnt(1)
v_mfma_f32_16x16x32_bf16 v[4:7], v[32:35], v[24:27], 0
s_waitcnt lgkmcnt(0)
v_mfma_f32_16x16x32_bf16 v[4:7], v[36:39], v[28:31], v[4:7]
v_mov_b64 v[44:45], s[56:57]
s_nop 5
v_permlane32_swap_b32 v4, v6
v_permlane32_swap_b32 v5, v7
v_add_f32_dpp v44, v6, v4 row_ror:8 row_mask:0xf bank_mask:0x3
s_nop 0
v_add_f32_dpp v45, v7, v5 row_ror:8 row_mask:0xf bank_mask:0x3
v_max3_f32 v46, v46, v44, v45
buffer_load_dwordx4 v[32:35], v0, s[4:7], s36 offen offset:2048 sc1
buffer_load_dwordx4 v[36:39], v0, s[4:7], s36 offen offset:3072 sc1
v_mov_b32 v47, v46
s_nop 1
v_permlane32_swap_b32 v46, v47
v_max_f32 v46, v46, v47
v_mov_b32 v47, v46
s_nop 1
v_permlane16_swap_b32 v46, v47
v_max_f32 v46, v46, v47
v_sub_f32 v8, v8, v46
v_exp_f32 v8, v8
v_sub_f32 v9, v9, v46
v_exp_f32 v9, v9
v_sub_f32 v10, v10, v46
v_exp_f32 v10, v10
v_sub_f32 v11, v11, v46
v_exp_f32 v11, v11
v_sub_f32 v12, v12, v46
v_exp_f32 v12, v12
v_sub_f32 v13, v13, v46
v_exp_f32 v13, v13
v_sub_f32 v14, v14, v46
v_exp_f32 v14, v14
v_sub_f32 v15, v15, v46
v_exp_f32 v15, v15
v_sub_f32 v44, v44, v46
v_exp_f32 v44, v44
v_sub_f32 v45, v45, v46
v_exp_f32 v45, v45
v_cvt_pk_bf16_f32 v4, v8, v9
v_cvt_pk_bf16_f32 v5, v10, v11
v_cvt_pk_bf16_f32 v6, v12, v13
v_cvt_pk_bf16_f32 v7, v14, v15
v_mov_b32_dpp v8, v4 row_ror:8 row_mask:0xf bank_mask:0xf
v_mov_b32_dpp v9, v5 row_ror:8 row_mask:0xf bank_mask:0xf
v_mov_b32_dpp v10, v6 row_ror:8 row_mask:0xf bank_mask:0xf
v_mov_b32_dpp v11, v7 row_ror:8 row_mask:0xf bank_mask:0xf
v_cvt_pk_bf16_f32 v24, v44, v45
v_cvt_pk_bf16_f32 v25, v44, v45
s_nop 0
v_mov_b32_dpp v26, v24 row_ror:8 row_mask:0xf bank_mask:0xf
v_mov_b32_dpp v27, v24 row_ror:8 row_mask:0xf bank_mask:0xf
v_mov_b64 v[28:29], s[52:53]
v_mov_b64 v[30:31], s[52:53]
s_nop 1
v_mfma_f32_16x16x32_bf16 v[44:47], v[28:31], v[4:7], 0
s_waitcnt vmcnt(1)
v_mfma_f32_16x16x32_bf16 v[12:15], v[32:35], v[4:7], 0
s_waitcnt vmcnt(0)
v_mfma_f32_16x16x32_bf16 v[12:15], v[36:39], v[8:11], v[12:15]
v_mfma_f32_16x16x32_bf16 v[12:15], v[40:43], v[24:27], v[12:15]
v_mov_b64 v[28:29], s[54:55]
s_nop 1
v_mfma_f32_16x16x16_bf16 v[44:47], v[28:29], v[24:25], v[44:47]
s_nop 6
v_rcp_f32 v4, v44
s_nop 1
v_rcp_f32_dpp v4, v44 row_ror:8 row_mask:0xf bank_mask:0xc
s_nop 0
v_mul_f32 v12, v4, v12
v_mul_f32 v13, v4, v13
v_mul_f32 v14, v4, v14
v_mul_f32 v15, v4, v15
v_cvt_pk_bf16_f32 v44, v12, v13
v_cvt_pk_bf16_f32 v45, v14, v15
v_and_b32 v12, 0xffffff7f, v0
v_and_or_b32 v8, v1, 8, v12
ds_write_b64 v8, v[44:45] offset:7168
v_mov_b32_dpp v46, v44 row_ror:8 row_mask:0xf bank_mask:0xf
v_mov_b32_dpp v47, v45 row_ror:8 row_mask:0xf bank_mask:0xf
v_mov_b64 v[24:25], 0
v_mov_b64 v[26:27], 0
v_mov_b64 v[28:29], 0
v_mov_b64 v[30:31], 0
v_mov_b64 v[32:33], 0
v_mov_b64 v[34:35], 0
v_mov_b64 v[36:37], 0
v_mov_b64 v[38:39], 0
s_waitcnt lgkmcnt(0)
s_branch k_okS_240
k_done_241:
buffer_load_dwordx4 v[16:19], v0, s[4:7], s35 offen offset:0 sc1
k_xs_247:
s_waitcnt vmcnt(1)
v_cmp_u_f32 vcc, v4, v12
s_waitcnt vmcnt(0)
v_cmp_u_f32 s[66:67], v16, v16
s_or_b64 vcc, vcc, s[66:67]
s_cbranch_vccz k_xd_248
buffer_load_dwordx4 v[4:7], v0, s[4:7], s33 offen offset:0 sc1
buffer_load_dwordx4 v[8:11], v0, s[4:7], s33 offen offset:1024 sc1
buffer_load_dwordx4 v[12:15], v0, s[4:7], s34 offen offset:0 sc1
buffer_load_dwordx4 v[16:19], v0, s[4:7], s35 offen offset:0 sc1
s_sub_u32 s32, s32, 1
s_cmp_gt_i32 s32, 0
s_cbranch_scc1 k_xs_247
k_xd_248:
s_waitcnt vmcnt(1)
buffer_store_dwordx4 v[12:15], v0, s[8:11], s37 offen offset:2048 sc1
s_waitcnt vmcnt(1)
buffer_store_dwordx4 v[16:19], v0, s[8:11], s59 offen offset:2048 sc1
s_add_u32 s31, s31, 1
s_branch k_jn_230
k_far_229:
s_branch k_cold2_251
k_T0_249:
s_waitcnt vmcnt(2)
v_smfmac_f32_16x16x64_bf16 v[40:43], v[4:7], v[48:55], v1
s_waitcnt vmcnt(1)
v_cmp_u_f32 vcc, v4, v8
v_smfmac_f32_16x16x64_bf16 v[24:27], v[8:11], a[24:31], v1
v_smfmac_f32_16x16x64_bf16 v[28:31], v[8:11], a[32:39], v1
s_cbranch_vccnz k_cold_250
k_okC_252:
s_waitcnt vmcnt(1)
v_smfmac_f32_16x16x64_bf16 v[36:39], v[8:11], a[40:47], v1
s_waitcnt lgkmcnt(0)
ds_read_b128 v[48:51], v2 offset:0
v_smfmac_f32_16x16x64_bf16 v[32:35], v[4:7], v[64:71], v1
ds_read_b128 v[52:55], v2 offset:1024
ds_read_b128 v[64:67], v0 offset:38912
v_smfmac_f32_16x16x64_bf16 v[44:47], v[4:7], v[56:63], v1
ds_read_b128 v[68:71], v0 offset:39936
v_smfmac_f32_16x16x64_bf16 v[28:31], v[4:7], a[8:15], v1
v_smfmac_f32_16x16x64_bf16 v[24:27], v[4:7], a[0:7], v1
ds_read_b128 v[56:59], v2 offset:28672
v_smfmac_f32_16x16x64_bf16 v[36:39], v[4:7], a[16:23], v1
ds_read_b128 v[60:63], v2 offset:29696
s_waitcnt lgkmcnt(4)
v_smfmac_f32_16x16x64_bf16 v[40:43], v[8:11], v[48:55], v1
s_waitcnt vmcnt(0)
ds_write_b128 v0, v[12:15] offset:2048
s_waitcnt lgkmcnt(3)
v_smfmac_f32_16x16x64_bf16 v[32:35], v[8:11], v[64:71], v1
buffer_load_dwordx4 v[16:19], v0, s[4:7], s35 offen offset:0 sc1
v_cmp_u_f32 vcc, v12, v12
s_waitcnt lgkmcnt(1)
v_smfmac_f32_16x16x64_bf16 v[44:47], v[8:11], v[56:63], v1
ds_read_b128 v[56:59], v2 offset:2048
ds_read_b128 v[60:63], v2 offset:3072
ds_read_b128 v[64:67], v0 offset:45056
s_cbranch_vccnz k_coldA_253
k_okA_254:
v_smfmac_f32_16x16x64_bf16 v[36:39], v[12:15], a[64:71], v1
ds_read_b128 v[68:71], v0 offset:46080
s_waitcnt lgkmcnt(4)
v_smfmac_f32_16x16x64_bf16 v[40:43], v[12:15], a[72:79], v1
s_barrier
v_smfmac_f32_16x16x64_bf16 v[28:31], v[12:15], a[56:63], v1
ds_read_b128 v[8:11], v0 offset:3072
buffer_load_dwordx4 v[48:51], v0, s[4:7], s36 offen offset:0 sc1
s_waitcnt lgkmcnt(3)
v_smfmac_f32_16x16x64_bf16 v[44:47], v[12:15], v[56:63], v1
ds_read_b128 v[56:59], v2 offset:4096
v_smfmac_f32_16x16x64_bf16 v[24:27], v[12:15], a[48:55], v1
ds_read_b128 v[60:63], v2 offset:5120
s_waitcnt lgkmcnt(3)
v_smfmac_f32_16x16x64_bf16 v[32:35], v[12:15], v[64:71], v1
buffer_load_dwordx4 v[52:55], v0, s[4:7], s36 offen offset:1024 sc1
s_waitcnt lgkmcnt(2)
v_smfmac_f32_16x16x64_bf16 v[24:27], v[8:11], a[80:87], v1
ds_read_b128 v[64:67], v0 offset:47104
ds_read_b128 v[68:71], v0 offset:48128
v_smfmac_f32_16x16x64_bf16 v[36:39], v[8:11], a[96:103], v1
buffer_store_dword v3, v0, s[20:23], s63 offen sc1
s_waitcnt lgkmcnt(2)
ds_read_b128 v[4:7], v0 offset:0
v_smfmac_f32_16x16x64_bf16 v[44:47], v[8:11], v[56:63], v1
ds_read_b128 v[56:59], v0 offset:49152
ds_read_b128 v[60:63], v0 offset:50176
v_smfmac_f32_16x16x64_bf16 v[28:31], v[8:11], a[88:95], v1
buffer_store_dwordx4 v[12:15], v0, s[8:11], s37 offen offset:2048 sc1
v_smfmac_f32_16x16x64_bf16 v[40:43], v[8:11], a[104:111], v1
s_waitcnt lgkmcnt(3)
s_waitcnt lgkmcnt(2)
v_smfmac_f32_16x16x64_bf16 v[32:35], v[8:11], v[64:71], v1
ds_read_b128 v[64:67], v0 offset:40960
ds_read_b128 v[12:15], v0 offset:1024
v_smfmac_f32_16x16x64_bf16 v[36:39], v[4:7], a[128:135], v1
s_waitcnt lgkmcnt(2)
v_smfmac_f32_16x16x64_bf16 v[44:47], v[4:7], v[56:63], v1
ds_read_b128 v[68:71], v0 offset:41984
buffer_load_dwordx4 v[56:59], v0, s[4:7], s36 offen offset:2048 sc1
v_smfmac_f32_16x16x64_bf16 v[28:31], v[4:7], a[120:127], v1
v_smfmac_f32_16x16x64_bf16 v[24:27], v[4:7], a[112:119], v1
s_waitcnt vmcnt(5)
ds_write_b128 v0, v[16:19] offset:6144
v_smfmac_f32_16x16x64_bf16 v[40:43], v[4:7], a[136:143], v1
s_waitcnt lgkmcnt(1)
buffer_load_dwordx4 v[60:63], v0, s[4:7], s36 offen offset:3072 sc1
v_cmp_u_f32 vcc, v16, v16
v_smfmac_f32_16x16x64_bf16 v[32:35], v[4:7], v[64:71], v1
ds_read_b128 v[64:67], v0 offset:43008
ds_read_b128 v[68:71], v0 offset:44032
v_smfmac_f32_16x16x64_bf16 v[28:31], v[12:15], a[152:159], v1
v_smfmac_f32_16x16x64_bf16 v[24:27], v[12:15], a[144:151], v1
s_cbranch_vccnz k_coldB_255
k_okB_256:
v_smfmac_f32_16x16x64_bf16 v[36:39], v[12:15], a[160:167], v1
s_waitcnt lgkmcnt(2)
buffer_store_dwordx4 v[16:19], v0, s[8:11], s59 offen offset:2048 sc1
s_barrier
ds_read_b128 v[4:7], v0 offset:4096
v_smfmac_f32_16x16x64_bf16 v[44:47], v[12:15], a[176:183], v1
ds_read_b128 v[8:11], v0 offset:7168
s_waitcnt lgkmcnt(2)
v_smfmac_f32_16x16x64_bf16 v[32:35], v[12:15], v[64:71], v1
ds_read_b128 v[64:67], v2 offset:34816
ds_read_b128 v[68:71], v2 offset:35840
v_smfmac_f32_16x16x64_bf16 v[24:27], v[16:19], a[184:191], v1
v_smfmac_f32_16x16x64_bf16 v[40:43], v[12:15], a[168:175], v1
s_waitcnt lgkmcnt(3)
ds_read_b128 v[12:15], v0 offset:5120
v_smfmac_f32_16x16x64_bf16 v[24:27], v[4:7], a[208:215], v1
s_waitcnt lgkmcnt(3)
v_smfmac_f32_16x16x64_bf16 v[28:31], v[4:7], a[216:223], v1
v_smfmac_f32_16x16x64_bf16 v[28:31], v[8:11], a[200:207], v1
s_waitcnt lgkmcnt(1)
v_smfmac_f32_16x16x64_bf16 v[24:27], v[8:11], v[64:71], v1
ds_read_b128 v[64:67], v2 offset:6144
s_waitcnt lgkmcnt(1)
v_smfmac_f32_16x16x64_bf16 v[24:27], v[12:15], a[224:231], v1
ds_read_b128 v[68:71], v2 offset:7168
v_smfmac_f32_16x16x64_bf16 v[28:31], v[12:15], a[232:239], v1
v_smfmac_f32_16x16x64_bf16 v[28:31], v[16:19], a[192:199], v1
v_cvt_pk_bf16_f32 v24, v24, v25
v_cvt_pk_bf16_f32 v25, v26, v27
v_smfmac_f32_16x16x64_bf16 v[32:35], v[4:7], v[80:87], v1
v_cvt_pk_bf16_f32 v26, v28, v29
v_cvt_pk_bf16_f32 v27, v30, v31
v_smfmac_f32_16x16x64_bf16 v[32:35], v[8:11], a[248:255], v1
s_waitcnt lgkmcnt(0)
v_mfma_f32_16x16x32_bf16 v[28:31], v[24:27], v[20:23], 0
v_and_b32 v26, 0xffffff7f, v0
v_smfmac_f32_16x16x64_bf16 v[32:35], v[16:19], v[64:71], v1
v_and_or_b32 v26, v1, 8, v26
v_mul_f32 v28, s51, v28
v_mul_f32 v29, s51, v29
v_mul_f32 v31, s51, v31
v_cvt_pk_bf16_f32 v24, v28, v29
v_mul_f32 v30, s51, v30
v_cvt_pk_bf16_f32 v25, v30, v31
v_smfmac_f32_16x16x64_bf16 v[32:35], v[12:15], v[96:103], v1
ds_write_b64 v26, v[24:25] offset:1024
v_smfmac_f32_16x16x64_bf16 v[36:39], v[8:11], v[72:79], v1
v_cvt_pk_bf16_f32 v32, v32, v33
v_smfmac_f32_16x16x64_bf16 v[36:39], v[16:19], a[240:247], v1
buffer_load_dwordx4 v[64:67], v0, s[4:7], s61 offen offset:0
v_cvt_pk_bf16_f32 v33, v34, v35
v_smfmac_f32_16x16x64_bf16 v[36:39], v[12:15], v[104:111], v1
s_waitcnt lgkmcnt(0)
v_smfmac_f32_16x16x64_bf16 v[36:39], v[4:7], v[88:95], v1
s_barrier
ds_read_b128 v[24:27], v0 offset:0
v_smfmac_f32_16x16x64_bf16 v[40:43], v[4:7], v[144:151], v1
ds_read_b128 v[28:31], v0 offset:1024
s_nop 0
v_cvt_pk_bf16_f32 v34, v36, v37
v_cvt_pk_bf16_f32 v35, v38, v39
s_nop 1
v_mfma_f32_16x16x32_bf16 v[36:39], v[32:35], v[20:23], 0
s_waitcnt vmcnt(6)
buffer_load_dwordx4 v[68:71], v0, s[4:7], s61 offen offset:1024
v_and_b32 v34, 0xffffff7f, v0
v_and_or_b32 v34, v1, 8, v34
s_waitcnt lgkmcnt(1)
v_mfma_f32_16x16x32_bf16 v[48:51], v[48:51], v[24:27], 0
v_cvt_pk_bf16_f32 v32, v36, v37
s_waitcnt lgkmcnt(0)
v_mfma_f32_16x16x32_bf16 v[48:51], v[52:55], v[28:31], v[48:51]
v_mov_b64 v[52:53], s[56:57]
v_cvt_pk_bf16_f32 v33, v38, v39
v_smfmac_f32_16x16x64_bf16 v[44:47], v[4:7], v[152:159], v1
ds_write_b64 v34, v[32:33] offset:3072
v_permlane32_swap_b32 v48, v50
v_permlane32_swap_b32 v49, v51
v_add_f32_dpp v52, v50, v48 row_ror:8 row_mask:0xf bank_mask:0x3
v_exp_f32 v52, v52
v_add_f32_dpp v53, v51, v49 row_ror:8 row_mask:0xf bank_mask:0x3
v_exp_f32 v53, v53
s_nop 0
v_cvt_pk_bf16_f32 v48, v52, v53
v_smfmac_f32_16x16x64_bf16 v[44:47], v[16:19], v[120:127], v1
ds_write_b32 v0, v48 offset:4104
v_smfmac_f32_16x16x64_bf16 v[44:47], v[12:15], v[168:175], v1
buffer_load_dwordx4 v[48:51], v0, s[4:7], s61 offen offset:2048
v_smfmac_f32_16x16x64_bf16 v[40:43], v[12:15], v[160:167], v1
s_waitcnt lgkmcnt(1)
v_xor_b32 v12, 0x80, v0
v_smfmac_f32_16x16x64_bf16 v[40:43], v[8:11], v[128:135], v1
s_waitcnt lgkmcnt(0)
s_barrier
ds_read_b128 v[32:35], v0 offset:2048
v_mov_b64 v[22:23], s[52:53]
v_smfmac_f32_16x16x64_bf16 v[40:43], v[16:19], v[112:119], v1
ds_read_b128 v[36:39], v0 offset:3072
ds_read_b128 v[16:19], v0 offset:4096
buffer_load_dwordx4 v[52:55], v0, s[4:7], s61 offen offset:3072
v_smfmac_f32_16x16x64_bf16 v[44:47], v[8:11], v[136:143], v1
ds_read_b128 v[12:15], v12 offset:4096
v_cvt_pk_bf16_f32 v40, v40, v41
v_mov_b64 v[20:21], s[52:53]
s_waitcnt lgkmcnt(3)
v_mfma_f32_16x16x32_bf16 v[24:27], v[32:35], v[24:27], 0
v_cvt_pk_bf16_f32 v41, v42, v43
s_waitcnt lgkmcnt(2)
v_mfma_f32_16x16x32_bf16 v[24:27], v[36:39], v[28:31], v[24:27]
s_waitcnt vmcnt(5)
s_waitcnt lgkmcnt(1)
v_mfma_f32_16x16x32_bf16 v[8:11], v[56:59], v[16:19], 0
buffer_load_dwordx4 v[56:59], v0, s[4:7], s62 offen offset:0
v_mov_b64 v[28:29], s[56:57]
v_cvt_pk_bf16_f32 v43, v46, v47
v_cvt_pk_bf16_f32 v42, v44, v45
v_permlane32_swap_b32 v25, v27
v_permlane32_swap_b32 v24, v26
v_mfma_f32_16x16x32_bf16 v[4:7], v[20:23], v[16:19], 0
s_waitcnt lgkmcnt(0)
v_add_f32_dpp v28, v26, v24 row_ror:8 row_mask:0xf bank_mask:0x3
v_add_f32_dpp v29, v27, v25 row_ror:8 row_mask:0xf bank_mask:0x3
v_exp_f32 v28, v28
v_mfma_f32_16x16x32_bf16 v[8:11], v[60:63], v[12:15], v[8:11]
buffer_load_dwordx4 v[60:63], v0, s[4:7], s62 offen offset:1024
v_exp_f32 v29, v29
v_permlane32_swap_b32 v42, v43
v_cvt_pk_bf16_f32 v24, v28, v29
v_mov_b64 v[44:45], s[54:55]
v_cvt_pk_bf16_f32 v25, v28, v29
v_mov_b32_dpp v26, v24 row_ror:8 row_mask:0xf bank_mask:0xf
v_mov_b32_dpp v27, v24 row_ror:8 row_mask:0xf bank_mask:0xf
v_mfma_f32_16x16x16_bf16 v[4:7], v[44:45], v[24:25], v[4:7]
v_permlane32_swap_b32 v40, v41
v_mov_b64 v[36:37], 0
v_mov_b64 v[38:39], 0
v_mov_b64 v[30:31], 0
v_mfma_f32_16x16x32_bf16 v[8:11], v[40:43], v[24:27], v[8:11]
buffer_load_dwordx4 v[16:19], v0, s[4:7], s62 offen offset:2048
v_rcp_f32 v6, v4
v_and_b32 v12, 0xffffff7f, v0
v_and_or_b32 v13, v1, 8, v12
v_rcp_f32_dpp v6, v4 row_ror:8 row_mask:0xf bank_mask:0xc
v_mov_b64 v[26:27], 0
v_pk_mul_f32 v[8:9], v[8:9], v[6:7] op_sel_hi:[1,0]
v_cvt_pk_bf16_f32 v44, v8, v9
v_pk_mul_f32 v[10:11], v[10:11], v[6:7] op_sel_hi:[1,0]
v_cvt_pk_bf16_f32 v45, v10, v11
s_waitcnt vmcnt(5)
ds_write_b64 v13, v[44:45] offset:7168
buffer_load_dwordx4 v[20:23], v0, s[4:7], s62 offen offset:3072
v_add_u32 v6, 0xd4800000, v6
v_cmp_lt_u32 vcc, 0x28000000, v6
v_mov_b64 v[34:35], 0
v_mov_b32_dpp v46, v44 row_ror:8 row_mask:0xf bank_mask:0xf
v_mov_b32_dpp v47, v45 row_ror:8 row_mask:0xf bank_mask:0xf
v_mov_b64 v[28:29], 0
v_mov_b64 v[32:33], 0
s_cbranch_vccnz k_slow_257
k_okS_258:
v_smfmac_f32_16x16x64_bf16 v[36:39], v[44:47], v[224:231], v1
s_waitcnt lgkmcnt(0)
s_barrier
ds_read_b128 v[8:11], v12 offset:6144
v_smfmac_f32_16x16x64_bf16 v[32:35], v[44:47], v[200:207], v1
s_waitcnt vmcnt(4)
ds_read_b128 v[4:7], v12 offset:7296
v_mov_b64 v[24:25], 0
v_smfmac_f32_16x16x64_bf16 v[28:31], v[44:47], v[48:55], v1
ds_read_b128 v[12:15], v12 offset:6272
ds_read_b128 v[48:51], v2 offset:26624
v_smfmac_f32_16x16x64_bf16 v[24:27], v[44:47], v[64:71], v1
ds_read_b128 v[52:55], v2 offset:27648
v_mov_b64 v[42:43], 0
s_waitcnt lgkmcnt(4)
v_smfmac_f32_16x16x64_bf16 v[24:27], v[8:11], v[184:191], v1
s_waitcnt lgkmcnt(3)
v_mov_b64 v[40:41], 0
v_smfmac_f32_16x16x64_bf16 v[24:27], v[4:7], v[176:183], v1
s_waitcnt lgkmcnt(2)
ds_read_b128 v[64:67], v2 offset:10240
v_smfmac_f32_16x16x64_bf16 v[24:27], v[12:15], v[192:199], v1
ds_read_b128 v[68:71], v2 offset:11264
v_smfmac_f32_16x16x64_bf16 v[40:43], v[44:47], v[240:247], v1
s_waitcnt vmcnt(2)
s_waitcnt lgkmcnt(2)
v_lshrrev_b32 v44, 16, v1
v_cvt_pk_bf16_f32 v24, v24, v25
v_bfi_b32 v24, 1, s45, v24
v_cvt_pk_bf16_f32 v25, v26, v27
v_smfmac_f32_16x16x64_bf16 v[28:31], v[8:11], v[48:55], v1
buffer_store_dwordx2 v[24:25], v44, s[4:7], s38 offen sc1
ds_read_b128 v[48:51], v2 offset:24576
ds_read_b128 v[52:55], v2 offset:25600
v_smfmac_f32_16x16x64_bf16 v[28:31], v[12:15], v[56:63], v1
s_waitcnt lgkmcnt(2)
ds_read_b128 v[56:59], v2 offset:8192
v_smfmac_f32_16x16x64_bf16 v[28:31], v[4:7], v[64:71], v1
ds_read_b128 v[60:63], v2 offset:9216
v_smfmac_f32_16x16x64_bf16 v[32:35], v[8:11], v[208:215], v1
ds_read_b128 v[64:67], v2 offset:30720
s_nop 0
v_cvt_pk_bf16_f32 v28, v28, v29
v_bfi_b32 v28, 1, s45, v28
v_cvt_pk_bf16_f32 v29, v30, v31
v_smfmac_f32_16x16x64_bf16 v[32:35], v[12:15], v[216:223], v1
buffer_store_dwordx2 v[28:29], v44, s[4:7], s39 offen sc1
v_smfmac_f32_16x16x64_bf16 v[40:43], v[12:15], v[248:255], v1
ds_read_b128 v[68:71], v2 offset:31744
s_waitcnt vmcnt(2)
v_smfmac_f32_16x16x64_bf16 v[32:35], v[4:7], v[16:23], v1
s_waitcnt lgkmcnt(2)
v_smfmac_f32_16x16x64_bf16 v[36:39], v[12:15], v[232:239], v1
ds_read_b128 v[16:19], v2 offset:32768
ds_read_b128 v[20:23], v2 offset:33792
v_cvt_pk_bf16_f32 v32, v32, v33
v_bfi_b32 v32, 1, s45, v32
v_cvt_pk_bf16_f32 v33, v34, v35
v_smfmac_f32_16x16x64_bf16 v[36:39], v[8:11], v[48:55], v1
buffer_store_dwordx2 v[32:33], v44, s[4:7], s40 offen sc1
s_waitcnt lgkmcnt(2)
v_smfmac_f32_16x16x64_bf16 v[36:39], v[4:7], v[64:71], v1
s_nop 6
v_cvt_pk_bf16_f32 v36, v36, v37
v_cvt_pk_bf16_f32 v37, v38, v39
s_waitcnt lgkmcnt(0)
v_bfi_b32 v36, 1, s45, v36
v_smfmac_f32_16x16x64_bf16 v[40:43], v[8:11], v[16:23], v1
buffer_store_dwordx2 v[36:37], v44, s[4:7], s41 offen sc1
v_smfmac_f32_16x16x64_bf16 v[40:43], v[4:7], v[56:63], v1
s_nop 6
v_cvt_pk_bf16_f32 v40, v40, v41
v_bfi_b32 v40, 1, s45, v40
v_cvt_pk_bf16_f32 v41, v42, v43
buffer_store_dwordx2 v[40:41], v44, s[4:7], s42 offen sc1
s_barrier
v_lshlrev_b32 v23, v0, s58
v_cndmask_b32 v16, 0, v23, s[12:13]
v_cndmask_b32 v17, 0, v23, s[14:15]
v_cndmask_b32 v18, 0, v23, s[16:17]
v_cndmask_b32 v19, 0, v23, s[18:19]
v_and_b32 v45, 0x30, v0
v_lshrrev_b32 v46, 8, v0
v_lshl_or_b32 v45, v46, 2, v45
v_bfe_u32 v46, v0, 6, 1
v_lshl_or_b32 v45, v46, 7, v45
v_cndmask_b32 v45, v45, 2.0, s[98:99]
buffer_load_dwordx4 v[48:51], v0, s[4:7], s60 offen offset:0
buffer_load_dwordx4 v[52:55], v0, s[4:7], s60 offen offset:1024
buffer_load_dwordx4 v[56:59], v0, s[4:7], s60 offen offset:2048
buffer_load_dwordx4 v[60:63], v0, s[4:7], s60 offen offset:3072
v_cndmask_b32 v20, 0, v23, s[90:91]
v_cndmask_b32 v21, 0, v23, s[92:93]
v_cndmask_b32 v22, 0, v23, s[94:95]
v_cndmask_b32 v23, 0, v23, s[96:97]
s_waitcnt vmcnt(4)
buffer_load_dwordx4 v[24:27], v0, s[4:7], s43 offen offset:0 sc1
buffer_load_dwordx4 v[28:31], v0, s[4:7], s43 offen offset:1024 sc1
buffer_load_dwordx4 v[32:35], v0, s[4:7], s43 offen offset:2048 sc1
buffer_load_dwordx4 v[36:39], v0, s[4:7], s43 offen offset:3072 sc1
s_add_u32 s33, s33, 16384
s_bitset0_b32 s33, 16
s_waitcnt vmcnt(3)
v_mfma_f32_16x16x32_bf16 v[40:43], v[24:27], v[16:19], 0
s_waitcnt vmcnt(2)
v_mfma_f32_16x16x32_bf16 v[40:43], v[28:31], v[16:19], v[40:43]
v_bitop3_b32 v46, v24, v28, s45 bitop3:0x7e
s_waitcnt vmcnt(1)
v_mfma_f32_16x16x32_bf16 v[40:43], v[32:35], v[16:19], v[40:43]
s_waitcnt vmcnt(0)
v_mfma_f32_16x16x32_bf16 v[40:43], v[36:39], v[16:19], v[40:43]
v_bitop3_b32 v47, v32, v36, s45 bitop3:0x7e
v_bitop3_b32 v46, v46, v47, 1 bitop3:0xa8
v_cmp_ne_u32 vcc, 0, v46
v_mov_b64 v[24:25], 0
v_mov_b64 v[26:27], 0
v_mov_b64 v[28:29], 0
v_mov_b64 v[30:31], 0
v_permlane32_swap_b32 v40, v41
v_permlane32_swap_b32 v42, v43
v_add_f32 v40, v40, v41
v_add_f32 v41, v42, v43
v_cvt_pk_bf16_f32 v42, v40, v41
s_cbranch_vccnz k_r1_260
k_ok1_261:
buffer_store_dword v42, v45, s[4:7], s44 offen sc1
s_barrier
buffer_load_dwordx4 v[4:7], v0, s[4:7], s33 offen offset:0 sc1
buffer_load_dwordx4 v[8:11], v0, s[4:7], s33 offen offset:1024 sc1
s_add_u32 s34, s33, 4096
s_add_u32 s35, s33, 8192
s_add_u32 s36, s36, 524288
s_add_u32 s37, s37, 10240
s_add_u32 s59, s59, 10240
s_add_u32 s63, s63, 16384
s_bitset0_b32 s63, 16
v_mov_b64 v[32:33], 0
v_mov_b64 v[34:35], 0
v_mov_b64 v[36:37], 0
v_mov_b64 v[38:39], 0
v_mov_b64 v[40:41], 0
v_mov_b64 v[42:43], 0
v_mov_b64 v[44:45], 0
v_mov_b64 v[46:47], 0
s_add_u32 s44, s44, 16384
s_bitset0_b32 s44, 16
s_sub_u32 s45, s45, 1
s_add_u32 s31, s31, 1
ds_read_b128 v[64:67], v0 offset:36864
ds_read_b128 v[68:71], v0 offset:37888
s_waitcnt lgkmcnt(0)
buffer_load_dwordx4 v[12:15], v0, s[4:7], s34 offen offset:0 sc1
s_cmp_lg_u32 s31, s47
s_cbranch_scc1 k_T0_249
s_branch k_done_259
k_cold2_251:
s_barrier
buffer_load_dwordx4 v[48:51], v0, s[4:7], s60 offen offset:0
buffer_load_dwordx4 v[52:55], v0, s[4:7], s60 offen offset:1024
buffer_load_dwordx4 v[56:59], v0, s[4:7], s60 offen offset:2048
buffer_load_dwordx4 v[60:63], v0, s[4:7], s60 offen offset:3072
ds_read_b128 v[64:67], v0 offset:36864
ds_read_b128 v[68:71], v0 offset:37888
k_cold_250:
buffer_load_dwordx4 v[4:7], v0, s[4:7], s33 offen offset:0 sc1
buffer_load_dwordx4 v[8:11], v0, s[4:7], s33 offen offset:1024 sc1
buffer_load_dwordx4 v[12:15], v0, s[4:7], s34 offen offset:0 sc1
s_sub_u32 s32, s32, 1
s_cmp_gt_i32 s32, 0
s_cbranch_scc0 k_okC_252
v_mov_b64 v[24:25], 0
v_mov_b64 v[26:27], 0
v_mov_b64 v[28:29], 0
v_mov_b64 v[30:31], 0
v_mov_b64 v[32:33], 0
v_mov_b64 v[34:35], 0
v_mov_b64 v[36:37], 0
v_mov_b64 v[38:39], 0
v_mov_b64 v[40:41], 0
v_mov_b64 v[42:43], 0
v_mov_b64 v[44:45], 0
v_mov_b64 v[46:47], 0
s_branch k_T0_249
k_coldA_253:
buffer_load_dwordx4 v[12:15], v0, s[4:7], s34 offen offset:0 sc1
s_sub_u32 s32, s32, 1
s_cmp_gt_i32 s32, 0
s_waitcnt vmcnt(0)
v_cmp_u_f32 vcc, v12, v12
ds_write_b128 v0, v[12:15] offset:2048
s_waitcnt lgkmcnt(0)
s_cbranch_vccz k_okA_254
s_cbranch_scc1 k_coldA_253
s_branch k_okA_254
k_coldB_255:
buffer_load_dwordx4 v[16:19], v0, s[4:7], s35 offen offset:0 sc1
s_sub_u32 s32, s32, 1
s_cmp_gt_i32 s32, 0
s_waitcnt vmcnt(0)
v_cmp_u_f32 vcc, v16, v16
ds_write_b128 v0, v[16:19] offset:6144
s_waitcnt lgkmcnt(0)
s_cbranch_vccz k_okB_256
s_cbranch_scc1 k_coldB_255
s_branch k_okB_256
k_r1_260:
buffer_load_dwordx4 v[24:27], v0, s[4:7], s43 offen offset:0 sc1
buffer_load_dwordx4 v[28:31], v0, s[4:7], s43 offen offset:1024 sc1
buffer_load_dwordx4 v[32:35], v0, s[4:7], s43 offen offset:2048 sc1
buffer_load_dwordx4 v[36:39], v0, s[4:7], s43 offen offset:3072 sc1
s_sub_u32 s32, s32, 1
s_cmp_gt_i32 s32, 0
s_waitcnt vmcnt(3)
v_mfma_f32_16x16x32_bf16 v[40:43], v[24:27], v[16:19], 0
s_waitcnt vmcnt(2)
v_mfma_f32_16x16x32_bf16 v[40:43], v[28:31], v[16:19], v[40:43]
v_bitop3_b32 v46, v24, v28, s45 bitop3:0x7e
s_waitcnt vmcnt(1)
v_mfma_f32_16x16x32_bf16 v[40:43], v[32:35], v[16:19], v[40:43]
s_waitcnt vmcnt(0)
v_mfma_f32_16x16x32_bf16 v[40:43], v[36:39], v[16:19], v[40:43]
v_bitop3_b32 v47, v32, v36, s45 bitop3:0x7e
v_bitop3_b32 v46, v46, v47, 1 bitop3:0xa8
v_cmp_ne_u32 vcc, 0, v46
v_mov_b64 v[24:25], 0
v_mov_b64 v[26:27], 0
v_mov_b64 v[28:29], 0
v_mov_b64 v[30:31], 0
v_permlane32_swap_b32 v40, v41
v_permlane32_swap_b32 v42, v43
v_add_f32 v40, v40, v41
v_add_f32 v41, v42, v43
v_cvt_pk_bf16_f32 v42, v40, v41
s_cbranch_vccz k_ok1_261
s_cbranch_scc1 k_r1_260
s_branch k_ok1_261
k_slow_257:
ds_read_b128 v[24:27], v0 offset:0
ds_read_b128 v[28:31], v0 offset:1024
v_mov_b32 v46, 0xff7fffff
s_add_u32 s48, s36, 0xffffe000
buffer_load_dwordx4 v[32:35], v0, s[4:7], s48 offen offset:0 sc1
buffer_load_dwordx4 v[36:39], v0, s[4:7], s48 offen offset:1024 sc1
s_waitcnt vmcnt(1) lgkmcnt(1)
v_mfma_f32_16x16x32_bf16 v[4:7], v[32:35], v[24:27], 0
s_waitcnt vmcnt(0) lgkmcnt(0)
v_mfma_f32_16x16x32_bf16 v[4:7], v[36:39], v[28:31], v[4:7]
v_mov_b64 v[8:9], s[56:57]
s_nop 5
v_permlane32_swap_b32 v4, v6
v_permlane32_swap_b32 v5, v7
v_add_f32_dpp v8, v6, v4 row_ror:8 row_mask:0xf bank_mask:0x3
s_nop 0
v_add_f32_dpp v9, v7, v5 row_ror:8 row_mask:0xf bank_mask:0x3
v_max3_f32 v46, v46, v8, v9
s_add_u32 s48, s36, 0xfffff000
buffer_load_dwordx4 v[32:35], v0, s[4:7], s48 offen offset:0 sc1
buffer_load_dwordx4 v[36:39], v0, s[4:7], s48 offen offset:1024 sc1
s_waitcnt vmcnt(1)
v_mfma_f32_16x16x32_bf16 v[4:7], v[32:35], v[24:27], 0
s_waitcnt vmcnt(0)
v_mfma_f32_16x16x32_bf16 v[4:7], v[36:39], v[28:31], v[4:7]
v_mov_b64 v[10:11], s[56:57]
s_nop 5
v_permlane32_swap_b32 v4, v6
v_permlane32_swap_b32 v5, v7
v_add_f32_dpp v10, v6, v4 row_ror:8 row_mask:0xf bank_mask:0x3
s_nop 0
v_add_f32_dpp v11, v7, v5 row_ror:8 row_mask:0xf bank_mask:0x3
v_max3_f32 v46, v46, v10, v11
s_add_u32 s48, s36, 0x0
buffer_load_dwordx4 v[32:35], v0, s[4:7], s48 offen offset:0 sc1
buffer_load_dwordx4 v[36:39], v0, s[4:7], s48 offen offset:1024 sc1
s_waitcnt vmcnt(1)
v_mfma_f32_16x16x32_bf16 v[4:7], v[32:35], v[24:27], 0
s_waitcnt vmcnt(0)
v_mfma_f32_16x16x32_bf16 v[4:7], v[36:39], v[28:31], v[4:7]
v_mov_b64 v[12:13], s[56:57]
s_nop 5
v_permlane32_swap_b32 v4, v6
v_permlane32_swap_b32 v5, v7
v_add_f32_dpp v12, v6, v4 row_ror:8 row_mask:0xf bank_mask:0x3
s_nop 0
v_add_f32_dpp v13, v7, v5 row_ror:8 row_mask:0xf bank_mask:0x3
v_max3_f32 v46, v46, v12, v13
s_add_u32 s48, s36, 0x1000
buffer_load_dwordx4 v[32:35], v0, s[4:7], s48 offen offset:0 sc1
buffer_load_dwordx4 v[36:39], v0, s[4:7], s48 offen offset:1024 sc1
s_waitcnt vmcnt(1)
v_mfma_f32_16x16x32_bf16 v[4:7], v[32:35], v[24:27], 0
s_waitcnt vmcnt(0)
v_mfma_f32_16x16x32_bf16 v[4:7], v[36:39], v[28:31], v[4:7]
v_mov_b64 v[14:15], s[56:57]
s_nop 5
v_permlane32_swap_b32 v4, v6
v_permlane32_swap_b32 v5, v7
v_add_f32_dpp v14, v6, v4 row_ror:8 row_mask:0xf bank_mask:0x3
s_nop 0
v_add_f32_dpp v15, v7, v5 row_ror:8 row_mask:0xf bank_mask:0x3
v_max3_f32 v46, v46, v14, v15
ds_read_b128 v[32:35], v0 offset:2048
ds_read_b128 v[36:39], v0 offset:3072
s_waitcnt lgkmcnt(1)
v_mfma_f32_16x16x32_bf16 v[4:7], v[32:35], v[24:27], 0
s_waitcnt lgkmcnt(0)
v_mfma_f32_16x16x32_bf16 v[4:7], v[36:39], v[28:31], v[4:7]
v_mov_b64 v[44:45], s[56:57]
s_nop 5
v_permlane32_swap_b32 v4, v6
v_permlane32_swap_b32 v5, v7
v_add_f32_dpp v44, v6, v4 row_ror:8 row_mask:0xf bank_mask:0x3
s_nop 0
v_add_f32_dpp v45, v7, v5 row_ror:8 row_mask:0xf bank_mask:0x3
v_max3_f32 v46, v46, v44, v45
buffer_load_dwordx4 v[32:35], v0, s[4:7], s36 offen offset:2048 sc1
buffer_load_dwordx4 v[36:39], v0, s[4:7], s36 offen offset:3072 sc1
v_mov_b32 v47, v46
s_nop 1
v_permlane32_swap_b32 v46, v47
v_max_f32 v46, v46, v47
v_mov_b32 v47, v46
s_nop 1
v_permlane16_swap_b32 v46, v47
v_max_f32 v46, v46, v47
v_sub_f32 v8, v8, v46
v_exp_f32 v8, v8
v_sub_f32 v9, v9, v46
v_exp_f32 v9, v9
v_sub_f32 v10, v10, v46
v_exp_f32 v10, v10
v_sub_f32 v11, v11, v46
v_exp_f32 v11, v11
v_sub_f32 v12, v12, v46
v_exp_f32 v12, v12
v_sub_f32 v13, v13, v46
v_exp_f32 v13, v13
v_sub_f32 v14, v14, v46
v_exp_f32 v14, v14
v_sub_f32 v15, v15, v46
v_exp_f32 v15, v15
v_sub_f32 v44, v44, v46
v_exp_f32 v44, v44
v_sub_f32 v45, v45, v46
v_exp_f32 v45, v45
v_cvt_pk_bf16_f32 v4, v8, v9
v_cvt_pk_bf16_f32 v5, v10, v11
v_cvt_pk_bf16_f32 v6, v12, v13
v_cvt_pk_bf16_f32 v7, v14, v15
v_mov_b32_dpp v8, v4 row_ror:8 row_mask:0xf bank_mask:0xf
v_mov_b32_dpp v9, v5 row_ror:8 row_mask:0xf bank_mask:0xf
v_mov_b32_dpp v10, v6 row_ror:8 row_mask:0xf bank_mask:0xf
v_mov_b32_dpp v11, v7 row_ror:8 row_mask:0xf bank_mask:0xf
v_cvt_pk_bf16_f32 v24, v44, v45
v_cvt_pk_bf16_f32 v25, v44, v45
s_nop 0
v_mov_b32_dpp v26, v24 row_ror:8 row_mask:0xf bank_mask:0xf
v_mov_b32_dpp v27, v24 row_ror:8 row_mask:0xf bank_mask:0xf
v_mov_b64 v[28:29], s[52:53]
v_mov_b64 v[30:31], s[52:53]
s_nop 1
v_mfma_f32_16x16x32_bf16 v[44:47], v[28:31], v[4:7], 0
s_waitcnt vmcnt(1)
v_mfma_f32_16x16x32_bf16 v[12:15], v[32:35], v[4:7], 0
s_waitcnt vmcnt(0)
v_mfma_f32_16x16x32_bf16 v[12:15], v[36:39], v[8:11], v[12:15]
v_mfma_f32_16x16x32_bf16 v[12:15], v[40:43], v[24:27], v[12:15]
v_mov_b64 v[28:29], s[54:55]
s_nop 1
v_mfma_f32_16x16x16_bf16 v[44:47], v[28:29], v[24:25], v[44:47]
s_nop 6
v_rcp_f32 v4, v44
s_nop 1
v_rcp_f32_dpp v4, v44 row_ror:8 row_mask:0xf bank_mask:0xc
s_nop 0
v_mul_f32 v12, v4, v12
v_mul_f32 v13, v4, v13
v_mul_f32 v14, v4, v14
v_mul_f32 v15, v4, v15
v_cvt_pk_bf16_f32 v44, v12, v13
v_cvt_pk_bf16_f32 v45, v14, v15
v_and_b32 v12, 0xffffff7f, v0
v_and_or_b32 v8, v1, 8, v12
ds_write_b64 v8, v[44:45] offset:7168
v_mov_b32_dpp v46, v44 row_ror:8 row_mask:0xf bank_mask:0xf
v_mov_b32_dpp v47, v45 row_ror:8 row_mask:0xf bank_mask:0xf
v_mov_b64 v[24:25], 0
v_mov_b64 v[26:27], 0
v_mov_b64 v[28:29], 0
v_mov_b64 v[30:31], 0
v_mov_b64 v[32:33], 0
v_mov_b64 v[34:35], 0
v_mov_b64 v[36:37], 0
v_mov_b64 v[38:39], 0
s_waitcnt lgkmcnt(0)
s_branch k_okS_258
k_done_259:
buffer_load_dwordx4 v[16:19], v0, s[4:7], s35 offen offset:0 sc1
k_xs_265:
s_waitcnt vmcnt(1)
v_cmp_u_f32 vcc, v4, v12
s_waitcnt vmcnt(0)
v_cmp_u_f32 s[66:67], v16, v16
s_or_b64 vcc, vcc, s[66:67]
s_cbranch_vccz k_xd_266
buffer_load_dwordx4 v[4:7], v0, s[4:7], s33 offen offset:0 sc1
buffer_load_dwordx4 v[8:11], v0, s[4:7], s33 offen offset:1024 sc1
buffer_load_dwordx4 v[12:15], v0, s[4:7], s34 offen offset:0 sc1
buffer_load_dwordx4 v[16:19], v0, s[4:7], s35 offen offset:0 sc1
s_sub_u32 s32, s32, 1
s_cmp_gt_i32 s32, 0
s_cbranch_scc1 k_xs_265
k_xd_266:
s_waitcnt vmcnt(1)
buffer_store_dwordx4 v[12:15], v0, s[8:11], s37 offen offset:2048 sc1
s_waitcnt vmcnt(1)
buffer_store_dwordx4 v[16:19], v0, s[8:11], s59 offen offset:2048 sc1
s_add_u32 s31, s31, 1
k_jn_230:
s_cmp_lt_u32 s31, 128
s_cbranch_scc1 k_lay_221
s_add_u32 s30, s30, 112
s_waitcnt vmcnt(0) lgkmcnt(0)
s_barrier
s_branch k_fin_7
k_w3_128:
v_lshlrev_b32 v0, 4, v0
s_mov_b32 s90, 0x300003
s_mov_b32 s91, 0x300003
s_mov_b32 s92, 0xc0000c
s_mov_b32 s93, 0xc0000c
s_mov_b32 s94, 0x30000300
s_mov_b32 s95, 0x30000300
s_mov_b32 s96, 0xc0000c00
s_mov_b32 s97, 0xc0000c00
s_mov_b32 s98, 0xff00ff00
s_mov_b32 s99, 0xff00ff00
v_mov_b32 v1, 0x4444
v_mov_b32 v4, 0xeeee
v_cndmask_b32 v1, v1, v4, s[98:99]
v_lshrrev_b32 v4, 8, v0
v_lshl_or_b32 v1, v4, 28, v1
v_bfe_u32 v4, v0, 4, 4
v_lshl_or_b32 v1, v4, 19, v1
s_mov_b32 s51, 0x3e0293ee
s_mov_b32 s52, 0x3f803f80
s_mov_b32 s53, 0x3f803f80
s_mov_b32 s54, 0x3f003f00
s_mov_b32 s55, 0x3f003f00
s_mov_b32 s56, 0xff800000
s_mov_b32 s57, 0xff800000
s_mov_b32 s58, 0x3f80
s_mov_b32 s31, 0
s_mov_b32 s45, -2
s_lshl_b32 s46, s30, 6
s_add_u32 s46, s46, 222330880
s_lshl_b32 s48, s30, 7
s_and_b32 s49, s30, 31
s_lshl_b32 s49, s49, 12
s_add_u32 s43, s49, 119537664
v_mov_b64 v[12:13], -1
s_add_u32 s38, s48, 119586816
s_add_u32 s39, s48, 119652352
s_add_u32 s40, s48, 119717888
s_add_u32 s41, s48, 119783424
s_add_u32 s42, s48, 119848960
v_lshrrev_b32 v4, 16, v1
buffer_store_dwordx2 v[12:13], v4, s[4:7], s38 offen sc1
buffer_store_dwordx2 v[12:13], v4, s[4:7], s39 offen sc1
buffer_store_dwordx2 v[12:13], v4, s[4:7], s40 offen sc1
buffer_store_dwordx2 v[12:13], v4, s[4:7], s41 offen sc1
buffer_store_dwordx2 v[12:13], v4, s[4:7], s42 offen sc1
s_add_u32 s47, s31, 63
s_mul_i32 s33, s31, 0
s_add_u32 s33, s33, 120324096
s_add_u32 s34, s33, 5120
s_add_u32 s35, s33, 9216
s_mul_i32 s48, s31, 655360
s_lshl_b32 s36, s30, 14
s_add_u32 s36, s36, s48
s_add_u32 s36, s36, 12288
v_mov_b32 v36, -1
s_lshl_b32 s63, s30, 10
s_add_u32 s63, s63, 0x8000
s_add_u32 s63, s63, s33
s_lshl_b32 s37, s31, 14
s_add_u32 s37, s37, 117443584
s_add_u32 s59, s37, 4096
v_lshrrev_b32 v0, 4, v0
v_lshrrev_b32 v12, 3, v0
v_lshlrev_b32 v10, 13, v12
v_bfe_u32 v12, v0, 1, 2
v_lshrrev_b32 v13, 4, v0
v_xor_b32 v12, v12, v13
v_lshl_add_u32 v10, v12, 5, v10
v_and_b32 v14, 1, v0
v_lshl_add_u32 v10, v14, 4, v10
v_mul_u32_u24 v11, 1280, v13
v_bfe_u32 v12, v0, 1, 3
v_and_b32 v13, 1, v13
v_lshlrev_b32 v13, 1, v13
v_xor_b32 v12, v12, v13
v_xor_b32 v12, 4, v12
v_lshl_add_u32 v11, v12, 5, v11
v_lshl_add_u32 v11, v14, 4, v11
v_bfe_u32 v12, v0, 5, 1
v_lshlrev_b32 v12, 4, v12
v_bfe_u32 v13, v0, 4, 1
v_lshl_add_u32 v12, v13, 1, v12
v_bfe_u32 v13, v0, 2, 1
v_lshl_add_u32 v12, v13, 2, v12
v_bfe_u32 v13, v0, 3, 1
v_mul_u32_u24 v15, 4224, v13
v_add_u32 v12, v13, v12
v_bfe_u32 v13, v12, 1, 2
v_xor_b32 v13, 3, v13
v_lshlrev_b32 v13, 5, v13
v_lshl_add_u32 v4, v12, 7, v13
v_and_b32 v14, 3, v0
v_lshl_add_u32 v4, v14, 3, v4
v_add_u32 v5, 0x10000, v4
v_add_u32 v6, 0x20000, v4
v_bfe_u32 v12, v0, 4, 1
v_lshlrev_b32 v13, 4, v12
v_lshlrev_b32 v12, 2, v12
v_bfe_u32 v8, v0, 5, 1
v_lshl_add_u32 v13, v8, 2, v13
v_bfe_u32 v8, v0, 2, 1
v_add_u32 v13, v8, v13
v_lshl_add_u32 v12, v8, 1, v12
v_bfe_u32 v8, v0, 3, 1
v_add_u32 v8, 6, v8
v_xor_b32 v12, v12, v8
v_lshlrev_b32 v12, 5, v12
v_lshl_add_u32 v7, v13, 8, v12
v_lshl_add_u32 v7, v14, 3, v7
v_add_u32 v8, 0x10000, v7
v_add_u32 v9, 0x20000, v7
v_lshlrev_b32 v0, 4, v0
v_add_u32 v2, 65536, v0
s_lshl_b32 s49, s30, 8
s_mul_i32 s50, s30, 163840
s_mul_i32 s60, s30, 131072
s_add_u32 s60, s60, 120684544
s_add_u32 s61, s60, 4096
s_add_u32 s62, s60, 8192
s_mov_b32 m0, 6144
s_add_u32 s48, s49, 393216
buffer_load_dwordx4 v10, s[8:11], s48 offen lds
s_mov_b32 m0, 7168
s_add_u32 s48, s49, 458752
buffer_load_dwordx4 v10, s[8:11], s48 offen lds
s_mov_b32 m0, 14336
s_add_u32 s48, s49, 393344
buffer_load_dwordx4 v10, s[8:11], s48 offen lds
s_mov_b32 m0, 15360
s_add_u32 s48, s49, 458880
buffer_load_dwordx4 v10, s[8:11], s48 offen lds
s_mov_b32 m0, 22528
s_add_u32 s48, s49, 393344
buffer_load_dwordx4 v10, s[12:15], s48 offen lds
s_mov_b32 m0, 23552
s_add_u32 s48, s49, 458880
buffer_load_dwordx4 v10, s[12:15], s48 offen lds
s_mov_b32 m0, 30720
s_add_u32 s48, s49, 393216
buffer_load_dwordx4 v10, s[16:19], s48 offen lds
s_mov_b32 m0, 31744
s_add_u32 s48, s49, 458752
buffer_load_dwordx4 v10, s[16:19], s48 offen lds
s_mov_b32 m0, 38912
s_add_u32 s48, s49, 393344
buffer_load_dwordx4 v10, s[16:19], s48 offen lds
s_mov_b32 m0, 39936
s_add_u32 s48, s49, 458880
buffer_load_dwordx4 v10, s[16:19], s48 offen lds
s_mov_b32 m0, 47104
s_add_u32 s48, s49, 917504
buffer_load_dwordx4 v10, s[8:11], s48 offen lds
s_mov_b32 m0, 48128
s_add_u32 s48, s49, 983040
buffer_load_dwordx4 v10, s[8:11], s48 offen lds
s_mov_b32 m0, 55296
s_add_u32 s48, s49, 917632
buffer_load_dwordx4 v10, s[8:11], s48 offen lds
s_mov_b32 m0, 56320
s_add_u32 s48, s49, 983168
buffer_load_dwordx4 v10, s[8:11], s48 offen lds
s_mov_b32 m0, 63488
s_add_u32 s48, s49, 917632
buffer_load_dwordx4 v10, s[12:15], s48 offen lds
s_mov_b32 m0, 64512
s_add_u32 s48, s49, 983168
buffer_load_dwordx4 v10, s[12:15], s48 offen lds
s_mov_b32 m0, 71680
s_add_u32 s48, s49, 917504
buffer_load_dwordx4 v10, s[16:19], s48 offen lds
s_mov_b32 m0, 72704
s_add_u32 s48, s49, 983040
buffer_load_dwordx4 v10, s[16:19], s48 offen lds
s_mov_b32 m0, 79872
s_add_u32 s48, s49, 917632
buffer_load_dwordx4 v10, s[16:19], s48 offen lds
s_mov_b32 m0, 80896
s_add_u32 s48, s49, 983168
buffer_load_dwordx4 v10, s[16:19], s48 offen lds
s_mov_b32 m0, 88064
s_add_u32 s48, s49, 1441792
buffer_load_dwordx4 v10, s[8:11], s48 offen lds
s_mov_b32 m0, 89088
s_add_u32 s48, s49, 1507328
buffer_load_dwordx4 v10, s[8:11], s48 offen lds
s_mov_b32 m0, 96256
s_add_u32 s48, s49, 1441920
buffer_load_dwordx4 v10, s[8:11], s48 offen lds
s_mov_b32 m0, 97280
s_add_u32 s48, s49, 1507456
buffer_load_dwordx4 v10, s[8:11], s48 offen lds
s_mov_b32 m0, 104448
s_add_u32 s48, s49, 1441920
buffer_load_dwordx4 v10, s[12:15], s48 offen lds
s_mov_b32 m0, 105472
s_add_u32 s48, s49, 1507456
buffer_load_dwordx4 v10, s[12:15], s48 offen lds
s_mov_b32 m0, 112640
s_add_u32 s48, s49, 1441792
buffer_load_dwordx4 v10, s[16:19], s48 offen lds
s_mov_b32 m0, 113664
s_add_u32 s48, s49, 1507328
buffer_load_dwordx4 v10, s[16:19], s48 offen lds
s_mov_b32 m0, 120832
s_add_u32 s48, s49, 1966080
buffer_load_dwordx4 v10, s[8:11], s48 offen lds
s_mov_b32 m0, 121856
s_add_u32 s48, s49, 2031616
buffer_load_dwordx4 v10, s[8:11], s48 offen lds
s_mov_b32 m0, 129024
s_add_u32 s48, s49, 1966208
buffer_load_dwordx4 v10, s[8:11], s48 offen lds
s_mov_b32 m0, 130048
s_add_u32 s48, s49, 2031744
buffer_load_dwordx4 v10, s[8:11], s48 offen lds
s_waitcnt vmcnt(24)
s_barrier
s_mov_b32 m0, 137216
s_add_u32 s48, s49, 1966208
buffer_load_dwordx4 v10, s[12:15], s48 offen lds
s_mov_b32 m0, 138240
s_add_u32 s48, s49, 2031744
buffer_load_dwordx4 v10, s[12:15], s48 offen lds
s_mov_b32 m0, 145408
s_add_u32 s48, s49, 1966080
buffer_load_dwordx4 v10, s[16:19], s48 offen lds
s_mov_b32 m0, 146432
s_add_u32 s48, s49, 2031616
buffer_load_dwordx4 v10, s[16:19], s48 offen lds
s_mov_b32 m0, 153600
s_add_u32 s48, s49, 2490368
buffer_load_dwordx4 v10, s[8:11], s48 offen lds
s_mov_b32 m0, 154624
s_add_u32 s48, s49, 2555904
buffer_load_dwordx4 v10, s[8:11], s48 offen lds
s_mov_b32 m0, 161792
s_add_u32 s48, s49, 2490496
buffer_load_dwordx4 v10, s[8:11], s48 offen lds
s_mov_b32 m0, 162816
s_add_u32 s48, s49, 2556032
buffer_load_dwordx4 v10, s[8:11], s48 offen lds
ds_read_b64_tr_b16 a[24:25], v4 offset:0
ds_read_b64_tr_b16 a[26:27], v4 offset:1024
ds_read_b64_tr_b16 a[28:29], v4 offset:4096
ds_read_b64_tr_b16 a[30:31], v4 offset:5120
ds_read_b64_tr_b16 a[32:33], v4 offset:8192
ds_read_b64_tr_b16 a[34:35], v4 offset:9216
ds_read_b64_tr_b16 a[36:37], v4 offset:12288
ds_read_b64_tr_b16 a[38:39], v4 offset:13312
ds_read_b64_tr_b16 a[40:41], v4 offset:16384
ds_read_b64_tr_b16 a[42:43], v4 offset:17408
ds_read_b64_tr_b16 a[44:45], v4 offset:20480
ds_read_b64_tr_b16 a[46:47], v4 offset:21504
ds_read_b64_tr_b16 a[176:177], v4 offset:24576
ds_read_b64_tr_b16 a[178:179], v4 offset:25600
ds_read_b64_tr_b16 a[180:181], v4 offset:28672
ds_read_b64_tr_b16 a[182:183], v4 offset:29696
s_waitcnt lgkmcnt(0)
s_waitcnt vmcnt(24)
s_barrier
s_mov_b32 m0, 6144
s_add_u32 s48, s49, 2490496
buffer_load_dwordx4 v10, s[12:15], s48 offen lds
s_mov_b32 m0, 7168
s_add_u32 s48, s49, 2556032
buffer_load_dwordx4 v10, s[12:15], s48 offen lds
s_mov_b32 m0, 14336
s_add_u32 s48, s49, 2490368
buffer_load_dwordx4 v10, s[16:19], s48 offen lds
s_mov_b32 m0, 15360
s_add_u32 s48, s49, 2555904
buffer_load_dwordx4 v10, s[16:19], s48 offen lds
s_mov_b32 m0, 22528
s_add_u32 s48, s49, 3014656
buffer_load_dwordx4 v10, s[8:11], s48 offen lds
s_mov_b32 m0, 23552
s_add_u32 s48, s49, 3080192
buffer_load_dwordx4 v10, s[8:11], s48 offen lds
s_mov_b32 m0, 30720
s_add_u32 s48, s49, 3014784
buffer_load_dwordx4 v10, s[8:11], s48 offen lds
s_mov_b32 m0, 31744
s_add_u32 s48, s49, 3080320
buffer_load_dwordx4 v10, s[8:11], s48 offen lds
ds_read_b64_tr_b16 v[224:225], v4 offset:32768
ds_read_b64_tr_b16 v[226:227], v4 offset:33792
ds_read_b64_tr_b16 v[228:229], v4 offset:36864
ds_read_b64_tr_b16 v[230:231], v4 offset:37888
ds_read_b64_tr_b16 a[0:1], v4 offset:40960
ds_read_b64_tr_b16 a[2:3], v4 offset:41984
ds_read_b64_tr_b16 a[4:5], v4 offset:45056
ds_read_b64_tr_b16 a[6:7], v4 offset:46080
ds_read_b64_tr_b16 a[8:9], v4 offset:49152
ds_read_b64_tr_b16 a[10:11], v4 offset:50176
ds_read_b64_tr_b16 a[12:13], v4 offset:53248
ds_read_b64_tr_b16 a[14:15], v4 offset:54272
ds_read_b64_tr_b16 a[16:17], v4 offset:57344
ds_read_b64_tr_b16 a[18:19], v4 offset:58368
ds_read_b64_tr_b16 a[20:21], v4 offset:61440
ds_read_b64_tr_b16 a[22:23], v4 offset:62464
s_waitcnt lgkmcnt(0)
s_waitcnt vmcnt(24)
s_barrier
s_mov_b32 m0, 38912
s_add_u32 s48, s49, 3014784
buffer_load_dwordx4 v10, s[12:15], s48 offen lds
s_mov_b32 m0, 39936
s_add_u32 s48, s49, 3080320
buffer_load_dwordx4 v10, s[12:15], s48 offen lds
s_mov_b32 m0, 47104
s_add_u32 s48, s49, 3014656
buffer_load_dwordx4 v10, s[16:19], s48 offen lds
s_mov_b32 m0, 48128
s_add_u32 s48, s49, 3080192
buffer_load_dwordx4 v10, s[16:19], s48 offen lds
s_mov_b32 m0, 55296
s_add_u32 s48, s49, 3539072
buffer_load_dwordx4 v10, s[8:11], s48 offen lds
s_mov_b32 m0, 56320
s_add_u32 s48, s49, 3604608
buffer_load_dwordx4 v10, s[8:11], s48 offen lds
s_mov_b32 m0, 63488
s_add_u32 s48, s49, 4063232
buffer_load_dwordx4 v10, s[8:11], s48 offen lds
s_mov_b32 m0, 64512
s_add_u32 s48, s49, 4128768
buffer_load_dwordx4 v10, s[8:11], s48 offen lds
ds_read_b64_tr_b16 v[16:17], v5 offset:0
ds_read_b64_tr_b16 v[18:19], v5 offset:1024
ds_read_b64_tr_b16 v[20:21], v5 offset:4096
ds_read_b64_tr_b16 v[22:23], v5 offset:5120
ds_read_b64_tr_b16 v[24:25], v5 offset:8192
ds_read_b64_tr_b16 v[26:27], v5 offset:9216
ds_read_b64_tr_b16 v[28:29], v5 offset:12288
ds_read_b64_tr_b16 v[30:31], v5 offset:13312
ds_read_b64_tr_b16 a[80:81], v5 offset:16384
ds_read_b64_tr_b16 a[82:83], v5 offset:17408
ds_read_b64_tr_b16 a[84:85], v5 offset:20480
ds_read_b64_tr_b16 a[86:87], v5 offset:21504
ds_read_b64_tr_b16 a[88:89], v5 offset:24576
ds_read_b64_tr_b16 a[90:91], v5 offset:25600
ds_read_b64_tr_b16 a[92:93], v5 offset:28672
ds_read_b64_tr_b16 a[94:95], v5 offset:29696
s_waitcnt lgkmcnt(0)
buffer_store_dwordx4 v[16:19], v0, s[4:7], s60 offen offset:0
buffer_store_dwordx4 v[20:23], v0, s[4:7], s60 offen offset:1024
buffer_store_dwordx4 v[24:27], v0, s[4:7], s60 offen offset:2048
buffer_store_dwordx4 v[28:31], v0, s[4:7], s60 offen offset:3072
s_waitcnt vmcnt(28)
s_barrier
s_mov_b32 m0, 71680
s_add_u32 s48, s49, 4063360
buffer_load_dwordx4 v10, s[8:11], s48 offen lds
s_mov_b32 m0, 72704
s_add_u32 s48, s49, 4128896
buffer_load_dwordx4 v10, s[8:11], s48 offen lds
s_mov_b32 m0, 79872
s_add_u32 s48, s49, 4587520
buffer_load_dwordx4 v10, s[8:11], s48 offen lds
s_mov_b32 m0, 80896
s_add_u32 s48, s49, 4653056
buffer_load_dwordx4 v10, s[8:11], s48 offen lds
s_mov_b32 m0, 88064
s_add_u32 s48, s49, 4587648
buffer_load_dwordx4 v10, s[8:11], s48 offen lds
s_mov_b32 m0, 89088
s_add_u32 s48, s49, 4653184
buffer_load_dwordx4 v10, s[8:11], s48 offen lds
s_mov_b32 m0, 96256
s_add_u32 s48, s49, 5111808
buffer_load_dwordx4 v10, s[8:11], s48 offen lds
s_mov_b32 m0, 97280
s_add_u32 s48, s49, 5177344
buffer_load_dwordx4 v10, s[8:11], s48 offen lds
ds_read_b64_tr_b16 a[96:97], v5 offset:32768
ds_read_b64_tr_b16 a[98:99], v5 offset:33792
ds_read_b64_tr_b16 a[100:101], v5 offset:36864
ds_read_b64_tr_b16 a[102:103], v5 offset:37888
ds_read_b64_tr_b16 a[104:105], v5 offset:40960
ds_read_b64_tr_b16 a[106:107], v5 offset:41984
ds_read_b64_tr_b16 a[108:109], v5 offset:45056
ds_read_b64_tr_b16 a[110:111], v5 offset:46080
ds_read_b64_tr_b16 a[112:113], v5 offset:49152
ds_read_b64_tr_b16 a[114:115], v5 offset:50176
ds_read_b64_tr_b16 a[116:117], v5 offset:53248
ds_read_b64_tr_b16 a[118:119], v5 offset:54272
ds_read_b64_tr_b16 a[120:121], v5 offset:57344
ds_read_b64_tr_b16 a[122:123], v5 offset:58368
ds_read_b64_tr_b16 a[124:125], v5 offset:61440
ds_read_b64_tr_b16 a[126:127], v5 offset:62464
s_waitcnt lgkmcnt(0)
s_waitcnt vmcnt(28)
s_barrier
s_mov_b32 m0, 104448
s_add_u32 s48, s49, 5111936
buffer_load_dwordx4 v10, s[8:11], s48 offen lds
s_mov_b32 m0, 105472
s_add_u32 s48, s49, 5177472
buffer_load_dwordx4 v10, s[8:11], s48 offen lds
s_mov_b32 m0, 112640
s_add_u32 s48, s49, 3538944
buffer_load_dwordx4 v10, s[12:15], s48 offen lds
s_mov_b32 m0, 113664
s_add_u32 s48, s49, 3604480
buffer_load_dwordx4 v10, s[12:15], s48 offen lds
s_mov_b32 m0, 120832
s_add_u32 s48, s49, 3539072
buffer_load_dwordx4 v10, s[12:15], s48 offen lds
s_mov_b32 m0, 121856
s_add_u32 s48, s49, 3604608
buffer_load_dwordx4 v10, s[12:15], s48 offen lds
s_mov_b32 m0, 129024
s_add_u32 s48, s49, 4063232
buffer_load_dwordx4 v10, s[12:15], s48 offen lds
s_mov_b32 m0, 130048
s_add_u32 s48, s49, 4128768
buffer_load_dwordx4 v10, s[12:15], s48 offen lds
ds_read_b64_tr_b16 a[128:129], v6 offset:0
ds_read_b64_tr_b16 a[130:131], v6 offset:1024
ds_read_b64_tr_b16 a[132:133], v6 offset:4096
ds_read_b64_tr_b16 a[134:135], v6 offset:5120
ds_read_b64_tr_b16 a[136:137], v6 offset:8192
ds_read_b64_tr_b16 a[138:139], v6 offset:9216
ds_read_b64_tr_b16 a[140:141], v6 offset:12288
ds_read_b64_tr_b16 a[142:143], v6 offset:13312
ds_read_b64_tr_b16 a[144:145], v6 offset:16384
ds_read_b64_tr_b16 a[146:147], v6 offset:17408
ds_read_b64_tr_b16 a[148:149], v6 offset:20480
ds_read_b64_tr_b16 a[150:151], v6 offset:21504
ds_read_b64_tr_b16 a[152:153], v6 offset:24576
ds_read_b64_tr_b16 a[154:155], v6 offset:25600
ds_read_b64_tr_b16 a[156:157], v6 offset:28672
ds_read_b64_tr_b16 a[158:159], v6 offset:29696
s_waitcnt lgkmcnt(0)
s_waitcnt vmcnt(28)
s_barrier
s_mov_b32 m0, 137216
s_add_u32 s48, s49, 4063360
buffer_load_dwordx4 v10, s[12:15], s48 offen lds
s_mov_b32 m0, 138240
s_add_u32 s48, s49, 4128896
buffer_load_dwordx4 v10, s[12:15], s48 offen lds
s_mov_b32 m0, 145408
s_add_u32 s48, s49, 4587520
buffer_load_dwordx4 v10, s[12:15], s48 offen lds
s_mov_b32 m0, 146432
s_add_u32 s48, s49, 4653056
buffer_load_dwordx4 v10, s[12:15], s48 offen lds
s_mov_b32 m0, 153600
s_add_u32 s48, s49, 4587648
buffer_load_dwordx4 v10, s[12:15], s48 offen lds
s_mov_b32 m0, 154624
s_add_u32 s48, s49, 4653184
buffer_load_dwordx4 v10, s[12:15], s48 offen lds
s_mov_b32 m0, 161792
s_add_u32 s48, s49, 5111808
buffer_load_dwordx4 v10, s[12:15], s48 offen lds
s_mov_b32 m0, 162816
s_add_u32 s48, s49, 5177344
buffer_load_dwordx4 v10, s[12:15], s48 offen lds
ds_read_b64_tr_b16 a[160:161], v4 offset:0
ds_read_b64_tr_b16 a[162:163], v4 offset:1024
ds_read_b64_tr_b16 a[164:165], v4 offset:4096
ds_read_b64_tr_b16 a[166:167], v4 offset:5120
ds_read_b64_tr_b16 a[168:169], v4 offset:8192
ds_read_b64_tr_b16 a[170:171], v4 offset:9216
ds_read_b64_tr_b16 a[172:173], v4 offset:12288
ds_read_b64_tr_b16 a[174:175], v4 offset:13312
ds_read_b64_tr_b16 a[48:49], v4 offset:16384
ds_read_b64_tr_b16 a[50:51], v4 offset:17408
ds_read_b64_tr_b16 a[52:53], v4 offset:20480
ds_read_b64_tr_b16 a[54:55], v4 offset:21504
ds_read_b64_tr_b16 a[56:57], v4 offset:24576
ds_read_b64_tr_b16 a[58:59], v4 offset:25600
ds_read_b64_tr_b16 a[60:61], v4 offset:28672
ds_read_b64_tr_b16 a[62:63], v4 offset:29696
s_waitcnt lgkmcnt(0)
s_waitcnt vmcnt(28)
s_barrier
s_mov_b32 m0, 6144
s_add_u32 s48, s49, 5111936
buffer_load_dwordx4 v10, s[12:15], s48 offen lds
s_mov_b32 m0, 7168
s_add_u32 s48, s49, 5177472
buffer_load_dwordx4 v10, s[12:15], s48 offen lds
s_mov_b32 m0, 14336
s_add_u32 s48, s49, 3538944
buffer_load_dwordx4 v10, s[16:19], s48 offen lds
s_mov_b32 m0, 15360
s_add_u32 s48, s49, 3604480
buffer_load_dwordx4 v10, s[16:19], s48 offen lds
s_mov_b32 m0, 22528
s_add_u32 s48, s49, 3539072
buffer_load_dwordx4 v10, s[16:19], s48 offen lds
s_mov_b32 m0, 23552
s_add_u32 s48, s49, 3604608
buffer_load_dwordx4 v10, s[16:19], s48 offen lds
s_mov_b32 m0, 30720
s_add_u32 s48, s49, 4063232
buffer_load_dwordx4 v10, s[16:19], s48 offen lds
s_mov_b32 m0, 31744
s_add_u32 s48, s49, 4128768
buffer_load_dwordx4 v10, s[16:19], s48 offen lds
ds_read_b64_tr_b16 a[64:65], v4 offset:32768
ds_read_b64_tr_b16 a[66:67], v4 offset:33792
ds_read_b64_tr_b16 a[68:69], v4 offset:36864
ds_read_b64_tr_b16 a[70:71], v4 offset:37888
ds_read_b64_tr_b16 a[72:73], v4 offset:40960
ds_read_b64_tr_b16 a[74:75], v4 offset:41984
ds_read_b64_tr_b16 a[76:77], v4 offset:45056
ds_read_b64_tr_b16 a[78:79], v4 offset:46080
ds_read_b64_tr_b16 a[200:201], v4 offset:49152
ds_read_b64_tr_b16 a[202:203], v4 offset:50176
ds_read_b64_tr_b16 a[204:205], v4 offset:53248
ds_read_b64_tr_b16 a[206:207], v4 offset:54272
ds_read_b64_tr_b16 a[208:209], v4 offset:57344
ds_read_b64_tr_b16 a[210:211], v4 offset:58368
ds_read_b64_tr_b16 a[212:213], v4 offset:61440
ds_read_b64_tr_b16 a[214:215], v4 offset:62464
s_waitcnt lgkmcnt(0)
s_waitcnt vmcnt(24)
s_barrier
s_mov_b32 m0, 38912
s_add_u32 s48, s49, 4063360
buffer_load_dwordx4 v10, s[16:19], s48 offen lds
s_mov_b32 m0, 39936
s_add_u32 s48, s49, 4128896
buffer_load_dwordx4 v10, s[16:19], s48 offen lds
s_mov_b32 m0, 47104
s_add_u32 s48, s49, 4587520
buffer_load_dwordx4 v10, s[16:19], s48 offen lds
s_mov_b32 m0, 48128
s_add_u32 s48, s49, 4653056
buffer_load_dwordx4 v10, s[16:19], s48 offen lds
s_mov_b32 m0, 55296
s_add_u32 s48, s49, 4587648
buffer_load_dwordx4 v10, s[16:19], s48 offen lds
s_mov_b32 m0, 56320
s_add_u32 s48, s49, 4653184
buffer_load_dwordx4 v10, s[16:19], s48 offen lds
s_mov_b32 m0, 63488
s_add_u32 s48, s49, 5111808
buffer_load_dwordx4 v10, s[16:19], s48 offen lds
s_mov_b32 m0, 64512
s_add_u32 s48, s49, 5177344
buffer_load_dwordx4 v10, s[16:19], s48 offen lds
ds_read_b64_tr_b16 a[216:217], v5 offset:0
ds_read_b64_tr_b16 a[218:219], v5 offset:1024
ds_read_b64_tr_b16 a[220:221], v5 offset:4096
ds_read_b64_tr_b16 a[222:223], v5 offset:5120
ds_read_b64_tr_b16 a[224:225], v5 offset:8192
ds_read_b64_tr_b16 a[226:227], v5 offset:9216
ds_read_b64_tr_b16 a[228:229], v5 offset:12288
ds_read_b64_tr_b16 a[230:231], v5 offset:13312
ds_read_b64_tr_b16 a[232:233], v5 offset:16384
ds_read_b64_tr_b16 a[234:235], v5 offset:17408
ds_read_b64_tr_b16 a[236:237], v5 offset:20480
ds_read_b64_tr_b16 a[238:239], v5 offset:21504
ds_read_b64_tr_b16 a[184:185], v5 offset:24576
ds_read_b64_tr_b16 a[186:187], v5 offset:25600
ds_read_b64_tr_b16 a[188:189], v5 offset:28672
ds_read_b64_tr_b16 a[190:191], v5 offset:29696
s_waitcnt lgkmcnt(0)
s_waitcnt vmcnt(24)
s_barrier
s_mov_b32 m0, 71680
s_add_u32 s48, s49, 5111936
buffer_load_dwordx4 v10, s[16:19], s48 offen lds
s_mov_b32 m0, 72704
s_add_u32 s48, s49, 5177472
buffer_load_dwordx4 v10, s[16:19], s48 offen lds
s_mov_b32 m0, 79872
s_add_u32 s48, s50, 92160
buffer_load_dwordx4 v11, s[20:23], s48 offen lds
s_mov_b32 m0, 80896
s_add_u32 s48, s50, 97280
buffer_load_dwordx4 v11, s[20:23], s48 offen lds
s_mov_b32 m0, 88064
s_add_u32 s48, s50, 112640
buffer_load_dwordx4 v11, s[20:23], s48 offen lds
s_mov_b32 m0, 89088
s_add_u32 s48, s50, 117760
buffer_load_dwordx4 v11, s[20:23], s48 offen lds
s_mov_b32 m0, 96256
s_add_u32 s48, s50, 133120
buffer_load_dwordx4 v11, s[20:23], s48 offen lds
s_mov_b32 m0, 97280
s_add_u32 s48, s50, 138240
buffer_load_dwordx4 v11, s[20:23], s48 offen lds
ds_read_b64_tr_b16 a[192:193], v5 offset:32768
ds_read_b64_tr_b16 a[194:195], v5 offset:33792
ds_read_b64_tr_b16 a[196:197], v5 offset:36864
ds_read_b64_tr_b16 a[198:199], v5 offset:37888
ds_read_b64_tr_b16 a[248:249], v5 offset:40960
ds_read_b64_tr_b16 a[250:251], v5 offset:41984
ds_read_b64_tr_b16 a[252:253], v5 offset:45056
ds_read_b64_tr_b16 a[254:255], v5 offset:46080
ds_read_b64_tr_b16 v[72:73], v5 offset:49152
ds_read_b64_tr_b16 v[74:75], v5 offset:50176
ds_read_b64_tr_b16 v[76:77], v5 offset:53248
ds_read_b64_tr_b16 v[78:79], v5 offset:54272
ds_read_b64_tr_b16 v[80:81], v5 offset:57344
ds_read_b64_tr_b16 v[82:83], v5 offset:58368
ds_read_b64_tr_b16 v[84:85], v5 offset:61440
ds_read_b64_tr_b16 v[86:87], v5 offset:62464
s_waitcnt lgkmcnt(0)
s_waitcnt vmcnt(24)
s_barrier
s_mov_b32 m0, 104448
s_add_u32 s48, s50, 153600
buffer_load_dwordx4 v11, s[20:23], s48 offen lds
s_mov_b32 m0, 105472
s_add_u32 s48, s50, 158720
buffer_load_dwordx4 v11, s[20:23], s48 offen lds
s_mov_b32 m0, 112640
s_add_u32 s48, s50, 92416
buffer_load_dwordx4 v11, s[20:23], s48 offen lds
s_mov_b32 m0, 113664
s_add_u32 s48, s50, 97536
buffer_load_dwordx4 v11, s[20:23], s48 offen lds
s_mov_b32 m0, 120832
s_add_u32 s48, s50, 112896
buffer_load_dwordx4 v11, s[20:23], s48 offen lds
s_mov_b32 m0, 121856
s_add_u32 s48, s50, 118016
buffer_load_dwordx4 v11, s[20:23], s48 offen lds
s_mov_b32 m0, 129024
s_add_u32 s48, s50, 133376
buffer_load_dwordx4 v11, s[20:23], s48 offen lds
s_mov_b32 m0, 130048
s_add_u32 s48, s50, 138496
buffer_load_dwordx4 v11, s[20:23], s48 offen lds
ds_read_b64_tr_b16 v[88:89], v6 offset:0
ds_read_b64_tr_b16 v[90:91], v6 offset:1024
ds_read_b64_tr_b16 v[92:93], v6 offset:4096
ds_read_b64_tr_b16 v[94:95], v6 offset:5120
ds_read_b64_tr_b16 v[96:97], v6 offset:8192
ds_read_b64_tr_b16 v[98:99], v6 offset:9216
ds_read_b64_tr_b16 v[100:101], v6 offset:12288
ds_read_b64_tr_b16 v[102:103], v6 offset:13312
ds_read_b64_tr_b16 v[104:105], v6 offset:16384
ds_read_b64_tr_b16 v[106:107], v6 offset:17408
ds_read_b64_tr_b16 v[108:109], v6 offset:20480
ds_read_b64_tr_b16 v[110:111], v6 offset:21504
ds_read_b64_tr_b16 v[248:249], v6 offset:24576
ds_read_b64_tr_b16 v[250:251], v6 offset:25600
ds_read_b64_tr_b16 v[252:253], v6 offset:28672
ds_read_b64_tr_b16 v[254:255], v6 offset:29696
s_waitcnt lgkmcnt(0)
s_waitcnt vmcnt(24)
s_barrier
s_mov_b32 m0, 137216
s_add_u32 s48, s50, 153856
buffer_load_dwordx4 v11, s[20:23], s48 offen lds
s_mov_b32 m0, 138240
s_add_u32 s48, s50, 158976
buffer_load_dwordx4 v11, s[20:23], s48 offen lds
s_mov_b32 m0, 145408
s_add_u32 s48, s50, 92672
buffer_load_dwordx4 v11, s[20:23], s48 offen lds
s_mov_b32 m0, 146432
s_add_u32 s48, s50, 97792
buffer_load_dwordx4 v11, s[20:23], s48 offen lds
s_mov_b32 m0, 153600
s_add_u32 s48, s50, 113152
buffer_load_dwordx4 v11, s[20:23], s48 offen lds
s_mov_b32 m0, 154624
s_add_u32 s48, s50, 118272
buffer_load_dwordx4 v11, s[20:23], s48 offen lds
s_mov_b32 m0, 161792
s_add_u32 s48, s50, 133632
buffer_load_dwordx4 v11, s[20:23], s48 offen lds
s_mov_b32 m0, 162816
s_add_u32 s48, s50, 138752
buffer_load_dwordx4 v11, s[20:23], s48 offen lds
ds_read_b64_tr_b16 a[240:241], v4 offset:0
ds_read_b64_tr_b16 a[242:243], v4 offset:1024
ds_read_b64_tr_b16 a[244:245], v4 offset:4096
ds_read_b64_tr_b16 a[246:247], v4 offset:5120
ds_read_b64_tr_b16 v[128:129], v4 offset:8192
ds_read_b64_tr_b16 v[130:131], v4 offset:9216
ds_read_b64_tr_b16 v[132:133], v4 offset:12288
ds_read_b64_tr_b16 v[134:135], v4 offset:13312
ds_read_b64_tr_b16 v[136:137], v4 offset:16384
ds_read_b64_tr_b16 v[138:139], v4 offset:17408
ds_read_b64_tr_b16 v[140:141], v4 offset:20480
ds_read_b64_tr_b16 v[142:143], v4 offset:21504
ds_read_b64_tr_b16 v[144:145], v4 offset:24576
ds_read_b64_tr_b16 v[146:147], v4 offset:25600
ds_read_b64_tr_b16 v[148:149], v4 offset:28672
ds_read_b64_tr_b16 v[150:151], v4 offset:29696
s_waitcnt lgkmcnt(0)
s_waitcnt vmcnt(24)
s_barrier
s_mov_b32 m0, 6144
s_add_u32 s48, s50, 154112
buffer_load_dwordx4 v11, s[20:23], s48 offen lds
s_mov_b32 m0, 7168
s_add_u32 s48, s50, 159232
buffer_load_dwordx4 v11, s[20:23], s48 offen lds
s_mov_b32 m0, 14336
s_add_u32 s48, s49, 393216
buffer_load_dwordx4 v10, s[12:15], s48 offen lds
s_mov_b32 m0, 15360
s_add_u32 s48, s49, 458752
buffer_load_dwordx4 v10, s[12:15], s48 offen lds
s_mov_b32 m0, 22528
s_add_u32 s48, s49, 917504
buffer_load_dwordx4 v10, s[12:15], s48 offen lds
s_mov_b32 m0, 23552
s_add_u32 s48, s49, 983040
buffer_load_dwordx4 v10, s[12:15], s48 offen lds
s_mov_b32 m0, 30720
s_add_u32 s48, s49, 1441792
buffer_load_dwordx4 v10, s[12:15], s48 offen lds
s_mov_b32 m0, 31744
s_add_u32 s48, s49, 1507328
buffer_load_dwordx4 v10, s[12:15], s48 offen lds
ds_read_b64_tr_b16 v[152:153], v4 offset:32768
ds_read_b64_tr_b16 v[154:155], v4 offset:33792
ds_read_b64_tr_b16 v[156:157], v4 offset:36864
ds_read_b64_tr_b16 v[158:159], v4 offset:37888
ds_read_b64_tr_b16 v[160:161], v4 offset:40960
ds_read_b64_tr_b16 v[162:163], v4 offset:41984
ds_read_b64_tr_b16 v[164:165], v4 offset:45056
ds_read_b64_tr_b16 v[166:167], v4 offset:46080
ds_read_b64_tr_b16 v[168:169], v4 offset:49152
ds_read_b64_tr_b16 v[170:171], v4 offset:50176
ds_read_b64_tr_b16 v[172:173], v4 offset:53248
ds_read_b64_tr_b16 v[174:175], v4 offset:54272
ds_read_b64_tr_b16 v[112:113], v4 offset:57344
ds_read_b64_tr_b16 v[114:115], v4 offset:58368
ds_read_b64_tr_b16 v[116:117], v4 offset:61440
ds_read_b64_tr_b16 v[118:119], v4 offset:62464
s_waitcnt lgkmcnt(0)
s_waitcnt vmcnt(24)
s_barrier
s_mov_b32 m0, 38912
s_add_u32 s48, s49, 1966080
buffer_load_dwordx4 v10, s[12:15], s48 offen lds
s_mov_b32 m0, 39936
s_add_u32 s48, s49, 2031616
buffer_load_dwordx4 v10, s[12:15], s48 offen lds
s_mov_b32 m0, 47104
s_add_u32 s48, s49, 2490368
buffer_load_dwordx4 v10, s[12:15], s48 offen lds
s_mov_b32 m0, 48128
s_add_u32 s48, s49, 2555904
buffer_load_dwordx4 v10, s[12:15], s48 offen lds
s_mov_b32 m0, 55296
s_add_u32 s48, s49, 3014656
buffer_load_dwordx4 v10, s[12:15], s48 offen lds
s_mov_b32 m0, 56320
s_add_u32 s48, s49, 3080192
buffer_load_dwordx4 v10, s[12:15], s48 offen lds
s_mov_b32 m0, 63488
s_add_u32 s48, s49, 1441920
buffer_load_dwordx4 v10, s[16:19], s48 offen lds
s_mov_b32 m0, 64512
s_add_u32 s48, s49, 1507456
buffer_load_dwordx4 v10, s[16:19], s48 offen lds
ds_read_b64_tr_b16 v[120:121], v5 offset:0
ds_read_b64_tr_b16 v[122:123], v5 offset:1024
ds_read_b64_tr_b16 v[124:125], v5 offset:4096
ds_read_b64_tr_b16 v[126:127], v5 offset:5120
ds_read_b64_tr_b16 v[176:177], v8 offset:8192
ds_read_b64_tr_b16 v[178:179], v8 offset:8704
ds_read_b64_tr_b16 v[180:181], v8 offset:10240
ds_read_b64_tr_b16 v[182:183], v8 offset:10752
ds_read_b64_tr_b16 v[184:185], v8 offset:16384
ds_read_b64_tr_b16 v[186:187], v8 offset:16896
ds_read_b64_tr_b16 v[188:189], v8 offset:18432
ds_read_b64_tr_b16 v[190:191], v8 offset:18944
ds_read_b64_tr_b16 v[192:193], v8 offset:24576
ds_read_b64_tr_b16 v[194:195], v8 offset:25088
ds_read_b64_tr_b16 v[196:197], v8 offset:26624
ds_read_b64_tr_b16 v[198:199], v8 offset:27136
s_waitcnt lgkmcnt(0)
s_waitcnt vmcnt(24)
s_barrier
s_mov_b32 m0, 71680
s_add_u32 s48, s49, 1966208
buffer_load_dwordx4 v10, s[16:19], s48 offen lds
s_mov_b32 m0, 72704
s_add_u32 s48, s49, 2031744
buffer_load_dwordx4 v10, s[16:19], s48 offen lds
s_mov_b32 m0, 79872
s_add_u32 s48, s49, 2490496
buffer_load_dwordx4 v10, s[16:19], s48 offen lds
s_mov_b32 m0, 80896
s_add_u32 s48, s49, 2556032
buffer_load_dwordx4 v10, s[16:19], s48 offen lds
s_mov_b32 m0, 88064
s_add_u32 s48, s49, 3014784
buffer_load_dwordx4 v10, s[16:19], s48 offen lds
s_mov_b32 m0, 89088
s_add_u32 s48, s49, 3080320
buffer_load_dwordx4 v10, s[16:19], s48 offen lds
s_mov_b32 m0, 96256
s_add_u32 s48, s50, 92928
buffer_load_dwordx4 v11, s[20:23], s48 offen lds
s_mov_b32 m0, 97280
s_add_u32 s48, s50, 98048
buffer_load_dwordx4 v11, s[20:23], s48 offen lds
v_xor_b32 v12, v15, v8
ds_read_b64_tr_b16 v[16:17], v12 offset:32768
ds_read_b64_tr_b16 v[18:19], v12 offset:33280
ds_read_b64_tr_b16 v[20:21], v12 offset:34816
ds_read_b64_tr_b16 v[22:23], v12 offset:35328
ds_read_b64_tr_b16 v[240:241], v8 offset:40960
ds_read_b64_tr_b16 v[242:243], v8 offset:41472
ds_read_b64_tr_b16 v[244:245], v8 offset:43008
ds_read_b64_tr_b16 v[246:247], v8 offset:43520
ds_read_b64_tr_b16 v[232:233], v8 offset:49152
ds_read_b64_tr_b16 v[234:235], v8 offset:49664
ds_read_b64_tr_b16 v[236:237], v8 offset:51200
ds_read_b64_tr_b16 v[238:239], v8 offset:51712
ds_read_b64_tr_b16 v[40:41], v8 offset:57344
ds_read_b64_tr_b16 v[42:43], v8 offset:57856
ds_read_b64_tr_b16 v[44:45], v8 offset:59392
ds_read_b64_tr_b16 v[46:47], v8 offset:59904
s_waitcnt lgkmcnt(0)
buffer_store_dwordx4 v[16:19], v0, s[4:7], s61 offen offset:0
buffer_store_dwordx4 v[20:23], v0, s[4:7], s61 offen offset:1024
buffer_store_dwordx4 v[40:43], v0, s[4:7], s62 offen offset:0
buffer_store_dwordx4 v[44:47], v0, s[4:7], s62 offen offset:1024
s_waitcnt vmcnt(28)
s_barrier
s_mov_b32 m0, 104448
s_add_u32 s48, s50, 113408
buffer_load_dwordx4 v11, s[20:23], s48 offen lds
s_mov_b32 m0, 105472
s_add_u32 s48, s50, 118528
buffer_load_dwordx4 v11, s[20:23], s48 offen lds
s_mov_b32 m0, 112640
s_add_u32 s48, s50, 133888
buffer_load_dwordx4 v11, s[20:23], s48 offen lds
s_mov_b32 m0, 113664
s_add_u32 s48, s50, 139008
buffer_load_dwordx4 v11, s[20:23], s48 offen lds
s_mov_b32 m0, 120832
s_add_u32 s48, s50, 154368
buffer_load_dwordx4 v11, s[20:23], s48 offen lds
s_mov_b32 m0, 121856
s_add_u32 s48, s50, 159488
buffer_load_dwordx4 v11, s[20:23], s48 offen lds
s_mov_b32 m0, 129024
s_add_u32 s48, s50, 93184
buffer_load_dwordx4 v11, s[20:23], s48 offen lds
s_mov_b32 m0, 130048
s_add_u32 s48, s50, 98304
buffer_load_dwordx4 v11, s[20:23], s48 offen lds
v_xor_b32 v12, v15, v9
ds_read_b64_tr_b16 v[16:17], v12 offset:0
ds_read_b64_tr_b16 v[18:19], v12 offset:512
ds_read_b64_tr_b16 v[20:21], v12 offset:2048
ds_read_b64_tr_b16 v[22:23], v12 offset:2560
ds_read_b64_tr_b16 v[24:25], v9 offset:8192
ds_read_b64_tr_b16 v[26:27], v9 offset:8704
ds_read_b64_tr_b16 v[28:29], v9 offset:10240
ds_read_b64_tr_b16 v[30:31], v9 offset:10752
ds_read_b64_tr_b16 v[208:209], v9 offset:16384
ds_read_b64_tr_b16 v[210:211], v9 offset:16896
ds_read_b64_tr_b16 v[212:213], v9 offset:18432
ds_read_b64_tr_b16 v[214:215], v9 offset:18944
ds_read_b64_tr_b16 v[216:217], v9 offset:24576
ds_read_b64_tr_b16 v[218:219], v9 offset:25088
ds_read_b64_tr_b16 v[220:221], v9 offset:26624
ds_read_b64_tr_b16 v[222:223], v9 offset:27136
s_waitcnt lgkmcnt(0)
buffer_store_dwordx4 v[16:19], v0, s[4:7], s61 offen offset:2048
buffer_store_dwordx4 v[20:23], v0, s[4:7], s61 offen offset:3072
buffer_store_dwordx4 v[24:27], v0, s[4:7], s62 offen offset:2048
buffer_store_dwordx4 v[28:31], v0, s[4:7], s62 offen offset:3072
s_waitcnt vmcnt(38)
s_barrier
s_mov_b32 m0, 137216
s_add_u32 s48, s50, 113664
buffer_load_dwordx4 v11, s[20:23], s48 offen lds
s_mov_b32 m0, 138240
s_add_u32 s48, s50, 118784
buffer_load_dwordx4 v11, s[20:23], s48 offen lds
s_mov_b32 m0, 145408
s_add_u32 s48, s50, 134144
buffer_load_dwordx4 v11, s[20:23], s48 offen lds
s_mov_b32 m0, 146432
s_add_u32 s48, s50, 139264
buffer_load_dwordx4 v11, s[20:23], s48 offen lds
s_mov_b32 m0, 153600
s_add_u32 s48, s50, 154624
buffer_load_dwordx4 v11, s[20:23], s48 offen lds
s_mov_b32 m0, 154624
s_add_u32 s48, s50, 159744
buffer_load_dwordx4 v11, s[20:23], s48 offen lds
s_mov_b32 m0, 161792
s_add_u32 s48, s49, 3538944
buffer_load_dwordx4 v10, s[8:11], s48 offen lds
s_mov_b32 m0, 162816
s_add_u32 s48, s49, 3604480
buffer_load_dwordx4 v10, s[8:11], s48 offen lds
v_xor_b32 v12, v15, v7
ds_read_b64_tr_b16 v[200:201], v12 offset:0
ds_read_b64_tr_b16 v[202:203], v12 offset:512
ds_read_b64_tr_b16 v[204:205], v12 offset:2048
ds_read_b64_tr_b16 v[206:207], v12 offset:2560
s_waitcnt lgkmcnt(0)
s_waitcnt vmcnt(32)
s_barrier
ds_read_b64_tr_b16 v[16:17], v4 offset:8192
ds_read_b64_tr_b16 v[18:19], v4 offset:9216
ds_read_b64_tr_b16 v[20:21], v4 offset:12288
ds_read_b64_tr_b16 v[22:23], v4 offset:13312
ds_read_b64_tr_b16 v[24:25], v4 offset:16384
ds_read_b64_tr_b16 v[26:27], v4 offset:17408
ds_read_b64_tr_b16 v[28:29], v4 offset:20480
ds_read_b64_tr_b16 v[30:31], v4 offset:21504
ds_read_b64_tr_b16 v[32:33], v4 offset:24576
ds_read_b64_tr_b16 v[34:35], v4 offset:25600
ds_read_b64_tr_b16 v[36:37], v4 offset:28672
ds_read_b64_tr_b16 v[38:39], v4 offset:29696
ds_read_b64_tr_b16 v[40:41], v4 offset:32768
ds_read_b64_tr_b16 v[42:43], v4 offset:33792
ds_read_b64_tr_b16 v[44:45], v4 offset:36864
ds_read_b64_tr_b16 v[46:47], v4 offset:37888
ds_read_b64_tr_b16 v[48:49], v4 offset:40960
ds_read_b64_tr_b16 v[50:51], v4 offset:41984
ds_read_b64_tr_b16 v[52:53], v4 offset:45056
ds_read_b64_tr_b16 v[54:55], v4 offset:46080
ds_read_b64_tr_b16 v[56:57], v4 offset:49152
ds_read_b64_tr_b16 v[58:59], v4 offset:50176
ds_read_b64_tr_b16 v[60:61], v4 offset:53248
ds_read_b64_tr_b16 v[62:63], v4 offset:54272
ds_read_b64_tr_b16 v[64:65], v4 offset:57344
ds_read_b64_tr_b16 v[66:67], v4 offset:58368
ds_read_b64_tr_b16 v[68:69], v4 offset:61440
ds_read_b64_tr_b16 v[70:71], v4 offset:62464
s_waitcnt lgkmcnt(0)
s_barrier
ds_write_b128 v0, v[16:19] offset:51200
ds_write_b128 v0, v[20:23] offset:52224
ds_write_b128 v0, v[24:27] offset:53248
ds_write_b128 v0, v[28:31] offset:54272
ds_write_b128 v0, v[32:35] offset:55296
ds_write_b128 v0, v[36:39] offset:56320
ds_write_b128 v0, v[40:43] offset:57344
ds_write_b128 v0, v[44:47] offset:58368
ds_write_b128 v0, v[48:51] offset:59392
ds_write_b128 v0, v[52:55] offset:60416
ds_write_b128 v0, v[56:59] offset:61440
ds_write_b128 v0, v[60:63] offset:62464
ds_write_b128 v0, v[64:67] offset:63488
ds_write_b128 v0, v[68:71] offset:64512
s_waitcnt lgkmcnt(0)
s_waitcnt vmcnt(6)
s_barrier
ds_read_b64_tr_b16 v[16:17], v8 offset:24576
ds_read_b64_tr_b16 v[18:19], v8 offset:25088
ds_read_b64_tr_b16 v[20:21], v8 offset:26624
ds_read_b64_tr_b16 v[22:23], v8 offset:27136
ds_read_b64_tr_b16 v[24:25], v8 offset:32768
ds_read_b64_tr_b16 v[26:27], v8 offset:33280
ds_read_b64_tr_b16 v[28:29], v8 offset:34816
ds_read_b64_tr_b16 v[30:31], v8 offset:35328
ds_read_b64_tr_b16 v[32:33], v8 offset:40960
ds_read_b64_tr_b16 v[34:35], v8 offset:41472
ds_read_b64_tr_b16 v[36:37], v8 offset:43008
ds_read_b64_tr_b16 v[38:39], v8 offset:43520
v_xor_b32 v12, v15, v8
ds_read_b64_tr_b16 v[40:41], v12 offset:49152
ds_read_b64_tr_b16 v[42:43], v12 offset:49664
ds_read_b64_tr_b16 v[44:45], v12 offset:51200
ds_read_b64_tr_b16 v[46:47], v12 offset:51712
ds_read_b64_tr_b16 v[48:49], v8 offset:57344
ds_read_b64_tr_b16 v[50:51], v8 offset:57856
ds_read_b64_tr_b16 v[52:53], v8 offset:59392
ds_read_b64_tr_b16 v[54:55], v8 offset:59904
ds_read_b64_tr_b16 v[56:57], v9 offset:0
ds_read_b64_tr_b16 v[58:59], v9 offset:512
ds_read_b64_tr_b16 v[60:61], v9 offset:2048
ds_read_b64_tr_b16 v[62:63], v9 offset:2560
s_waitcnt lgkmcnt(0)
s_barrier
ds_write_b128 v2, v[16:19] offset:36864
ds_write_b128 v2, v[20:23] offset:37888
ds_write_b128 v2, v[24:27] offset:38912
ds_write_b128 v2, v[28:31] offset:39936
ds_write_b128 v2, v[232:235] offset:40960
ds_write_b128 v2, v[236:239] offset:41984
ds_write_b128 v2, v[224:227] offset:43008
ds_write_b128 v2, v[228:231] offset:44032
ds_write_b128 v2, v[48:51] offset:45056
ds_write_b128 v2, v[52:55] offset:46080
ds_write_b128 v2, v[56:59] offset:47104
ds_write_b128 v2, v[60:63] offset:48128
s_waitcnt lgkmcnt(0)
v_mov_b32 v232, v32
v_mov_b32 v233, v33
v_mov_b32 v234, v34
v_mov_b32 v235, v35
v_mov_b32 v236, v36
v_mov_b32 v237, v37
v_mov_b32 v238, v38
v_mov_b32 v239, v39
v_mov_b32 v224, v40
v_mov_b32 v225, v41
v_mov_b32 v226, v42
v_mov_b32 v227, v43
v_mov_b32 v228, v44
v_mov_b32 v229, v45
v_mov_b32 v230, v46
v_mov_b32 v231, v47
s_waitcnt vmcnt(0)
s_barrier
ds_read_b64_tr_b16 v[16:17], v5 offset:0
ds_read_b64_tr_b16 v[18:19], v5 offset:1024
ds_read_b64_tr_b16 v[20:21], v5 offset:4096
ds_read_b64_tr_b16 v[22:23], v5 offset:5120
ds_read_b64_tr_b16 v[24:25], v5 offset:8192
ds_read_b64_tr_b16 v[26:27], v5 offset:9216
ds_read_b64_tr_b16 v[28:29], v5 offset:12288
ds_read_b64_tr_b16 v[30:31], v5 offset:13312
ds_read_b64_tr_b16 v[32:33], v5 offset:16384
ds_read_b64_tr_b16 v[34:35], v5 offset:17408
ds_read_b64_tr_b16 v[36:37], v5 offset:20480
ds_read_b64_tr_b16 v[38:39], v5 offset:21504
ds_read_b64_tr_b16 v[40:41], v9 offset:8192
ds_read_b64_tr_b16 v[42:43], v9 offset:8704
ds_read_b64_tr_b16 v[44:45], v9 offset:10240
ds_read_b64_tr_b16 v[46:47], v9 offset:10752
v_xor_b32 v12, v15, v9
ds_read_b64_tr_b16 v[48:49], v12 offset:16384
ds_read_b64_tr_b16 v[50:51], v12 offset:16896
ds_read_b64_tr_b16 v[52:53], v12 offset:18432
ds_read_b64_tr_b16 v[54:55], v12 offset:18944
ds_read_b64_tr_b16 v[56:57], v6 offset:24576
ds_read_b64_tr_b16 v[58:59], v6 offset:25600
ds_read_b64_tr_b16 v[60:61], v6 offset:28672
ds_read_b64_tr_b16 v[62:63], v6 offset:29696
s_waitcnt lgkmcnt(0)
s_barrier
ds_write_b128 v2, v[16:19] offset:12288
ds_write_b128 v2, v[20:23] offset:13312
ds_write_b128 v2, a[176:179] offset:14336
ds_write_b128 v2, a[180:183] offset:15360
ds_write_b128 v2, v[32:35] offset:16384
ds_write_b128 v2, v[36:39] offset:17408
ds_write_b128 v2, v[248:251] offset:18432
ds_write_b128 v2, v[252:255] offset:19456
ds_write_b128 v2, v[240:243] offset:20480
ds_write_b128 v2, v[244:247] offset:21504
ds_write_b128 v2, v[56:59] offset:22528
ds_write_b128 v2, v[60:63] offset:23552
s_waitcnt lgkmcnt(0)
v_accvgpr_write_b32 a176, v24
v_accvgpr_write_b32 a177, v25
v_accvgpr_write_b32 a178, v26
v_accvgpr_write_b32 a179, v27
v_accvgpr_write_b32 a180, v28
v_accvgpr_write_b32 a181, v29
v_accvgpr_write_b32 a182, v30
v_accvgpr_write_b32 a183, v31
v_mov_b32 v248, v40
v_mov_b32 v249, v41
v_mov_b32 v250, v42
v_mov_b32 v251, v43
v_mov_b32 v252, v44
v_mov_b32 v253, v45
v_mov_b32 v254, v46
v_mov_b32 v255, v47
v_mov_b32 v240, v48
v_mov_b32 v241, v49
v_mov_b32 v242, v50
v_mov_b32 v243, v51
v_mov_b32 v244, v52
v_mov_b32 v245, v53
v_mov_b32 v246, v54
v_mov_b32 v247, v55
s_mov_b32 s12, 0x3030303
s_mov_b32 s13, 0x3030303
s_mov_b32 s14, 0xc0c0c0c
s_mov_b32 s15, 0xc0c0c0c
s_mov_b32 s16, 0x30303030
s_mov_b32 s17, 0x30303030
s_mov_b32 s18, 0xc0c0c0c0
s_mov_b32 s19, 0xc0c0c0c0
s_mov_b32 s8, s4
s_mov_b32 s9, s5
s_cmp_eq_u32 s30, 31
s_cselect_b32 s10, s6, 0
s_waitcnt vmcnt(0)
s_barrier
v_mov_b32 v8, 160
s_barrier
ds_read_b32 v9, v8
s_waitcnt lgkmcnt(0)
v_readfirstlane_b32 s64, v9
v_lshlrev_b32 v23, v0, s58
v_cndmask_b32 v20, 0, v23, s[90:91]
v_cndmask_b32 v21, 0, v23, s[92:93]
v_cndmask_b32 v22, 0, v23, s[94:95]
v_cndmask_b32 v23, 0, v23, s[96:97]
s_branch k_go_268
k_lay_267:
s_add_u32 s47, s31, 63
s_mul_i32 s33, s31, 0
s_add_u32 s33, s33, 120324096
s_add_u32 s34, s33, 5120
s_add_u32 s35, s33, 9216
s_mul_i32 s48, s31, 655360
s_lshl_b32 s36, s30, 14
s_add_u32 s36, s36, s48
s_add_u32 s36, s36, 12288
v_mov_b32 v36, -1
s_lshl_b32 s63, s30, 10
s_add_u32 s63, s63, 0x8000
s_add_u32 s63, s63, s33
s_lshl_b32 s37, s31, 14
s_add_u32 s37, s37, 117443584
s_add_u32 s59, s37, 4096
s_waitcnt vmcnt(0)
s_barrier
v_mov_b32 v8, 160
s_barrier
ds_read_b32 v9, v8
s_waitcnt lgkmcnt(0)
v_readfirstlane_b32 s64, v9
s_waitcnt vmcnt(0)
s_barrier
v_mov_b32 v8, 160
s_barrier
ds_read_b32 v9, v8
s_waitcnt lgkmcnt(0)
v_readfirstlane_b32 s64, v9
v_lshlrev_b32 v23, v0, s58
v_cndmask_b32 v20, 0, v23, s[90:91]
v_cndmask_b32 v21, 0, v23, s[92:93]
v_cndmask_b32 v22, 0, v23, s[94:95]
v_cndmask_b32 v23, 0, v23, s[96:97]
k_go_268:
s_cmp_lg_u32 s64, 0
s_cbranch_scc1 k_far_275
s_mov_b32 s66, 0
k_fl2_291:
buffer_load_dwordx2 v[46:47], off, s[4:7], s46 sc1
s_waitcnt vmcnt(0)
v_min_u32 v46, v46, v47
v_cmp_lt_u32 vcc, s31, v46
v_mov_b64 v[46:47], 0
s_cbranch_vccnz k_cold2_279
s_sub_u32 s32, s32, 1
s_cmp_gt_i32 s32, 0
s_cbranch_scc1 k_fl2_291
s_branch k_cold2_279
k_T0_277:
s_waitcnt vmcnt(2)
v_smfmac_f32_16x16x64_bf16 v[40:43], v[4:7], v[48:55], v1
s_waitcnt vmcnt(1)
v_cmp_u_f32 vcc, v4, v8
v_smfmac_f32_16x16x64_bf16 v[24:27], v[8:11], a[24:31], v1
v_smfmac_f32_16x16x64_bf16 v[28:31], v[8:11], a[32:39], v1
s_cbranch_vccnz k_cold_278
k_okC_280:
s_waitcnt vmcnt(1)
v_smfmac_f32_16x16x64_bf16 v[36:39], v[8:11], a[40:47], v1
s_waitcnt lgkmcnt(0)
ds_read_b128 v[48:51], v2 offset:14336
v_smfmac_f32_16x16x64_bf16 v[32:35], v[4:7], v[64:71], v1
ds_read_b128 v[52:55], v2 offset:15360
ds_read_b128 v[64:67], v0 offset:51200
v_smfmac_f32_16x16x64_bf16 v[44:47], v[4:7], v[56:63], v1
ds_read_b128 v[68:71], v0 offset:52224
v_smfmac_f32_16x16x64_bf16 v[28:31], v[4:7], a[8:15], v1
v_smfmac_f32_16x16x64_bf16 v[24:27], v[4:7], a[0:7], v1
ds_read_b128 v[56:59], v2 offset:43008
v_smfmac_f32_16x16x64_bf16 v[36:39], v[4:7], a[16:23], v1
ds_read_b128 v[60:63], v2 offset:44032
s_waitcnt lgkmcnt(4)
v_smfmac_f32_16x16x64_bf16 v[40:43], v[8:11], v[48:55], v1
s_waitcnt vmcnt(0)
ds_write_b128 v0, v[12:15] offset:3072
s_waitcnt lgkmcnt(3)
v_smfmac_f32_16x16x64_bf16 v[32:35], v[8:11], v[64:71], v1
buffer_load_dwordx4 v[16:19], v0, s[4:7], s35 offen offset:0 sc1
v_cmp_u_f32 vcc, v12, v12
s_waitcnt lgkmcnt(1)
v_smfmac_f32_16x16x64_bf16 v[44:47], v[8:11], v[56:63], v1
ds_read_b128 v[56:59], v2 offset:16384
ds_read_b128 v[60:63], v2 offset:17408
ds_read_b128 v[64:67], v0 offset:61440
s_cbranch_vccnz k_coldA_281
k_okA_282:
v_smfmac_f32_16x16x64_bf16 v[36:39], v[12:15], a[64:71], v1
ds_read_b128 v[68:71], v0 offset:62464
s_waitcnt lgkmcnt(4)
v_smfmac_f32_16x16x64_bf16 v[40:43], v[12:15], a[72:79], v1
s_barrier
v_smfmac_f32_16x16x64_bf16 v[28:31], v[12:15], a[56:63], v1
ds_read_b128 v[8:11], v0 offset:0
buffer_load_dwordx4 v[48:51], v0, s[4:7], s36 offen offset:0 sc1
s_waitcnt lgkmcnt(3)
v_smfmac_f32_16x16x64_bf16 v[44:47], v[12:15], v[56:63], v1
ds_read_b128 v[56:59], v0 offset:63488
v_smfmac_f32_16x16x64_bf16 v[24:27], v[12:15], a[48:55], v1
ds_read_b128 v[60:63], v0 offset:64512
s_waitcnt lgkmcnt(3)
v_smfmac_f32_16x16x64_bf16 v[32:35], v[12:15], v[64:71], v1
buffer_load_dwordx4 v[52:55], v0, s[4:7], s36 offen offset:1024 sc1
s_waitcnt lgkmcnt(2)
v_smfmac_f32_16x16x64_bf16 v[24:27], v[8:11], a[80:87], v1
ds_read_b128 v[64:67], v0 offset:55296
ds_read_b128 v[68:71], v0 offset:56320
v_smfmac_f32_16x16x64_bf16 v[36:39], v[8:11], a[96:103], v1
s_waitcnt lgkmcnt(2)
ds_read_b128 v[4:7], v0 offset:1024
v_smfmac_f32_16x16x64_bf16 v[44:47], v[8:11], v[56:63], v1
ds_read_b128 v[56:59], v2 offset:12288
ds_read_b128 v[60:63], v2 offset:13312
v_smfmac_f32_16x16x64_bf16 v[28:31], v[8:11], a[88:95], v1
buffer_store_dwordx4 v[12:15], v0, s[8:11], s37 offen offset:2048 sc1
v_smfmac_f32_16x16x64_bf16 v[40:43], v[8:11], a[104:111], v1
s_waitcnt lgkmcnt(3)
s_waitcnt lgkmcnt(2)
v_smfmac_f32_16x16x64_bf16 v[32:35], v[8:11], v[64:71], v1
ds_read_b128 v[64:67], v0 offset:57344
ds_read_b128 v[12:15], v0 offset:2048
v_smfmac_f32_16x16x64_bf16 v[36:39], v[4:7], a[128:135], v1
s_waitcnt lgkmcnt(2)
v_smfmac_f32_16x16x64_bf16 v[44:47], v[4:7], v[56:63], v1
ds_read_b128 v[68:71], v0 offset:58368
buffer_load_dwordx4 v[56:59], v0, s[4:7], s36 offen offset:2048 sc1
v_smfmac_f32_16x16x64_bf16 v[28:31], v[4:7], a[120:127], v1
v_smfmac_f32_16x16x64_bf16 v[24:27], v[4:7], a[112:119], v1
s_waitcnt vmcnt(4)
ds_write_b128 v0, v[16:19] offset:7168
v_smfmac_f32_16x16x64_bf16 v[40:43], v[4:7], a[136:143], v1
s_waitcnt lgkmcnt(1)
buffer_load_dwordx4 v[60:63], v0, s[4:7], s36 offen offset:3072 sc1
v_cmp_u_f32 vcc, v16, v16
v_smfmac_f32_16x16x64_bf16 v[32:35], v[4:7], v[64:71], v1
ds_read_b128 v[64:67], v0 offset:59392
ds_read_b128 v[68:71], v0 offset:60416
v_smfmac_f32_16x16x64_bf16 v[28:31], v[12:15], a[152:159], v1
v_smfmac_f32_16x16x64_bf16 v[24:27], v[12:15], a[144:151], v1
s_cbranch_vccnz k_coldB_283
k_okB_284:
v_smfmac_f32_16x16x64_bf16 v[36:39], v[12:15], a[160:167], v1
s_waitcnt lgkmcnt(2)
buffer_store_dwordx4 v[16:19], v0, s[8:11], s59 offen offset:2048 sc1
s_barrier
ds_read_b128 v[4:7], v0 offset:5120
v_smfmac_f32_16x16x64_bf16 v[44:47], v[12:15], a[176:183], v1
ds_read_b128 v[8:11], v0 offset:4096
s_waitcnt lgkmcnt(2)
v_smfmac_f32_16x16x64_bf16 v[32:35], v[12:15], v[64:71], v1
ds_read_b128 v[64:67], v2 offset:22528
ds_read_b128 v[68:71], v2 offset:23552
v_smfmac_f32_16x16x64_bf16 v[24:27], v[16:19], a[184:191], v1
v_smfmac_f32_16x16x64_bf16 v[40:43], v[12:15], a[168:175], v1
s_waitcnt lgkmcnt(3)
ds_read_b128 v[12:15], v0 offset:6144
v_smfmac_f32_16x16x64_bf16 v[24:27], v[4:7], a[208:215], v1
s_waitcnt lgkmcnt(3)
v_smfmac_f32_16x16x64_bf16 v[28:31], v[4:7], a[216:223], v1
v_smfmac_f32_16x16x64_bf16 v[28:31], v[8:11], a[200:207], v1
s_waitcnt lgkmcnt(1)
v_smfmac_f32_16x16x64_bf16 v[24:27], v[8:11], v[64:71], v1
ds_read_b128 v[64:67], v2 offset:18432
s_waitcnt lgkmcnt(1)
v_smfmac_f32_16x16x64_bf16 v[24:27], v[12:15], a[224:231], v1
ds_read_b128 v[68:71], v2 offset:19456
v_smfmac_f32_16x16x64_bf16 v[28:31], v[12:15], a[232:239], v1
v_smfmac_f32_16x16x64_bf16 v[28:31], v[16:19], a[192:199], v1
v_cvt_pk_bf16_f32 v24, v24, v25
v_cvt_pk_bf16_f32 v25, v26, v27
v_smfmac_f32_16x16x64_bf16 v[32:35], v[4:7], v[80:87], v1
v_cvt_pk_bf16_f32 v26, v28, v29
v_cvt_pk_bf16_f32 v27, v30, v31
v_smfmac_f32_16x16x64_bf16 v[32:35], v[8:11], a[248:255], v1
s_waitcnt lgkmcnt(0)
v_mfma_f32_16x16x32_bf16 v[28:31], v[24:27], v[20:23], 0
v_and_b32 v26, 0xffffff7f, v0
v_smfmac_f32_16x16x64_bf16 v[32:35], v[16:19], v[64:71], v1
v_and_or_b32 v26, v1, 8, v26
v_mul_f32 v28, s51, v28
v_mul_f32 v29, s51, v29
v_mul_f32 v31, s51, v31
v_cvt_pk_bf16_f32 v24, v28, v29
v_mul_f32 v30, s51, v30
v_cvt_pk_bf16_f32 v25, v30, v31
v_smfmac_f32_16x16x64_bf16 v[32:35], v[12:15], v[96:103], v1
ds_write_b64 v26, v[24:25] offset:1152
v_smfmac_f32_16x16x64_bf16 v[36:39], v[8:11], v[72:79], v1
v_cvt_pk_bf16_f32 v32, v32, v33
v_smfmac_f32_16x16x64_bf16 v[36:39], v[16:19], a[240:247], v1
buffer_load_dwordx4 v[64:67], v0, s[4:7], s61 offen offset:0
v_cvt_pk_bf16_f32 v33, v34, v35
v_smfmac_f32_16x16x64_bf16 v[36:39], v[12:15], v[104:111], v1
s_waitcnt lgkmcnt(0)
v_smfmac_f32_16x16x64_bf16 v[36:39], v[4:7], v[88:95], v1
s_barrier
ds_read_b128 v[24:27], v0 offset:0
v_smfmac_f32_16x16x64_bf16 v[40:43], v[4:7], v[144:151], v1
ds_read_b128 v[28:31], v0 offset:1024
s_nop 0
v_cvt_pk_bf16_f32 v34, v36, v37
v_cvt_pk_bf16_f32 v35, v38, v39
s_nop 1
v_mfma_f32_16x16x32_bf16 v[36:39], v[32:35], v[20:23], 0
s_waitcnt vmcnt(5)
buffer_load_dwordx4 v[68:71], v0, s[4:7], s61 offen offset:1024
v_and_b32 v34, 0xffffff7f, v0
v_and_or_b32 v34, v1, 8, v34
s_waitcnt lgkmcnt(1)
v_mfma_f32_16x16x32_bf16 v[48:51], v[48:51], v[24:27], 0
v_cvt_pk_bf16_f32 v32, v36, v37
s_waitcnt lgkmcnt(0)
v_mfma_f32_16x16x32_bf16 v[48:51], v[52:55], v[28:31], v[48:51]
v_mov_b64 v[52:53], s[56:57]
v_cvt_pk_bf16_f32 v33, v38, v39
v_smfmac_f32_16x16x64_bf16 v[44:47], v[4:7], v[152:159], v1
ds_write_b64 v34, v[32:33] offset:3200
v_permlane32_swap_b32 v48, v50
v_permlane32_swap_b32 v49, v51
v_add_f32_dpp v52, v50, v48 row_ror:8 row_mask:0xf bank_mask:0x3
v_exp_f32 v52, v52
v_add_f32_dpp v53, v51, v49 row_ror:8 row_mask:0xf bank_mask:0x3
v_exp_f32 v53, v53
s_nop 0
v_cvt_pk_bf16_f32 v48, v52, v53
v_smfmac_f32_16x16x64_bf16 v[44:47], v[16:19], v[120:127], v1
ds_write_b32 v0, v48 offset:4108
v_smfmac_f32_16x16x64_bf16 v[44:47], v[12:15], v[168:175], v1
buffer_load_dwordx4 v[48:51], v0, s[4:7], s61 offen offset:2048
v_smfmac_f32_16x16x64_bf16 v[40:43], v[12:15], v[160:167], v1
s_waitcnt lgkmcnt(1)
v_xor_b32 v12, 0x80, v0
v_smfmac_f32_16x16x64_bf16 v[40:43], v[8:11], v[128:135], v1
s_waitcnt lgkmcnt(0)
s_barrier
ds_read_b128 v[32:35], v0 offset:2048
v_mov_b64 v[22:23], s[52:53]
v_smfmac_f32_16x16x64_bf16 v[40:43], v[16:19], v[112:119], v1
ds_read_b128 v[36:39], v0 offset:3072
ds_read_b128 v[16:19], v0 offset:4096
buffer_load_dwordx4 v[52:55], v0, s[4:7], s61 offen offset:3072
v_smfmac_f32_16x16x64_bf16 v[44:47], v[8:11], v[136:143], v1
ds_read_b128 v[12:15], v12 offset:4096
v_cvt_pk_bf16_f32 v40, v40, v41
v_mov_b64 v[20:21], s[52:53]
s_waitcnt lgkmcnt(3)
v_mfma_f32_16x16x32_bf16 v[24:27], v[32:35], v[24:27], 0
v_cvt_pk_bf16_f32 v41, v42, v43
s_waitcnt lgkmcnt(2)
v_mfma_f32_16x16x32_bf16 v[24:27], v[36:39], v[28:31], v[24:27]
s_waitcnt vmcnt(5)
s_waitcnt lgkmcnt(1)
v_mfma_f32_16x16x32_bf16 v[8:11], v[56:59], v[16:19], 0
buffer_load_dwordx4 v[56:59], v0, s[4:7], s62 offen offset:0
v_mov_b64 v[28:29], s[56:57]
v_cvt_pk_bf16_f32 v43, v46, v47
v_cvt_pk_bf16_f32 v42, v44, v45
v_permlane32_swap_b32 v25, v27
v_permlane32_swap_b32 v24, v26
v_mfma_f32_16x16x32_bf16 v[4:7], v[20:23], v[16:19], 0
s_waitcnt lgkmcnt(0)
v_add_f32_dpp v28, v26, v24 row_ror:8 row_mask:0xf bank_mask:0x3
v_add_f32_dpp v29, v27, v25 row_ror:8 row_mask:0xf bank_mask:0x3
v_exp_f32 v28, v28
v_mfma_f32_16x16x32_bf16 v[8:11], v[60:63], v[12:15], v[8:11]
buffer_load_dwordx4 v[60:63], v0, s[4:7], s62 offen offset:1024
v_exp_f32 v29, v29
v_permlane32_swap_b32 v42, v43
v_cvt_pk_bf16_f32 v24, v28, v29
v_mov_b64 v[44:45], s[54:55]
v_cvt_pk_bf16_f32 v25, v28, v29
v_mov_b32_dpp v26, v24 row_ror:8 row_mask:0xf bank_mask:0xf
v_mov_b32_dpp v27, v24 row_ror:8 row_mask:0xf bank_mask:0xf
v_mfma_f32_16x16x16_bf16 v[4:7], v[44:45], v[24:25], v[4:7]
v_permlane32_swap_b32 v40, v41
v_mov_b64 v[36:37], 0
v_mov_b64 v[38:39], 0
v_mov_b64 v[30:31], 0
v_mfma_f32_16x16x32_bf16 v[8:11], v[40:43], v[24:27], v[8:11]
buffer_load_dwordx4 v[16:19], v0, s[4:7], s62 offen offset:2048
v_rcp_f32 v6, v4
v_and_b32 v12, 0xffffff7f, v0
v_and_or_b32 v13, v1, 8, v12
v_rcp_f32_dpp v6, v4 row_ror:8 row_mask:0xf bank_mask:0xc
v_mov_b64 v[26:27], 0
v_pk_mul_f32 v[8:9], v[8:9], v[6:7] op_sel_hi:[1,0]
v_cvt_pk_bf16_f32 v44, v8, v9
v_pk_mul_f32 v[10:11], v[10:11], v[6:7] op_sel_hi:[1,0]
v_cvt_pk_bf16_f32 v45, v10, v11
s_waitcnt vmcnt(5)
ds_write_b64 v13, v[44:45] offset:7296
buffer_load_dwordx4 v[20:23], v0, s[4:7], s62 offen offset:3072
v_add_u32 v6, 0xd4800000, v6
v_cmp_lt_u32 vcc, 0x28000000, v6
v_mov_b64 v[34:35], 0
v_mov_b32_dpp v46, v44 row_ror:8 row_mask:0xf bank_mask:0xf
v_mov_b32_dpp v47, v45 row_ror:8 row_mask:0xf bank_mask:0xf
v_mov_b64 v[28:29], 0
v_mov_b64 v[32:33], 0
s_cbranch_vccnz k_slow_285
k_okS_286:
v_smfmac_f32_16x16x64_bf16 v[36:39], v[44:47], v[224:231], v1
s_waitcnt lgkmcnt(0)
s_barrier
ds_read_b128 v[8:11], v12 offset:6272
v_smfmac_f32_16x16x64_bf16 v[32:35], v[44:47], v[200:207], v1
s_waitcnt vmcnt(4)
ds_read_b128 v[4:7], v12 offset:6144
v_mov_b64 v[24:25], 0
v_smfmac_f32_16x16x64_bf16 v[28:31], v[44:47], v[48:55], v1
ds_read_b128 v[12:15], v12 offset:7168
ds_read_b128 v[48:51], v2 offset:40960
v_smfmac_f32_16x16x64_bf16 v[24:27], v[44:47], v[64:71], v1
ds_read_b128 v[52:55], v2 offset:41984
v_mov_b64 v[42:43], 0
s_waitcnt lgkmcnt(4)
v_smfmac_f32_16x16x64_bf16 v[24:27], v[8:11], v[184:191], v1
s_waitcnt lgkmcnt(3)
v_mov_b64 v[40:41], 0
v_smfmac_f32_16x16x64_bf16 v[24:27], v[4:7], v[176:183], v1
s_waitcnt lgkmcnt(2)
ds_read_b128 v[64:67], v2 offset:20480
v_smfmac_f32_16x16x64_bf16 v[24:27], v[12:15], v[192:199], v1
ds_read_b128 v[68:71], v2 offset:21504
v_smfmac_f32_16x16x64_bf16 v[40:43], v[44:47], v[240:247], v1
s_waitcnt vmcnt(2)
s_waitcnt lgkmcnt(2)
v_lshrrev_b32 v44, 16, v1
v_cvt_pk_bf16_f32 v24, v24, v25
v_bfi_b32 v24, 1, s45, v24
v_cvt_pk_bf16_f32 v25, v26, v27
v_smfmac_f32_16x16x64_bf16 v[28:31], v[8:11], v[48:55], v1
buffer_store_dwordx2 v[24:25], v44, s[4:7], s38 offen
ds_read_b128 v[48:51], v2 offset:38912
ds_read_b128 v[52:55], v2 offset:39936
v_smfmac_f32_16x16x64_bf16 v[28:31], v[12:15], v[56:63], v1
s_waitcnt lgkmcnt(2)
ds_read_b128 v[56:59], v2 offset:45056
v_smfmac_f32_16x16x64_bf16 v[28:31], v[4:7], v[64:71], v1
ds_read_b128 v[60:63], v2 offset:46080
v_smfmac_f32_16x16x64_bf16 v[32:35], v[8:11], v[208:215], v1
ds_read_b128 v[64:67], v2 offset:36864
s_nop 0
v_cvt_pk_bf16_f32 v28, v28, v29
v_bfi_b32 v28, 1, s45, v28
v_cvt_pk_bf16_f32 v29, v30, v31
v_smfmac_f32_16x16x64_bf16 v[32:35], v[12:15], v[216:223], v1
buffer_store_dwordx2 v[28:29], v44, s[4:7], s39 offen
v_smfmac_f32_16x16x64_bf16 v[40:43], v[12:15], v[248:255], v1
ds_read_b128 v[68:71], v2 offset:37888
s_waitcnt vmcnt(2)
v_smfmac_f32_16x16x64_bf16 v[32:35], v[4:7], v[16:23], v1
s_waitcnt lgkmcnt(2)
v_smfmac_f32_16x16x64_bf16 v[36:39], v[12:15], v[232:239], v1
ds_read_b128 v[16:19], v2 offset:47104
ds_read_b128 v[20:23], v2 offset:48128
v_cvt_pk_bf16_f32 v32, v32, v33
v_bfi_b32 v32, 1, s45, v32
v_cvt_pk_bf16_f32 v33, v34, v35
v_smfmac_f32_16x16x64_bf16 v[36:39], v[8:11], v[48:55], v1
buffer_store_dwordx2 v[32:33], v44, s[4:7], s40 offen
s_waitcnt lgkmcnt(2)
v_smfmac_f32_16x16x64_bf16 v[36:39], v[4:7], v[64:71], v1
s_nop 6
v_cvt_pk_bf16_f32 v36, v36, v37
v_cvt_pk_bf16_f32 v37, v38, v39
s_waitcnt lgkmcnt(0)
v_bfi_b32 v36, 1, s45, v36
v_smfmac_f32_16x16x64_bf16 v[40:43], v[8:11], v[16:23], v1
buffer_store_dwordx2 v[36:37], v44, s[4:7], s41 offen
v_smfmac_f32_16x16x64_bf16 v[40:43], v[4:7], v[56:63], v1
s_nop 6
v_cvt_pk_bf16_f32 v40, v40, v41
v_bfi_b32 v40, 1, s45, v40
v_cvt_pk_bf16_f32 v41, v42, v43
buffer_store_dwordx2 v[40:41], v44, s[4:7], s42 offen
s_barrier
buffer_load_dwordx4 v[48:51], v0, s[4:7], s60 offen offset:0
buffer_load_dwordx4 v[52:55], v0, s[4:7], s60 offen offset:1024
buffer_load_dwordx4 v[56:59], v0, s[4:7], s60 offen offset:2048
buffer_load_dwordx4 v[60:63], v0, s[4:7], s60 offen offset:3072
s_add_u32 s31, s31, 1
s_min_u32 s66, s66, s67
s_cmp_gt_u32 s66, s31
s_cbranch_scc0 k_fl_290
k_okF_292:
s_buffer_load_dwordx2 s[66:67], s[4:7], s46 glc
s_add_u32 s33, s33, 16384
s_bitset0_b32 s33, 16
s_barrier
buffer_load_dwordx4 v[4:7], v0, s[4:7], s33 offen offset:1024 sc1
buffer_load_dwordx4 v[8:11], v0, s[4:7], s33 offen offset:0 sc1
s_add_u32 s34, s33, 5120
s_add_u32 s35, s33, 9216
s_add_u32 s36, s36, 524288
s_add_u32 s37, s37, 10240
s_add_u32 s59, s59, 10240
v_mov_b64 v[32:33], 0
v_mov_b64 v[34:35], 0
v_mov_b64 v[36:37], 0
v_mov_b64 v[38:39], 0
v_mov_b64 v[40:41], 0
v_mov_b64 v[42:43], 0
v_mov_b64 v[44:45], 0
v_mov_b64 v[46:47], 0
s_sub_u32 s45, s45, 1
v_mov_b64 v[24:25], 0
v_mov_b64 v[26:27], 0
v_mov_b64 v[28:29], 0
v_mov_b64 v[30:31], 0
v_lshlrev_b32 v23, v0, s58
v_cndmask_b32 v20, 0, v23, s[90:91]
v_cndmask_b32 v21, 0, v23, s[92:93]
v_cndmask_b32 v22, 0, v23, s[94:95]
v_cndmask_b32 v23, 0, v23, s[96:97]
ds_read_b128 v[64:67], v0 offset:53248
ds_read_b128 v[68:71], v0 offset:54272
s_waitcnt lgkmcnt(0)
buffer_load_dwordx4 v[12:15], v0, s[4:7], s34 offen offset:0 sc1
s_cmp_lg_u32 s31, s47
s_cbranch_scc1 k_T0_277
s_branch k_done_287
k_cold2_279:
s_barrier
buffer_load_dwordx4 v[48:51], v0, s[4:7], s60 offen offset:0
buffer_load_dwordx4 v[52:55], v0, s[4:7], s60 offen offset:1024
buffer_load_dwordx4 v[56:59], v0, s[4:7], s60 offen offset:2048
buffer_load_dwordx4 v[60:63], v0, s[4:7], s60 offen offset:3072
ds_read_b128 v[64:67], v0 offset:53248
ds_read_b128 v[68:71], v0 offset:54272
k_cold_278:
buffer_load_dwordx4 v[4:7], v0, s[4:7], s33 offen offset:1024 sc1
buffer_load_dwordx4 v[8:11], v0, s[4:7], s33 offen offset:0 sc1
buffer_load_dwordx4 v[12:15], v0, s[4:7], s34 offen offset:0 sc1
s_sub_u32 s32, s32, 1
s_cmp_gt_i32 s32, 0
s_cbranch_scc0 k_okC_280
v_mov_b64 v[24:25], 0
v_mov_b64 v[26:27], 0
v_mov_b64 v[28:29], 0
v_mov_b64 v[30:31], 0
v_mov_b64 v[32:33], 0
v_mov_b64 v[34:35], 0
v_mov_b64 v[36:37], 0
v_mov_b64 v[38:39], 0
v_mov_b64 v[40:41], 0
v_mov_b64 v[42:43], 0
v_mov_b64 v[44:45], 0
v_mov_b64 v[46:47], 0
s_branch k_T0_277
k_coldA_281:
buffer_load_dwordx4 v[12:15], v0, s[4:7], s34 offen offset:0 sc1
s_sub_u32 s32, s32, 1
s_cmp_gt_i32 s32, 0
s_waitcnt vmcnt(0)
v_cmp_u_f32 vcc, v12, v12
ds_write_b128 v0, v[12:15] offset:3072
s_waitcnt lgkmcnt(0)
s_cbranch_vccz k_okA_282
s_cbranch_scc1 k_coldA_281
s_branch k_okA_282
k_coldB_283:
buffer_load_dwordx4 v[16:19], v0, s[4:7], s35 offen offset:0 sc1
s_sub_u32 s32, s32, 1
s_cmp_gt_i32 s32, 0
s_waitcnt vmcnt(0)
v_cmp_u_f32 vcc, v16, v16
ds_write_b128 v0, v[16:19] offset:7168
s_waitcnt lgkmcnt(0)
s_cbranch_vccz k_okB_284
s_cbranch_scc1 k_coldB_283
s_branch k_okB_284
k_fl_290:
buffer_load_dwordx2 v[46:47], off, s[4:7], s46 sc1
s_waitcnt vmcnt(0)
v_min_u32 v46, v46, v47
v_cmp_lt_u32 vcc, s31, v46
v_mov_b64 v[46:47], 0
s_cbranch_vccnz k_okF_292
s_sub_u32 s32, s32, 1
s_cmp_gt_i32 s32, 0
s_cbranch_scc1 k_fl_290
s_branch k_okF_292
k_slow_285:
ds_read_b128 v[24:27], v0 offset:0
ds_read_b128 v[28:31], v0 offset:1024
v_mov_b32 v46, 0xff7fffff
s_add_u32 s48, s36, 0xffffd000
buffer_load_dwordx4 v[32:35], v0, s[4:7], s48 offen offset:0 sc1
buffer_load_dwordx4 v[36:39], v0, s[4:7], s48 offen offset:1024 sc1
s_waitcnt vmcnt(1) lgkmcnt(1)
v_mfma_f32_16x16x32_bf16 v[4:7], v[32:35], v[24:27], 0
s_waitcnt vmcnt(0) lgkmcnt(0)
v_mfma_f32_16x16x32_bf16 v[4:7], v[36:39], v[28:31], v[4:7]
v_mov_b64 v[8:9], s[56:57]
s_nop 5
v_permlane32_swap_b32 v4, v6
v_permlane32_swap_b32 v5, v7
v_add_f32_dpp v8, v6, v4 row_ror:8 row_mask:0xf bank_mask:0x3
s_nop 0
v_add_f32_dpp v9, v7, v5 row_ror:8 row_mask:0xf bank_mask:0x3
v_max3_f32 v46, v46, v8, v9
s_add_u32 s48, s36, 0xffffe000
buffer_load_dwordx4 v[32:35], v0, s[4:7], s48 offen offset:0 sc1
buffer_load_dwordx4 v[36:39], v0, s[4:7], s48 offen offset:1024 sc1
s_waitcnt vmcnt(1)
v_mfma_f32_16x16x32_bf16 v[4:7], v[32:35], v[24:27], 0
s_waitcnt vmcnt(0)
v_mfma_f32_16x16x32_bf16 v[4:7], v[36:39], v[28:31], v[4:7]
v_mov_b64 v[10:11], s[56:57]
s_nop 5
v_permlane32_swap_b32 v4, v6
v_permlane32_swap_b32 v5, v7
v_add_f32_dpp v10, v6, v4 row_ror:8 row_mask:0xf bank_mask:0x3
s_nop 0
v_add_f32_dpp v11, v7, v5 row_ror:8 row_mask:0xf bank_mask:0x3
v_max3_f32 v46, v46, v10, v11
s_add_u32 s48, s36, 0xfffff000
buffer_load_dwordx4 v[32:35], v0, s[4:7], s48 offen offset:0 sc1
buffer_load_dwordx4 v[36:39], v0, s[4:7], s48 offen offset:1024 sc1
s_waitcnt vmcnt(1)
v_mfma_f32_16x16x32_bf16 v[4:7], v[32:35], v[24:27], 0
s_waitcnt vmcnt(0)
v_mfma_f32_16x16x32_bf16 v[4:7], v[36:39], v[28:31], v[4:7]
v_mov_b64 v[12:13], s[56:57]
s_nop 5
v_permlane32_swap_b32 v4, v6
v_permlane32_swap_b32 v5, v7
v_add_f32_dpp v12, v6, v4 row_ror:8 row_mask:0xf bank_mask:0x3
s_nop 0
v_add_f32_dpp v13, v7, v5 row_ror:8 row_mask:0xf bank_mask:0x3
v_max3_f32 v46, v46, v12, v13
s_add_u32 s48, s36, 0x0
buffer_load_dwordx4 v[32:35], v0, s[4:7], s48 offen offset:0 sc1
buffer_load_dwordx4 v[36:39], v0, s[4:7], s48 offen offset:1024 sc1
s_waitcnt vmcnt(1)
v_mfma_f32_16x16x32_bf16 v[4:7], v[32:35], v[24:27], 0
s_waitcnt vmcnt(0)
v_mfma_f32_16x16x32_bf16 v[4:7], v[36:39], v[28:31], v[4:7]
v_mov_b64 v[14:15], s[56:57]
s_nop 5
v_permlane32_swap_b32 v4, v6
v_permlane32_swap_b32 v5, v7
v_add_f32_dpp v14, v6, v4 row_ror:8 row_mask:0xf bank_mask:0x3
s_nop 0
v_add_f32_dpp v15, v7, v5 row_ror:8 row_mask:0xf bank_mask:0x3
v_max3_f32 v46, v46, v14, v15
ds_read_b128 v[32:35], v0 offset:2048
ds_read_b128 v[36:39], v0 offset:3072
s_waitcnt lgkmcnt(1)
v_mfma_f32_16x16x32_bf16 v[4:7], v[32:35], v[24:27], 0
s_waitcnt lgkmcnt(0)
v_mfma_f32_16x16x32_bf16 v[4:7], v[36:39], v[28:31], v[4:7]
v_mov_b64 v[44:45], s[56:57]
s_nop 5
v_permlane32_swap_b32 v4, v6
v_permlane32_swap_b32 v5, v7
v_add_f32_dpp v44, v6, v4 row_ror:8 row_mask:0xf bank_mask:0x3
s_nop 0
v_add_f32_dpp v45, v7, v5 row_ror:8 row_mask:0xf bank_mask:0x3
v_max3_f32 v46, v46, v44, v45
buffer_load_dwordx4 v[32:35], v0, s[4:7], s36 offen offset:2048 sc1
buffer_load_dwordx4 v[36:39], v0, s[4:7], s36 offen offset:3072 sc1
v_mov_b32 v47, v46
s_nop 1
v_permlane32_swap_b32 v46, v47
v_max_f32 v46, v46, v47
v_mov_b32 v47, v46
s_nop 1
v_permlane16_swap_b32 v46, v47
v_max_f32 v46, v46, v47
v_sub_f32 v8, v8, v46
v_exp_f32 v8, v8
v_sub_f32 v9, v9, v46
v_exp_f32 v9, v9
v_sub_f32 v10, v10, v46
v_exp_f32 v10, v10
v_sub_f32 v11, v11, v46
v_exp_f32 v11, v11
v_sub_f32 v12, v12, v46
v_exp_f32 v12, v12
v_sub_f32 v13, v13, v46
v_exp_f32 v13, v13
v_sub_f32 v14, v14, v46
v_exp_f32 v14, v14
v_sub_f32 v15, v15, v46
v_exp_f32 v15, v15
v_sub_f32 v44, v44, v46
v_exp_f32 v44, v44
v_sub_f32 v45, v45, v46
v_exp_f32 v45, v45
v_cvt_pk_bf16_f32 v4, v8, v9
v_cvt_pk_bf16_f32 v5, v10, v11
v_cvt_pk_bf16_f32 v6, v12, v13
v_cvt_pk_bf16_f32 v7, v14, v15
v_mov_b32_dpp v8, v4 row_ror:8 row_mask:0xf bank_mask:0xf
v_mov_b32_dpp v9, v5 row_ror:8 row_mask:0xf bank_mask:0xf
v_mov_b32_dpp v10, v6 row_ror:8 row_mask:0xf bank_mask:0xf
v_mov_b32_dpp v11, v7 row_ror:8 row_mask:0xf bank_mask:0xf
v_cvt_pk_bf16_f32 v24, v44, v45
v_cvt_pk_bf16_f32 v25, v44, v45
s_nop 0
v_mov_b32_dpp v26, v24 row_ror:8 row_mask:0xf bank_mask:0xf
v_mov_b32_dpp v27, v24 row_ror:8 row_mask:0xf bank_mask:0xf
v_mov_b64 v[28:29], s[52:53]
v_mov_b64 v[30:31], s[52:53]
s_nop 1
v_mfma_f32_16x16x32_bf16 v[44:47], v[28:31], v[4:7], 0
s_waitcnt vmcnt(1)
v_mfma_f32_16x16x32_bf16 v[12:15], v[32:35], v[4:7], 0
s_waitcnt vmcnt(0)
v_mfma_f32_16x16x32_bf16 v[12:15], v[36:39], v[8:11], v[12:15]
v_mfma_f32_16x16x32_bf16 v[12:15], v[40:43], v[24:27], v[12:15]
v_mov_b64 v[28:29], s[54:55]
s_nop 1
v_mfma_f32_16x16x16_bf16 v[44:47], v[28:29], v[24:25], v[44:47]
s_nop 6
v_rcp_f32 v4, v44
s_nop 1
v_rcp_f32_dpp v4, v44 row_ror:8 row_mask:0xf bank_mask:0xc
s_nop 0
v_mul_f32 v12, v4, v12
v_mul_f32 v13, v4, v13
v_mul_f32 v14, v4, v14
v_mul_f32 v15, v4, v15
v_cvt_pk_bf16_f32 v44, v12, v13
v_cvt_pk_bf16_f32 v45, v14, v15
v_and_b32 v12, 0xffffff7f, v0
v_and_or_b32 v8, v1, 8, v12
ds_write_b64 v8, v[44:45] offset:7296
v_mov_b32_dpp v46, v44 row_ror:8 row_mask:0xf bank_mask:0xf
v_mov_b32_dpp v47, v45 row_ror:8 row_mask:0xf bank_mask:0xf
v_mov_b64 v[24:25], 0
v_mov_b64 v[26:27], 0
v_mov_b64 v[28:29], 0
v_mov_b64 v[30:31], 0
v_mov_b64 v[32:33], 0
v_mov_b64 v[34:35], 0
v_mov_b64 v[36:37], 0
v_mov_b64 v[38:39], 0
s_waitcnt lgkmcnt(0)
s_branch k_okS_286
k_done_287:
buffer_load_dwordx4 v[16:19], v0, s[4:7], s35 offen offset:0 sc1
k_xs_293:
s_waitcnt vmcnt(1)
v_cmp_u_f32 vcc, v4, v12
s_waitcnt vmcnt(0)
v_cmp_u_f32 s[66:67], v16, v16
s_or_b64 vcc, vcc, s[66:67]
s_cbranch_vccz k_xd_294
buffer_load_dwordx4 v[4:7], v0, s[4:7], s33 offen offset:1024 sc1
buffer_load_dwordx4 v[8:11], v0, s[4:7], s33 offen offset:0 sc1
buffer_load_dwordx4 v[12:15], v0, s[4:7], s34 offen offset:0 sc1
buffer_load_dwordx4 v[16:19], v0, s[4:7], s35 offen offset:0 sc1
s_sub_u32 s32, s32, 1
s_cmp_gt_i32 s32, 0
s_cbranch_scc1 k_xs_293
k_xd_294:
s_waitcnt vmcnt(1)
buffer_store_dwordx4 v[12:15], v0, s[8:11], s37 offen offset:2048 sc1
s_waitcnt vmcnt(1)
buffer_store_dwordx4 v[16:19], v0, s[8:11], s59 offen offset:2048 sc1
s_add_u32 s31, s31, 1
s_branch k_jn_276
k_far_275:
s_mov_b32 s66, 0
k_fl2_309:
buffer_load_dwordx2 v[46:47], off, s[4:7], s46 sc1
s_waitcnt vmcnt(0)
v_min_u32 v46, v46, v47
v_cmp_lt_u32 vcc, s31, v46
v_mov_b64 v[46:47], 0
s_cbranch_vccnz k_cold2_297
s_sub_u32 s32, s32, 1
s_cmp_gt_i32 s32, 0
s_cbranch_scc1 k_fl2_309
s_branch k_cold2_297
k_T0_295:
s_waitcnt vmcnt(2)
v_smfmac_f32_16x16x64_bf16 v[40:43], v[4:7], v[48:55], v1
s_waitcnt vmcnt(1)
v_cmp_u_f32 vcc, v4, v8
v_smfmac_f32_16x16x64_bf16 v[24:27], v[8:11], a[24:31], v1
v_smfmac_f32_16x16x64_bf16 v[28:31], v[8:11], a[32:39], v1
s_cbranch_vccnz k_cold_296
k_okC_298:
s_waitcnt vmcnt(1)
v_smfmac_f32_16x16x64_bf16 v[36:39], v[8:11], a[40:47], v1
s_waitcnt lgkmcnt(0)
ds_read_b128 v[48:51], v2 offset:14336
v_smfmac_f32_16x16x64_bf16 v[32:35], v[4:7], v[64:71], v1
ds_read_b128 v[52:55], v2 offset:15360
ds_read_b128 v[64:67], v0 offset:51200
v_smfmac_f32_16x16x64_bf16 v[44:47], v[4:7], v[56:63], v1
ds_read_b128 v[68:71], v0 offset:52224
v_smfmac_f32_16x16x64_bf16 v[28:31], v[4:7], a[8:15], v1
v_smfmac_f32_16x16x64_bf16 v[24:27], v[4:7], a[0:7], v1
ds_read_b128 v[56:59], v2 offset:43008
v_smfmac_f32_16x16x64_bf16 v[36:39], v[4:7], a[16:23], v1
ds_read_b128 v[60:63], v2 offset:44032
s_waitcnt lgkmcnt(4)
v_smfmac_f32_16x16x64_bf16 v[40:43], v[8:11], v[48:55], v1
s_waitcnt vmcnt(0)
ds_write_b128 v0, v[12:15] offset:3072
s_waitcnt lgkmcnt(3)
v_smfmac_f32_16x16x64_bf16 v[32:35], v[8:11], v[64:71], v1
buffer_load_dwordx4 v[16:19], v0, s[4:7], s35 offen offset:0 sc1
v_cmp_u_f32 vcc, v12, v12
s_waitcnt lgkmcnt(1)
v_smfmac_f32_16x16x64_bf16 v[44:47], v[8:11], v[56:63], v1
ds_read_b128 v[56:59], v2 offset:16384
ds_read_b128 v[60:63], v2 offset:17408
ds_read_b128 v[64:67], v0 offset:61440
s_cbranch_vccnz k_coldA_299
k_okA_300:
v_smfmac_f32_16x16x64_bf16 v[36:39], v[12:15], a[64:71], v1
ds_read_b128 v[68:71], v0 offset:62464
s_waitcnt lgkmcnt(4)
v_smfmac_f32_16x16x64_bf16 v[40:43], v[12:15], a[72:79], v1
s_barrier
v_smfmac_f32_16x16x64_bf16 v[28:31], v[12:15], a[56:63], v1
ds_read_b128 v[8:11], v0 offset:0
buffer_load_dwordx4 v[48:51], v0, s[4:7], s36 offen offset:0 sc1
s_waitcnt lgkmcnt(3)
v_smfmac_f32_16x16x64_bf16 v[44:47], v[12:15], v[56:63], v1
ds_read_b128 v[56:59], v0 offset:63488
v_smfmac_f32_16x16x64_bf16 v[24:27], v[12:15], a[48:55], v1
ds_read_b128 v[60:63], v0 offset:64512
s_waitcnt lgkmcnt(3)
v_smfmac_f32_16x16x64_bf16 v[32:35], v[12:15], v[64:71], v1
buffer_load_dwordx4 v[52:55], v0, s[4:7], s36 offen offset:1024 sc1
s_waitcnt lgkmcnt(2)
v_smfmac_f32_16x16x64_bf16 v[24:27], v[8:11], a[80:87], v1
ds_read_b128 v[64:67], v0 offset:55296
ds_read_b128 v[68:71], v0 offset:56320
v_smfmac_f32_16x16x64_bf16 v[36:39], v[8:11], a[96:103], v1
s_waitcnt lgkmcnt(2)
ds_read_b128 v[4:7], v0 offset:1024
v_smfmac_f32_16x16x64_bf16 v[44:47], v[8:11], v[56:63], v1
ds_read_b128 v[56:59], v2 offset:12288
ds_read_b128 v[60:63], v2 offset:13312
v_smfmac_f32_16x16x64_bf16 v[28:31], v[8:11], a[88:95], v1
buffer_store_dwordx4 v[12:15], v0, s[8:11], s37 offen offset:2048 sc1
v_smfmac_f32_16x16x64_bf16 v[40:43], v[8:11], a[104:111], v1
s_waitcnt lgkmcnt(3)
s_waitcnt lgkmcnt(2)
v_smfmac_f32_16x16x64_bf16 v[32:35], v[8:11], v[64:71], v1
ds_read_b128 v[64:67], v0 offset:57344
ds_read_b128 v[12:15], v0 offset:2048
v_smfmac_f32_16x16x64_bf16 v[36:39], v[4:7], a[128:135], v1
s_waitcnt lgkmcnt(2)
v_smfmac_f32_16x16x64_bf16 v[44:47], v[4:7], v[56:63], v1
ds_read_b128 v[68:71], v0 offset:58368
buffer_load_dwordx4 v[56:59], v0, s[4:7], s36 offen offset:2048 sc1
v_smfmac_f32_16x16x64_bf16 v[28:31], v[4:7], a[120:127], v1
v_smfmac_f32_16x16x64_bf16 v[24:27], v[4:7], a[112:119], v1
s_waitcnt vmcnt(4)
ds_write_b128 v0, v[16:19] offset:7168
v_smfmac_f32_16x16x64_bf16 v[40:43], v[4:7], a[136:143], v1
s_waitcnt lgkmcnt(1)
buffer_load_dwordx4 v[60:63], v0, s[4:7], s36 offen offset:3072 sc1
v_cmp_u_f32 vcc, v16, v16
v_smfmac_f32_16x16x64_bf16 v[32:35], v[4:7], v[64:71], v1
ds_read_b128 v[64:67], v0 offset:59392
ds_read_b128 v[68:71], v0 offset:60416
v_smfmac_f32_16x16x64_bf16 v[28:31], v[12:15], a[152:159], v1
v_smfmac_f32_16x16x64_bf16 v[24:27], v[12:15], a[144:151], v1
s_cbranch_vccnz k_coldB_301
k_okB_302:
v_smfmac_f32_16x16x64_bf16 v[36:39], v[12:15], a[160:167], v1
s_waitcnt lgkmcnt(2)
buffer_store_dwordx4 v[16:19], v0, s[8:11], s59 offen offset:2048 sc1
s_barrier
ds_read_b128 v[4:7], v0 offset:5120
v_smfmac_f32_16x16x64_bf16 v[44:47], v[12:15], a[176:183], v1
ds_read_b128 v[8:11], v0 offset:4096
s_waitcnt lgkmcnt(2)
v_smfmac_f32_16x16x64_bf16 v[32:35], v[12:15], v[64:71], v1
ds_read_b128 v[64:67], v2 offset:22528
ds_read_b128 v[68:71], v2 offset:23552
v_smfmac_f32_16x16x64_bf16 v[24:27], v[16:19], a[184:191], v1
v_smfmac_f32_16x16x64_bf16 v[40:43], v[12:15], a[168:175], v1
s_waitcnt lgkmcnt(3)
ds_read_b128 v[12:15], v0 offset:6144
v_smfmac_f32_16x16x64_bf16 v[24:27], v[4:7], a[208:215], v1
s_waitcnt lgkmcnt(3)
v_smfmac_f32_16x16x64_bf16 v[28:31], v[4:7], a[216:223], v1
v_smfmac_f32_16x16x64_bf16 v[28:31], v[8:11], a[200:207], v1
s_waitcnt lgkmcnt(1)
v_smfmac_f32_16x16x64_bf16 v[24:27], v[8:11], v[64:71], v1
ds_read_b128 v[64:67], v2 offset:18432
s_waitcnt lgkmcnt(1)
v_smfmac_f32_16x16x64_bf16 v[24:27], v[12:15], a[224:231], v1
ds_read_b128 v[68:71], v2 offset:19456
v_smfmac_f32_16x16x64_bf16 v[28:31], v[12:15], a[232:239], v1
v_smfmac_f32_16x16x64_bf16 v[28:31], v[16:19], a[192:199], v1
v_cvt_pk_bf16_f32 v24, v24, v25
v_cvt_pk_bf16_f32 v25, v26, v27
v_smfmac_f32_16x16x64_bf16 v[32:35], v[4:7], v[80:87], v1
v_cvt_pk_bf16_f32 v26, v28, v29
v_cvt_pk_bf16_f32 v27, v30, v31
v_smfmac_f32_16x16x64_bf16 v[32:35], v[8:11], a[248:255], v1
s_waitcnt lgkmcnt(0)
v_mfma_f32_16x16x32_bf16 v[28:31], v[24:27], v[20:23], 0
v_and_b32 v26, 0xffffff7f, v0
v_smfmac_f32_16x16x64_bf16 v[32:35], v[16:19], v[64:71], v1
v_and_or_b32 v26, v1, 8, v26
v_mul_f32 v28, s51, v28
v_mul_f32 v29, s51, v29
v_mul_f32 v31, s51, v31
v_cvt_pk_bf16_f32 v24, v28, v29
v_mul_f32 v30, s51, v30
v_cvt_pk_bf16_f32 v25, v30, v31
v_smfmac_f32_16x16x64_bf16 v[32:35], v[12:15], v[96:103], v1
ds_write_b64 v26, v[24:25] offset:1152
v_smfmac_f32_16x16x64_bf16 v[36:39], v[8:11], v[72:79], v1
v_cvt_pk_bf16_f32 v32, v32, v33
v_smfmac_f32_16x16x64_bf16 v[36:39], v[16:19], a[240:247], v1
buffer_load_dwordx4 v[64:67], v0, s[4:7], s61 offen offset:0
v_cvt_pk_bf16_f32 v33, v34, v35
v_smfmac_f32_16x16x64_bf16 v[36:39], v[12:15], v[104:111], v1
s_waitcnt lgkmcnt(0)
v_smfmac_f32_16x16x64_bf16 v[36:39], v[4:7], v[88:95], v1
s_barrier
ds_read_b128 v[24:27], v0 offset:0
v_smfmac_f32_16x16x64_bf16 v[40:43], v[4:7], v[144:151], v1
ds_read_b128 v[28:31], v0 offset:1024
s_nop 0
v_cvt_pk_bf16_f32 v34, v36, v37
v_cvt_pk_bf16_f32 v35, v38, v39
s_nop 1
v_mfma_f32_16x16x32_bf16 v[36:39], v[32:35], v[20:23], 0
s_waitcnt vmcnt(5)
buffer_load_dwordx4 v[68:71], v0, s[4:7], s61 offen offset:1024
v_and_b32 v34, 0xffffff7f, v0
v_and_or_b32 v34, v1, 8, v34
s_waitcnt lgkmcnt(1)
v_mfma_f32_16x16x32_bf16 v[48:51], v[48:51], v[24:27], 0
v_cvt_pk_bf16_f32 v32, v36, v37
s_waitcnt lgkmcnt(0)
v_mfma_f32_16x16x32_bf16 v[48:51], v[52:55], v[28:31], v[48:51]
v_mov_b64 v[52:53], s[56:57]
v_cvt_pk_bf16_f32 v33, v38, v39
v_smfmac_f32_16x16x64_bf16 v[44:47], v[4:7], v[152:159], v1
ds_write_b64 v34, v[32:33] offset:3200
v_permlane32_swap_b32 v48, v50
v_permlane32_swap_b32 v49, v51
v_add_f32_dpp v52, v50, v48 row_ror:8 row_mask:0xf bank_mask:0x3
v_exp_f32 v52, v52
v_add_f32_dpp v53, v51, v49 row_ror:8 row_mask:0xf bank_mask:0x3
v_exp_f32 v53, v53
s_nop 0
v_cvt_pk_bf16_f32 v48, v52, v53
v_smfmac_f32_16x16x64_bf16 v[44:47], v[16:19], v[120:127], v1
ds_write_b32 v0, v48 offset:4108
v_smfmac_f32_16x16x64_bf16 v[44:47], v[12:15], v[168:175], v1
buffer_load_dwordx4 v[48:51], v0, s[4:7], s61 offen offset:2048
v_smfmac_f32_16x16x64_bf16 v[40:43], v[12:15], v[160:167], v1
s_waitcnt lgkmcnt(1)
v_xor_b32 v12, 0x80, v0
v_smfmac_f32_16x16x64_bf16 v[40:43], v[8:11], v[128:135], v1
s_waitcnt lgkmcnt(0)
s_barrier
ds_read_b128 v[32:35], v0 offset:2048
v_mov_b64 v[22:23], s[52:53]
v_smfmac_f32_16x16x64_bf16 v[40:43], v[16:19], v[112:119], v1
ds_read_b128 v[36:39], v0 offset:3072
ds_read_b128 v[16:19], v0 offset:4096
buffer_load_dwordx4 v[52:55], v0, s[4:7], s61 offen offset:3072
v_smfmac_f32_16x16x64_bf16 v[44:47], v[8:11], v[136:143], v1
ds_read_b128 v[12:15], v12 offset:4096
v_cvt_pk_bf16_f32 v40, v40, v41
v_mov_b64 v[20:21], s[52:53]
s_waitcnt lgkmcnt(3)
v_mfma_f32_16x16x32_bf16 v[24:27], v[32:35], v[24:27], 0
v_cvt_pk_bf16_f32 v41, v42, v43
s_waitcnt lgkmcnt(2)
v_mfma_f32_16x16x32_bf16 v[24:27], v[36:39], v[28:31], v[24:27]
s_waitcnt vmcnt(5)
s_waitcnt lgkmcnt(1)
v_mfma_f32_16x16x32_bf16 v[8:11], v[56:59], v[16:19], 0
buffer_load_dwordx4 v[56:59], v0, s[4:7], s62 offen offset:0
v_mov_b64 v[28:29], s[56:57]
v_cvt_pk_bf16_f32 v43, v46, v47
v_cvt_pk_bf16_f32 v42, v44, v45
v_permlane32_swap_b32 v25, v27
v_permlane32_swap_b32 v24, v26
v_mfma_f32_16x16x32_bf16 v[4:7], v[20:23], v[16:19], 0
s_waitcnt lgkmcnt(0)
v_add_f32_dpp v28, v26, v24 row_ror:8 row_mask:0xf bank_mask:0x3
v_add_f32_dpp v29, v27, v25 row_ror:8 row_mask:0xf bank_mask:0x3
v_exp_f32 v28, v28
v_mfma_f32_16x16x32_bf16 v[8:11], v[60:63], v[12:15], v[8:11]
buffer_load_dwordx4 v[60:63], v0, s[4:7], s62 offen offset:1024
v_exp_f32 v29, v29
v_permlane32_swap_b32 v42, v43
v_cvt_pk_bf16_f32 v24, v28, v29
v_mov_b64 v[44:45], s[54:55]
v_cvt_pk_bf16_f32 v25, v28, v29
v_mov_b32_dpp v26, v24 row_ror:8 row_mask:0xf bank_mask:0xf
v_mov_b32_dpp v27, v24 row_ror:8 row_mask:0xf bank_mask:0xf
v_mfma_f32_16x16x16_bf16 v[4:7], v[44:45], v[24:25], v[4:7]
v_permlane32_swap_b32 v40, v41
v_mov_b64 v[36:37], 0
v_mov_b64 v[38:39], 0
v_mov_b64 v[30:31], 0
v_mfma_f32_16x16x32_bf16 v[8:11], v[40:43], v[24:27], v[8:11]
buffer_load_dwordx4 v[16:19], v0, s[4:7], s62 offen offset:2048
v_rcp_f32 v6, v4
v_and_b32 v12, 0xffffff7f, v0
v_and_or_b32 v13, v1, 8, v12
v_rcp_f32_dpp v6, v4 row_ror:8 row_mask:0xf bank_mask:0xc
v_mov_b64 v[26:27], 0
v_pk_mul_f32 v[8:9], v[8:9], v[6:7] op_sel_hi:[1,0]
v_cvt_pk_bf16_f32 v44, v8, v9
v_pk_mul_f32 v[10:11], v[10:11], v[6:7] op_sel_hi:[1,0]
v_cvt_pk_bf16_f32 v45, v10, v11
s_waitcnt vmcnt(5)
ds_write_b64 v13, v[44:45] offset:7296
buffer_load_dwordx4 v[20:23], v0, s[4:7], s62 offen offset:3072
v_add_u32 v6, 0xd4800000, v6
v_cmp_lt_u32 vcc, 0x28000000, v6
v_mov_b64 v[34:35], 0
v_mov_b32_dpp v46, v44 row_ror:8 row_mask:0xf bank_mask:0xf
v_mov_b32_dpp v47, v45 row_ror:8 row_mask:0xf bank_mask:0xf
v_mov_b64 v[28:29], 0
v_mov_b64 v[32:33], 0
s_cbranch_vccnz k_slow_303
k_okS_304:
v_smfmac_f32_16x16x64_bf16 v[36:39], v[44:47], v[224:231], v1
s_waitcnt lgkmcnt(0)
s_barrier
ds_read_b128 v[8:11], v12 offset:6272
v_smfmac_f32_16x16x64_bf16 v[32:35], v[44:47], v[200:207], v1
s_waitcnt vmcnt(4)
ds_read_b128 v[4:7], v12 offset:6144
v_mov_b64 v[24:25], 0
v_smfmac_f32_16x16x64_bf16 v[28:31], v[44:47], v[48:55], v1
ds_read_b128 v[12:15], v12 offset:7168
ds_read_b128 v[48:51], v2 offset:40960
v_smfmac_f32_16x16x64_bf16 v[24:27], v[44:47], v[64:71], v1
ds_read_b128 v[52:55], v2 offset:41984
v_mov_b64 v[42:43], 0
s_waitcnt lgkmcnt(4)
v_smfmac_f32_16x16x64_bf16 v[24:27], v[8:11], v[184:191], v1
s_waitcnt lgkmcnt(3)
v_mov_b64 v[40:41], 0
v_smfmac_f32_16x16x64_bf16 v[24:27], v[4:7], v[176:183], v1
s_waitcnt lgkmcnt(2)
ds_read_b128 v[64:67], v2 offset:20480
v_smfmac_f32_16x16x64_bf16 v[24:27], v[12:15], v[192:199], v1
ds_read_b128 v[68:71], v2 offset:21504
v_smfmac_f32_16x16x64_bf16 v[40:43], v[44:47], v[240:247], v1
s_waitcnt vmcnt(2)
s_waitcnt lgkmcnt(2)
v_lshrrev_b32 v44, 16, v1
v_cvt_pk_bf16_f32 v24, v24, v25
v_bfi_b32 v24, 1, s45, v24
v_cvt_pk_bf16_f32 v25, v26, v27
v_smfmac_f32_16x16x64_bf16 v[28:31], v[8:11], v[48:55], v1
buffer_store_dwordx2 v[24:25], v44, s[4:7], s38 offen sc1
ds_read_b128 v[48:51], v2 offset:38912
ds_read_b128 v[52:55], v2 offset:39936
v_smfmac_f32_16x16x64_bf16 v[28:31], v[12:15], v[56:63], v1
s_waitcnt lgkmcnt(2)
ds_read_b128 v[56:59], v2 offset:45056
v_smfmac_f32_16x16x64_bf16 v[28:31], v[4:7], v[64:71], v1
ds_read_b128 v[60:63], v2 offset:46080
v_smfmac_f32_16x16x64_bf16 v[32:35], v[8:11], v[208:215], v1
ds_read_b128 v[64:67], v2 offset:36864
s_nop 0
v_cvt_pk_bf16_f32 v28, v28, v29
v_bfi_b32 v28, 1, s45, v28
v_cvt_pk_bf16_f32 v29, v30, v31
v_smfmac_f32_16x16x64_bf16 v[32:35], v[12:15], v[216:223], v1
buffer_store_dwordx2 v[28:29], v44, s[4:7], s39 offen sc1
v_smfmac_f32_16x16x64_bf16 v[40:43], v[12:15], v[248:255], v1
ds_read_b128 v[68:71], v2 offset:37888
s_waitcnt vmcnt(2)
v_smfmac_f32_16x16x64_bf16 v[32:35], v[4:7], v[16:23], v1
s_waitcnt lgkmcnt(2)
v_smfmac_f32_16x16x64_bf16 v[36:39], v[12:15], v[232:239], v1
ds_read_b128 v[16:19], v2 offset:47104
ds_read_b128 v[20:23], v2 offset:48128
v_cvt_pk_bf16_f32 v32, v32, v33
v_bfi_b32 v32, 1, s45, v32
v_cvt_pk_bf16_f32 v33, v34, v35
v_smfmac_f32_16x16x64_bf16 v[36:39], v[8:11], v[48:55], v1
buffer_store_dwordx2 v[32:33], v44, s[4:7], s40 offen sc1
s_waitcnt lgkmcnt(2)
v_smfmac_f32_16x16x64_bf16 v[36:39], v[4:7], v[64:71], v1
s_nop 6
v_cvt_pk_bf16_f32 v36, v36, v37
v_cvt_pk_bf16_f32 v37, v38, v39
s_waitcnt lgkmcnt(0)
v_bfi_b32 v36, 1, s45, v36
v_smfmac_f32_16x16x64_bf16 v[40:43], v[8:11], v[16:23], v1
buffer_store_dwordx2 v[36:37], v44, s[4:7], s41 offen sc1
v_smfmac_f32_16x16x64_bf16 v[40:43], v[4:7], v[56:63], v1
s_nop 6
v_cvt_pk_bf16_f32 v40, v40, v41
v_bfi_b32 v40, 1, s45, v40
v_cvt_pk_bf16_f32 v41, v42, v43
buffer_store_dwordx2 v[40:41], v44, s[4:7], s42 offen sc1
s_barrier
buffer_load_dwordx4 v[48:51], v0, s[4:7], s60 offen offset:0
buffer_load_dwordx4 v[52:55], v0, s[4:7], s60 offen offset:1024
buffer_load_dwordx4 v[56:59], v0, s[4:7], s60 offen offset:2048
buffer_load_dwordx4 v[60:63], v0, s[4:7], s60 offen offset:3072
s_add_u32 s31, s31, 1
s_min_u32 s66, s66, s67
s_cmp_gt_u32 s66, s31
s_cbranch_scc0 k_fl_308
k_okF_310:
s_buffer_load_dwordx2 s[66:67], s[4:7], s46 glc
s_add_u32 s33, s33, 16384
s_bitset0_b32 s33, 16
s_barrier
buffer_load_dwordx4 v[4:7], v0, s[4:7], s33 offen offset:1024 sc1
buffer_load_dwordx4 v[8:11], v0, s[4:7], s33 offen offset:0 sc1
s_add_u32 s34, s33, 5120
s_add_u32 s35, s33, 9216
s_add_u32 s36, s36, 524288
s_add_u32 s37, s37, 10240
s_add_u32 s59, s59, 10240
v_mov_b64 v[32:33], 0
v_mov_b64 v[34:35], 0
v_mov_b64 v[36:37], 0
v_mov_b64 v[38:39], 0
v_mov_b64 v[40:41], 0
v_mov_b64 v[42:43], 0
v_mov_b64 v[44:45], 0
v_mov_b64 v[46:47], 0
s_sub_u32 s45, s45, 1
v_mov_b64 v[24:25], 0
v_mov_b64 v[26:27], 0
v_mov_b64 v[28:29], 0
v_mov_b64 v[30:31], 0
v_lshlrev_b32 v23, v0, s58
v_cndmask_b32 v20, 0, v23, s[90:91]
v_cndmask_b32 v21, 0, v23, s[92:93]
v_cndmask_b32 v22, 0, v23, s[94:95]
v_cndmask_b32 v23, 0, v23, s[96:97]
ds_read_b128 v[64:67], v0 offset:53248
ds_read_b128 v[68:71], v0 offset:54272
s_waitcnt lgkmcnt(0)
buffer_load_dwordx4 v[12:15], v0, s[4:7], s34 offen offset:0 sc1
s_cmp_lg_u32 s31, s47
s_cbranch_scc1 k_T0_295
s_branch k_done_305
k_cold2_297:
s_barrier
buffer_load_dwordx4 v[48:51], v0, s[4:7], s60 offen offset:0
buffer_load_dwordx4 v[52:55], v0, s[4:7], s60 offen offset:1024
buffer_load_dwordx4 v[56:59], v0, s[4:7], s60 offen offset:2048
buffer_load_dwordx4 v[60:63], v0, s[4:7], s60 offen offset:3072
ds_read_b128 v[64:67], v0 offset:53248
ds_read_b128 v[68:71], v0 offset:54272
k_cold_296:
buffer_load_dwordx4 v[4:7], v0, s[4:7], s33 offen offset:1024 sc1
buffer_load_dwordx4 v[8:11], v0, s[4:7], s33 offen offset:0 sc1
buffer_load_dwordx4 v[12:15], v0, s[4:7], s34 offen offset:0 sc1
s_sub_u32 s32, s32, 1
s_cmp_gt_i32 s32, 0
s_cbranch_scc0 k_okC_298
v_mov_b64 v[24:25], 0
v_mov_b64 v[26:27], 0
v_mov_b64 v[28:29], 0
v_mov_b64 v[30:31], 0
v_mov_b64 v[32:33], 0
v_mov_b64 v[34:35], 0
v_mov_b64 v[36:37], 0
v_mov_b64 v[38:39], 0
v_mov_b64 v[40:41], 0
v_mov_b64 v[42:43], 0
v_mov_b64 v[44:45], 0
v_mov_b64 v[46:47], 0
s_branch k_T0_295
k_coldA_299:
buffer_load_dwordx4 v[12:15], v0, s[4:7], s34 offen offset:0 sc1
s_sub_u32 s32, s32, 1
s_cmp_gt_i32 s32, 0
s_waitcnt vmcnt(0)
v_cmp_u_f32 vcc, v12, v12
ds_write_b128 v0, v[12:15] offset:3072
s_waitcnt lgkmcnt(0)
s_cbranch_vccz k_okA_300
s_cbranch_scc1 k_coldA_299
s_branch k_okA_300
k_coldB_301:
buffer_load_dwordx4 v[16:19], v0, s[4:7], s35 offen offset:0 sc1
s_sub_u32 s32, s32, 1
s_cmp_gt_i32 s32, 0
s_waitcnt vmcnt(0)
v_cmp_u_f32 vcc, v16, v16
ds_write_b128 v0, v[16:19] offset:7168
s_waitcnt lgkmcnt(0)
s_cbranch_vccz k_okB_302
s_cbranch_scc1 k_coldB_301
s_branch k_okB_302
k_fl_308:
buffer_load_dwordx2 v[46:47], off, s[4:7], s46 sc1
s_waitcnt vmcnt(0)
v_min_u32 v46, v46, v47
v_cmp_lt_u32 vcc, s31, v46
v_mov_b64 v[46:47], 0
s_cbranch_vccnz k_okF_310
s_sub_u32 s32, s32, 1
s_cmp_gt_i32 s32, 0
s_cbranch_scc1 k_fl_308
s_branch k_okF_310
k_slow_303:
ds_read_b128 v[24:27], v0 offset:0
ds_read_b128 v[28:31], v0 offset:1024
v_mov_b32 v46, 0xff7fffff
s_add_u32 s48, s36, 0xffffd000
buffer_load_dwordx4 v[32:35], v0, s[4:7], s48 offen offset:0 sc1
buffer_load_dwordx4 v[36:39], v0, s[4:7], s48 offen offset:1024 sc1
s_waitcnt vmcnt(1) lgkmcnt(1)
v_mfma_f32_16x16x32_bf16 v[4:7], v[32:35], v[24:27], 0
s_waitcnt vmcnt(0) lgkmcnt(0)
v_mfma_f32_16x16x32_bf16 v[4:7], v[36:39], v[28:31], v[4:7]
v_mov_b64 v[8:9], s[56:57]
s_nop 5
v_permlane32_swap_b32 v4, v6
v_permlane32_swap_b32 v5, v7
v_add_f32_dpp v8, v6, v4 row_ror:8 row_mask:0xf bank_mask:0x3
s_nop 0
v_add_f32_dpp v9, v7, v5 row_ror:8 row_mask:0xf bank_mask:0x3
v_max3_f32 v46, v46, v8, v9
s_add_u32 s48, s36, 0xffffe000
buffer_load_dwordx4 v[32:35], v0, s[4:7], s48 offen offset:0 sc1
buffer_load_dwordx4 v[36:39], v0, s[4:7], s48 offen offset:1024 sc1
s_waitcnt vmcnt(1)
v_mfma_f32_16x16x32_bf16 v[4:7], v[32:35], v[24:27], 0
s_waitcnt vmcnt(0)
v_mfma_f32_16x16x32_bf16 v[4:7], v[36:39], v[28:31], v[4:7]
v_mov_b64 v[10:11], s[56:57]
s_nop 5
v_permlane32_swap_b32 v4, v6
v_permlane32_swap_b32 v5, v7
v_add_f32_dpp v10, v6, v4 row_ror:8 row_mask:0xf bank_mask:0x3
s_nop 0
v_add_f32_dpp v11, v7, v5 row_ror:8 row_mask:0xf bank_mask:0x3
v_max3_f32 v46, v46, v10, v11
s_add_u32 s48, s36, 0xfffff000
buffer_load_dwordx4 v[32:35], v0, s[4:7], s48 offen offset:0 sc1
buffer_load_dwordx4 v[36:39], v0, s[4:7], s48 offen offset:1024 sc1
s_waitcnt vmcnt(1)
v_mfma_f32_16x16x32_bf16 v[4:7], v[32:35], v[24:27], 0
s_waitcnt vmcnt(0)
v_mfma_f32_16x16x32_bf16 v[4:7], v[36:39], v[28:31], v[4:7]
v_mov_b64 v[12:13], s[56:57]
s_nop 5
v_permlane32_swap_b32 v4, v6
v_permlane32_swap_b32 v5, v7
v_add_f32_dpp v12, v6, v4 row_ror:8 row_mask:0xf bank_mask:0x3
s_nop 0
v_add_f32_dpp v13, v7, v5 row_ror:8 row_mask:0xf bank_mask:0x3
v_max3_f32 v46, v46, v12, v13
s_add_u32 s48, s36, 0x0
buffer_load_dwordx4 v[32:35], v0, s[4:7], s48 offen offset:0 sc1
buffer_load_dwordx4 v[36:39], v0, s[4:7], s48 offen offset:1024 sc1
s_waitcnt vmcnt(1)
v_mfma_f32_16x16x32_bf16 v[4:7], v[32:35], v[24:27], 0
s_waitcnt vmcnt(0)
v_mfma_f32_16x16x32_bf16 v[4:7], v[36:39], v[28:31], v[4:7]
v_mov_b64 v[14:15], s[56:57]
s_nop 5
v_permlane32_swap_b32 v4, v6
v_permlane32_swap_b32 v5, v7
v_add_f32_dpp v14, v6, v4 row_ror:8 row_mask:0xf bank_mask:0x3
s_nop 0
v_add_f32_dpp v15, v7, v5 row_ror:8 row_mask:0xf bank_mask:0x3
v_max3_f32 v46, v46, v14, v15
ds_read_b128 v[32:35], v0 offset:2048
ds_read_b128 v[36:39], v0 offset:3072
s_waitcnt lgkmcnt(1)
v_mfma_f32_16x16x32_bf16 v[4:7], v[32:35], v[24:27], 0
s_waitcnt lgkmcnt(0)
v_mfma_f32_16x16x32_bf16 v[4:7], v[36:39], v[28:31], v[4:7]
v_mov_b64 v[44:45], s[56:57]
s_nop 5
v_permlane32_swap_b32 v4, v6
v_permlane32_swap_b32 v5, v7
v_add_f32_dpp v44, v6, v4 row_ror:8 row_mask:0xf bank_mask:0x3
s_nop 0
v_add_f32_dpp v45, v7, v5 row_ror:8 row_mask:0xf bank_mask:0x3
v_max3_f32 v46, v46, v44, v45
buffer_load_dwordx4 v[32:35], v0, s[4:7], s36 offen offset:2048 sc1
buffer_load_dwordx4 v[36:39], v0, s[4:7], s36 offen offset:3072 sc1
v_mov_b32 v47, v46
s_nop 1
v_permlane32_swap_b32 v46, v47
v_max_f32 v46, v46, v47
v_mov_b32 v47, v46
s_nop 1
v_permlane16_swap_b32 v46, v47
v_max_f32 v46, v46, v47
v_sub_f32 v8, v8, v46
v_exp_f32 v8, v8
v_sub_f32 v9, v9, v46
v_exp_f32 v9, v9
v_sub_f32 v10, v10, v46
v_exp_f32 v10, v10
v_sub_f32 v11, v11, v46
v_exp_f32 v11, v11
v_sub_f32 v12, v12, v46
v_exp_f32 v12, v12
v_sub_f32 v13, v13, v46
v_exp_f32 v13, v13
v_sub_f32 v14, v14, v46
v_exp_f32 v14, v14
v_sub_f32 v15, v15, v46
v_exp_f32 v15, v15
v_sub_f32 v44, v44, v46
v_exp_f32 v44, v44
v_sub_f32 v45, v45, v46
v_exp_f32 v45, v45
v_cvt_pk_bf16_f32 v4, v8, v9
v_cvt_pk_bf16_f32 v5, v10, v11
v_cvt_pk_bf16_f32 v6, v12, v13
v_cvt_pk_bf16_f32 v7, v14, v15
v_mov_b32_dpp v8, v4 row_ror:8 row_mask:0xf bank_mask:0xf
v_mov_b32_dpp v9, v5 row_ror:8 row_mask:0xf bank_mask:0xf
v_mov_b32_dpp v10, v6 row_ror:8 row_mask:0xf bank_mask:0xf
v_mov_b32_dpp v11, v7 row_ror:8 row_mask:0xf bank_mask:0xf
v_cvt_pk_bf16_f32 v24, v44, v45
v_cvt_pk_bf16_f32 v25, v44, v45
s_nop 0
v_mov_b32_dpp v26, v24 row_ror:8 row_mask:0xf bank_mask:0xf
v_mov_b32_dpp v27, v24 row_ror:8 row_mask:0xf bank_mask:0xf
v_mov_b64 v[28:29], s[52:53]
v_mov_b64 v[30:31], s[52:53]
s_nop 1
v_mfma_f32_16x16x32_bf16 v[44:47], v[28:31], v[4:7], 0
s_waitcnt vmcnt(1)
v_mfma_f32_16x16x32_bf16 v[12:15], v[32:35], v[4:7], 0
s_waitcnt vmcnt(0)
v_mfma_f32_16x16x32_bf16 v[12:15], v[36:39], v[8:11], v[12:15]
v_mfma_f32_16x16x32_bf16 v[12:15], v[40:43], v[24:27], v[12:15]
v_mov_b64 v[28:29], s[54:55]
s_nop 1
v_mfma_f32_16x16x16_bf16 v[44:47], v[28:29], v[24:25], v[44:47]
s_nop 6
v_rcp_f32 v4, v44
s_nop 1
v_rcp_f32_dpp v4, v44 row_ror:8 row_mask:0xf bank_mask:0xc
s_nop 0
v_mul_f32 v12, v4, v12
v_mul_f32 v13, v4, v13
v_mul_f32 v14, v4, v14
v_mul_f32 v15, v4, v15
v_cvt_pk_bf16_f32 v44, v12, v13
v_cvt_pk_bf16_f32 v45, v14, v15
v_and_b32 v12, 0xffffff7f, v0
v_and_or_b32 v8, v1, 8, v12
ds_write_b64 v8, v[44:45] offset:7296
v_mov_b32_dpp v46, v44 row_ror:8 row_mask:0xf bank_mask:0xf
v_mov_b32_dpp v47, v45 row_ror:8 row_mask:0xf bank_mask:0xf
v_mov_b64 v[24:25], 0
v_mov_b64 v[26:27], 0
v_mov_b64 v[28:29], 0
v_mov_b64 v[30:31], 0
v_mov_b64 v[32:33], 0
v_mov_b64 v[34:35], 0
v_mov_b64 v[36:37], 0
v_mov_b64 v[38:39], 0
s_waitcnt lgkmcnt(0)
s_branch k_okS_304
k_done_305:
buffer_load_dwordx4 v[16:19], v0, s[4:7], s35 offen offset:0 sc1
k_xs_311:
s_waitcnt vmcnt(1)
v_cmp_u_f32 vcc, v4, v12
s_waitcnt vmcnt(0)
v_cmp_u_f32 s[66:67], v16, v16
s_or_b64 vcc, vcc, s[66:67]
s_cbranch_vccz k_xd_312
buffer_load_dwordx4 v[4:7], v0, s[4:7], s33 offen offset:1024 sc1
buffer_load_dwordx4 v[8:11], v0, s[4:7], s33 offen offset:0 sc1
buffer_load_dwordx4 v[12:15], v0, s[4:7], s34 offen offset:0 sc1
buffer_load_dwordx4 v[16:19], v0, s[4:7], s35 offen offset:0 sc1
s_sub_u32 s32, s32, 1
s_cmp_gt_i32 s32, 0
s_cbranch_scc1 k_xs_311
k_xd_312:
s_waitcnt vmcnt(1)
buffer_store_dwordx4 v[12:15], v0, s[8:11], s37 offen offset:2048 sc1
s_waitcnt vmcnt(1)
buffer_store_dwordx4 v[16:19], v0, s[8:11], s59 offen offset:2048 sc1
s_add_u32 s31, s31, 1
k_jn_276:
s_cmp_lt_u32 s31, 128
s_cbranch_scc1 k_lay_267
s_add_u32 s30, s30, 112
s_waitcnt vmcnt(0) lgkmcnt(0)
s_barrier
s_branch k_fin_7
.section .rodata,"a"
.p2align 6
.amdhsa_kernel interleave_layers__memory_aug_recurrent_mem_tr__spectral_gfnet__prompt_kernel
  .amdhsa_next_free_vgpr 512
  .amdhsa_next_free_sgpr 102
  .amdhsa_accum_offset 256
  .amdhsa_group_segment_fixed_size 0
  .amdhsa_kernarg_size 104
  .amdhsa_user_sgpr_count 2
  .amdhsa_user_sgpr_kernarg_segment_ptr 1
  .amdhsa_system_sgpr_workgroup_id_x 1
  .amdhsa_float_denorm_mode_32 3
.end_amdhsa_kernel
```
